```python
import torch

def _softmax(x, axis=-1):
    return torch.softmax(x, dim=axis)
def _gelu(x):
    return torch.nn.functional.gelu(x, approximate="tanh")
def _silu(x):
    return torch.nn.functional.silu(x)
def _sigmoid(x):
    return torch.sigmoid(x)
def _layernorm(x, axis=-1, eps=1e-5):
    m = x.mean(dim=axis, keepdim=True)
    v = x.var(dim=axis, keepdim=True, unbiased=False)
    return (x - m) / torch.sqrt(v + eps)
def _scatter_add(tgt, idx, src, axis=0):
    return tgt.clone().index_add_(axis, idx, src)
def _segment_sum(src, seg, n):
    out = torch.zeros((n,) + src.shape[1:], dtype=src.dtype)
    return out.index_add_(0, seg, src)
def _pad(x, pw):
    flat = tuple(v for pair in reversed(pw) for v in pair)
    return torch.nn.functional.pad(x, flat)

kernel_name = 'concat_heads__ssm_conv_h3__linear_attn_block__prompt'

def setup_inputs():

    _w = (lambda a: (lambda t: t.to(torch.bfloat16) if t.is_floating_point() else t)(torch.as_tensor(a)))
    def _A_setup():
        B, S, D = 1, 2048, 1024
        ks = 4
        return {
            "q": _w((lambda *s: torch.randn(*s, dtype=torch.bfloat16) * 0.05)(B, S, D)),
            "k": _w((lambda *s: torch.randn(*s, dtype=torch.bfloat16) * 0.4)(B, S, D)),
            "v": _w((lambda *s: torch.randn(*s, dtype=torch.bfloat16) * 0.4)(B, S, D)),
            "shift_k": _w((lambda *s: torch.randn(*s, dtype=torch.bfloat16) * 0.4)(D, ks) * 0.5),
            "ssm_k": _w((lambda *s: torch.randn(*s, dtype=torch.bfloat16) * 1.6)(D, S) * (1.0 / S ** 0.5)),
            "ssm_D": _w((lambda *s: torch.randn(*s, dtype=torch.bfloat16) * 0.4)(D)),
        }
    _A_in = _A_setup()

    def _B_setup():
        B, S, D = 1, 2048, 1024
        return {
            "x": _w((lambda *s: torch.randn(*s, dtype=torch.bfloat16) * 0.05)(B, S, D)),
            "wqkv": _w((lambda *s: torch.randn(*s, dtype=torch.bfloat16) * 0.8)(D, 3 * D)),
            "wo": _w((lambda *s: torch.randn(*s, dtype=torch.bfloat16) * 0.05)(D, D)),
        }
    _B_in = _B_setup()

    return {
        "A_q": _A_in["q"],
        "A_k": _A_in["k"],
        "A_v": _A_in["v"],
        "A_shift_k": _A_in["shift_k"],
        "A_ssm_k": _A_in["ssm_k"],
        "A_ssm_D": _A_in["ssm_D"],
        "B_x": _B_in["x"],
        "B_wqkv": _B_in["wqkv"],
        "B_wo": _B_in["wo"],
    }

def reference(A_q, A_k, A_v, A_shift_k, A_ssm_k, A_ssm_D, B_x, B_wqkv, B_wo):
    def _A_ref(q, k, v, shift_k, ssm_k, ssm_D):
        B, S, D = q.shape
        ks = shift_k.shape[-1]
        k_pad = _pad(k, ((0, 0), (ks - 1, 0), (0, 0)))
        k_shift = torch.zeros_like(k)
        for t in range(ks):
            k_shift = k_shift + k_pad[:, t:t + S, :] * shift_k[:, ks - 1 - t][None, None, :]
        kv = k_shift * v
        L = 2 * S
        kv_pad = _pad(kv, ((0, 0), (0, S), (0, 0)))
        kf_pad = _pad(ssm_k, ((0, 0), (0, S)))
        kv_f = (lambda x, axes=(-2,-1): torch.fft.rfft2(x.float(), dim=axes))(kv_pad[:, None, :, :], axes=(1, 2))
        kf_f = (lambda x, axes=(-2,-1): torch.fft.rfft2(x.float(), dim=axes))(kf_pad[:, None, :], axes=(1, 2))
        kf_f = (lambda x, *d: x.permute(*d))(kf_f, 1, 2, 0)
        y_f = kv_f * kf_f[None, :, :, :]
        y = (lambda x, s, axes=(-2,-1): torch.fft.irfft2(x, s=s, dim=axes).to(torch.bfloat16))(y_f, (1, L), axes=(1, 2))[:, 0, :S, :]
        y = y + kv * ssm_D[None, None, :]
        return q * y

    def _B_ref(x, wqkv, wo):
        B, S, D = x.shape
        H = 32; Dh = D // H
        qkv = (lambda x, *d: x.permute(*d))((x @ wqkv).reshape(B, S, 3, H, Dh), 2, 0, 3, 1, 4)
        q, k, v = qkv[0], qkv[1], qkv[2]
        phi = lambda t: torch.where(t > 0, t + 1, torch.exp(t)) + 1e-6
        pq, pk = phi(q), phi(k)
        kv = torch.einsum("bhsd,bhse->bhde", pk, v)
        z = torch.einsum("bhsd->bhd", pk)
        num = torch.einsum("bhqd,bhde->bhqe", pq, kv)
        den = torch.einsum("bhqd,bhd->bhq", pq, z)[..., None] + 1e-6
        o = num / den
        return (lambda x, *d: x.permute(*d))(o, 0, 2, 1, 3).reshape(B, S, D) @ wo

    a = _A_ref(A_q, A_k, A_v, A_shift_k, A_ssm_k, A_ssm_D)
    b = _B_ref(B_x, B_wqkv, B_wo)
    return torch.concatenate([a, b], axis=-1)
```

```asm
; @launch kernel=pre_kernel grid=(128,1,1) block=(256,1,1) lds=0
; @launch kernel=g1_kernel grid=(256,1,1) block=(512,1,1) lds=163840
; @launch kernel=conv_kernel grid=(256,1,1) block=(256,1,1) lds=36864
; @launch kernel=opass_kernel grid=(128,1,1) block=(256,1,1) lds=32768
; @launch kernel=g2_kernel grid=(256,1,1) block=(512,1,1) lds=131072
; @launch kernel=post_kernel grid=(128,1,1) block=(256,1,1) lds=0
.amdgcn_target "amdgcn-amd-amdhsa--gfx950"
.text
.globl pre_kernel
.p2align 8
.type pre_kernel,@function
pre_kernel:
  s_cmp_ge_u32 s2, 128
  s_cbranch_scc1 PR_end
  s_load_dwordx4 s[4:7], s[0:1], 8
  s_load_dwordx2 s[10:11], s[0:1], 24
  s_load_dwordx2 s[8:9], s[0:1], 88
  v_lshrrev_b32 v1, 6, v0
  v_and_b32 v2, 63, v0
  s_lshl_b32 s12, s2, 2
  v_readfirstlane_b32 s3, v1
  v_and_b32 v3, 7, v2
  v_lshrrev_b32 v4, 3, v2
  s_add_u32 s12, s12, s3
  s_and_b32 s13, s12, 15
  s_lshr_b32 s14, s12, 4
  s_waitcnt lgkmcnt(0)
  s_mov_b32 s16, s4
  s_mov_b32 s17, s5
  s_mov_b32 s18, 4194304
  s_mov_b32 s19, 0x20000
  s_mov_b32 s20, s6
  s_mov_b32 s21, s7
  s_mov_b32 s22, 4194304
  s_mov_b32 s23, 0x20000
  s_mov_b32 s24, s10
  s_mov_b32 s25, s11
  s_mov_b32 s26, 8192
  s_mov_b32 s27, 0x20000
  s_add_u32 s28, s8, 16777216
  s_addc_u32 s29, s9, 0
  s_mov_b32 s30, 4194304
  s_mov_b32 s31, 0x20000
  s_lshl_b32 s15, s14, 17
  s_lshl_b32 s32, s13, 7
  s_add_u32 s15, s15, s32
  v_lshlrev_b32 v5, 14, v4
  v_lshl_add_u32 v5, v3, 4, v5
  v_add_u32 v5, s15, v5
  s_lshl_b32 s32, s13, 9
  v_lshlrev_b32 v6, 6, v3
  buffer_load_dwordx4 v[8:11], v6, s[24:27], s32 offen offset:0
  buffer_load_dwordx4 v[12:15], v6, s[24:27], s32 offen offset:16
  buffer_load_dwordx4 v[16:19], v6, s[24:27], s32 offen offset:32
  buffer_load_dwordx4 v[20:23], v6, s[24:27], s32 offen offset:48
  v_add_u32 v7, 4294961152, v5
  buffer_load_dwordx4 v[24:27], v7, s[16:19], 0 offen
  v_add_u32 v7, 4294963200, v5
  buffer_load_dwordx4 v[28:31], v7, s[16:19], 0 offen
  v_add_u32 v7, 4294965248, v5
  buffer_load_dwordx4 v[32:35], v7, s[16:19], 0 offen
  v_add_u32 v7, 0, v5
  buffer_load_dwordx4 v[36:39], v7, s[16:19], 0 offen
  v_add_u32 v7, 2048, v5
  buffer_load_dwordx4 v[40:43], v7, s[16:19], 0 offen
  v_add_u32 v7, 4096, v5
  buffer_load_dwordx4 v[44:47], v7, s[16:19], 0 offen
  v_add_u32 v7, 6144, v5
  buffer_load_dwordx4 v[48:51], v7, s[16:19], 0 offen
  v_add_u32 v7, 8192, v5
  buffer_load_dwordx4 v[52:55], v7, s[16:19], 0 offen
  v_add_u32 v7, 10240, v5
  buffer_load_dwordx4 v[56:59], v7, s[16:19], 0 offen
  v_add_u32 v7, 12288, v5
  buffer_load_dwordx4 v[60:63], v7, s[16:19], 0 offen
  v_add_u32 v7, 14336, v5
  buffer_load_dwordx4 v[64:67], v7, s[16:19], 0 offen
  v_add_u32 v7, 0, v5
  buffer_load_dwordx4 v[68:71], v7, s[20:23], 0 offen
  v_add_u32 v7, 2048, v5
  buffer_load_dwordx4 v[72:75], v7, s[20:23], 0 offen
  v_add_u32 v7, 4096, v5
  buffer_load_dwordx4 v[76:79], v7, s[20:23], 0 offen
  v_add_u32 v7, 6144, v5
  buffer_load_dwordx4 v[80:83], v7, s[20:23], 0 offen
  v_add_u32 v7, 8192, v5
  buffer_load_dwordx4 v[84:87], v7, s[20:23], 0 offen
  v_add_u32 v7, 10240, v5
  buffer_load_dwordx4 v[88:91], v7, s[20:23], 0 offen
  v_add_u32 v7, 12288, v5
  buffer_load_dwordx4 v[92:95], v7, s[20:23], 0 offen
  v_add_u32 v7, 14336, v5
  buffer_load_dwordx4 v[96:99], v7, s[20:23], 0 offen
  s_waitcnt vmcnt(19)
  v_lshlrev_b32 v100, 16, v8
  v_and_b32 v108, 0xffff0000, v8
  v_lshlrev_b32 v116, 16, v9
  v_and_b32 v124, 0xffff0000, v9
  v_lshlrev_b32 v101, 16, v10
  v_and_b32 v109, 0xffff0000, v10
  v_lshlrev_b32 v117, 16, v11
  v_and_b32 v125, 0xffff0000, v11
  v_lshlrev_b32 v102, 16, v12
  v_and_b32 v110, 0xffff0000, v12
  v_lshlrev_b32 v118, 16, v13
  v_and_b32 v126, 0xffff0000, v13
  v_lshlrev_b32 v103, 16, v14
  v_and_b32 v111, 0xffff0000, v14
  v_lshlrev_b32 v119, 16, v15
  v_and_b32 v127, 0xffff0000, v15
  v_lshlrev_b32 v104, 16, v16
  v_and_b32 v112, 0xffff0000, v16
  v_lshlrev_b32 v120, 16, v17
  v_and_b32 v128, 0xffff0000, v17
  v_lshlrev_b32 v105, 16, v18
  v_and_b32 v113, 0xffff0000, v18
  v_lshlrev_b32 v121, 16, v19
  v_and_b32 v129, 0xffff0000, v19
  v_lshlrev_b32 v106, 16, v20
  v_and_b32 v114, 0xffff0000, v20
  v_lshlrev_b32 v122, 16, v21
  v_and_b32 v130, 0xffff0000, v21
  v_lshlrev_b32 v107, 16, v22
  v_and_b32 v115, 0xffff0000, v22
  v_lshlrev_b32 v123, 16, v23
  v_and_b32 v131, 0xffff0000, v23
  s_waitcnt vmcnt(0)
  s_lshl_b32 s33, s13, 18
  s_lshl_b32 s34, s14, 7
  s_add_u32 s33, s33, s34
  v_lshlrev_b32 v6, 15, v3
  v_lshl_add_u32 v6, v4, 4, v6
  v_lshlrev_b32 v132, 16, v24
  v_and_b32 v133, 0xffff0000, v24
  v_lshlrev_b32 v134, 16, v28
  v_and_b32 v135, 0xffff0000, v28
  v_lshlrev_b32 v136, 16, v32
  v_and_b32 v137, 0xffff0000, v32
  v_lshlrev_b32 v138, 16, v36
  v_and_b32 v139, 0xffff0000, v36
  v_lshlrev_b32 v140, 16, v40
  v_and_b32 v141, 0xffff0000, v40
  v_lshlrev_b32 v142, 16, v44
  v_and_b32 v143, 0xffff0000, v44
  v_lshlrev_b32 v144, 16, v48
  v_and_b32 v145, 0xffff0000, v48
  v_lshlrev_b32 v146, 16, v52
  v_and_b32 v147, 0xffff0000, v52
  v_lshlrev_b32 v148, 16, v56
  v_and_b32 v149, 0xffff0000, v56
  v_lshlrev_b32 v150, 16, v60
  v_and_b32 v151, 0xffff0000, v60
  v_lshlrev_b32 v152, 16, v64
  v_and_b32 v153, 0xffff0000, v64
  v_lshlrev_b32 v154, 16, v68
  v_and_b32 v155, 0xffff0000, v68
  v_lshlrev_b32 v156, 16, v72
  v_and_b32 v157, 0xffff0000, v72
  v_lshlrev_b32 v158, 16, v76
  v_and_b32 v159, 0xffff0000, v76
  v_lshlrev_b32 v160, 16, v80
  v_and_b32 v161, 0xffff0000, v80
  v_lshlrev_b32 v162, 16, v84
  v_and_b32 v163, 0xffff0000, v84
  v_lshlrev_b32 v164, 16, v88
  v_and_b32 v165, 0xffff0000, v88
  v_lshlrev_b32 v166, 16, v92
  v_and_b32 v167, 0xffff0000, v92
  v_lshlrev_b32 v168, 16, v96
  v_and_b32 v169, 0xffff0000, v96
  v_pk_mul_f32 v[170:171], v[132:133], v[124:125]
  v_pk_mul_f32 v[172:173], v[134:135], v[124:125]
  v_pk_mul_f32 v[174:175], v[136:137], v[124:125]
  v_pk_mul_f32 v[176:177], v[138:139], v[124:125]
  v_pk_mul_f32 v[178:179], v[140:141], v[124:125]
  v_pk_mul_f32 v[180:181], v[142:143], v[124:125]
  v_pk_mul_f32 v[182:183], v[144:145], v[124:125]
  v_pk_mul_f32 v[184:185], v[146:147], v[124:125]
  v_pk_fma_f32 v[170:171], v[134:135], v[116:117], v[170:171]
  v_pk_fma_f32 v[172:173], v[136:137], v[116:117], v[172:173]
  v_pk_fma_f32 v[174:175], v[138:139], v[116:117], v[174:175]
  v_pk_fma_f32 v[176:177], v[140:141], v[116:117], v[176:177]
  v_pk_fma_f32 v[178:179], v[142:143], v[116:117], v[178:179]
  v_pk_fma_f32 v[180:181], v[144:145], v[116:117], v[180:181]
  v_pk_fma_f32 v[182:183], v[146:147], v[116:117], v[182:183]
  v_pk_fma_f32 v[184:185], v[148:149], v[116:117], v[184:185]
  v_pk_fma_f32 v[170:171], v[136:137], v[108:109], v[170:171]
  v_pk_fma_f32 v[172:173], v[138:139], v[108:109], v[172:173]
  v_pk_fma_f32 v[174:175], v[140:141], v[108:109], v[174:175]
  v_pk_fma_f32 v[176:177], v[142:143], v[108:109], v[176:177]
  v_pk_fma_f32 v[178:179], v[144:145], v[108:109], v[178:179]
  v_pk_fma_f32 v[180:181], v[146:147], v[108:109], v[180:181]
  v_pk_fma_f32 v[182:183], v[148:149], v[108:109], v[182:183]
  v_pk_fma_f32 v[184:185], v[150:151], v[108:109], v[184:185]
  v_pk_fma_f32 v[170:171], v[138:139], v[100:101], v[170:171]
  v_pk_fma_f32 v[172:173], v[140:141], v[100:101], v[172:173]
  v_pk_fma_f32 v[174:175], v[142:143], v[100:101], v[174:175]
  v_pk_fma_f32 v[176:177], v[144:145], v[100:101], v[176:177]
  v_pk_fma_f32 v[178:179], v[146:147], v[100:101], v[178:179]
  v_pk_fma_f32 v[180:181], v[148:149], v[100:101], v[180:181]
  v_pk_fma_f32 v[182:183], v[150:151], v[100:101], v[182:183]
  v_pk_fma_f32 v[184:185], v[152:153], v[100:101], v[184:185]
  v_pk_mul_f32 v[170:171], v[170:171], v[154:155]
  v_pk_mul_f32 v[172:173], v[172:173], v[156:157]
  v_pk_mul_f32 v[174:175], v[174:175], v[158:159]
  v_pk_mul_f32 v[176:177], v[176:177], v[160:161]
  v_pk_mul_f32 v[178:179], v[178:179], v[162:163]
  v_pk_mul_f32 v[180:181], v[180:181], v[164:165]
  v_pk_mul_f32 v[182:183], v[182:183], v[166:167]
  v_pk_mul_f32 v[184:185], v[184:185], v[168:169]
  v_cvt_pk_bf16_f32 v188, v170, v172
  v_cvt_pk_bf16_f32 v189, v174, v176
  v_cvt_pk_bf16_f32 v190, v178, v180
  v_cvt_pk_bf16_f32 v191, v182, v184
  v_cvt_pk_bf16_f32 v192, v171, v173
  v_cvt_pk_bf16_f32 v193, v175, v177
  v_cvt_pk_bf16_f32 v194, v179, v181
  v_cvt_pk_bf16_f32 v195, v183, v185
  buffer_store_dwordx4 v[188:191], v6, s[28:31], s33 offen
  s_add_u32 s33, s33, 4096
  buffer_store_dwordx4 v[192:195], v6, s[28:31], s33 offen
  s_add_u32 s33, s33, 4096
  v_lshlrev_b32 v132, 16, v25
  v_and_b32 v133, 0xffff0000, v25
  v_lshlrev_b32 v134, 16, v29
  v_and_b32 v135, 0xffff0000, v29
  v_lshlrev_b32 v136, 16, v33
  v_and_b32 v137, 0xffff0000, v33
  v_lshlrev_b32 v138, 16, v37
  v_and_b32 v139, 0xffff0000, v37
  v_lshlrev_b32 v140, 16, v41
  v_and_b32 v141, 0xffff0000, v41
  v_lshlrev_b32 v142, 16, v45
  v_and_b32 v143, 0xffff0000, v45
  v_lshlrev_b32 v144, 16, v49
  v_and_b32 v145, 0xffff0000, v49
  v_lshlrev_b32 v146, 16, v53
  v_and_b32 v147, 0xffff0000, v53
  v_lshlrev_b32 v148, 16, v57
  v_and_b32 v149, 0xffff0000, v57
  v_lshlrev_b32 v150, 16, v61
  v_and_b32 v151, 0xffff0000, v61
  v_lshlrev_b32 v152, 16, v65
  v_and_b32 v153, 0xffff0000, v65
  v_lshlrev_b32 v154, 16, v69
  v_and_b32 v155, 0xffff0000, v69
  v_lshlrev_b32 v156, 16, v73
  v_and_b32 v157, 0xffff0000, v73
  v_lshlrev_b32 v158, 16, v77
  v_and_b32 v159, 0xffff0000, v77
  v_lshlrev_b32 v160, 16, v81
  v_and_b32 v161, 0xffff0000, v81
  v_lshlrev_b32 v162, 16, v85
  v_and_b32 v163, 0xffff0000, v85
  v_lshlrev_b32 v164, 16, v89
  v_and_b32 v165, 0xffff0000, v89
  v_lshlrev_b32 v166, 16, v93
  v_and_b32 v167, 0xffff0000, v93
  v_lshlrev_b32 v168, 16, v97
  v_and_b32 v169, 0xffff0000, v97
  v_pk_mul_f32 v[170:171], v[132:133], v[126:127]
  v_pk_mul_f32 v[172:173], v[134:135], v[126:127]
  v_pk_mul_f32 v[174:175], v[136:137], v[126:127]
  v_pk_mul_f32 v[176:177], v[138:139], v[126:127]
  v_pk_mul_f32 v[178:179], v[140:141], v[126:127]
  v_pk_mul_f32 v[180:181], v[142:143], v[126:127]
  v_pk_mul_f32 v[182:183], v[144:145], v[126:127]
  v_pk_mul_f32 v[184:185], v[146:147], v[126:127]
  v_pk_fma_f32 v[170:171], v[134:135], v[118:119], v[170:171]
  v_pk_fma_f32 v[172:173], v[136:137], v[118:119], v[172:173]
  v_pk_fma_f32 v[174:175], v[138:139], v[118:119], v[174:175]
  v_pk_fma_f32 v[176:177], v[140:141], v[118:119], v[176:177]
  v_pk_fma_f32 v[178:179], v[142:143], v[118:119], v[178:179]
  v_pk_fma_f32 v[180:181], v[144:145], v[118:119], v[180:181]
  v_pk_fma_f32 v[182:183], v[146:147], v[118:119], v[182:183]
  v_pk_fma_f32 v[184:185], v[148:149], v[118:119], v[184:185]
  v_pk_fma_f32 v[170:171], v[136:137], v[110:111], v[170:171]
  v_pk_fma_f32 v[172:173], v[138:139], v[110:111], v[172:173]
  v_pk_fma_f32 v[174:175], v[140:141], v[110:111], v[174:175]
  v_pk_fma_f32 v[176:177], v[142:143], v[110:111], v[176:177]
  v_pk_fma_f32 v[178:179], v[144:145], v[110:111], v[178:179]
  v_pk_fma_f32 v[180:181], v[146:147], v[110:111], v[180:181]
  v_pk_fma_f32 v[182:183], v[148:149], v[110:111], v[182:183]
  v_pk_fma_f32 v[184:185], v[150:151], v[110:111], v[184:185]
  v_pk_fma_f32 v[170:171], v[138:139], v[102:103], v[170:171]
  v_pk_fma_f32 v[172:173], v[140:141], v[102:103], v[172:173]
  v_pk_fma_f32 v[174:175], v[142:143], v[102:103], v[174:175]
  v_pk_fma_f32 v[176:177], v[144:145], v[102:103], v[176:177]
  v_pk_fma_f32 v[178:179], v[146:147], v[102:103], v[178:179]
  v_pk_fma_f32 v[180:181], v[148:149], v[102:103], v[180:181]
  v_pk_fma_f32 v[182:183], v[150:151], v[102:103], v[182:183]
  v_pk_fma_f32 v[184:185], v[152:153], v[102:103], v[184:185]
  v_pk_mul_f32 v[170:171], v[170:171], v[154:155]
  v_pk_mul_f32 v[172:173], v[172:173], v[156:157]
  v_pk_mul_f32 v[174:175], v[174:175], v[158:159]
  v_pk_mul_f32 v[176:177], v[176:177], v[160:161]
  v_pk_mul_f32 v[178:179], v[178:179], v[162:163]
  v_pk_mul_f32 v[180:181], v[180:181], v[164:165]
  v_pk_mul_f32 v[182:183], v[182:183], v[166:167]
  v_pk_mul_f32 v[184:185], v[184:185], v[168:169]
  v_cvt_pk_bf16_f32 v196, v170, v172
  v_cvt_pk_bf16_f32 v197, v174, v176
  v_cvt_pk_bf16_f32 v198, v178, v180
  v_cvt_pk_bf16_f32 v199, v182, v184
  v_cvt_pk_bf16_f32 v200, v171, v173
  v_cvt_pk_bf16_f32 v201, v175, v177
  v_cvt_pk_bf16_f32 v202, v179, v181
  v_cvt_pk_bf16_f32 v203, v183, v185
  buffer_store_dwordx4 v[196:199], v6, s[28:31], s33 offen
  s_add_u32 s33, s33, 4096
  buffer_store_dwordx4 v[200:203], v6, s[28:31], s33 offen
  s_add_u32 s33, s33, 4096
  v_lshlrev_b32 v132, 16, v26
  v_and_b32 v133, 0xffff0000, v26
  v_lshlrev_b32 v134, 16, v30
  v_and_b32 v135, 0xffff0000, v30
  v_lshlrev_b32 v136, 16, v34
  v_and_b32 v137, 0xffff0000, v34
  v_lshlrev_b32 v138, 16, v38
  v_and_b32 v139, 0xffff0000, v38
  v_lshlrev_b32 v140, 16, v42
  v_and_b32 v141, 0xffff0000, v42
  v_lshlrev_b32 v142, 16, v46
  v_and_b32 v143, 0xffff0000, v46
  v_lshlrev_b32 v144, 16, v50
  v_and_b32 v145, 0xffff0000, v50
  v_lshlrev_b32 v146, 16, v54
  v_and_b32 v147, 0xffff0000, v54
  v_lshlrev_b32 v148, 16, v58
  v_and_b32 v149, 0xffff0000, v58
  v_lshlrev_b32 v150, 16, v62
  v_and_b32 v151, 0xffff0000, v62
  v_lshlrev_b32 v152, 16, v66
  v_and_b32 v153, 0xffff0000, v66
  v_lshlrev_b32 v154, 16, v70
  v_and_b32 v155, 0xffff0000, v70
  v_lshlrev_b32 v156, 16, v74
  v_and_b32 v157, 0xffff0000, v74
  v_lshlrev_b32 v158, 16, v78
  v_and_b32 v159, 0xffff0000, v78
  v_lshlrev_b32 v160, 16, v82
  v_and_b32 v161, 0xffff0000, v82
  v_lshlrev_b32 v162, 16, v86
  v_and_b32 v163, 0xffff0000, v86
  v_lshlrev_b32 v164, 16, v90
  v_and_b32 v165, 0xffff0000, v90
  v_lshlrev_b32 v166, 16, v94
  v_and_b32 v167, 0xffff0000, v94
  v_lshlrev_b32 v168, 16, v98
  v_and_b32 v169, 0xffff0000, v98
  v_pk_mul_f32 v[170:171], v[132:133], v[128:129]
  v_pk_mul_f32 v[172:173], v[134:135], v[128:129]
  v_pk_mul_f32 v[174:175], v[136:137], v[128:129]
  v_pk_mul_f32 v[176:177], v[138:139], v[128:129]
  v_pk_mul_f32 v[178:179], v[140:141], v[128:129]
  v_pk_mul_f32 v[180:181], v[142:143], v[128:129]
  v_pk_mul_f32 v[182:183], v[144:145], v[128:129]
  v_pk_mul_f32 v[184:185], v[146:147], v[128:129]
  v_pk_fma_f32 v[170:171], v[134:135], v[120:121], v[170:171]
  v_pk_fma_f32 v[172:173], v[136:137], v[120:121], v[172:173]
  v_pk_fma_f32 v[174:175], v[138:139], v[120:121], v[174:175]
  v_pk_fma_f32 v[176:177], v[140:141], v[120:121], v[176:177]
  v_pk_fma_f32 v[178:179], v[142:143], v[120:121], v[178:179]
  v_pk_fma_f32 v[180:181], v[144:145], v[120:121], v[180:181]
  v_pk_fma_f32 v[182:183], v[146:147], v[120:121], v[182:183]
  v_pk_fma_f32 v[184:185], v[148:149], v[120:121], v[184:185]
  v_pk_fma_f32 v[170:171], v[136:137], v[112:113], v[170:171]
  v_pk_fma_f32 v[172:173], v[138:139], v[112:113], v[172:173]
  v_pk_fma_f32 v[174:175], v[140:141], v[112:113], v[174:175]
  v_pk_fma_f32 v[176:177], v[142:143], v[112:113], v[176:177]
  v_pk_fma_f32 v[178:179], v[144:145], v[112:113], v[178:179]
  v_pk_fma_f32 v[180:181], v[146:147], v[112:113], v[180:181]
  v_pk_fma_f32 v[182:183], v[148:149], v[112:113], v[182:183]
  v_pk_fma_f32 v[184:185], v[150:151], v[112:113], v[184:185]
  v_pk_fma_f32 v[170:171], v[138:139], v[104:105], v[170:171]
  v_pk_fma_f32 v[172:173], v[140:141], v[104:105], v[172:173]
  v_pk_fma_f32 v[174:175], v[142:143], v[104:105], v[174:175]
  v_pk_fma_f32 v[176:177], v[144:145], v[104:105], v[176:177]
  v_pk_fma_f32 v[178:179], v[146:147], v[104:105], v[178:179]
  v_pk_fma_f32 v[180:181], v[148:149], v[104:105], v[180:181]
  v_pk_fma_f32 v[182:183], v[150:151], v[104:105], v[182:183]
  v_pk_fma_f32 v[184:185], v[152:153], v[104:105], v[184:185]
  v_pk_mul_f32 v[170:171], v[170:171], v[154:155]
  v_pk_mul_f32 v[172:173], v[172:173], v[156:157]
  v_pk_mul_f32 v[174:175], v[174:175], v[158:159]
  v_pk_mul_f32 v[176:177], v[176:177], v[160:161]
  v_pk_mul_f32 v[178:179], v[178:179], v[162:163]
  v_pk_mul_f32 v[180:181], v[180:181], v[164:165]
  v_pk_mul_f32 v[182:183], v[182:183], v[166:167]
  v_pk_mul_f32 v[184:185], v[184:185], v[168:169]
  v_cvt_pk_bf16_f32 v188, v170, v172
  v_cvt_pk_bf16_f32 v189, v174, v176
  v_cvt_pk_bf16_f32 v190, v178, v180
  v_cvt_pk_bf16_f32 v191, v182, v184
  v_cvt_pk_bf16_f32 v192, v171, v173
  v_cvt_pk_bf16_f32 v193, v175, v177
  v_cvt_pk_bf16_f32 v194, v179, v181
  v_cvt_pk_bf16_f32 v195, v183, v185
  buffer_store_dwordx4 v[188:191], v6, s[28:31], s33 offen
  s_add_u32 s33, s33, 4096
  buffer_store_dwordx4 v[192:195], v6, s[28:31], s33 offen
  s_add_u32 s33, s33, 4096
  v_lshlrev_b32 v132, 16, v27
  v_and_b32 v133, 0xffff0000, v27
  v_lshlrev_b32 v134, 16, v31
  v_and_b32 v135, 0xffff0000, v31
  v_lshlrev_b32 v136, 16, v35
  v_and_b32 v137, 0xffff0000, v35
  v_lshlrev_b32 v138, 16, v39
  v_and_b32 v139, 0xffff0000, v39
  v_lshlrev_b32 v140, 16, v43
  v_and_b32 v141, 0xffff0000, v43
  v_lshlrev_b32 v142, 16, v47
  v_and_b32 v143, 0xffff0000, v47
  v_lshlrev_b32 v144, 16, v51
  v_and_b32 v145, 0xffff0000, v51
  v_lshlrev_b32 v146, 16, v55
  v_and_b32 v147, 0xffff0000, v55
  v_lshlrev_b32 v148, 16, v59
  v_and_b32 v149, 0xffff0000, v59
  v_lshlrev_b32 v150, 16, v63
  v_and_b32 v151, 0xffff0000, v63
  v_lshlrev_b32 v152, 16, v67
  v_and_b32 v153, 0xffff0000, v67
  v_lshlrev_b32 v154, 16, v71
  v_and_b32 v155, 0xffff0000, v71
  v_lshlrev_b32 v156, 16, v75
  v_and_b32 v157, 0xffff0000, v75
  v_lshlrev_b32 v158, 16, v79
  v_and_b32 v159, 0xffff0000, v79
  v_lshlrev_b32 v160, 16, v83
  v_and_b32 v161, 0xffff0000, v83
  v_lshlrev_b32 v162, 16, v87
  v_and_b32 v163, 0xffff0000, v87
  v_lshlrev_b32 v164, 16, v91
  v_and_b32 v165, 0xffff0000, v91
  v_lshlrev_b32 v166, 16, v95
  v_and_b32 v167, 0xffff0000, v95
  v_lshlrev_b32 v168, 16, v99
  v_and_b32 v169, 0xffff0000, v99
  v_pk_mul_f32 v[170:171], v[132:133], v[130:131]
  v_pk_mul_f32 v[172:173], v[134:135], v[130:131]
  v_pk_mul_f32 v[174:175], v[136:137], v[130:131]
  v_pk_mul_f32 v[176:177], v[138:139], v[130:131]
  v_pk_mul_f32 v[178:179], v[140:141], v[130:131]
  v_pk_mul_f32 v[180:181], v[142:143], v[130:131]
  v_pk_mul_f32 v[182:183], v[144:145], v[130:131]
  v_pk_mul_f32 v[184:185], v[146:147], v[130:131]
  v_pk_fma_f32 v[170:171], v[134:135], v[122:123], v[170:171]
  v_pk_fma_f32 v[172:173], v[136:137], v[122:123], v[172:173]
  v_pk_fma_f32 v[174:175], v[138:139], v[122:123], v[174:175]
  v_pk_fma_f32 v[176:177], v[140:141], v[122:123], v[176:177]
  v_pk_fma_f32 v[178:179], v[142:143], v[122:123], v[178:179]
  v_pk_fma_f32 v[180:181], v[144:145], v[122:123], v[180:181]
  v_pk_fma_f32 v[182:183], v[146:147], v[122:123], v[182:183]
  v_pk_fma_f32 v[184:185], v[148:149], v[122:123], v[184:185]
  v_pk_fma_f32 v[170:171], v[136:137], v[114:115], v[170:171]
  v_pk_fma_f32 v[172:173], v[138:139], v[114:115], v[172:173]
  v_pk_fma_f32 v[174:175], v[140:141], v[114:115], v[174:175]
  v_pk_fma_f32 v[176:177], v[142:143], v[114:115], v[176:177]
  v_pk_fma_f32 v[178:179], v[144:145], v[114:115], v[178:179]
  v_pk_fma_f32 v[180:181], v[146:147], v[114:115], v[180:181]
  v_pk_fma_f32 v[182:183], v[148:149], v[114:115], v[182:183]
  v_pk_fma_f32 v[184:185], v[150:151], v[114:115], v[184:185]
  v_pk_fma_f32 v[170:171], v[138:139], v[106:107], v[170:171]
  v_pk_fma_f32 v[172:173], v[140:141], v[106:107], v[172:173]
  v_pk_fma_f32 v[174:175], v[142:143], v[106:107], v[174:175]
  v_pk_fma_f32 v[176:177], v[144:145], v[106:107], v[176:177]
  v_pk_fma_f32 v[178:179], v[146:147], v[106:107], v[178:179]
  v_pk_fma_f32 v[180:181], v[148:149], v[106:107], v[180:181]
  v_pk_fma_f32 v[182:183], v[150:151], v[106:107], v[182:183]
  v_pk_fma_f32 v[184:185], v[152:153], v[106:107], v[184:185]
  v_pk_mul_f32 v[170:171], v[170:171], v[154:155]
  v_pk_mul_f32 v[172:173], v[172:173], v[156:157]
  v_pk_mul_f32 v[174:175], v[174:175], v[158:159]
  v_pk_mul_f32 v[176:177], v[176:177], v[160:161]
  v_pk_mul_f32 v[178:179], v[178:179], v[162:163]
  v_pk_mul_f32 v[180:181], v[180:181], v[164:165]
  v_pk_mul_f32 v[182:183], v[182:183], v[166:167]
  v_pk_mul_f32 v[184:185], v[184:185], v[168:169]
  v_cvt_pk_bf16_f32 v196, v170, v172
  v_cvt_pk_bf16_f32 v197, v174, v176
  v_cvt_pk_bf16_f32 v198, v178, v180
  v_cvt_pk_bf16_f32 v199, v182, v184
  v_cvt_pk_bf16_f32 v200, v171, v173
  v_cvt_pk_bf16_f32 v201, v175, v177
  v_cvt_pk_bf16_f32 v202, v179, v181
  v_cvt_pk_bf16_f32 v203, v183, v185
  buffer_store_dwordx4 v[196:199], v6, s[28:31], s33 offen
  s_add_u32 s33, s33, 4096
  buffer_store_dwordx4 v[200:203], v6, s[28:31], s33 offen
  s_add_u32 s33, s33, 4096
PR_end:
  s_endpgm
.globl g1_kernel
.p2align 8
.type g1_kernel,@function
g1_kernel:
  s_cmp_ge_u32 s2, 256
  s_cbranch_scc1 G1_end
  s_load_dwordx4 s[4:7], s[0:1], 48
  s_load_dwordx2 s[8:9], s[0:1], 88
  v_lshrrev_b32 v1, 6, v0
  v_and_b32 v2, 63, v0
  s_and_b32 s10, s2, 7
  v_readfirstlane_b32 s3, v1
  s_lshr_b32 s11, s2, 3
  s_and_b32 s12, s10, 1
  s_lshl_b32 s12, s12, 3
  s_and_b32 s13, s11, 7
  s_add_u32 s12, s12, s13
  s_lshr_b32 s13, s10, 1
  s_lshl_b32 s13, s13, 2
  s_lshr_b32 s14, s11, 3
  s_add_u32 s13, s13, s14
  s_waitcnt lgkmcnt(0)
  s_mov_b32 s16, s4
  s_mov_b32 s17, s5
  s_mov_b32 s18, 4194304
  s_mov_b32 s19, 0x20000
  s_mov_b32 s20, s6
  s_mov_b32 s21, s7
  s_mov_b32 s22, 6291456
  s_mov_b32 s23, 0x20000
  s_add_u32 s24, s8, 0
  s_addc_u32 s25, s9, 0
  s_mov_b32 s26, 4194304
  s_mov_b32 s27, 0x20000
  s_add_u32 s28, s8, 8388608
  s_addc_u32 s29, s9, 0
  s_mov_b32 s30, 4194304
  s_mov_b32 s31, 0x20000
  s_add_u32 s32, s8, 12582912
  s_addc_u32 s33, s9, 0
  s_mov_b32 s34, 131072
  s_mov_b32 s35, 0x20000
  s_cmp_ge_u32 s3, 4
  s_cbranch_scc1 G1_loader
  s_and_b32 s36, s3, 1
  s_lshr_b32 s37, s3, 1
  v_and_b32 v3, 31, v2
  v_lshrrev_b32 v14, 5, v2
  s_lshl_b32 s38, s36, 6
  v_add_u32 v15, s38, v3
  v_lshrrev_b32 v16, 1, v15
  v_and_b32 v16, 7, v16
  v_lshlrev_b32 v15, 7, v15
  v_add_u32 v17, 0, v14
  v_xor_b32 v17, v17, v16
  v_lshl_add_u32 v4, v17, 4, v15
  v_add_u32 v8, 81920, v4
  v_add_u32 v17, 2, v14
  v_xor_b32 v17, v17, v16
  v_lshl_add_u32 v5, v17, 4, v15
  v_add_u32 v9, 81920, v5
  v_add_u32 v17, 4, v14
  v_xor_b32 v17, v17, v16
  v_lshl_add_u32 v6, v17, 4, v15
  v_add_u32 v10, 81920, v6
  v_add_u32 v17, 6, v14
  v_xor_b32 v17, v17, v16
  v_lshl_add_u32 v7, v17, 4, v15
  v_add_u32 v11, 81920, v7
  v_and_b32 v17, 15, v2
  v_lshrrev_b32 v18, 2, v17
  v_and_b32 v17, 3, v17
  v_lshlrev_b32 v18, 6, v18
  v_lshl_add_u32 v18, v17, 3, v18
  v_bfe_u32 v17, v2, 4, 1
  v_lshl_add_u32 v18, v17, 5, v18
  v_lshl_add_u32 v18, v14, 10, v18
  s_lshl_b32 s38, s37, 8
  s_add_u32 s38, s38, 16384
  v_add_u32 v12, s38, v18
  v_add_u32 v13, 81920, v12
  v_mov_b32 v64, 0
  v_mov_b32 v65, 0
  v_mov_b32 v66, 0
  v_mov_b32 v67, 0
  v_mov_b32 v68, 0
  v_mov_b32 v69, 0
  v_mov_b32 v70, 0
  v_mov_b32 v71, 0
  v_mov_b32 v72, 0
  v_mov_b32 v73, 0
  v_mov_b32 v74, 0
  v_mov_b32 v75, 0
  v_mov_b32 v76, 0
  v_mov_b32 v77, 0
  v_mov_b32 v78, 0
  v_mov_b32 v79, 0
  v_mov_b32 v80, 0
  v_mov_b32 v81, 0
  v_mov_b32 v82, 0
  v_mov_b32 v83, 0
  v_mov_b32 v84, 0
  v_mov_b32 v85, 0
  v_mov_b32 v86, 0
  v_mov_b32 v87, 0
  v_mov_b32 v88, 0
  v_mov_b32 v89, 0
  v_mov_b32 v90, 0
  v_mov_b32 v91, 0
  v_mov_b32 v92, 0
  v_mov_b32 v93, 0
  v_mov_b32 v94, 0
  v_mov_b32 v95, 0
  v_mov_b32 v96, 0
  v_mov_b32 v97, 0
  v_mov_b32 v98, 0
  v_mov_b32 v99, 0
  v_mov_b32 v100, 0
  v_mov_b32 v101, 0
  v_mov_b32 v102, 0
  v_mov_b32 v103, 0
  v_mov_b32 v104, 0
  v_mov_b32 v105, 0
  v_mov_b32 v106, 0
  v_mov_b32 v107, 0
  v_mov_b32 v108, 0
  v_mov_b32 v109, 0
  v_mov_b32 v110, 0
  v_mov_b32 v111, 0
  v_mov_b32 v112, 0
  v_mov_b32 v113, 0
  v_mov_b32 v114, 0
  v_mov_b32 v115, 0
  v_mov_b32 v116, 0
  v_mov_b32 v117, 0
  v_mov_b32 v118, 0
  v_mov_b32 v119, 0
  v_mov_b32 v120, 0
  v_mov_b32 v121, 0
  v_mov_b32 v122, 0
  v_mov_b32 v123, 0
  v_mov_b32 v124, 0
  v_mov_b32 v125, 0
  v_mov_b32 v126, 0
  v_mov_b32 v127, 0
  v_mov_b32 v128, 0
  v_mov_b32 v129, 0
  v_mov_b32 v130, 0
  v_mov_b32 v131, 0
  v_mov_b32 v132, 0
  v_mov_b32 v133, 0
  v_mov_b32 v134, 0
  v_mov_b32 v135, 0
  v_mov_b32 v136, 0
  v_mov_b32 v137, 0
  v_mov_b32 v138, 0
  v_mov_b32 v139, 0
  v_mov_b32 v140, 0
  v_mov_b32 v141, 0
  v_mov_b32 v142, 0
  v_mov_b32 v143, 0
  v_mov_b32 v144, 0
  v_mov_b32 v145, 0
  v_mov_b32 v146, 0
  v_mov_b32 v147, 0
  v_mov_b32 v148, 0
  v_mov_b32 v149, 0
  v_mov_b32 v150, 0
  v_mov_b32 v151, 0
  v_mov_b32 v152, 0
  v_mov_b32 v153, 0
  v_mov_b32 v154, 0
  v_mov_b32 v155, 0
  v_mov_b32 v156, 0
  v_mov_b32 v157, 0
  v_mov_b32 v158, 0
  v_mov_b32 v159, 0
  s_barrier
  ds_read_b128 v[16:19], v4 offset:0
  ds_read_b64_tr_b16 v[24:25], v12 offset:0
  ds_read_b64_tr_b16 v[26:27], v12 offset:512
  ds_read_b128 v[20:23], v4 offset:4096
  ds_read_b64_tr_b16 v[28:29], v12 offset:2048
  ds_read_b64_tr_b16 v[30:31], v12 offset:2560
  ds_read_b64_tr_b16 v[32:33], v12 offset:4096
  ds_read_b64_tr_b16 v[34:35], v12 offset:4608
  s_mov_b32 s39, 4
G1_loop:
  s_waitcnt lgkmcnt(5)
  v_mfma_f32_32x32x16_bf16 v[64:79], v[24:27], v[16:19], v[64:79]
  ds_read_b128 v[36:39], v5 offset:0
  ds_read_b64_tr_b16 v[44:45], v12 offset:6144
  s_waitcnt lgkmcnt(6)
  v_mfma_f32_32x32x16_bf16 v[80:95], v[24:27], v[20:23], v[80:95]
  ds_read_b64_tr_b16 v[46:47], v12 offset:6656
  ds_read_b128 v[40:43], v5 offset:4096
  s_waitcnt lgkmcnt(6)
  v_mfma_f32_32x32x16_bf16 v[96:111], v[16:19], v[28:31], v[96:111]
  ds_read_b64_tr_b16 v[48:49], v12 offset:8192
  ds_read_b64_tr_b16 v[50:51], v12 offset:8704
  v_mfma_f32_32x32x16_bf16 v[112:127], v[20:23], v[28:31], v[112:127]
  ds_read_b64_tr_b16 v[52:53], v12 offset:10240
  ds_read_b64_tr_b16 v[54:55], v12 offset:10752
  s_waitcnt lgkmcnt(8)
  v_mfma_f32_32x32x16_bf16 v[128:143], v[16:19], v[32:35], v[128:143]
  v_mfma_f32_32x32x16_bf16 v[144:159], v[20:23], v[32:35], v[144:159]
  s_waitcnt lgkmcnt(5)
  v_mfma_f32_32x32x16_bf16 v[64:79], v[44:47], v[36:39], v[64:79]
  ds_read_b128 v[16:19], v6 offset:0
  ds_read_b64_tr_b16 v[24:25], v12 offset:12288
  s_waitcnt lgkmcnt(6)
  v_mfma_f32_32x32x16_bf16 v[80:95], v[44:47], v[40:43], v[80:95]
  ds_read_b64_tr_b16 v[26:27], v12 offset:12800
  ds_read_b128 v[20:23], v6 offset:4096
  s_waitcnt lgkmcnt(6)
  v_mfma_f32_32x32x16_bf16 v[96:111], v[36:39], v[48:51], v[96:111]
  ds_read_b64_tr_b16 v[28:29], v12 offset:14336
  ds_read_b64_tr_b16 v[30:31], v12 offset:14848
  v_mfma_f32_32x32x16_bf16 v[112:127], v[40:43], v[48:51], v[112:127]
  ds_read_b64_tr_b16 v[32:33], v12 offset:16384
  ds_read_b64_tr_b16 v[34:35], v12 offset:16896
  s_waitcnt lgkmcnt(8)
  v_mfma_f32_32x32x16_bf16 v[128:143], v[36:39], v[52:55], v[128:143]
  v_mfma_f32_32x32x16_bf16 v[144:159], v[40:43], v[52:55], v[144:159]
  s_waitcnt lgkmcnt(5)
  v_mfma_f32_32x32x16_bf16 v[64:79], v[24:27], v[16:19], v[64:79]
  ds_read_b128 v[36:39], v7 offset:0
  ds_read_b64_tr_b16 v[44:45], v12 offset:18432
  s_waitcnt lgkmcnt(6)
  v_mfma_f32_32x32x16_bf16 v[80:95], v[24:27], v[20:23], v[80:95]
  ds_read_b64_tr_b16 v[46:47], v12 offset:18944
  ds_read_b128 v[40:43], v7 offset:4096
  s_waitcnt lgkmcnt(6)
  v_mfma_f32_32x32x16_bf16 v[96:111], v[16:19], v[28:31], v[96:111]
  ds_read_b64_tr_b16 v[48:49], v12 offset:20480
  ds_read_b64_tr_b16 v[50:51], v12 offset:20992
  v_mfma_f32_32x32x16_bf16 v[112:127], v[20:23], v[28:31], v[112:127]
  ds_read_b64_tr_b16 v[52:53], v12 offset:22528
  ds_read_b64_tr_b16 v[54:55], v12 offset:23040
  s_waitcnt lgkmcnt(8)
  v_mfma_f32_32x32x16_bf16 v[128:143], v[16:19], v[32:35], v[128:143]
  v_mfma_f32_32x32x16_bf16 v[144:159], v[20:23], v[32:35], v[144:159]
  s_waitcnt lgkmcnt(0)
  s_barrier
  v_mfma_f32_32x32x16_bf16 v[64:79], v[44:47], v[36:39], v[64:79]
  ds_read_b128 v[16:19], v4 offset:40960
  ds_read_b64_tr_b16 v[24:25], v12 offset:40960
  v_mfma_f32_32x32x16_bf16 v[80:95], v[44:47], v[40:43], v[80:95]
  ds_read_b64_tr_b16 v[26:27], v12 offset:41472
  ds_read_b128 v[20:23], v4 offset:45056
  v_mfma_f32_32x32x16_bf16 v[96:111], v[36:39], v[48:51], v[96:111]
  ds_read_b64_tr_b16 v[28:29], v12 offset:43008
  ds_read_b64_tr_b16 v[30:31], v12 offset:43520
  v_mfma_f32_32x32x16_bf16 v[112:127], v[40:43], v[48:51], v[112:127]
  ds_read_b64_tr_b16 v[32:33], v12 offset:45056
  ds_read_b64_tr_b16 v[34:35], v12 offset:45568
  v_mfma_f32_32x32x16_bf16 v[128:143], v[36:39], v[52:55], v[128:143]
  v_mfma_f32_32x32x16_bf16 v[144:159], v[40:43], v[52:55], v[144:159]
  s_waitcnt lgkmcnt(5)
  v_mfma_f32_32x32x16_bf16 v[64:79], v[24:27], v[16:19], v[64:79]
  ds_read_b128 v[36:39], v5 offset:40960
  ds_read_b64_tr_b16 v[44:45], v12 offset:47104
  s_waitcnt lgkmcnt(6)
  v_mfma_f32_32x32x16_bf16 v[80:95], v[24:27], v[20:23], v[80:95]
  ds_read_b64_tr_b16 v[46:47], v12 offset:47616
  ds_read_b128 v[40:43], v5 offset:45056
  s_waitcnt lgkmcnt(6)
  v_mfma_f32_32x32x16_bf16 v[96:111], v[16:19], v[28:31], v[96:111]
  ds_read_b64_tr_b16 v[48:49], v12 offset:49152
  ds_read_b64_tr_b16 v[50:51], v12 offset:49664
  v_mfma_f32_32x32x16_bf16 v[112:127], v[20:23], v[28:31], v[112:127]
  ds_read_b64_tr_b16 v[52:53], v12 offset:51200
  ds_read_b64_tr_b16 v[54:55], v12 offset:51712
  s_waitcnt lgkmcnt(8)
  v_mfma_f32_32x32x16_bf16 v[128:143], v[16:19], v[32:35], v[128:143]
  v_mfma_f32_32x32x16_bf16 v[144:159], v[20:23], v[32:35], v[144:159]
  s_waitcnt lgkmcnt(5)
  v_mfma_f32_32x32x16_bf16 v[64:79], v[44:47], v[36:39], v[64:79]
  ds_read_b128 v[16:19], v6 offset:40960
  ds_read_b64_tr_b16 v[24:25], v12 offset:53248
  s_waitcnt lgkmcnt(6)
  v_mfma_f32_32x32x16_bf16 v[80:95], v[44:47], v[40:43], v[80:95]
  ds_read_b64_tr_b16 v[26:27], v12 offset:53760
  ds_read_b128 v[20:23], v6 offset:45056
  s_waitcnt lgkmcnt(6)
  v_mfma_f32_32x32x16_bf16 v[96:111], v[36:39], v[48:51], v[96:111]
  ds_read_b64_tr_b16 v[28:29], v12 offset:55296
  ds_read_b64_tr_b16 v[30:31], v12 offset:55808
  v_mfma_f32_32x32x16_bf16 v[112:127], v[40:43], v[48:51], v[112:127]
  ds_read_b64_tr_b16 v[32:33], v12 offset:57344
  ds_read_b64_tr_b16 v[34:35], v12 offset:57856
  s_waitcnt lgkmcnt(8)
  v_mfma_f32_32x32x16_bf16 v[128:143], v[36:39], v[52:55], v[128:143]
  v_mfma_f32_32x32x16_bf16 v[144:159], v[40:43], v[52:55], v[144:159]
  s_waitcnt lgkmcnt(5)
  v_mfma_f32_32x32x16_bf16 v[64:79], v[24:27], v[16:19], v[64:79]
  ds_read_b128 v[36:39], v7 offset:40960
  ds_read_b64_tr_b16 v[44:45], v12 offset:59392
  s_waitcnt lgkmcnt(6)
  v_mfma_f32_32x32x16_bf16 v[80:95], v[24:27], v[20:23], v[80:95]
  ds_read_b64_tr_b16 v[46:47], v12 offset:59904
  ds_read_b128 v[40:43], v7 offset:45056
  s_waitcnt lgkmcnt(6)
  v_mfma_f32_32x32x16_bf16 v[96:111], v[16:19], v[28:31], v[96:111]
  ds_read_b64_tr_b16 v[48:49], v12 offset:61440
  ds_read_b64_tr_b16 v[50:51], v12 offset:61952
  v_mfma_f32_32x32x16_bf16 v[112:127], v[20:23], v[28:31], v[112:127]
  ds_read_b64_tr_b16 v[52:53], v12 offset:63488
  ds_read_b64_tr_b16 v[54:55], v12 offset:64000
  s_waitcnt lgkmcnt(8)
  v_mfma_f32_32x32x16_bf16 v[128:143], v[16:19], v[32:35], v[128:143]
  v_mfma_f32_32x32x16_bf16 v[144:159], v[20:23], v[32:35], v[144:159]
  s_waitcnt lgkmcnt(0)
  s_barrier
  v_mfma_f32_32x32x16_bf16 v[64:79], v[44:47], v[36:39], v[64:79]
  ds_read_b128 v[16:19], v8 offset:0
  ds_read_b64_tr_b16 v[24:25], v13 offset:0
  v_mfma_f32_32x32x16_bf16 v[80:95], v[44:47], v[40:43], v[80:95]
  ds_read_b64_tr_b16 v[26:27], v13 offset:512
  ds_read_b128 v[20:23], v8 offset:4096
  v_mfma_f32_32x32x16_bf16 v[96:111], v[36:39], v[48:51], v[96:111]
  ds_read_b64_tr_b16 v[28:29], v13 offset:2048
  ds_read_b64_tr_b16 v[30:31], v13 offset:2560
  v_mfma_f32_32x32x16_bf16 v[112:127], v[40:43], v[48:51], v[112:127]
  ds_read_b64_tr_b16 v[32:33], v13 offset:4096
  ds_read_b64_tr_b16 v[34:35], v13 offset:4608
  v_mfma_f32_32x32x16_bf16 v[128:143], v[36:39], v[52:55], v[128:143]
  v_mfma_f32_32x32x16_bf16 v[144:159], v[40:43], v[52:55], v[144:159]
  s_waitcnt lgkmcnt(5)
  v_mfma_f32_32x32x16_bf16 v[64:79], v[24:27], v[16:19], v[64:79]
  ds_read_b128 v[36:39], v9 offset:0
  ds_read_b64_tr_b16 v[44:45], v13 offset:6144
  s_waitcnt lgkmcnt(6)
  v_mfma_f32_32x32x16_bf16 v[80:95], v[24:27], v[20:23], v[80:95]
  ds_read_b64_tr_b16 v[46:47], v13 offset:6656
  ds_read_b128 v[40:43], v9 offset:4096
  s_waitcnt lgkmcnt(6)
  v_mfma_f32_32x32x16_bf16 v[96:111], v[16:19], v[28:31], v[96:111]
  ds_read_b64_tr_b16 v[48:49], v13 offset:8192
  ds_read_b64_tr_b16 v[50:51], v13 offset:8704
  v_mfma_f32_32x32x16_bf16 v[112:127], v[20:23], v[28:31], v[112:127]
  ds_read_b64_tr_b16 v[52:53], v13 offset:10240
  ds_read_b64_tr_b16 v[54:55], v13 offset:10752
  s_waitcnt lgkmcnt(8)
  v_mfma_f32_32x32x16_bf16 v[128:143], v[16:19], v[32:35], v[128:143]
  v_mfma_f32_32x32x16_bf16 v[144:159], v[20:23], v[32:35], v[144:159]
  s_waitcnt lgkmcnt(5)
  v_mfma_f32_32x32x16_bf16 v[64:79], v[44:47], v[36:39], v[64:79]
  ds_read_b128 v[16:19], v10 offset:0
  ds_read_b64_tr_b16 v[24:25], v13 offset:12288
  s_waitcnt lgkmcnt(6)
  v_mfma_f32_32x32x16_bf16 v[80:95], v[44:47], v[40:43], v[80:95]
  ds_read_b64_tr_b16 v[26:27], v13 offset:12800
  ds_read_b128 v[20:23], v10 offset:4096
  s_waitcnt lgkmcnt(6)
  v_mfma_f32_32x32x16_bf16 v[96:111], v[36:39], v[48:51], v[96:111]
  ds_read_b64_tr_b16 v[28:29], v13 offset:14336
  ds_read_b64_tr_b16 v[30:31], v13 offset:14848
  v_mfma_f32_32x32x16_bf16 v[112:127], v[40:43], v[48:51], v[112:127]
  ds_read_b64_tr_b16 v[32:33], v13 offset:16384
  ds_read_b64_tr_b16 v[34:35], v13 offset:16896
  s_waitcnt lgkmcnt(8)
  v_mfma_f32_32x32x16_bf16 v[128:143], v[36:39], v[52:55], v[128:143]
  v_mfma_f32_32x32x16_bf16 v[144:159], v[40:43], v[52:55], v[144:159]
  s_waitcnt lgkmcnt(5)
  v_mfma_f32_32x32x16_bf16 v[64:79], v[24:27], v[16:19], v[64:79]
  ds_read_b128 v[36:39], v11 offset:0
  ds_read_b64_tr_b16 v[44:45], v13 offset:18432
  s_waitcnt lgkmcnt(6)
  v_mfma_f32_32x32x16_bf16 v[80:95], v[24:27], v[20:23], v[80:95]
  ds_read_b64_tr_b16 v[46:47], v13 offset:18944
  ds_read_b128 v[40:43], v11 offset:4096
  s_waitcnt lgkmcnt(6)
  v_mfma_f32_32x32x16_bf16 v[96:111], v[16:19], v[28:31], v[96:111]
  ds_read_b64_tr_b16 v[48:49], v13 offset:20480
  ds_read_b64_tr_b16 v[50:51], v13 offset:20992
  v_mfma_f32_32x32x16_bf16 v[112:127], v[20:23], v[28:31], v[112:127]
  ds_read_b64_tr_b16 v[52:53], v13 offset:22528
  ds_read_b64_tr_b16 v[54:55], v13 offset:23040
  s_waitcnt lgkmcnt(8)
  v_mfma_f32_32x32x16_bf16 v[128:143], v[16:19], v[32:35], v[128:143]
  v_mfma_f32_32x32x16_bf16 v[144:159], v[20:23], v[32:35], v[144:159]
  s_waitcnt lgkmcnt(0)
  s_barrier
  v_mfma_f32_32x32x16_bf16 v[64:79], v[44:47], v[36:39], v[64:79]
  ds_read_b128 v[16:19], v8 offset:40960
  ds_read_b64_tr_b16 v[24:25], v13 offset:40960
  v_mfma_f32_32x32x16_bf16 v[80:95], v[44:47], v[40:43], v[80:95]
  ds_read_b64_tr_b16 v[26:27], v13 offset:41472
  ds_read_b128 v[20:23], v8 offset:45056
  v_mfma_f32_32x32x16_bf16 v[96:111], v[36:39], v[48:51], v[96:111]
  ds_read_b64_tr_b16 v[28:29], v13 offset:43008
  ds_read_b64_tr_b16 v[30:31], v13 offset:43520
  v_mfma_f32_32x32x16_bf16 v[112:127], v[40:43], v[48:51], v[112:127]
  ds_read_b64_tr_b16 v[32:33], v13 offset:45056
  ds_read_b64_tr_b16 v[34:35], v13 offset:45568
  v_mfma_f32_32x32x16_bf16 v[128:143], v[36:39], v[52:55], v[128:143]
  v_mfma_f32_32x32x16_bf16 v[144:159], v[40:43], v[52:55], v[144:159]
  s_waitcnt lgkmcnt(5)
  v_mfma_f32_32x32x16_bf16 v[64:79], v[24:27], v[16:19], v[64:79]
  ds_read_b128 v[36:39], v9 offset:40960
  ds_read_b64_tr_b16 v[44:45], v13 offset:47104
  s_waitcnt lgkmcnt(6)
  v_mfma_f32_32x32x16_bf16 v[80:95], v[24:27], v[20:23], v[80:95]
  ds_read_b64_tr_b16 v[46:47], v13 offset:47616
  ds_read_b128 v[40:43], v9 offset:45056
  s_waitcnt lgkmcnt(6)
  v_mfma_f32_32x32x16_bf16 v[96:111], v[16:19], v[28:31], v[96:111]
  ds_read_b64_tr_b16 v[48:49], v13 offset:49152
  ds_read_b64_tr_b16 v[50:51], v13 offset:49664
  v_mfma_f32_32x32x16_bf16 v[112:127], v[20:23], v[28:31], v[112:127]
  ds_read_b64_tr_b16 v[52:53], v13 offset:51200
  ds_read_b64_tr_b16 v[54:55], v13 offset:51712
  s_waitcnt lgkmcnt(8)
  v_mfma_f32_32x32x16_bf16 v[128:143], v[16:19], v[32:35], v[128:143]
  v_mfma_f32_32x32x16_bf16 v[144:159], v[20:23], v[32:35], v[144:159]
  s_waitcnt lgkmcnt(5)
  v_mfma_f32_32x32x16_bf16 v[64:79], v[44:47], v[36:39], v[64:79]
  ds_read_b128 v[16:19], v10 offset:40960
  ds_read_b64_tr_b16 v[24:25], v13 offset:53248
  s_waitcnt lgkmcnt(6)
  v_mfma_f32_32x32x16_bf16 v[80:95], v[44:47], v[40:43], v[80:95]
  ds_read_b64_tr_b16 v[26:27], v13 offset:53760
  ds_read_b128 v[20:23], v10 offset:45056
  s_waitcnt lgkmcnt(6)
  v_mfma_f32_32x32x16_bf16 v[96:111], v[36:39], v[48:51], v[96:111]
  ds_read_b64_tr_b16 v[28:29], v13 offset:55296
  ds_read_b64_tr_b16 v[30:31], v13 offset:55808
  v_mfma_f32_32x32x16_bf16 v[112:127], v[40:43], v[48:51], v[112:127]
  ds_read_b64_tr_b16 v[32:33], v13 offset:57344
  ds_read_b64_tr_b16 v[34:35], v13 offset:57856
  s_waitcnt lgkmcnt(8)
  v_mfma_f32_32x32x16_bf16 v[128:143], v[36:39], v[52:55], v[128:143]
  v_mfma_f32_32x32x16_bf16 v[144:159], v[40:43], v[52:55], v[144:159]
  s_waitcnt lgkmcnt(5)
  v_mfma_f32_32x32x16_bf16 v[64:79], v[24:27], v[16:19], v[64:79]
  ds_read_b128 v[36:39], v11 offset:40960
  ds_read_b64_tr_b16 v[44:45], v13 offset:59392
  s_waitcnt lgkmcnt(6)
  v_mfma_f32_32x32x16_bf16 v[80:95], v[24:27], v[20:23], v[80:95]
  ds_read_b64_tr_b16 v[46:47], v13 offset:59904
  ds_read_b128 v[40:43], v11 offset:45056
  s_waitcnt lgkmcnt(6)
  v_mfma_f32_32x32x16_bf16 v[96:111], v[16:19], v[28:31], v[96:111]
  ds_read_b64_tr_b16 v[48:49], v13 offset:61440
  ds_read_b64_tr_b16 v[50:51], v13 offset:61952
  v_mfma_f32_32x32x16_bf16 v[112:127], v[20:23], v[28:31], v[112:127]
  ds_read_b64_tr_b16 v[52:53], v13 offset:63488
  ds_read_b64_tr_b16 v[54:55], v13 offset:64000
  s_waitcnt lgkmcnt(8)
  v_mfma_f32_32x32x16_bf16 v[128:143], v[16:19], v[32:35], v[128:143]
  v_mfma_f32_32x32x16_bf16 v[144:159], v[20:23], v[32:35], v[144:159]
  s_waitcnt lgkmcnt(0)
  s_barrier
  v_mfma_f32_32x32x16_bf16 v[64:79], v[44:47], v[36:39], v[64:79]
  ds_read_b128 v[16:19], v4 offset:0
  ds_read_b64_tr_b16 v[24:25], v12 offset:0
  v_mfma_f32_32x32x16_bf16 v[80:95], v[44:47], v[40:43], v[80:95]
  ds_read_b64_tr_b16 v[26:27], v12 offset:512
  ds_read_b128 v[20:23], v4 offset:4096
  v_mfma_f32_32x32x16_bf16 v[96:111], v[36:39], v[48:51], v[96:111]
  ds_read_b64_tr_b16 v[28:29], v12 offset:2048
  ds_read_b64_tr_b16 v[30:31], v12 offset:2560
  v_mfma_f32_32x32x16_bf16 v[112:127], v[40:43], v[48:51], v[112:127]
  ds_read_b64_tr_b16 v[32:33], v12 offset:4096
  ds_read_b64_tr_b16 v[34:35], v12 offset:4608
  v_mfma_f32_32x32x16_bf16 v[128:143], v[36:39], v[52:55], v[128:143]
  v_mfma_f32_32x32x16_bf16 v[144:159], v[40:43], v[52:55], v[144:159]
  s_sub_u32 s39, s39, 1
  s_cmp_lg_u32 s39, 0
  s_cbranch_scc1 G1_loop
  s_waitcnt lgkmcnt(0)
  s_lshl_b32 s40, s13, 1
  s_add_u32 s40, s40, s37
  s_lshl_b32 s41, s12, 2
  s_lshl_b32 s42, s36, 1
  s_add_u32 s41, s41, s42
  s_lshl_b32 s42, s41, 5
  s_add_u32 s42, s42, s40
  s_lshl_b32 s42, s42, 11
  s_add_u32 s43, s42, 65536
  v_lshlrev_b32 v3, 4, v2
  s_mov_b32 s44, 1069066811
  s_mov_b32 s45, 1069066811
  s_mov_b32 s46, 897988541
  s_mov_b32 s47, 897988541
  v_cvt_pk_bf16_f32 v160, v64, v65
  v_cvt_pk_bf16_f32 v161, v66, v67
  v_cvt_pk_bf16_f32 v162, v68, v69
  v_cvt_pk_bf16_f32 v163, v70, v71
  v_cvt_pk_bf16_f32 v164, v72, v73
  v_cvt_pk_bf16_f32 v165, v74, v75
  v_cvt_pk_bf16_f32 v166, v76, v77
  v_cvt_pk_bf16_f32 v167, v78, v79
  buffer_store_dwordx4 v[160:163], v3, s[24:27], s42 offen offset:0
  buffer_store_dwordx4 v[164:167], v3, s[24:27], s42 offen offset:1024
  v_cvt_pk_bf16_f32 v168, v80, v81
  v_cvt_pk_bf16_f32 v169, v82, v83
  v_cvt_pk_bf16_f32 v170, v84, v85
  v_cvt_pk_bf16_f32 v171, v86, v87
  v_cvt_pk_bf16_f32 v172, v88, v89
  v_cvt_pk_bf16_f32 v173, v90, v91
  v_cvt_pk_bf16_f32 v174, v92, v93
  v_cvt_pk_bf16_f32 v175, v94, v95
  buffer_store_dwordx4 v[168:171], v3, s[24:27], s43 offen offset:0
  buffer_store_dwordx4 v[172:175], v3, s[24:27], s43 offen offset:1024
  v_cvt_pk_bf16_f32 v16, v128, v129
  v_cvt_pk_bf16_f32 v17, v130, v131
  v_cvt_pk_bf16_f32 v18, v132, v133
  v_cvt_pk_bf16_f32 v19, v134, v135
  v_cvt_pk_bf16_f32 v20, v136, v137
  v_cvt_pk_bf16_f32 v21, v138, v139
  v_cvt_pk_bf16_f32 v22, v140, v141
  v_cvt_pk_bf16_f32 v23, v142, v143
  v_cvt_pk_bf16_f32 v24, v144, v145
  v_cvt_pk_bf16_f32 v25, v146, v147
  v_cvt_pk_bf16_f32 v26, v148, v149
  v_cvt_pk_bf16_f32 v27, v150, v151
  v_cvt_pk_bf16_f32 v28, v152, v153
  v_cvt_pk_bf16_f32 v29, v154, v155
  v_cvt_pk_bf16_f32 v30, v156, v157
  v_cvt_pk_bf16_f32 v31, v158, v159
  v_mov_b32 v56, 0x3f803f80
  v_mov_b32 v57, 0x3f803f80
  v_mov_b32 v58, 0x3f803f80
  v_mov_b32 v59, 0x3f803f80
  v_cvt_pk_bf16_f32 v176, v96, v97
  v_cvt_pk_bf16_f32 v177, v98, v99
  v_cvt_pk_bf16_f32 v178, v100, v101
  v_cvt_pk_bf16_f32 v179, v102, v103
  v_lshlrev_b32 v180, 16, v176
  v_and_b32 v181, 0xffff0000, v176
  v_lshlrev_b32 v182, 16, v177
  v_and_b32 v183, 0xffff0000, v177
  v_lshlrev_b32 v184, 16, v178
  v_and_b32 v185, 0xffff0000, v178
  v_lshlrev_b32 v186, 16, v179
  v_and_b32 v187, 0xffff0000, v179
  v_min_f32 v188, 0, v180
  v_min_f32 v189, 0, v181
  v_min_f32 v190, 0, v182
  v_min_f32 v191, 0, v183
  v_min_f32 v192, 0, v184
  v_min_f32 v193, 0, v185
  v_min_f32 v194, 0, v186
  v_min_f32 v195, 0, v187
  v_pk_mul_f32 v[196:197], v[188:189], s[44:45]
  v_pk_mul_f32 v[198:199], v[190:191], s[44:45]
  v_pk_mul_f32 v[200:201], v[192:193], s[44:45]
  v_pk_mul_f32 v[202:203], v[194:195], s[44:45]
  v_exp_f32 v196, v196
  v_exp_f32 v197, v197
  v_exp_f32 v198, v198
  v_exp_f32 v199, v199
  v_exp_f32 v200, v200
  v_exp_f32 v201, v201
  v_exp_f32 v202, v202
  v_exp_f32 v203, v203
  v_pk_add_f32 v[180:181], v[180:181], v[188:189] neg_lo:[0,1] neg_hi:[0,1]
  v_pk_add_f32 v[182:183], v[182:183], v[190:191] neg_lo:[0,1] neg_hi:[0,1]
  v_pk_add_f32 v[184:185], v[184:185], v[192:193] neg_lo:[0,1] neg_hi:[0,1]
  v_pk_add_f32 v[186:187], v[186:187], v[194:195] neg_lo:[0,1] neg_hi:[0,1]
  v_pk_add_f32 v[180:181], v[180:181], v[196:197]
  v_pk_add_f32 v[182:183], v[182:183], v[198:199]
  v_pk_add_f32 v[184:185], v[184:185], v[200:201]
  v_pk_add_f32 v[186:187], v[186:187], v[202:203]
  v_pk_add_f32 v[180:181], v[180:181], s[46:47]
  v_pk_add_f32 v[182:183], v[182:183], s[46:47]
  v_pk_add_f32 v[184:185], v[184:185], s[46:47]
  v_pk_add_f32 v[186:187], v[186:187], s[46:47]
  v_cvt_pk_bf16_f32 v32, v180, v181
  v_cvt_pk_bf16_f32 v33, v182, v183
  v_cvt_pk_bf16_f32 v34, v184, v185
  v_cvt_pk_bf16_f32 v35, v186, v187
  s_nop 1
  v_mfma_f32_32x32x16_bf16 v[64:79], v[32:35], v[16:19], 0
  v_mfma_f32_32x32x16_bf16 v[80:95], v[32:35], v[56:59], 0
  v_cvt_pk_bf16_f32 v176, v104, v105
  v_cvt_pk_bf16_f32 v177, v106, v107
  v_cvt_pk_bf16_f32 v178, v108, v109
  v_cvt_pk_bf16_f32 v179, v110, v111
  v_lshlrev_b32 v180, 16, v176
  v_and_b32 v181, 0xffff0000, v176
  v_lshlrev_b32 v182, 16, v177
  v_and_b32 v183, 0xffff0000, v177
  v_lshlrev_b32 v184, 16, v178
  v_and_b32 v185, 0xffff0000, v178
  v_lshlrev_b32 v186, 16, v179
  v_and_b32 v187, 0xffff0000, v179
  v_min_f32 v188, 0, v180
  v_min_f32 v189, 0, v181
  v_min_f32 v190, 0, v182
  v_min_f32 v191, 0, v183
  v_min_f32 v192, 0, v184
  v_min_f32 v193, 0, v185
  v_min_f32 v194, 0, v186
  v_min_f32 v195, 0, v187
  v_pk_mul_f32 v[196:197], v[188:189], s[44:45]
  v_pk_mul_f32 v[198:199], v[190:191], s[44:45]
  v_pk_mul_f32 v[200:201], v[192:193], s[44:45]
  v_pk_mul_f32 v[202:203], v[194:195], s[44:45]
  v_exp_f32 v196, v196
  v_exp_f32 v197, v197
  v_exp_f32 v198, v198
  v_exp_f32 v199, v199
  v_exp_f32 v200, v200
  v_exp_f32 v201, v201
  v_exp_f32 v202, v202
  v_exp_f32 v203, v203
  v_pk_add_f32 v[180:181], v[180:181], v[188:189] neg_lo:[0,1] neg_hi:[0,1]
  v_pk_add_f32 v[182:183], v[182:183], v[190:191] neg_lo:[0,1] neg_hi:[0,1]
  v_pk_add_f32 v[184:185], v[184:185], v[192:193] neg_lo:[0,1] neg_hi:[0,1]
  v_pk_add_f32 v[186:187], v[186:187], v[194:195] neg_lo:[0,1] neg_hi:[0,1]
  v_pk_add_f32 v[180:181], v[180:181], v[196:197]
  v_pk_add_f32 v[182:183], v[182:183], v[198:199]
  v_pk_add_f32 v[184:185], v[184:185], v[200:201]
  v_pk_add_f32 v[186:187], v[186:187], v[202:203]
  v_pk_add_f32 v[180:181], v[180:181], s[46:47]
  v_pk_add_f32 v[182:183], v[182:183], s[46:47]
  v_pk_add_f32 v[184:185], v[184:185], s[46:47]
  v_pk_add_f32 v[186:187], v[186:187], s[46:47]
  v_cvt_pk_bf16_f32 v36, v180, v181
  v_cvt_pk_bf16_f32 v37, v182, v183
  v_cvt_pk_bf16_f32 v38, v184, v185
  v_cvt_pk_bf16_f32 v39, v186, v187
  s_nop 1
  v_mfma_f32_32x32x16_bf16 v[64:79], v[36:39], v[20:23], v[64:79]
  v_mfma_f32_32x32x16_bf16 v[80:95], v[36:39], v[56:59], v[80:95]
  v_cvt_pk_bf16_f32 v176, v112, v113
  v_cvt_pk_bf16_f32 v177, v114, v115
  v_cvt_pk_bf16_f32 v178, v116, v117
  v_cvt_pk_bf16_f32 v179, v118, v119
  v_lshlrev_b32 v180, 16, v176
  v_and_b32 v181, 0xffff0000, v176
  v_lshlrev_b32 v182, 16, v177
  v_and_b32 v183, 0xffff0000, v177
  v_lshlrev_b32 v184, 16, v178
  v_and_b32 v185, 0xffff0000, v178
  v_lshlrev_b32 v186, 16, v179
  v_and_b32 v187, 0xffff0000, v179
  v_min_f32 v188, 0, v180
  v_min_f32 v189, 0, v181
  v_min_f32 v190, 0, v182
  v_min_f32 v191, 0, v183
  v_min_f32 v192, 0, v184
  v_min_f32 v193, 0, v185
  v_min_f32 v194, 0, v186
  v_min_f32 v195, 0, v187
  v_pk_mul_f32 v[196:197], v[188:189], s[44:45]
  v_pk_mul_f32 v[198:199], v[190:191], s[44:45]
  v_pk_mul_f32 v[200:201], v[192:193], s[44:45]
  v_pk_mul_f32 v[202:203], v[194:195], s[44:45]
  v_exp_f32 v196, v196
  v_exp_f32 v197, v197
  v_exp_f32 v198, v198
  v_exp_f32 v199, v199
  v_exp_f32 v200, v200
  v_exp_f32 v201, v201
  v_exp_f32 v202, v202
  v_exp_f32 v203, v203
  v_pk_add_f32 v[180:181], v[180:181], v[188:189] neg_lo:[0,1] neg_hi:[0,1]
  v_pk_add_f32 v[182:183], v[182:183], v[190:191] neg_lo:[0,1] neg_hi:[0,1]
  v_pk_add_f32 v[184:185], v[184:185], v[192:193] neg_lo:[0,1] neg_hi:[0,1]
  v_pk_add_f32 v[186:187], v[186:187], v[194:195] neg_lo:[0,1] neg_hi:[0,1]
  v_pk_add_f32 v[180:181], v[180:181], v[196:197]
  v_pk_add_f32 v[182:183], v[182:183], v[198:199]
  v_pk_add_f32 v[184:185], v[184:185], v[200:201]
  v_pk_add_f32 v[186:187], v[186:187], v[202:203]
  v_pk_add_f32 v[180:181], v[180:181], s[46:47]
  v_pk_add_f32 v[182:183], v[182:183], s[46:47]
  v_pk_add_f32 v[184:185], v[184:185], s[46:47]
  v_pk_add_f32 v[186:187], v[186:187], s[46:47]
  v_cvt_pk_bf16_f32 v40, v180, v181
  v_cvt_pk_bf16_f32 v41, v182, v183
  v_cvt_pk_bf16_f32 v42, v184, v185
  v_cvt_pk_bf16_f32 v43, v186, v187
  s_nop 1
  v_mfma_f32_32x32x16_bf16 v[64:79], v[40:43], v[24:27], v[64:79]
  v_mfma_f32_32x32x16_bf16 v[80:95], v[40:43], v[56:59], v[80:95]
  v_cvt_pk_bf16_f32 v176, v120, v121
  v_cvt_pk_bf16_f32 v177, v122, v123
  v_cvt_pk_bf16_f32 v178, v124, v125
  v_cvt_pk_bf16_f32 v179, v126, v127
  v_lshlrev_b32 v180, 16, v176
  v_and_b32 v181, 0xffff0000, v176
  v_lshlrev_b32 v182, 16, v177
  v_and_b32 v183, 0xffff0000, v177
  v_lshlrev_b32 v184, 16, v178
  v_and_b32 v185, 0xffff0000, v178
  v_lshlrev_b32 v186, 16, v179
  v_and_b32 v187, 0xffff0000, v179
  v_min_f32 v188, 0, v180
  v_min_f32 v189, 0, v181
  v_min_f32 v190, 0, v182
  v_min_f32 v191, 0, v183
  v_min_f32 v192, 0, v184
  v_min_f32 v193, 0, v185
  v_min_f32 v194, 0, v186
  v_min_f32 v195, 0, v187
  v_pk_mul_f32 v[196:197], v[188:189], s[44:45]
  v_pk_mul_f32 v[198:199], v[190:191], s[44:45]
  v_pk_mul_f32 v[200:201], v[192:193], s[44:45]
  v_pk_mul_f32 v[202:203], v[194:195], s[44:45]
  v_exp_f32 v196, v196
  v_exp_f32 v197, v197
  v_exp_f32 v198, v198
  v_exp_f32 v199, v199
  v_exp_f32 v200, v200
  v_exp_f32 v201, v201
  v_exp_f32 v202, v202
  v_exp_f32 v203, v203
  v_pk_add_f32 v[180:181], v[180:181], v[188:189] neg_lo:[0,1] neg_hi:[0,1]
  v_pk_add_f32 v[182:183], v[182:183], v[190:191] neg_lo:[0,1] neg_hi:[0,1]
  v_pk_add_f32 v[184:185], v[184:185], v[192:193] neg_lo:[0,1] neg_hi:[0,1]
  v_pk_add_f32 v[186:187], v[186:187], v[194:195] neg_lo:[0,1] neg_hi:[0,1]
  v_pk_add_f32 v[180:181], v[180:181], v[196:197]
  v_pk_add_f32 v[182:183], v[182:183], v[198:199]
  v_pk_add_f32 v[184:185], v[184:185], v[200:201]
  v_pk_add_f32 v[186:187], v[186:187], v[202:203]
  v_pk_add_f32 v[180:181], v[180:181], s[46:47]
  v_pk_add_f32 v[182:183], v[182:183], s[46:47]
  v_pk_add_f32 v[184:185], v[184:185], s[46:47]
  v_pk_add_f32 v[186:187], v[186:187], s[46:47]
  v_cvt_pk_bf16_f32 v44, v180, v181
  v_cvt_pk_bf16_f32 v45, v182, v183
  v_cvt_pk_bf16_f32 v46, v184, v185
  v_cvt_pk_bf16_f32 v47, v186, v187
  s_nop 1
  v_mfma_f32_32x32x16_bf16 v[64:79], v[44:47], v[28:31], v[64:79]
  v_mfma_f32_32x32x16_bf16 v[80:95], v[44:47], v[56:59], v[80:95]
  s_lshl_b32 s48, s12, 1
  s_add_u32 s48, s48, s36
  s_lshl_b32 s49, s40, 5
  s_add_u32 s48, s48, s49
  s_lshl_b32 s49, s48, 12
  s_lshl_b32 s50, s48, 7
  v_lshlrev_b32 v4, 6, v14
  s_nop 3
  buffer_store_dwordx4 v[64:67], v3, s[28:31], s49 offen offset:0
  buffer_store_dwordx4 v[68:71], v3, s[28:31], s49 offen offset:1024
  buffer_store_dwordx4 v[72:75], v3, s[28:31], s49 offen offset:2048
  buffer_store_dwordx4 v[76:79], v3, s[28:31], s49 offen offset:3072
  s_mov_b32 exec_lo, 1
  s_mov_b32 exec_hi, 1
  buffer_store_dwordx4 v[80:83], v4, s[32:35], s50 offen offset:0
  buffer_store_dwordx4 v[84:87], v4, s[32:35], s50 offen offset:16
  buffer_store_dwordx4 v[88:91], v4, s[32:35], s50 offen offset:32
  buffer_store_dwordx4 v[92:95], v4, s[32:35], s50 offen offset:48
  s_endpgm
G1_loader:
  s_sub_u32 s36, s3, 4
  v_lshrrev_b32 v3, 3, v2
  v_and_b32 v4, 7, v2
  v_lshrrev_b32 v5, 4, v2
  v_add_u32 v6, 0, v5
  v_xor_b32 v6, v6, v4
  v_lshlrev_b32 v6, 4, v6
  v_lshl_add_u32 v6, v3, 11, v6
  v_add_u32 v8, 0, v6
  v_add_u32 v6, 4, v5
  v_xor_b32 v6, v6, v4
  v_lshlrev_b32 v6, 4, v6
  v_lshl_add_u32 v6, v3, 11, v6
  v_add_u32 v9, 15360, v6
  v_add_u32 v6, 0, v5
  v_xor_b32 v6, v6, v4
  v_lshlrev_b32 v6, 4, v6
  v_lshl_add_u32 v6, v3, 11, v6
  v_add_u32 v10, 30720, v6
  v_add_u32 v6, 4, v5
  v_xor_b32 v6, v6, v4
  v_lshlrev_b32 v6, 4, v6
  v_lshl_add_u32 v6, v3, 11, v6
  v_add_u32 v11, 46080, v6
  v_lshrrev_b32 v6, 5, v2
  v_bfe_u32 v7, v2, 2, 2
  v_lshl_add_u32 v6, v6, 2, v7
  s_movk_i32 s37, 6144
  v_mul_lo_u32 v6, v6, s37
  v_bfe_u32 v7, v2, 4, 1
  v_lshl_add_u32 v6, v7, 6, v6
  v_and_b32 v7, 3, v2
  v_lshl_add_u32 v6, v7, 4, v6
  v_add_u32 v12, 0, v6
  v_add_u32 v13, 48128, v6
  v_add_u32 v14, 0, v6
  v_add_u32 v15, 48128, v6
  v_add_u32 v16, 4096, v6
  v_add_u32 v17, 52224, v6
  s_lshl_b32 s38, s12, 7
  s_lshl_b32 s40, s36, 5
  s_add_u32 s38, s38, s40
  s_lshl_b32 s38, s38, 11
  s_mul_i32 s39, s36, 98304
  s_lshl_b32 s40, s13, 7
  s_add_u32 s39, s39, s40
  s_lshl_b32 s41, s36, 12
  s_mul_i32 s42, s36, 6144
  s_add_u32 s42, s42, 16384
  s_add_u32 m0, s41, 0
  s_nop 0
  buffer_load_dwordx4 v8, s[16:19], s38 offen offset:0 lds
  buffer_load_dwordx4 v9, s[16:19], s38 offen offset:1024 lds
  buffer_load_dwordx4 v10, s[16:19], s38 offen offset:2048 lds
  buffer_load_dwordx4 v11, s[16:19], s38 offen offset:3072 lds
  s_add_u32 m0, s42, 0
  s_nop 0
  buffer_load_dwordx4 v12, s[20:23], s39 offen offset:0 lds
  buffer_load_dwordx4 v13, s[20:23], s39 offen offset:1024 lds
  buffer_load_dwordx4 v14, s[20:23], s39 offen offset:2048 lds
  buffer_load_dwordx4 v15, s[20:23], s39 offen offset:3072 lds
  s_add_u32 m0, s42, 4096
  s_nop 0
  buffer_load_dwordx4 v16, s[20:23], s39 offen offset:0 lds
  buffer_load_dwordx4 v17, s[20:23], s39 offen offset:1024 lds
  s_add_u32 s38, s38, 128
  s_add_u32 s39, s39, 393216
  s_add_u32 m0, s41, 40960
  s_nop 0
  buffer_load_dwordx4 v8, s[16:19], s38 offen offset:0 lds
  buffer_load_dwordx4 v9, s[16:19], s38 offen offset:1024 lds
  buffer_load_dwordx4 v10, s[16:19], s38 offen offset:2048 lds
  buffer_load_dwordx4 v11, s[16:19], s38 offen offset:3072 lds
  s_add_u32 m0, s42, 40960
  s_nop 0
  buffer_load_dwordx4 v12, s[20:23], s39 offen offset:0 lds
  buffer_load_dwordx4 v13, s[20:23], s39 offen offset:1024 lds
  buffer_load_dwordx4 v14, s[20:23], s39 offen offset:2048 lds
  buffer_load_dwordx4 v15, s[20:23], s39 offen offset:3072 lds
  s_add_u32 m0, s42, 45056
  s_nop 0
  buffer_load_dwordx4 v16, s[20:23], s39 offen offset:0 lds
  buffer_load_dwordx4 v17, s[20:23], s39 offen offset:1024 lds
  s_add_u32 s38, s38, 128
  s_add_u32 s39, s39, 393216
  s_add_u32 m0, s41, 81920
  s_nop 0
  buffer_load_dwordx4 v8, s[16:19], s38 offen offset:0 lds
  buffer_load_dwordx4 v9, s[16:19], s38 offen offset:1024 lds
  buffer_load_dwordx4 v10, s[16:19], s38 offen offset:2048 lds
  buffer_load_dwordx4 v11, s[16:19], s38 offen offset:3072 lds
  s_add_u32 m0, s42, 81920
  s_nop 0
  buffer_load_dwordx4 v12, s[20:23], s39 offen offset:0 lds
  buffer_load_dwordx4 v13, s[20:23], s39 offen offset:1024 lds
  buffer_load_dwordx4 v14, s[20:23], s39 offen offset:2048 lds
  buffer_load_dwordx4 v15, s[20:23], s39 offen offset:3072 lds
  s_add_u32 m0, s42, 86016
  s_nop 0
  buffer_load_dwordx4 v16, s[20:23], s39 offen offset:0 lds
  buffer_load_dwordx4 v17, s[20:23], s39 offen offset:1024 lds
  s_add_u32 s38, s38, 128
  s_add_u32 s39, s39, 393216
  s_waitcnt vmcnt(20)
  s_barrier
  s_add_u32 m0, s41, 122880
  s_nop 0
  buffer_load_dwordx4 v8, s[16:19], s38 offen offset:0 lds
  buffer_load_dwordx4 v9, s[16:19], s38 offen offset:1024 lds
  buffer_load_dwordx4 v10, s[16:19], s38 offen offset:2048 lds
  buffer_load_dwordx4 v11, s[16:19], s38 offen offset:3072 lds
  s_add_u32 m0, s42, 122880
  s_nop 0
  buffer_load_dwordx4 v12, s[20:23], s39 offen offset:0 lds
  buffer_load_dwordx4 v13, s[20:23], s39 offen offset:1024 lds
  buffer_load_dwordx4 v14, s[20:23], s39 offen offset:2048 lds
  buffer_load_dwordx4 v15, s[20:23], s39 offen offset:3072 lds
  s_add_u32 m0, s42, 126976
  s_nop 0
  buffer_load_dwordx4 v16, s[20:23], s39 offen offset:0 lds
  buffer_load_dwordx4 v17, s[20:23], s39 offen offset:1024 lds
  s_add_u32 s38, s38, 128
  s_add_u32 s39, s39, 393216
  s_waitcnt vmcnt(20)
  s_barrier
  s_add_u32 m0, s41, 0
  s_nop 0
  buffer_load_dwordx4 v8, s[16:19], s38 offen offset:0 lds
  buffer_load_dwordx4 v9, s[16:19], s38 offen offset:1024 lds
  buffer_load_dwordx4 v10, s[16:19], s38 offen offset:2048 lds
  buffer_load_dwordx4 v11, s[16:19], s38 offen offset:3072 lds
  s_add_u32 m0, s42, 0
  s_nop 0
  buffer_load_dwordx4 v12, s[20:23], s39 offen offset:0 lds
  buffer_load_dwordx4 v13, s[20:23], s39 offen offset:1024 lds
  buffer_load_dwordx4 v14, s[20:23], s39 offen offset:2048 lds
  buffer_load_dwordx4 v15, s[20:23], s39 offen offset:3072 lds
  s_add_u32 m0, s42, 4096
  s_nop 0
  buffer_load_dwordx4 v16, s[20:23], s39 offen offset:0 lds
  buffer_load_dwordx4 v17, s[20:23], s39 offen offset:1024 lds
  s_add_u32 s38, s38, 128
  s_add_u32 s39, s39, 393216
  s_waitcnt vmcnt(20)
  s_barrier
  s_add_u32 m0, s41, 40960
  s_nop 0
  buffer_load_dwordx4 v8, s[16:19], s38 offen offset:0 lds
  buffer_load_dwordx4 v9, s[16:19], s38 offen offset:1024 lds
  buffer_load_dwordx4 v10, s[16:19], s38 offen offset:2048 lds
  buffer_load_dwordx4 v11, s[16:19], s38 offen offset:3072 lds
  s_add_u32 m0, s42, 40960
  s_nop 0
  buffer_load_dwordx4 v12, s[20:23], s39 offen offset:0 lds
  buffer_load_dwordx4 v13, s[20:23], s39 offen offset:1024 lds
  buffer_load_dwordx4 v14, s[20:23], s39 offen offset:2048 lds
  buffer_load_dwordx4 v15, s[20:23], s39 offen offset:3072 lds
  s_add_u32 m0, s42, 45056
  s_nop 0
  buffer_load_dwordx4 v16, s[20:23], s39 offen offset:0 lds
  buffer_load_dwordx4 v17, s[20:23], s39 offen offset:1024 lds
  s_add_u32 s38, s38, 128
  s_add_u32 s39, s39, 393216
  s_waitcnt vmcnt(20)
  s_barrier
  s_add_u32 m0, s41, 81920
  s_nop 0
  buffer_load_dwordx4 v8, s[16:19], s38 offen offset:0 lds
  buffer_load_dwordx4 v9, s[16:19], s38 offen offset:1024 lds
  buffer_load_dwordx4 v10, s[16:19], s38 offen offset:2048 lds
  buffer_load_dwordx4 v11, s[16:19], s38 offen offset:3072 lds
  s_add_u32 m0, s42, 81920
  s_nop 0
  buffer_load_dwordx4 v12, s[20:23], s39 offen offset:0 lds
  buffer_load_dwordx4 v13, s[20:23], s39 offen offset:1024 lds
  buffer_load_dwordx4 v14, s[20:23], s39 offen offset:2048 lds
  buffer_load_dwordx4 v15, s[20:23], s39 offen offset:3072 lds
  s_add_u32 m0, s42, 86016
  s_nop 0
  buffer_load_dwordx4 v16, s[20:23], s39 offen offset:0 lds
  buffer_load_dwordx4 v17, s[20:23], s39 offen offset:1024 lds
  s_add_u32 s38, s38, 128
  s_add_u32 s39, s39, 393216
  s_waitcnt vmcnt(20)
  s_barrier
  s_add_u32 m0, s41, 122880
  s_nop 0
  buffer_load_dwordx4 v8, s[16:19], s38 offen offset:0 lds
  buffer_load_dwordx4 v9, s[16:19], s38 offen offset:1024 lds
  buffer_load_dwordx4 v10, s[16:19], s38 offen offset:2048 lds
  buffer_load_dwordx4 v11, s[16:19], s38 offen offset:3072 lds
  s_add_u32 m0, s42, 122880
  s_nop 0
  buffer_load_dwordx4 v12, s[20:23], s39 offen offset:0 lds
  buffer_load_dwordx4 v13, s[20:23], s39 offen offset:1024 lds
  buffer_load_dwordx4 v14, s[20:23], s39 offen offset:2048 lds
  buffer_load_dwordx4 v15, s[20:23], s39 offen offset:3072 lds
  s_add_u32 m0, s42, 126976
  s_nop 0
  buffer_load_dwordx4 v16, s[20:23], s39 offen offset:0 lds
  buffer_load_dwordx4 v17, s[20:23], s39 offen offset:1024 lds
  s_add_u32 s38, s38, 128
  s_add_u32 s39, s39, 393216
  s_waitcnt vmcnt(20)
  s_barrier
  s_add_u32 m0, s41, 0
  s_nop 0
  buffer_load_dwordx4 v8, s[16:19], s38 offen offset:0 lds
  buffer_load_dwordx4 v9, s[16:19], s38 offen offset:1024 lds
  buffer_load_dwordx4 v10, s[16:19], s38 offen offset:2048 lds
  buffer_load_dwordx4 v11, s[16:19], s38 offen offset:3072 lds
  s_add_u32 m0, s42, 0
  s_nop 0
  buffer_load_dwordx4 v12, s[20:23], s39 offen offset:0 lds
  buffer_load_dwordx4 v13, s[20:23], s39 offen offset:1024 lds
  buffer_load_dwordx4 v14, s[20:23], s39 offen offset:2048 lds
  buffer_load_dwordx4 v15, s[20:23], s39 offen offset:3072 lds
  s_add_u32 m0, s42, 4096
  s_nop 0
  buffer_load_dwordx4 v16, s[20:23], s39 offen offset:0 lds
  buffer_load_dwordx4 v17, s[20:23], s39 offen offset:1024 lds
  s_add_u32 s38, s38, 128
  s_add_u32 s39, s39, 393216
  s_waitcnt vmcnt(20)
  s_barrier
  s_add_u32 m0, s41, 40960
  s_nop 0
  buffer_load_dwordx4 v8, s[16:19], s38 offen offset:0 lds
  buffer_load_dwordx4 v9, s[16:19], s38 offen offset:1024 lds
  buffer_load_dwordx4 v10, s[16:19], s38 offen offset:2048 lds
  buffer_load_dwordx4 v11, s[16:19], s38 offen offset:3072 lds
  s_add_u32 m0, s42, 40960
  s_nop 0
  buffer_load_dwordx4 v12, s[20:23], s39 offen offset:0 lds
  buffer_load_dwordx4 v13, s[20:23], s39 offen offset:1024 lds
  buffer_load_dwordx4 v14, s[20:23], s39 offen offset:2048 lds
  buffer_load_dwordx4 v15, s[20:23], s39 offen offset:3072 lds
  s_add_u32 m0, s42, 45056
  s_nop 0
  buffer_load_dwordx4 v16, s[20:23], s39 offen offset:0 lds
  buffer_load_dwordx4 v17, s[20:23], s39 offen offset:1024 lds
  s_add_u32 s38, s38, 128
  s_add_u32 s39, s39, 393216
  s_waitcnt vmcnt(20)
  s_barrier
  s_add_u32 m0, s41, 81920
  s_nop 0
  buffer_load_dwordx4 v8, s[16:19], s38 offen offset:0 lds
  buffer_load_dwordx4 v9, s[16:19], s38 offen offset:1024 lds
  buffer_load_dwordx4 v10, s[16:19], s38 offen offset:2048 lds
  buffer_load_dwordx4 v11, s[16:19], s38 offen offset:3072 lds
  s_add_u32 m0, s42, 81920
  s_nop 0
  buffer_load_dwordx4 v12, s[20:23], s39 offen offset:0 lds
  buffer_load_dwordx4 v13, s[20:23], s39 offen offset:1024 lds
  buffer_load_dwordx4 v14, s[20:23], s39 offen offset:2048 lds
  buffer_load_dwordx4 v15, s[20:23], s39 offen offset:3072 lds
  s_add_u32 m0, s42, 86016
  s_nop 0
  buffer_load_dwordx4 v16, s[20:23], s39 offen offset:0 lds
  buffer_load_dwordx4 v17, s[20:23], s39 offen offset:1024 lds
  s_add_u32 s38, s38, 128
  s_add_u32 s39, s39, 393216
  s_waitcnt vmcnt(20)
  s_barrier
  s_add_u32 m0, s41, 122880
  s_nop 0
  buffer_load_dwordx4 v8, s[16:19], s38 offen offset:0 lds
  buffer_load_dwordx4 v9, s[16:19], s38 offen offset:1024 lds
  buffer_load_dwordx4 v10, s[16:19], s38 offen offset:2048 lds
  buffer_load_dwordx4 v11, s[16:19], s38 offen offset:3072 lds
  s_add_u32 m0, s42, 122880
  s_nop 0
  buffer_load_dwordx4 v12, s[20:23], s39 offen offset:0 lds
  buffer_load_dwordx4 v13, s[20:23], s39 offen offset:1024 lds
  buffer_load_dwordx4 v14, s[20:23], s39 offen offset:2048 lds
  buffer_load_dwordx4 v15, s[20:23], s39 offen offset:3072 lds
  s_add_u32 m0, s42, 126976
  s_nop 0
  buffer_load_dwordx4 v16, s[20:23], s39 offen offset:0 lds
  buffer_load_dwordx4 v17, s[20:23], s39 offen offset:1024 lds
  s_add_u32 s38, s38, 128
  s_add_u32 s39, s39, 393216
  s_waitcnt vmcnt(20)
  s_barrier
  s_add_u32 m0, s41, 0
  s_nop 0
  buffer_load_dwordx4 v8, s[16:19], s38 offen offset:0 lds
  buffer_load_dwordx4 v9, s[16:19], s38 offen offset:1024 lds
  buffer_load_dwordx4 v10, s[16:19], s38 offen offset:2048 lds
  buffer_load_dwordx4 v11, s[16:19], s38 offen offset:3072 lds
  s_add_u32 m0, s42, 0
  s_nop 0
  buffer_load_dwordx4 v12, s[20:23], s39 offen offset:0 lds
  buffer_load_dwordx4 v13, s[20:23], s39 offen offset:1024 lds
  buffer_load_dwordx4 v14, s[20:23], s39 offen offset:2048 lds
  buffer_load_dwordx4 v15, s[20:23], s39 offen offset:3072 lds
  s_add_u32 m0, s42, 4096
  s_nop 0
  buffer_load_dwordx4 v16, s[20:23], s39 offen offset:0 lds
  buffer_load_dwordx4 v17, s[20:23], s39 offen offset:1024 lds
  s_add_u32 s38, s38, 128
  s_add_u32 s39, s39, 393216
  s_waitcnt vmcnt(20)
  s_barrier
  s_add_u32 m0, s41, 40960
  s_nop 0
  buffer_load_dwordx4 v8, s[16:19], s38 offen offset:0 lds
  buffer_load_dwordx4 v9, s[16:19], s38 offen offset:1024 lds
  buffer_load_dwordx4 v10, s[16:19], s38 offen offset:2048 lds
  buffer_load_dwordx4 v11, s[16:19], s38 offen offset:3072 lds
  s_add_u32 m0, s42, 40960
  s_nop 0
  buffer_load_dwordx4 v12, s[20:23], s39 offen offset:0 lds
  buffer_load_dwordx4 v13, s[20:23], s39 offen offset:1024 lds
  buffer_load_dwordx4 v14, s[20:23], s39 offen offset:2048 lds
  buffer_load_dwordx4 v15, s[20:23], s39 offen offset:3072 lds
  s_add_u32 m0, s42, 45056
  s_nop 0
  buffer_load_dwordx4 v16, s[20:23], s39 offen offset:0 lds
  buffer_load_dwordx4 v17, s[20:23], s39 offen offset:1024 lds
  s_add_u32 s38, s38, 128
  s_add_u32 s39, s39, 393216
  s_waitcnt vmcnt(20)
  s_barrier
  s_add_u32 m0, s41, 81920
  s_nop 0
  buffer_load_dwordx4 v8, s[16:19], s38 offen offset:0 lds
  buffer_load_dwordx4 v9, s[16:19], s38 offen offset:1024 lds
  buffer_load_dwordx4 v10, s[16:19], s38 offen offset:2048 lds
  buffer_load_dwordx4 v11, s[16:19], s38 offen offset:3072 lds
  s_add_u32 m0, s42, 81920
  s_nop 0
  buffer_load_dwordx4 v12, s[20:23], s39 offen offset:0 lds
  buffer_load_dwordx4 v13, s[20:23], s39 offen offset:1024 lds
  buffer_load_dwordx4 v14, s[20:23], s39 offen offset:2048 lds
  buffer_load_dwordx4 v15, s[20:23], s39 offen offset:3072 lds
  s_add_u32 m0, s42, 86016
  s_nop 0
  buffer_load_dwordx4 v16, s[20:23], s39 offen offset:0 lds
  buffer_load_dwordx4 v17, s[20:23], s39 offen offset:1024 lds
  s_add_u32 s38, s38, 128
  s_add_u32 s39, s39, 393216
  s_waitcnt vmcnt(20)
  s_barrier
  s_add_u32 m0, s41, 122880
  s_nop 0
  buffer_load_dwordx4 v8, s[16:19], s38 offen offset:0 lds
  buffer_load_dwordx4 v9, s[16:19], s38 offen offset:1024 lds
  buffer_load_dwordx4 v10, s[16:19], s38 offen offset:2048 lds
  buffer_load_dwordx4 v11, s[16:19], s38 offen offset:3072 lds
  s_add_u32 m0, s42, 122880
  s_nop 0
  buffer_load_dwordx4 v12, s[20:23], s39 offen offset:0 lds
  buffer_load_dwordx4 v13, s[20:23], s39 offen offset:1024 lds
  buffer_load_dwordx4 v14, s[20:23], s39 offen offset:2048 lds
  buffer_load_dwordx4 v15, s[20:23], s39 offen offset:3072 lds
  s_add_u32 m0, s42, 126976
  s_nop 0
  buffer_load_dwordx4 v16, s[20:23], s39 offen offset:0 lds
  buffer_load_dwordx4 v17, s[20:23], s39 offen offset:1024 lds
  s_add_u32 s38, s38, 128
  s_add_u32 s39, s39, 393216
  s_waitcnt vmcnt(20)
  s_barrier
  s_waitcnt vmcnt(10)
  s_barrier
  s_waitcnt vmcnt(0)
  s_barrier
  s_barrier
G1_end:
  s_endpgm
.globl conv_kernel
.p2align 8
.type conv_kernel,@function
conv_kernel:
  s_cmp_ge_u32 s2, 256
  s_cbranch_scc1 CV_end
  s_load_dwordx4 s[4:7], s[0:1], 32
  s_load_dwordx2 s[8:9], s[0:1], 88
  v_lshrrev_b32 v1, 6, v0
  v_and_b32 v2, 63, v0
  s_lshl_b32 s12, s2, 2
  v_readfirstlane_b32 s3, v1
  v_lshlrev_b32 v3, 4, v2
  s_add_u32 s12, s12, s3
  s_mul_i32 s13, s3, 9216
  s_lshl_b32 s14, s12, 12
  s_waitcnt lgkmcnt(0)
  s_mov_b32 s16, s4
  s_mov_b32 s17, s5
  s_mov_b32 s18, 4194304
  s_mov_b32 s19, 0x20000
  s_mov_b32 s20, s6
  s_mov_b32 s21, s7
  s_mov_b32 s22, 2048
  s_mov_b32 s23, 0x20000
  s_add_u32 s24, s8, 16777216
  s_addc_u32 s25, s9, 0
  s_mov_b32 s26, 4194304
  s_mov_b32 s27, 0x20000
  s_add_u32 s28, s8, 20971520
  s_addc_u32 s29, s9, 0
  s_mov_b32 s30, 4194304
  s_mov_b32 s31, 0x20000
  s_lshl_b32 s15, s12, 1
  v_mov_b32 v4, 0
  buffer_load_ushort v5, v4, s[20:23], s15 offen
  s_add_u32 m0, s13, 4672
  s_nop 0
  buffer_load_dwordx4 v3, s[24:27], s14 offen offset:0 lds
  s_add_u32 m0, s13, 64
  s_nop 0
  buffer_load_dwordx4 v3, s[16:19], s14 offen offset:0 lds
  s_add_u32 m0, s13, 4672
  s_nop 0
  buffer_load_dwordx4 v3, s[24:27], s14 offen offset:1024 lds
  s_add_u32 m0, s13, 64
  s_nop 0
  buffer_load_dwordx4 v3, s[16:19], s14 offen offset:1024 lds
  s_add_u32 m0, s13, 4672
  s_nop 0
  buffer_load_dwordx4 v3, s[24:27], s14 offen offset:2048 lds
  s_add_u32 m0, s13, 64
  s_nop 0
  buffer_load_dwordx4 v3, s[16:19], s14 offen offset:2048 lds
  s_add_u32 m0, s13, 4672
  s_nop 0
  buffer_load_dwordx4 v3, s[24:27], s14 offen offset:3072 lds
  s_add_u32 m0, s13, 64
  s_nop 0
  buffer_load_dwordx4 v3, s[16:19], s14 offen offset:3072 lds
  v_mov_b32 v6, 0
  v_mov_b32 v7, 0
  v_lshlrev_b32 v8, 3, v2
  v_add_u32 v8, s13, v8
  ds_write_b64 v8, v[6:7] offset:4160
  v_and_b32 v8, 15, v2
  v_lshlrev_b32 v8, 2, v8
  v_add_u32 v8, s13, v8
  ds_write_b32 v8, v6
  v_and_b32 v8, 3, v2
  v_bfe_u32 v9, v2, 2, 2
  v_bfe_u32 v10, v2, 4, 1
  v_lshrrev_b32 v11, 5, v2
  v_lshlrev_b32 v12, 5, v10
  v_lshl_add_u32 v12, v8, 3, v12
  v_lshl_add_u32 v12, v11, 6, v12
  v_lshlrev_b32 v13, 3, v9
  v_sub_u32 v12, v12, v13
  s_add_u32 s32, s13, 32
  v_add_u32 v12, s32, v12
  v_lshlrev_b32 v14, 8, v10
  v_lshl_add_u32 v14, v8, 6, v14
  v_add_u32 v14, v14, v13
  v_lshlrev_b32 v15, 6, v11
  v_sub_u32 v14, v14, v15
  s_add_u32 s32, s13, 4288
  v_add_u32 v14, s32, v14
  v_mov_b32 v15, s13
  s_waitcnt vmcnt(6)
  ds_read_u16 v16, v15 offset:64
  v_lshlrev_b32 v5, 16, v5
  s_waitcnt lgkmcnt(0)
  v_lshlrev_b32 v16, 16, v16
  v_add_f32 v16, v16, v5
  v_cvt_pk_bf16_f32 v16, v16, v16
  ds_write_b16 v15, v16 offset:64
  s_waitcnt lgkmcnt(0)
  ds_read_b64_tr_b16 v[156:157], v14 offset:896
  ds_read_b64_tr_b16 v[158:159], v14 offset:928
  ds_read_b64_tr_b16 v[140:141], v14 offset:384
  ds_read_b64_tr_b16 v[142:143], v14 offset:416
  ds_read_b64_tr_b16 v[16:17], v12 offset:32
  ds_read_b64_tr_b16 v[18:19], v12 offset:0
  ds_read_b64_tr_b16 v[152:153], v14 offset:768
  ds_read_b64_tr_b16 v[154:155], v14 offset:800
  ds_read_b64_tr_b16 v[136:137], v14 offset:256
  ds_read_b64_tr_b16 v[138:139], v14 offset:288
  ds_read_b64_tr_b16 v[20:21], v12 offset:160
  ds_read_b64_tr_b16 v[22:23], v12 offset:128
  ds_read_b64_tr_b16 v[148:149], v14 offset:640
  ds_read_b64_tr_b16 v[150:151], v14 offset:672
  ds_read_b64_tr_b16 v[132:133], v14 offset:128
  ds_read_b64_tr_b16 v[134:135], v14 offset:160
  ds_read_b64_tr_b16 v[24:25], v12 offset:288
  ds_read_b64_tr_b16 v[26:27], v12 offset:256
  s_waitcnt lgkmcnt(12)
  v_mfma_f32_32x32x16_bf16 v[48:63], v[156:159], v[16:19], 0
  ds_read_b64_tr_b16 v[144:145], v14 offset:512
  ds_read_b64_tr_b16 v[146:147], v14 offset:544
  ds_read_b64_tr_b16 v[128:129], v14 offset:0
  ds_read_b64_tr_b16 v[130:131], v14 offset:32
  ds_read_b64_tr_b16 v[28:29], v12 offset:416
  ds_read_b64_tr_b16 v[30:31], v12 offset:384
  v_mfma_f32_32x32x16_bf16 v[32:47], v[140:143], v[16:19], 0
  s_waitcnt lgkmcnt(12)
  v_mfma_f32_32x32x16_bf16 v[48:63], v[152:155], v[20:23], v[48:63]
  ds_read_b64_tr_b16 v[16:17], v12 offset:544
  ds_read_b64_tr_b16 v[18:19], v12 offset:512
  v_mfma_f32_32x32x16_bf16 v[32:47], v[136:139], v[20:23], v[32:47]
  s_waitcnt lgkmcnt(8)
  v_mfma_f32_32x32x16_bf16 v[48:63], v[148:151], v[24:27], v[48:63]
  ds_read_b64_tr_b16 v[20:21], v12 offset:672
  ds_read_b64_tr_b16 v[22:23], v12 offset:640
  v_mfma_f32_32x32x16_bf16 v[32:47], v[132:135], v[24:27], v[32:47]
  s_waitcnt lgkmcnt(4)
  v_mfma_f32_32x32x16_bf16 v[48:63], v[144:147], v[28:31], v[48:63]
  ds_read_b64_tr_b16 v[24:25], v12 offset:800
  ds_read_b64_tr_b16 v[26:27], v12 offset:768
  v_mfma_f32_32x32x16_bf16 v[32:47], v[128:131], v[28:31], v[32:47]
  s_waitcnt lgkmcnt(4)
  v_mfma_f32_32x32x16_bf16 v[48:63], v[140:143], v[16:19], v[48:63]
  ds_read_b64_tr_b16 v[28:29], v12 offset:928
  ds_read_b64_tr_b16 v[30:31], v12 offset:896
  s_waitcnt lgkmcnt(4)
  v_mfma_f32_32x32x16_bf16 v[48:63], v[136:139], v[20:23], v[48:63]
  s_waitcnt vmcnt(5)
  ds_read_b64_tr_b16 v[188:189], v14 offset:1920
  ds_read_b64_tr_b16 v[190:191], v14 offset:1952
  ds_read_b64_tr_b16 v[172:173], v14 offset:1408
  ds_read_b64_tr_b16 v[174:175], v14 offset:1440
  ds_read_b64_tr_b16 v[16:17], v12 offset:32
  ds_read_b64_tr_b16 v[18:19], v12 offset:0
  s_waitcnt lgkmcnt(8)
  v_mfma_f32_32x32x16_bf16 v[48:63], v[132:135], v[24:27], v[48:63]
  ds_read_b64_tr_b16 v[184:185], v14 offset:1792
  ds_read_b64_tr_b16 v[186:187], v14 offset:1824
  ds_read_b64_tr_b16 v[168:169], v14 offset:1280
  ds_read_b64_tr_b16 v[170:171], v14 offset:1312
  ds_read_b64_tr_b16 v[20:21], v12 offset:160
  ds_read_b64_tr_b16 v[22:23], v12 offset:128
  s_waitcnt lgkmcnt(12)
  v_mfma_f32_32x32x16_bf16 v[48:63], v[128:131], v[28:31], v[48:63]
  ds_read_b64_tr_b16 v[180:181], v14 offset:1664
  ds_read_b64_tr_b16 v[182:183], v14 offset:1696
  ds_read_b64_tr_b16 v[164:165], v14 offset:1152
  ds_read_b64_tr_b16 v[166:167], v14 offset:1184
  ds_read_b64_tr_b16 v[24:25], v12 offset:288
  ds_read_b64_tr_b16 v[26:27], v12 offset:256
  s_waitcnt lgkmcnt(12)
  v_mfma_f32_32x32x16_bf16 v[80:95], v[188:191], v[16:19], 0
  ds_read_b64_tr_b16 v[176:177], v14 offset:1536
  ds_read_b64_tr_b16 v[178:179], v14 offset:1568
  ds_read_b64_tr_b16 v[160:161], v14 offset:1024
  ds_read_b64_tr_b16 v[162:163], v14 offset:1056
  ds_read_b64_tr_b16 v[28:29], v12 offset:416
  ds_read_b64_tr_b16 v[30:31], v12 offset:384
  v_mfma_f32_32x32x16_bf16 v[64:79], v[172:175], v[16:19], 0
  s_waitcnt lgkmcnt(12)
  v_mfma_f32_32x32x16_bf16 v[80:95], v[184:187], v[20:23], v[80:95]
  ds_read_b64_tr_b16 v[16:17], v12 offset:544
  ds_read_b64_tr_b16 v[18:19], v12 offset:512
  v_mfma_f32_32x32x16_bf16 v[64:79], v[168:171], v[20:23], v[64:79]
  s_waitcnt lgkmcnt(8)
  v_mfma_f32_32x32x16_bf16 v[80:95], v[180:183], v[24:27], v[80:95]
  ds_read_b64_tr_b16 v[20:21], v12 offset:672
  ds_read_b64_tr_b16 v[22:23], v12 offset:640
  v_add_f32_dpp v96, v35, v34 wave_shr:1 row_mask:0xf bank_mask:0xf bound_ctrl:0
  s_nop 1
  v_add_f32_dpp v98, v96, v33 wave_shr:1 row_mask:0xf bank_mask:0xf bound_ctrl:0
  s_nop 1
  v_add_f32_dpp v100, v98, v32 wave_shr:1 row_mask:0xf bank_mask:0xf bound_ctrl:0
  v_mfma_f32_32x32x16_bf16 v[64:79], v[164:167], v[24:27], v[64:79]
  v_add_f32_dpp v97, v35, v38 wave_ror:1 row_mask:0xf bank_mask:0xf
  v_add_f32_dpp v99, v96, v37 wave_ror:1 row_mask:0xf bank_mask:0xf
  v_add_f32_dpp v101, v98, v36 wave_ror:1 row_mask:0xf bank_mask:0xf
  s_waitcnt lgkmcnt(4)
  v_mfma_f32_32x32x16_bf16 v[80:95], v[176:179], v[28:31], v[80:95]
  ds_read_b64_tr_b16 v[24:25], v12 offset:800
  ds_read_b64_tr_b16 v[26:27], v12 offset:768
  v_add_f32_dpp v97, v39, v38 wave_shr:1 row_mask:0xf bank_mask:0xf
  s_nop 1
  v_add_f32_dpp v99, v97, v37 wave_shr:1 row_mask:0xf bank_mask:0xf
  s_nop 1
  v_add_f32_dpp v101, v99, v36 wave_shr:1 row_mask:0xf bank_mask:0xf
  v_mfma_f32_32x32x16_bf16 v[64:79], v[160:163], v[28:31], v[64:79]
  v_cvt_pk_bf16_f32 v104, v100, v101
  v_add_f32_dpp v96, v39, v42 wave_ror:1 row_mask:0xf bank_mask:0xf
  v_add_f32_dpp v98, v97, v41 wave_ror:1 row_mask:0xf bank_mask:0xf
  s_waitcnt lgkmcnt(4)
  v_mfma_f32_32x32x16_bf16 v[80:95], v[172:175], v[16:19], v[80:95]
  ds_read_b64_tr_b16 v[28:29], v12 offset:928
  ds_read_b64_tr_b16 v[30:31], v12 offset:896
  v_add_f32_dpp v100, v99, v40 wave_ror:1 row_mask:0xf bank_mask:0xf
  v_add_f32_dpp v96, v43, v42 wave_shr:1 row_mask:0xf bank_mask:0xf
  s_nop 1
  v_add_f32_dpp v98, v96, v41 wave_shr:1 row_mask:0xf bank_mask:0xf
  v_mfma_f32_32x32x16_bf16 v[64:79], v[156:159], v[16:19], v[64:79]
  s_nop 0
  v_add_f32_dpp v100, v98, v40 wave_shr:1 row_mask:0xf bank_mask:0xf
  v_add_f32_dpp v97, v43, v46 wave_ror:1 row_mask:0xf bank_mask:0xf
  v_add_f32_dpp v99, v96, v45 wave_ror:1 row_mask:0xf bank_mask:0xf
  s_waitcnt lgkmcnt(4)
  v_mfma_f32_32x32x16_bf16 v[80:95], v[168:171], v[20:23], v[80:95]
  s_waitcnt vmcnt(4)
  ds_read_b64_tr_b16 v[16:17], v12 offset:1056
  ds_read_b64_tr_b16 v[18:19], v12 offset:1024
  v_add_f32_dpp v101, v98, v44 wave_ror:1 row_mask:0xf bank_mask:0xf
  v_add_f32_dpp v97, v47, v46 wave_shr:1 row_mask:0xf bank_mask:0xf
  s_nop 1
  v_add_f32_dpp v99, v97, v45 wave_shr:1 row_mask:0xf bank_mask:0xf
  v_mfma_f32_32x32x16_bf16 v[64:79], v[152:155], v[20:23], v[64:79]
  s_nop 0
  v_add_f32_dpp v101, v99, v44 wave_shr:1 row_mask:0xf bank_mask:0xf
  v_cvt_pk_bf16_f32 v105, v100, v101
  v_add_f32_dpp v96, v47, v50 wave_ror:1 row_mask:0xf bank_mask:0xf
  s_waitcnt lgkmcnt(4)
  v_mfma_f32_32x32x16_bf16 v[80:95], v[164:167], v[24:27], v[80:95]
  ds_read_b64_tr_b16 v[20:21], v12 offset:1184
  ds_read_b64_tr_b16 v[22:23], v12 offset:1152
  v_add_f32_dpp v98, v97, v49 wave_ror:1 row_mask:0xf bank_mask:0xf
  v_add_f32_dpp v100, v99, v48 wave_ror:1 row_mask:0xf bank_mask:0xf
  v_add_f32_dpp v96, v51, v50 wave_shr:1 row_mask:0xf bank_mask:0xf
  v_mfma_f32_32x32x16_bf16 v[64:79], v[148:151], v[24:27], v[64:79]
  s_nop 0
  v_add_f32_dpp v98, v96, v49 wave_shr:1 row_mask:0xf bank_mask:0xf
  s_nop 1
  v_add_f32_dpp v100, v98, v48 wave_shr:1 row_mask:0xf bank_mask:0xf
  v_add_f32_dpp v97, v51, v54 wave_ror:1 row_mask:0xf bank_mask:0xf
  s_waitcnt lgkmcnt(4)
  v_mfma_f32_32x32x16_bf16 v[80:95], v[160:163], v[28:31], v[80:95]
  ds_read_b64_tr_b16 v[24:25], v12 offset:1312
  ds_read_b64_tr_b16 v[26:27], v12 offset:1280
  v_add_f32_dpp v99, v96, v53 wave_ror:1 row_mask:0xf bank_mask:0xf
  v_add_f32_dpp v101, v98, v52 wave_ror:1 row_mask:0xf bank_mask:0xf
  v_add_f32_dpp v97, v55, v54 wave_shr:1 row_mask:0xf bank_mask:0xf
  v_mfma_f32_32x32x16_bf16 v[64:79], v[144:147], v[28:31], v[64:79]
  s_nop 0
  v_add_f32_dpp v99, v97, v53 wave_shr:1 row_mask:0xf bank_mask:0xf
  s_nop 1
  v_add_f32_dpp v101, v99, v52 wave_shr:1 row_mask:0xf bank_mask:0xf
  v_cvt_pk_bf16_f32 v106, v100, v101
  s_waitcnt lgkmcnt(4)
  v_mfma_f32_32x32x16_bf16 v[80:95], v[156:159], v[16:19], v[80:95]
  ds_read_b64_tr_b16 v[28:29], v12 offset:1440
  ds_read_b64_tr_b16 v[30:31], v12 offset:1408
  v_add_f32_dpp v96, v55, v58 wave_ror:1 row_mask:0xf bank_mask:0xf
  v_add_f32_dpp v98, v97, v57 wave_ror:1 row_mask:0xf bank_mask:0xf
  v_add_f32_dpp v100, v99, v56 wave_ror:1 row_mask:0xf bank_mask:0xf
  v_mfma_f32_32x32x16_bf16 v[64:79], v[140:143], v[16:19], v[64:79]
  v_add_f32_dpp v96, v59, v58 wave_shr:1 row_mask:0xf bank_mask:0xf
  s_nop 1
  v_add_f32_dpp v98, v96, v57 wave_shr:1 row_mask:0xf bank_mask:0xf
  s_nop 1
  v_add_f32_dpp v100, v98, v56 wave_shr:1 row_mask:0xf bank_mask:0xf
  s_waitcnt lgkmcnt(4)
  v_mfma_f32_32x32x16_bf16 v[80:95], v[152:155], v[20:23], v[80:95]
  ds_read_b64_tr_b16 v[16:17], v12 offset:1568
  ds_read_b64_tr_b16 v[18:19], v12 offset:1536
  v_add_f32_dpp v97, v59, v62 wave_ror:1 row_mask:0xf bank_mask:0xf
  v_add_f32_dpp v99, v96, v61 wave_ror:1 row_mask:0xf bank_mask:0xf
  v_add_f32_dpp v101, v98, v60 wave_ror:1 row_mask:0xf bank_mask:0xf
  v_mfma_f32_32x32x16_bf16 v[64:79], v[136:139], v[20:23], v[64:79]
  v_add_f32_dpp v97, v63, v62 wave_shr:1 row_mask:0xf bank_mask:0xf
  s_nop 1
  v_add_f32_dpp v99, v97, v61 wave_shr:1 row_mask:0xf bank_mask:0xf
  s_nop 1
  v_add_f32_dpp v101, v99, v60 wave_shr:1 row_mask:0xf bank_mask:0xf
  s_waitcnt lgkmcnt(4)
  v_mfma_f32_32x32x16_bf16 v[80:95], v[148:151], v[24:27], v[80:95]
  ds_read_b64_tr_b16 v[20:21], v12 offset:1696
  ds_read_b64_tr_b16 v[22:23], v12 offset:1664
  v_cvt_pk_bf16_f32 v107, v100, v101
  v_mov_b32 v112, v63
  buffer_store_dwordx4 v[104:107], v3, s[28:31], s14 offen offset:0
  v_mfma_f32_32x32x16_bf16 v[64:79], v[132:135], v[24:27], v[64:79]
  s_waitcnt lgkmcnt(4)
  v_mfma_f32_32x32x16_bf16 v[80:95], v[144:147], v[28:31], v[80:95]
  ds_read_b64_tr_b16 v[24:25], v12 offset:1824
  ds_read_b64_tr_b16 v[26:27], v12 offset:1792
  v_mfma_f32_32x32x16_bf16 v[64:79], v[128:131], v[28:31], v[64:79]
  s_waitcnt lgkmcnt(4)
  v_mfma_f32_32x32x16_bf16 v[80:95], v[140:143], v[16:19], v[80:95]
  ds_read_b64_tr_b16 v[28:29], v12 offset:1952
  ds_read_b64_tr_b16 v[30:31], v12 offset:1920
  s_waitcnt lgkmcnt(4)
  v_mfma_f32_32x32x16_bf16 v[80:95], v[136:139], v[20:23], v[80:95]
  s_waitcnt vmcnt(3)
  ds_read_b64_tr_b16 v[220:221], v14 offset:2944
  ds_read_b64_tr_b16 v[222:223], v14 offset:2976
  ds_read_b64_tr_b16 v[204:205], v14 offset:2432
  ds_read_b64_tr_b16 v[206:207], v14 offset:2464
  ds_read_b64_tr_b16 v[16:17], v12 offset:32
  ds_read_b64_tr_b16 v[18:19], v12 offset:0
  s_waitcnt lgkmcnt(8)
  v_mfma_f32_32x32x16_bf16 v[80:95], v[132:135], v[24:27], v[80:95]
  ds_read_b64_tr_b16 v[216:217], v14 offset:2816
  ds_read_b64_tr_b16 v[218:219], v14 offset:2848
  ds_read_b64_tr_b16 v[200:201], v14 offset:2304
  ds_read_b64_tr_b16 v[202:203], v14 offset:2336
  ds_read_b64_tr_b16 v[20:21], v12 offset:160
  ds_read_b64_tr_b16 v[22:23], v12 offset:128
  s_waitcnt lgkmcnt(12)
  v_mfma_f32_32x32x16_bf16 v[80:95], v[128:131], v[28:31], v[80:95]
  ds_read_b64_tr_b16 v[212:213], v14 offset:2688
  ds_read_b64_tr_b16 v[214:215], v14 offset:2720
  ds_read_b64_tr_b16 v[196:197], v14 offset:2176
  ds_read_b64_tr_b16 v[198:199], v14 offset:2208
  ds_read_b64_tr_b16 v[24:25], v12 offset:288
  ds_read_b64_tr_b16 v[26:27], v12 offset:256
  s_waitcnt lgkmcnt(12)
  v_mfma_f32_32x32x16_bf16 v[48:63], v[220:223], v[16:19], 0
  ds_read_b64_tr_b16 v[208:209], v14 offset:2560
  ds_read_b64_tr_b16 v[210:211], v14 offset:2592
  ds_read_b64_tr_b16 v[192:193], v14 offset:2048
  ds_read_b64_tr_b16 v[194:195], v14 offset:2080
  ds_read_b64_tr_b16 v[28:29], v12 offset:416
  ds_read_b64_tr_b16 v[30:31], v12 offset:384
  v_mfma_f32_32x32x16_bf16 v[32:47], v[204:207], v[16:19], 0
  s_waitcnt lgkmcnt(12)
  v_mfma_f32_32x32x16_bf16 v[48:63], v[216:219], v[20:23], v[48:63]
  ds_read_b64_tr_b16 v[16:17], v12 offset:544
  ds_read_b64_tr_b16 v[18:19], v12 offset:512
  v_mfma_f32_32x32x16_bf16 v[32:47], v[200:203], v[20:23], v[32:47]
  s_waitcnt lgkmcnt(8)
  v_mfma_f32_32x32x16_bf16 v[48:63], v[212:215], v[24:27], v[48:63]
  ds_read_b64_tr_b16 v[20:21], v12 offset:672
  ds_read_b64_tr_b16 v[22:23], v12 offset:640
  v_add_f32_dpp v96, v112, v66 wave_ror:1 row_mask:0xf bank_mask:0xf
  v_add_f32_dpp v98, v97, v65 wave_ror:1 row_mask:0xf bank_mask:0xf
  v_add_f32_dpp v100, v99, v64 wave_ror:1 row_mask:0xf bank_mask:0xf
  v_mfma_f32_32x32x16_bf16 v[32:47], v[196:199], v[24:27], v[32:47]
  v_add_f32_dpp v96, v67, v66 wave_shr:1 row_mask:0xf bank_mask:0xf
  s_nop 1
  v_add_f32_dpp v98, v96, v65 wave_shr:1 row_mask:0xf bank_mask:0xf
  s_nop 1
  v_add_f32_dpp v100, v98, v64 wave_shr:1 row_mask:0xf bank_mask:0xf
  s_waitcnt lgkmcnt(4)
  v_mfma_f32_32x32x16_bf16 v[48:63], v[208:211], v[28:31], v[48:63]
  ds_read_b64_tr_b16 v[24:25], v12 offset:800
  ds_read_b64_tr_b16 v[26:27], v12 offset:768
  v_add_f32_dpp v97, v67, v70 wave_ror:1 row_mask:0xf bank_mask:0xf
  v_add_f32_dpp v99, v96, v69 wave_ror:1 row_mask:0xf bank_mask:0xf
  v_add_f32_dpp v101, v98, v68 wave_ror:1 row_mask:0xf bank_mask:0xf
  v_mfma_f32_32x32x16_bf16 v[32:47], v[192:195], v[28:31], v[32:47]
  v_add_f32_dpp v97, v71, v70 wave_shr:1 row_mask:0xf bank_mask:0xf
  s_nop 1
  v_add_f32_dpp v99, v97, v69 wave_shr:1 row_mask:0xf bank_mask:0xf
  s_nop 1
  v_add_f32_dpp v101, v99, v68 wave_shr:1 row_mask:0xf bank_mask:0xf
  s_waitcnt lgkmcnt(4)
  v_mfma_f32_32x32x16_bf16 v[48:63], v[204:207], v[16:19], v[48:63]
  ds_read_b64_tr_b16 v[28:29], v12 offset:928
  ds_read_b64_tr_b16 v[30:31], v12 offset:896
  v_cvt_pk_bf16_f32 v108, v100, v101
  v_add_f32_dpp v96, v71, v74 wave_ror:1 row_mask:0xf bank_mask:0xf
  v_add_f32_dpp v98, v97, v73 wave_ror:1 row_mask:0xf bank_mask:0xf
  v_mfma_f32_32x32x16_bf16 v[32:47], v[188:191], v[16:19], v[32:47]
  v_add_f32_dpp v100, v99, v72 wave_ror:1 row_mask:0xf bank_mask:0xf
  v_add_f32_dpp v96, v75, v74 wave_shr:1 row_mask:0xf bank_mask:0xf
  s_nop 1
  v_add_f32_dpp v98, v96, v73 wave_shr:1 row_mask:0xf bank_mask:0xf
  s_waitcnt lgkmcnt(4)
  v_mfma_f32_32x32x16_bf16 v[48:63], v[200:203], v[20:23], v[48:63]
  ds_read_b64_tr_b16 v[16:17], v12 offset:1056
  ds_read_b64_tr_b16 v[18:19], v12 offset:1024
  v_add_f32_dpp v100, v98, v72 wave_shr:1 row_mask:0xf bank_mask:0xf
  v_add_f32_dpp v97, v75, v78 wave_ror:1 row_mask:0xf bank_mask:0xf
  v_add_f32_dpp v99, v96, v77 wave_ror:1 row_mask:0xf bank_mask:0xf
  v_mfma_f32_32x32x16_bf16 v[32:47], v[184:187], v[20:23], v[32:47]
  v_add_f32_dpp v101, v98, v76 wave_ror:1 row_mask:0xf bank_mask:0xf
  v_add_f32_dpp v97, v79, v78 wave_shr:1 row_mask:0xf bank_mask:0xf
  s_nop 1
  v_add_f32_dpp v99, v97, v77 wave_shr:1 row_mask:0xf bank_mask:0xf
  s_waitcnt lgkmcnt(4)
  v_mfma_f32_32x32x16_bf16 v[48:63], v[196:199], v[24:27], v[48:63]
  ds_read_b64_tr_b16 v[20:21], v12 offset:1184
  ds_read_b64_tr_b16 v[22:23], v12 offset:1152
  v_add_f32_dpp v101, v99, v76 wave_shr:1 row_mask:0xf bank_mask:0xf
  v_cvt_pk_bf16_f32 v109, v100, v101
  v_add_f32_dpp v96, v79, v82 wave_ror:1 row_mask:0xf bank_mask:0xf
  v_mfma_f32_32x32x16_bf16 v[32:47], v[180:183], v[24:27], v[32:47]
  v_add_f32_dpp v98, v97, v81 wave_ror:1 row_mask:0xf bank_mask:0xf
  v_add_f32_dpp v100, v99, v80 wave_ror:1 row_mask:0xf bank_mask:0xf
  v_add_f32_dpp v96, v83, v82 wave_shr:1 row_mask:0xf bank_mask:0xf
  s_waitcnt lgkmcnt(4)
  v_mfma_f32_32x32x16_bf16 v[48:63], v[192:195], v[28:31], v[48:63]
  ds_read_b64_tr_b16 v[24:25], v12 offset:1312
  ds_read_b64_tr_b16 v[26:27], v12 offset:1280
  v_add_f32_dpp v98, v96, v81 wave_shr:1 row_mask:0xf bank_mask:0xf
  s_nop 1
  v_add_f32_dpp v100, v98, v80 wave_shr:1 row_mask:0xf bank_mask:0xf
  v_add_f32_dpp v97, v83, v86 wave_ror:1 row_mask:0xf bank_mask:0xf
  v_mfma_f32_32x32x16_bf16 v[32:47], v[176:179], v[28:31], v[32:47]
  v_add_f32_dpp v99, v96, v85 wave_ror:1 row_mask:0xf bank_mask:0xf
  v_add_f32_dpp v101, v98, v84 wave_ror:1 row_mask:0xf bank_mask:0xf
  v_add_f32_dpp v97, v87, v86 wave_shr:1 row_mask:0xf bank_mask:0xf
  s_waitcnt lgkmcnt(4)
  v_mfma_f32_32x32x16_bf16 v[48:63], v[188:191], v[16:19], v[48:63]
  ds_read_b64_tr_b16 v[28:29], v12 offset:1440
  ds_read_b64_tr_b16 v[30:31], v12 offset:1408
  v_add_f32_dpp v99, v97, v85 wave_shr:1 row_mask:0xf bank_mask:0xf
  s_nop 1
  v_add_f32_dpp v101, v99, v84 wave_shr:1 row_mask:0xf bank_mask:0xf
  v_cvt_pk_bf16_f32 v110, v100, v101
  v_mfma_f32_32x32x16_bf16 v[32:47], v[172:175], v[16:19], v[32:47]
  v_add_f32_dpp v96, v87, v90 wave_ror:1 row_mask:0xf bank_mask:0xf
  v_add_f32_dpp v98, v97, v89 wave_ror:1 row_mask:0xf bank_mask:0xf
  v_add_f32_dpp v100, v99, v88 wave_ror:1 row_mask:0xf bank_mask:0xf
  s_waitcnt lgkmcnt(4)
  v_mfma_f32_32x32x16_bf16 v[48:63], v[184:187], v[20:23], v[48:63]
  ds_read_b64_tr_b16 v[16:17], v12 offset:1568
  ds_read_b64_tr_b16 v[18:19], v12 offset:1536
  v_add_f32_dpp v96, v91, v90 wave_shr:1 row_mask:0xf bank_mask:0xf
  s_nop 1
  v_add_f32_dpp v98, v96, v89 wave_shr:1 row_mask:0xf bank_mask:0xf
  s_nop 1
  v_add_f32_dpp v100, v98, v88 wave_shr:1 row_mask:0xf bank_mask:0xf
  v_mfma_f32_32x32x16_bf16 v[32:47], v[168:171], v[20:23], v[32:47]
  v_add_f32_dpp v97, v91, v94 wave_ror:1 row_mask:0xf bank_mask:0xf
  v_add_f32_dpp v99, v96, v93 wave_ror:1 row_mask:0xf bank_mask:0xf
  v_add_f32_dpp v101, v98, v92 wave_ror:1 row_mask:0xf bank_mask:0xf
  s_waitcnt lgkmcnt(4)
  v_mfma_f32_32x32x16_bf16 v[48:63], v[180:183], v[24:27], v[48:63]
  ds_read_b64_tr_b16 v[20:21], v12 offset:1696
  ds_read_b64_tr_b16 v[22:23], v12 offset:1664
  v_add_f32_dpp v97, v95, v94 wave_shr:1 row_mask:0xf bank_mask:0xf
  s_nop 1
  v_add_f32_dpp v99, v97, v93 wave_shr:1 row_mask:0xf bank_mask:0xf
  s_nop 1
  v_add_f32_dpp v101, v99, v92 wave_shr:1 row_mask:0xf bank_mask:0xf
  v_mfma_f32_32x32x16_bf16 v[32:47], v[164:167], v[24:27], v[32:47]
  v_cvt_pk_bf16_f32 v111, v100, v101
  v_mov_b32 v112, v95
  buffer_store_dwordx4 v[108:111], v3, s[28:31], s14 offen offset:1024
  s_waitcnt lgkmcnt(4)
  v_mfma_f32_32x32x16_bf16 v[48:63], v[176:179], v[28:31], v[48:63]
  ds_read_b64_tr_b16 v[24:25], v12 offset:1824
  ds_read_b64_tr_b16 v[26:27], v12 offset:1792
  v_mfma_f32_32x32x16_bf16 v[32:47], v[160:163], v[28:31], v[32:47]
  s_waitcnt lgkmcnt(4)
  v_mfma_f32_32x32x16_bf16 v[48:63], v[172:175], v[16:19], v[48:63]
  ds_read_b64_tr_b16 v[28:29], v12 offset:1952
  ds_read_b64_tr_b16 v[30:31], v12 offset:1920
  v_mfma_f32_32x32x16_bf16 v[32:47], v[156:159], v[16:19], v[32:47]
  s_waitcnt lgkmcnt(4)
  v_mfma_f32_32x32x16_bf16 v[48:63], v[168:171], v[20:23], v[48:63]
  s_waitcnt vmcnt(2)
  ds_read_b64_tr_b16 v[16:17], v12 offset:2080
  ds_read_b64_tr_b16 v[18:19], v12 offset:2048
  v_mfma_f32_32x32x16_bf16 v[32:47], v[152:155], v[20:23], v[32:47]
  s_waitcnt lgkmcnt(4)
  v_mfma_f32_32x32x16_bf16 v[48:63], v[164:167], v[24:27], v[48:63]
  ds_read_b64_tr_b16 v[20:21], v12 offset:2208
  ds_read_b64_tr_b16 v[22:23], v12 offset:2176
  v_mfma_f32_32x32x16_bf16 v[32:47], v[148:151], v[24:27], v[32:47]
  s_waitcnt lgkmcnt(4)
  v_mfma_f32_32x32x16_bf16 v[48:63], v[160:163], v[28:31], v[48:63]
  ds_read_b64_tr_b16 v[24:25], v12 offset:2336
  ds_read_b64_tr_b16 v[26:27], v12 offset:2304
  v_mfma_f32_32x32x16_bf16 v[32:47], v[144:147], v[28:31], v[32:47]
  s_waitcnt lgkmcnt(4)
  v_mfma_f32_32x32x16_bf16 v[48:63], v[156:159], v[16:19], v[48:63]
  ds_read_b64_tr_b16 v[28:29], v12 offset:2464
  ds_read_b64_tr_b16 v[30:31], v12 offset:2432
  v_mfma_f32_32x32x16_bf16 v[32:47], v[140:143], v[16:19], v[32:47]
  s_waitcnt lgkmcnt(4)
  v_mfma_f32_32x32x16_bf16 v[48:63], v[152:155], v[20:23], v[48:63]
  ds_read_b64_tr_b16 v[16:17], v12 offset:2592
  ds_read_b64_tr_b16 v[18:19], v12 offset:2560
  v_mfma_f32_32x32x16_bf16 v[32:47], v[136:139], v[20:23], v[32:47]
  s_waitcnt lgkmcnt(4)
  v_mfma_f32_32x32x16_bf16 v[48:63], v[148:151], v[24:27], v[48:63]
  ds_read_b64_tr_b16 v[20:21], v12 offset:2720
  ds_read_b64_tr_b16 v[22:23], v12 offset:2688
  v_mfma_f32_32x32x16_bf16 v[32:47], v[132:135], v[24:27], v[32:47]
  s_waitcnt lgkmcnt(4)
  v_mfma_f32_32x32x16_bf16 v[48:63], v[144:147], v[28:31], v[48:63]
  ds_read_b64_tr_b16 v[24:25], v12 offset:2848
  ds_read_b64_tr_b16 v[26:27], v12 offset:2816
  v_mfma_f32_32x32x16_bf16 v[32:47], v[128:131], v[28:31], v[32:47]
  s_waitcnt lgkmcnt(4)
  v_mfma_f32_32x32x16_bf16 v[48:63], v[140:143], v[16:19], v[48:63]
  ds_read_b64_tr_b16 v[28:29], v12 offset:2976
  ds_read_b64_tr_b16 v[30:31], v12 offset:2944
  s_waitcnt lgkmcnt(4)
  v_mfma_f32_32x32x16_bf16 v[48:63], v[136:139], v[20:23], v[48:63]
  s_waitcnt vmcnt(1)
  ds_read_b64_tr_b16 v[252:253], v14 offset:3968
  ds_read_b64_tr_b16 v[254:255], v14 offset:4000
  ds_read_b64_tr_b16 v[236:237], v14 offset:3456
  ds_read_b64_tr_b16 v[238:239], v14 offset:3488
  ds_read_b64_tr_b16 v[16:17], v12 offset:32
  ds_read_b64_tr_b16 v[18:19], v12 offset:0
  s_waitcnt lgkmcnt(8)
  v_mfma_f32_32x32x16_bf16 v[48:63], v[132:135], v[24:27], v[48:63]
  ds_read_b64_tr_b16 v[248:249], v14 offset:3840
  ds_read_b64_tr_b16 v[250:251], v14 offset:3872
  ds_read_b64_tr_b16 v[232:233], v14 offset:3328
  ds_read_b64_tr_b16 v[234:235], v14 offset:3360
  ds_read_b64_tr_b16 v[20:21], v12 offset:160
  ds_read_b64_tr_b16 v[22:23], v12 offset:128
  s_waitcnt lgkmcnt(12)
  v_mfma_f32_32x32x16_bf16 v[48:63], v[128:131], v[28:31], v[48:63]
  ds_read_b64_tr_b16 v[244:245], v14 offset:3712
  ds_read_b64_tr_b16 v[246:247], v14 offset:3744
  ds_read_b64_tr_b16 v[228:229], v14 offset:3200
  ds_read_b64_tr_b16 v[230:231], v14 offset:3232
  ds_read_b64_tr_b16 v[24:25], v12 offset:288
  ds_read_b64_tr_b16 v[26:27], v12 offset:256
  s_waitcnt lgkmcnt(12)
  v_mfma_f32_32x32x16_bf16 v[80:95], v[252:255], v[16:19], 0
  ds_read_b64_tr_b16 v[240:241], v14 offset:3584
  ds_read_b64_tr_b16 v[242:243], v14 offset:3616
  ds_read_b64_tr_b16 v[224:225], v14 offset:3072
  ds_read_b64_tr_b16 v[226:227], v14 offset:3104
  ds_read_b64_tr_b16 v[28:29], v12 offset:416
  ds_read_b64_tr_b16 v[30:31], v12 offset:384
  v_mfma_f32_32x32x16_bf16 v[64:79], v[236:239], v[16:19], 0
  s_waitcnt lgkmcnt(12)
  v_mfma_f32_32x32x16_bf16 v[80:95], v[248:251], v[20:23], v[80:95]
  ds_read_b64_tr_b16 v[16:17], v12 offset:544
  ds_read_b64_tr_b16 v[18:19], v12 offset:512
  v_mfma_f32_32x32x16_bf16 v[64:79], v[232:235], v[20:23], v[64:79]
  s_waitcnt lgkmcnt(8)
  v_mfma_f32_32x32x16_bf16 v[80:95], v[244:247], v[24:27], v[80:95]
  ds_read_b64_tr_b16 v[20:21], v12 offset:672
  ds_read_b64_tr_b16 v[22:23], v12 offset:640
  v_add_f32_dpp v96, v112, v34 wave_ror:1 row_mask:0xf bank_mask:0xf
  v_add_f32_dpp v98, v97, v33 wave_ror:1 row_mask:0xf bank_mask:0xf
  v_add_f32_dpp v100, v99, v32 wave_ror:1 row_mask:0xf bank_mask:0xf
  v_mfma_f32_32x32x16_bf16 v[64:79], v[228:231], v[24:27], v[64:79]
  v_add_f32_dpp v96, v35, v34 wave_shr:1 row_mask:0xf bank_mask:0xf
  s_nop 1
  v_add_f32_dpp v98, v96, v33 wave_shr:1 row_mask:0xf bank_mask:0xf
  s_nop 1
  v_add_f32_dpp v100, v98, v32 wave_shr:1 row_mask:0xf bank_mask:0xf
  s_waitcnt lgkmcnt(4)
  v_mfma_f32_32x32x16_bf16 v[80:95], v[240:243], v[28:31], v[80:95]
  ds_read_b64_tr_b16 v[24:25], v12 offset:800
  ds_read_b64_tr_b16 v[26:27], v12 offset:768
  v_add_f32_dpp v97, v35, v38 wave_ror:1 row_mask:0xf bank_mask:0xf
  v_add_f32_dpp v99, v96, v37 wave_ror:1 row_mask:0xf bank_mask:0xf
  v_add_f32_dpp v101, v98, v36 wave_ror:1 row_mask:0xf bank_mask:0xf
  v_mfma_f32_32x32x16_bf16 v[64:79], v[224:227], v[28:31], v[64:79]
  v_add_f32_dpp v97, v39, v38 wave_shr:1 row_mask:0xf bank_mask:0xf
  s_nop 1
  v_add_f32_dpp v99, v97, v37 wave_shr:1 row_mask:0xf bank_mask:0xf
  s_nop 1
  v_add_f32_dpp v101, v99, v36 wave_shr:1 row_mask:0xf bank_mask:0xf
  s_waitcnt lgkmcnt(4)
  v_mfma_f32_32x32x16_bf16 v[80:95], v[236:239], v[16:19], v[80:95]
  ds_read_b64_tr_b16 v[28:29], v12 offset:928
  ds_read_b64_tr_b16 v[30:31], v12 offset:896
  v_cvt_pk_bf16_f32 v104, v100, v101
  v_add_f32_dpp v96, v39, v42 wave_ror:1 row_mask:0xf bank_mask:0xf
  v_add_f32_dpp v98, v97, v41 wave_ror:1 row_mask:0xf bank_mask:0xf
  v_mfma_f32_32x32x16_bf16 v[64:79], v[220:223], v[16:19], v[64:79]
  v_add_f32_dpp v100, v99, v40 wave_ror:1 row_mask:0xf bank_mask:0xf
  v_add_f32_dpp v96, v43, v42 wave_shr:1 row_mask:0xf bank_mask:0xf
  s_nop 1
  v_add_f32_dpp v98, v96, v41 wave_shr:1 row_mask:0xf bank_mask:0xf
  s_waitcnt lgkmcnt(4)
  v_mfma_f32_32x32x16_bf16 v[80:95], v[232:235], v[20:23], v[80:95]
  ds_read_b64_tr_b16 v[16:17], v12 offset:1056
  ds_read_b64_tr_b16 v[18:19], v12 offset:1024
  v_add_f32_dpp v100, v98, v40 wave_shr:1 row_mask:0xf bank_mask:0xf
  v_add_f32_dpp v97, v43, v46 wave_ror:1 row_mask:0xf bank_mask:0xf
  v_add_f32_dpp v99, v96, v45 wave_ror:1 row_mask:0xf bank_mask:0xf
  v_mfma_f32_32x32x16_bf16 v[64:79], v[216:219], v[20:23], v[64:79]
  v_add_f32_dpp v101, v98, v44 wave_ror:1 row_mask:0xf bank_mask:0xf
  v_add_f32_dpp v97, v47, v46 wave_shr:1 row_mask:0xf bank_mask:0xf
  s_nop 1
  v_add_f32_dpp v99, v97, v45 wave_shr:1 row_mask:0xf bank_mask:0xf
  s_waitcnt lgkmcnt(4)
  v_mfma_f32_32x32x16_bf16 v[80:95], v[228:231], v[24:27], v[80:95]
  ds_read_b64_tr_b16 v[20:21], v12 offset:1184
  ds_read_b64_tr_b16 v[22:23], v12 offset:1152
  v_add_f32_dpp v101, v99, v44 wave_shr:1 row_mask:0xf bank_mask:0xf
  v_cvt_pk_bf16_f32 v105, v100, v101
  v_add_f32_dpp v96, v47, v50 wave_ror:1 row_mask:0xf bank_mask:0xf
  v_mfma_f32_32x32x16_bf16 v[64:79], v[212:215], v[24:27], v[64:79]
  v_add_f32_dpp v98, v97, v49 wave_ror:1 row_mask:0xf bank_mask:0xf
  v_add_f32_dpp v100, v99, v48 wave_ror:1 row_mask:0xf bank_mask:0xf
  v_add_f32_dpp v96, v51, v50 wave_shr:1 row_mask:0xf bank_mask:0xf
  s_waitcnt lgkmcnt(4)
  v_mfma_f32_32x32x16_bf16 v[80:95], v[224:227], v[28:31], v[80:95]
  ds_read_b64_tr_b16 v[24:25], v12 offset:1312
  ds_read_b64_tr_b16 v[26:27], v12 offset:1280
  v_add_f32_dpp v98, v96, v49 wave_shr:1 row_mask:0xf bank_mask:0xf
  s_nop 1
  v_add_f32_dpp v100, v98, v48 wave_shr:1 row_mask:0xf bank_mask:0xf
  v_add_f32_dpp v97, v51, v54 wave_ror:1 row_mask:0xf bank_mask:0xf
  v_mfma_f32_32x32x16_bf16 v[64:79], v[208:211], v[28:31], v[64:79]
  v_add_f32_dpp v99, v96, v53 wave_ror:1 row_mask:0xf bank_mask:0xf
  v_add_f32_dpp v101, v98, v52 wave_ror:1 row_mask:0xf bank_mask:0xf
  v_add_f32_dpp v97, v55, v54 wave_shr:1 row_mask:0xf bank_mask:0xf
  s_waitcnt lgkmcnt(4)
  v_mfma_f32_32x32x16_bf16 v[80:95], v[220:223], v[16:19], v[80:95]
  ds_read_b64_tr_b16 v[28:29], v12 offset:1440
  ds_read_b64_tr_b16 v[30:31], v12 offset:1408
  v_add_f32_dpp v99, v97, v53 wave_shr:1 row_mask:0xf bank_mask:0xf
  s_nop 1
  v_add_f32_dpp v101, v99, v52 wave_shr:1 row_mask:0xf bank_mask:0xf
  v_cvt_pk_bf16_f32 v106, v100, v101
  v_mfma_f32_32x32x16_bf16 v[64:79], v[204:207], v[16:19], v[64:79]
  v_add_f32_dpp v96, v55, v58 wave_ror:1 row_mask:0xf bank_mask:0xf
  v_add_f32_dpp v98, v97, v57 wave_ror:1 row_mask:0xf bank_mask:0xf
  v_add_f32_dpp v100, v99, v56 wave_ror:1 row_mask:0xf bank_mask:0xf
  s_waitcnt lgkmcnt(4)
  v_mfma_f32_32x32x16_bf16 v[80:95], v[216:219], v[20:23], v[80:95]
  ds_read_b64_tr_b16 v[16:17], v12 offset:1568
  ds_read_b64_tr_b16 v[18:19], v12 offset:1536
  v_add_f32_dpp v96, v59, v58 wave_shr:1 row_mask:0xf bank_mask:0xf
  s_nop 1
  v_add_f32_dpp v98, v96, v57 wave_shr:1 row_mask:0xf bank_mask:0xf
  s_nop 1
  v_add_f32_dpp v100, v98, v56 wave_shr:1 row_mask:0xf bank_mask:0xf
  v_mfma_f32_32x32x16_bf16 v[64:79], v[200:203], v[20:23], v[64:79]
  v_add_f32_dpp v97, v59, v62 wave_ror:1 row_mask:0xf bank_mask:0xf
  v_add_f32_dpp v99, v96, v61 wave_ror:1 row_mask:0xf bank_mask:0xf
  v_add_f32_dpp v101, v98, v60 wave_ror:1 row_mask:0xf bank_mask:0xf
  s_waitcnt lgkmcnt(4)
  v_mfma_f32_32x32x16_bf16 v[80:95], v[212:215], v[24:27], v[80:95]
  ds_read_b64_tr_b16 v[20:21], v12 offset:1696
  ds_read_b64_tr_b16 v[22:23], v12 offset:1664
  v_add_f32_dpp v97, v63, v62 wave_shr:1 row_mask:0xf bank_mask:0xf
  s_nop 1
  v_add_f32_dpp v99, v97, v61 wave_shr:1 row_mask:0xf bank_mask:0xf
  s_nop 1
  v_add_f32_dpp v101, v99, v60 wave_shr:1 row_mask:0xf bank_mask:0xf
  v_mfma_f32_32x32x16_bf16 v[64:79], v[196:199], v[24:27], v[64:79]
  v_cvt_pk_bf16_f32 v107, v100, v101
  v_mov_b32 v112, v63
  buffer_store_dwordx4 v[104:107], v3, s[28:31], s14 offen offset:2048
  s_waitcnt lgkmcnt(4)
  v_mfma_f32_32x32x16_bf16 v[80:95], v[208:211], v[28:31], v[80:95]
  ds_read_b64_tr_b16 v[24:25], v12 offset:1824
  ds_read_b64_tr_b16 v[26:27], v12 offset:1792
  v_mfma_f32_32x32x16_bf16 v[64:79], v[192:195], v[28:31], v[64:79]
  s_waitcnt lgkmcnt(4)
  v_mfma_f32_32x32x16_bf16 v[80:95], v[204:207], v[16:19], v[80:95]
  ds_read_b64_tr_b16 v[28:29], v12 offset:1952
  ds_read_b64_tr_b16 v[30:31], v12 offset:1920
  v_mfma_f32_32x32x16_bf16 v[64:79], v[188:191], v[16:19], v[64:79]
  s_waitcnt lgkmcnt(4)
  v_mfma_f32_32x32x16_bf16 v[80:95], v[200:203], v[20:23], v[80:95]
  ds_read_b64_tr_b16 v[16:17], v12 offset:2080
  ds_read_b64_tr_b16 v[18:19], v12 offset:2048
  v_mfma_f32_32x32x16_bf16 v[64:79], v[184:187], v[20:23], v[64:79]
  s_waitcnt lgkmcnt(4)
  v_mfma_f32_32x32x16_bf16 v[80:95], v[196:199], v[24:27], v[80:95]
  ds_read_b64_tr_b16 v[20:21], v12 offset:2208
  ds_read_b64_tr_b16 v[22:23], v12 offset:2176
  v_mfma_f32_32x32x16_bf16 v[64:79], v[180:183], v[24:27], v[64:79]
  s_waitcnt lgkmcnt(4)
  v_mfma_f32_32x32x16_bf16 v[80:95], v[192:195], v[28:31], v[80:95]
  ds_read_b64_tr_b16 v[24:25], v12 offset:2336
  ds_read_b64_tr_b16 v[26:27], v12 offset:2304
  v_mfma_f32_32x32x16_bf16 v[64:79], v[176:179], v[28:31], v[64:79]
  s_waitcnt lgkmcnt(4)
  v_mfma_f32_32x32x16_bf16 v[80:95], v[188:191], v[16:19], v[80:95]
  ds_read_b64_tr_b16 v[28:29], v12 offset:2464
  ds_read_b64_tr_b16 v[30:31], v12 offset:2432
  v_mfma_f32_32x32x16_bf16 v[64:79], v[172:175], v[16:19], v[64:79]
  s_waitcnt lgkmcnt(4)
  v_mfma_f32_32x32x16_bf16 v[80:95], v[184:187], v[20:23], v[80:95]
  ds_read_b64_tr_b16 v[16:17], v12 offset:2592
  ds_read_b64_tr_b16 v[18:19], v12 offset:2560
  v_mfma_f32_32x32x16_bf16 v[64:79], v[168:171], v[20:23], v[64:79]
  s_waitcnt lgkmcnt(4)
  v_mfma_f32_32x32x16_bf16 v[80:95], v[180:183], v[24:27], v[80:95]
  ds_read_b64_tr_b16 v[20:21], v12 offset:2720
  ds_read_b64_tr_b16 v[22:23], v12 offset:2688
  v_mfma_f32_32x32x16_bf16 v[64:79], v[164:167], v[24:27], v[64:79]
  s_waitcnt lgkmcnt(4)
  v_mfma_f32_32x32x16_bf16 v[80:95], v[176:179], v[28:31], v[80:95]
  ds_read_b64_tr_b16 v[24:25], v12 offset:2848
  ds_read_b64_tr_b16 v[26:27], v12 offset:2816
  v_mfma_f32_32x32x16_bf16 v[64:79], v[160:163], v[28:31], v[64:79]
  s_waitcnt lgkmcnt(4)
  v_mfma_f32_32x32x16_bf16 v[80:95], v[172:175], v[16:19], v[80:95]
  ds_read_b64_tr_b16 v[28:29], v12 offset:2976
  ds_read_b64_tr_b16 v[30:31], v12 offset:2944
  v_mfma_f32_32x32x16_bf16 v[64:79], v[156:159], v[16:19], v[64:79]
  s_waitcnt lgkmcnt(4)
  v_mfma_f32_32x32x16_bf16 v[80:95], v[168:171], v[20:23], v[80:95]
  s_waitcnt vmcnt(0)
  ds_read_b64_tr_b16 v[16:17], v12 offset:3104
  ds_read_b64_tr_b16 v[18:19], v12 offset:3072
  v_mfma_f32_32x32x16_bf16 v[64:79], v[152:155], v[20:23], v[64:79]
  s_waitcnt lgkmcnt(4)
  v_mfma_f32_32x32x16_bf16 v[80:95], v[164:167], v[24:27], v[80:95]
  ds_read_b64_tr_b16 v[20:21], v12 offset:3232
  ds_read_b64_tr_b16 v[22:23], v12 offset:3200
  v_mfma_f32_32x32x16_bf16 v[64:79], v[148:151], v[24:27], v[64:79]
  s_waitcnt lgkmcnt(4)
  v_mfma_f32_32x32x16_bf16 v[80:95], v[160:163], v[28:31], v[80:95]
  ds_read_b64_tr_b16 v[24:25], v12 offset:3360
  ds_read_b64_tr_b16 v[26:27], v12 offset:3328
  v_mfma_f32_32x32x16_bf16 v[64:79], v[144:147], v[28:31], v[64:79]
  s_waitcnt lgkmcnt(4)
  v_mfma_f32_32x32x16_bf16 v[80:95], v[156:159], v[16:19], v[80:95]
  ds_read_b64_tr_b16 v[28:29], v12 offset:3488
  ds_read_b64_tr_b16 v[30:31], v12 offset:3456
  v_mfma_f32_32x32x16_bf16 v[64:79], v[140:143], v[16:19], v[64:79]
  s_waitcnt lgkmcnt(4)
  v_mfma_f32_32x32x16_bf16 v[80:95], v[152:155], v[20:23], v[80:95]
  ds_read_b64_tr_b16 v[16:17], v12 offset:3616
  ds_read_b64_tr_b16 v[18:19], v12 offset:3584
  v_mfma_f32_32x32x16_bf16 v[64:79], v[136:139], v[20:23], v[64:79]
  s_waitcnt lgkmcnt(4)
  v_mfma_f32_32x32x16_bf16 v[80:95], v[148:151], v[24:27], v[80:95]
  ds_read_b64_tr_b16 v[20:21], v12 offset:3744
  ds_read_b64_tr_b16 v[22:23], v12 offset:3712
  v_mfma_f32_32x32x16_bf16 v[64:79], v[132:135], v[24:27], v[64:79]
  s_waitcnt lgkmcnt(4)
  v_mfma_f32_32x32x16_bf16 v[80:95], v[144:147], v[28:31], v[80:95]
  ds_read_b64_tr_b16 v[24:25], v12 offset:3872
  ds_read_b64_tr_b16 v[26:27], v12 offset:3840
  v_mfma_f32_32x32x16_bf16 v[64:79], v[128:131], v[28:31], v[64:79]
  s_waitcnt lgkmcnt(4)
  v_mfma_f32_32x32x16_bf16 v[80:95], v[140:143], v[16:19], v[80:95]
  ds_read_b64_tr_b16 v[28:29], v12 offset:4000
  ds_read_b64_tr_b16 v[30:31], v12 offset:3968
  s_waitcnt lgkmcnt(4)
  v_mfma_f32_32x32x16_bf16 v[80:95], v[136:139], v[20:23], v[80:95]
  s_waitcnt lgkmcnt(2)
  v_mfma_f32_32x32x16_bf16 v[80:95], v[132:135], v[24:27], v[80:95]
  s_waitcnt lgkmcnt(0)
  v_mfma_f32_32x32x16_bf16 v[80:95], v[128:131], v[28:31], v[80:95]
  s_nop 1
  v_add_f32_dpp v96, v112, v66 wave_ror:1 row_mask:0xf bank_mask:0xf
  v_add_f32_dpp v98, v97, v65 wave_ror:1 row_mask:0xf bank_mask:0xf
  v_add_f32_dpp v100, v99, v64 wave_ror:1 row_mask:0xf bank_mask:0xf
  v_add_f32_dpp v96, v67, v66 wave_shr:1 row_mask:0xf bank_mask:0xf
  s_nop 1
  v_add_f32_dpp v98, v96, v65 wave_shr:1 row_mask:0xf bank_mask:0xf
  s_nop 1
  v_add_f32_dpp v100, v98, v64 wave_shr:1 row_mask:0xf bank_mask:0xf
  v_add_f32_dpp v97, v67, v70 wave_ror:1 row_mask:0xf bank_mask:0xf
  v_add_f32_dpp v99, v96, v69 wave_ror:1 row_mask:0xf bank_mask:0xf
  v_add_f32_dpp v101, v98, v68 wave_ror:1 row_mask:0xf bank_mask:0xf
  v_add_f32_dpp v97, v71, v70 wave_shr:1 row_mask:0xf bank_mask:0xf
  s_nop 1
  v_add_f32_dpp v99, v97, v69 wave_shr:1 row_mask:0xf bank_mask:0xf
  s_nop 1
  v_add_f32_dpp v101, v99, v68 wave_shr:1 row_mask:0xf bank_mask:0xf
  v_cvt_pk_bf16_f32 v108, v100, v101
  v_add_f32_dpp v96, v71, v74 wave_ror:1 row_mask:0xf bank_mask:0xf
  v_add_f32_dpp v98, v97, v73 wave_ror:1 row_mask:0xf bank_mask:0xf
  v_add_f32_dpp v100, v99, v72 wave_ror:1 row_mask:0xf bank_mask:0xf
  v_add_f32_dpp v96, v75, v74 wave_shr:1 row_mask:0xf bank_mask:0xf
  s_nop 1
  v_add_f32_dpp v98, v96, v73 wave_shr:1 row_mask:0xf bank_mask:0xf
  s_nop 1
  v_add_f32_dpp v100, v98, v72 wave_shr:1 row_mask:0xf bank_mask:0xf
  v_add_f32_dpp v97, v75, v78 wave_ror:1 row_mask:0xf bank_mask:0xf
  v_add_f32_dpp v99, v96, v77 wave_ror:1 row_mask:0xf bank_mask:0xf
  v_add_f32_dpp v101, v98, v76 wave_ror:1 row_mask:0xf bank_mask:0xf
  v_add_f32_dpp v97, v79, v78 wave_shr:1 row_mask:0xf bank_mask:0xf
  s_nop 1
  v_add_f32_dpp v99, v97, v77 wave_shr:1 row_mask:0xf bank_mask:0xf
  s_nop 1
  v_add_f32_dpp v101, v99, v76 wave_shr:1 row_mask:0xf bank_mask:0xf
  v_cvt_pk_bf16_f32 v109, v100, v101
  v_add_f32_dpp v96, v79, v82 wave_ror:1 row_mask:0xf bank_mask:0xf
  v_add_f32_dpp v98, v97, v81 wave_ror:1 row_mask:0xf bank_mask:0xf
  v_add_f32_dpp v100, v99, v80 wave_ror:1 row_mask:0xf bank_mask:0xf
  v_add_f32_dpp v96, v83, v82 wave_shr:1 row_mask:0xf bank_mask:0xf
  s_nop 1
  v_add_f32_dpp v98, v96, v81 wave_shr:1 row_mask:0xf bank_mask:0xf
  s_nop 1
  v_add_f32_dpp v100, v98, v80 wave_shr:1 row_mask:0xf bank_mask:0xf
  v_add_f32_dpp v97, v83, v86 wave_ror:1 row_mask:0xf bank_mask:0xf
  v_add_f32_dpp v99, v96, v85 wave_ror:1 row_mask:0xf bank_mask:0xf
  v_add_f32_dpp v101, v98, v84 wave_ror:1 row_mask:0xf bank_mask:0xf
  v_add_f32_dpp v97, v87, v86 wave_shr:1 row_mask:0xf bank_mask:0xf
  s_nop 1
  v_add_f32_dpp v99, v97, v85 wave_shr:1 row_mask:0xf bank_mask:0xf
  s_nop 1
  v_add_f32_dpp v101, v99, v84 wave_shr:1 row_mask:0xf bank_mask:0xf
  v_cvt_pk_bf16_f32 v110, v100, v101
  v_add_f32_dpp v96, v87, v90 wave_ror:1 row_mask:0xf bank_mask:0xf
  v_add_f32_dpp v98, v97, v89 wave_ror:1 row_mask:0xf bank_mask:0xf
  v_add_f32_dpp v100, v99, v88 wave_ror:1 row_mask:0xf bank_mask:0xf
  v_add_f32_dpp v96, v91, v90 wave_shr:1 row_mask:0xf bank_mask:0xf
  s_nop 1
  v_add_f32_dpp v98, v96, v89 wave_shr:1 row_mask:0xf bank_mask:0xf
  s_nop 1
  v_add_f32_dpp v100, v98, v88 wave_shr:1 row_mask:0xf bank_mask:0xf
  v_add_f32_dpp v97, v91, v94 wave_ror:1 row_mask:0xf bank_mask:0xf
  v_add_f32_dpp v99, v96, v93 wave_ror:1 row_mask:0xf bank_mask:0xf
  v_add_f32_dpp v101, v98, v92 wave_ror:1 row_mask:0xf bank_mask:0xf
  v_add_f32_dpp v97, v95, v94 wave_shr:1 row_mask:0xf bank_mask:0xf
  s_nop 1
  v_add_f32_dpp v99, v97, v93 wave_shr:1 row_mask:0xf bank_mask:0xf
  s_nop 1
  v_add_f32_dpp v101, v99, v92 wave_shr:1 row_mask:0xf bank_mask:0xf
  v_cvt_pk_bf16_f32 v111, v100, v101
  v_mov_b32 v112, v95
  buffer_store_dwordx4 v[108:111], v3, s[28:31], s14 offen offset:3072
CV_end:
  s_endpgm
.globl opass_kernel
.p2align 8
.type opass_kernel,@function
opass_kernel:
  s_cmp_ge_u32 s2, 128
  s_cbranch_scc1 OP_end
  s_load_dwordx2 s[8:9], s[0:1], 88
  v_lshrrev_b32 v1, 6, v0
  v_and_b32 v2, 63, v0
  s_and_b32 s10, s2, 31
  v_readfirstlane_b32 s3, v1
  s_lshr_b32 s11, s2, 5
  v_lshlrev_b32 v3, 4, v2
  v_lshrrev_b32 v4, 5, v2
  v_lshlrev_b32 v4, 6, v4
  s_waitcnt lgkmcnt(0)
  s_add_u32 s24, s8, 0
  s_addc_u32 s25, s9, 0
  s_mov_b32 s26, 4194304
  s_mov_b32 s27, 0x20000
  s_add_u32 s28, s8, 8388608
  s_addc_u32 s29, s9, 0
  s_mov_b32 s30, 4194304
  s_mov_b32 s31, 0x20000
  s_add_u32 s32, s8, 12582912
  s_addc_u32 s33, s9, 0
  s_mov_b32 s34, 131072
  s_mov_b32 s35, 0x20000
  s_add_u32 s36, s8, 4194304
  s_addc_u32 s37, s9, 0
  s_mov_b32 s38, 4194304
  s_mov_b32 s39, 0x20000
  s_lshl_b32 s12, s10, 5
  s_lshl_b32 s13, s3, 3
  s_add_u32 s12, s12, s13
  s_lshl_b32 s13, s12, 12
  s_lshl_b32 s14, s12, 7
  buffer_load_dwordx4 v[64:67], v3, s[28:31], s13 offen offset:0
  buffer_load_dwordx4 v[68:71], v3, s[28:31], s13 offen offset:1024
  buffer_load_dwordx4 v[72:75], v3, s[28:31], s13 offen offset:2048
  buffer_load_dwordx4 v[76:79], v3, s[28:31], s13 offen offset:3072
  s_add_u32 s13, s13, 4096
  buffer_load_dwordx4 v[80:83], v3, s[28:31], s13 offen offset:0
  buffer_load_dwordx4 v[84:87], v3, s[28:31], s13 offen offset:1024
  buffer_load_dwordx4 v[88:91], v3, s[28:31], s13 offen offset:2048
  buffer_load_dwordx4 v[92:95], v3, s[28:31], s13 offen offset:3072
  s_add_u32 s13, s13, 4096
  buffer_load_dwordx4 v[96:99], v3, s[28:31], s13 offen offset:0
  buffer_load_dwordx4 v[100:103], v3, s[28:31], s13 offen offset:1024
  buffer_load_dwordx4 v[104:107], v3, s[28:31], s13 offen offset:2048
  buffer_load_dwordx4 v[108:111], v3, s[28:31], s13 offen offset:3072
  s_add_u32 s13, s13, 4096
  buffer_load_dwordx4 v[112:115], v3, s[28:31], s13 offen offset:0
  buffer_load_dwordx4 v[116:119], v3, s[28:31], s13 offen offset:1024
  buffer_load_dwordx4 v[120:123], v3, s[28:31], s13 offen offset:2048
  buffer_load_dwordx4 v[124:127], v3, s[28:31], s13 offen offset:3072
  s_add_u32 s13, s13, 4096
  buffer_load_dwordx4 v[128:131], v3, s[28:31], s13 offen offset:0
  buffer_load_dwordx4 v[132:135], v3, s[28:31], s13 offen offset:1024
  buffer_load_dwordx4 v[136:139], v3, s[28:31], s13 offen offset:2048
  buffer_load_dwordx4 v[140:143], v3, s[28:31], s13 offen offset:3072
  s_add_u32 s13, s13, 4096
  buffer_load_dwordx4 v[144:147], v3, s[28:31], s13 offen offset:0
  buffer_load_dwordx4 v[148:151], v3, s[28:31], s13 offen offset:1024
  buffer_load_dwordx4 v[152:155], v3, s[28:31], s13 offen offset:2048
  buffer_load_dwordx4 v[156:159], v3, s[28:31], s13 offen offset:3072
  s_add_u32 s13, s13, 4096
  buffer_load_dwordx4 v[160:163], v3, s[28:31], s13 offen offset:0
  buffer_load_dwordx4 v[164:167], v3, s[28:31], s13 offen offset:1024
  buffer_load_dwordx4 v[168:171], v3, s[28:31], s13 offen offset:2048
  buffer_load_dwordx4 v[172:175], v3, s[28:31], s13 offen offset:3072
  s_add_u32 s13, s13, 4096
  buffer_load_dwordx4 v[176:179], v3, s[28:31], s13 offen offset:0
  buffer_load_dwordx4 v[180:183], v3, s[28:31], s13 offen offset:1024
  buffer_load_dwordx4 v[184:187], v3, s[28:31], s13 offen offset:2048
  buffer_load_dwordx4 v[188:191], v3, s[28:31], s13 offen offset:3072
  s_add_u32 s13, s13, 4096
  s_lshl_b32 s15, s11, 4
  s_lshl_b32 s16, s3, 2
  s_add_u32 s15, s15, s16
  s_lshl_b32 s16, s15, 5
  s_add_u32 s16, s16, s10
  s_lshl_b32 s16, s16, 11
  s_mov_b32 s17, s16
  buffer_load_dwordx4 v[8:11], v3, s[24:27], s17 offen offset:0
  buffer_load_dwordx4 v[12:15], v3, s[24:27], s17 offen offset:1024
  s_add_u32 s17, s17, 65536
  buffer_load_dwordx4 v[16:19], v3, s[24:27], s17 offen offset:0
  buffer_load_dwordx4 v[20:23], v3, s[24:27], s17 offen offset:1024
  s_add_u32 s17, s17, 65536
  buffer_load_dwordx4 v[24:27], v3, s[24:27], s17 offen offset:0
  buffer_load_dwordx4 v[28:31], v3, s[24:27], s17 offen offset:1024
  s_add_u32 s17, s17, 65536
  buffer_load_dwordx4 v[32:35], v3, s[24:27], s17 offen offset:0
  buffer_load_dwordx4 v[36:39], v3, s[24:27], s17 offen offset:1024
  s_add_u32 s17, s17, 65536
  buffer_load_dwordx4 v[192:195], v4, s[32:35], s14 offen offset:0
  buffer_load_dwordx4 v[196:199], v4, s[32:35], s14 offen offset:16
  buffer_load_dwordx4 v[200:203], v4, s[32:35], s14 offen offset:32
  buffer_load_dwordx4 v[204:207], v4, s[32:35], s14 offen offset:48
  buffer_load_dwordx4 v[208:211], v4, s[32:35], s14 offen offset:128
  buffer_load_dwordx4 v[212:215], v4, s[32:35], s14 offen offset:144
  buffer_load_dwordx4 v[216:219], v4, s[32:35], s14 offen offset:160
  buffer_load_dwordx4 v[220:223], v4, s[32:35], s14 offen offset:176
  buffer_load_dwordx4 v[224:227], v4, s[32:35], s14 offen offset:256
  buffer_load_dwordx4 v[228:231], v4, s[32:35], s14 offen offset:272
  buffer_load_dwordx4 v[232:235], v4, s[32:35], s14 offen offset:288
  buffer_load_dwordx4 v[236:239], v4, s[32:35], s14 offen offset:304
  buffer_load_dwordx4 v[240:243], v4, s[32:35], s14 offen offset:384
  buffer_load_dwordx4 v[244:247], v4, s[32:35], s14 offen offset:400
  buffer_load_dwordx4 v[248:251], v4, s[32:35], s14 offen offset:416
  buffer_load_dwordx4 v[252:255], v4, s[32:35], s14 offen offset:432
  s_waitcnt vmcnt(48)
  v_pk_add_f32 v[64:65], v[64:65], v[80:81]
  v_pk_add_f32 v[66:67], v[66:67], v[82:83]
  v_pk_add_f32 v[68:69], v[68:69], v[84:85]
  v_pk_add_f32 v[70:71], v[70:71], v[86:87]
  v_pk_add_f32 v[72:73], v[72:73], v[88:89]
  v_pk_add_f32 v[74:75], v[74:75], v[90:91]
  v_pk_add_f32 v[76:77], v[76:77], v[92:93]
  v_pk_add_f32 v[78:79], v[78:79], v[94:95]
  s_waitcnt vmcnt(44)
  v_pk_add_f32 v[64:65], v[64:65], v[96:97]
  v_pk_add_f32 v[66:67], v[66:67], v[98:99]
  v_pk_add_f32 v[68:69], v[68:69], v[100:101]
  v_pk_add_f32 v[70:71], v[70:71], v[102:103]
  v_pk_add_f32 v[72:73], v[72:73], v[104:105]
  v_pk_add_f32 v[74:75], v[74:75], v[106:107]
  v_pk_add_f32 v[76:77], v[76:77], v[108:109]
  v_pk_add_f32 v[78:79], v[78:79], v[110:111]
  s_waitcnt vmcnt(40)
  v_pk_add_f32 v[64:65], v[64:65], v[112:113]
  v_pk_add_f32 v[66:67], v[66:67], v[114:115]
  v_pk_add_f32 v[68:69], v[68:69], v[116:117]
  v_pk_add_f32 v[70:71], v[70:71], v[118:119]
  v_pk_add_f32 v[72:73], v[72:73], v[120:121]
  v_pk_add_f32 v[74:75], v[74:75], v[122:123]
  v_pk_add_f32 v[76:77], v[76:77], v[124:125]
  v_pk_add_f32 v[78:79], v[78:79], v[126:127]
  s_waitcnt vmcnt(36)
  v_pk_add_f32 v[64:65], v[64:65], v[128:129]
  v_pk_add_f32 v[66:67], v[66:67], v[130:131]
  v_pk_add_f32 v[68:69], v[68:69], v[132:133]
  v_pk_add_f32 v[70:71], v[70:71], v[134:135]
  v_pk_add_f32 v[72:73], v[72:73], v[136:137]
  v_pk_add_f32 v[74:75], v[74:75], v[138:139]
  v_pk_add_f32 v[76:77], v[76:77], v[140:141]
  v_pk_add_f32 v[78:79], v[78:79], v[142:143]
  s_waitcnt vmcnt(32)
  v_pk_add_f32 v[64:65], v[64:65], v[144:145]
  v_pk_add_f32 v[66:67], v[66:67], v[146:147]
  v_pk_add_f32 v[68:69], v[68:69], v[148:149]
  v_pk_add_f32 v[70:71], v[70:71], v[150:151]
  v_pk_add_f32 v[72:73], v[72:73], v[152:153]
  v_pk_add_f32 v[74:75], v[74:75], v[154:155]
  v_pk_add_f32 v[76:77], v[76:77], v[156:157]
  v_pk_add_f32 v[78:79], v[78:79], v[158:159]
  s_waitcnt vmcnt(28)
  v_pk_add_f32 v[64:65], v[64:65], v[160:161]
  v_pk_add_f32 v[66:67], v[66:67], v[162:163]
  v_pk_add_f32 v[68:69], v[68:69], v[164:165]
  v_pk_add_f32 v[70:71], v[70:71], v[166:167]
  v_pk_add_f32 v[72:73], v[72:73], v[168:169]
  v_pk_add_f32 v[74:75], v[74:75], v[170:171]
  v_pk_add_f32 v[76:77], v[76:77], v[172:173]
  v_pk_add_f32 v[78:79], v[78:79], v[174:175]
  s_waitcnt vmcnt(24)
  v_pk_add_f32 v[64:65], v[64:65], v[176:177]
  v_pk_add_f32 v[66:67], v[66:67], v[178:179]
  v_pk_add_f32 v[68:69], v[68:69], v[180:181]
  v_pk_add_f32 v[70:71], v[70:71], v[182:183]
  v_pk_add_f32 v[72:73], v[72:73], v[184:185]
  v_pk_add_f32 v[74:75], v[74:75], v[186:187]
  v_pk_add_f32 v[76:77], v[76:77], v[188:189]
  v_pk_add_f32 v[78:79], v[78:79], v[190:191]
  buffer_load_dwordx4 v[80:83], v4, s[32:35], s14 offen offset:512
  buffer_load_dwordx4 v[84:87], v4, s[32:35], s14 offen offset:528
  buffer_load_dwordx4 v[88:91], v4, s[32:35], s14 offen offset:544
  buffer_load_dwordx4 v[92:95], v4, s[32:35], s14 offen offset:560
  buffer_load_dwordx4 v[96:99], v4, s[32:35], s14 offen offset:640
  buffer_load_dwordx4 v[100:103], v4, s[32:35], s14 offen offset:656
  buffer_load_dwordx4 v[104:107], v4, s[32:35], s14 offen offset:672
  buffer_load_dwordx4 v[108:111], v4, s[32:35], s14 offen offset:688
  buffer_load_dwordx4 v[112:115], v4, s[32:35], s14 offen offset:768
  buffer_load_dwordx4 v[116:119], v4, s[32:35], s14 offen offset:784
  buffer_load_dwordx4 v[120:123], v4, s[32:35], s14 offen offset:800
  buffer_load_dwordx4 v[124:127], v4, s[32:35], s14 offen offset:816
  buffer_load_dwordx4 v[128:131], v4, s[32:35], s14 offen offset:896
  buffer_load_dwordx4 v[132:135], v4, s[32:35], s14 offen offset:912
  buffer_load_dwordx4 v[136:139], v4, s[32:35], s14 offen offset:928
  buffer_load_dwordx4 v[140:143], v4, s[32:35], s14 offen offset:944
  s_waitcnt vmcnt(24)
  v_pk_add_f32 v[192:193], v[192:193], v[208:209]
  v_pk_add_f32 v[194:195], v[194:195], v[210:211]
  v_pk_add_f32 v[196:197], v[196:197], v[212:213]
  v_pk_add_f32 v[198:199], v[198:199], v[214:215]
  v_pk_add_f32 v[200:201], v[200:201], v[216:217]
  v_pk_add_f32 v[202:203], v[202:203], v[218:219]
  v_pk_add_f32 v[204:205], v[204:205], v[220:221]
  v_pk_add_f32 v[206:207], v[206:207], v[222:223]
  s_waitcnt vmcnt(20)
  v_pk_add_f32 v[192:193], v[192:193], v[224:225]
  v_pk_add_f32 v[194:195], v[194:195], v[226:227]
  v_pk_add_f32 v[196:197], v[196:197], v[228:229]
  v_pk_add_f32 v[198:199], v[198:199], v[230:231]
  v_pk_add_f32 v[200:201], v[200:201], v[232:233]
  v_pk_add_f32 v[202:203], v[202:203], v[234:235]
  v_pk_add_f32 v[204:205], v[204:205], v[236:237]
  v_pk_add_f32 v[206:207], v[206:207], v[238:239]
  s_waitcnt vmcnt(16)
  v_pk_add_f32 v[192:193], v[192:193], v[240:241]
  v_pk_add_f32 v[194:195], v[194:195], v[242:243]
  v_pk_add_f32 v[196:197], v[196:197], v[244:245]
  v_pk_add_f32 v[198:199], v[198:199], v[246:247]
  v_pk_add_f32 v[200:201], v[200:201], v[248:249]
  v_pk_add_f32 v[202:203], v[202:203], v[250:251]
  v_pk_add_f32 v[204:205], v[204:205], v[252:253]
  v_pk_add_f32 v[206:207], v[206:207], v[254:255]
  s_waitcnt vmcnt(12)
  v_pk_add_f32 v[192:193], v[192:193], v[80:81]
  v_pk_add_f32 v[194:195], v[194:195], v[82:83]
  v_pk_add_f32 v[196:197], v[196:197], v[84:85]
  v_pk_add_f32 v[198:199], v[198:199], v[86:87]
  v_pk_add_f32 v[200:201], v[200:201], v[88:89]
  v_pk_add_f32 v[202:203], v[202:203], v[90:91]
  v_pk_add_f32 v[204:205], v[204:205], v[92:93]
  v_pk_add_f32 v[206:207], v[206:207], v[94:95]
  s_waitcnt vmcnt(8)
  v_pk_add_f32 v[192:193], v[192:193], v[96:97]
  v_pk_add_f32 v[194:195], v[194:195], v[98:99]
  v_pk_add_f32 v[196:197], v[196:197], v[100:101]
  v_pk_add_f32 v[198:199], v[198:199], v[102:103]
  v_pk_add_f32 v[200:201], v[200:201], v[104:105]
  v_pk_add_f32 v[202:203], v[202:203], v[106:107]
  v_pk_add_f32 v[204:205], v[204:205], v[108:109]
  v_pk_add_f32 v[206:207], v[206:207], v[110:111]
  s_waitcnt vmcnt(4)
  v_pk_add_f32 v[192:193], v[192:193], v[112:113]
  v_pk_add_f32 v[194:195], v[194:195], v[114:115]
  v_pk_add_f32 v[196:197], v[196:197], v[116:117]
  v_pk_add_f32 v[198:199], v[198:199], v[118:119]
  v_pk_add_f32 v[200:201], v[200:201], v[120:121]
  v_pk_add_f32 v[202:203], v[202:203], v[122:123]
  v_pk_add_f32 v[204:205], v[204:205], v[124:125]
  v_pk_add_f32 v[206:207], v[206:207], v[126:127]
  s_waitcnt vmcnt(0)
  v_pk_add_f32 v[192:193], v[192:193], v[128:129]
  v_pk_add_f32 v[194:195], v[194:195], v[130:131]
  v_pk_add_f32 v[196:197], v[196:197], v[132:133]
  v_pk_add_f32 v[198:199], v[198:199], v[134:135]
  v_pk_add_f32 v[200:201], v[200:201], v[136:137]
  v_pk_add_f32 v[202:203], v[202:203], v[138:139]
  v_pk_add_f32 v[204:205], v[204:205], v[140:141]
  v_pk_add_f32 v[206:207], v[206:207], v[142:143]
  s_lshl_b32 s18, s3, 13
  v_add_u32 v5, s18, v3
  ds_write_b128 v5, v[64:67] offset:0
  ds_write_b128 v5, v[68:71] offset:1024
  ds_write_b128 v5, v[72:75] offset:2048
  ds_write_b128 v5, v[76:79] offset:3072
  ds_write_b128 v5, v[192:195] offset:4096
  ds_write_b128 v5, v[196:199] offset:5120
  ds_write_b128 v5, v[200:203] offset:6144
  ds_write_b128 v5, v[204:207] offset:7168
  s_waitcnt lgkmcnt(0)
  s_barrier
  ds_read_b128 v[64:67], v3 offset:0
  ds_read_b128 v[68:71], v3 offset:1024
  ds_read_b128 v[72:75], v3 offset:2048
  ds_read_b128 v[76:79], v3 offset:3072
  ds_read_b128 v[80:83], v3 offset:8192
  ds_read_b128 v[84:87], v3 offset:9216
  ds_read_b128 v[88:91], v3 offset:10240
  ds_read_b128 v[92:95], v3 offset:11264
  ds_read_b128 v[96:99], v3 offset:16384
  ds_read_b128 v[100:103], v3 offset:17408
  ds_read_b128 v[104:107], v3 offset:18432
  ds_read_b128 v[108:111], v3 offset:19456
  ds_read_b128 v[112:115], v3 offset:24576
  ds_read_b128 v[116:119], v3 offset:25600
  ds_read_b128 v[120:123], v3 offset:26624
  ds_read_b128 v[124:127], v3 offset:27648
  s_waitcnt lgkmcnt(0)
  ds_read_b128 v[128:131], v3 offset:4096
  ds_read_b128 v[132:135], v3 offset:5120
  ds_read_b128 v[136:139], v3 offset:6144
  ds_read_b128 v[140:143], v3 offset:7168
  ds_read_b128 v[144:147], v3 offset:12288
  ds_read_b128 v[148:151], v3 offset:13312
  ds_read_b128 v[152:155], v3 offset:14336
  ds_read_b128 v[156:159], v3 offset:15360
  ds_read_b128 v[160:163], v3 offset:20480
  ds_read_b128 v[164:167], v3 offset:21504
  ds_read_b128 v[168:171], v3 offset:22528
  ds_read_b128 v[172:175], v3 offset:23552
  ds_read_b128 v[176:179], v3 offset:28672
  ds_read_b128 v[180:183], v3 offset:29696
  ds_read_b128 v[184:187], v3 offset:30720
  ds_read_b128 v[188:191], v3 offset:31744
  v_pk_add_f32 v[64:65], v[64:65], v[80:81]
  v_pk_add_f32 v[66:67], v[66:67], v[82:83]
  v_pk_add_f32 v[68:69], v[68:69], v[84:85]
  v_pk_add_f32 v[70:71], v[70:71], v[86:87]
  v_pk_add_f32 v[72:73], v[72:73], v[88:89]
  v_pk_add_f32 v[74:75], v[74:75], v[90:91]
  v_pk_add_f32 v[76:77], v[76:77], v[92:93]
  v_pk_add_f32 v[78:79], v[78:79], v[94:95]
  v_pk_add_f32 v[64:65], v[64:65], v[96:97]
  v_pk_add_f32 v[66:67], v[66:67], v[98:99]
  v_pk_add_f32 v[68:69], v[68:69], v[100:101]
  v_pk_add_f32 v[70:71], v[70:71], v[102:103]
  v_pk_add_f32 v[72:73], v[72:73], v[104:105]
  v_pk_add_f32 v[74:75], v[74:75], v[106:107]
  v_pk_add_f32 v[76:77], v[76:77], v[108:109]
  v_pk_add_f32 v[78:79], v[78:79], v[110:111]
  v_pk_add_f32 v[64:65], v[64:65], v[112:113]
  v_pk_add_f32 v[66:67], v[66:67], v[114:115]
  v_pk_add_f32 v[68:69], v[68:69], v[116:117]
  v_pk_add_f32 v[70:71], v[70:71], v[118:119]
  v_pk_add_f32 v[72:73], v[72:73], v[120:121]
  v_pk_add_f32 v[74:75], v[74:75], v[122:123]
  v_pk_add_f32 v[76:77], v[76:77], v[124:125]
  v_pk_add_f32 v[78:79], v[78:79], v[126:127]
  s_waitcnt lgkmcnt(0)
  v_pk_add_f32 v[128:129], v[128:129], v[144:145]
  v_pk_add_f32 v[130:131], v[130:131], v[146:147]
  v_pk_add_f32 v[132:133], v[132:133], v[148:149]
  v_pk_add_f32 v[134:135], v[134:135], v[150:151]
  v_pk_add_f32 v[136:137], v[136:137], v[152:153]
  v_pk_add_f32 v[138:139], v[138:139], v[154:155]
  v_pk_add_f32 v[140:141], v[140:141], v[156:157]
  v_pk_add_f32 v[142:143], v[142:143], v[158:159]
  v_pk_add_f32 v[128:129], v[128:129], v[160:161]
  v_pk_add_f32 v[130:131], v[130:131], v[162:163]
  v_pk_add_f32 v[132:133], v[132:133], v[164:165]
  v_pk_add_f32 v[134:135], v[134:135], v[166:167]
  v_pk_add_f32 v[136:137], v[136:137], v[168:169]
  v_pk_add_f32 v[138:139], v[138:139], v[170:171]
  v_pk_add_f32 v[140:141], v[140:141], v[172:173]
  v_pk_add_f32 v[142:143], v[142:143], v[174:175]
  v_pk_add_f32 v[128:129], v[128:129], v[176:177]
  v_pk_add_f32 v[130:131], v[130:131], v[178:179]
  v_pk_add_f32 v[132:133], v[132:133], v[180:181]
  v_pk_add_f32 v[134:135], v[134:135], v[182:183]
  v_pk_add_f32 v[136:137], v[136:137], v[184:185]
  v_pk_add_f32 v[138:139], v[138:139], v[186:187]
  v_pk_add_f32 v[140:141], v[140:141], v[188:189]
  v_pk_add_f32 v[142:143], v[142:143], v[190:191]
  v_cvt_pk_bf16_f32 v40, v64, v65
  v_cvt_pk_bf16_f32 v41, v66, v67
  v_cvt_pk_bf16_f32 v42, v68, v69
  v_cvt_pk_bf16_f32 v43, v70, v71
  v_cvt_pk_bf16_f32 v44, v72, v73
  v_cvt_pk_bf16_f32 v45, v74, v75
  v_cvt_pk_bf16_f32 v46, v76, v77
  v_cvt_pk_bf16_f32 v47, v78, v79
  v_cvt_pk_bf16_f32 v48, v128, v129
  v_cvt_pk_bf16_f32 v49, v130, v131
  v_cvt_pk_bf16_f32 v50, v132, v133
  v_cvt_pk_bf16_f32 v51, v134, v135
  v_cvt_pk_bf16_f32 v52, v136, v137
  v_cvt_pk_bf16_f32 v53, v138, v139
  v_cvt_pk_bf16_f32 v54, v140, v141
  v_cvt_pk_bf16_f32 v55, v142, v143
  s_mov_b32 s44, 1069066811
  s_mov_b32 s45, 1069066811
  s_mov_b32 s46, 897988541
  s_mov_b32 s47, 897988541
  s_mov_b32 s17, s16
  v_lshlrev_b32 v180, 16, v8
  v_and_b32 v181, 0xffff0000, v8
  v_lshlrev_b32 v182, 16, v9
  v_and_b32 v183, 0xffff0000, v9
  v_lshlrev_b32 v184, 16, v10
  v_and_b32 v185, 0xffff0000, v10
  v_lshlrev_b32 v186, 16, v11
  v_and_b32 v187, 0xffff0000, v11
  v_min_f32 v188, 0, v180
  v_min_f32 v189, 0, v181
  v_min_f32 v190, 0, v182
  v_min_f32 v191, 0, v183
  v_min_f32 v192, 0, v184
  v_min_f32 v193, 0, v185
  v_min_f32 v194, 0, v186
  v_min_f32 v195, 0, v187
  v_pk_mul_f32 v[196:197], v[188:189], s[44:45]
  v_pk_mul_f32 v[198:199], v[190:191], s[44:45]
  v_pk_mul_f32 v[200:201], v[192:193], s[44:45]
  v_pk_mul_f32 v[202:203], v[194:195], s[44:45]
  v_exp_f32 v196, v196
  v_exp_f32 v197, v197
  v_exp_f32 v198, v198
  v_exp_f32 v199, v199
  v_exp_f32 v200, v200
  v_exp_f32 v201, v201
  v_exp_f32 v202, v202
  v_exp_f32 v203, v203
  v_pk_add_f32 v[180:181], v[180:181], v[188:189] neg_lo:[0,1] neg_hi:[0,1]
  v_pk_add_f32 v[182:183], v[182:183], v[190:191] neg_lo:[0,1] neg_hi:[0,1]
  v_pk_add_f32 v[184:185], v[184:185], v[192:193] neg_lo:[0,1] neg_hi:[0,1]
  v_pk_add_f32 v[186:187], v[186:187], v[194:195] neg_lo:[0,1] neg_hi:[0,1]
  v_pk_add_f32 v[180:181], v[180:181], v[196:197]
  v_pk_add_f32 v[182:183], v[182:183], v[198:199]
  v_pk_add_f32 v[184:185], v[184:185], v[200:201]
  v_pk_add_f32 v[186:187], v[186:187], v[202:203]
  v_pk_add_f32 v[180:181], v[180:181], s[46:47]
  v_pk_add_f32 v[182:183], v[182:183], s[46:47]
  v_pk_add_f32 v[184:185], v[184:185], s[46:47]
  v_pk_add_f32 v[186:187], v[186:187], s[46:47]
  v_cvt_pk_bf16_f32 v8, v180, v181
  v_cvt_pk_bf16_f32 v9, v182, v183
  v_cvt_pk_bf16_f32 v10, v184, v185
  v_cvt_pk_bf16_f32 v11, v186, v187
  v_lshlrev_b32 v180, 16, v12
  v_and_b32 v181, 0xffff0000, v12
  v_lshlrev_b32 v182, 16, v13
  v_and_b32 v183, 0xffff0000, v13
  v_lshlrev_b32 v184, 16, v14
  v_and_b32 v185, 0xffff0000, v14
  v_lshlrev_b32 v186, 16, v15
  v_and_b32 v187, 0xffff0000, v15
  v_min_f32 v188, 0, v180
  v_min_f32 v189, 0, v181
  v_min_f32 v190, 0, v182
  v_min_f32 v191, 0, v183
  v_min_f32 v192, 0, v184
  v_min_f32 v193, 0, v185
  v_min_f32 v194, 0, v186
  v_min_f32 v195, 0, v187
  v_pk_mul_f32 v[196:197], v[188:189], s[44:45]
  v_pk_mul_f32 v[198:199], v[190:191], s[44:45]
  v_pk_mul_f32 v[200:201], v[192:193], s[44:45]
  v_pk_mul_f32 v[202:203], v[194:195], s[44:45]
  v_exp_f32 v196, v196
  v_exp_f32 v197, v197
  v_exp_f32 v198, v198
  v_exp_f32 v199, v199
  v_exp_f32 v200, v200
  v_exp_f32 v201, v201
  v_exp_f32 v202, v202
  v_exp_f32 v203, v203
  v_pk_add_f32 v[180:181], v[180:181], v[188:189] neg_lo:[0,1] neg_hi:[0,1]
  v_pk_add_f32 v[182:183], v[182:183], v[190:191] neg_lo:[0,1] neg_hi:[0,1]
  v_pk_add_f32 v[184:185], v[184:185], v[192:193] neg_lo:[0,1] neg_hi:[0,1]
  v_pk_add_f32 v[186:187], v[186:187], v[194:195] neg_lo:[0,1] neg_hi:[0,1]
  v_pk_add_f32 v[180:181], v[180:181], v[196:197]
  v_pk_add_f32 v[182:183], v[182:183], v[198:199]
  v_pk_add_f32 v[184:185], v[184:185], v[200:201]
  v_pk_add_f32 v[186:187], v[186:187], v[202:203]
  v_pk_add_f32 v[180:181], v[180:181], s[46:47]
  v_pk_add_f32 v[182:183], v[182:183], s[46:47]
  v_pk_add_f32 v[184:185], v[184:185], s[46:47]
  v_pk_add_f32 v[186:187], v[186:187], s[46:47]
  v_cvt_pk_bf16_f32 v12, v180, v181
  v_cvt_pk_bf16_f32 v13, v182, v183
  v_cvt_pk_bf16_f32 v14, v184, v185
  v_cvt_pk_bf16_f32 v15, v186, v187
  v_mfma_f32_32x32x16_bf16 v[64:79], v[40:43], v[8:11], 0
  v_mfma_f32_32x32x16_bf16 v[80:95], v[48:51], v[8:11], 0
  v_mfma_f32_32x32x16_bf16 v[64:79], v[44:47], v[12:15], v[64:79]
  v_mfma_f32_32x32x16_bf16 v[80:95], v[52:55], v[12:15], v[80:95]
  s_nop 11
  v_add_f32 v56, s46, v80
  v_rcp_f32 v56, v56
  s_nop 0
  v_mov_b32 v57, v56
  v_pk_mul_f32 v[64:65], v[64:65], v[56:57]
  v_pk_mul_f32 v[66:67], v[66:67], v[56:57]
  v_pk_mul_f32 v[68:69], v[68:69], v[56:57]
  v_pk_mul_f32 v[70:71], v[70:71], v[56:57]
  v_pk_mul_f32 v[72:73], v[72:73], v[56:57]
  v_pk_mul_f32 v[74:75], v[74:75], v[56:57]
  v_pk_mul_f32 v[76:77], v[76:77], v[56:57]
  v_pk_mul_f32 v[78:79], v[78:79], v[56:57]
  v_cvt_pk_bf16_f32 v208, v64, v65
  v_cvt_pk_bf16_f32 v209, v66, v67
  v_cvt_pk_bf16_f32 v210, v68, v69
  v_cvt_pk_bf16_f32 v211, v70, v71
  v_cvt_pk_bf16_f32 v212, v72, v73
  v_cvt_pk_bf16_f32 v213, v74, v75
  v_cvt_pk_bf16_f32 v214, v76, v77
  v_cvt_pk_bf16_f32 v215, v78, v79
  buffer_store_dwordx4 v[208:211], v3, s[36:39], s17 offen offset:0
  buffer_store_dwordx4 v[212:215], v3, s[36:39], s17 offen offset:1024
  s_add_u32 s17, s17, 65536
  v_lshlrev_b32 v180, 16, v16
  v_and_b32 v181, 0xffff0000, v16
  v_lshlrev_b32 v182, 16, v17
  v_and_b32 v183, 0xffff0000, v17
  v_lshlrev_b32 v184, 16, v18
  v_and_b32 v185, 0xffff0000, v18
  v_lshlrev_b32 v186, 16, v19
  v_and_b32 v187, 0xffff0000, v19
  v_min_f32 v188, 0, v180
  v_min_f32 v189, 0, v181
  v_min_f32 v190, 0, v182
  v_min_f32 v191, 0, v183
  v_min_f32 v192, 0, v184
  v_min_f32 v193, 0, v185
  v_min_f32 v194, 0, v186
  v_min_f32 v195, 0, v187
  v_pk_mul_f32 v[196:197], v[188:189], s[44:45]
  v_pk_mul_f32 v[198:199], v[190:191], s[44:45]
  v_pk_mul_f32 v[200:201], v[192:193], s[44:45]
  v_pk_mul_f32 v[202:203], v[194:195], s[44:45]
  v_exp_f32 v196, v196
  v_exp_f32 v197, v197
  v_exp_f32 v198, v198
  v_exp_f32 v199, v199
  v_exp_f32 v200, v200
  v_exp_f32 v201, v201
  v_exp_f32 v202, v202
  v_exp_f32 v203, v203
  v_pk_add_f32 v[180:181], v[180:181], v[188:189] neg_lo:[0,1] neg_hi:[0,1]
  v_pk_add_f32 v[182:183], v[182:183], v[190:191] neg_lo:[0,1] neg_hi:[0,1]
  v_pk_add_f32 v[184:185], v[184:185], v[192:193] neg_lo:[0,1] neg_hi:[0,1]
  v_pk_add_f32 v[186:187], v[186:187], v[194:195] neg_lo:[0,1] neg_hi:[0,1]
  v_pk_add_f32 v[180:181], v[180:181], v[196:197]
  v_pk_add_f32 v[182:183], v[182:183], v[198:199]
  v_pk_add_f32 v[184:185], v[184:185], v[200:201]
  v_pk_add_f32 v[186:187], v[186:187], v[202:203]
  v_pk_add_f32 v[180:181], v[180:181], s[46:47]
  v_pk_add_f32 v[182:183], v[182:183], s[46:47]
  v_pk_add_f32 v[184:185], v[184:185], s[46:47]
  v_pk_add_f32 v[186:187], v[186:187], s[46:47]
  v_cvt_pk_bf16_f32 v16, v180, v181
  v_cvt_pk_bf16_f32 v17, v182, v183
  v_cvt_pk_bf16_f32 v18, v184, v185
  v_cvt_pk_bf16_f32 v19, v186, v187
  v_lshlrev_b32 v180, 16, v20
  v_and_b32 v181, 0xffff0000, v20
  v_lshlrev_b32 v182, 16, v21
  v_and_b32 v183, 0xffff0000, v21
  v_lshlrev_b32 v184, 16, v22
  v_and_b32 v185, 0xffff0000, v22
  v_lshlrev_b32 v186, 16, v23
  v_and_b32 v187, 0xffff0000, v23
  v_min_f32 v188, 0, v180
  v_min_f32 v189, 0, v181
  v_min_f32 v190, 0, v182
  v_min_f32 v191, 0, v183
  v_min_f32 v192, 0, v184
  v_min_f32 v193, 0, v185
  v_min_f32 v194, 0, v186
  v_min_f32 v195, 0, v187
  v_pk_mul_f32 v[196:197], v[188:189], s[44:45]
  v_pk_mul_f32 v[198:199], v[190:191], s[44:45]
  v_pk_mul_f32 v[200:201], v[192:193], s[44:45]
  v_pk_mul_f32 v[202:203], v[194:195], s[44:45]
  v_exp_f32 v196, v196
  v_exp_f32 v197, v197
  v_exp_f32 v198, v198
  v_exp_f32 v199, v199
  v_exp_f32 v200, v200
  v_exp_f32 v201, v201
  v_exp_f32 v202, v202
  v_exp_f32 v203, v203
  v_pk_add_f32 v[180:181], v[180:181], v[188:189] neg_lo:[0,1] neg_hi:[0,1]
  v_pk_add_f32 v[182:183], v[182:183], v[190:191] neg_lo:[0,1] neg_hi:[0,1]
  v_pk_add_f32 v[184:185], v[184:185], v[192:193] neg_lo:[0,1] neg_hi:[0,1]
  v_pk_add_f32 v[186:187], v[186:187], v[194:195] neg_lo:[0,1] neg_hi:[0,1]
  v_pk_add_f32 v[180:181], v[180:181], v[196:197]
  v_pk_add_f32 v[182:183], v[182:183], v[198:199]
  v_pk_add_f32 v[184:185], v[184:185], v[200:201]
  v_pk_add_f32 v[186:187], v[186:187], v[202:203]
  v_pk_add_f32 v[180:181], v[180:181], s[46:47]
  v_pk_add_f32 v[182:183], v[182:183], s[46:47]
  v_pk_add_f32 v[184:185], v[184:185], s[46:47]
  v_pk_add_f32 v[186:187], v[186:187], s[46:47]
  v_cvt_pk_bf16_f32 v20, v180, v181
  v_cvt_pk_bf16_f32 v21, v182, v183
  v_cvt_pk_bf16_f32 v22, v184, v185
  v_cvt_pk_bf16_f32 v23, v186, v187
  v_mfma_f32_32x32x16_bf16 v[96:111], v[40:43], v[16:19], 0
  v_mfma_f32_32x32x16_bf16 v[112:127], v[48:51], v[16:19], 0
  v_mfma_f32_32x32x16_bf16 v[96:111], v[44:47], v[20:23], v[96:111]
  v_mfma_f32_32x32x16_bf16 v[112:127], v[52:55], v[20:23], v[112:127]
  s_nop 11
  v_add_f32 v56, s46, v112
  v_rcp_f32 v56, v56
  s_nop 0
  v_mov_b32 v57, v56
  v_pk_mul_f32 v[96:97], v[96:97], v[56:57]
  v_pk_mul_f32 v[98:99], v[98:99], v[56:57]
  v_pk_mul_f32 v[100:101], v[100:101], v[56:57]
  v_pk_mul_f32 v[102:103], v[102:103], v[56:57]
  v_pk_mul_f32 v[104:105], v[104:105], v[56:57]
  v_pk_mul_f32 v[106:107], v[106:107], v[56:57]
  v_pk_mul_f32 v[108:109], v[108:109], v[56:57]
  v_pk_mul_f32 v[110:111], v[110:111], v[56:57]
  v_cvt_pk_bf16_f32 v216, v96, v97
  v_cvt_pk_bf16_f32 v217, v98, v99
  v_cvt_pk_bf16_f32 v218, v100, v101
  v_cvt_pk_bf16_f32 v219, v102, v103
  v_cvt_pk_bf16_f32 v220, v104, v105
  v_cvt_pk_bf16_f32 v221, v106, v107
  v_cvt_pk_bf16_f32 v222, v108, v109
  v_cvt_pk_bf16_f32 v223, v110, v111
  buffer_store_dwordx4 v[216:219], v3, s[36:39], s17 offen offset:0
  buffer_store_dwordx4 v[220:223], v3, s[36:39], s17 offen offset:1024
  s_add_u32 s17, s17, 65536
  v_lshlrev_b32 v180, 16, v24
  v_and_b32 v181, 0xffff0000, v24
  v_lshlrev_b32 v182, 16, v25
  v_and_b32 v183, 0xffff0000, v25
  v_lshlrev_b32 v184, 16, v26
  v_and_b32 v185, 0xffff0000, v26
  v_lshlrev_b32 v186, 16, v27
  v_and_b32 v187, 0xffff0000, v27
  v_min_f32 v188, 0, v180
  v_min_f32 v189, 0, v181
  v_min_f32 v190, 0, v182
  v_min_f32 v191, 0, v183
  v_min_f32 v192, 0, v184
  v_min_f32 v193, 0, v185
  v_min_f32 v194, 0, v186
  v_min_f32 v195, 0, v187
  v_pk_mul_f32 v[196:197], v[188:189], s[44:45]
  v_pk_mul_f32 v[198:199], v[190:191], s[44:45]
  v_pk_mul_f32 v[200:201], v[192:193], s[44:45]
  v_pk_mul_f32 v[202:203], v[194:195], s[44:45]
  v_exp_f32 v196, v196
  v_exp_f32 v197, v197
  v_exp_f32 v198, v198
  v_exp_f32 v199, v199
  v_exp_f32 v200, v200
  v_exp_f32 v201, v201
  v_exp_f32 v202, v202
  v_exp_f32 v203, v203
  v_pk_add_f32 v[180:181], v[180:181], v[188:189] neg_lo:[0,1] neg_hi:[0,1]
  v_pk_add_f32 v[182:183], v[182:183], v[190:191] neg_lo:[0,1] neg_hi:[0,1]
  v_pk_add_f32 v[184:185], v[184:185], v[192:193] neg_lo:[0,1] neg_hi:[0,1]
  v_pk_add_f32 v[186:187], v[186:187], v[194:195] neg_lo:[0,1] neg_hi:[0,1]
  v_pk_add_f32 v[180:181], v[180:181], v[196:197]
  v_pk_add_f32 v[182:183], v[182:183], v[198:199]
  v_pk_add_f32 v[184:185], v[184:185], v[200:201]
  v_pk_add_f32 v[186:187], v[186:187], v[202:203]
  v_pk_add_f32 v[180:181], v[180:181], s[46:47]
  v_pk_add_f32 v[182:183], v[182:183], s[46:47]
  v_pk_add_f32 v[184:185], v[184:185], s[46:47]
  v_pk_add_f32 v[186:187], v[186:187], s[46:47]
  v_cvt_pk_bf16_f32 v24, v180, v181
  v_cvt_pk_bf16_f32 v25, v182, v183
  v_cvt_pk_bf16_f32 v26, v184, v185
  v_cvt_pk_bf16_f32 v27, v186, v187
  v_lshlrev_b32 v180, 16, v28
  v_and_b32 v181, 0xffff0000, v28
  v_lshlrev_b32 v182, 16, v29
  v_and_b32 v183, 0xffff0000, v29
  v_lshlrev_b32 v184, 16, v30
  v_and_b32 v185, 0xffff0000, v30
  v_lshlrev_b32 v186, 16, v31
  v_and_b32 v187, 0xffff0000, v31
  v_min_f32 v188, 0, v180
  v_min_f32 v189, 0, v181
  v_min_f32 v190, 0, v182
  v_min_f32 v191, 0, v183
  v_min_f32 v192, 0, v184
  v_min_f32 v193, 0, v185
  v_min_f32 v194, 0, v186
  v_min_f32 v195, 0, v187
  v_pk_mul_f32 v[196:197], v[188:189], s[44:45]
  v_pk_mul_f32 v[198:199], v[190:191], s[44:45]
  v_pk_mul_f32 v[200:201], v[192:193], s[44:45]
  v_pk_mul_f32 v[202:203], v[194:195], s[44:45]
  v_exp_f32 v196, v196
  v_exp_f32 v197, v197
  v_exp_f32 v198, v198
  v_exp_f32 v199, v199
  v_exp_f32 v200, v200
  v_exp_f32 v201, v201
  v_exp_f32 v202, v202
  v_exp_f32 v203, v203
  v_pk_add_f32 v[180:181], v[180:181], v[188:189] neg_lo:[0,1] neg_hi:[0,1]
  v_pk_add_f32 v[182:183], v[182:183], v[190:191] neg_lo:[0,1] neg_hi:[0,1]
  v_pk_add_f32 v[184:185], v[184:185], v[192:193] neg_lo:[0,1] neg_hi:[0,1]
  v_pk_add_f32 v[186:187], v[186:187], v[194:195] neg_lo:[0,1] neg_hi:[0,1]
  v_pk_add_f32 v[180:181], v[180:181], v[196:197]
  v_pk_add_f32 v[182:183], v[182:183], v[198:199]
  v_pk_add_f32 v[184:185], v[184:185], v[200:201]
  v_pk_add_f32 v[186:187], v[186:187], v[202:203]
  v_pk_add_f32 v[180:181], v[180:181], s[46:47]
  v_pk_add_f32 v[182:183], v[182:183], s[46:47]
  v_pk_add_f32 v[184:185], v[184:185], s[46:47]
  v_pk_add_f32 v[186:187], v[186:187], s[46:47]
  v_cvt_pk_bf16_f32 v28, v180, v181
  v_cvt_pk_bf16_f32 v29, v182, v183
  v_cvt_pk_bf16_f32 v30, v184, v185
  v_cvt_pk_bf16_f32 v31, v186, v187
  v_mfma_f32_32x32x16_bf16 v[64:79], v[40:43], v[24:27], 0
  v_mfma_f32_32x32x16_bf16 v[80:95], v[48:51], v[24:27], 0
  v_mfma_f32_32x32x16_bf16 v[64:79], v[44:47], v[28:31], v[64:79]
  v_mfma_f32_32x32x16_bf16 v[80:95], v[52:55], v[28:31], v[80:95]
  s_nop 11
  v_add_f32 v56, s46, v80
  v_rcp_f32 v56, v56
  s_nop 0
  v_mov_b32 v57, v56
  v_pk_mul_f32 v[64:65], v[64:65], v[56:57]
  v_pk_mul_f32 v[66:67], v[66:67], v[56:57]
  v_pk_mul_f32 v[68:69], v[68:69], v[56:57]
  v_pk_mul_f32 v[70:71], v[70:71], v[56:57]
  v_pk_mul_f32 v[72:73], v[72:73], v[56:57]
  v_pk_mul_f32 v[74:75], v[74:75], v[56:57]
  v_pk_mul_f32 v[76:77], v[76:77], v[56:57]
  v_pk_mul_f32 v[78:79], v[78:79], v[56:57]
  v_cvt_pk_bf16_f32 v208, v64, v65
  v_cvt_pk_bf16_f32 v209, v66, v67
  v_cvt_pk_bf16_f32 v210, v68, v69
  v_cvt_pk_bf16_f32 v211, v70, v71
  v_cvt_pk_bf16_f32 v212, v72, v73
  v_cvt_pk_bf16_f32 v213, v74, v75
  v_cvt_pk_bf16_f32 v214, v76, v77
  v_cvt_pk_bf16_f32 v215, v78, v79
  buffer_store_dwordx4 v[208:211], v3, s[36:39], s17 offen offset:0
  buffer_store_dwordx4 v[212:215], v3, s[36:39], s17 offen offset:1024
  s_add_u32 s17, s17, 65536
  v_lshlrev_b32 v180, 16, v32
  v_and_b32 v181, 0xffff0000, v32
  v_lshlrev_b32 v182, 16, v33
  v_and_b32 v183, 0xffff0000, v33
  v_lshlrev_b32 v184, 16, v34
  v_and_b32 v185, 0xffff0000, v34
  v_lshlrev_b32 v186, 16, v35
  v_and_b32 v187, 0xffff0000, v35
  v_min_f32 v188, 0, v180
  v_min_f32 v189, 0, v181
  v_min_f32 v190, 0, v182
  v_min_f32 v191, 0, v183
  v_min_f32 v192, 0, v184
  v_min_f32 v193, 0, v185
  v_min_f32 v194, 0, v186
  v_min_f32 v195, 0, v187
  v_pk_mul_f32 v[196:197], v[188:189], s[44:45]
  v_pk_mul_f32 v[198:199], v[190:191], s[44:45]
  v_pk_mul_f32 v[200:201], v[192:193], s[44:45]
  v_pk_mul_f32 v[202:203], v[194:195], s[44:45]
  v_exp_f32 v196, v196
  v_exp_f32 v197, v197
  v_exp_f32 v198, v198
  v_exp_f32 v199, v199
  v_exp_f32 v200, v200
  v_exp_f32 v201, v201
  v_exp_f32 v202, v202
  v_exp_f32 v203, v203
  v_pk_add_f32 v[180:181], v[180:181], v[188:189] neg_lo:[0,1] neg_hi:[0,1]
  v_pk_add_f32 v[182:183], v[182:183], v[190:191] neg_lo:[0,1] neg_hi:[0,1]
  v_pk_add_f32 v[184:185], v[184:185], v[192:193] neg_lo:[0,1] neg_hi:[0,1]
  v_pk_add_f32 v[186:187], v[186:187], v[194:195] neg_lo:[0,1] neg_hi:[0,1]
  v_pk_add_f32 v[180:181], v[180:181], v[196:197]
  v_pk_add_f32 v[182:183], v[182:183], v[198:199]
  v_pk_add_f32 v[184:185], v[184:185], v[200:201]
  v_pk_add_f32 v[186:187], v[186:187], v[202:203]
  v_pk_add_f32 v[180:181], v[180:181], s[46:47]
  v_pk_add_f32 v[182:183], v[182:183], s[46:47]
  v_pk_add_f32 v[184:185], v[184:185], s[46:47]
  v_pk_add_f32 v[186:187], v[186:187], s[46:47]
  v_cvt_pk_bf16_f32 v32, v180, v181
  v_cvt_pk_bf16_f32 v33, v182, v183
  v_cvt_pk_bf16_f32 v34, v184, v185
  v_cvt_pk_bf16_f32 v35, v186, v187
  v_lshlrev_b32 v180, 16, v36
  v_and_b32 v181, 0xffff0000, v36
  v_lshlrev_b32 v182, 16, v37
  v_and_b32 v183, 0xffff0000, v37
  v_lshlrev_b32 v184, 16, v38
  v_and_b32 v185, 0xffff0000, v38
  v_lshlrev_b32 v186, 16, v39
  v_and_b32 v187, 0xffff0000, v39
  v_min_f32 v188, 0, v180
  v_min_f32 v189, 0, v181
  v_min_f32 v190, 0, v182
  v_min_f32 v191, 0, v183
  v_min_f32 v192, 0, v184
  v_min_f32 v193, 0, v185
  v_min_f32 v194, 0, v186
  v_min_f32 v195, 0, v187
  v_pk_mul_f32 v[196:197], v[188:189], s[44:45]
  v_pk_mul_f32 v[198:199], v[190:191], s[44:45]
  v_pk_mul_f32 v[200:201], v[192:193], s[44:45]
  v_pk_mul_f32 v[202:203], v[194:195], s[44:45]
  v_exp_f32 v196, v196
  v_exp_f32 v197, v197
  v_exp_f32 v198, v198
  v_exp_f32 v199, v199
  v_exp_f32 v200, v200
  v_exp_f32 v201, v201
  v_exp_f32 v202, v202
  v_exp_f32 v203, v203
  v_pk_add_f32 v[180:181], v[180:181], v[188:189] neg_lo:[0,1] neg_hi:[0,1]
  v_pk_add_f32 v[182:183], v[182:183], v[190:191] neg_lo:[0,1] neg_hi:[0,1]
  v_pk_add_f32 v[184:185], v[184:185], v[192:193] neg_lo:[0,1] neg_hi:[0,1]
  v_pk_add_f32 v[186:187], v[186:187], v[194:195] neg_lo:[0,1] neg_hi:[0,1]
  v_pk_add_f32 v[180:181], v[180:181], v[196:197]
  v_pk_add_f32 v[182:183], v[182:183], v[198:199]
  v_pk_add_f32 v[184:185], v[184:185], v[200:201]
  v_pk_add_f32 v[186:187], v[186:187], v[202:203]
  v_pk_add_f32 v[180:181], v[180:181], s[46:47]
  v_pk_add_f32 v[182:183], v[182:183], s[46:47]
  v_pk_add_f32 v[184:185], v[184:185], s[46:47]
  v_pk_add_f32 v[186:187], v[186:187], s[46:47]
  v_cvt_pk_bf16_f32 v36, v180, v181
  v_cvt_pk_bf16_f32 v37, v182, v183
  v_cvt_pk_bf16_f32 v38, v184, v185
  v_cvt_pk_bf16_f32 v39, v186, v187
  v_mfma_f32_32x32x16_bf16 v[96:111], v[40:43], v[32:35], 0
  v_mfma_f32_32x32x16_bf16 v[112:127], v[48:51], v[32:35], 0
  v_mfma_f32_32x32x16_bf16 v[96:111], v[44:47], v[36:39], v[96:111]
  v_mfma_f32_32x32x16_bf16 v[112:127], v[52:55], v[36:39], v[112:127]
  s_nop 11
  v_add_f32 v56, s46, v112
  v_rcp_f32 v56, v56
  s_nop 0
  v_mov_b32 v57, v56
  v_pk_mul_f32 v[96:97], v[96:97], v[56:57]
  v_pk_mul_f32 v[98:99], v[98:99], v[56:57]
  v_pk_mul_f32 v[100:101], v[100:101], v[56:57]
  v_pk_mul_f32 v[102:103], v[102:103], v[56:57]
  v_pk_mul_f32 v[104:105], v[104:105], v[56:57]
  v_pk_mul_f32 v[106:107], v[106:107], v[56:57]
  v_pk_mul_f32 v[108:109], v[108:109], v[56:57]
  v_pk_mul_f32 v[110:111], v[110:111], v[56:57]
  v_cvt_pk_bf16_f32 v216, v96, v97
  v_cvt_pk_bf16_f32 v217, v98, v99
  v_cvt_pk_bf16_f32 v218, v100, v101
  v_cvt_pk_bf16_f32 v219, v102, v103
  v_cvt_pk_bf16_f32 v220, v104, v105
  v_cvt_pk_bf16_f32 v221, v106, v107
  v_cvt_pk_bf16_f32 v222, v108, v109
  v_cvt_pk_bf16_f32 v223, v110, v111
  buffer_store_dwordx4 v[216:219], v3, s[36:39], s17 offen offset:0
  buffer_store_dwordx4 v[220:223], v3, s[36:39], s17 offen offset:1024
  s_add_u32 s17, s17, 65536
OP_end:
  s_endpgm
.globl g2_kernel
.p2align 8
.type g2_kernel,@function
g2_kernel:
  s_cmp_ge_u32 s2, 256
  s_cbranch_scc1 G2_end
  s_load_dwordx4 s[4:7], s[0:1], 64
  s_load_dwordx2 s[8:9], s[0:1], 88
  v_lshrrev_b32 v1, 6, v0
  v_and_b32 v2, 63, v0
  s_and_b32 s10, s2, 7
  v_readfirstlane_b32 s3, v1
  s_lshr_b32 s11, s2, 3
  s_and_b32 s12, s10, 3
  s_lshl_b32 s12, s12, 2
  s_and_b32 s13, s11, 3
  s_add_u32 s12, s12, s13
  s_lshr_b32 s13, s10, 2
  s_lshl_b32 s13, s13, 3
  s_lshr_b32 s14, s11, 2
  s_add_u32 s13, s13, s14
  s_waitcnt lgkmcnt(0)
  s_mov_b32 s16, s4
  s_mov_b32 s17, s5
  s_mov_b32 s18, 2097152
  s_mov_b32 s19, 0x20000
  s_mov_b32 s20, s6
  s_mov_b32 s21, s7
  s_mov_b32 s22, 8388608
  s_mov_b32 s23, 0x20000
  s_add_u32 s24, s8, 4194304
  s_addc_u32 s25, s9, 0
  s_mov_b32 s26, 4194304
  s_mov_b32 s27, 0x20000
  s_cmp_ge_u32 s3, 4
  s_cbranch_scc1 G2_loader
  v_lshlrev_b32 v3, 4, v2
  s_lshl_b32 s36, s12, 2
  s_add_u32 s36, s36, s3
  s_lshl_b32 s37, s36, 16
  buffer_load_dwordx4 v[64:67], v3, s[24:27], s37 offen offset:0
  buffer_load_dwordx4 v[68:71], v3, s[24:27], s37 offen offset:1024
  buffer_load_dwordx4 v[72:75], v3, s[24:27], s37 offen offset:2048
  buffer_load_dwordx4 v[76:79], v3, s[24:27], s37 offen offset:3072
  s_add_u32 s37, s37, 4096
  buffer_load_dwordx4 v[80:83], v3, s[24:27], s37 offen offset:0
  buffer_load_dwordx4 v[84:87], v3, s[24:27], s37 offen offset:1024
  buffer_load_dwordx4 v[88:91], v3, s[24:27], s37 offen offset:2048
  buffer_load_dwordx4 v[92:95], v3, s[24:27], s37 offen offset:3072
  s_add_u32 s37, s37, 4096
  buffer_load_dwordx4 v[96:99], v3, s[24:27], s37 offen offset:0
  buffer_load_dwordx4 v[100:103], v3, s[24:27], s37 offen offset:1024
  buffer_load_dwordx4 v[104:107], v3, s[24:27], s37 offen offset:2048
  buffer_load_dwordx4 v[108:111], v3, s[24:27], s37 offen offset:3072
  s_add_u32 s37, s37, 4096
  buffer_load_dwordx4 v[112:115], v3, s[24:27], s37 offen offset:0
  buffer_load_dwordx4 v[116:119], v3, s[24:27], s37 offen offset:1024
  buffer_load_dwordx4 v[120:123], v3, s[24:27], s37 offen offset:2048
  buffer_load_dwordx4 v[124:127], v3, s[24:27], s37 offen offset:3072
  s_add_u32 s37, s37, 4096
  buffer_load_dwordx4 v[128:131], v3, s[24:27], s37 offen offset:0
  buffer_load_dwordx4 v[132:135], v3, s[24:27], s37 offen offset:1024
  buffer_load_dwordx4 v[136:139], v3, s[24:27], s37 offen offset:2048
  buffer_load_dwordx4 v[140:143], v3, s[24:27], s37 offen offset:3072
  s_add_u32 s37, s37, 4096
  buffer_load_dwordx4 v[144:147], v3, s[24:27], s37 offen offset:0
  buffer_load_dwordx4 v[148:151], v3, s[24:27], s37 offen offset:1024
  buffer_load_dwordx4 v[152:155], v3, s[24:27], s37 offen offset:2048
  buffer_load_dwordx4 v[156:159], v3, s[24:27], s37 offen offset:3072
  s_add_u32 s37, s37, 4096
  v_and_b32 v17, 15, v2
  v_lshrrev_b32 v18, 2, v17
  v_and_b32 v17, 3, v17
  v_lshlrev_b32 v18, 6, v18
  v_lshl_add_u32 v18, v17, 3, v18
  v_bfe_u32 v17, v2, 4, 1
  v_lshl_add_u32 v18, v17, 5, v18
  v_lshrrev_b32 v14, 5, v2
  v_lshl_add_u32 v12, v14, 9, v18
  v_add_u32 v13, 0x10000, v12
  s_barrier
  ds_read_b64_tr_b16 v[16:17], v12 offset:0
  ds_read_b64_tr_b16 v[18:19], v12 offset:1024
  ds_read_b64_tr_b16 v[20:21], v12 offset:256
  ds_read_b64_tr_b16 v[22:23], v12 offset:1280
  s_waitcnt vmcnt(23)
  s_waitcnt lgkmcnt(2)
  v_mfma_f32_32x32x16_bf16 v[32:47], v[16:19], v[64:67], 0
  ds_read_b64_tr_b16 v[24:25], v12 offset:2048
  ds_read_b64_tr_b16 v[26:27], v12 offset:3072
  s_waitcnt lgkmcnt(2)
  v_mfma_f32_32x32x16_bf16 v[48:63], v[20:23], v[64:67], 0
  ds_read_b64_tr_b16 v[28:29], v12 offset:2304
  ds_read_b64_tr_b16 v[30:31], v12 offset:3328
  buffer_load_dwordx4 v[64:67], v3, s[24:27], s37 offen offset:0
  s_waitcnt vmcnt(23)
  s_waitcnt lgkmcnt(2)
  v_mfma_f32_32x32x16_bf16 v[32:47], v[24:27], v[68:71], v[32:47]
  ds_read_b64_tr_b16 v[16:17], v12 offset:4096
  ds_read_b64_tr_b16 v[18:19], v12 offset:5120
  s_waitcnt lgkmcnt(2)
  v_mfma_f32_32x32x16_bf16 v[48:63], v[28:31], v[68:71], v[48:63]
  ds_read_b64_tr_b16 v[20:21], v12 offset:4352
  ds_read_b64_tr_b16 v[22:23], v12 offset:5376
  buffer_load_dwordx4 v[68:71], v3, s[24:27], s37 offen offset:1024
  s_waitcnt vmcnt(23)
  s_waitcnt lgkmcnt(2)
  v_mfma_f32_32x32x16_bf16 v[32:47], v[16:19], v[72:75], v[32:47]
  ds_read_b64_tr_b16 v[24:25], v12 offset:6144
  ds_read_b64_tr_b16 v[26:27], v12 offset:7168
  s_waitcnt lgkmcnt(2)
  v_mfma_f32_32x32x16_bf16 v[48:63], v[20:23], v[72:75], v[48:63]
  ds_read_b64_tr_b16 v[28:29], v12 offset:6400
  ds_read_b64_tr_b16 v[30:31], v12 offset:7424
  buffer_load_dwordx4 v[72:75], v3, s[24:27], s37 offen offset:2048
  s_waitcnt vmcnt(23)
  s_waitcnt lgkmcnt(2)
  v_mfma_f32_32x32x16_bf16 v[32:47], v[24:27], v[76:79], v[32:47]
  ds_read_b64_tr_b16 v[16:17], v12 offset:8192
  ds_read_b64_tr_b16 v[18:19], v12 offset:9216
  s_waitcnt lgkmcnt(2)
  v_mfma_f32_32x32x16_bf16 v[48:63], v[28:31], v[76:79], v[48:63]
  ds_read_b64_tr_b16 v[20:21], v12 offset:8448
  ds_read_b64_tr_b16 v[22:23], v12 offset:9472
  buffer_load_dwordx4 v[76:79], v3, s[24:27], s37 offen offset:3072
  s_add_u32 s37, s37, 4096
  s_waitcnt vmcnt(23)
  s_waitcnt lgkmcnt(2)
  v_mfma_f32_32x32x16_bf16 v[32:47], v[16:19], v[80:83], v[32:47]
  ds_read_b64_tr_b16 v[24:25], v12 offset:10240
  ds_read_b64_tr_b16 v[26:27], v12 offset:11264
  s_waitcnt lgkmcnt(2)
  v_mfma_f32_32x32x16_bf16 v[48:63], v[20:23], v[80:83], v[48:63]
  ds_read_b64_tr_b16 v[28:29], v12 offset:10496
  ds_read_b64_tr_b16 v[30:31], v12 offset:11520
  buffer_load_dwordx4 v[80:83], v3, s[24:27], s37 offen offset:0
  s_waitcnt vmcnt(23)
  s_waitcnt lgkmcnt(2)
  v_mfma_f32_32x32x16_bf16 v[32:47], v[24:27], v[84:87], v[32:47]
  ds_read_b64_tr_b16 v[16:17], v12 offset:12288
  ds_read_b64_tr_b16 v[18:19], v12 offset:13312
  s_waitcnt lgkmcnt(2)
  v_mfma_f32_32x32x16_bf16 v[48:63], v[28:31], v[84:87], v[48:63]
  ds_read_b64_tr_b16 v[20:21], v12 offset:12544
  ds_read_b64_tr_b16 v[22:23], v12 offset:13568
  buffer_load_dwordx4 v[84:87], v3, s[24:27], s37 offen offset:1024
  s_waitcnt vmcnt(23)
  s_waitcnt lgkmcnt(2)
  v_mfma_f32_32x32x16_bf16 v[32:47], v[16:19], v[88:91], v[32:47]
  ds_read_b64_tr_b16 v[24:25], v12 offset:14336
  ds_read_b64_tr_b16 v[26:27], v12 offset:15360
  s_waitcnt lgkmcnt(2)
  v_mfma_f32_32x32x16_bf16 v[48:63], v[20:23], v[88:91], v[48:63]
  ds_read_b64_tr_b16 v[28:29], v12 offset:14592
  ds_read_b64_tr_b16 v[30:31], v12 offset:15616
  buffer_load_dwordx4 v[88:91], v3, s[24:27], s37 offen offset:2048
  s_barrier
  s_waitcnt vmcnt(23)
  s_waitcnt lgkmcnt(2)
  v_mfma_f32_32x32x16_bf16 v[32:47], v[24:27], v[92:95], v[32:47]
  ds_read_b64_tr_b16 v[16:17], v12 offset:16384
  ds_read_b64_tr_b16 v[18:19], v12 offset:17408
  s_waitcnt lgkmcnt(2)
  v_mfma_f32_32x32x16_bf16 v[48:63], v[28:31], v[92:95], v[48:63]
  ds_read_b64_tr_b16 v[20:21], v12 offset:16640
  ds_read_b64_tr_b16 v[22:23], v12 offset:17664
  buffer_load_dwordx4 v[92:95], v3, s[24:27], s37 offen offset:3072
  s_add_u32 s37, s37, 4096
  s_waitcnt vmcnt(23)
  s_waitcnt lgkmcnt(2)
  v_mfma_f32_32x32x16_bf16 v[32:47], v[16:19], v[96:99], v[32:47]
  ds_read_b64_tr_b16 v[24:25], v12 offset:18432
  ds_read_b64_tr_b16 v[26:27], v12 offset:19456
  s_waitcnt lgkmcnt(2)
  v_mfma_f32_32x32x16_bf16 v[48:63], v[20:23], v[96:99], v[48:63]
  ds_read_b64_tr_b16 v[28:29], v12 offset:18688
  ds_read_b64_tr_b16 v[30:31], v12 offset:19712
  buffer_load_dwordx4 v[96:99], v3, s[24:27], s37 offen offset:0
  s_waitcnt vmcnt(23)
  s_waitcnt lgkmcnt(2)
  v_mfma_f32_32x32x16_bf16 v[32:47], v[24:27], v[100:103], v[32:47]
  ds_read_b64_tr_b16 v[16:17], v12 offset:20480
  ds_read_b64_tr_b16 v[18:19], v12 offset:21504
  s_waitcnt lgkmcnt(2)
  v_mfma_f32_32x32x16_bf16 v[48:63], v[28:31], v[100:103], v[48:63]
  ds_read_b64_tr_b16 v[20:21], v12 offset:20736
  ds_read_b64_tr_b16 v[22:23], v12 offset:21760
  buffer_load_dwordx4 v[100:103], v3, s[24:27], s37 offen offset:1024
  s_waitcnt vmcnt(23)
  s_waitcnt lgkmcnt(2)
  v_mfma_f32_32x32x16_bf16 v[32:47], v[16:19], v[104:107], v[32:47]
  ds_read_b64_tr_b16 v[24:25], v12 offset:22528
  ds_read_b64_tr_b16 v[26:27], v12 offset:23552
  s_waitcnt lgkmcnt(2)
  v_mfma_f32_32x32x16_bf16 v[48:63], v[20:23], v[104:107], v[48:63]
  ds_read_b64_tr_b16 v[28:29], v12 offset:22784
  ds_read_b64_tr_b16 v[30:31], v12 offset:23808
  buffer_load_dwordx4 v[104:107], v3, s[24:27], s37 offen offset:2048
  s_waitcnt vmcnt(23)
  s_waitcnt lgkmcnt(2)
  v_mfma_f32_32x32x16_bf16 v[32:47], v[24:27], v[108:111], v[32:47]
  ds_read_b64_tr_b16 v[16:17], v12 offset:24576
  ds_read_b64_tr_b16 v[18:19], v12 offset:25600
  s_waitcnt lgkmcnt(2)
  v_mfma_f32_32x32x16_bf16 v[48:63], v[28:31], v[108:111], v[48:63]
  ds_read_b64_tr_b16 v[20:21], v12 offset:24832
  ds_read_b64_tr_b16 v[22:23], v12 offset:25856
  buffer_load_dwordx4 v[108:111], v3, s[24:27], s37 offen offset:3072
  s_add_u32 s37, s37, 4096
  s_waitcnt vmcnt(23)
  s_waitcnt lgkmcnt(2)
  v_mfma_f32_32x32x16_bf16 v[32:47], v[16:19], v[112:115], v[32:47]
  ds_read_b64_tr_b16 v[24:25], v12 offset:26624
  ds_read_b64_tr_b16 v[26:27], v12 offset:27648
  s_waitcnt lgkmcnt(2)
  v_mfma_f32_32x32x16_bf16 v[48:63], v[20:23], v[112:115], v[48:63]
  ds_read_b64_tr_b16 v[28:29], v12 offset:26880
  ds_read_b64_tr_b16 v[30:31], v12 offset:27904
  buffer_load_dwordx4 v[112:115], v3, s[24:27], s37 offen offset:0
  s_waitcnt vmcnt(23)
  s_waitcnt lgkmcnt(2)
  v_mfma_f32_32x32x16_bf16 v[32:47], v[24:27], v[116:119], v[32:47]
  ds_read_b64_tr_b16 v[16:17], v12 offset:28672
  ds_read_b64_tr_b16 v[18:19], v12 offset:29696
  s_waitcnt lgkmcnt(2)
  v_mfma_f32_32x32x16_bf16 v[48:63], v[28:31], v[116:119], v[48:63]
  ds_read_b64_tr_b16 v[20:21], v12 offset:28928
  ds_read_b64_tr_b16 v[22:23], v12 offset:29952
  buffer_load_dwordx4 v[116:119], v3, s[24:27], s37 offen offset:1024
  s_waitcnt vmcnt(23)
  s_waitcnt lgkmcnt(2)
  v_mfma_f32_32x32x16_bf16 v[32:47], v[16:19], v[120:123], v[32:47]
  ds_read_b64_tr_b16 v[24:25], v12 offset:30720
  ds_read_b64_tr_b16 v[26:27], v12 offset:31744
  s_waitcnt lgkmcnt(2)
  v_mfma_f32_32x32x16_bf16 v[48:63], v[20:23], v[120:123], v[48:63]
  ds_read_b64_tr_b16 v[28:29], v12 offset:30976
  ds_read_b64_tr_b16 v[30:31], v12 offset:32000
  buffer_load_dwordx4 v[120:123], v3, s[24:27], s37 offen offset:2048
  s_barrier
  s_waitcnt vmcnt(23)
  s_waitcnt lgkmcnt(2)
  v_mfma_f32_32x32x16_bf16 v[32:47], v[24:27], v[124:127], v[32:47]
  ds_read_b64_tr_b16 v[16:17], v12 offset:32768
  ds_read_b64_tr_b16 v[18:19], v12 offset:33792
  s_waitcnt lgkmcnt(2)
  v_mfma_f32_32x32x16_bf16 v[48:63], v[28:31], v[124:127], v[48:63]
  ds_read_b64_tr_b16 v[20:21], v12 offset:33024
  ds_read_b64_tr_b16 v[22:23], v12 offset:34048
  buffer_load_dwordx4 v[124:127], v3, s[24:27], s37 offen offset:3072
  s_add_u32 s37, s37, 4096
  s_waitcnt vmcnt(23)
  s_waitcnt lgkmcnt(2)
  v_mfma_f32_32x32x16_bf16 v[32:47], v[16:19], v[128:131], v[32:47]
  ds_read_b64_tr_b16 v[24:25], v12 offset:34816
  ds_read_b64_tr_b16 v[26:27], v12 offset:35840
  s_waitcnt lgkmcnt(2)
  v_mfma_f32_32x32x16_bf16 v[48:63], v[20:23], v[128:131], v[48:63]
  ds_read_b64_tr_b16 v[28:29], v12 offset:35072
  ds_read_b64_tr_b16 v[30:31], v12 offset:36096
  buffer_load_dwordx4 v[128:131], v3, s[24:27], s37 offen offset:0
  s_waitcnt vmcnt(23)
  s_waitcnt lgkmcnt(2)
  v_mfma_f32_32x32x16_bf16 v[32:47], v[24:27], v[132:135], v[32:47]
  ds_read_b64_tr_b16 v[16:17], v12 offset:36864
  ds_read_b64_tr_b16 v[18:19], v12 offset:37888
  s_waitcnt lgkmcnt(2)
  v_mfma_f32_32x32x16_bf16 v[48:63], v[28:31], v[132:135], v[48:63]
  ds_read_b64_tr_b16 v[20:21], v12 offset:37120
  ds_read_b64_tr_b16 v[22:23], v12 offset:38144
  buffer_load_dwordx4 v[132:135], v3, s[24:27], s37 offen offset:1024
  s_waitcnt vmcnt(23)
  s_waitcnt lgkmcnt(2)
  v_mfma_f32_32x32x16_bf16 v[32:47], v[16:19], v[136:139], v[32:47]
  ds_read_b64_tr_b16 v[24:25], v12 offset:38912
  ds_read_b64_tr_b16 v[26:27], v12 offset:39936
  s_waitcnt lgkmcnt(2)
  v_mfma_f32_32x32x16_bf16 v[48:63], v[20:23], v[136:139], v[48:63]
  ds_read_b64_tr_b16 v[28:29], v12 offset:39168
  ds_read_b64_tr_b16 v[30:31], v12 offset:40192
  buffer_load_dwordx4 v[136:139], v3, s[24:27], s37 offen offset:2048
  s_waitcnt vmcnt(23)
  s_waitcnt lgkmcnt(2)
  v_mfma_f32_32x32x16_bf16 v[32:47], v[24:27], v[140:143], v[32:47]
  ds_read_b64_tr_b16 v[16:17], v12 offset:40960
  ds_read_b64_tr_b16 v[18:19], v12 offset:41984
  s_waitcnt lgkmcnt(2)
  v_mfma_f32_32x32x16_bf16 v[48:63], v[28:31], v[140:143], v[48:63]
  ds_read_b64_tr_b16 v[20:21], v12 offset:41216
  ds_read_b64_tr_b16 v[22:23], v12 offset:42240
  buffer_load_dwordx4 v[140:143], v3, s[24:27], s37 offen offset:3072
  s_add_u32 s37, s37, 4096
  s_waitcnt vmcnt(23)
  s_waitcnt lgkmcnt(2)
  v_mfma_f32_32x32x16_bf16 v[32:47], v[16:19], v[144:147], v[32:47]
  ds_read_b64_tr_b16 v[24:25], v12 offset:43008
  ds_read_b64_tr_b16 v[26:27], v12 offset:44032
  s_waitcnt lgkmcnt(2)
  v_mfma_f32_32x32x16_bf16 v[48:63], v[20:23], v[144:147], v[48:63]
  ds_read_b64_tr_b16 v[28:29], v12 offset:43264
  ds_read_b64_tr_b16 v[30:31], v12 offset:44288
  buffer_load_dwordx4 v[144:147], v3, s[24:27], s37 offen offset:0
  s_waitcnt vmcnt(23)
  s_waitcnt lgkmcnt(2)
  v_mfma_f32_32x32x16_bf16 v[32:47], v[24:27], v[148:151], v[32:47]
  ds_read_b64_tr_b16 v[16:17], v12 offset:45056
  ds_read_b64_tr_b16 v[18:19], v12 offset:46080
  s_waitcnt lgkmcnt(2)
  v_mfma_f32_32x32x16_bf16 v[48:63], v[28:31], v[148:151], v[48:63]
  ds_read_b64_tr_b16 v[20:21], v12 offset:45312
  ds_read_b64_tr_b16 v[22:23], v12 offset:46336
  buffer_load_dwordx4 v[148:151], v3, s[24:27], s37 offen offset:1024
  s_waitcnt vmcnt(23)
  s_waitcnt lgkmcnt(2)
  v_mfma_f32_32x32x16_bf16 v[32:47], v[16:19], v[152:155], v[32:47]
  ds_read_b64_tr_b16 v[24:25], v12 offset:47104
  ds_read_b64_tr_b16 v[26:27], v12 offset:48128
  s_waitcnt lgkmcnt(2)
  v_mfma_f32_32x32x16_bf16 v[48:63], v[20:23], v[152:155], v[48:63]
  ds_read_b64_tr_b16 v[28:29], v12 offset:47360
  ds_read_b64_tr_b16 v[30:31], v12 offset:48384
  buffer_load_dwordx4 v[152:155], v3, s[24:27], s37 offen offset:2048
  s_barrier
  s_waitcnt vmcnt(23)
  s_waitcnt lgkmcnt(2)
  v_mfma_f32_32x32x16_bf16 v[32:47], v[24:27], v[156:159], v[32:47]
  ds_read_b64_tr_b16 v[16:17], v12 offset:49152
  ds_read_b64_tr_b16 v[18:19], v12 offset:50176
  s_waitcnt lgkmcnt(2)
  v_mfma_f32_32x32x16_bf16 v[48:63], v[28:31], v[156:159], v[48:63]
  ds_read_b64_tr_b16 v[20:21], v12 offset:49408
  ds_read_b64_tr_b16 v[22:23], v12 offset:50432
  buffer_load_dwordx4 v[156:159], v3, s[24:27], s37 offen offset:3072
  s_add_u32 s37, s37, 4096
  s_waitcnt vmcnt(23)
  s_waitcnt lgkmcnt(2)
  v_mfma_f32_32x32x16_bf16 v[32:47], v[16:19], v[64:67], v[32:47]
  ds_read_b64_tr_b16 v[24:25], v12 offset:51200
  ds_read_b64_tr_b16 v[26:27], v12 offset:52224
  s_waitcnt lgkmcnt(2)
  v_mfma_f32_32x32x16_bf16 v[48:63], v[20:23], v[64:67], v[48:63]
  ds_read_b64_tr_b16 v[28:29], v12 offset:51456
  ds_read_b64_tr_b16 v[30:31], v12 offset:52480
  buffer_load_dwordx4 v[64:67], v3, s[24:27], s37 offen offset:0
  s_waitcnt vmcnt(23)
  s_waitcnt lgkmcnt(2)
  v_mfma_f32_32x32x16_bf16 v[32:47], v[24:27], v[68:71], v[32:47]
  ds_read_b64_tr_b16 v[16:17], v12 offset:53248
  ds_read_b64_tr_b16 v[18:19], v12 offset:54272
  s_waitcnt lgkmcnt(2)
  v_mfma_f32_32x32x16_bf16 v[48:63], v[28:31], v[68:71], v[48:63]
  ds_read_b64_tr_b16 v[20:21], v12 offset:53504
  ds_read_b64_tr_b16 v[22:23], v12 offset:54528
  buffer_load_dwordx4 v[68:71], v3, s[24:27], s37 offen offset:1024
  s_waitcnt vmcnt(23)
  s_waitcnt lgkmcnt(2)
  v_mfma_f32_32x32x16_bf16 v[32:47], v[16:19], v[72:75], v[32:47]
  ds_read_b64_tr_b16 v[24:25], v12 offset:55296
  ds_read_b64_tr_b16 v[26:27], v12 offset:56320
  s_waitcnt lgkmcnt(2)
  v_mfma_f32_32x32x16_bf16 v[48:63], v[20:23], v[72:75], v[48:63]
  ds_read_b64_tr_b16 v[28:29], v12 offset:55552
  ds_read_b64_tr_b16 v[30:31], v12 offset:56576
  buffer_load_dwordx4 v[72:75], v3, s[24:27], s37 offen offset:2048
  s_waitcnt vmcnt(23)
  s_waitcnt lgkmcnt(2)
  v_mfma_f32_32x32x16_bf16 v[32:47], v[24:27], v[76:79], v[32:47]
  ds_read_b64_tr_b16 v[16:17], v12 offset:57344
  ds_read_b64_tr_b16 v[18:19], v12 offset:58368
  s_waitcnt lgkmcnt(2)
  v_mfma_f32_32x32x16_bf16 v[48:63], v[28:31], v[76:79], v[48:63]
  ds_read_b64_tr_b16 v[20:21], v12 offset:57600
  ds_read_b64_tr_b16 v[22:23], v12 offset:58624
  buffer_load_dwordx4 v[76:79], v3, s[24:27], s37 offen offset:3072
  s_add_u32 s37, s37, 4096
  s_waitcnt vmcnt(23)
  s_waitcnt lgkmcnt(2)
  v_mfma_f32_32x32x16_bf16 v[32:47], v[16:19], v[80:83], v[32:47]
  ds_read_b64_tr_b16 v[24:25], v12 offset:59392
  ds_read_b64_tr_b16 v[26:27], v12 offset:60416
  s_waitcnt lgkmcnt(2)
  v_mfma_f32_32x32x16_bf16 v[48:63], v[20:23], v[80:83], v[48:63]
  ds_read_b64_tr_b16 v[28:29], v12 offset:59648
  ds_read_b64_tr_b16 v[30:31], v12 offset:60672
  buffer_load_dwordx4 v[80:83], v3, s[24:27], s37 offen offset:0
  s_waitcnt vmcnt(23)
  s_waitcnt lgkmcnt(2)
  v_mfma_f32_32x32x16_bf16 v[32:47], v[24:27], v[84:87], v[32:47]
  ds_read_b64_tr_b16 v[16:17], v12 offset:61440
  ds_read_b64_tr_b16 v[18:19], v12 offset:62464
  s_waitcnt lgkmcnt(2)
  v_mfma_f32_32x32x16_bf16 v[48:63], v[28:31], v[84:87], v[48:63]
  ds_read_b64_tr_b16 v[20:21], v12 offset:61696
  ds_read_b64_tr_b16 v[22:23], v12 offset:62720
  buffer_load_dwordx4 v[84:87], v3, s[24:27], s37 offen offset:1024
  s_waitcnt vmcnt(23)
  s_waitcnt lgkmcnt(2)
  v_mfma_f32_32x32x16_bf16 v[32:47], v[16:19], v[88:91], v[32:47]
  ds_read_b64_tr_b16 v[24:25], v12 offset:63488
  ds_read_b64_tr_b16 v[26:27], v12 offset:64512
  s_waitcnt lgkmcnt(2)
  v_mfma_f32_32x32x16_bf16 v[48:63], v[20:23], v[88:91], v[48:63]
  ds_read_b64_tr_b16 v[28:29], v12 offset:63744
  ds_read_b64_tr_b16 v[30:31], v12 offset:64768
  buffer_load_dwordx4 v[88:91], v3, s[24:27], s37 offen offset:2048
  s_barrier
  s_waitcnt vmcnt(23)
  s_waitcnt lgkmcnt(2)
  v_mfma_f32_32x32x16_bf16 v[32:47], v[24:27], v[92:95], v[32:47]
  ds_read_b64_tr_b16 v[16:17], v13 offset:0
  ds_read_b64_tr_b16 v[18:19], v13 offset:1024
  s_waitcnt lgkmcnt(2)
  v_mfma_f32_32x32x16_bf16 v[48:63], v[28:31], v[92:95], v[48:63]
  ds_read_b64_tr_b16 v[20:21], v13 offset:256
  ds_read_b64_tr_b16 v[22:23], v13 offset:1280
  buffer_load_dwordx4 v[92:95], v3, s[24:27], s37 offen offset:3072
  s_add_u32 s37, s37, 4096
  s_waitcnt vmcnt(23)
  s_waitcnt lgkmcnt(2)
  v_mfma_f32_32x32x16_bf16 v[32:47], v[16:19], v[96:99], v[32:47]
  ds_read_b64_tr_b16 v[24:25], v13 offset:2048
  ds_read_b64_tr_b16 v[26:27], v13 offset:3072
  s_waitcnt lgkmcnt(2)
  v_mfma_f32_32x32x16_bf16 v[48:63], v[20:23], v[96:99], v[48:63]
  ds_read_b64_tr_b16 v[28:29], v13 offset:2304
  ds_read_b64_tr_b16 v[30:31], v13 offset:3328
  buffer_load_dwordx4 v[96:99], v3, s[24:27], s37 offen offset:0
  s_waitcnt vmcnt(23)
  s_waitcnt lgkmcnt(2)
  v_mfma_f32_32x32x16_bf16 v[32:47], v[24:27], v[100:103], v[32:47]
  ds_read_b64_tr_b16 v[16:17], v13 offset:4096
  ds_read_b64_tr_b16 v[18:19], v13 offset:5120
  s_waitcnt lgkmcnt(2)
  v_mfma_f32_32x32x16_bf16 v[48:63], v[28:31], v[100:103], v[48:63]
  ds_read_b64_tr_b16 v[20:21], v13 offset:4352
  ds_read_b64_tr_b16 v[22:23], v13 offset:5376
  buffer_load_dwordx4 v[100:103], v3, s[24:27], s37 offen offset:1024
  s_waitcnt vmcnt(23)
  s_waitcnt lgkmcnt(2)
  v_mfma_f32_32x32x16_bf16 v[32:47], v[16:19], v[104:107], v[32:47]
  ds_read_b64_tr_b16 v[24:25], v13 offset:6144
  ds_read_b64_tr_b16 v[26:27], v13 offset:7168
  s_waitcnt lgkmcnt(2)
  v_mfma_f32_32x32x16_bf16 v[48:63], v[20:23], v[104:107], v[48:63]
  ds_read_b64_tr_b16 v[28:29], v13 offset:6400
  ds_read_b64_tr_b16 v[30:31], v13 offset:7424
  buffer_load_dwordx4 v[104:107], v3, s[24:27], s37 offen offset:2048
  s_waitcnt vmcnt(23)
  s_waitcnt lgkmcnt(2)
  v_mfma_f32_32x32x16_bf16 v[32:47], v[24:27], v[108:111], v[32:47]
  ds_read_b64_tr_b16 v[16:17], v13 offset:8192
  ds_read_b64_tr_b16 v[18:19], v13 offset:9216
  s_waitcnt lgkmcnt(2)
  v_mfma_f32_32x32x16_bf16 v[48:63], v[28:31], v[108:111], v[48:63]
  ds_read_b64_tr_b16 v[20:21], v13 offset:8448
  ds_read_b64_tr_b16 v[22:23], v13 offset:9472
  buffer_load_dwordx4 v[108:111], v3, s[24:27], s37 offen offset:3072
  s_add_u32 s37, s37, 4096
  s_waitcnt vmcnt(23)
  s_waitcnt lgkmcnt(2)
  v_mfma_f32_32x32x16_bf16 v[32:47], v[16:19], v[112:115], v[32:47]
  ds_read_b64_tr_b16 v[24:25], v13 offset:10240
  ds_read_b64_tr_b16 v[26:27], v13 offset:11264
  s_waitcnt lgkmcnt(2)
  v_mfma_f32_32x32x16_bf16 v[48:63], v[20:23], v[112:115], v[48:63]
  ds_read_b64_tr_b16 v[28:29], v13 offset:10496
  ds_read_b64_tr_b16 v[30:31], v13 offset:11520
  buffer_load_dwordx4 v[112:115], v3, s[24:27], s37 offen offset:0
  s_waitcnt vmcnt(23)
  s_waitcnt lgkmcnt(2)
  v_mfma_f32_32x32x16_bf16 v[32:47], v[24:27], v[116:119], v[32:47]
  ds_read_b64_tr_b16 v[16:17], v13 offset:12288
  ds_read_b64_tr_b16 v[18:19], v13 offset:13312
  s_waitcnt lgkmcnt(2)
  v_mfma_f32_32x32x16_bf16 v[48:63], v[28:31], v[116:119], v[48:63]
  ds_read_b64_tr_b16 v[20:21], v13 offset:12544
  ds_read_b64_tr_b16 v[22:23], v13 offset:13568
  buffer_load_dwordx4 v[116:119], v3, s[24:27], s37 offen offset:1024
  s_waitcnt vmcnt(23)
  s_waitcnt lgkmcnt(2)
  v_mfma_f32_32x32x16_bf16 v[32:47], v[16:19], v[120:123], v[32:47]
  ds_read_b64_tr_b16 v[24:25], v13 offset:14336
  ds_read_b64_tr_b16 v[26:27], v13 offset:15360
  s_waitcnt lgkmcnt(2)
  v_mfma_f32_32x32x16_bf16 v[48:63], v[20:23], v[120:123], v[48:63]
  ds_read_b64_tr_b16 v[28:29], v13 offset:14592
  ds_read_b64_tr_b16 v[30:31], v13 offset:15616
  buffer_load_dwordx4 v[120:123], v3, s[24:27], s37 offen offset:2048
  s_barrier
  s_waitcnt vmcnt(23)
  s_waitcnt lgkmcnt(2)
  v_mfma_f32_32x32x16_bf16 v[32:47], v[24:27], v[124:127], v[32:47]
  ds_read_b64_tr_b16 v[16:17], v13 offset:16384
  ds_read_b64_tr_b16 v[18:19], v13 offset:17408
  s_waitcnt lgkmcnt(2)
  v_mfma_f32_32x32x16_bf16 v[48:63], v[28:31], v[124:127], v[48:63]
  ds_read_b64_tr_b16 v[20:21], v13 offset:16640
  ds_read_b64_tr_b16 v[22:23], v13 offset:17664
  buffer_load_dwordx4 v[124:127], v3, s[24:27], s37 offen offset:3072
  s_add_u32 s37, s37, 4096
  s_waitcnt vmcnt(23)
  s_waitcnt lgkmcnt(2)
  v_mfma_f32_32x32x16_bf16 v[32:47], v[16:19], v[128:131], v[32:47]
  ds_read_b64_tr_b16 v[24:25], v13 offset:18432
  ds_read_b64_tr_b16 v[26:27], v13 offset:19456
  s_waitcnt lgkmcnt(2)
  v_mfma_f32_32x32x16_bf16 v[48:63], v[20:23], v[128:131], v[48:63]
  ds_read_b64_tr_b16 v[28:29], v13 offset:18688
  ds_read_b64_tr_b16 v[30:31], v13 offset:19712
  s_waitcnt vmcnt(22)
  s_waitcnt lgkmcnt(2)
  v_mfma_f32_32x32x16_bf16 v[32:47], v[24:27], v[132:135], v[32:47]
  ds_read_b64_tr_b16 v[16:17], v13 offset:20480
  ds_read_b64_tr_b16 v[18:19], v13 offset:21504
  s_waitcnt lgkmcnt(2)
  v_mfma_f32_32x32x16_bf16 v[48:63], v[28:31], v[132:135], v[48:63]
  ds_read_b64_tr_b16 v[20:21], v13 offset:20736
  ds_read_b64_tr_b16 v[22:23], v13 offset:21760
  s_waitcnt vmcnt(21)
  s_waitcnt lgkmcnt(2)
  v_mfma_f32_32x32x16_bf16 v[32:47], v[16:19], v[136:139], v[32:47]
  ds_read_b64_tr_b16 v[24:25], v13 offset:22528
  ds_read_b64_tr_b16 v[26:27], v13 offset:23552
  s_waitcnt lgkmcnt(2)
  v_mfma_f32_32x32x16_bf16 v[48:63], v[20:23], v[136:139], v[48:63]
  ds_read_b64_tr_b16 v[28:29], v13 offset:22784
  ds_read_b64_tr_b16 v[30:31], v13 offset:23808
  s_waitcnt vmcnt(20)
  s_waitcnt lgkmcnt(2)
  v_mfma_f32_32x32x16_bf16 v[32:47], v[24:27], v[140:143], v[32:47]
  ds_read_b64_tr_b16 v[16:17], v13 offset:24576
  ds_read_b64_tr_b16 v[18:19], v13 offset:25600
  s_waitcnt lgkmcnt(2)
  v_mfma_f32_32x32x16_bf16 v[48:63], v[28:31], v[140:143], v[48:63]
  ds_read_b64_tr_b16 v[20:21], v13 offset:24832
  ds_read_b64_tr_b16 v[22:23], v13 offset:25856
  s_waitcnt vmcnt(19)
  s_waitcnt lgkmcnt(2)
  v_mfma_f32_32x32x16_bf16 v[32:47], v[16:19], v[144:147], v[32:47]
  ds_read_b64_tr_b16 v[24:25], v13 offset:26624
  ds_read_b64_tr_b16 v[26:27], v13 offset:27648
  s_waitcnt lgkmcnt(2)
  v_mfma_f32_32x32x16_bf16 v[48:63], v[20:23], v[144:147], v[48:63]
  ds_read_b64_tr_b16 v[28:29], v13 offset:26880
  ds_read_b64_tr_b16 v[30:31], v13 offset:27904
  s_waitcnt vmcnt(18)
  s_waitcnt lgkmcnt(2)
  v_mfma_f32_32x32x16_bf16 v[32:47], v[24:27], v[148:151], v[32:47]
  ds_read_b64_tr_b16 v[16:17], v13 offset:28672
  ds_read_b64_tr_b16 v[18:19], v13 offset:29696
  s_waitcnt lgkmcnt(2)
  v_mfma_f32_32x32x16_bf16 v[48:63], v[28:31], v[148:151], v[48:63]
  ds_read_b64_tr_b16 v[20:21], v13 offset:28928
  ds_read_b64_tr_b16 v[22:23], v13 offset:29952
  s_waitcnt vmcnt(17)
  s_waitcnt lgkmcnt(2)
  v_mfma_f32_32x32x16_bf16 v[32:47], v[16:19], v[152:155], v[32:47]
  ds_read_b64_tr_b16 v[24:25], v13 offset:30720
  ds_read_b64_tr_b16 v[26:27], v13 offset:31744
  s_waitcnt lgkmcnt(2)
  v_mfma_f32_32x32x16_bf16 v[48:63], v[20:23], v[152:155], v[48:63]
  ds_read_b64_tr_b16 v[28:29], v13 offset:30976
  ds_read_b64_tr_b16 v[30:31], v13 offset:32000
  s_barrier
  s_waitcnt vmcnt(16)
  s_waitcnt lgkmcnt(2)
  v_mfma_f32_32x32x16_bf16 v[32:47], v[24:27], v[156:159], v[32:47]
  ds_read_b64_tr_b16 v[16:17], v13 offset:32768
  ds_read_b64_tr_b16 v[18:19], v13 offset:33792
  s_waitcnt lgkmcnt(2)
  v_mfma_f32_32x32x16_bf16 v[48:63], v[28:31], v[156:159], v[48:63]
  ds_read_b64_tr_b16 v[20:21], v13 offset:33024
  ds_read_b64_tr_b16 v[22:23], v13 offset:34048
  s_waitcnt vmcnt(15)
  s_waitcnt lgkmcnt(2)
  v_mfma_f32_32x32x16_bf16 v[32:47], v[16:19], v[64:67], v[32:47]
  ds_read_b64_tr_b16 v[24:25], v13 offset:34816
  ds_read_b64_tr_b16 v[26:27], v13 offset:35840
  s_waitcnt lgkmcnt(2)
  v_mfma_f32_32x32x16_bf16 v[48:63], v[20:23], v[64:67], v[48:63]
  ds_read_b64_tr_b16 v[28:29], v13 offset:35072
  ds_read_b64_tr_b16 v[30:31], v13 offset:36096
  s_waitcnt vmcnt(14)
  s_waitcnt lgkmcnt(2)
  v_mfma_f32_32x32x16_bf16 v[32:47], v[24:27], v[68:71], v[32:47]
  ds_read_b64_tr_b16 v[16:17], v13 offset:36864
  ds_read_b64_tr_b16 v[18:19], v13 offset:37888
  s_waitcnt lgkmcnt(2)
  v_mfma_f32_32x32x16_bf16 v[48:63], v[28:31], v[68:71], v[48:63]
  ds_read_b64_tr_b16 v[20:21], v13 offset:37120
  ds_read_b64_tr_b16 v[22:23], v13 offset:38144
  s_waitcnt vmcnt(13)
  s_waitcnt lgkmcnt(2)
  v_mfma_f32_32x32x16_bf16 v[32:47], v[16:19], v[72:75], v[32:47]
  ds_read_b64_tr_b16 v[24:25], v13 offset:38912
  ds_read_b64_tr_b16 v[26:27], v13 offset:39936
  s_waitcnt lgkmcnt(2)
  v_mfma_f32_32x32x16_bf16 v[48:63], v[20:23], v[72:75], v[48:63]
  ds_read_b64_tr_b16 v[28:29], v13 offset:39168
  ds_read_b64_tr_b16 v[30:31], v13 offset:40192
  s_waitcnt vmcnt(12)
  s_waitcnt lgkmcnt(2)
  v_mfma_f32_32x32x16_bf16 v[32:47], v[24:27], v[76:79], v[32:47]
  ds_read_b64_tr_b16 v[16:17], v13 offset:40960
  ds_read_b64_tr_b16 v[18:19], v13 offset:41984
  s_waitcnt lgkmcnt(2)
  v_mfma_f32_32x32x16_bf16 v[48:63], v[28:31], v[76:79], v[48:63]
  ds_read_b64_tr_b16 v[20:21], v13 offset:41216
  ds_read_b64_tr_b16 v[22:23], v13 offset:42240
  s_waitcnt vmcnt(11)
  s_waitcnt lgkmcnt(2)
  v_mfma_f32_32x32x16_bf16 v[32:47], v[16:19], v[80:83], v[32:47]
  ds_read_b64_tr_b16 v[24:25], v13 offset:43008
  ds_read_b64_tr_b16 v[26:27], v13 offset:44032
  s_waitcnt lgkmcnt(2)
  v_mfma_f32_32x32x16_bf16 v[48:63], v[20:23], v[80:83], v[48:63]
  ds_read_b64_tr_b16 v[28:29], v13 offset:43264
  ds_read_b64_tr_b16 v[30:31], v13 offset:44288
  s_waitcnt vmcnt(10)
  s_waitcnt lgkmcnt(2)
  v_mfma_f32_32x32x16_bf16 v[32:47], v[24:27], v[84:87], v[32:47]
  ds_read_b64_tr_b16 v[16:17], v13 offset:45056
  ds_read_b64_tr_b16 v[18:19], v13 offset:46080
  s_waitcnt lgkmcnt(2)
  v_mfma_f32_32x32x16_bf16 v[48:63], v[28:31], v[84:87], v[48:63]
  ds_read_b64_tr_b16 v[20:21], v13 offset:45312
  ds_read_b64_tr_b16 v[22:23], v13 offset:46336
  s_waitcnt vmcnt(9)
  s_waitcnt lgkmcnt(2)
  v_mfma_f32_32x32x16_bf16 v[32:47], v[16:19], v[88:91], v[32:47]
  ds_read_b64_tr_b16 v[24:25], v13 offset:47104
  ds_read_b64_tr_b16 v[26:27], v13 offset:48128
  s_waitcnt lgkmcnt(2)
  v_mfma_f32_32x32x16_bf16 v[48:63], v[20:23], v[88:91], v[48:63]
  ds_read_b64_tr_b16 v[28:29], v13 offset:47360
  ds_read_b64_tr_b16 v[30:31], v13 offset:48384
  s_barrier
  s_waitcnt vmcnt(8)
  s_waitcnt lgkmcnt(2)
  v_mfma_f32_32x32x16_bf16 v[32:47], v[24:27], v[92:95], v[32:47]
  ds_read_b64_tr_b16 v[16:17], v13 offset:49152
  ds_read_b64_tr_b16 v[18:19], v13 offset:50176
  s_waitcnt lgkmcnt(2)
  v_mfma_f32_32x32x16_bf16 v[48:63], v[28:31], v[92:95], v[48:63]
  ds_read_b64_tr_b16 v[20:21], v13 offset:49408
  ds_read_b64_tr_b16 v[22:23], v13 offset:50432
  s_waitcnt vmcnt(7)
  s_waitcnt lgkmcnt(2)
  v_mfma_f32_32x32x16_bf16 v[32:47], v[16:19], v[96:99], v[32:47]
  ds_read_b64_tr_b16 v[24:25], v13 offset:51200
  ds_read_b64_tr_b16 v[26:27], v13 offset:52224
  s_waitcnt lgkmcnt(2)
  v_mfma_f32_32x32x16_bf16 v[48:63], v[20:23], v[96:99], v[48:63]
  ds_read_b64_tr_b16 v[28:29], v13 offset:51456
  ds_read_b64_tr_b16 v[30:31], v13 offset:52480
  s_waitcnt vmcnt(6)
  s_waitcnt lgkmcnt(2)
  v_mfma_f32_32x32x16_bf16 v[32:47], v[24:27], v[100:103], v[32:47]
  ds_read_b64_tr_b16 v[16:17], v13 offset:53248
  ds_read_b64_tr_b16 v[18:19], v13 offset:54272
  s_waitcnt lgkmcnt(2)
  v_mfma_f32_32x32x16_bf16 v[48:63], v[28:31], v[100:103], v[48:63]
  ds_read_b64_tr_b16 v[20:21], v13 offset:53504
  ds_read_b64_tr_b16 v[22:23], v13 offset:54528
  s_waitcnt vmcnt(5)
  s_waitcnt lgkmcnt(2)
  v_mfma_f32_32x32x16_bf16 v[32:47], v[16:19], v[104:107], v[32:47]
  ds_read_b64_tr_b16 v[24:25], v13 offset:55296
  ds_read_b64_tr_b16 v[26:27], v13 offset:56320
  s_waitcnt lgkmcnt(2)
  v_mfma_f32_32x32x16_bf16 v[48:63], v[20:23], v[104:107], v[48:63]
  ds_read_b64_tr_b16 v[28:29], v13 offset:55552
  ds_read_b64_tr_b16 v[30:31], v13 offset:56576
  s_waitcnt vmcnt(4)
  s_waitcnt lgkmcnt(2)
  v_mfma_f32_32x32x16_bf16 v[32:47], v[24:27], v[108:111], v[32:47]
  ds_read_b64_tr_b16 v[16:17], v13 offset:57344
  ds_read_b64_tr_b16 v[18:19], v13 offset:58368
  s_waitcnt lgkmcnt(2)
  v_mfma_f32_32x32x16_bf16 v[48:63], v[28:31], v[108:111], v[48:63]
  ds_read_b64_tr_b16 v[20:21], v13 offset:57600
  ds_read_b64_tr_b16 v[22:23], v13 offset:58624
  s_waitcnt vmcnt(3)
  s_waitcnt lgkmcnt(2)
  v_mfma_f32_32x32x16_bf16 v[32:47], v[16:19], v[112:115], v[32:47]
  ds_read_b64_tr_b16 v[24:25], v13 offset:59392
  ds_read_b64_tr_b16 v[26:27], v13 offset:60416
  s_waitcnt lgkmcnt(2)
  v_mfma_f32_32x32x16_bf16 v[48:63], v[20:23], v[112:115], v[48:63]
  ds_read_b64_tr_b16 v[28:29], v13 offset:59648
  ds_read_b64_tr_b16 v[30:31], v13 offset:60672
  s_waitcnt vmcnt(2)
  s_waitcnt lgkmcnt(2)
  v_mfma_f32_32x32x16_bf16 v[32:47], v[24:27], v[116:119], v[32:47]
  ds_read_b64_tr_b16 v[16:17], v13 offset:61440
  ds_read_b64_tr_b16 v[18:19], v13 offset:62464
  s_waitcnt lgkmcnt(2)
  v_mfma_f32_32x32x16_bf16 v[48:63], v[28:31], v[116:119], v[48:63]
  ds_read_b64_tr_b16 v[20:21], v13 offset:61696
  ds_read_b64_tr_b16 v[22:23], v13 offset:62720
  s_waitcnt vmcnt(1)
  s_waitcnt lgkmcnt(2)
  v_mfma_f32_32x32x16_bf16 v[32:47], v[16:19], v[120:123], v[32:47]
  ds_read_b64_tr_b16 v[24:25], v13 offset:63488
  ds_read_b64_tr_b16 v[26:27], v13 offset:64512
  s_waitcnt lgkmcnt(2)
  v_mfma_f32_32x32x16_bf16 v[48:63], v[20:23], v[120:123], v[48:63]
  ds_read_b64_tr_b16 v[28:29], v13 offset:63744
  ds_read_b64_tr_b16 v[30:31], v13 offset:64768
  s_waitcnt vmcnt(0)
  s_waitcnt lgkmcnt(2)
  v_mfma_f32_32x32x16_bf16 v[32:47], v[24:27], v[124:127], v[32:47]
  s_waitcnt lgkmcnt(0)
  v_mfma_f32_32x32x16_bf16 v[48:63], v[28:31], v[124:127], v[48:63]
  v_and_b32 v4, 31, v2
  v_lshlrev_b32 v4, 12, v4
  v_lshl_add_u32 v4, v14, 4, v4
  s_lshl_b32 s38, s36, 17
  s_lshl_b32 s39, s13, 7
  s_add_u32 s38, s38, s39
  s_add_u32 s38, s38, 2048
  s_nop 2
  v_cvt_pk_bf16_f32 v160, v32, v33
  v_cvt_pk_bf16_f32 v161, v34, v35
  v_cvt_pk_bf16_f32 v162, v36, v37
  v_cvt_pk_bf16_f32 v163, v38, v39
  s_nop 0
  v_permlane32_swap_b32 v160, v162
  v_permlane32_swap_b32 v161, v163
  buffer_store_dwordx4 v[160:163], v4, s[20:23], s38 offen offset:0
  v_cvt_pk_bf16_f32 v164, v40, v41
  v_cvt_pk_bf16_f32 v165, v42, v43
  v_cvt_pk_bf16_f32 v166, v44, v45
  v_cvt_pk_bf16_f32 v167, v46, v47
  s_nop 0
  v_permlane32_swap_b32 v164, v166
  v_permlane32_swap_b32 v165, v167
  buffer_store_dwordx4 v[164:167], v4, s[20:23], s38 offen offset:32
  v_cvt_pk_bf16_f32 v168, v48, v49
  v_cvt_pk_bf16_f32 v169, v50, v51
  v_cvt_pk_bf16_f32 v170, v52, v53
  v_cvt_pk_bf16_f32 v171, v54, v55
  s_nop 0
  v_permlane32_swap_b32 v168, v170
  v_permlane32_swap_b32 v169, v171
  buffer_store_dwordx4 v[168:171], v4, s[20:23], s38 offen offset:64
  v_cvt_pk_bf16_f32 v172, v56, v57
  v_cvt_pk_bf16_f32 v173, v58, v59
  v_cvt_pk_bf16_f32 v174, v60, v61
  v_cvt_pk_bf16_f32 v175, v62, v63
  s_nop 0
  v_permlane32_swap_b32 v172, v174
  v_permlane32_swap_b32 v173, v175
  buffer_store_dwordx4 v[172:175], v4, s[20:23], s38 offen offset:96
  s_endpgm
G2_loader:
  s_sub_u32 s36, s3, 4
  v_lshrrev_b32 v6, 5, v2
  v_bfe_u32 v7, v2, 2, 2
  v_lshl_add_u32 v6, v6, 2, v7
  v_lshlrev_b32 v6, 11, v6
  v_bfe_u32 v7, v2, 4, 1
  v_lshl_add_u32 v6, v7, 6, v6
  v_and_b32 v7, 3, v2
  v_lshl_add_u32 v6, v7, 4, v6
  v_add_u32 v8, 0, v6
  v_add_u32 v9, 15360, v6
  v_add_u32 v10, 30720, v6
  v_add_u32 v11, 46080, v6
  s_lshl_b32 s38, s36, 16
  s_lshl_b32 s39, s13, 7
  s_add_u32 s38, s38, s39
  s_lshl_b32 s41, s36, 12
  s_add_u32 m0, s41, 0
  s_nop 0
  buffer_load_dwordx4 v8, s[16:19], s38 offen offset:0 lds
  buffer_load_dwordx4 v9, s[16:19], s38 offen offset:1024 lds
  buffer_load_dwordx4 v10, s[16:19], s38 offen offset:2048 lds
  buffer_load_dwordx4 v11, s[16:19], s38 offen offset:3072 lds
  s_add_u32 s38, s38, 262144
  s_add_u32 m0, s41, 16384
  s_nop 0
  buffer_load_dwordx4 v8, s[16:19], s38 offen offset:0 lds
  buffer_load_dwordx4 v9, s[16:19], s38 offen offset:1024 lds
  buffer_load_dwordx4 v10, s[16:19], s38 offen offset:2048 lds
  buffer_load_dwordx4 v11, s[16:19], s38 offen offset:3072 lds
  s_add_u32 s38, s38, 262144
  s_add_u32 m0, s41, 32768
  s_nop 0
  buffer_load_dwordx4 v8, s[16:19], s38 offen offset:0 lds
  buffer_load_dwordx4 v9, s[16:19], s38 offen offset:1024 lds
  buffer_load_dwordx4 v10, s[16:19], s38 offen offset:2048 lds
  buffer_load_dwordx4 v11, s[16:19], s38 offen offset:3072 lds
  s_add_u32 s38, s38, 262144
  s_add_u32 m0, s41, 49152
  s_nop 0
  buffer_load_dwordx4 v8, s[16:19], s38 offen offset:0 lds
  buffer_load_dwordx4 v9, s[16:19], s38 offen offset:1024 lds
  buffer_load_dwordx4 v10, s[16:19], s38 offen offset:2048 lds
  buffer_load_dwordx4 v11, s[16:19], s38 offen offset:3072 lds
  s_add_u32 s38, s38, 262144
  s_add_u32 m0, s41, 65536
  s_nop 0
  buffer_load_dwordx4 v8, s[16:19], s38 offen offset:0 lds
  buffer_load_dwordx4 v9, s[16:19], s38 offen offset:1024 lds
  buffer_load_dwordx4 v10, s[16:19], s38 offen offset:2048 lds
  buffer_load_dwordx4 v11, s[16:19], s38 offen offset:3072 lds
  s_add_u32 s38, s38, 262144
  s_add_u32 m0, s41, 81920
  s_nop 0
  buffer_load_dwordx4 v8, s[16:19], s38 offen offset:0 lds
  buffer_load_dwordx4 v9, s[16:19], s38 offen offset:1024 lds
  buffer_load_dwordx4 v10, s[16:19], s38 offen offset:2048 lds
  buffer_load_dwordx4 v11, s[16:19], s38 offen offset:3072 lds
  s_add_u32 s38, s38, 262144
  s_add_u32 m0, s41, 98304
  s_nop 0
  buffer_load_dwordx4 v8, s[16:19], s38 offen offset:0 lds
  buffer_load_dwordx4 v9, s[16:19], s38 offen offset:1024 lds
  buffer_load_dwordx4 v10, s[16:19], s38 offen offset:2048 lds
  buffer_load_dwordx4 v11, s[16:19], s38 offen offset:3072 lds
  s_add_u32 s38, s38, 262144
  s_add_u32 m0, s41, 114688
  s_nop 0
  buffer_load_dwordx4 v8, s[16:19], s38 offen offset:0 lds
  buffer_load_dwordx4 v9, s[16:19], s38 offen offset:1024 lds
  buffer_load_dwordx4 v10, s[16:19], s38 offen offset:2048 lds
  buffer_load_dwordx4 v11, s[16:19], s38 offen offset:3072 lds
  s_add_u32 s38, s38, 262144
  s_waitcnt vmcnt(28)
  s_barrier
  s_waitcnt vmcnt(24)
  s_barrier
  s_waitcnt vmcnt(20)
  s_barrier
  s_waitcnt vmcnt(16)
  s_barrier
  s_waitcnt vmcnt(12)
  s_barrier
  s_waitcnt vmcnt(8)
  s_barrier
  s_waitcnt vmcnt(4)
  s_barrier
  s_waitcnt vmcnt(0)
  s_barrier
G2_end:
  s_endpgm
.globl post_kernel
.p2align 8
.type post_kernel,@function
post_kernel:
  s_cmp_ge_u32 s2, 128
  s_cbranch_scc1 PO_end
  s_load_dwordx2 s[4:5], s[0:1], 0
  s_load_dwordx2 s[6:7], s[0:1], 72
  s_load_dwordx2 s[8:9], s[0:1], 88
  v_lshrrev_b32 v1, 6, v0
  v_and_b32 v2, 63, v0
  s_lshl_b32 s12, s2, 2
  v_readfirstlane_b32 s3, v1
  v_and_b32 v3, 7, v2
  v_lshrrev_b32 v4, 3, v2
  s_add_u32 s12, s12, s3
  s_and_b32 s13, s12, 15
  s_bfe_u32 s14, s12, 0x30004
  s_lshr_b32 s15, s12, 7
  s_waitcnt lgkmcnt(0)
  s_mov_b32 s16, s4
  s_mov_b32 s17, s5
  s_mov_b32 s18, 4194304
  s_mov_b32 s19, 0x20000
  s_mov_b32 s20, s6
  s_mov_b32 s21, s7
  s_mov_b32 s22, 8388608
  s_mov_b32 s23, 0x20000
  s_add_u32 s24, s8, 20971520
  s_addc_u32 s25, s9, 0
  s_mov_b32 s26, 4194304
  s_mov_b32 s27, 0x20000
  s_lshl_b32 s32, s13, 18
  s_lshl_b32 s33, s15, 10
  s_add_u32 s32, s32, s33
  s_lshl_b32 s33, s14, 7
  s_add_u32 s32, s32, s33
  v_lshlrev_b32 v5, 15, v3
  v_lshl_add_u32 v5, v4, 4, v5
  buffer_load_dwordx4 v[8:11], v5, s[24:27], s32 offen
  s_add_u32 s32, s32, 4096
  buffer_load_dwordx4 v[12:15], v5, s[24:27], s32 offen
  s_add_u32 s32, s32, 4096
  buffer_load_dwordx4 v[16:19], v5, s[24:27], s32 offen
  s_add_u32 s32, s32, 4096
  buffer_load_dwordx4 v[20:23], v5, s[24:27], s32 offen
  s_add_u32 s32, s32, 4096
  buffer_load_dwordx4 v[24:27], v5, s[24:27], s32 offen
  s_add_u32 s32, s32, 4096
  buffer_load_dwordx4 v[28:31], v5, s[24:27], s32 offen
  s_add_u32 s32, s32, 4096
  buffer_load_dwordx4 v[32:35], v5, s[24:27], s32 offen
  s_add_u32 s32, s32, 4096
  buffer_load_dwordx4 v[36:39], v5, s[24:27], s32 offen
  s_add_u32 s32, s32, 4096
  s_lshl_b32 s33, s15, 9
  s_lshl_b32 s34, s14, 3
  s_add_u32 s33, s33, s34
  s_lshl_b32 s34, s33, 11
  s_lshl_b32 s35, s13, 7
  s_add_u32 s34, s34, s35
  s_lshl_b32 s36, s33, 12
  s_add_u32 s36, s36, s35
  v_lshlrev_b32 v6, 11, v4
  v_lshl_add_u32 v6, v3, 4, v6
  v_lshlrev_b32 v7, 12, v4
  v_lshl_add_u32 v7, v3, 4, v7
  buffer_load_dwordx4 v[40:43], v6, s[16:19], s34 offen
  s_add_u32 s34, s34, 131072
  buffer_load_dwordx4 v[44:47], v6, s[16:19], s34 offen
  s_add_u32 s34, s34, 131072
  buffer_load_dwordx4 v[48:51], v6, s[16:19], s34 offen
  s_add_u32 s34, s34, 131072
  buffer_load_dwordx4 v[52:55], v6, s[16:19], s34 offen
  s_add_u32 s34, s34, 131072
  buffer_load_dwordx4 v[56:59], v6, s[16:19], s34 offen
  s_add_u32 s34, s34, 131072
  buffer_load_dwordx4 v[60:63], v6, s[16:19], s34 offen
  s_add_u32 s34, s34, 131072
  buffer_load_dwordx4 v[64:67], v6, s[16:19], s34 offen
  s_add_u32 s34, s34, 131072
  buffer_load_dwordx4 v[68:71], v6, s[16:19], s34 offen
  s_add_u32 s34, s34, 131072
  s_waitcnt vmcnt(8)
  s_waitcnt vmcnt(7)
  v_lshlrev_b32 v72, 16, v8
  v_lshlrev_b32 v73, 16, v12
  v_lshlrev_b32 v74, 16, v16
  v_lshlrev_b32 v75, 16, v20
  v_lshlrev_b32 v76, 16, v24
  v_lshlrev_b32 v77, 16, v28
  v_lshlrev_b32 v78, 16, v32
  v_lshlrev_b32 v79, 16, v36
  v_lshlrev_b32 v80, 16, v40
  v_and_b32 v81, 0xffff0000, v40
  v_lshlrev_b32 v82, 16, v41
  v_and_b32 v83, 0xffff0000, v41
  v_lshlrev_b32 v84, 16, v42
  v_and_b32 v85, 0xffff0000, v42
  v_lshlrev_b32 v86, 16, v43
  v_and_b32 v87, 0xffff0000, v43
  v_pk_mul_f32 v[72:73], v[72:73], v[80:81]
  v_pk_mul_f32 v[74:75], v[74:75], v[82:83]
  v_pk_mul_f32 v[76:77], v[76:77], v[84:85]
  v_pk_mul_f32 v[78:79], v[78:79], v[86:87]
  v_cvt_pk_bf16_f32 v104, v72, v73
  v_cvt_pk_bf16_f32 v105, v74, v75
  v_cvt_pk_bf16_f32 v106, v76, v77
  v_cvt_pk_bf16_f32 v107, v78, v79
  buffer_store_dwordx4 v[104:107], v7, s[20:23], s36 offen
  s_add_u32 s36, s36, 262144
  s_waitcnt vmcnt(6)
  v_and_b32 v88, 0xffff0000, v8
  v_and_b32 v89, 0xffff0000, v12
  v_and_b32 v90, 0xffff0000, v16
  v_and_b32 v91, 0xffff0000, v20
  v_and_b32 v92, 0xffff0000, v24
  v_and_b32 v93, 0xffff0000, v28
  v_and_b32 v94, 0xffff0000, v32
  v_and_b32 v95, 0xffff0000, v36
  v_lshlrev_b32 v96, 16, v44
  v_and_b32 v97, 0xffff0000, v44
  v_lshlrev_b32 v98, 16, v45
  v_and_b32 v99, 0xffff0000, v45
  v_lshlrev_b32 v100, 16, v46
  v_and_b32 v101, 0xffff0000, v46
  v_lshlrev_b32 v102, 16, v47
  v_and_b32 v103, 0xffff0000, v47
  v_pk_mul_f32 v[88:89], v[88:89], v[96:97]
  v_pk_mul_f32 v[90:91], v[90:91], v[98:99]
  v_pk_mul_f32 v[92:93], v[92:93], v[100:101]
  v_pk_mul_f32 v[94:95], v[94:95], v[102:103]
  v_cvt_pk_bf16_f32 v108, v88, v89
  v_cvt_pk_bf16_f32 v109, v90, v91
  v_cvt_pk_bf16_f32 v110, v92, v93
  v_cvt_pk_bf16_f32 v111, v94, v95
  buffer_store_dwordx4 v[108:111], v7, s[20:23], s36 offen
  s_add_u32 s36, s36, 262144
  s_waitcnt vmcnt(5)
  v_lshlrev_b32 v72, 16, v9
  v_lshlrev_b32 v73, 16, v13
  v_lshlrev_b32 v74, 16, v17
  v_lshlrev_b32 v75, 16, v21
  v_lshlrev_b32 v76, 16, v25
  v_lshlrev_b32 v77, 16, v29
  v_lshlrev_b32 v78, 16, v33
  v_lshlrev_b32 v79, 16, v37
  v_lshlrev_b32 v80, 16, v48
  v_and_b32 v81, 0xffff0000, v48
  v_lshlrev_b32 v82, 16, v49
  v_and_b32 v83, 0xffff0000, v49
  v_lshlrev_b32 v84, 16, v50
  v_and_b32 v85, 0xffff0000, v50
  v_lshlrev_b32 v86, 16, v51
  v_and_b32 v87, 0xffff0000, v51
  v_pk_mul_f32 v[72:73], v[72:73], v[80:81]
  v_pk_mul_f32 v[74:75], v[74:75], v[82:83]
  v_pk_mul_f32 v[76:77], v[76:77], v[84:85]
  v_pk_mul_f32 v[78:79], v[78:79], v[86:87]
  v_cvt_pk_bf16_f32 v104, v72, v73
  v_cvt_pk_bf16_f32 v105, v74, v75
  v_cvt_pk_bf16_f32 v106, v76, v77
  v_cvt_pk_bf16_f32 v107, v78, v79
  buffer_store_dwordx4 v[104:107], v7, s[20:23], s36 offen
  s_add_u32 s36, s36, 262144
  s_waitcnt vmcnt(4)
  v_and_b32 v88, 0xffff0000, v9
  v_and_b32 v89, 0xffff0000, v13
  v_and_b32 v90, 0xffff0000, v17
  v_and_b32 v91, 0xffff0000, v21
  v_and_b32 v92, 0xffff0000, v25
  v_and_b32 v93, 0xffff0000, v29
  v_and_b32 v94, 0xffff0000, v33
  v_and_b32 v95, 0xffff0000, v37
  v_lshlrev_b32 v96, 16, v52
  v_and_b32 v97, 0xffff0000, v52
  v_lshlrev_b32 v98, 16, v53
  v_and_b32 v99, 0xffff0000, v53
  v_lshlrev_b32 v100, 16, v54
  v_and_b32 v101, 0xffff0000, v54
  v_lshlrev_b32 v102, 16, v55
  v_and_b32 v103, 0xffff0000, v55
  v_pk_mul_f32 v[88:89], v[88:89], v[96:97]
  v_pk_mul_f32 v[90:91], v[90:91], v[98:99]
  v_pk_mul_f32 v[92:93], v[92:93], v[100:101]
  v_pk_mul_f32 v[94:95], v[94:95], v[102:103]
  v_cvt_pk_bf16_f32 v108, v88, v89
  v_cvt_pk_bf16_f32 v109, v90, v91
  v_cvt_pk_bf16_f32 v110, v92, v93
  v_cvt_pk_bf16_f32 v111, v94, v95
  buffer_store_dwordx4 v[108:111], v7, s[20:23], s36 offen
  s_add_u32 s36, s36, 262144
  s_waitcnt vmcnt(3)
  v_lshlrev_b32 v72, 16, v10
  v_lshlrev_b32 v73, 16, v14
  v_lshlrev_b32 v74, 16, v18
  v_lshlrev_b32 v75, 16, v22
  v_lshlrev_b32 v76, 16, v26
  v_lshlrev_b32 v77, 16, v30
  v_lshlrev_b32 v78, 16, v34
  v_lshlrev_b32 v79, 16, v38
  v_lshlrev_b32 v80, 16, v56
  v_and_b32 v81, 0xffff0000, v56
  v_lshlrev_b32 v82, 16, v57
  v_and_b32 v83, 0xffff0000, v57
  v_lshlrev_b32 v84, 16, v58
  v_and_b32 v85, 0xffff0000, v58
  v_lshlrev_b32 v86, 16, v59
  v_and_b32 v87, 0xffff0000, v59
  v_pk_mul_f32 v[72:73], v[72:73], v[80:81]
  v_pk_mul_f32 v[74:75], v[74:75], v[82:83]
  v_pk_mul_f32 v[76:77], v[76:77], v[84:85]
  v_pk_mul_f32 v[78:79], v[78:79], v[86:87]
  v_cvt_pk_bf16_f32 v104, v72, v73
  v_cvt_pk_bf16_f32 v105, v74, v75
  v_cvt_pk_bf16_f32 v106, v76, v77
  v_cvt_pk_bf16_f32 v107, v78, v79
  buffer_store_dwordx4 v[104:107], v7, s[20:23], s36 offen
  s_add_u32 s36, s36, 262144
  s_waitcnt vmcnt(2)
  v_and_b32 v88, 0xffff0000, v10
  v_and_b32 v89, 0xffff0000, v14
  v_and_b32 v90, 0xffff0000, v18
  v_and_b32 v91, 0xffff0000, v22
  v_and_b32 v92, 0xffff0000, v26
  v_and_b32 v93, 0xffff0000, v30
  v_and_b32 v94, 0xffff0000, v34
  v_and_b32 v95, 0xffff0000, v38
  v_lshlrev_b32 v96, 16, v60
  v_and_b32 v97, 0xffff0000, v60
  v_lshlrev_b32 v98, 16, v61
  v_and_b32 v99, 0xffff0000, v61
  v_lshlrev_b32 v100, 16, v62
  v_and_b32 v101, 0xffff0000, v62
  v_lshlrev_b32 v102, 16, v63
  v_and_b32 v103, 0xffff0000, v63
  v_pk_mul_f32 v[88:89], v[88:89], v[96:97]
  v_pk_mul_f32 v[90:91], v[90:91], v[98:99]
  v_pk_mul_f32 v[92:93], v[92:93], v[100:101]
  v_pk_mul_f32 v[94:95], v[94:95], v[102:103]
  v_cvt_pk_bf16_f32 v108, v88, v89
  v_cvt_pk_bf16_f32 v109, v90, v91
  v_cvt_pk_bf16_f32 v110, v92, v93
  v_cvt_pk_bf16_f32 v111, v94, v95
  buffer_store_dwordx4 v[108:111], v7, s[20:23], s36 offen
  s_add_u32 s36, s36, 262144
  s_waitcnt vmcnt(1)
  v_lshlrev_b32 v72, 16, v11
  v_lshlrev_b32 v73, 16, v15
  v_lshlrev_b32 v74, 16, v19
  v_lshlrev_b32 v75, 16, v23
  v_lshlrev_b32 v76, 16, v27
  v_lshlrev_b32 v77, 16, v31
  v_lshlrev_b32 v78, 16, v35
  v_lshlrev_b32 v79, 16, v39
  v_lshlrev_b32 v80, 16, v64
  v_and_b32 v81, 0xffff0000, v64
  v_lshlrev_b32 v82, 16, v65
  v_and_b32 v83, 0xffff0000, v65
  v_lshlrev_b32 v84, 16, v66
  v_and_b32 v85, 0xffff0000, v66
  v_lshlrev_b32 v86, 16, v67
  v_and_b32 v87, 0xffff0000, v67
  v_pk_mul_f32 v[72:73], v[72:73], v[80:81]
  v_pk_mul_f32 v[74:75], v[74:75], v[82:83]
  v_pk_mul_f32 v[76:77], v[76:77], v[84:85]
  v_pk_mul_f32 v[78:79], v[78:79], v[86:87]
  v_cvt_pk_bf16_f32 v104, v72, v73
  v_cvt_pk_bf16_f32 v105, v74, v75
  v_cvt_pk_bf16_f32 v106, v76, v77
  v_cvt_pk_bf16_f32 v107, v78, v79
  buffer_store_dwordx4 v[104:107], v7, s[20:23], s36 offen
  s_add_u32 s36, s36, 262144
  s_waitcnt vmcnt(0)
  v_and_b32 v88, 0xffff0000, v11
  v_and_b32 v89, 0xffff0000, v15
  v_and_b32 v90, 0xffff0000, v19
  v_and_b32 v91, 0xffff0000, v23
  v_and_b32 v92, 0xffff0000, v27
  v_and_b32 v93, 0xffff0000, v31
  v_and_b32 v94, 0xffff0000, v35
  v_and_b32 v95, 0xffff0000, v39
  v_lshlrev_b32 v96, 16, v68
  v_and_b32 v97, 0xffff0000, v68
  v_lshlrev_b32 v98, 16, v69
  v_and_b32 v99, 0xffff0000, v69
  v_lshlrev_b32 v100, 16, v70
  v_and_b32 v101, 0xffff0000, v70
  v_lshlrev_b32 v102, 16, v71
  v_and_b32 v103, 0xffff0000, v71
  v_pk_mul_f32 v[88:89], v[88:89], v[96:97]
  v_pk_mul_f32 v[90:91], v[90:91], v[98:99]
  v_pk_mul_f32 v[92:93], v[92:93], v[100:101]
  v_pk_mul_f32 v[94:95], v[94:95], v[102:103]
  v_cvt_pk_bf16_f32 v108, v88, v89
  v_cvt_pk_bf16_f32 v109, v90, v91
  v_cvt_pk_bf16_f32 v110, v92, v93
  v_cvt_pk_bf16_f32 v111, v94, v95
  buffer_store_dwordx4 v[108:111], v7, s[20:23], s36 offen
  s_add_u32 s36, s36, 262144
PO_end:
  s_endpgm
.section .rodata,"a"
.p2align 6
.amdhsa_kernel pre_kernel
  .amdhsa_next_free_vgpr 208
  .amdhsa_next_free_sgpr 96
  .amdhsa_accum_offset 208
  .amdhsa_group_segment_fixed_size 0
  .amdhsa_kernarg_size 96
  .amdhsa_user_sgpr_count 2
  .amdhsa_user_sgpr_kernarg_segment_ptr 1
  .amdhsa_system_sgpr_workgroup_id_x 1
.end_amdhsa_kernel
.p2align 6
.amdhsa_kernel g1_kernel
  .amdhsa_next_free_vgpr 208
  .amdhsa_next_free_sgpr 96
  .amdhsa_accum_offset 208
  .amdhsa_group_segment_fixed_size 0
  .amdhsa_kernarg_size 96
  .amdhsa_user_sgpr_count 2
  .amdhsa_user_sgpr_kernarg_segment_ptr 1
  .amdhsa_system_sgpr_workgroup_id_x 1
.end_amdhsa_kernel
.p2align 6
.amdhsa_kernel conv_kernel
  .amdhsa_next_free_vgpr 256
  .amdhsa_next_free_sgpr 96
  .amdhsa_accum_offset 256
  .amdhsa_group_segment_fixed_size 0
  .amdhsa_kernarg_size 96
  .amdhsa_user_sgpr_count 2
  .amdhsa_user_sgpr_kernarg_segment_ptr 1
  .amdhsa_system_sgpr_workgroup_id_x 1
.end_amdhsa_kernel
.p2align 6
.amdhsa_kernel opass_kernel
  .amdhsa_next_free_vgpr 256
  .amdhsa_next_free_sgpr 96
  .amdhsa_accum_offset 256
  .amdhsa_group_segment_fixed_size 0
  .amdhsa_kernarg_size 96
  .amdhsa_user_sgpr_count 2
  .amdhsa_user_sgpr_kernarg_segment_ptr 1
  .amdhsa_system_sgpr_workgroup_id_x 1
.end_amdhsa_kernel
.p2align 6
.amdhsa_kernel g2_kernel
  .amdhsa_next_free_vgpr 176
  .amdhsa_next_free_sgpr 96
  .amdhsa_accum_offset 176
  .amdhsa_group_segment_fixed_size 0
  .amdhsa_kernarg_size 96
  .amdhsa_user_sgpr_count 2
  .amdhsa_user_sgpr_kernarg_segment_ptr 1
  .amdhsa_system_sgpr_workgroup_id_x 1
.end_amdhsa_kernel
.p2align 6
.amdhsa_kernel post_kernel
  .amdhsa_next_free_vgpr 112
  .amdhsa_next_free_sgpr 96
  .amdhsa_accum_offset 112
  .amdhsa_group_segment_fixed_size 0
  .amdhsa_kernarg_size 96
  .amdhsa_user_sgpr_count 2
  .amdhsa_user_sgpr_kernarg_segment_ptr 1
  .amdhsa_system_sgpr_workgroup_id_x 1
.end_amdhsa_kernel
```

```asm
; @launch kernel=k1_kernel grid=(256,1,1) block=(512,1,1) lds=163840
; @launch kernel=k2_kernel grid=(256,1,1) block=(512,1,1) lds=153856
.amdgcn_target "amdgcn-amd-amdhsa--gfx950"
.text
.globl k1_kernel
.p2align 8
.type k1_kernel,@function
k1_kernel:
  s_cmp_ge_u32 s2, 256
  s_cbranch_scc1 K1_end
  s_load_dwordx4 s[4:7], s[0:1], 48
  s_load_dwordx2 s[8:9], s[0:1], 88
  s_load_dwordx8 s[76:83], s[0:1], 0
  s_load_dwordx2 s[84:85], s[0:1], 32
  s_load_dwordx2 s[86:87], s[0:1], 64
  v_lshrrev_b32 v1, 6, v0
  v_and_b32 v2, 63, v0
  s_and_b32 s10, s2, 7
  v_readfirstlane_b32 s3, v1
  s_lshr_b32 s11, s2, 3
  s_and_b32 s12, s10, 1
  s_lshl_b32 s12, s12, 3
  s_and_b32 s13, s11, 7
  s_add_u32 s12, s12, s13
  s_lshr_b32 s13, s10, 1
  s_lshl_b32 s13, s13, 2
  s_lshr_b32 s14, s11, 3
  s_add_u32 s13, s13, s14
  s_cmp_ge_u32 s3, 4
  s_cbranch_scc1 K1_loader
  s_and_b32 s36, s3, 1
  s_lshr_b32 s37, s3, 1
  s_waitcnt lgkmcnt(0)
  s_cmp_lg_u32 s3, 0
  s_cbranch_scc1 K1_pfw
  s_mov_b32 s40, s4
  s_mov_b32 s41, s5
  s_mov_b32 s42, 4194304
  s_mov_b32 s43, 0x20000
  v_lshrrev_b32 v192, 3, v2
  v_lshlrev_b32 v192, 11, v192
  v_and_b32 v15, 7, v2
  v_lshl_add_u32 v192, v15, 7, v192
  s_lshl_b32 s45, s2, 14
  s_add_u32 s44, s45, 1024
  s_branch K1_pfd
K1_pfw:
  s_mov_b32 s40, s6
  s_mov_b32 s41, s7
  s_mov_b32 s42, 6291456
  s_mov_b32 s43, 0x20000
  s_cmp_eq_u32 s3, 3
  s_cbranch_scc1 K1_pfs
  v_lshlrev_b32 v192, 7, v2
  s_mul_i32 s45, s2, 12288
  s_sub_u32 s44, s3, 1
  s_lshl_b32 s44, s44, 12
  s_add_u32 s45, s45, s44
  s_add_u32 s44, s45, 3145728
  s_branch K1_pfd
K1_pfs:
  v_lshlrev_b32 v192, 11, v2
  s_mul_i32 s45, s11, 60
  s_add_u32 s45, s45, 1152
  s_lshl_b32 s45, s45, 11
  s_lshr_b32 s44, s10, 1
  s_lshl_b32 s44, s44, 9
  s_add_u32 s45, s45, s44
  s_add_u32 s45, s45, 384
  s_bitcmp1_b32 s10, 1
  s_cselect_b32 s45, 8388608, s45
  s_mov_b32 s44, 8388608
K1_pfd:
  buffer_load_dword v195, v192, s[40:43], s45 offen
  s_cmp_ge_u32 s3, 2
  s_cselect_b32 s48, s80, s78
  s_cselect_b32 s49, s81, s79
  s_mov_b32 s50, 4194304
  s_mov_b32 s51, 0x20000
  v_lshrrev_b32 v193, 2, v2
  v_lshlrev_b32 v193, 11, v193
  v_and_b32 v15, 3, v2
  v_lshl_add_u32 v193, v15, 7, v193
  s_lshr_b32 s45, s2, 2
  s_lshl_b32 s45, s45, 16
  s_lshl_b32 s46, s36, 15
  s_add_u32 s45, s45, s46
  s_and_b32 s46, s2, 3
  s_lshl_b32 s46, s46, 9
  s_add_u32 s45, s45, s46
  s_cmp_lg_u32 s3, 0
  s_cbranch_scc1 K1_e3_1
  s_mov_b32 s56, s84
  s_mov_b32 s57, s85
  s_mov_b32 s58, 4194304
  s_mov_b32 s59, 0x20000
  s_lshl_b32 s46, s10, 19
  s_lshl_b32 s47, s11, 14
  s_add_u32 s46, s46, s47
  s_add_u32 s47, s46, 8192
  v_lshlrev_b32 v194, 7, v2
  s_branch K1_e3_done
K1_e3_1:
  s_cmp_lg_u32 s3, 1
  s_cbranch_scc1 K1_e3_2
  s_mov_b32 s56, s76
  s_mov_b32 s57, s77
  s_mov_b32 s58, 4194304
  s_mov_b32 s59, 0x20000
  s_lshl_b32 s46, s11, 17
  s_lshl_b32 s47, s10, 8
  s_add_u32 s46, s46, s47
  s_add_u32 s47, s46, 65536
  v_lshrrev_b32 v194, 1, v2
  v_lshlrev_b32 v194, 11, v194
  v_and_b32 v15, 1, v2
  v_lshl_add_u32 v194, v15, 7, v194
  s_branch K1_e3_done
K1_e3_2:
  s_cmp_lg_u32 s3, 2
  s_cbranch_scc1 K1_e3_3
  s_mov_b32 s56, s86
  s_mov_b32 s57, s87
  s_mov_b32 s58, 2097152
  s_mov_b32 s59, 0x20000
  s_lshl_b32 s46, s11, 16
  s_lshr_b32 s47, s10, 2
  s_lshl_b32 s47, s47, 10
  s_add_u32 s46, s46, s47
  s_add_u32 s47, s46, 16384
  v_lshrrev_b32 v194, 3, v2
  v_lshlrev_b32 v194, 11, v194
  v_and_b32 v15, 7, v2
  v_lshl_add_u32 v194, v15, 7, v194
  s_branch K1_e3_done
K1_e3_3:
  s_mov_b32 s56, s86
  s_mov_b32 s57, s87
  s_mov_b32 s58, 2097152
  s_mov_b32 s59, 0x20000
  s_lshl_b32 s46, s11, 16
  s_lshr_b32 s47, s10, 2
  s_lshl_b32 s47, s47, 10
  s_add_u32 s46, s46, s47
  s_add_u32 s46, s46, 32768
  s_add_u32 s47, s46, 16384
  v_lshrrev_b32 v194, 3, v2
  v_lshlrev_b32 v194, 11, v194
  v_and_b32 v15, 7, v2
  v_lshl_add_u32 v194, v15, 7, v194
K1_e3_done:
  s_and_b32 s55, s11, 3
  s_add_u32 s55, s55, 0
  s_and_b32 s52, s11, 0
  s_add_u32 s52, s52, 4
  s_and_b32 s53, s11, 7
  s_add_u32 s53, s53, 5
  s_sub_u32 s53, s53, s52
  s_sub_u32 s53, s53, 1
  s_sub_u32 s52, s52, s55
  s_sub_u32 s52, s52, 1
  s_mov_b32 s54, 0
  s_mov_b32 s45, 16777216
  v_and_b32 v3, 15, v2
  v_lshrrev_b32 v14, 4, v2
  s_lshl_b32 s38, s36, 6
  v_add_u32 v15, s38, v3
  v_lshrrev_b32 v16, 1, v3
  v_lshlrev_b32 v15, 7, v15
  v_xor_b32 v17, v14, v16
  v_lshl_add_u32 v4, v17, 4, v15
  v_xor_b32 v5, 64, v4
  v_add_u32 v6, 81920, v4
  v_add_u32 v7, 81920, v5
  v_bfe_u32 v17, v2, 2, 2
  v_and_b32 v18, 3, v2
  v_lshlrev_b32 v17, 6, v17
  v_lshl_add_u32 v17, v18, 3, v17
  v_and_b32 v18, 1, v14
  v_lshl_add_u32 v17, v18, 10, v17
  v_lshl_add_u32 v17, v18, 5, v17
  v_lshrrev_b32 v18, 1, v14
  v_mul_u32_u24 v18, 6144, v18
  v_add_u32 v17, v17, v18
  s_lshl_b32 s38, s37, 8
  s_add_u32 s38, s38, 16384
  v_add_u32 v8, s38, v17
  v_xor_b32 v9, 32, v8
  v_add_u32 v10, 81920, v8
  v_add_u32 v11, 81920, v9
  v_mov_b32 v96, 0
  v_mov_b32 v97, 0
  v_mov_b32 v98, 0
  v_mov_b32 v99, 0
  v_mov_b32 v100, 0
  v_mov_b32 v101, 0
  v_mov_b32 v102, 0
  v_mov_b32 v103, 0
  v_mov_b32 v104, 0
  v_mov_b32 v105, 0
  v_mov_b32 v106, 0
  v_mov_b32 v107, 0
  v_mov_b32 v108, 0
  v_mov_b32 v109, 0
  v_mov_b32 v110, 0
  v_mov_b32 v111, 0
  v_mov_b32 v112, 0
  v_mov_b32 v113, 0
  v_mov_b32 v114, 0
  v_mov_b32 v115, 0
  v_mov_b32 v116, 0
  v_mov_b32 v117, 0
  v_mov_b32 v118, 0
  v_mov_b32 v119, 0
  v_mov_b32 v120, 0
  v_mov_b32 v121, 0
  v_mov_b32 v122, 0
  v_mov_b32 v123, 0
  v_mov_b32 v124, 0
  v_mov_b32 v125, 0
  v_mov_b32 v126, 0
  v_mov_b32 v127, 0
  v_mov_b32 v128, 0
  v_mov_b32 v129, 0
  v_mov_b32 v130, 0
  v_mov_b32 v131, 0
  v_mov_b32 v132, 0
  v_mov_b32 v133, 0
  v_mov_b32 v134, 0
  v_mov_b32 v135, 0
  v_mov_b32 v136, 0
  v_mov_b32 v137, 0
  v_mov_b32 v138, 0
  v_mov_b32 v139, 0
  v_mov_b32 v140, 0
  v_mov_b32 v141, 0
  v_mov_b32 v142, 0
  v_mov_b32 v143, 0
  v_mov_b32 v144, 0
  v_mov_b32 v145, 0
  v_mov_b32 v146, 0
  v_mov_b32 v147, 0
  v_mov_b32 v148, 0
  v_mov_b32 v149, 0
  v_mov_b32 v150, 0
  v_mov_b32 v151, 0
  v_mov_b32 v152, 0
  v_mov_b32 v153, 0
  v_mov_b32 v154, 0
  v_mov_b32 v155, 0
  v_mov_b32 v156, 0
  v_mov_b32 v157, 0
  v_mov_b32 v158, 0
  v_mov_b32 v159, 0
  v_mov_b32 v160, 0
  v_mov_b32 v161, 0
  v_mov_b32 v162, 0
  v_mov_b32 v163, 0
  v_mov_b32 v164, 0
  v_mov_b32 v165, 0
  v_mov_b32 v166, 0
  v_mov_b32 v167, 0
  v_mov_b32 v168, 0
  v_mov_b32 v169, 0
  v_mov_b32 v170, 0
  v_mov_b32 v171, 0
  v_mov_b32 v172, 0
  v_mov_b32 v173, 0
  v_mov_b32 v174, 0
  v_mov_b32 v175, 0
  v_mov_b32 v176, 0
  v_mov_b32 v177, 0
  v_mov_b32 v178, 0
  v_mov_b32 v179, 0
  v_mov_b32 v180, 0
  v_mov_b32 v181, 0
  v_mov_b32 v182, 0
  v_mov_b32 v183, 0
  v_mov_b32 v184, 0
  v_mov_b32 v185, 0
  v_mov_b32 v186, 0
  v_mov_b32 v187, 0
  v_mov_b32 v188, 0
  v_mov_b32 v189, 0
  v_mov_b32 v190, 0
  v_mov_b32 v191, 0
  s_add_u32 s24, s8, 0
  s_addc_u32 s25, s9, 0
  s_mov_b32 s26, 4194304
  s_mov_b32 s27, 0x20000
  s_add_u32 s28, s8, 8388608
  s_addc_u32 s29, s9, 0
  s_mov_b32 s30, 2097152
  s_mov_b32 s31, 0x20000
  s_add_u32 s32, s8, 12582912
  s_addc_u32 s33, s9, 0
  s_mov_b32 s34, 65536
  s_mov_b32 s35, 0x20000
  s_barrier
  ds_read_b128 v[16:19], v4 offset:0
  ds_read_b64_tr_b16 v[32:33], v8 offset:0
  ds_read_b64_tr_b16 v[34:35], v8 offset:512
  ds_read_b128 v[20:23], v4 offset:2048
  ds_read_b128 v[24:27], v4 offset:4096
  ds_read_b128 v[28:31], v4 offset:6144
  ds_read_b64_tr_b16 v[36:37], v9 offset:0
  ds_read_b64_tr_b16 v[38:39], v9 offset:512
  ds_read_b64_tr_b16 v[40:41], v8 offset:2048
  ds_read_b64_tr_b16 v[42:43], v8 offset:2560
  ds_read_b64_tr_b16 v[44:45], v9 offset:2048
  ds_read_b64_tr_b16 v[46:47], v9 offset:2560
  ds_read_b64_tr_b16 v[48:49], v8 offset:4096
  ds_read_b64_tr_b16 v[50:51], v8 offset:4608
  ds_read_b64_tr_b16 v[52:53], v9 offset:4096
  ds_read_b64_tr_b16 v[54:55], v9 offset:4608
  s_waitcnt lgkmcnt(0)
  s_mov_b32 s39, 4
K1_loop:
  v_mfma_f32_16x16x32_bf16 v[96:99], v[32:35], v[16:19], v[96:99]
  ds_read_b128 v[56:59], v5 offset:0
  v_mfma_f32_16x16x32_bf16 v[104:107], v[32:35], v[20:23], v[104:107]
  ds_read_b64_tr_b16 v[72:73], v8 offset:12288
  v_mfma_f32_16x16x32_bf16 v[112:115], v[32:35], v[24:27], v[112:115]
  ds_read_b64_tr_b16 v[74:75], v8 offset:12800
  v_mfma_f32_16x16x32_bf16 v[120:123], v[32:35], v[28:31], v[120:123]
  ds_read_b128 v[60:63], v5 offset:2048
  v_mfma_f32_16x16x32_bf16 v[100:103], v[36:39], v[16:19], v[100:103]
  ds_read_b128 v[64:67], v5 offset:4096
  v_mfma_f32_16x16x32_bf16 v[108:111], v[36:39], v[20:23], v[108:111]
  ds_read_b128 v[68:71], v5 offset:6144
  v_mfma_f32_16x16x32_bf16 v[116:119], v[36:39], v[24:27], v[116:119]
  ds_read_b64_tr_b16 v[76:77], v9 offset:12288
  v_mfma_f32_16x16x32_bf16 v[124:127], v[36:39], v[28:31], v[124:127]
  ds_read_b64_tr_b16 v[78:79], v9 offset:12800
  v_mfma_f32_16x16x32_bf16 v[128:131], v[16:19], v[40:43], v[128:131]
  ds_read_b64_tr_b16 v[80:81], v8 offset:14336
  v_mfma_f32_16x16x32_bf16 v[136:139], v[20:23], v[40:43], v[136:139]
  ds_read_b64_tr_b16 v[82:83], v8 offset:14848
  v_mfma_f32_16x16x32_bf16 v[144:147], v[24:27], v[40:43], v[144:147]
  ds_read_b64_tr_b16 v[84:85], v9 offset:14336
  v_mfma_f32_16x16x32_bf16 v[152:155], v[28:31], v[40:43], v[152:155]
  ds_read_b64_tr_b16 v[86:87], v9 offset:14848
  v_mfma_f32_16x16x32_bf16 v[132:135], v[16:19], v[44:47], v[132:135]
  ds_read_b64_tr_b16 v[88:89], v8 offset:16384
  v_mfma_f32_16x16x32_bf16 v[140:143], v[20:23], v[44:47], v[140:143]
  ds_read_b64_tr_b16 v[90:91], v8 offset:16896
  v_mfma_f32_16x16x32_bf16 v[148:151], v[24:27], v[44:47], v[148:151]
  ds_read_b64_tr_b16 v[92:93], v9 offset:16384
  v_mfma_f32_16x16x32_bf16 v[156:159], v[28:31], v[44:47], v[156:159]
  ds_read_b64_tr_b16 v[94:95], v9 offset:16896
  v_mfma_f32_16x16x32_bf16 v[160:163], v[16:19], v[48:51], v[160:163]
  v_mfma_f32_16x16x32_bf16 v[168:171], v[20:23], v[48:51], v[168:171]
  v_mfma_f32_16x16x32_bf16 v[176:179], v[24:27], v[48:51], v[176:179]
  v_mfma_f32_16x16x32_bf16 v[184:187], v[28:31], v[48:51], v[184:187]
  v_mfma_f32_16x16x32_bf16 v[164:167], v[16:19], v[52:55], v[164:167]
  v_mfma_f32_16x16x32_bf16 v[172:175], v[20:23], v[52:55], v[172:175]
  v_mfma_f32_16x16x32_bf16 v[180:183], v[24:27], v[52:55], v[180:183]
  v_mfma_f32_16x16x32_bf16 v[188:191], v[28:31], v[52:55], v[188:191]
  s_waitcnt lgkmcnt(0)
  s_barrier
  s_sub_u32 s55, s55, 1
  s_cbranch_scc1 K1_event0
K1_noev0:
  v_mfma_f32_16x16x32_bf16 v[96:99], v[72:75], v[56:59], v[96:99]
  ds_read_b128 v[16:19], v4 offset:40960
  v_mfma_f32_16x16x32_bf16 v[104:107], v[72:75], v[60:63], v[104:107]
  ds_read_b64_tr_b16 v[32:33], v8 offset:40960
  v_mfma_f32_16x16x32_bf16 v[112:115], v[72:75], v[64:67], v[112:115]
  ds_read_b64_tr_b16 v[34:35], v8 offset:41472
  v_mfma_f32_16x16x32_bf16 v[120:123], v[72:75], v[68:71], v[120:123]
  ds_read_b128 v[20:23], v4 offset:43008
  v_mfma_f32_16x16x32_bf16 v[100:103], v[76:79], v[56:59], v[100:103]
  ds_read_b128 v[24:27], v4 offset:45056
  v_mfma_f32_16x16x32_bf16 v[108:111], v[76:79], v[60:63], v[108:111]
  ds_read_b128 v[28:31], v4 offset:47104
  v_mfma_f32_16x16x32_bf16 v[116:119], v[76:79], v[64:67], v[116:119]
  ds_read_b64_tr_b16 v[36:37], v9 offset:40960
  v_mfma_f32_16x16x32_bf16 v[124:127], v[76:79], v[68:71], v[124:127]
  ds_read_b64_tr_b16 v[38:39], v9 offset:41472
  v_mfma_f32_16x16x32_bf16 v[128:131], v[56:59], v[80:83], v[128:131]
  ds_read_b64_tr_b16 v[40:41], v8 offset:43008
  v_mfma_f32_16x16x32_bf16 v[136:139], v[60:63], v[80:83], v[136:139]
  ds_read_b64_tr_b16 v[42:43], v8 offset:43520
  v_mfma_f32_16x16x32_bf16 v[144:147], v[64:67], v[80:83], v[144:147]
  ds_read_b64_tr_b16 v[44:45], v9 offset:43008
  v_mfma_f32_16x16x32_bf16 v[152:155], v[68:71], v[80:83], v[152:155]
  ds_read_b64_tr_b16 v[46:47], v9 offset:43520
  v_mfma_f32_16x16x32_bf16 v[132:135], v[56:59], v[84:87], v[132:135]
  ds_read_b64_tr_b16 v[48:49], v8 offset:45056
  v_mfma_f32_16x16x32_bf16 v[140:143], v[60:63], v[84:87], v[140:143]
  ds_read_b64_tr_b16 v[50:51], v8 offset:45568
  v_mfma_f32_16x16x32_bf16 v[148:151], v[64:67], v[84:87], v[148:151]
  ds_read_b64_tr_b16 v[52:53], v9 offset:45056
  v_mfma_f32_16x16x32_bf16 v[156:159], v[68:71], v[84:87], v[156:159]
  ds_read_b64_tr_b16 v[54:55], v9 offset:45568
  v_mfma_f32_16x16x32_bf16 v[160:163], v[56:59], v[88:91], v[160:163]
  v_mfma_f32_16x16x32_bf16 v[168:171], v[60:63], v[88:91], v[168:171]
  v_mfma_f32_16x16x32_bf16 v[176:179], v[64:67], v[88:91], v[176:179]
  v_mfma_f32_16x16x32_bf16 v[184:187], v[68:71], v[88:91], v[184:187]
  v_mfma_f32_16x16x32_bf16 v[164:167], v[56:59], v[92:95], v[164:167]
  v_mfma_f32_16x16x32_bf16 v[172:175], v[60:63], v[92:95], v[172:175]
  v_mfma_f32_16x16x32_bf16 v[180:183], v[64:67], v[92:95], v[180:183]
  v_mfma_f32_16x16x32_bf16 v[188:191], v[68:71], v[92:95], v[188:191]
  s_waitcnt lgkmcnt(13)
  v_mfma_f32_16x16x32_bf16 v[96:99], v[32:35], v[16:19], v[96:99]
  ds_read_b128 v[56:59], v5 offset:40960
  s_waitcnt lgkmcnt(13)
  v_mfma_f32_16x16x32_bf16 v[104:107], v[32:35], v[20:23], v[104:107]
  ds_read_b64_tr_b16 v[72:73], v8 offset:53248
  s_waitcnt lgkmcnt(13)
  v_mfma_f32_16x16x32_bf16 v[112:115], v[32:35], v[24:27], v[112:115]
  ds_read_b64_tr_b16 v[74:75], v8 offset:53760
  s_waitcnt lgkmcnt(13)
  v_mfma_f32_16x16x32_bf16 v[120:123], v[32:35], v[28:31], v[120:123]
  ds_read_b128 v[60:63], v5 offset:43008
  s_waitcnt lgkmcnt(12)
  v_mfma_f32_16x16x32_bf16 v[100:103], v[36:39], v[16:19], v[100:103]
  ds_read_b128 v[64:67], v5 offset:45056
  v_mfma_f32_16x16x32_bf16 v[108:111], v[36:39], v[20:23], v[108:111]
  ds_read_b128 v[68:71], v5 offset:47104
  v_mfma_f32_16x16x32_bf16 v[116:119], v[36:39], v[24:27], v[116:119]
  ds_read_b64_tr_b16 v[76:77], v9 offset:53248
  v_mfma_f32_16x16x32_bf16 v[124:127], v[36:39], v[28:31], v[124:127]
  ds_read_b64_tr_b16 v[78:79], v9 offset:53760
  s_waitcnt lgkmcnt(14)
  v_mfma_f32_16x16x32_bf16 v[128:131], v[16:19], v[40:43], v[128:131]
  ds_read_b64_tr_b16 v[80:81], v8 offset:55296
  v_mfma_f32_16x16x32_bf16 v[136:139], v[20:23], v[40:43], v[136:139]
  ds_read_b64_tr_b16 v[82:83], v8 offset:55808
  v_mfma_f32_16x16x32_bf16 v[144:147], v[24:27], v[40:43], v[144:147]
  ds_read_b64_tr_b16 v[84:85], v9 offset:55296
  v_mfma_f32_16x16x32_bf16 v[152:155], v[28:31], v[40:43], v[152:155]
  ds_read_b64_tr_b16 v[86:87], v9 offset:55808
  s_waitcnt lgkmcnt(15)
  v_mfma_f32_16x16x32_bf16 v[132:135], v[16:19], v[44:47], v[132:135]
  ds_read_b64_tr_b16 v[88:89], v8 offset:57344
  v_mfma_f32_16x16x32_bf16 v[140:143], v[20:23], v[44:47], v[140:143]
  ds_read_b64_tr_b16 v[90:91], v8 offset:57856
  v_mfma_f32_16x16x32_bf16 v[148:151], v[24:27], v[44:47], v[148:151]
  ds_read_b64_tr_b16 v[92:93], v9 offset:57344
  v_mfma_f32_16x16x32_bf16 v[156:159], v[28:31], v[44:47], v[156:159]
  ds_read_b64_tr_b16 v[94:95], v9 offset:57856
  s_waitcnt lgkmcnt(15)
  v_mfma_f32_16x16x32_bf16 v[160:163], v[16:19], v[48:51], v[160:163]
  v_mfma_f32_16x16x32_bf16 v[168:171], v[20:23], v[48:51], v[168:171]
  v_mfma_f32_16x16x32_bf16 v[176:179], v[24:27], v[48:51], v[176:179]
  v_mfma_f32_16x16x32_bf16 v[184:187], v[28:31], v[48:51], v[184:187]
  v_mfma_f32_16x16x32_bf16 v[164:167], v[16:19], v[52:55], v[164:167]
  v_mfma_f32_16x16x32_bf16 v[172:175], v[20:23], v[52:55], v[172:175]
  v_mfma_f32_16x16x32_bf16 v[180:183], v[24:27], v[52:55], v[180:183]
  v_mfma_f32_16x16x32_bf16 v[188:191], v[28:31], v[52:55], v[188:191]
  s_waitcnt lgkmcnt(0)
  s_barrier
  s_sub_u32 s55, s55, 1
  s_cbranch_scc1 K1_event1
K1_noev1:
  v_mfma_f32_16x16x32_bf16 v[96:99], v[72:75], v[56:59], v[96:99]
  ds_read_b128 v[16:19], v6 offset:0
  v_mfma_f32_16x16x32_bf16 v[104:107], v[72:75], v[60:63], v[104:107]
  ds_read_b64_tr_b16 v[32:33], v10 offset:0
  v_mfma_f32_16x16x32_bf16 v[112:115], v[72:75], v[64:67], v[112:115]
  ds_read_b64_tr_b16 v[34:35], v10 offset:512
  v_mfma_f32_16x16x32_bf16 v[120:123], v[72:75], v[68:71], v[120:123]
  ds_read_b128 v[20:23], v6 offset:2048
  v_mfma_f32_16x16x32_bf16 v[100:103], v[76:79], v[56:59], v[100:103]
  ds_read_b128 v[24:27], v6 offset:4096
  v_mfma_f32_16x16x32_bf16 v[108:111], v[76:79], v[60:63], v[108:111]
  ds_read_b128 v[28:31], v6 offset:6144
  v_mfma_f32_16x16x32_bf16 v[116:119], v[76:79], v[64:67], v[116:119]
  ds_read_b64_tr_b16 v[36:37], v11 offset:0
  v_mfma_f32_16x16x32_bf16 v[124:127], v[76:79], v[68:71], v[124:127]
  ds_read_b64_tr_b16 v[38:39], v11 offset:512
  v_mfma_f32_16x16x32_bf16 v[128:131], v[56:59], v[80:83], v[128:131]
  ds_read_b64_tr_b16 v[40:41], v10 offset:2048
  v_mfma_f32_16x16x32_bf16 v[136:139], v[60:63], v[80:83], v[136:139]
  ds_read_b64_tr_b16 v[42:43], v10 offset:2560
  v_mfma_f32_16x16x32_bf16 v[144:147], v[64:67], v[80:83], v[144:147]
  ds_read_b64_tr_b16 v[44:45], v11 offset:2048
  v_mfma_f32_16x16x32_bf16 v[152:155], v[68:71], v[80:83], v[152:155]
  ds_read_b64_tr_b16 v[46:47], v11 offset:2560
  v_mfma_f32_16x16x32_bf16 v[132:135], v[56:59], v[84:87], v[132:135]
  ds_read_b64_tr_b16 v[48:49], v10 offset:4096
  v_mfma_f32_16x16x32_bf16 v[140:143], v[60:63], v[84:87], v[140:143]
  ds_read_b64_tr_b16 v[50:51], v10 offset:4608
  v_mfma_f32_16x16x32_bf16 v[148:151], v[64:67], v[84:87], v[148:151]
  ds_read_b64_tr_b16 v[52:53], v11 offset:4096
  v_mfma_f32_16x16x32_bf16 v[156:159], v[68:71], v[84:87], v[156:159]
  ds_read_b64_tr_b16 v[54:55], v11 offset:4608
  v_mfma_f32_16x16x32_bf16 v[160:163], v[56:59], v[88:91], v[160:163]
  v_mfma_f32_16x16x32_bf16 v[168:171], v[60:63], v[88:91], v[168:171]
  v_mfma_f32_16x16x32_bf16 v[176:179], v[64:67], v[88:91], v[176:179]
  v_mfma_f32_16x16x32_bf16 v[184:187], v[68:71], v[88:91], v[184:187]
  v_mfma_f32_16x16x32_bf16 v[164:167], v[56:59], v[92:95], v[164:167]
  v_mfma_f32_16x16x32_bf16 v[172:175], v[60:63], v[92:95], v[172:175]
  v_mfma_f32_16x16x32_bf16 v[180:183], v[64:67], v[92:95], v[180:183]
  v_mfma_f32_16x16x32_bf16 v[188:191], v[68:71], v[92:95], v[188:191]
  s_waitcnt lgkmcnt(13)
  v_mfma_f32_16x16x32_bf16 v[96:99], v[32:35], v[16:19], v[96:99]
  ds_read_b128 v[56:59], v7 offset:0
  s_waitcnt lgkmcnt(13)
  v_mfma_f32_16x16x32_bf16 v[104:107], v[32:35], v[20:23], v[104:107]
  ds_read_b64_tr_b16 v[72:73], v10 offset:12288
  s_waitcnt lgkmcnt(13)
  v_mfma_f32_16x16x32_bf16 v[112:115], v[32:35], v[24:27], v[112:115]
  ds_read_b64_tr_b16 v[74:75], v10 offset:12800
  s_waitcnt lgkmcnt(13)
  v_mfma_f32_16x16x32_bf16 v[120:123], v[32:35], v[28:31], v[120:123]
  ds_read_b128 v[60:63], v7 offset:2048
  s_waitcnt lgkmcnt(12)
  v_mfma_f32_16x16x32_bf16 v[100:103], v[36:39], v[16:19], v[100:103]
  ds_read_b128 v[64:67], v7 offset:4096
  v_mfma_f32_16x16x32_bf16 v[108:111], v[36:39], v[20:23], v[108:111]
  ds_read_b128 v[68:71], v7 offset:6144
  v_mfma_f32_16x16x32_bf16 v[116:119], v[36:39], v[24:27], v[116:119]
  ds_read_b64_tr_b16 v[76:77], v11 offset:12288
  v_mfma_f32_16x16x32_bf16 v[124:127], v[36:39], v[28:31], v[124:127]
  ds_read_b64_tr_b16 v[78:79], v11 offset:12800
  s_waitcnt lgkmcnt(14)
  v_mfma_f32_16x16x32_bf16 v[128:131], v[16:19], v[40:43], v[128:131]
  ds_read_b64_tr_b16 v[80:81], v10 offset:14336
  v_mfma_f32_16x16x32_bf16 v[136:139], v[20:23], v[40:43], v[136:139]
  ds_read_b64_tr_b16 v[82:83], v10 offset:14848
  v_mfma_f32_16x16x32_bf16 v[144:147], v[24:27], v[40:43], v[144:147]
  ds_read_b64_tr_b16 v[84:85], v11 offset:14336
  v_mfma_f32_16x16x32_bf16 v[152:155], v[28:31], v[40:43], v[152:155]
  ds_read_b64_tr_b16 v[86:87], v11 offset:14848
  s_waitcnt lgkmcnt(15)
  v_mfma_f32_16x16x32_bf16 v[132:135], v[16:19], v[44:47], v[132:135]
  ds_read_b64_tr_b16 v[88:89], v10 offset:16384
  v_mfma_f32_16x16x32_bf16 v[140:143], v[20:23], v[44:47], v[140:143]
  ds_read_b64_tr_b16 v[90:91], v10 offset:16896
  v_mfma_f32_16x16x32_bf16 v[148:151], v[24:27], v[44:47], v[148:151]
  ds_read_b64_tr_b16 v[92:93], v11 offset:16384
  v_mfma_f32_16x16x32_bf16 v[156:159], v[28:31], v[44:47], v[156:159]
  ds_read_b64_tr_b16 v[94:95], v11 offset:16896
  s_waitcnt lgkmcnt(15)
  v_mfma_f32_16x16x32_bf16 v[160:163], v[16:19], v[48:51], v[160:163]
  v_mfma_f32_16x16x32_bf16 v[168:171], v[20:23], v[48:51], v[168:171]
  v_mfma_f32_16x16x32_bf16 v[176:179], v[24:27], v[48:51], v[176:179]
  v_mfma_f32_16x16x32_bf16 v[184:187], v[28:31], v[48:51], v[184:187]
  v_mfma_f32_16x16x32_bf16 v[164:167], v[16:19], v[52:55], v[164:167]
  v_mfma_f32_16x16x32_bf16 v[172:175], v[20:23], v[52:55], v[172:175]
  v_mfma_f32_16x16x32_bf16 v[180:183], v[24:27], v[52:55], v[180:183]
  v_mfma_f32_16x16x32_bf16 v[188:191], v[28:31], v[52:55], v[188:191]
  s_waitcnt lgkmcnt(0)
  s_barrier
  s_sub_u32 s55, s55, 1
  s_cbranch_scc1 K1_event2
K1_noev2:
  v_mfma_f32_16x16x32_bf16 v[96:99], v[72:75], v[56:59], v[96:99]
  ds_read_b128 v[16:19], v6 offset:40960
  v_mfma_f32_16x16x32_bf16 v[104:107], v[72:75], v[60:63], v[104:107]
  ds_read_b64_tr_b16 v[32:33], v10 offset:40960
  v_mfma_f32_16x16x32_bf16 v[112:115], v[72:75], v[64:67], v[112:115]
  ds_read_b64_tr_b16 v[34:35], v10 offset:41472
  v_mfma_f32_16x16x32_bf16 v[120:123], v[72:75], v[68:71], v[120:123]
  ds_read_b128 v[20:23], v6 offset:43008
  v_mfma_f32_16x16x32_bf16 v[100:103], v[76:79], v[56:59], v[100:103]
  ds_read_b128 v[24:27], v6 offset:45056
  v_mfma_f32_16x16x32_bf16 v[108:111], v[76:79], v[60:63], v[108:111]
  ds_read_b128 v[28:31], v6 offset:47104
  v_mfma_f32_16x16x32_bf16 v[116:119], v[76:79], v[64:67], v[116:119]
  ds_read_b64_tr_b16 v[36:37], v11 offset:40960
  v_mfma_f32_16x16x32_bf16 v[124:127], v[76:79], v[68:71], v[124:127]
  ds_read_b64_tr_b16 v[38:39], v11 offset:41472
  v_mfma_f32_16x16x32_bf16 v[128:131], v[56:59], v[80:83], v[128:131]
  ds_read_b64_tr_b16 v[40:41], v10 offset:43008
  v_mfma_f32_16x16x32_bf16 v[136:139], v[60:63], v[80:83], v[136:139]
  ds_read_b64_tr_b16 v[42:43], v10 offset:43520
  v_mfma_f32_16x16x32_bf16 v[144:147], v[64:67], v[80:83], v[144:147]
  ds_read_b64_tr_b16 v[44:45], v11 offset:43008
  v_mfma_f32_16x16x32_bf16 v[152:155], v[68:71], v[80:83], v[152:155]
  ds_read_b64_tr_b16 v[46:47], v11 offset:43520
  v_mfma_f32_16x16x32_bf16 v[132:135], v[56:59], v[84:87], v[132:135]
  ds_read_b64_tr_b16 v[48:49], v10 offset:45056
  v_mfma_f32_16x16x32_bf16 v[140:143], v[60:63], v[84:87], v[140:143]
  ds_read_b64_tr_b16 v[50:51], v10 offset:45568
  v_mfma_f32_16x16x32_bf16 v[148:151], v[64:67], v[84:87], v[148:151]
  ds_read_b64_tr_b16 v[52:53], v11 offset:45056
  v_mfma_f32_16x16x32_bf16 v[156:159], v[68:71], v[84:87], v[156:159]
  ds_read_b64_tr_b16 v[54:55], v11 offset:45568
  v_mfma_f32_16x16x32_bf16 v[160:163], v[56:59], v[88:91], v[160:163]
  v_mfma_f32_16x16x32_bf16 v[168:171], v[60:63], v[88:91], v[168:171]
  v_mfma_f32_16x16x32_bf16 v[176:179], v[64:67], v[88:91], v[176:179]
  v_mfma_f32_16x16x32_bf16 v[184:187], v[68:71], v[88:91], v[184:187]
  v_mfma_f32_16x16x32_bf16 v[164:167], v[56:59], v[92:95], v[164:167]
  v_mfma_f32_16x16x32_bf16 v[172:175], v[60:63], v[92:95], v[172:175]
  v_mfma_f32_16x16x32_bf16 v[180:183], v[64:67], v[92:95], v[180:183]
  v_mfma_f32_16x16x32_bf16 v[188:191], v[68:71], v[92:95], v[188:191]
  s_waitcnt lgkmcnt(13)
  v_mfma_f32_16x16x32_bf16 v[96:99], v[32:35], v[16:19], v[96:99]
  ds_read_b128 v[56:59], v7 offset:40960
  s_waitcnt lgkmcnt(13)
  v_mfma_f32_16x16x32_bf16 v[104:107], v[32:35], v[20:23], v[104:107]
  ds_read_b64_tr_b16 v[72:73], v10 offset:53248
  s_waitcnt lgkmcnt(13)
  v_mfma_f32_16x16x32_bf16 v[112:115], v[32:35], v[24:27], v[112:115]
  ds_read_b64_tr_b16 v[74:75], v10 offset:53760
  s_waitcnt lgkmcnt(13)
  v_mfma_f32_16x16x32_bf16 v[120:123], v[32:35], v[28:31], v[120:123]
  ds_read_b128 v[60:63], v7 offset:43008
  s_waitcnt lgkmcnt(12)
  v_mfma_f32_16x16x32_bf16 v[100:103], v[36:39], v[16:19], v[100:103]
  ds_read_b128 v[64:67], v7 offset:45056
  v_mfma_f32_16x16x32_bf16 v[108:111], v[36:39], v[20:23], v[108:111]
  ds_read_b128 v[68:71], v7 offset:47104
  v_mfma_f32_16x16x32_bf16 v[116:119], v[36:39], v[24:27], v[116:119]
  ds_read_b64_tr_b16 v[76:77], v11 offset:53248
  v_mfma_f32_16x16x32_bf16 v[124:127], v[36:39], v[28:31], v[124:127]
  ds_read_b64_tr_b16 v[78:79], v11 offset:53760
  s_waitcnt lgkmcnt(14)
  v_mfma_f32_16x16x32_bf16 v[128:131], v[16:19], v[40:43], v[128:131]
  ds_read_b64_tr_b16 v[80:81], v10 offset:55296
  v_mfma_f32_16x16x32_bf16 v[136:139], v[20:23], v[40:43], v[136:139]
  ds_read_b64_tr_b16 v[82:83], v10 offset:55808
  v_mfma_f32_16x16x32_bf16 v[144:147], v[24:27], v[40:43], v[144:147]
  ds_read_b64_tr_b16 v[84:85], v11 offset:55296
  v_mfma_f32_16x16x32_bf16 v[152:155], v[28:31], v[40:43], v[152:155]
  ds_read_b64_tr_b16 v[86:87], v11 offset:55808
  s_waitcnt lgkmcnt(15)
  v_mfma_f32_16x16x32_bf16 v[132:135], v[16:19], v[44:47], v[132:135]
  ds_read_b64_tr_b16 v[88:89], v10 offset:57344
  v_mfma_f32_16x16x32_bf16 v[140:143], v[20:23], v[44:47], v[140:143]
  ds_read_b64_tr_b16 v[90:91], v10 offset:57856
  v_mfma_f32_16x16x32_bf16 v[148:151], v[24:27], v[44:47], v[148:151]
  ds_read_b64_tr_b16 v[92:93], v11 offset:57344
  v_mfma_f32_16x16x32_bf16 v[156:159], v[28:31], v[44:47], v[156:159]
  ds_read_b64_tr_b16 v[94:95], v11 offset:57856
  s_waitcnt lgkmcnt(15)
  v_mfma_f32_16x16x32_bf16 v[160:163], v[16:19], v[48:51], v[160:163]
  v_mfma_f32_16x16x32_bf16 v[168:171], v[20:23], v[48:51], v[168:171]
  v_mfma_f32_16x16x32_bf16 v[176:179], v[24:27], v[48:51], v[176:179]
  v_mfma_f32_16x16x32_bf16 v[184:187], v[28:31], v[48:51], v[184:187]
  v_mfma_f32_16x16x32_bf16 v[164:167], v[16:19], v[52:55], v[164:167]
  v_mfma_f32_16x16x32_bf16 v[172:175], v[20:23], v[52:55], v[172:175]
  v_mfma_f32_16x16x32_bf16 v[180:183], v[24:27], v[52:55], v[180:183]
  v_mfma_f32_16x16x32_bf16 v[188:191], v[28:31], v[52:55], v[188:191]
  s_waitcnt lgkmcnt(0)
  s_barrier
  s_sub_u32 s55, s55, 1
  s_cbranch_scc1 K1_event3
K1_noev3:
  v_mfma_f32_16x16x32_bf16 v[96:99], v[72:75], v[56:59], v[96:99]
  ds_read_b128 v[16:19], v4 offset:0
  v_mfma_f32_16x16x32_bf16 v[104:107], v[72:75], v[60:63], v[104:107]
  ds_read_b64_tr_b16 v[32:33], v8 offset:0
  v_mfma_f32_16x16x32_bf16 v[112:115], v[72:75], v[64:67], v[112:115]
  ds_read_b64_tr_b16 v[34:35], v8 offset:512
  v_mfma_f32_16x16x32_bf16 v[120:123], v[72:75], v[68:71], v[120:123]
  ds_read_b128 v[20:23], v4 offset:2048
  v_mfma_f32_16x16x32_bf16 v[100:103], v[76:79], v[56:59], v[100:103]
  ds_read_b128 v[24:27], v4 offset:4096
  v_mfma_f32_16x16x32_bf16 v[108:111], v[76:79], v[60:63], v[108:111]
  ds_read_b128 v[28:31], v4 offset:6144
  v_mfma_f32_16x16x32_bf16 v[116:119], v[76:79], v[64:67], v[116:119]
  ds_read_b64_tr_b16 v[36:37], v9 offset:0
  v_mfma_f32_16x16x32_bf16 v[124:127], v[76:79], v[68:71], v[124:127]
  ds_read_b64_tr_b16 v[38:39], v9 offset:512
  v_mfma_f32_16x16x32_bf16 v[128:131], v[56:59], v[80:83], v[128:131]
  ds_read_b64_tr_b16 v[40:41], v8 offset:2048
  v_mfma_f32_16x16x32_bf16 v[136:139], v[60:63], v[80:83], v[136:139]
  ds_read_b64_tr_b16 v[42:43], v8 offset:2560
  v_mfma_f32_16x16x32_bf16 v[144:147], v[64:67], v[80:83], v[144:147]
  ds_read_b64_tr_b16 v[44:45], v9 offset:2048
  v_mfma_f32_16x16x32_bf16 v[152:155], v[68:71], v[80:83], v[152:155]
  ds_read_b64_tr_b16 v[46:47], v9 offset:2560
  v_mfma_f32_16x16x32_bf16 v[132:135], v[56:59], v[84:87], v[132:135]
  ds_read_b64_tr_b16 v[48:49], v8 offset:4096
  v_mfma_f32_16x16x32_bf16 v[140:143], v[60:63], v[84:87], v[140:143]
  ds_read_b64_tr_b16 v[50:51], v8 offset:4608
  v_mfma_f32_16x16x32_bf16 v[148:151], v[64:67], v[84:87], v[148:151]
  ds_read_b64_tr_b16 v[52:53], v9 offset:4096
  v_mfma_f32_16x16x32_bf16 v[156:159], v[68:71], v[84:87], v[156:159]
  ds_read_b64_tr_b16 v[54:55], v9 offset:4608
  v_mfma_f32_16x16x32_bf16 v[160:163], v[56:59], v[88:91], v[160:163]
  v_mfma_f32_16x16x32_bf16 v[168:171], v[60:63], v[88:91], v[168:171]
  v_mfma_f32_16x16x32_bf16 v[176:179], v[64:67], v[88:91], v[176:179]
  v_mfma_f32_16x16x32_bf16 v[184:187], v[68:71], v[88:91], v[184:187]
  v_mfma_f32_16x16x32_bf16 v[164:167], v[56:59], v[92:95], v[164:167]
  v_mfma_f32_16x16x32_bf16 v[172:175], v[60:63], v[92:95], v[172:175]
  v_mfma_f32_16x16x32_bf16 v[180:183], v[64:67], v[92:95], v[180:183]
  v_mfma_f32_16x16x32_bf16 v[188:191], v[68:71], v[92:95], v[188:191]
  s_sub_u32 s39, s39, 1
  s_cmp_lg_u32 s39, 0
  s_waitcnt lgkmcnt(0)
  s_cbranch_scc1 K1_loop
  s_lshl_b32 s40, s13, 1
  s_add_u32 s40, s40, s37
  s_lshl_b32 s41, s12, 3
  s_lshl_b32 s42, s36, 2
  s_add_u32 s41, s41, s42
  s_lshl_b32 s42, s41, 5
  s_add_u32 s42, s42, s40
  s_lshl_b32 s42, s42, 10
  v_lshlrev_b32 v3, 4, v2
  s_mov_b32 s44, 1069066811
  s_mov_b32 s45, 1069066811
  s_mov_b32 s46, 897988541
  s_mov_b32 s47, 897988541
  v_cvt_pk_bf16_f32 v16, v160, v161
  v_cvt_pk_bf16_f32 v17, v162, v163
  v_cvt_pk_bf16_f32 v18, v168, v169
  v_cvt_pk_bf16_f32 v19, v170, v171
  v_cvt_pk_bf16_f32 v20, v176, v177
  v_cvt_pk_bf16_f32 v21, v178, v179
  v_cvt_pk_bf16_f32 v22, v184, v185
  v_cvt_pk_bf16_f32 v23, v186, v187
  v_cvt_pk_bf16_f32 v24, v164, v165
  v_cvt_pk_bf16_f32 v25, v166, v167
  v_cvt_pk_bf16_f32 v26, v172, v173
  v_cvt_pk_bf16_f32 v27, v174, v175
  v_cvt_pk_bf16_f32 v28, v180, v181
  v_cvt_pk_bf16_f32 v29, v182, v183
  v_cvt_pk_bf16_f32 v30, v188, v189
  v_cvt_pk_bf16_f32 v31, v190, v191
  v_mov_b32 v48, 0x3f803f80
  v_mov_b32 v49, 0x3f803f80
  v_mov_b32 v50, 0x3f803f80
  v_mov_b32 v51, 0x3f803f80
  v_cvt_pk_bf16_f32 v52, v128, v129
  v_cvt_pk_bf16_f32 v53, v130, v131
  v_cvt_pk_bf16_f32 v54, v136, v137
  v_cvt_pk_bf16_f32 v55, v138, v139
  v_lshlrev_b32 v56, 16, v52
  v_and_b32 v57, 0xffff0000, v52
  v_lshlrev_b32 v58, 16, v53
  v_and_b32 v59, 0xffff0000, v53
  v_lshlrev_b32 v60, 16, v54
  v_and_b32 v61, 0xffff0000, v54
  v_lshlrev_b32 v62, 16, v55
  v_and_b32 v63, 0xffff0000, v55
  v_min_f32 v64, 0, v56
  v_min_f32 v65, 0, v57
  v_min_f32 v66, 0, v58
  v_min_f32 v67, 0, v59
  v_min_f32 v68, 0, v60
  v_min_f32 v69, 0, v61
  v_min_f32 v70, 0, v62
  v_min_f32 v71, 0, v63
  v_pk_mul_f32 v[72:73], v[64:65], s[44:45]
  v_pk_mul_f32 v[74:75], v[66:67], s[44:45]
  v_pk_mul_f32 v[76:77], v[68:69], s[44:45]
  v_pk_mul_f32 v[78:79], v[70:71], s[44:45]
  v_exp_f32 v72, v72
  v_exp_f32 v73, v73
  v_exp_f32 v74, v74
  v_exp_f32 v75, v75
  v_exp_f32 v76, v76
  v_exp_f32 v77, v77
  v_exp_f32 v78, v78
  v_exp_f32 v79, v79
  v_pk_add_f32 v[56:57], v[56:57], v[64:65] neg_lo:[0,1] neg_hi:[0,1]
  v_pk_add_f32 v[58:59], v[58:59], v[66:67] neg_lo:[0,1] neg_hi:[0,1]
  v_pk_add_f32 v[60:61], v[60:61], v[68:69] neg_lo:[0,1] neg_hi:[0,1]
  v_pk_add_f32 v[62:63], v[62:63], v[70:71] neg_lo:[0,1] neg_hi:[0,1]
  v_pk_add_f32 v[56:57], v[56:57], v[72:73]
  v_pk_add_f32 v[58:59], v[58:59], v[74:75]
  v_pk_add_f32 v[60:61], v[60:61], v[76:77]
  v_pk_add_f32 v[62:63], v[62:63], v[78:79]
  v_pk_add_f32 v[56:57], v[56:57], s[46:47]
  v_pk_add_f32 v[58:59], v[58:59], s[46:47]
  v_pk_add_f32 v[60:61], v[60:61], s[46:47]
  v_pk_add_f32 v[62:63], v[62:63], s[46:47]
  v_cvt_pk_bf16_f32 v32, v56, v57
  v_cvt_pk_bf16_f32 v33, v58, v59
  v_cvt_pk_bf16_f32 v34, v60, v61
  v_cvt_pk_bf16_f32 v35, v62, v63
  s_nop 1
  v_mfma_f32_16x16x32_bf16 v[160:163], v[32:35], v[16:19], 0
  v_mfma_f32_16x16x32_bf16 v[168:171], v[32:35], v[24:27], 0
  v_mfma_f32_16x16x32_bf16 v[176:179], v[32:35], v[48:51], 0
  v_cvt_pk_bf16_f32 v52, v132, v133
  v_cvt_pk_bf16_f32 v53, v134, v135
  v_cvt_pk_bf16_f32 v54, v140, v141
  v_cvt_pk_bf16_f32 v55, v142, v143
  v_lshlrev_b32 v56, 16, v52
  v_and_b32 v57, 0xffff0000, v52
  v_lshlrev_b32 v58, 16, v53
  v_and_b32 v59, 0xffff0000, v53
  v_lshlrev_b32 v60, 16, v54
  v_and_b32 v61, 0xffff0000, v54
  v_lshlrev_b32 v62, 16, v55
  v_and_b32 v63, 0xffff0000, v55
  v_min_f32 v64, 0, v56
  v_min_f32 v65, 0, v57
  v_min_f32 v66, 0, v58
  v_min_f32 v67, 0, v59
  v_min_f32 v68, 0, v60
  v_min_f32 v69, 0, v61
  v_min_f32 v70, 0, v62
  v_min_f32 v71, 0, v63
  v_pk_mul_f32 v[72:73], v[64:65], s[44:45]
  v_pk_mul_f32 v[74:75], v[66:67], s[44:45]
  v_pk_mul_f32 v[76:77], v[68:69], s[44:45]
  v_pk_mul_f32 v[78:79], v[70:71], s[44:45]
  v_exp_f32 v72, v72
  v_exp_f32 v73, v73
  v_exp_f32 v74, v74
  v_exp_f32 v75, v75
  v_exp_f32 v76, v76
  v_exp_f32 v77, v77
  v_exp_f32 v78, v78
  v_exp_f32 v79, v79
  v_pk_add_f32 v[56:57], v[56:57], v[64:65] neg_lo:[0,1] neg_hi:[0,1]
  v_pk_add_f32 v[58:59], v[58:59], v[66:67] neg_lo:[0,1] neg_hi:[0,1]
  v_pk_add_f32 v[60:61], v[60:61], v[68:69] neg_lo:[0,1] neg_hi:[0,1]
  v_pk_add_f32 v[62:63], v[62:63], v[70:71] neg_lo:[0,1] neg_hi:[0,1]
  v_pk_add_f32 v[56:57], v[56:57], v[72:73]
  v_pk_add_f32 v[58:59], v[58:59], v[74:75]
  v_pk_add_f32 v[60:61], v[60:61], v[76:77]
  v_pk_add_f32 v[62:63], v[62:63], v[78:79]
  v_pk_add_f32 v[56:57], v[56:57], s[46:47]
  v_pk_add_f32 v[58:59], v[58:59], s[46:47]
  v_pk_add_f32 v[60:61], v[60:61], s[46:47]
  v_pk_add_f32 v[62:63], v[62:63], s[46:47]
  v_cvt_pk_bf16_f32 v40, v56, v57
  v_cvt_pk_bf16_f32 v41, v58, v59
  v_cvt_pk_bf16_f32 v42, v60, v61
  v_cvt_pk_bf16_f32 v43, v62, v63
  s_nop 1
  v_mfma_f32_16x16x32_bf16 v[164:167], v[40:43], v[16:19], 0
  v_mfma_f32_16x16x32_bf16 v[172:175], v[40:43], v[24:27], 0
  v_mfma_f32_16x16x32_bf16 v[180:183], v[40:43], v[48:51], 0
  v_cvt_pk_bf16_f32 v52, v144, v145
  v_cvt_pk_bf16_f32 v53, v146, v147
  v_cvt_pk_bf16_f32 v54, v152, v153
  v_cvt_pk_bf16_f32 v55, v154, v155
  v_lshlrev_b32 v56, 16, v52
  v_and_b32 v57, 0xffff0000, v52
  v_lshlrev_b32 v58, 16, v53
  v_and_b32 v59, 0xffff0000, v53
  v_lshlrev_b32 v60, 16, v54
  v_and_b32 v61, 0xffff0000, v54
  v_lshlrev_b32 v62, 16, v55
  v_and_b32 v63, 0xffff0000, v55
  v_min_f32 v64, 0, v56
  v_min_f32 v65, 0, v57
  v_min_f32 v66, 0, v58
  v_min_f32 v67, 0, v59
  v_min_f32 v68, 0, v60
  v_min_f32 v69, 0, v61
  v_min_f32 v70, 0, v62
  v_min_f32 v71, 0, v63
  v_pk_mul_f32 v[72:73], v[64:65], s[44:45]
  v_pk_mul_f32 v[74:75], v[66:67], s[44:45]
  v_pk_mul_f32 v[76:77], v[68:69], s[44:45]
  v_pk_mul_f32 v[78:79], v[70:71], s[44:45]
  v_exp_f32 v72, v72
  v_exp_f32 v73, v73
  v_exp_f32 v74, v74
  v_exp_f32 v75, v75
  v_exp_f32 v76, v76
  v_exp_f32 v77, v77
  v_exp_f32 v78, v78
  v_exp_f32 v79, v79
  v_pk_add_f32 v[56:57], v[56:57], v[64:65] neg_lo:[0,1] neg_hi:[0,1]
  v_pk_add_f32 v[58:59], v[58:59], v[66:67] neg_lo:[0,1] neg_hi:[0,1]
  v_pk_add_f32 v[60:61], v[60:61], v[68:69] neg_lo:[0,1] neg_hi:[0,1]
  v_pk_add_f32 v[62:63], v[62:63], v[70:71] neg_lo:[0,1] neg_hi:[0,1]
  v_pk_add_f32 v[56:57], v[56:57], v[72:73]
  v_pk_add_f32 v[58:59], v[58:59], v[74:75]
  v_pk_add_f32 v[60:61], v[60:61], v[76:77]
  v_pk_add_f32 v[62:63], v[62:63], v[78:79]
  v_pk_add_f32 v[56:57], v[56:57], s[46:47]
  v_pk_add_f32 v[58:59], v[58:59], s[46:47]
  v_pk_add_f32 v[60:61], v[60:61], s[46:47]
  v_pk_add_f32 v[62:63], v[62:63], s[46:47]
  v_cvt_pk_bf16_f32 v36, v56, v57
  v_cvt_pk_bf16_f32 v37, v58, v59
  v_cvt_pk_bf16_f32 v38, v60, v61
  v_cvt_pk_bf16_f32 v39, v62, v63
  s_nop 1
  v_mfma_f32_16x16x32_bf16 v[160:163], v[36:39], v[20:23], v[160:163]
  v_mfma_f32_16x16x32_bf16 v[168:171], v[36:39], v[28:31], v[168:171]
  v_mfma_f32_16x16x32_bf16 v[176:179], v[36:39], v[48:51], v[176:179]
  v_cvt_pk_bf16_f32 v52, v148, v149
  v_cvt_pk_bf16_f32 v53, v150, v151
  v_cvt_pk_bf16_f32 v54, v156, v157
  v_cvt_pk_bf16_f32 v55, v158, v159
  v_lshlrev_b32 v56, 16, v52
  v_and_b32 v57, 0xffff0000, v52
  v_lshlrev_b32 v58, 16, v53
  v_and_b32 v59, 0xffff0000, v53
  v_lshlrev_b32 v60, 16, v54
  v_and_b32 v61, 0xffff0000, v54
  v_lshlrev_b32 v62, 16, v55
  v_and_b32 v63, 0xffff0000, v55
  v_min_f32 v64, 0, v56
  v_min_f32 v65, 0, v57
  v_min_f32 v66, 0, v58
  v_min_f32 v67, 0, v59
  v_min_f32 v68, 0, v60
  v_min_f32 v69, 0, v61
  v_min_f32 v70, 0, v62
  v_min_f32 v71, 0, v63
  v_pk_mul_f32 v[72:73], v[64:65], s[44:45]
  v_pk_mul_f32 v[74:75], v[66:67], s[44:45]
  v_pk_mul_f32 v[76:77], v[68:69], s[44:45]
  v_pk_mul_f32 v[78:79], v[70:71], s[44:45]
  v_exp_f32 v72, v72
  v_exp_f32 v73, v73
  v_exp_f32 v74, v74
  v_exp_f32 v75, v75
  v_exp_f32 v76, v76
  v_exp_f32 v77, v77
  v_exp_f32 v78, v78
  v_exp_f32 v79, v79
  v_pk_add_f32 v[56:57], v[56:57], v[64:65] neg_lo:[0,1] neg_hi:[0,1]
  v_pk_add_f32 v[58:59], v[58:59], v[66:67] neg_lo:[0,1] neg_hi:[0,1]
  v_pk_add_f32 v[60:61], v[60:61], v[68:69] neg_lo:[0,1] neg_hi:[0,1]
  v_pk_add_f32 v[62:63], v[62:63], v[70:71] neg_lo:[0,1] neg_hi:[0,1]
  v_pk_add_f32 v[56:57], v[56:57], v[72:73]
  v_pk_add_f32 v[58:59], v[58:59], v[74:75]
  v_pk_add_f32 v[60:61], v[60:61], v[76:77]
  v_pk_add_f32 v[62:63], v[62:63], v[78:79]
  v_pk_add_f32 v[56:57], v[56:57], s[46:47]
  v_pk_add_f32 v[58:59], v[58:59], s[46:47]
  v_pk_add_f32 v[60:61], v[60:61], s[46:47]
  v_pk_add_f32 v[62:63], v[62:63], s[46:47]
  v_cvt_pk_bf16_f32 v44, v56, v57
  v_cvt_pk_bf16_f32 v45, v58, v59
  v_cvt_pk_bf16_f32 v46, v60, v61
  v_cvt_pk_bf16_f32 v47, v62, v63
  s_nop 1
  v_mfma_f32_16x16x32_bf16 v[164:167], v[44:47], v[20:23], v[164:167]
  v_mfma_f32_16x16x32_bf16 v[172:175], v[44:47], v[28:31], v[172:175]
  v_mfma_f32_16x16x32_bf16 v[180:183], v[44:47], v[48:51], v[180:183]
  s_lshl_b32 s43, s37, 13
  v_add_u32 v4, s43, v3
  s_cmp_eq_u32 s36, 0
  s_cbranch_scc1 K1_wr0
  ds_write_b128 v4, v[160:163] offset:0
  s_nop 0
  ds_write_b128 v4, v[164:167] offset:1024
  ds_write_b128 v4, v[168:171] offset:2048
  ds_write_b128 v4, v[172:175] offset:3072
  ds_write_b128 v4, v[176:179] offset:4096
  ds_write_b128 v4, v[180:183] offset:5120
  s_waitcnt lgkmcnt(0)
  s_barrier
  s_branch K1_q
K1_wr0:
  s_lshl_b32 s48, s40, 4
  s_add_u32 s48, s48, s12
  s_lshl_b32 s49, s48, 12
  s_lshl_b32 s50, s48, 7
  v_lshlrev_b32 v5, 4, v14
  s_barrier
  ds_read_b128 v[16:19], v4 offset:0
  ds_read_b128 v[20:23], v4 offset:1024
  ds_read_b128 v[24:27], v4 offset:2048
  ds_read_b128 v[28:31], v4 offset:3072
  ds_read_b128 v[32:35], v4 offset:4096
  ds_read_b128 v[36:39], v4 offset:5120
  s_waitcnt lgkmcnt(5)
  v_pk_add_f32 v[160:161], v[160:161], v[16:17]
  v_pk_add_f32 v[162:163], v[162:163], v[18:19]
  buffer_store_dwordx4 v[160:163], v3, s[28:31], s49 offen offset:0
  s_waitcnt lgkmcnt(4)
  v_pk_add_f32 v[164:165], v[164:165], v[20:21]
  v_pk_add_f32 v[166:167], v[166:167], v[22:23]
  buffer_store_dwordx4 v[164:167], v3, s[28:31], s49 offen offset:1024
  s_waitcnt lgkmcnt(3)
  v_pk_add_f32 v[168:169], v[168:169], v[24:25]
  v_pk_add_f32 v[170:171], v[170:171], v[26:27]
  buffer_store_dwordx4 v[168:171], v3, s[28:31], s49 offen offset:2048
  s_waitcnt lgkmcnt(2)
  v_pk_add_f32 v[172:173], v[172:173], v[28:29]
  v_pk_add_f32 v[174:175], v[174:175], v[30:31]
  buffer_store_dwordx4 v[172:175], v3, s[28:31], s49 offen offset:3072
  s_waitcnt lgkmcnt(1)
  v_pk_add_f32 v[176:177], v[176:177], v[32:33]
  v_pk_add_f32 v[178:179], v[178:179], v[34:35]
  s_waitcnt lgkmcnt(0)
  v_pk_add_f32 v[180:181], v[180:181], v[36:37]
  v_pk_add_f32 v[182:183], v[182:183], v[38:39]
  s_mov_b32 exec_lo, 0x00010001
  s_mov_b32 exec_hi, 0x00010001
  buffer_store_dwordx4 v[176:179], v5, s[32:35], s50 offen offset:0
  buffer_store_dwordx4 v[180:183], v5, s[32:35], s50 offen offset:64
  s_mov_b64 exec, -1
K1_q:
  v_cvt_pk_bf16_f32 v52, v96, v97
  v_cvt_pk_bf16_f32 v53, v98, v99
  v_cvt_pk_bf16_f32 v54, v100, v101
  v_cvt_pk_bf16_f32 v55, v102, v103
  v_lshlrev_b32 v56, 16, v52
  v_and_b32 v57, 0xffff0000, v52
  v_lshlrev_b32 v58, 16, v53
  v_and_b32 v59, 0xffff0000, v53
  v_lshlrev_b32 v60, 16, v54
  v_and_b32 v61, 0xffff0000, v54
  v_lshlrev_b32 v62, 16, v55
  v_and_b32 v63, 0xffff0000, v55
  v_min_f32 v64, 0, v56
  v_min_f32 v65, 0, v57
  v_min_f32 v66, 0, v58
  v_min_f32 v67, 0, v59
  v_min_f32 v68, 0, v60
  v_min_f32 v69, 0, v61
  v_min_f32 v70, 0, v62
  v_min_f32 v71, 0, v63
  v_pk_mul_f32 v[72:73], v[64:65], s[44:45]
  v_pk_mul_f32 v[74:75], v[66:67], s[44:45]
  v_pk_mul_f32 v[76:77], v[68:69], s[44:45]
  v_pk_mul_f32 v[78:79], v[70:71], s[44:45]
  v_exp_f32 v72, v72
  v_exp_f32 v73, v73
  v_exp_f32 v74, v74
  v_exp_f32 v75, v75
  v_exp_f32 v76, v76
  v_exp_f32 v77, v77
  v_exp_f32 v78, v78
  v_exp_f32 v79, v79
  v_pk_add_f32 v[56:57], v[56:57], v[64:65] neg_lo:[0,1] neg_hi:[0,1]
  v_pk_add_f32 v[58:59], v[58:59], v[66:67] neg_lo:[0,1] neg_hi:[0,1]
  v_pk_add_f32 v[60:61], v[60:61], v[68:69] neg_lo:[0,1] neg_hi:[0,1]
  v_pk_add_f32 v[62:63], v[62:63], v[70:71] neg_lo:[0,1] neg_hi:[0,1]
  v_pk_add_f32 v[56:57], v[56:57], v[72:73]
  v_pk_add_f32 v[58:59], v[58:59], v[74:75]
  v_pk_add_f32 v[60:61], v[60:61], v[76:77]
  v_pk_add_f32 v[62:63], v[62:63], v[78:79]
  v_pk_add_f32 v[56:57], v[56:57], s[46:47]
  v_pk_add_f32 v[58:59], v[58:59], s[46:47]
  v_pk_add_f32 v[60:61], v[60:61], s[46:47]
  v_pk_add_f32 v[62:63], v[62:63], s[46:47]
  v_cvt_pk_bf16_f32 v80, v56, v57
  v_cvt_pk_bf16_f32 v81, v58, v59
  v_cvt_pk_bf16_f32 v82, v60, v61
  v_cvt_pk_bf16_f32 v83, v62, v63
  v_and_b32 v80, -2, v80
  v_and_b32 v81, -2, v81
  v_and_b32 v82, -2, v82
  v_and_b32 v83, -2, v83
  buffer_store_dwordx4 v[80:83], v3, s[24:27], s42 offen
  s_add_u32 s42, s42, 32768
  v_cvt_pk_bf16_f32 v52, v104, v105
  v_cvt_pk_bf16_f32 v53, v106, v107
  v_cvt_pk_bf16_f32 v54, v108, v109
  v_cvt_pk_bf16_f32 v55, v110, v111
  v_lshlrev_b32 v56, 16, v52
  v_and_b32 v57, 0xffff0000, v52
  v_lshlrev_b32 v58, 16, v53
  v_and_b32 v59, 0xffff0000, v53
  v_lshlrev_b32 v60, 16, v54
  v_and_b32 v61, 0xffff0000, v54
  v_lshlrev_b32 v62, 16, v55
  v_and_b32 v63, 0xffff0000, v55
  v_min_f32 v64, 0, v56
  v_min_f32 v65, 0, v57
  v_min_f32 v66, 0, v58
  v_min_f32 v67, 0, v59
  v_min_f32 v68, 0, v60
  v_min_f32 v69, 0, v61
  v_min_f32 v70, 0, v62
  v_min_f32 v71, 0, v63
  v_pk_mul_f32 v[72:73], v[64:65], s[44:45]
  v_pk_mul_f32 v[74:75], v[66:67], s[44:45]
  v_pk_mul_f32 v[76:77], v[68:69], s[44:45]
  v_pk_mul_f32 v[78:79], v[70:71], s[44:45]
  v_exp_f32 v72, v72
  v_exp_f32 v73, v73
  v_exp_f32 v74, v74
  v_exp_f32 v75, v75
  v_exp_f32 v76, v76
  v_exp_f32 v77, v77
  v_exp_f32 v78, v78
  v_exp_f32 v79, v79
  v_pk_add_f32 v[56:57], v[56:57], v[64:65] neg_lo:[0,1] neg_hi:[0,1]
  v_pk_add_f32 v[58:59], v[58:59], v[66:67] neg_lo:[0,1] neg_hi:[0,1]
  v_pk_add_f32 v[60:61], v[60:61], v[68:69] neg_lo:[0,1] neg_hi:[0,1]
  v_pk_add_f32 v[62:63], v[62:63], v[70:71] neg_lo:[0,1] neg_hi:[0,1]
  v_pk_add_f32 v[56:57], v[56:57], v[72:73]
  v_pk_add_f32 v[58:59], v[58:59], v[74:75]
  v_pk_add_f32 v[60:61], v[60:61], v[76:77]
  v_pk_add_f32 v[62:63], v[62:63], v[78:79]
  v_pk_add_f32 v[56:57], v[56:57], s[46:47]
  v_pk_add_f32 v[58:59], v[58:59], s[46:47]
  v_pk_add_f32 v[60:61], v[60:61], s[46:47]
  v_pk_add_f32 v[62:63], v[62:63], s[46:47]
  v_cvt_pk_bf16_f32 v84, v56, v57
  v_cvt_pk_bf16_f32 v85, v58, v59
  v_cvt_pk_bf16_f32 v86, v60, v61
  v_cvt_pk_bf16_f32 v87, v62, v63
  v_and_b32 v84, -2, v84
  v_and_b32 v85, -2, v85
  v_and_b32 v86, -2, v86
  v_and_b32 v87, -2, v87
  buffer_store_dwordx4 v[84:87], v3, s[24:27], s42 offen
  s_add_u32 s42, s42, 32768
  v_cvt_pk_bf16_f32 v52, v112, v113
  v_cvt_pk_bf16_f32 v53, v114, v115
  v_cvt_pk_bf16_f32 v54, v116, v117
  v_cvt_pk_bf16_f32 v55, v118, v119
  v_lshlrev_b32 v56, 16, v52
  v_and_b32 v57, 0xffff0000, v52
  v_lshlrev_b32 v58, 16, v53
  v_and_b32 v59, 0xffff0000, v53
  v_lshlrev_b32 v60, 16, v54
  v_and_b32 v61, 0xffff0000, v54
  v_lshlrev_b32 v62, 16, v55
  v_and_b32 v63, 0xffff0000, v55
  v_min_f32 v64, 0, v56
  v_min_f32 v65, 0, v57
  v_min_f32 v66, 0, v58
  v_min_f32 v67, 0, v59
  v_min_f32 v68, 0, v60
  v_min_f32 v69, 0, v61
  v_min_f32 v70, 0, v62
  v_min_f32 v71, 0, v63
  v_pk_mul_f32 v[72:73], v[64:65], s[44:45]
  v_pk_mul_f32 v[74:75], v[66:67], s[44:45]
  v_pk_mul_f32 v[76:77], v[68:69], s[44:45]
  v_pk_mul_f32 v[78:79], v[70:71], s[44:45]
  v_exp_f32 v72, v72
  v_exp_f32 v73, v73
  v_exp_f32 v74, v74
  v_exp_f32 v75, v75
  v_exp_f32 v76, v76
  v_exp_f32 v77, v77
  v_exp_f32 v78, v78
  v_exp_f32 v79, v79
  v_pk_add_f32 v[56:57], v[56:57], v[64:65] neg_lo:[0,1] neg_hi:[0,1]
  v_pk_add_f32 v[58:59], v[58:59], v[66:67] neg_lo:[0,1] neg_hi:[0,1]
  v_pk_add_f32 v[60:61], v[60:61], v[68:69] neg_lo:[0,1] neg_hi:[0,1]
  v_pk_add_f32 v[62:63], v[62:63], v[70:71] neg_lo:[0,1] neg_hi:[0,1]
  v_pk_add_f32 v[56:57], v[56:57], v[72:73]
  v_pk_add_f32 v[58:59], v[58:59], v[74:75]
  v_pk_add_f32 v[60:61], v[60:61], v[76:77]
  v_pk_add_f32 v[62:63], v[62:63], v[78:79]
  v_pk_add_f32 v[56:57], v[56:57], s[46:47]
  v_pk_add_f32 v[58:59], v[58:59], s[46:47]
  v_pk_add_f32 v[60:61], v[60:61], s[46:47]
  v_pk_add_f32 v[62:63], v[62:63], s[46:47]
  v_cvt_pk_bf16_f32 v88, v56, v57
  v_cvt_pk_bf16_f32 v89, v58, v59
  v_cvt_pk_bf16_f32 v90, v60, v61
  v_cvt_pk_bf16_f32 v91, v62, v63
  v_and_b32 v88, -2, v88
  v_and_b32 v89, -2, v89
  v_and_b32 v90, -2, v90
  v_and_b32 v91, -2, v91
  buffer_store_dwordx4 v[88:91], v3, s[24:27], s42 offen
  s_add_u32 s42, s42, 32768
  v_cvt_pk_bf16_f32 v52, v120, v121
  v_cvt_pk_bf16_f32 v53, v122, v123
  v_cvt_pk_bf16_f32 v54, v124, v125
  v_cvt_pk_bf16_f32 v55, v126, v127
  v_lshlrev_b32 v56, 16, v52
  v_and_b32 v57, 0xffff0000, v52
  v_lshlrev_b32 v58, 16, v53
  v_and_b32 v59, 0xffff0000, v53
  v_lshlrev_b32 v60, 16, v54
  v_and_b32 v61, 0xffff0000, v54
  v_lshlrev_b32 v62, 16, v55
  v_and_b32 v63, 0xffff0000, v55
  v_min_f32 v64, 0, v56
  v_min_f32 v65, 0, v57
  v_min_f32 v66, 0, v58
  v_min_f32 v67, 0, v59
  v_min_f32 v68, 0, v60
  v_min_f32 v69, 0, v61
  v_min_f32 v70, 0, v62
  v_min_f32 v71, 0, v63
  v_pk_mul_f32 v[72:73], v[64:65], s[44:45]
  v_pk_mul_f32 v[74:75], v[66:67], s[44:45]
  v_pk_mul_f32 v[76:77], v[68:69], s[44:45]
  v_pk_mul_f32 v[78:79], v[70:71], s[44:45]
  v_exp_f32 v72, v72
  v_exp_f32 v73, v73
  v_exp_f32 v74, v74
  v_exp_f32 v75, v75
  v_exp_f32 v76, v76
  v_exp_f32 v77, v77
  v_exp_f32 v78, v78
  v_exp_f32 v79, v79
  v_pk_add_f32 v[56:57], v[56:57], v[64:65] neg_lo:[0,1] neg_hi:[0,1]
  v_pk_add_f32 v[58:59], v[58:59], v[66:67] neg_lo:[0,1] neg_hi:[0,1]
  v_pk_add_f32 v[60:61], v[60:61], v[68:69] neg_lo:[0,1] neg_hi:[0,1]
  v_pk_add_f32 v[62:63], v[62:63], v[70:71] neg_lo:[0,1] neg_hi:[0,1]
  v_pk_add_f32 v[56:57], v[56:57], v[72:73]
  v_pk_add_f32 v[58:59], v[58:59], v[74:75]
  v_pk_add_f32 v[60:61], v[60:61], v[76:77]
  v_pk_add_f32 v[62:63], v[62:63], v[78:79]
  v_pk_add_f32 v[56:57], v[56:57], s[46:47]
  v_pk_add_f32 v[58:59], v[58:59], s[46:47]
  v_pk_add_f32 v[60:61], v[60:61], s[46:47]
  v_pk_add_f32 v[62:63], v[62:63], s[46:47]
  v_cvt_pk_bf16_f32 v92, v56, v57
  v_cvt_pk_bf16_f32 v93, v58, v59
  v_cvt_pk_bf16_f32 v94, v60, v61
  v_cvt_pk_bf16_f32 v95, v62, v63
  v_and_b32 v92, -2, v92
  v_and_b32 v93, -2, v93
  v_and_b32 v94, -2, v94
  v_and_b32 v95, -2, v95
  buffer_store_dwordx4 v[92:95], v3, s[24:27], s42 offen
  s_add_u32 s42, s42, 32768
  s_endpgm
K1_event0:
  s_add_u32 s54, s54, 1
  s_cmp_lg_u32 s54, 1
  s_cbranch_scc1 K1_ev2_0
  buffer_load_dword v195, v192, s[40:43], s44 offen
  s_mov_b32 s55, s52
  s_branch K1_noev0
K1_ev2_0:
  s_cmp_lg_u32 s54, 2
  s_cbranch_scc1 K1_ev3_0
  buffer_load_dword v195, v193, s[48:51], s45 offen
  s_mov_b32 s55, s53
  s_branch K1_noev0
K1_ev3_0:
  buffer_load_dword v195, v194, s[56:59], s46 offen
  buffer_load_dword v195, v194, s[56:59], s47 offen
  s_mov_b32 s55, 1000
  s_branch K1_noev0
K1_event1:
  s_add_u32 s54, s54, 1
  s_cmp_lg_u32 s54, 1
  s_cbranch_scc1 K1_ev2_1
  buffer_load_dword v195, v192, s[40:43], s44 offen
  s_mov_b32 s55, s52
  s_branch K1_noev1
K1_ev2_1:
  s_cmp_lg_u32 s54, 2
  s_cbranch_scc1 K1_ev3_1
  buffer_load_dword v195, v193, s[48:51], s45 offen
  s_mov_b32 s55, s53
  s_branch K1_noev1
K1_ev3_1:
  buffer_load_dword v195, v194, s[56:59], s46 offen
  buffer_load_dword v195, v194, s[56:59], s47 offen
  s_mov_b32 s55, 1000
  s_branch K1_noev1
K1_event2:
  s_add_u32 s54, s54, 1
  s_cmp_lg_u32 s54, 1
  s_cbranch_scc1 K1_ev2_2
  buffer_load_dword v195, v192, s[40:43], s44 offen
  s_mov_b32 s55, s52
  s_branch K1_noev2
K1_ev2_2:
  s_cmp_lg_u32 s54, 2
  s_cbranch_scc1 K1_ev3_2
  buffer_load_dword v195, v193, s[48:51], s45 offen
  s_mov_b32 s55, s53
  s_branch K1_noev2
K1_ev3_2:
  buffer_load_dword v195, v194, s[56:59], s46 offen
  buffer_load_dword v195, v194, s[56:59], s47 offen
  s_mov_b32 s55, 1000
  s_branch K1_noev2
K1_event3:
  s_add_u32 s54, s54, 1
  s_cmp_lg_u32 s54, 1
  s_cbranch_scc1 K1_ev2_3
  buffer_load_dword v195, v192, s[40:43], s44 offen
  s_mov_b32 s55, s52
  s_branch K1_noev3
K1_ev2_3:
  s_cmp_lg_u32 s54, 2
  s_cbranch_scc1 K1_ev3_3
  buffer_load_dword v195, v193, s[48:51], s45 offen
  s_mov_b32 s55, s53
  s_branch K1_noev3
K1_ev3_3:
  buffer_load_dword v195, v194, s[56:59], s46 offen
  buffer_load_dword v195, v194, s[56:59], s47 offen
  s_mov_b32 s55, 1000
  s_branch K1_noev3
K1_loader:
  s_sub_u32 s36, s3, 4
  v_lshrrev_b32 v3, 3, v2
  v_and_b32 v4, 7, v2
  v_lshrrev_b32 v5, 4, v2
  v_add_u32 v6, 0, v5
  v_xor_b32 v6, v6, v4
  v_lshlrev_b32 v6, 4, v6
  v_lshl_add_u32 v6, v3, 11, v6
  v_add_u32 v8, 0, v6
  v_add_u32 v6, 4, v5
  v_xor_b32 v6, v6, v4
  v_lshlrev_b32 v6, 4, v6
  v_lshl_add_u32 v6, v3, 11, v6
  v_add_u32 v9, 15360, v6
  v_add_u32 v6, 0, v5
  v_xor_b32 v6, v6, v4
  v_lshlrev_b32 v6, 4, v6
  v_lshl_add_u32 v6, v3, 11, v6
  v_add_u32 v10, 30720, v6
  v_add_u32 v6, 4, v5
  v_xor_b32 v6, v6, v4
  v_lshlrev_b32 v6, 4, v6
  v_lshl_add_u32 v6, v3, 11, v6
  v_add_u32 v11, 46080, v6
  v_lshrrev_b32 v6, 5, v2
  v_bfe_u32 v7, v2, 2, 2
  v_lshl_add_u32 v6, v6, 2, v7
  v_mul_u32_u24 v6, 6144, v6
  v_bfe_u32 v7, v2, 4, 1
  v_lshl_add_u32 v6, v7, 6, v6
  v_and_b32 v7, 3, v2
  v_lshl_add_u32 v6, v7, 4, v6
  v_xor_b32 v7, 32, v6
  v_add_u32 v12, 0, v6
  v_add_u32 v13, 48128, v7
  v_add_u32 v14, 0, v6
  v_add_u32 v15, 48128, v7
  v_add_u32 v16, 4096, v6
  v_add_u32 v17, 52224, v7
  s_lshl_b32 s38, s12, 7
  s_lshl_b32 s40, s36, 5
  s_add_u32 s38, s38, s40
  s_lshl_b32 s38, s38, 11
  s_mul_i32 s39, s36, 98304
  s_lshl_b32 s40, s13, 7
  s_add_u32 s39, s39, s40
  s_lshl_b32 s41, s36, 12
  s_mul_i32 s42, s36, 6144
  s_add_u32 s42, s42, 16384
  s_waitcnt lgkmcnt(0)
  s_mov_b32 s16, s4
  s_mov_b32 s17, s5
  s_mov_b32 s18, 4194304
  s_mov_b32 s19, 0x20000
  s_mov_b32 s20, s6
  s_mov_b32 s21, s7
  s_mov_b32 s22, 6291456
  s_mov_b32 s23, 0x20000
  s_add_u32 s44, s42, 4096
  s_mov_b32 s43, 0
  s_add_u32 m0, s41, s43
  s_nop 0
  buffer_load_dwordx4 v8, s[16:19], s38 offen offset:0 lds
  buffer_load_dwordx4 v9, s[16:19], s38 offen offset:1024 lds
  buffer_load_dwordx4 v10, s[16:19], s38 offen offset:2048 lds
  buffer_load_dwordx4 v11, s[16:19], s38 offen offset:3072 lds
  s_add_u32 m0, s42, s43
  s_nop 0
  buffer_load_dwordx4 v12, s[20:23], s39 offen offset:0 lds
  buffer_load_dwordx4 v13, s[20:23], s39 offen offset:1024 lds
  buffer_load_dwordx4 v14, s[20:23], s39 offen offset:2048 lds
  buffer_load_dwordx4 v15, s[20:23], s39 offen offset:3072 lds
  s_add_u32 m0, s44, s43
  s_nop 0
  buffer_load_dwordx4 v16, s[20:23], s39 offen offset:0 lds
  buffer_load_dwordx4 v17, s[20:23], s39 offen offset:1024 lds
  s_add_u32 s38, s38, 128
  s_add_u32 s39, s39, 393216
  s_add_u32 s43, s43, 40960
  s_cmp_eq_u32 s43, 163840
  s_cselect_b32 s43, 0, s43
  s_add_u32 m0, s41, s43
  s_nop 0
  buffer_load_dwordx4 v8, s[16:19], s38 offen offset:0 lds
  buffer_load_dwordx4 v9, s[16:19], s38 offen offset:1024 lds
  buffer_load_dwordx4 v10, s[16:19], s38 offen offset:2048 lds
  buffer_load_dwordx4 v11, s[16:19], s38 offen offset:3072 lds
  s_add_u32 m0, s42, s43
  s_nop 0
  buffer_load_dwordx4 v12, s[20:23], s39 offen offset:0 lds
  buffer_load_dwordx4 v13, s[20:23], s39 offen offset:1024 lds
  buffer_load_dwordx4 v14, s[20:23], s39 offen offset:2048 lds
  buffer_load_dwordx4 v15, s[20:23], s39 offen offset:3072 lds
  s_add_u32 m0, s44, s43
  s_nop 0
  buffer_load_dwordx4 v16, s[20:23], s39 offen offset:0 lds
  buffer_load_dwordx4 v17, s[20:23], s39 offen offset:1024 lds
  s_add_u32 s38, s38, 128
  s_add_u32 s39, s39, 393216
  s_add_u32 s43, s43, 40960
  s_cmp_eq_u32 s43, 163840
  s_cselect_b32 s43, 0, s43
  s_add_u32 m0, s41, s43
  s_nop 0
  buffer_load_dwordx4 v8, s[16:19], s38 offen offset:0 lds
  buffer_load_dwordx4 v9, s[16:19], s38 offen offset:1024 lds
  buffer_load_dwordx4 v10, s[16:19], s38 offen offset:2048 lds
  buffer_load_dwordx4 v11, s[16:19], s38 offen offset:3072 lds
  s_add_u32 m0, s42, s43
  s_nop 0
  buffer_load_dwordx4 v12, s[20:23], s39 offen offset:0 lds
  buffer_load_dwordx4 v13, s[20:23], s39 offen offset:1024 lds
  buffer_load_dwordx4 v14, s[20:23], s39 offen offset:2048 lds
  buffer_load_dwordx4 v15, s[20:23], s39 offen offset:3072 lds
  s_add_u32 m0, s44, s43
  s_nop 0
  buffer_load_dwordx4 v16, s[20:23], s39 offen offset:0 lds
  buffer_load_dwordx4 v17, s[20:23], s39 offen offset:1024 lds
  s_add_u32 s38, s38, 128
  s_add_u32 s39, s39, 393216
  s_add_u32 s43, s43, 40960
  s_cmp_eq_u32 s43, 163840
  s_cselect_b32 s43, 0, s43
  s_mov_b32 s24, s78
  s_mov_b32 s25, s79
  s_mov_b32 s26, 4194304
  s_mov_b32 s27, 0x20000
  s_mov_b32 s28, s80
  s_mov_b32 s29, s81
  s_mov_b32 s30, 4194304
  s_mov_b32 s31, 0x20000
  s_mov_b32 s32, s82
  s_mov_b32 s33, s83
  s_mov_b32 s34, 8192
  s_mov_b32 s35, 0x20000
  s_add_u32 s48, s8, 16777216
  s_addc_u32 s49, s9, 0
  s_mov_b32 s50, 4194304
  s_mov_b32 s51, 0x20000
  s_lshl_b32 s58, s2, 2
  s_add_u32 s58, s58, s36
  s_and_b32 s59, s58, 15
  s_lshr_b32 s60, s58, 4
  s_lshl_b32 s61, s60, 16
  s_lshl_b32 s62, s59, 7
  s_add_u32 s61, s61, s62
  v_and_b32 v20, 15, v2
  v_lshlrev_b32 v21, 14, v5
  v_lshl_add_u32 v21, v20, 3, v21
  v_add_u32 v21, s61, v21
  s_lshl_b32 s62, s59, 9
  v_lshlrev_b32 v22, 5, v20
  s_lshl_b32 s61, s59, 18
  s_lshl_b32 s63, s60, 6
  s_add_u32 s61, s61, s63
  v_lshlrev_b32 v19, 14, v20
  v_lshl_add_u32 v19, v5, 4, v19
  s_mov_b32 s47, 13
K1_lloop:
  s_waitcnt vmcnt(20)
  s_barrier
  s_add_u32 m0, s41, s43
  s_nop 0
  buffer_load_dwordx4 v8, s[16:19], s38 offen offset:0 lds
  buffer_load_dwordx4 v9, s[16:19], s38 offen offset:1024 lds
  buffer_load_dwordx4 v10, s[16:19], s38 offen offset:2048 lds
  buffer_load_dwordx4 v11, s[16:19], s38 offen offset:3072 lds
  s_add_u32 m0, s42, s43
  s_nop 0
  buffer_load_dwordx4 v12, s[20:23], s39 offen offset:0 lds
  buffer_load_dwordx4 v13, s[20:23], s39 offen offset:1024 lds
  buffer_load_dwordx4 v14, s[20:23], s39 offen offset:2048 lds
  buffer_load_dwordx4 v15, s[20:23], s39 offen offset:3072 lds
  s_add_u32 m0, s44, s43
  s_nop 0
  buffer_load_dwordx4 v16, s[20:23], s39 offen offset:0 lds
  buffer_load_dwordx4 v17, s[20:23], s39 offen offset:1024 lds
  s_add_u32 s38, s38, 128
  s_add_u32 s39, s39, 393216
  s_add_u32 s43, s43, 40960
  s_cmp_eq_u32 s43, 163840
  s_cselect_b32 s43, 0, s43
  s_sub_u32 s47, s47, 1
  s_cmp_lg_u32 s47, 0
  s_cbranch_scc1 K1_lloop
  s_waitcnt vmcnt(20)
  s_barrier
  s_waitcnt vmcnt(10)
  s_barrier
  buffer_load_dwordx4 v[24:27], v22, s[32:35], s62 offen offset:0
  buffer_load_dwordx4 v[28:31], v22, s[32:35], s62 offen offset:16
  v_add_u32 v23, 4294961152, v21
  buffer_load_dwordx2 v[32:33], v23, s[24:27], 0 offen
  v_add_u32 v23, 4294963200, v21
  buffer_load_dwordx2 v[34:35], v23, s[24:27], 0 offen
  v_add_u32 v23, 4294965248, v21
  buffer_load_dwordx2 v[36:37], v23, s[24:27], 0 offen
  v_add_u32 v23, 0, v21
  buffer_load_dwordx2 v[38:39], v23, s[24:27], 0 offen
  v_add_u32 v23, 2048, v21
  buffer_load_dwordx2 v[40:41], v23, s[24:27], 0 offen
  v_add_u32 v23, 4096, v21
  buffer_load_dwordx2 v[42:43], v23, s[24:27], 0 offen
  v_add_u32 v23, 6144, v21
  buffer_load_dwordx2 v[44:45], v23, s[24:27], 0 offen
  v_add_u32 v23, 8192, v21
  buffer_load_dwordx2 v[46:47], v23, s[24:27], 0 offen
  v_add_u32 v23, 10240, v21
  buffer_load_dwordx2 v[48:49], v23, s[24:27], 0 offen
  v_add_u32 v23, 12288, v21
  buffer_load_dwordx2 v[50:51], v23, s[24:27], 0 offen
  v_add_u32 v23, 14336, v21
  buffer_load_dwordx2 v[52:53], v23, s[24:27], 0 offen
  s_waitcnt vmcnt(13)
  s_barrier
  v_add_u32 v23, 0, v21
  buffer_load_dwordx2 v[54:55], v23, s[28:31], 0 offen
  v_add_u32 v23, 2048, v21
  buffer_load_dwordx2 v[56:57], v23, s[28:31], 0 offen
  v_add_u32 v23, 4096, v21
  buffer_load_dwordx2 v[58:59], v23, s[28:31], 0 offen
  v_add_u32 v23, 6144, v21
  buffer_load_dwordx2 v[60:61], v23, s[28:31], 0 offen
  v_add_u32 v23, 8192, v21
  buffer_load_dwordx2 v[62:63], v23, s[28:31], 0 offen
  v_add_u32 v23, 10240, v21
  buffer_load_dwordx2 v[64:65], v23, s[28:31], 0 offen
  v_add_u32 v23, 12288, v21
  buffer_load_dwordx2 v[66:67], v23, s[28:31], 0 offen
  v_add_u32 v23, 14336, v21
  buffer_load_dwordx2 v[68:69], v23, s[28:31], 0 offen
  s_barrier
  s_waitcnt vmcnt(0)
  v_lshlrev_b32 v72, 16, v24
  v_and_b32 v76, 0xffff0000, v24
  v_lshlrev_b32 v80, 16, v25
  v_and_b32 v84, 0xffff0000, v25
  v_lshlrev_b32 v73, 16, v26
  v_and_b32 v77, 0xffff0000, v26
  v_lshlrev_b32 v81, 16, v27
  v_and_b32 v85, 0xffff0000, v27
  v_lshlrev_b32 v74, 16, v28
  v_and_b32 v78, 0xffff0000, v28
  v_lshlrev_b32 v82, 16, v29
  v_and_b32 v86, 0xffff0000, v29
  v_lshlrev_b32 v75, 16, v30
  v_and_b32 v79, 0xffff0000, v30
  v_lshlrev_b32 v83, 16, v31
  v_and_b32 v87, 0xffff0000, v31
  v_lshlrev_b32 v88, 16, v32
  v_and_b32 v89, 0xffff0000, v32
  v_lshlrev_b32 v90, 16, v34
  v_and_b32 v91, 0xffff0000, v34
  v_lshlrev_b32 v92, 16, v36
  v_and_b32 v93, 0xffff0000, v36
  v_lshlrev_b32 v94, 16, v38
  v_and_b32 v95, 0xffff0000, v38
  v_lshlrev_b32 v96, 16, v40
  v_and_b32 v97, 0xffff0000, v40
  v_lshlrev_b32 v98, 16, v42
  v_and_b32 v99, 0xffff0000, v42
  v_lshlrev_b32 v100, 16, v44
  v_and_b32 v101, 0xffff0000, v44
  v_lshlrev_b32 v102, 16, v46
  v_and_b32 v103, 0xffff0000, v46
  v_lshlrev_b32 v104, 16, v48
  v_and_b32 v105, 0xffff0000, v48
  v_lshlrev_b32 v106, 16, v50
  v_and_b32 v107, 0xffff0000, v50
  v_lshlrev_b32 v108, 16, v52
  v_and_b32 v109, 0xffff0000, v52
  v_lshlrev_b32 v110, 16, v54
  v_and_b32 v111, 0xffff0000, v54
  v_lshlrev_b32 v112, 16, v56
  v_and_b32 v113, 0xffff0000, v56
  v_lshlrev_b32 v114, 16, v58
  v_and_b32 v115, 0xffff0000, v58
  v_lshlrev_b32 v116, 16, v60
  v_and_b32 v117, 0xffff0000, v60
  v_lshlrev_b32 v118, 16, v62
  v_and_b32 v119, 0xffff0000, v62
  v_lshlrev_b32 v120, 16, v64
  v_and_b32 v121, 0xffff0000, v64
  v_lshlrev_b32 v122, 16, v66
  v_and_b32 v123, 0xffff0000, v66
  v_lshlrev_b32 v124, 16, v68
  v_and_b32 v125, 0xffff0000, v68
  v_pk_mul_f32 v[126:127], v[88:89], v[84:85]
  v_pk_mul_f32 v[128:129], v[90:91], v[84:85]
  v_pk_mul_f32 v[130:131], v[92:93], v[84:85]
  v_pk_mul_f32 v[132:133], v[94:95], v[84:85]
  v_pk_mul_f32 v[134:135], v[96:97], v[84:85]
  v_pk_mul_f32 v[136:137], v[98:99], v[84:85]
  v_pk_mul_f32 v[138:139], v[100:101], v[84:85]
  v_pk_mul_f32 v[140:141], v[102:103], v[84:85]
  v_pk_fma_f32 v[126:127], v[90:91], v[80:81], v[126:127]
  v_pk_fma_f32 v[128:129], v[92:93], v[80:81], v[128:129]
  v_pk_fma_f32 v[130:131], v[94:95], v[80:81], v[130:131]
  v_pk_fma_f32 v[132:133], v[96:97], v[80:81], v[132:133]
  v_pk_fma_f32 v[134:135], v[98:99], v[80:81], v[134:135]
  v_pk_fma_f32 v[136:137], v[100:101], v[80:81], v[136:137]
  v_pk_fma_f32 v[138:139], v[102:103], v[80:81], v[138:139]
  v_pk_fma_f32 v[140:141], v[104:105], v[80:81], v[140:141]
  v_pk_fma_f32 v[126:127], v[92:93], v[76:77], v[126:127]
  v_pk_fma_f32 v[128:129], v[94:95], v[76:77], v[128:129]
  v_pk_fma_f32 v[130:131], v[96:97], v[76:77], v[130:131]
  v_pk_fma_f32 v[132:133], v[98:99], v[76:77], v[132:133]
  v_pk_fma_f32 v[134:135], v[100:101], v[76:77], v[134:135]
  v_pk_fma_f32 v[136:137], v[102:103], v[76:77], v[136:137]
  v_pk_fma_f32 v[138:139], v[104:105], v[76:77], v[138:139]
  v_pk_fma_f32 v[140:141], v[106:107], v[76:77], v[140:141]
  v_pk_fma_f32 v[126:127], v[94:95], v[72:73], v[126:127]
  v_pk_fma_f32 v[128:129], v[96:97], v[72:73], v[128:129]
  v_pk_fma_f32 v[130:131], v[98:99], v[72:73], v[130:131]
  v_pk_fma_f32 v[132:133], v[100:101], v[72:73], v[132:133]
  v_pk_fma_f32 v[134:135], v[102:103], v[72:73], v[134:135]
  v_pk_fma_f32 v[136:137], v[104:105], v[72:73], v[136:137]
  v_pk_fma_f32 v[138:139], v[106:107], v[72:73], v[138:139]
  v_pk_fma_f32 v[140:141], v[108:109], v[72:73], v[140:141]
  v_pk_mul_f32 v[126:127], v[126:127], v[110:111]
  v_pk_mul_f32 v[128:129], v[128:129], v[112:113]
  v_pk_mul_f32 v[130:131], v[130:131], v[114:115]
  v_pk_mul_f32 v[132:133], v[132:133], v[116:117]
  v_pk_mul_f32 v[134:135], v[134:135], v[118:119]
  v_pk_mul_f32 v[136:137], v[136:137], v[120:121]
  v_pk_mul_f32 v[138:139], v[138:139], v[122:123]
  v_pk_mul_f32 v[140:141], v[140:141], v[124:125]
  v_cvt_pk_bf16_f32 v144, v126, v128
  v_cvt_pk_bf16_f32 v145, v130, v132
  v_cvt_pk_bf16_f32 v146, v134, v136
  v_cvt_pk_bf16_f32 v147, v138, v140
  v_cvt_pk_bf16_f32 v148, v127, v129
  v_cvt_pk_bf16_f32 v149, v131, v133
  v_cvt_pk_bf16_f32 v150, v135, v137
  v_cvt_pk_bf16_f32 v151, v139, v141
  v_and_b32 v144, -2, v144
  v_and_b32 v145, -2, v145
  v_and_b32 v146, -2, v146
  v_and_b32 v147, -2, v147
  v_and_b32 v148, -2, v148
  v_and_b32 v149, -2, v149
  v_and_b32 v150, -2, v150
  v_and_b32 v151, -2, v151
  buffer_store_dwordx4 v[144:147], v19, s[48:51], s61 offen
  s_add_u32 s61, s61, 4096
  buffer_store_dwordx4 v[148:151], v19, s[48:51], s61 offen
  s_add_u32 s61, s61, 4096
  s_barrier
  v_lshlrev_b32 v88, 16, v33
  v_and_b32 v89, 0xffff0000, v33
  v_lshlrev_b32 v90, 16, v35
  v_and_b32 v91, 0xffff0000, v35
  v_lshlrev_b32 v92, 16, v37
  v_and_b32 v93, 0xffff0000, v37
  v_lshlrev_b32 v94, 16, v39
  v_and_b32 v95, 0xffff0000, v39
  v_lshlrev_b32 v96, 16, v41
  v_and_b32 v97, 0xffff0000, v41
  v_lshlrev_b32 v98, 16, v43
  v_and_b32 v99, 0xffff0000, v43
  v_lshlrev_b32 v100, 16, v45
  v_and_b32 v101, 0xffff0000, v45
  v_lshlrev_b32 v102, 16, v47
  v_and_b32 v103, 0xffff0000, v47
  v_lshlrev_b32 v104, 16, v49
  v_and_b32 v105, 0xffff0000, v49
  v_lshlrev_b32 v106, 16, v51
  v_and_b32 v107, 0xffff0000, v51
  v_lshlrev_b32 v108, 16, v53
  v_and_b32 v109, 0xffff0000, v53
  v_lshlrev_b32 v110, 16, v55
  v_and_b32 v111, 0xffff0000, v55
  v_lshlrev_b32 v112, 16, v57
  v_and_b32 v113, 0xffff0000, v57
  v_lshlrev_b32 v114, 16, v59
  v_and_b32 v115, 0xffff0000, v59
  v_lshlrev_b32 v116, 16, v61
  v_and_b32 v117, 0xffff0000, v61
  v_lshlrev_b32 v118, 16, v63
  v_and_b32 v119, 0xffff0000, v63
  v_lshlrev_b32 v120, 16, v65
  v_and_b32 v121, 0xffff0000, v65
  v_lshlrev_b32 v122, 16, v67
  v_and_b32 v123, 0xffff0000, v67
  v_lshlrev_b32 v124, 16, v69
  v_and_b32 v125, 0xffff0000, v69
  v_pk_mul_f32 v[126:127], v[88:89], v[86:87]
  v_pk_mul_f32 v[128:129], v[90:91], v[86:87]
  v_pk_mul_f32 v[130:131], v[92:93], v[86:87]
  v_pk_mul_f32 v[132:133], v[94:95], v[86:87]
  v_pk_mul_f32 v[134:135], v[96:97], v[86:87]
  v_pk_mul_f32 v[136:137], v[98:99], v[86:87]
  v_pk_mul_f32 v[138:139], v[100:101], v[86:87]
  v_pk_mul_f32 v[140:141], v[102:103], v[86:87]
  v_pk_fma_f32 v[126:127], v[90:91], v[82:83], v[126:127]
  v_pk_fma_f32 v[128:129], v[92:93], v[82:83], v[128:129]
  v_pk_fma_f32 v[130:131], v[94:95], v[82:83], v[130:131]
  v_pk_fma_f32 v[132:133], v[96:97], v[82:83], v[132:133]
  v_pk_fma_f32 v[134:135], v[98:99], v[82:83], v[134:135]
  v_pk_fma_f32 v[136:137], v[100:101], v[82:83], v[136:137]
  v_pk_fma_f32 v[138:139], v[102:103], v[82:83], v[138:139]
  v_pk_fma_f32 v[140:141], v[104:105], v[82:83], v[140:141]
  v_pk_fma_f32 v[126:127], v[92:93], v[78:79], v[126:127]
  v_pk_fma_f32 v[128:129], v[94:95], v[78:79], v[128:129]
  v_pk_fma_f32 v[130:131], v[96:97], v[78:79], v[130:131]
  v_pk_fma_f32 v[132:133], v[98:99], v[78:79], v[132:133]
  v_pk_fma_f32 v[134:135], v[100:101], v[78:79], v[134:135]
  v_pk_fma_f32 v[136:137], v[102:103], v[78:79], v[136:137]
  v_pk_fma_f32 v[138:139], v[104:105], v[78:79], v[138:139]
  v_pk_fma_f32 v[140:141], v[106:107], v[78:79], v[140:141]
  v_pk_fma_f32 v[126:127], v[94:95], v[74:75], v[126:127]
  v_pk_fma_f32 v[128:129], v[96:97], v[74:75], v[128:129]
  v_pk_fma_f32 v[130:131], v[98:99], v[74:75], v[130:131]
  v_pk_fma_f32 v[132:133], v[100:101], v[74:75], v[132:133]
  v_pk_fma_f32 v[134:135], v[102:103], v[74:75], v[134:135]
  v_pk_fma_f32 v[136:137], v[104:105], v[74:75], v[136:137]
  v_pk_fma_f32 v[138:139], v[106:107], v[74:75], v[138:139]
  v_pk_fma_f32 v[140:141], v[108:109], v[74:75], v[140:141]
  v_pk_mul_f32 v[126:127], v[126:127], v[110:111]
  v_pk_mul_f32 v[128:129], v[128:129], v[112:113]
  v_pk_mul_f32 v[130:131], v[130:131], v[114:115]
  v_pk_mul_f32 v[132:133], v[132:133], v[116:117]
  v_pk_mul_f32 v[134:135], v[134:135], v[118:119]
  v_pk_mul_f32 v[136:137], v[136:137], v[120:121]
  v_pk_mul_f32 v[138:139], v[138:139], v[122:123]
  v_pk_mul_f32 v[140:141], v[140:141], v[124:125]
  v_cvt_pk_bf16_f32 v152, v126, v128
  v_cvt_pk_bf16_f32 v153, v130, v132
  v_cvt_pk_bf16_f32 v154, v134, v136
  v_cvt_pk_bf16_f32 v155, v138, v140
  v_cvt_pk_bf16_f32 v156, v127, v129
  v_cvt_pk_bf16_f32 v157, v131, v133
  v_cvt_pk_bf16_f32 v158, v135, v137
  v_cvt_pk_bf16_f32 v159, v139, v141
  v_and_b32 v152, -2, v152
  v_and_b32 v153, -2, v153
  v_and_b32 v154, -2, v154
  v_and_b32 v155, -2, v155
  v_and_b32 v156, -2, v156
  v_and_b32 v157, -2, v157
  v_and_b32 v158, -2, v158
  v_and_b32 v159, -2, v159
  buffer_store_dwordx4 v[152:155], v19, s[48:51], s61 offen
  s_add_u32 s61, s61, 4096
  buffer_store_dwordx4 v[156:159], v19, s[48:51], s61 offen
  s_add_u32 s61, s61, 4096
K1_end:
  s_endpgm
.globl k2_kernel
.p2align 8
.type k2_kernel,@function
k2_kernel:
  s_cmp_ge_u32 s2, 256
  s_cbranch_scc1 K2_end
  s_mov_b32 s93, 0
  s_load_dwordx2 s[8:9], s[0:1], 88
  s_load_dwordx4 s[4:7], s[0:1], 64
  s_load_dwordx4 s[52:55], s[0:1], 32
  s_load_dwordx2 s[56:57], s[0:1], 0
  v_lshrrev_b32 v1, 6, v0
  v_and_b32 v2, 63, v0
  s_and_b32 s10, s2, 7
  v_readfirstlane_b32 s3, v1
  s_lshr_b32 s11, s2, 3
  s_lshl_b32 s12, s10, 1
  s_lshr_b32 s13, s11, 4
  s_add_u32 s12, s12, s13
  s_and_b32 s13, s11, 15
  v_lshlrev_b32 v3, 4, v2
  v_lshrrev_b32 v14, 4, v2
  v_and_b32 v15, 15, v2
  v_mov_b32 v10, 153600
  v_lshlrev_b32 v11, 2, v15
  s_cmp_ge_u32 s3, 4
  s_cbranch_scc1 K2_L
  s_lshl_b32 s40, s10, 2
  s_and_b32 s36, s11, 3
  s_add_u32 s40, s40, s36
  s_lshr_b32 s37, s11, 2
  v_mov_b32 v4, 0
  v_add_u32 v5, 153600, v11
  ds_write_b32 v5, v4
  s_lshl_b32 s41, s37, 4
  s_lshl_b32 s42, s3, 2
  s_add_u32 s41, s41, s42
  s_lshl_b32 s42, s41, 5
  s_add_u32 s42, s42, s40
  s_lshl_b32 s42, s42, 10
  s_lshl_b32 s43, s40, 16
  s_lshl_b32 s44, s3, 10
  s_add_u32 s43, s43, s44
  s_lshl_b32 s44, s40, 11
  v_lshlrev_b32 v6, 7, v15
  v_lshl_add_u32 v6, v14, 4, v6
  s_waitcnt lgkmcnt(0)
  s_add_u32 s24, s8, 0
  s_addc_u32 s25, s9, 0
  s_mov_b32 s26, 4194304
  s_mov_b32 s27, 0x20000
  s_add_u32 s28, s8, 8388608
  s_addc_u32 s29, s9, 0
  s_mov_b32 s30, 2097152
  s_mov_b32 s31, 0x20000
  s_add_u32 s32, s8, 12582912
  s_addc_u32 s33, s9, 0
  s_mov_b32 s34, 65536
  s_mov_b32 s35, 0x20000
  s_setprio 2
  s_barrier
  buffer_load_dwordx4 v[64:67], v3, s[28:31], s43 offen
  s_add_u32 s43, s43, 4096
  buffer_load_dwordx4 v[68:71], v3, s[28:31], s43 offen
  s_add_u32 s43, s43, 4096
  buffer_load_dwordx4 v[72:75], v3, s[28:31], s43 offen
  s_add_u32 s43, s43, 4096
  buffer_load_dwordx4 v[76:79], v3, s[28:31], s43 offen
  s_add_u32 s43, s43, 4096
  buffer_load_dwordx4 v[80:83], v3, s[28:31], s43 offen
  s_add_u32 s43, s43, 4096
  buffer_load_dwordx4 v[84:87], v3, s[28:31], s43 offen
  s_add_u32 s43, s43, 4096
  buffer_load_dwordx4 v[88:91], v3, s[28:31], s43 offen
  s_add_u32 s43, s43, 4096
  buffer_load_dwordx4 v[92:95], v3, s[28:31], s43 offen
  s_add_u32 s43, s43, 4096
  buffer_load_dwordx4 v[96:99], v3, s[28:31], s43 offen
  s_add_u32 s43, s43, 4096
  buffer_load_dwordx4 v[100:103], v3, s[28:31], s43 offen
  s_add_u32 s43, s43, 4096
  buffer_load_dwordx4 v[104:107], v3, s[28:31], s43 offen
  s_add_u32 s43, s43, 4096
  buffer_load_dwordx4 v[108:111], v3, s[28:31], s43 offen
  s_add_u32 s43, s43, 4096
  buffer_load_dwordx4 v[112:115], v3, s[28:31], s43 offen
  s_add_u32 s43, s43, 4096
  buffer_load_dwordx4 v[116:119], v3, s[28:31], s43 offen
  s_add_u32 s43, s43, 4096
  buffer_load_dwordx4 v[120:123], v3, s[28:31], s43 offen
  s_add_u32 s43, s43, 4096
  buffer_load_dwordx4 v[124:127], v3, s[28:31], s43 offen
  s_add_u32 s43, s43, 4096
  buffer_load_dwordx4 v[32:35], v6, s[32:35], s44 offen offset:0
  buffer_load_dwordx4 v[36:39], v6, s[32:35], s44 offen offset:64
  s_mov_b32 s45, s42
  buffer_load_dwordx4 v[16:19], v3, s[24:27], s45 offen
  s_add_u32 s45, s45, 32768
  buffer_load_dwordx4 v[20:23], v3, s[24:27], s45 offen
  s_add_u32 s45, s45, 32768
  buffer_load_dwordx4 v[24:27], v3, s[24:27], s45 offen
  s_add_u32 s45, s45, 32768
  buffer_load_dwordx4 v[28:31], v3, s[24:27], s45 offen
  s_add_u32 s45, s45, 32768
  s_mov_b32 s20, s4
  s_mov_b32 s21, s5
  s_mov_b32 s22, 2097152
  s_mov_b32 s23, 0x20000
  v_lshrrev_b32 v6, 5, v2
  v_bfe_u32 v7, v2, 2, 2
  v_lshl_add_u32 v7, v6, 2, v7
  v_lshlrev_b32 v7, 11, v7
  v_bfe_u32 v8, v2, 4, 1
  v_lshl_add_u32 v7, v8, 6, v7
  v_and_b32 v8, 3, v2
  v_lshlrev_b32 v6, 1, v6
  v_xor_b32 v8, v8, v6
  v_lshl_add_u32 v7, v8, 4, v7
  v_add_u32 v240, 0, v7
  v_add_u32 v241, 15360, v7
  v_add_u32 v242, 30720, v7
  v_add_u32 v243, 46080, v7
  s_lshl_b32 s58, s3, 16
  s_lshr_b32 s59, s10, 2
  s_lshl_b32 s59, s59, 3
  s_lshr_b32 s60, s11, 2
  s_add_u32 s59, s59, s60
  s_lshl_b32 s59, s59, 7
  s_add_u32 s58, s58, s59
  s_lshl_b32 s59, s3, 12
  s_add_u32 s16, s8, 0
  s_addc_u32 s17, s9, 0
  s_mov_b32 s18, 4194304
  s_mov_b32 s19, 0x20000
  s_mov_b32 s48, s6
  s_mov_b32 s49, s7
  s_mov_b32 s50, 8388608
  s_mov_b32 s51, 0x20000
  s_mov_b32 s44, 1069066811
  s_mov_b32 s45, 1069066811
  s_mov_b32 s46, 897988541
  s_mov_b32 s47, 897988541
  s_lshr_b32 s38, s3, 1
  s_lshl_b32 s38, s38, 10
  s_and_b32 s39, s3, 1
  s_lshl_b32 s39, s39, 3
  s_add_u32 s38, s38, s39
  s_add_u32 s38, s38, 149504
  v_add_u32 v5, s38, v3
  v_add_u32 v6, 149504, v3
  v_mov_b32 v7, 1
  s_waitcnt vmcnt(19)
  v_add_f32 v64, v64, v72
  v_add_f32 v65, v65, v73
  v_add_f32 v66, v66, v74
  v_add_f32 v67, v67, v75
  s_waitcnt vmcnt(18)
  v_add_f32 v68, v68, v76
  v_add_f32 v69, v69, v77
  v_add_f32 v70, v70, v78
  v_add_f32 v71, v71, v79
  s_waitcnt vmcnt(17)
  v_add_f32 v64, v64, v80
  v_add_f32 v65, v65, v81
  v_add_f32 v66, v66, v82
  v_add_f32 v67, v67, v83
  s_waitcnt vmcnt(16)
  v_add_f32 v68, v68, v84
  v_add_f32 v69, v69, v85
  v_add_f32 v70, v70, v86
  v_add_f32 v71, v71, v87
  s_waitcnt vmcnt(15)
  v_add_f32 v64, v64, v88
  v_add_f32 v65, v65, v89
  v_add_f32 v66, v66, v90
  v_add_f32 v67, v67, v91
  s_waitcnt vmcnt(14)
  v_add_f32 v68, v68, v92
  v_add_f32 v69, v69, v93
  v_add_f32 v70, v70, v94
  v_add_f32 v71, v71, v95
  s_waitcnt vmcnt(13)
  v_add_f32 v64, v64, v96
  v_add_f32 v65, v65, v97
  v_add_f32 v66, v66, v98
  v_add_f32 v67, v67, v99
  s_waitcnt vmcnt(12)
  v_add_f32 v68, v68, v100
  v_add_f32 v69, v69, v101
  v_add_f32 v70, v70, v102
  v_add_f32 v71, v71, v103
  s_waitcnt vmcnt(11)
  v_add_f32 v64, v64, v104
  v_add_f32 v65, v65, v105
  v_add_f32 v66, v66, v106
  v_add_f32 v67, v67, v107
  s_waitcnt vmcnt(10)
  v_add_f32 v68, v68, v108
  v_add_f32 v69, v69, v109
  v_add_f32 v70, v70, v110
  v_add_f32 v71, v71, v111
  s_waitcnt vmcnt(9)
  v_add_f32 v64, v64, v112
  v_add_f32 v65, v65, v113
  v_add_f32 v66, v66, v114
  v_add_f32 v67, v67, v115
  s_waitcnt vmcnt(8)
  v_add_f32 v68, v68, v116
  v_add_f32 v69, v69, v117
  v_add_f32 v70, v70, v118
  v_add_f32 v71, v71, v119
  s_waitcnt vmcnt(7)
  v_add_f32 v64, v64, v120
  v_add_f32 v65, v65, v121
  v_add_f32 v66, v66, v122
  v_add_f32 v67, v67, v123
  s_waitcnt vmcnt(6)
  v_add_f32 v68, v68, v124
  v_add_f32 v69, v69, v125
  v_add_f32 v70, v70, v126
  v_add_f32 v71, v71, v127
  v_add_f32 v64, v64, v68
  v_add_f32 v65, v65, v69
  v_add_f32 v66, v66, v70
  v_add_f32 v67, v67, v71
  v_cvt_pk_bf16_f32 v40, v64, v65
  v_cvt_pk_bf16_f32 v41, v66, v67
  ds_write_b64 v5, v[40:41]
  s_mov_b64 exec, 1
  s_waitcnt lgkmcnt(0)
  ds_add_u32 v10, v7 offset:0
  s_mov_b64 exec, -1
  s_waitcnt vmcnt(4)
  v_add_f32_dpp v32, v32, v32 row_ror:8 row_mask:0xf bank_mask:0xf
  v_add_f32_dpp v33, v33, v33 row_ror:8 row_mask:0xf bank_mask:0xf
  v_add_f32_dpp v34, v34, v34 row_ror:8 row_mask:0xf bank_mask:0xf
  v_add_f32_dpp v35, v35, v35 row_ror:8 row_mask:0xf bank_mask:0xf
  v_add_f32_dpp v36, v36, v36 row_ror:8 row_mask:0xf bank_mask:0xf
  v_add_f32_dpp v37, v37, v37 row_ror:8 row_mask:0xf bank_mask:0xf
  v_add_f32_dpp v38, v38, v38 row_ror:8 row_mask:0xf bank_mask:0xf
  v_add_f32_dpp v39, v39, v39 row_ror:8 row_mask:0xf bank_mask:0xf
  v_add_f32_dpp v32, v32, v32 row_ror:4 row_mask:0xf bank_mask:0xf
  v_add_f32_dpp v33, v33, v33 row_ror:4 row_mask:0xf bank_mask:0xf
  v_add_f32_dpp v34, v34, v34 row_ror:4 row_mask:0xf bank_mask:0xf
  v_add_f32_dpp v35, v35, v35 row_ror:4 row_mask:0xf bank_mask:0xf
  v_add_f32_dpp v36, v36, v36 row_ror:4 row_mask:0xf bank_mask:0xf
  v_add_f32_dpp v37, v37, v37 row_ror:4 row_mask:0xf bank_mask:0xf
  v_add_f32_dpp v38, v38, v38 row_ror:4 row_mask:0xf bank_mask:0xf
  v_add_f32_dpp v39, v39, v39 row_ror:4 row_mask:0xf bank_mask:0xf
  v_add_f32_dpp v32, v32, v32 row_ror:2 row_mask:0xf bank_mask:0xf
  v_add_f32_dpp v33, v33, v33 row_ror:2 row_mask:0xf bank_mask:0xf
  v_add_f32_dpp v34, v34, v34 row_ror:2 row_mask:0xf bank_mask:0xf
  v_add_f32_dpp v35, v35, v35 row_ror:2 row_mask:0xf bank_mask:0xf
  v_add_f32_dpp v36, v36, v36 row_ror:2 row_mask:0xf bank_mask:0xf
  v_add_f32_dpp v37, v37, v37 row_ror:2 row_mask:0xf bank_mask:0xf
  v_add_f32_dpp v38, v38, v38 row_ror:2 row_mask:0xf bank_mask:0xf
  v_add_f32_dpp v39, v39, v39 row_ror:2 row_mask:0xf bank_mask:0xf
  v_add_f32_dpp v32, v32, v32 row_ror:1 row_mask:0xf bank_mask:0xf
  v_add_f32_dpp v33, v33, v33 row_ror:1 row_mask:0xf bank_mask:0xf
  v_add_f32_dpp v34, v34, v34 row_ror:1 row_mask:0xf bank_mask:0xf
  v_add_f32_dpp v35, v35, v35 row_ror:1 row_mask:0xf bank_mask:0xf
  v_add_f32_dpp v36, v36, v36 row_ror:1 row_mask:0xf bank_mask:0xf
  v_add_f32_dpp v37, v37, v37 row_ror:1 row_mask:0xf bank_mask:0xf
  v_add_f32_dpp v38, v38, v38 row_ror:1 row_mask:0xf bank_mask:0xf
  v_add_f32_dpp v39, v39, v39 row_ror:1 row_mask:0xf bank_mask:0xf
  v_cvt_pk_bf16_f32 v48, v32, v33
  v_cvt_pk_bf16_f32 v49, v34, v35
  v_cvt_pk_bf16_f32 v50, v36, v37
  v_cvt_pk_bf16_f32 v51, v38, v39
  s_waitcnt vmcnt(0)
  s_mov_b32 s39, 4194304
K2_wkv:
  ds_read_b32 v8, v10 offset:0
  s_waitcnt lgkmcnt(0)
  v_readfirstlane_b32 s38, v8
  s_sub_u32 s39, s39, 1
  s_cbranch_scc1 K2_wkv_ok
  s_cmp_lt_u32 s38, 4
  s_cbranch_scc1 K2_wkv
K2_wkv_ok:
  ds_read_b128 v[40:43], v6
  ds_read_b128 v[44:47], v6 offset:1024
  s_waitcnt lgkmcnt(0)
  v_mfma_f32_16x16x32_bf16 v[72:75], v[48:51], v[16:19], 0
  v_mfma_f32_16x16x32_bf16 v[64:67], v[40:43], v[16:19], 0
  v_mfma_f32_16x16x32_bf16 v[68:71], v[44:47], v[16:19], 0
  v_mfma_f32_16x16x32_bf16 v[84:87], v[48:51], v[20:23], 0
  v_mfma_f32_16x16x32_bf16 v[76:79], v[40:43], v[20:23], 0
  v_mfma_f32_16x16x32_bf16 v[80:83], v[44:47], v[20:23], 0
  v_mfma_f32_16x16x32_bf16 v[96:99], v[48:51], v[24:27], 0
  v_mfma_f32_16x16x32_bf16 v[88:91], v[40:43], v[24:27], 0
  v_mfma_f32_16x16x32_bf16 v[92:95], v[44:47], v[24:27], 0
  v_mfma_f32_16x16x32_bf16 v[108:111], v[48:51], v[28:31], 0
  v_mfma_f32_16x16x32_bf16 v[100:103], v[40:43], v[28:31], 0
  v_mfma_f32_16x16x32_bf16 v[104:107], v[44:47], v[28:31], 0
  s_mov_b32 s38, s42
  v_add_f32 v112, s46, v72
  v_rcp_f32 v112, v112
  v_add_f32 v114, s46, v84
  v_rcp_f32 v114, v114
  v_add_f32 v116, s46, v96
  v_rcp_f32 v116, v116
  v_add_f32 v118, s46, v108
  v_rcp_f32 v118, v118
  v_mul_f32 v64, v64, v112
  v_mul_f32 v65, v65, v112
  v_mul_f32 v66, v66, v112
  v_mul_f32 v67, v67, v112
  v_mul_f32 v68, v68, v112
  v_mul_f32 v69, v69, v112
  v_mul_f32 v70, v70, v112
  v_mul_f32 v71, v71, v112
  v_cvt_pk_bf16_f32 v120, v64, v65
  v_cvt_pk_bf16_f32 v121, v66, v67
  v_cvt_pk_bf16_f32 v122, v68, v69
  v_cvt_pk_bf16_f32 v123, v70, v71
  v_or_b32 v120, 1, v120
  v_or_b32 v121, 1, v121
  v_or_b32 v122, 1, v122
  v_or_b32 v123, 1, v123
  buffer_store_dwordx4 v[120:123], v3, s[16:19], s38 offen sc1
  s_add_u32 s38, s38, 32768
  v_mul_f32 v76, v76, v114
  v_mul_f32 v77, v77, v114
  v_mul_f32 v78, v78, v114
  v_mul_f32 v79, v79, v114
  v_mul_f32 v80, v80, v114
  v_mul_f32 v81, v81, v114
  v_mul_f32 v82, v82, v114
  v_mul_f32 v83, v83, v114
  v_cvt_pk_bf16_f32 v124, v76, v77
  v_cvt_pk_bf16_f32 v125, v78, v79
  v_cvt_pk_bf16_f32 v126, v80, v81
  v_cvt_pk_bf16_f32 v127, v82, v83
  v_or_b32 v124, 1, v124
  v_or_b32 v125, 1, v125
  v_or_b32 v126, 1, v126
  v_or_b32 v127, 1, v127
  buffer_store_dwordx4 v[124:127], v3, s[16:19], s38 offen sc1
  s_add_u32 s38, s38, 32768
  v_mul_f32 v88, v88, v116
  v_mul_f32 v89, v89, v116
  v_mul_f32 v90, v90, v116
  v_mul_f32 v91, v91, v116
  v_mul_f32 v92, v92, v116
  v_mul_f32 v93, v93, v116
  v_mul_f32 v94, v94, v116
  v_mul_f32 v95, v95, v116
  v_cvt_pk_bf16_f32 v128, v88, v89
  v_cvt_pk_bf16_f32 v129, v90, v91
  v_cvt_pk_bf16_f32 v130, v92, v93
  v_cvt_pk_bf16_f32 v131, v94, v95
  v_or_b32 v128, 1, v128
  v_or_b32 v129, 1, v129
  v_or_b32 v130, 1, v130
  v_or_b32 v131, 1, v131
  buffer_store_dwordx4 v[128:131], v3, s[16:19], s38 offen sc1
  s_add_u32 s38, s38, 32768
  v_mul_f32 v100, v100, v118
  v_mul_f32 v101, v101, v118
  v_mul_f32 v102, v102, v118
  v_mul_f32 v103, v103, v118
  v_mul_f32 v104, v104, v118
  v_mul_f32 v105, v105, v118
  v_mul_f32 v106, v106, v118
  v_mul_f32 v107, v107, v118
  v_cvt_pk_bf16_f32 v132, v100, v101
  v_cvt_pk_bf16_f32 v133, v102, v103
  v_cvt_pk_bf16_f32 v134, v104, v105
  v_cvt_pk_bf16_f32 v135, v106, v107
  v_or_b32 v132, 1, v132
  v_or_b32 v133, 1, v133
  v_or_b32 v134, 1, v134
  v_or_b32 v135, 1, v135
  buffer_store_dwordx4 v[132:135], v3, s[16:19], s38 offen sc1
  s_add_u32 s38, s38, 32768
  s_add_u32 m0, s59, 0
  s_nop 0
  buffer_load_dwordx4 v240, s[20:23], s58 offen offset:0 lds
  buffer_load_dwordx4 v241, s[20:23], s58 offen offset:1024 lds
  buffer_load_dwordx4 v242, s[20:23], s58 offen offset:2048 lds
  buffer_load_dwordx4 v243, s[20:23], s58 offen offset:3072 lds
  s_add_u32 s58, s58, 262144
  s_add_u32 m0, s59, 16384
  s_nop 0
  buffer_load_dwordx4 v240, s[20:23], s58 offen offset:0 lds
  buffer_load_dwordx4 v241, s[20:23], s58 offen offset:1024 lds
  buffer_load_dwordx4 v242, s[20:23], s58 offen offset:2048 lds
  buffer_load_dwordx4 v243, s[20:23], s58 offen offset:3072 lds
  s_add_u32 s58, s58, 262144
  s_add_u32 m0, s59, 32768
  s_nop 0
  buffer_load_dwordx4 v240, s[20:23], s58 offen offset:0 lds
  buffer_load_dwordx4 v241, s[20:23], s58 offen offset:1024 lds
  buffer_load_dwordx4 v242, s[20:23], s58 offen offset:2048 lds
  buffer_load_dwordx4 v243, s[20:23], s58 offen offset:3072 lds
  s_add_u32 s58, s58, 262144
  s_add_u32 m0, s59, 49152
  s_nop 0
  buffer_load_dwordx4 v240, s[20:23], s58 offen offset:0 lds
  buffer_load_dwordx4 v241, s[20:23], s58 offen offset:1024 lds
  buffer_load_dwordx4 v242, s[20:23], s58 offen offset:2048 lds
  buffer_load_dwordx4 v243, s[20:23], s58 offen offset:3072 lds
  s_add_u32 s58, s58, 262144
  s_add_u32 m0, s59, 65536
  s_nop 0
  buffer_load_dwordx4 v240, s[20:23], s58 offen offset:0 lds
  buffer_load_dwordx4 v241, s[20:23], s58 offen offset:1024 lds
  buffer_load_dwordx4 v242, s[20:23], s58 offen offset:2048 lds
  buffer_load_dwordx4 v243, s[20:23], s58 offen offset:3072 lds
  s_add_u32 s58, s58, 262144
  s_add_u32 m0, s59, 81920
  s_nop 0
  buffer_load_dwordx4 v240, s[20:23], s58 offen offset:0 lds
  buffer_load_dwordx4 v241, s[20:23], s58 offen offset:1024 lds
  buffer_load_dwordx4 v242, s[20:23], s58 offen offset:2048 lds
  buffer_load_dwordx4 v243, s[20:23], s58 offen offset:3072 lds
  s_add_u32 s58, s58, 262144
  s_add_u32 m0, s59, 98304
  s_nop 0
  buffer_load_dwordx4 v240, s[20:23], s58 offen offset:0 lds
  buffer_load_dwordx4 v241, s[20:23], s58 offen offset:1024 lds
  buffer_load_dwordx4 v242, s[20:23], s58 offen offset:2048 lds
  buffer_load_dwordx4 v243, s[20:23], s58 offen offset:3072 lds
  s_add_u32 s58, s58, 262144
  v_bfe_u32 v4, v2, 2, 2
  v_and_b32 v5, 3, v2
  v_lshlrev_b32 v4, 6, v4
  v_lshl_add_u32 v4, v5, 3, v4
  v_lshrrev_b32 v5, 5, v2
  v_lshl_add_u32 v4, v5, 9, v4
  v_and_b32 v6, 1, v14
  v_xor_b32 v7, v6, v5
  v_lshl_add_u32 v4, v7, 5, v4
  v_add_u32 v8, 0x10000, v4
  v_add_u32 v9, 114688, v4
  v_lshlrev_b32 v12, 15, v6
  v_lshl_add_u32 v12, v5, 8, v12
  v_lshl_add_u32 v12, v15, 4, v12
  s_and_b32 s40, s10, 3
  s_lshl_b32 s40, s40, 2
  s_add_u32 s40, s40, s36
  s_lshr_b32 s36, s10, 2
  s_lshl_b32 s36, s36, 3
  s_add_u32 s36, s36, s37
  s_waitcnt vmcnt(0)
  v_mov_b32 v7, 1
  s_mov_b64 exec, 1
  ds_add_u32 v10, v7 offset:24
  s_mov_b64 exec, -1
  s_lshl_b32 s41, s40, 3
  s_lshl_b32 s42, s3, 1
  s_add_u32 s41, s41, s42
  s_lshl_b32 s42, s41, 15
  s_mov_b32 s44, s42
  buffer_load_dwordx4 v[96:99], v12, s[16:19], s42 offen offset:0
  buffer_load_dwordx4 v[100:103], v12, s[16:19], s42 offen offset:512
  buffer_load_dwordx4 v[104:107], v12, s[16:19], s42 offen offset:1024
  buffer_load_dwordx4 v[108:111], v12, s[16:19], s42 offen offset:1536
  buffer_load_dwordx4 v[112:115], v12, s[16:19], s42 offen offset:2048
  buffer_load_dwordx4 v[116:119], v12, s[16:19], s42 offen offset:2560
  buffer_load_dwordx4 v[120:123], v12, s[16:19], s42 offen offset:3072
  buffer_load_dwordx4 v[124:127], v12, s[16:19], s42 offen offset:3584
  s_add_u32 s42, s42, 4096
  buffer_load_dwordx4 v[128:131], v12, s[16:19], s42 offen offset:0
  buffer_load_dwordx4 v[132:135], v12, s[16:19], s42 offen offset:512
  buffer_load_dwordx4 v[136:139], v12, s[16:19], s42 offen offset:1024
  buffer_load_dwordx4 v[140:143], v12, s[16:19], s42 offen offset:1536
  buffer_load_dwordx4 v[144:147], v12, s[16:19], s42 offen offset:2048
  buffer_load_dwordx4 v[148:151], v12, s[16:19], s42 offen offset:2560
  buffer_load_dwordx4 v[152:155], v12, s[16:19], s42 offen offset:3072
  buffer_load_dwordx4 v[156:159], v12, s[16:19], s42 offen offset:3584
  s_add_u32 s42, s42, 4096
  buffer_load_dwordx4 v[160:163], v12, s[16:19], s42 offen offset:0
  buffer_load_dwordx4 v[164:167], v12, s[16:19], s42 offen offset:512
  buffer_load_dwordx4 v[168:171], v12, s[16:19], s42 offen offset:1024
  buffer_load_dwordx4 v[172:175], v12, s[16:19], s42 offen offset:1536
  buffer_load_dwordx4 v[176:179], v12, s[16:19], s42 offen offset:2048
  buffer_load_dwordx4 v[180:183], v12, s[16:19], s42 offen offset:2560
  buffer_load_dwordx4 v[184:187], v12, s[16:19], s42 offen offset:3072
  buffer_load_dwordx4 v[188:191], v12, s[16:19], s42 offen offset:3584
  s_add_u32 s42, s42, 4096
  buffer_load_dwordx4 v[192:195], v12, s[16:19], s42 offen offset:0
  buffer_load_dwordx4 v[196:199], v12, s[16:19], s42 offen offset:512
  buffer_load_dwordx4 v[200:203], v12, s[16:19], s42 offen offset:1024
  buffer_load_dwordx4 v[204:207], v12, s[16:19], s42 offen offset:1536
  buffer_load_dwordx4 v[208:211], v12, s[16:19], s42 offen offset:2048
  buffer_load_dwordx4 v[212:215], v12, s[16:19], s42 offen offset:2560
  buffer_load_dwordx4 v[216:219], v12, s[16:19], s42 offen offset:3072
  buffer_load_dwordx4 v[220:223], v12, s[16:19], s42 offen offset:3584
  s_add_u32 s42, s42, 4096
  s_setprio 0
  s_mov_b32 s39, 4194304
K2_wwo:
  ds_read_b32 v16, v10 offset:24
  s_waitcnt lgkmcnt(0)
  v_readfirstlane_b32 s38, v16
  s_sub_u32 s39, s39, 1
  s_cbranch_scc1 K2_wwo_ok
  s_cmp_lt_u32 s38, 4
  s_cbranch_scc1 K2_wwo
K2_wwo_ok:
  ds_read_b64_tr_b16 v[48:49], v4 offset:0
  ds_read_b64_tr_b16 v[50:51], v4 offset:2048
  ds_read_b64_tr_b16 v[52:53], v4 offset:256
  ds_read_b64_tr_b16 v[54:55], v4 offset:2304
  ds_read_b64_tr_b16 v[56:57], v4 offset:1024
  ds_read_b64_tr_b16 v[58:59], v4 offset:3072
  ds_read_b64_tr_b16 v[60:61], v4 offset:1280
  ds_read_b64_tr_b16 v[62:63], v4 offset:3328
  s_waitcnt vmcnt(24)
  v_bitop3_b32 v81, v96, v97, v98 bitop3:0x80
  v_bitop3_b32 v81, v81, v99, v100 bitop3:0x80
  v_bitop3_b32 v81, v81, v101, v102 bitop3:0x80
  v_bitop3_b32 v81, v81, v103, v104 bitop3:0x80
  v_bitop3_b32 v81, v81, v105, v106 bitop3:0x80
  v_bitop3_b32 v81, v81, v107, v108 bitop3:0x80
  v_bitop3_b32 v81, v81, v109, v110 bitop3:0x80
  v_bitop3_b32 v81, v81, v111, v112 bitop3:0x80
  v_bitop3_b32 v81, v81, v113, v114 bitop3:0x80
  v_bitop3_b32 v81, v81, v115, v116 bitop3:0x80
  v_bitop3_b32 v81, v81, v117, v118 bitop3:0x80
  v_bitop3_b32 v81, v81, v119, v120 bitop3:0x80
  v_bitop3_b32 v81, v81, v121, v122 bitop3:0x80
  v_bitop3_b32 v81, v81, v123, v124 bitop3:0x80
  v_bitop3_b32 v81, v81, v125, v126 bitop3:0x80
  v_bitop3_b32 v81, v81, v127, 1 bitop3:0x80
  v_cmp_eq_u32 vcc, 0, v81
  s_nop 0
  s_cmp_lg_u64 vcc, 0
  s_cbranch_scc1 K2_retry0
K2_retry0_ret:
  s_waitcnt lgkmcnt(6)
  v_mfma_f32_32x32x16_bf16 v[16:31], v[48:51], v[96:99], 0
  ds_read_b64_tr_b16 v[64:65], v4 offset:4096
  ds_read_b64_tr_b16 v[66:67], v4 offset:6144
  s_waitcnt lgkmcnt(6)
  v_mfma_f32_32x32x16_bf16 v[32:47], v[52:55], v[96:99], 0
  ds_read_b64_tr_b16 v[68:69], v4 offset:4352
  ds_read_b64_tr_b16 v[70:71], v4 offset:6400
  s_waitcnt lgkmcnt(6)
  v_mfma_f32_32x32x16_bf16 v[16:31], v[56:59], v[100:103], v[16:31]
  ds_read_b64_tr_b16 v[72:73], v4 offset:5120
  ds_read_b64_tr_b16 v[74:75], v4 offset:7168
  s_waitcnt lgkmcnt(6)
  v_mfma_f32_32x32x16_bf16 v[32:47], v[60:63], v[100:103], v[32:47]
  ds_read_b64_tr_b16 v[76:77], v4 offset:5376
  ds_read_b64_tr_b16 v[78:79], v4 offset:7424
  buffer_load_dwordx4 v[96:99], v12, s[16:19], s42 offen offset:0
  buffer_load_dwordx4 v[100:103], v12, s[16:19], s42 offen offset:512
  s_waitcnt lgkmcnt(6)
  v_mfma_f32_32x32x16_bf16 v[16:31], v[64:67], v[104:107], v[16:31]
  ds_read_b64_tr_b16 v[48:49], v4 offset:8192
  ds_read_b64_tr_b16 v[50:51], v4 offset:10240
  s_waitcnt lgkmcnt(6)
  v_mfma_f32_32x32x16_bf16 v[32:47], v[68:71], v[104:107], v[32:47]
  ds_read_b64_tr_b16 v[52:53], v4 offset:8448
  ds_read_b64_tr_b16 v[54:55], v4 offset:10496
  s_waitcnt lgkmcnt(6)
  v_mfma_f32_32x32x16_bf16 v[16:31], v[72:75], v[108:111], v[16:31]
  ds_read_b64_tr_b16 v[56:57], v4 offset:9216
  ds_read_b64_tr_b16 v[58:59], v4 offset:11264
  s_waitcnt lgkmcnt(6)
  v_mfma_f32_32x32x16_bf16 v[32:47], v[76:79], v[108:111], v[32:47]
  ds_read_b64_tr_b16 v[60:61], v4 offset:9472
  ds_read_b64_tr_b16 v[62:63], v4 offset:11520
  buffer_load_dwordx4 v[104:107], v12, s[16:19], s42 offen offset:1024
  buffer_load_dwordx4 v[108:111], v12, s[16:19], s42 offen offset:1536
  s_waitcnt vmcnt(20)
  s_waitcnt lgkmcnt(6)
  v_mfma_f32_32x32x16_bf16 v[16:31], v[48:51], v[112:115], v[16:31]
  ds_read_b64_tr_b16 v[64:65], v4 offset:12288
  v_bitop3_b32 v81, v128, v129, v130 bitop3:0x80
  ds_read_b64_tr_b16 v[66:67], v4 offset:14336
  v_bitop3_b32 v81, v81, v131, v132 bitop3:0x80
  s_waitcnt lgkmcnt(6)
  v_mfma_f32_32x32x16_bf16 v[32:47], v[52:55], v[112:115], v[32:47]
  ds_read_b64_tr_b16 v[68:69], v4 offset:12544
  v_bitop3_b32 v81, v81, v133, v134 bitop3:0x80
  ds_read_b64_tr_b16 v[70:71], v4 offset:14592
  v_bitop3_b32 v81, v81, v135, v136 bitop3:0x80
  s_waitcnt lgkmcnt(6)
  v_mfma_f32_32x32x16_bf16 v[16:31], v[56:59], v[116:119], v[16:31]
  ds_read_b64_tr_b16 v[72:73], v4 offset:13312
  v_bitop3_b32 v81, v81, v137, v138 bitop3:0x80
  ds_read_b64_tr_b16 v[74:75], v4 offset:15360
  v_bitop3_b32 v81, v81, v139, v140 bitop3:0x80
  s_waitcnt lgkmcnt(6)
  v_mfma_f32_32x32x16_bf16 v[32:47], v[60:63], v[116:119], v[32:47]
  ds_read_b64_tr_b16 v[76:77], v4 offset:13568
  v_bitop3_b32 v81, v81, v141, v142 bitop3:0x80
  ds_read_b64_tr_b16 v[78:79], v4 offset:15616
  v_bitop3_b32 v81, v81, v143, v144 bitop3:0x80
  buffer_load_dwordx4 v[112:115], v12, s[16:19], s42 offen offset:2048
  buffer_load_dwordx4 v[116:119], v12, s[16:19], s42 offen offset:2560
  s_waitcnt lgkmcnt(6)
  v_mfma_f32_32x32x16_bf16 v[16:31], v[64:67], v[120:123], v[16:31]
  ds_read_b64_tr_b16 v[48:49], v4 offset:16384
  v_bitop3_b32 v81, v81, v145, v146 bitop3:0x80
  ds_read_b64_tr_b16 v[50:51], v4 offset:18432
  v_bitop3_b32 v81, v81, v147, v148 bitop3:0x80
  s_waitcnt lgkmcnt(6)
  v_mfma_f32_32x32x16_bf16 v[32:47], v[68:71], v[120:123], v[32:47]
  ds_read_b64_tr_b16 v[52:53], v4 offset:16640
  v_bitop3_b32 v81, v81, v149, v150 bitop3:0x80
  ds_read_b64_tr_b16 v[54:55], v4 offset:18688
  v_bitop3_b32 v81, v81, v151, v152 bitop3:0x80
  s_waitcnt lgkmcnt(6)
  v_mfma_f32_32x32x16_bf16 v[16:31], v[72:75], v[124:127], v[16:31]
  ds_read_b64_tr_b16 v[56:57], v4 offset:17408
  v_bitop3_b32 v81, v81, v153, v154 bitop3:0x80
  ds_read_b64_tr_b16 v[58:59], v4 offset:19456
  v_bitop3_b32 v81, v81, v155, v156 bitop3:0x80
  s_waitcnt lgkmcnt(6)
  v_mfma_f32_32x32x16_bf16 v[32:47], v[76:79], v[124:127], v[32:47]
  ds_read_b64_tr_b16 v[60:61], v4 offset:17664
  v_bitop3_b32 v81, v81, v157, v158 bitop3:0x80
  ds_read_b64_tr_b16 v[62:63], v4 offset:19712
  v_bitop3_b32 v81, v81, v159, 1 bitop3:0x80
  v_cmp_eq_u32 vcc, 0, v81
  s_nop 0
  s_cmp_lg_u64 vcc, 0
  s_cbranch_scc1 K2_retry1
K2_retry1_ret:
  buffer_load_dwordx4 v[120:123], v12, s[16:19], s42 offen offset:3072
  buffer_load_dwordx4 v[124:127], v12, s[16:19], s42 offen offset:3584
  s_add_u32 s42, s42, 4096
  s_waitcnt lgkmcnt(6)
  v_mfma_f32_32x32x16_bf16 v[16:31], v[48:51], v[128:131], v[16:31]
  ds_read_b64_tr_b16 v[64:65], v4 offset:20480
  ds_read_b64_tr_b16 v[66:67], v4 offset:22528
  s_waitcnt lgkmcnt(6)
  v_mfma_f32_32x32x16_bf16 v[32:47], v[52:55], v[128:131], v[32:47]
  ds_read_b64_tr_b16 v[68:69], v4 offset:20736
  ds_read_b64_tr_b16 v[70:71], v4 offset:22784
  s_waitcnt lgkmcnt(6)
  v_mfma_f32_32x32x16_bf16 v[16:31], v[56:59], v[132:135], v[16:31]
  ds_read_b64_tr_b16 v[72:73], v4 offset:21504
  ds_read_b64_tr_b16 v[74:75], v4 offset:23552
  s_waitcnt lgkmcnt(6)
  v_mfma_f32_32x32x16_bf16 v[32:47], v[60:63], v[132:135], v[32:47]
  ds_read_b64_tr_b16 v[76:77], v4 offset:21760
  ds_read_b64_tr_b16 v[78:79], v4 offset:23808
  buffer_load_dwordx4 v[128:131], v12, s[16:19], s42 offen offset:0
  buffer_load_dwordx4 v[132:135], v12, s[16:19], s42 offen offset:512
  s_waitcnt lgkmcnt(6)
  v_mfma_f32_32x32x16_bf16 v[16:31], v[64:67], v[136:139], v[16:31]
  ds_read_b64_tr_b16 v[48:49], v4 offset:24576
  ds_read_b64_tr_b16 v[50:51], v4 offset:26624
  s_waitcnt lgkmcnt(6)
  v_mfma_f32_32x32x16_bf16 v[32:47], v[68:71], v[136:139], v[32:47]
  ds_read_b64_tr_b16 v[52:53], v4 offset:24832
  ds_read_b64_tr_b16 v[54:55], v4 offset:26880
  s_waitcnt lgkmcnt(6)
  v_mfma_f32_32x32x16_bf16 v[16:31], v[72:75], v[140:143], v[16:31]
  ds_read_b64_tr_b16 v[56:57], v4 offset:25600
  ds_read_b64_tr_b16 v[58:59], v4 offset:27648
  s_waitcnt lgkmcnt(6)
  v_mfma_f32_32x32x16_bf16 v[32:47], v[76:79], v[140:143], v[32:47]
  ds_read_b64_tr_b16 v[60:61], v4 offset:25856
  ds_read_b64_tr_b16 v[62:63], v4 offset:27904
  buffer_load_dwordx4 v[136:139], v12, s[16:19], s42 offen offset:1024
  buffer_load_dwordx4 v[140:143], v12, s[16:19], s42 offen offset:1536
  s_waitcnt vmcnt(20)
  s_waitcnt lgkmcnt(6)
  v_mfma_f32_32x32x16_bf16 v[16:31], v[48:51], v[144:147], v[16:31]
  ds_read_b64_tr_b16 v[64:65], v4 offset:28672
  v_bitop3_b32 v81, v160, v161, v162 bitop3:0x80
  ds_read_b64_tr_b16 v[66:67], v4 offset:30720
  v_bitop3_b32 v81, v81, v163, v164 bitop3:0x80
  s_waitcnt lgkmcnt(6)
  v_mfma_f32_32x32x16_bf16 v[32:47], v[52:55], v[144:147], v[32:47]
  ds_read_b64_tr_b16 v[68:69], v4 offset:28928
  v_bitop3_b32 v81, v81, v165, v166 bitop3:0x80
  ds_read_b64_tr_b16 v[70:71], v4 offset:30976
  v_bitop3_b32 v81, v81, v167, v168 bitop3:0x80
  s_waitcnt lgkmcnt(6)
  v_mfma_f32_32x32x16_bf16 v[16:31], v[56:59], v[148:151], v[16:31]
  ds_read_b64_tr_b16 v[72:73], v4 offset:29696
  v_bitop3_b32 v81, v81, v169, v170 bitop3:0x80
  ds_read_b64_tr_b16 v[74:75], v4 offset:31744
  v_bitop3_b32 v81, v81, v171, v172 bitop3:0x80
  s_waitcnt lgkmcnt(6)
  v_mfma_f32_32x32x16_bf16 v[32:47], v[60:63], v[148:151], v[32:47]
  ds_read_b64_tr_b16 v[76:77], v4 offset:29952
  v_bitop3_b32 v81, v81, v173, v174 bitop3:0x80
  ds_read_b64_tr_b16 v[78:79], v4 offset:32000
  v_bitop3_b32 v81, v81, v175, v176 bitop3:0x80
  buffer_load_dwordx4 v[144:147], v12, s[16:19], s42 offen offset:2048
  buffer_load_dwordx4 v[148:151], v12, s[16:19], s42 offen offset:2560
  s_waitcnt lgkmcnt(6)
  v_mfma_f32_32x32x16_bf16 v[16:31], v[64:67], v[152:155], v[16:31]
  ds_read_b64_tr_b16 v[48:49], v4 offset:32768
  v_bitop3_b32 v81, v81, v177, v178 bitop3:0x80
  ds_read_b64_tr_b16 v[50:51], v4 offset:34816
  v_bitop3_b32 v81, v81, v179, v180 bitop3:0x80
  s_waitcnt lgkmcnt(6)
  v_mfma_f32_32x32x16_bf16 v[32:47], v[68:71], v[152:155], v[32:47]
  ds_read_b64_tr_b16 v[52:53], v4 offset:33024
  v_bitop3_b32 v81, v81, v181, v182 bitop3:0x80
  ds_read_b64_tr_b16 v[54:55], v4 offset:35072
  v_bitop3_b32 v81, v81, v183, v184 bitop3:0x80
  s_waitcnt lgkmcnt(6)
  v_mfma_f32_32x32x16_bf16 v[16:31], v[72:75], v[156:159], v[16:31]
  ds_read_b64_tr_b16 v[56:57], v4 offset:33792
  v_bitop3_b32 v81, v81, v185, v186 bitop3:0x80
  ds_read_b64_tr_b16 v[58:59], v4 offset:35840
  v_bitop3_b32 v81, v81, v187, v188 bitop3:0x80
  s_waitcnt lgkmcnt(6)
  v_mfma_f32_32x32x16_bf16 v[32:47], v[76:79], v[156:159], v[32:47]
  ds_read_b64_tr_b16 v[60:61], v4 offset:34048
  v_bitop3_b32 v81, v81, v189, v190 bitop3:0x80
  ds_read_b64_tr_b16 v[62:63], v4 offset:36096
  v_bitop3_b32 v81, v81, v191, 1 bitop3:0x80
  v_cmp_eq_u32 vcc, 0, v81
  s_nop 0
  s_cmp_lg_u64 vcc, 0
  s_cbranch_scc1 K2_retry2
K2_retry2_ret:
  buffer_load_dwordx4 v[152:155], v12, s[16:19], s42 offen offset:3072
  buffer_load_dwordx4 v[156:159], v12, s[16:19], s42 offen offset:3584
  s_add_u32 s42, s42, 4096
  s_waitcnt lgkmcnt(6)
  v_mfma_f32_32x32x16_bf16 v[16:31], v[48:51], v[160:163], v[16:31]
  ds_read_b64_tr_b16 v[64:65], v4 offset:36864
  ds_read_b64_tr_b16 v[66:67], v4 offset:38912
  s_waitcnt lgkmcnt(6)
  v_mfma_f32_32x32x16_bf16 v[32:47], v[52:55], v[160:163], v[32:47]
  ds_read_b64_tr_b16 v[68:69], v4 offset:37120
  ds_read_b64_tr_b16 v[70:71], v4 offset:39168
  s_waitcnt lgkmcnt(6)
  v_mfma_f32_32x32x16_bf16 v[16:31], v[56:59], v[164:167], v[16:31]
  ds_read_b64_tr_b16 v[72:73], v4 offset:37888
  ds_read_b64_tr_b16 v[74:75], v4 offset:39936
  s_waitcnt lgkmcnt(6)
  v_mfma_f32_32x32x16_bf16 v[32:47], v[60:63], v[164:167], v[32:47]
  ds_read_b64_tr_b16 v[76:77], v4 offset:38144
  ds_read_b64_tr_b16 v[78:79], v4 offset:40192
  buffer_load_dwordx4 v[160:163], v12, s[16:19], s42 offen offset:0
  buffer_load_dwordx4 v[164:167], v12, s[16:19], s42 offen offset:512
  s_waitcnt lgkmcnt(6)
  v_mfma_f32_32x32x16_bf16 v[16:31], v[64:67], v[168:171], v[16:31]
  ds_read_b64_tr_b16 v[48:49], v4 offset:40960
  ds_read_b64_tr_b16 v[50:51], v4 offset:43008
  s_waitcnt lgkmcnt(6)
  v_mfma_f32_32x32x16_bf16 v[32:47], v[68:71], v[168:171], v[32:47]
  ds_read_b64_tr_b16 v[52:53], v4 offset:41216
  ds_read_b64_tr_b16 v[54:55], v4 offset:43264
  s_waitcnt lgkmcnt(6)
  v_mfma_f32_32x32x16_bf16 v[16:31], v[72:75], v[172:175], v[16:31]
  ds_read_b64_tr_b16 v[56:57], v4 offset:41984
  ds_read_b64_tr_b16 v[58:59], v4 offset:44032
  s_waitcnt lgkmcnt(6)
  v_mfma_f32_32x32x16_bf16 v[32:47], v[76:79], v[172:175], v[32:47]
  ds_read_b64_tr_b16 v[60:61], v4 offset:42240
  ds_read_b64_tr_b16 v[62:63], v4 offset:44288
  buffer_load_dwordx4 v[168:171], v12, s[16:19], s42 offen offset:1024
  buffer_load_dwordx4 v[172:175], v12, s[16:19], s42 offen offset:1536
  s_waitcnt vmcnt(20)
  s_waitcnt lgkmcnt(6)
  v_mfma_f32_32x32x16_bf16 v[16:31], v[48:51], v[176:179], v[16:31]
  ds_read_b64_tr_b16 v[64:65], v4 offset:45056
  v_bitop3_b32 v81, v192, v193, v194 bitop3:0x80
  ds_read_b64_tr_b16 v[66:67], v4 offset:47104
  v_bitop3_b32 v81, v81, v195, v196 bitop3:0x80
  s_waitcnt lgkmcnt(6)
  v_mfma_f32_32x32x16_bf16 v[32:47], v[52:55], v[176:179], v[32:47]
  ds_read_b64_tr_b16 v[68:69], v4 offset:45312
  v_bitop3_b32 v81, v81, v197, v198 bitop3:0x80
  ds_read_b64_tr_b16 v[70:71], v4 offset:47360
  v_bitop3_b32 v81, v81, v199, v200 bitop3:0x80
  s_waitcnt lgkmcnt(6)
  v_mfma_f32_32x32x16_bf16 v[16:31], v[56:59], v[180:183], v[16:31]
  ds_read_b64_tr_b16 v[72:73], v4 offset:46080
  v_bitop3_b32 v81, v81, v201, v202 bitop3:0x80
  ds_read_b64_tr_b16 v[74:75], v4 offset:48128
  v_bitop3_b32 v81, v81, v203, v204 bitop3:0x80
  s_waitcnt lgkmcnt(6)
  v_mfma_f32_32x32x16_bf16 v[32:47], v[60:63], v[180:183], v[32:47]
  ds_read_b64_tr_b16 v[76:77], v4 offset:46336
  v_bitop3_b32 v81, v81, v205, v206 bitop3:0x80
  ds_read_b64_tr_b16 v[78:79], v4 offset:48384
  v_bitop3_b32 v81, v81, v207, v208 bitop3:0x80
  buffer_load_dwordx4 v[176:179], v12, s[16:19], s42 offen offset:2048
  buffer_load_dwordx4 v[180:183], v12, s[16:19], s42 offen offset:2560
  s_waitcnt lgkmcnt(6)
  v_mfma_f32_32x32x16_bf16 v[16:31], v[64:67], v[184:187], v[16:31]
  ds_read_b64_tr_b16 v[48:49], v4 offset:49152
  v_bitop3_b32 v81, v81, v209, v210 bitop3:0x80
  ds_read_b64_tr_b16 v[50:51], v4 offset:51200
  v_bitop3_b32 v81, v81, v211, v212 bitop3:0x80
  s_waitcnt lgkmcnt(6)
  v_mfma_f32_32x32x16_bf16 v[32:47], v[68:71], v[184:187], v[32:47]
  ds_read_b64_tr_b16 v[52:53], v4 offset:49408
  v_bitop3_b32 v81, v81, v213, v214 bitop3:0x80
  ds_read_b64_tr_b16 v[54:55], v4 offset:51456
  v_bitop3_b32 v81, v81, v215, v216 bitop3:0x80
  s_waitcnt lgkmcnt(6)
  v_mfma_f32_32x32x16_bf16 v[16:31], v[72:75], v[188:191], v[16:31]
  ds_read_b64_tr_b16 v[56:57], v4 offset:50176
  v_bitop3_b32 v81, v81, v217, v218 bitop3:0x80
  ds_read_b64_tr_b16 v[58:59], v4 offset:52224
  v_bitop3_b32 v81, v81, v219, v220 bitop3:0x80
  s_waitcnt lgkmcnt(6)
  v_mfma_f32_32x32x16_bf16 v[32:47], v[76:79], v[188:191], v[32:47]
  ds_read_b64_tr_b16 v[60:61], v4 offset:50432
  v_bitop3_b32 v81, v81, v221, v222 bitop3:0x80
  ds_read_b64_tr_b16 v[62:63], v4 offset:52480
  v_bitop3_b32 v81, v81, v223, 1 bitop3:0x80
  v_cmp_eq_u32 vcc, 0, v81
  s_nop 0
  s_cmp_lg_u64 vcc, 0
  s_cbranch_scc1 K2_retry3
K2_retry3_ret:
  buffer_load_dwordx4 v[184:187], v12, s[16:19], s42 offen offset:3072
  buffer_load_dwordx4 v[188:191], v12, s[16:19], s42 offen offset:3584
  s_add_u32 s42, s42, 4096
  s_waitcnt lgkmcnt(6)
  v_mfma_f32_32x32x16_bf16 v[16:31], v[48:51], v[192:195], v[16:31]
  ds_read_b64_tr_b16 v[64:65], v4 offset:53248
  ds_read_b64_tr_b16 v[66:67], v4 offset:55296
  s_waitcnt lgkmcnt(6)
  v_mfma_f32_32x32x16_bf16 v[32:47], v[52:55], v[192:195], v[32:47]
  ds_read_b64_tr_b16 v[68:69], v4 offset:53504
  ds_read_b64_tr_b16 v[70:71], v4 offset:55552
  s_waitcnt lgkmcnt(6)
  v_mfma_f32_32x32x16_bf16 v[16:31], v[56:59], v[196:199], v[16:31]
  ds_read_b64_tr_b16 v[72:73], v4 offset:54272
  ds_read_b64_tr_b16 v[74:75], v4 offset:56320
  s_waitcnt lgkmcnt(6)
  v_mfma_f32_32x32x16_bf16 v[32:47], v[60:63], v[196:199], v[32:47]
  ds_read_b64_tr_b16 v[76:77], v4 offset:54528
  ds_read_b64_tr_b16 v[78:79], v4 offset:56576
  buffer_load_dwordx4 v[192:195], v12, s[16:19], s42 offen offset:0
  buffer_load_dwordx4 v[196:199], v12, s[16:19], s42 offen offset:512
  s_waitcnt lgkmcnt(6)
  v_mfma_f32_32x32x16_bf16 v[16:31], v[64:67], v[200:203], v[16:31]
  ds_read_b64_tr_b16 v[48:49], v4 offset:57344
  ds_read_b64_tr_b16 v[50:51], v4 offset:59392
  s_waitcnt lgkmcnt(6)
  v_mfma_f32_32x32x16_bf16 v[32:47], v[68:71], v[200:203], v[32:47]
  ds_read_b64_tr_b16 v[52:53], v4 offset:57600
  ds_read_b64_tr_b16 v[54:55], v4 offset:59648
  s_waitcnt lgkmcnt(6)
  v_mfma_f32_32x32x16_bf16 v[16:31], v[72:75], v[204:207], v[16:31]
  ds_read_b64_tr_b16 v[56:57], v4 offset:58368
  ds_read_b64_tr_b16 v[58:59], v4 offset:60416
  s_waitcnt lgkmcnt(6)
  v_mfma_f32_32x32x16_bf16 v[32:47], v[76:79], v[204:207], v[32:47]
  ds_read_b64_tr_b16 v[60:61], v4 offset:58624
  ds_read_b64_tr_b16 v[62:63], v4 offset:60672
  buffer_load_dwordx4 v[200:203], v12, s[16:19], s42 offen offset:1024
  buffer_load_dwordx4 v[204:207], v12, s[16:19], s42 offen offset:1536
  s_waitcnt vmcnt(20)
  s_waitcnt lgkmcnt(6)
  v_mfma_f32_32x32x16_bf16 v[16:31], v[48:51], v[208:211], v[16:31]
  ds_read_b64_tr_b16 v[64:65], v4 offset:61440
  v_bitop3_b32 v81, v96, v97, v98 bitop3:0x80
  ds_read_b64_tr_b16 v[66:67], v4 offset:63488
  v_bitop3_b32 v81, v81, v99, v100 bitop3:0x80
  s_waitcnt lgkmcnt(6)
  v_mfma_f32_32x32x16_bf16 v[32:47], v[52:55], v[208:211], v[32:47]
  ds_read_b64_tr_b16 v[68:69], v4 offset:61696
  v_bitop3_b32 v81, v81, v101, v102 bitop3:0x80
  ds_read_b64_tr_b16 v[70:71], v4 offset:63744
  v_bitop3_b32 v81, v81, v103, v104 bitop3:0x80
  s_waitcnt lgkmcnt(6)
  v_mfma_f32_32x32x16_bf16 v[16:31], v[56:59], v[212:215], v[16:31]
  ds_read_b64_tr_b16 v[72:73], v4 offset:62464
  v_bitop3_b32 v81, v81, v105, v106 bitop3:0x80
  ds_read_b64_tr_b16 v[74:75], v4 offset:64512
  v_bitop3_b32 v81, v81, v107, v108 bitop3:0x80
  s_waitcnt lgkmcnt(6)
  v_mfma_f32_32x32x16_bf16 v[32:47], v[60:63], v[212:215], v[32:47]
  ds_read_b64_tr_b16 v[76:77], v4 offset:62720
  v_bitop3_b32 v81, v81, v109, v110 bitop3:0x80
  ds_read_b64_tr_b16 v[78:79], v4 offset:64768
  v_bitop3_b32 v81, v81, v111, v112 bitop3:0x80
  buffer_load_dwordx4 v[208:211], v12, s[16:19], s42 offen offset:2048
  buffer_load_dwordx4 v[212:215], v12, s[16:19], s42 offen offset:2560
  s_waitcnt lgkmcnt(6)
  v_mfma_f32_32x32x16_bf16 v[16:31], v[64:67], v[216:219], v[16:31]
  ds_read_b64_tr_b16 v[48:49], v8 offset:0
  v_bitop3_b32 v81, v81, v113, v114 bitop3:0x80
  ds_read_b64_tr_b16 v[50:51], v8 offset:2048
  v_bitop3_b32 v81, v81, v115, v116 bitop3:0x80
  s_waitcnt lgkmcnt(6)
  v_mfma_f32_32x32x16_bf16 v[32:47], v[68:71], v[216:219], v[32:47]
  ds_read_b64_tr_b16 v[52:53], v8 offset:256
  v_bitop3_b32 v81, v81, v117, v118 bitop3:0x80
  ds_read_b64_tr_b16 v[54:55], v8 offset:2304
  v_bitop3_b32 v81, v81, v119, v120 bitop3:0x80
  s_waitcnt lgkmcnt(6)
  v_mfma_f32_32x32x16_bf16 v[16:31], v[72:75], v[220:223], v[16:31]
  ds_read_b64_tr_b16 v[56:57], v8 offset:1024
  v_bitop3_b32 v81, v81, v121, v122 bitop3:0x80
  ds_read_b64_tr_b16 v[58:59], v8 offset:3072
  v_bitop3_b32 v81, v81, v123, v124 bitop3:0x80
  s_waitcnt lgkmcnt(6)
  v_mfma_f32_32x32x16_bf16 v[32:47], v[76:79], v[220:223], v[32:47]
  ds_read_b64_tr_b16 v[60:61], v8 offset:1280
  v_bitop3_b32 v81, v81, v125, v126 bitop3:0x80
  ds_read_b64_tr_b16 v[62:63], v8 offset:3328
  v_bitop3_b32 v81, v81, v127, 1 bitop3:0x80
  v_cmp_eq_u32 vcc, 0, v81
  s_nop 0
  s_cmp_lg_u64 vcc, 0
  s_cbranch_scc1 K2_retry4
K2_retry4_ret:
  buffer_load_dwordx4 v[216:219], v12, s[16:19], s42 offen offset:3072
  buffer_load_dwordx4 v[220:223], v12, s[16:19], s42 offen offset:3584
  s_add_u32 s42, s42, 4096
  s_waitcnt lgkmcnt(6)
  v_mfma_f32_32x32x16_bf16 v[16:31], v[48:51], v[96:99], v[16:31]
  ds_read_b64_tr_b16 v[64:65], v8 offset:4096
  ds_read_b64_tr_b16 v[66:67], v8 offset:6144
  s_waitcnt lgkmcnt(6)
  v_mfma_f32_32x32x16_bf16 v[32:47], v[52:55], v[96:99], v[32:47]
  ds_read_b64_tr_b16 v[68:69], v8 offset:4352
  ds_read_b64_tr_b16 v[70:71], v8 offset:6400
  s_waitcnt lgkmcnt(6)
  v_mfma_f32_32x32x16_bf16 v[16:31], v[56:59], v[100:103], v[16:31]
  ds_read_b64_tr_b16 v[72:73], v8 offset:5120
  ds_read_b64_tr_b16 v[74:75], v8 offset:7168
  s_waitcnt lgkmcnt(6)
  v_mfma_f32_32x32x16_bf16 v[32:47], v[60:63], v[100:103], v[32:47]
  ds_read_b64_tr_b16 v[76:77], v8 offset:5376
  ds_read_b64_tr_b16 v[78:79], v8 offset:7424
  s_waitcnt lgkmcnt(6)
  v_mfma_f32_32x32x16_bf16 v[16:31], v[64:67], v[104:107], v[16:31]
  ds_read_b64_tr_b16 v[48:49], v8 offset:8192
  ds_read_b64_tr_b16 v[50:51], v8 offset:10240
  s_waitcnt lgkmcnt(6)
  v_mfma_f32_32x32x16_bf16 v[32:47], v[68:71], v[104:107], v[32:47]
  ds_read_b64_tr_b16 v[52:53], v8 offset:8448
  ds_read_b64_tr_b16 v[54:55], v8 offset:10496
  s_waitcnt lgkmcnt(6)
  v_mfma_f32_32x32x16_bf16 v[16:31], v[72:75], v[108:111], v[16:31]
  ds_read_b64_tr_b16 v[56:57], v8 offset:9216
  ds_read_b64_tr_b16 v[58:59], v8 offset:11264
  s_waitcnt lgkmcnt(6)
  v_mfma_f32_32x32x16_bf16 v[32:47], v[76:79], v[108:111], v[32:47]
  ds_read_b64_tr_b16 v[60:61], v8 offset:9472
  ds_read_b64_tr_b16 v[62:63], v8 offset:11520
  s_waitcnt vmcnt(16)
  s_waitcnt lgkmcnt(6)
  v_mfma_f32_32x32x16_bf16 v[16:31], v[48:51], v[112:115], v[16:31]
  ds_read_b64_tr_b16 v[64:65], v8 offset:12288
  v_bitop3_b32 v81, v128, v129, v130 bitop3:0x80
  ds_read_b64_tr_b16 v[66:67], v8 offset:14336
  v_bitop3_b32 v81, v81, v131, v132 bitop3:0x80
  s_waitcnt lgkmcnt(6)
  v_mfma_f32_32x32x16_bf16 v[32:47], v[52:55], v[112:115], v[32:47]
  ds_read_b64_tr_b16 v[68:69], v8 offset:12544
  v_bitop3_b32 v81, v81, v133, v134 bitop3:0x80
  ds_read_b64_tr_b16 v[70:71], v8 offset:14592
  v_bitop3_b32 v81, v81, v135, v136 bitop3:0x80
  s_waitcnt lgkmcnt(6)
  v_mfma_f32_32x32x16_bf16 v[16:31], v[56:59], v[116:119], v[16:31]
  ds_read_b64_tr_b16 v[72:73], v8 offset:13312
  v_bitop3_b32 v81, v81, v137, v138 bitop3:0x80
  ds_read_b64_tr_b16 v[74:75], v8 offset:15360
  v_bitop3_b32 v81, v81, v139, v140 bitop3:0x80
  s_waitcnt lgkmcnt(6)
  v_mfma_f32_32x32x16_bf16 v[32:47], v[60:63], v[116:119], v[32:47]
  ds_read_b64_tr_b16 v[76:77], v8 offset:13568
  v_bitop3_b32 v81, v81, v141, v142 bitop3:0x80
  ds_read_b64_tr_b16 v[78:79], v8 offset:15616
  v_bitop3_b32 v81, v81, v143, v144 bitop3:0x80
  s_waitcnt lgkmcnt(6)
  v_mfma_f32_32x32x16_bf16 v[16:31], v[64:67], v[120:123], v[16:31]
  ds_read_b64_tr_b16 v[48:49], v8 offset:16384
  v_bitop3_b32 v81, v81, v145, v146 bitop3:0x80
  ds_read_b64_tr_b16 v[50:51], v8 offset:18432
  v_bitop3_b32 v81, v81, v147, v148 bitop3:0x80
  s_waitcnt lgkmcnt(6)
  v_mfma_f32_32x32x16_bf16 v[32:47], v[68:71], v[120:123], v[32:47]
  ds_read_b64_tr_b16 v[52:53], v8 offset:16640
  v_bitop3_b32 v81, v81, v149, v150 bitop3:0x80
  ds_read_b64_tr_b16 v[54:55], v8 offset:18688
  v_bitop3_b32 v81, v81, v151, v152 bitop3:0x80
  s_waitcnt lgkmcnt(6)
  v_mfma_f32_32x32x16_bf16 v[16:31], v[72:75], v[124:127], v[16:31]
  ds_read_b64_tr_b16 v[56:57], v8 offset:17408
  v_bitop3_b32 v81, v81, v153, v154 bitop3:0x80
  ds_read_b64_tr_b16 v[58:59], v8 offset:19456
  v_bitop3_b32 v81, v81, v155, v156 bitop3:0x80
  s_waitcnt lgkmcnt(6)
  v_mfma_f32_32x32x16_bf16 v[32:47], v[76:79], v[124:127], v[32:47]
  ds_read_b64_tr_b16 v[60:61], v8 offset:17664
  v_bitop3_b32 v81, v81, v157, v158 bitop3:0x80
  ds_read_b64_tr_b16 v[62:63], v8 offset:19712
  v_bitop3_b32 v81, v81, v159, 1 bitop3:0x80
  v_cmp_eq_u32 vcc, 0, v81
  s_nop 0
  s_cmp_lg_u64 vcc, 0
  s_cbranch_scc1 K2_retry5
K2_retry5_ret:
  s_waitcnt lgkmcnt(6)
  v_mfma_f32_32x32x16_bf16 v[16:31], v[48:51], v[128:131], v[16:31]
  ds_read_b64_tr_b16 v[64:65], v8 offset:20480
  ds_read_b64_tr_b16 v[66:67], v8 offset:22528
  s_waitcnt lgkmcnt(6)
  v_mfma_f32_32x32x16_bf16 v[32:47], v[52:55], v[128:131], v[32:47]
  ds_read_b64_tr_b16 v[68:69], v8 offset:20736
  ds_read_b64_tr_b16 v[70:71], v8 offset:22784
  s_waitcnt lgkmcnt(6)
  v_mfma_f32_32x32x16_bf16 v[16:31], v[56:59], v[132:135], v[16:31]
  ds_read_b64_tr_b16 v[72:73], v8 offset:21504
  ds_read_b64_tr_b16 v[74:75], v8 offset:23552
  s_waitcnt lgkmcnt(6)
  v_mfma_f32_32x32x16_bf16 v[32:47], v[60:63], v[132:135], v[32:47]
  ds_read_b64_tr_b16 v[76:77], v8 offset:21760
  ds_read_b64_tr_b16 v[78:79], v8 offset:23808
  s_waitcnt lgkmcnt(6)
  v_mfma_f32_32x32x16_bf16 v[16:31], v[64:67], v[136:139], v[16:31]
  ds_read_b64_tr_b16 v[48:49], v8 offset:24576
  ds_read_b64_tr_b16 v[50:51], v8 offset:26624
  s_waitcnt lgkmcnt(6)
  v_mfma_f32_32x32x16_bf16 v[32:47], v[68:71], v[136:139], v[32:47]
  ds_read_b64_tr_b16 v[52:53], v8 offset:24832
  ds_read_b64_tr_b16 v[54:55], v8 offset:26880
  s_waitcnt lgkmcnt(6)
  v_mfma_f32_32x32x16_bf16 v[16:31], v[72:75], v[140:143], v[16:31]
  ds_read_b64_tr_b16 v[56:57], v8 offset:25600
  ds_read_b64_tr_b16 v[58:59], v8 offset:27648
  s_waitcnt lgkmcnt(6)
  v_mfma_f32_32x32x16_bf16 v[32:47], v[76:79], v[140:143], v[32:47]
  ds_read_b64_tr_b16 v[60:61], v8 offset:25856
  ds_read_b64_tr_b16 v[62:63], v8 offset:27904
  s_waitcnt vmcnt(8)
  s_waitcnt lgkmcnt(6)
  v_mfma_f32_32x32x16_bf16 v[16:31], v[48:51], v[144:147], v[16:31]
  ds_read_b64_tr_b16 v[64:65], v8 offset:28672
  v_bitop3_b32 v81, v160, v161, v162 bitop3:0x80
  ds_read_b64_tr_b16 v[66:67], v8 offset:30720
  v_bitop3_b32 v81, v81, v163, v164 bitop3:0x80
  s_waitcnt lgkmcnt(6)
  v_mfma_f32_32x32x16_bf16 v[32:47], v[52:55], v[144:147], v[32:47]
  ds_read_b64_tr_b16 v[68:69], v8 offset:28928
  v_bitop3_b32 v81, v81, v165, v166 bitop3:0x80
  ds_read_b64_tr_b16 v[70:71], v8 offset:30976
  v_bitop3_b32 v81, v81, v167, v168 bitop3:0x80
  s_waitcnt lgkmcnt(6)
  v_mfma_f32_32x32x16_bf16 v[16:31], v[56:59], v[148:151], v[16:31]
  ds_read_b64_tr_b16 v[72:73], v8 offset:29696
  v_bitop3_b32 v81, v81, v169, v170 bitop3:0x80
  ds_read_b64_tr_b16 v[74:75], v8 offset:31744
  v_bitop3_b32 v81, v81, v171, v172 bitop3:0x80
  s_waitcnt lgkmcnt(6)
  v_mfma_f32_32x32x16_bf16 v[32:47], v[60:63], v[148:151], v[32:47]
  ds_read_b64_tr_b16 v[76:77], v8 offset:29952
  v_bitop3_b32 v81, v81, v173, v174 bitop3:0x80
  ds_read_b64_tr_b16 v[78:79], v8 offset:32000
  v_bitop3_b32 v81, v81, v175, v176 bitop3:0x80
  s_waitcnt lgkmcnt(6)
  v_mfma_f32_32x32x16_bf16 v[16:31], v[64:67], v[152:155], v[16:31]
  ds_read_b64_tr_b16 v[48:49], v8 offset:32768
  v_bitop3_b32 v81, v81, v177, v178 bitop3:0x80
  ds_read_b64_tr_b16 v[50:51], v8 offset:34816
  v_bitop3_b32 v81, v81, v179, v180 bitop3:0x80
  s_waitcnt lgkmcnt(6)
  v_mfma_f32_32x32x16_bf16 v[32:47], v[68:71], v[152:155], v[32:47]
  ds_read_b64_tr_b16 v[52:53], v8 offset:33024
  v_bitop3_b32 v81, v81, v181, v182 bitop3:0x80
  ds_read_b64_tr_b16 v[54:55], v8 offset:35072
  v_bitop3_b32 v81, v81, v183, v184 bitop3:0x80
  s_waitcnt lgkmcnt(6)
  v_mfma_f32_32x32x16_bf16 v[16:31], v[72:75], v[156:159], v[16:31]
  ds_read_b64_tr_b16 v[56:57], v8 offset:33792
  v_bitop3_b32 v81, v81, v185, v186 bitop3:0x80
  ds_read_b64_tr_b16 v[58:59], v8 offset:35840
  v_bitop3_b32 v81, v81, v187, v188 bitop3:0x80
  s_waitcnt lgkmcnt(6)
  v_mfma_f32_32x32x16_bf16 v[32:47], v[76:79], v[156:159], v[32:47]
  ds_read_b64_tr_b16 v[60:61], v8 offset:34048
  v_bitop3_b32 v81, v81, v189, v190 bitop3:0x80
  ds_read_b64_tr_b16 v[62:63], v8 offset:36096
  v_bitop3_b32 v81, v81, v191, 1 bitop3:0x80
  v_cmp_eq_u32 vcc, 0, v81
  s_nop 0
  s_cmp_lg_u64 vcc, 0
  s_cbranch_scc1 K2_retry6
K2_retry6_ret:
  s_waitcnt lgkmcnt(6)
  v_mfma_f32_32x32x16_bf16 v[16:31], v[48:51], v[160:163], v[16:31]
  ds_read_b64_tr_b16 v[64:65], v8 offset:36864
  ds_read_b64_tr_b16 v[66:67], v8 offset:38912
  s_waitcnt lgkmcnt(6)
  v_mfma_f32_32x32x16_bf16 v[32:47], v[52:55], v[160:163], v[32:47]
  ds_read_b64_tr_b16 v[68:69], v8 offset:37120
  ds_read_b64_tr_b16 v[70:71], v8 offset:39168
  s_waitcnt lgkmcnt(6)
  v_mfma_f32_32x32x16_bf16 v[16:31], v[56:59], v[164:167], v[16:31]
  ds_read_b64_tr_b16 v[72:73], v8 offset:37888
  ds_read_b64_tr_b16 v[74:75], v8 offset:39936
  s_waitcnt lgkmcnt(6)
  v_mfma_f32_32x32x16_bf16 v[32:47], v[60:63], v[164:167], v[32:47]
  ds_read_b64_tr_b16 v[76:77], v8 offset:38144
  ds_read_b64_tr_b16 v[78:79], v8 offset:40192
  s_waitcnt lgkmcnt(6)
  v_mfma_f32_32x32x16_bf16 v[16:31], v[64:67], v[168:171], v[16:31]
  ds_read_b64_tr_b16 v[48:49], v8 offset:40960
  ds_read_b64_tr_b16 v[50:51], v8 offset:43008
  s_waitcnt lgkmcnt(6)
  v_mfma_f32_32x32x16_bf16 v[32:47], v[68:71], v[168:171], v[32:47]
  ds_read_b64_tr_b16 v[52:53], v8 offset:41216
  ds_read_b64_tr_b16 v[54:55], v8 offset:43264
  s_waitcnt lgkmcnt(6)
  v_mfma_f32_32x32x16_bf16 v[16:31], v[72:75], v[172:175], v[16:31]
  ds_read_b64_tr_b16 v[56:57], v8 offset:41984
  ds_read_b64_tr_b16 v[58:59], v8 offset:44032
  s_waitcnt lgkmcnt(6)
  v_mfma_f32_32x32x16_bf16 v[32:47], v[76:79], v[172:175], v[32:47]
  ds_read_b64_tr_b16 v[60:61], v8 offset:42240
  ds_read_b64_tr_b16 v[62:63], v8 offset:44288
  s_waitcnt vmcnt(0)
  s_waitcnt lgkmcnt(6)
  v_mfma_f32_32x32x16_bf16 v[16:31], v[48:51], v[176:179], v[16:31]
  ds_read_b64_tr_b16 v[64:65], v8 offset:45056
  v_bitop3_b32 v81, v192, v193, v194 bitop3:0x80
  ds_read_b64_tr_b16 v[66:67], v8 offset:47104
  v_bitop3_b32 v81, v81, v195, v196 bitop3:0x80
  s_waitcnt lgkmcnt(6)
  v_mfma_f32_32x32x16_bf16 v[32:47], v[52:55], v[176:179], v[32:47]
  ds_read_b64_tr_b16 v[68:69], v8 offset:45312
  v_bitop3_b32 v81, v81, v197, v198 bitop3:0x80
  ds_read_b64_tr_b16 v[70:71], v8 offset:47360
  v_bitop3_b32 v81, v81, v199, v200 bitop3:0x80
  s_waitcnt lgkmcnt(6)
  v_mfma_f32_32x32x16_bf16 v[16:31], v[56:59], v[180:183], v[16:31]
  ds_read_b64_tr_b16 v[72:73], v8 offset:46080
  v_bitop3_b32 v81, v81, v201, v202 bitop3:0x80
  ds_read_b64_tr_b16 v[74:75], v8 offset:48128
  v_bitop3_b32 v81, v81, v203, v204 bitop3:0x80
  s_waitcnt lgkmcnt(6)
  v_mfma_f32_32x32x16_bf16 v[32:47], v[60:63], v[180:183], v[32:47]
  ds_read_b64_tr_b16 v[76:77], v8 offset:46336
  v_bitop3_b32 v81, v81, v205, v206 bitop3:0x80
  ds_read_b64_tr_b16 v[78:79], v8 offset:48384
  v_bitop3_b32 v81, v81, v207, v208 bitop3:0x80
  s_waitcnt lgkmcnt(0)
  s_mov_b32 s39, 4194304
K2_wwt:
  ds_read_b32 v80, v10 offset:28
  s_waitcnt lgkmcnt(0)
  v_readfirstlane_b32 s38, v80
  s_sub_u32 s39, s39, 1
  s_cbranch_scc1 K2_wwt_ok
  s_cmp_lt_u32 s38, 4
  s_cbranch_scc1 K2_wwt
K2_wwt_ok:
  v_mfma_f32_32x32x16_bf16 v[16:31], v[64:67], v[184:187], v[16:31]
  ds_read_b64_tr_b16 v[48:49], v9 offset:0
  v_bitop3_b32 v81, v81, v209, v210 bitop3:0x80
  ds_read_b64_tr_b16 v[50:51], v9 offset:2048
  v_bitop3_b32 v81, v81, v211, v212 bitop3:0x80
  v_mfma_f32_32x32x16_bf16 v[32:47], v[68:71], v[184:187], v[32:47]
  ds_read_b64_tr_b16 v[52:53], v9 offset:256
  v_bitop3_b32 v81, v81, v213, v214 bitop3:0x80
  ds_read_b64_tr_b16 v[54:55], v9 offset:2304
  v_bitop3_b32 v81, v81, v215, v216 bitop3:0x80
  v_mfma_f32_32x32x16_bf16 v[16:31], v[72:75], v[188:191], v[16:31]
  ds_read_b64_tr_b16 v[56:57], v9 offset:1024
  v_bitop3_b32 v81, v81, v217, v218 bitop3:0x80
  ds_read_b64_tr_b16 v[58:59], v9 offset:3072
  v_bitop3_b32 v81, v81, v219, v220 bitop3:0x80
  v_mfma_f32_32x32x16_bf16 v[32:47], v[76:79], v[188:191], v[32:47]
  ds_read_b64_tr_b16 v[60:61], v9 offset:1280
  v_bitop3_b32 v81, v81, v221, v222 bitop3:0x80
  ds_read_b64_tr_b16 v[62:63], v9 offset:3328
  v_bitop3_b32 v81, v81, v223, 1 bitop3:0x80
  v_cmp_eq_u32 vcc, 0, v81
  s_nop 0
  s_cmp_lg_u64 vcc, 0
  s_cbranch_scc1 K2_retry7
K2_retry7_ret:
  s_waitcnt lgkmcnt(6)
  v_mfma_f32_32x32x16_bf16 v[16:31], v[48:51], v[192:195], v[16:31]
  ds_read_b64_tr_b16 v[64:65], v9 offset:8704
  ds_read_b64_tr_b16 v[66:67], v9 offset:10752
  s_waitcnt lgkmcnt(6)
  v_mfma_f32_32x32x16_bf16 v[32:47], v[52:55], v[192:195], v[32:47]
  ds_read_b64_tr_b16 v[68:69], v9 offset:8960
  ds_read_b64_tr_b16 v[70:71], v9 offset:11008
  s_waitcnt lgkmcnt(6)
  v_mfma_f32_32x32x16_bf16 v[16:31], v[56:59], v[196:199], v[16:31]
  ds_read_b64_tr_b16 v[72:73], v9 offset:9728
  ds_read_b64_tr_b16 v[74:75], v9 offset:11776
  s_waitcnt lgkmcnt(6)
  v_mfma_f32_32x32x16_bf16 v[32:47], v[60:63], v[196:199], v[32:47]
  ds_read_b64_tr_b16 v[76:77], v9 offset:9984
  ds_read_b64_tr_b16 v[78:79], v9 offset:12032
  s_waitcnt lgkmcnt(6)
  v_mfma_f32_32x32x16_bf16 v[16:31], v[64:67], v[200:203], v[16:31]
  ds_read_b64_tr_b16 v[48:49], v9 offset:17408
  ds_read_b64_tr_b16 v[50:51], v9 offset:19456
  s_waitcnt lgkmcnt(6)
  v_mfma_f32_32x32x16_bf16 v[32:47], v[68:71], v[200:203], v[32:47]
  ds_read_b64_tr_b16 v[52:53], v9 offset:17664
  ds_read_b64_tr_b16 v[54:55], v9 offset:19712
  s_waitcnt lgkmcnt(6)
  v_mfma_f32_32x32x16_bf16 v[16:31], v[72:75], v[204:207], v[16:31]
  ds_read_b64_tr_b16 v[56:57], v9 offset:18432
  ds_read_b64_tr_b16 v[58:59], v9 offset:20480
  s_waitcnt lgkmcnt(6)
  v_mfma_f32_32x32x16_bf16 v[32:47], v[76:79], v[204:207], v[32:47]
  ds_read_b64_tr_b16 v[60:61], v9 offset:18688
  ds_read_b64_tr_b16 v[62:63], v9 offset:20736
  s_waitcnt lgkmcnt(6)
  v_mfma_f32_32x32x16_bf16 v[16:31], v[48:51], v[208:211], v[16:31]
  ds_read_b64_tr_b16 v[64:65], v9 offset:26112
  ds_read_b64_tr_b16 v[66:67], v9 offset:28160
  s_waitcnt lgkmcnt(6)
  v_mfma_f32_32x32x16_bf16 v[32:47], v[52:55], v[208:211], v[32:47]
  ds_read_b64_tr_b16 v[68:69], v9 offset:26368
  ds_read_b64_tr_b16 v[70:71], v9 offset:28416
  s_waitcnt lgkmcnt(6)
  v_mfma_f32_32x32x16_bf16 v[16:31], v[56:59], v[212:215], v[16:31]
  ds_read_b64_tr_b16 v[72:73], v9 offset:27136
  ds_read_b64_tr_b16 v[74:75], v9 offset:29184
  s_waitcnt lgkmcnt(6)
  v_mfma_f32_32x32x16_bf16 v[32:47], v[60:63], v[212:215], v[32:47]
  ds_read_b64_tr_b16 v[76:77], v9 offset:27392
  ds_read_b64_tr_b16 v[78:79], v9 offset:29440
  s_waitcnt lgkmcnt(6)
  v_mfma_f32_32x32x16_bf16 v[16:31], v[64:67], v[216:219], v[16:31]
  s_waitcnt lgkmcnt(4)
  v_mfma_f32_32x32x16_bf16 v[32:47], v[68:71], v[216:219], v[32:47]
  s_waitcnt lgkmcnt(2)
  v_mfma_f32_32x32x16_bf16 v[16:31], v[72:75], v[220:223], v[16:31]
  s_waitcnt lgkmcnt(0)
  v_mfma_f32_32x32x16_bf16 v[32:47], v[76:79], v[220:223], v[32:47]
  v_and_b32 v4, 31, v2
  v_lshlrev_b32 v4, 12, v4
  v_lshrrev_b32 v5, 5, v2
  v_lshl_add_u32 v4, v5, 4, v4
  s_lshl_b32 s38, s41, 16
  s_lshl_b32 s39, s36, 7
  s_add_u32 s38, s38, s39
  s_add_u32 s38, s38, 2048
  s_nop 1
  v_cvt_pk_bf16_f32 v80, v16, v17
  v_cvt_pk_bf16_f32 v81, v18, v19
  v_cvt_pk_bf16_f32 v82, v20, v21
  v_cvt_pk_bf16_f32 v83, v22, v23
  s_nop 0
  v_permlane32_swap_b32 v80, v82
  v_permlane32_swap_b32 v81, v83
  buffer_store_dwordx4 v[80:83], v4, s[48:51], s38 offen offset:0
  v_cvt_pk_bf16_f32 v84, v24, v25
  v_cvt_pk_bf16_f32 v85, v26, v27
  v_cvt_pk_bf16_f32 v86, v28, v29
  v_cvt_pk_bf16_f32 v87, v30, v31
  s_nop 0
  v_permlane32_swap_b32 v84, v86
  v_permlane32_swap_b32 v85, v87
  buffer_store_dwordx4 v[84:87], v4, s[48:51], s38 offen offset:32
  v_cvt_pk_bf16_f32 v88, v32, v33
  v_cvt_pk_bf16_f32 v89, v34, v35
  v_cvt_pk_bf16_f32 v90, v36, v37
  v_cvt_pk_bf16_f32 v91, v38, v39
  s_nop 0
  v_permlane32_swap_b32 v88, v90
  v_permlane32_swap_b32 v89, v91
  buffer_store_dwordx4 v[88:91], v4, s[48:51], s38 offen offset:64
  v_cvt_pk_bf16_f32 v92, v40, v41
  v_cvt_pk_bf16_f32 v93, v42, v43
  v_cvt_pk_bf16_f32 v94, v44, v45
  v_cvt_pk_bf16_f32 v95, v46, v47
  s_nop 0
  v_permlane32_swap_b32 v92, v94
  v_permlane32_swap_b32 v93, v95
  buffer_store_dwordx4 v[92:95], v4, s[48:51], s38 offen offset:96
  s_endpgm
K2_retry0:
  s_mov_b32 s46, 20000
  s_add_u32 s38, s44, 0
K2_retry0_l:
  s_sleep 4
  buffer_load_dwordx4 v[96:99], v12, s[16:19], s38 offen offset:0 sc1
  buffer_load_dwordx4 v[100:103], v12, s[16:19], s38 offen offset:512 sc1
  buffer_load_dwordx4 v[104:107], v12, s[16:19], s38 offen offset:1024 sc1
  buffer_load_dwordx4 v[108:111], v12, s[16:19], s38 offen offset:1536 sc1
  buffer_load_dwordx4 v[112:115], v12, s[16:19], s38 offen offset:2048 sc1
  buffer_load_dwordx4 v[116:119], v12, s[16:19], s38 offen offset:2560 sc1
  buffer_load_dwordx4 v[120:123], v12, s[16:19], s38 offen offset:3072 sc1
  buffer_load_dwordx4 v[124:127], v12, s[16:19], s38 offen offset:3584 sc1
  s_waitcnt vmcnt(0)
  v_bitop3_b32 v81, v96, v97, v98 bitop3:0x80
  v_bitop3_b32 v81, v81, v99, v100 bitop3:0x80
  v_bitop3_b32 v81, v81, v101, v102 bitop3:0x80
  v_bitop3_b32 v81, v81, v103, v104 bitop3:0x80
  v_bitop3_b32 v81, v81, v105, v106 bitop3:0x80
  v_bitop3_b32 v81, v81, v107, v108 bitop3:0x80
  v_bitop3_b32 v81, v81, v109, v110 bitop3:0x80
  v_bitop3_b32 v81, v81, v111, v112 bitop3:0x80
  v_bitop3_b32 v81, v81, v113, v114 bitop3:0x80
  v_bitop3_b32 v81, v81, v115, v116 bitop3:0x80
  v_bitop3_b32 v81, v81, v117, v118 bitop3:0x80
  v_bitop3_b32 v81, v81, v119, v120 bitop3:0x80
  v_bitop3_b32 v81, v81, v121, v122 bitop3:0x80
  v_bitop3_b32 v81, v81, v123, v124 bitop3:0x80
  v_bitop3_b32 v81, v81, v125, v126 bitop3:0x80
  v_bitop3_b32 v81, v81, v127, 1 bitop3:0x80
  v_cmp_eq_u32 vcc, 0, v81
  s_sub_u32 s46, s46, 1
  s_cbranch_scc1 K2_retry0_ret
  s_cmp_lg_u64 vcc, 0
  s_cbranch_scc1 K2_retry0_l
  s_branch K2_retry0_ret
K2_retry1:
  s_mov_b32 s46, 20000
  s_add_u32 s38, s44, 4096
K2_retry1_l:
  s_sleep 4
  buffer_load_dwordx4 v[128:131], v12, s[16:19], s38 offen offset:0 sc1
  buffer_load_dwordx4 v[132:135], v12, s[16:19], s38 offen offset:512 sc1
  buffer_load_dwordx4 v[136:139], v12, s[16:19], s38 offen offset:1024 sc1
  buffer_load_dwordx4 v[140:143], v12, s[16:19], s38 offen offset:1536 sc1
  buffer_load_dwordx4 v[144:147], v12, s[16:19], s38 offen offset:2048 sc1
  buffer_load_dwordx4 v[148:151], v12, s[16:19], s38 offen offset:2560 sc1
  buffer_load_dwordx4 v[152:155], v12, s[16:19], s38 offen offset:3072 sc1
  buffer_load_dwordx4 v[156:159], v12, s[16:19], s38 offen offset:3584 sc1
  s_waitcnt vmcnt(0)
  v_bitop3_b32 v81, v128, v129, v130 bitop3:0x80
  v_bitop3_b32 v81, v81, v131, v132 bitop3:0x80
  v_bitop3_b32 v81, v81, v133, v134 bitop3:0x80
  v_bitop3_b32 v81, v81, v135, v136 bitop3:0x80
  v_bitop3_b32 v81, v81, v137, v138 bitop3:0x80
  v_bitop3_b32 v81, v81, v139, v140 bitop3:0x80
  v_bitop3_b32 v81, v81, v141, v142 bitop3:0x80
  v_bitop3_b32 v81, v81, v143, v144 bitop3:0x80
  v_bitop3_b32 v81, v81, v145, v146 bitop3:0x80
  v_bitop3_b32 v81, v81, v147, v148 bitop3:0x80
  v_bitop3_b32 v81, v81, v149, v150 bitop3:0x80
  v_bitop3_b32 v81, v81, v151, v152 bitop3:0x80
  v_bitop3_b32 v81, v81, v153, v154 bitop3:0x80
  v_bitop3_b32 v81, v81, v155, v156 bitop3:0x80
  v_bitop3_b32 v81, v81, v157, v158 bitop3:0x80
  v_bitop3_b32 v81, v81, v159, 1 bitop3:0x80
  v_cmp_eq_u32 vcc, 0, v81
  s_sub_u32 s46, s46, 1
  s_cbranch_scc1 K2_retry1_ret
  s_cmp_lg_u64 vcc, 0
  s_cbranch_scc1 K2_retry1_l
  s_branch K2_retry1_ret
K2_retry2:
  s_mov_b32 s46, 20000
  s_add_u32 s38, s44, 8192
K2_retry2_l:
  s_sleep 4
  buffer_load_dwordx4 v[160:163], v12, s[16:19], s38 offen offset:0 sc1
  buffer_load_dwordx4 v[164:167], v12, s[16:19], s38 offen offset:512 sc1
  buffer_load_dwordx4 v[168:171], v12, s[16:19], s38 offen offset:1024 sc1
  buffer_load_dwordx4 v[172:175], v12, s[16:19], s38 offen offset:1536 sc1
  buffer_load_dwordx4 v[176:179], v12, s[16:19], s38 offen offset:2048 sc1
  buffer_load_dwordx4 v[180:183], v12, s[16:19], s38 offen offset:2560 sc1
  buffer_load_dwordx4 v[184:187], v12, s[16:19], s38 offen offset:3072 sc1
  buffer_load_dwordx4 v[188:191], v12, s[16:19], s38 offen offset:3584 sc1
  s_waitcnt vmcnt(0)
  v_bitop3_b32 v81, v160, v161, v162 bitop3:0x80
  v_bitop3_b32 v81, v81, v163, v164 bitop3:0x80
  v_bitop3_b32 v81, v81, v165, v166 bitop3:0x80
  v_bitop3_b32 v81, v81, v167, v168 bitop3:0x80
  v_bitop3_b32 v81, v81, v169, v170 bitop3:0x80
  v_bitop3_b32 v81, v81, v171, v172 bitop3:0x80
  v_bitop3_b32 v81, v81, v173, v174 bitop3:0x80
  v_bitop3_b32 v81, v81, v175, v176 bitop3:0x80
  v_bitop3_b32 v81, v81, v177, v178 bitop3:0x80
  v_bitop3_b32 v81, v81, v179, v180 bitop3:0x80
  v_bitop3_b32 v81, v81, v181, v182 bitop3:0x80
  v_bitop3_b32 v81, v81, v183, v184 bitop3:0x80
  v_bitop3_b32 v81, v81, v185, v186 bitop3:0x80
  v_bitop3_b32 v81, v81, v187, v188 bitop3:0x80
  v_bitop3_b32 v81, v81, v189, v190 bitop3:0x80
  v_bitop3_b32 v81, v81, v191, 1 bitop3:0x80
  v_cmp_eq_u32 vcc, 0, v81
  s_sub_u32 s46, s46, 1
  s_cbranch_scc1 K2_retry2_ret
  s_cmp_lg_u64 vcc, 0
  s_cbranch_scc1 K2_retry2_l
  s_branch K2_retry2_ret
K2_retry3:
  s_mov_b32 s46, 20000
  s_add_u32 s38, s44, 12288
K2_retry3_l:
  s_sleep 4
  buffer_load_dwordx4 v[192:195], v12, s[16:19], s38 offen offset:0 sc1
  buffer_load_dwordx4 v[196:199], v12, s[16:19], s38 offen offset:512 sc1
  buffer_load_dwordx4 v[200:203], v12, s[16:19], s38 offen offset:1024 sc1
  buffer_load_dwordx4 v[204:207], v12, s[16:19], s38 offen offset:1536 sc1
  buffer_load_dwordx4 v[208:211], v12, s[16:19], s38 offen offset:2048 sc1
  buffer_load_dwordx4 v[212:215], v12, s[16:19], s38 offen offset:2560 sc1
  buffer_load_dwordx4 v[216:219], v12, s[16:19], s38 offen offset:3072 sc1
  buffer_load_dwordx4 v[220:223], v12, s[16:19], s38 offen offset:3584 sc1
  s_waitcnt vmcnt(0)
  v_bitop3_b32 v81, v192, v193, v194 bitop3:0x80
  v_bitop3_b32 v81, v81, v195, v196 bitop3:0x80
  v_bitop3_b32 v81, v81, v197, v198 bitop3:0x80
  v_bitop3_b32 v81, v81, v199, v200 bitop3:0x80
  v_bitop3_b32 v81, v81, v201, v202 bitop3:0x80
  v_bitop3_b32 v81, v81, v203, v204 bitop3:0x80
  v_bitop3_b32 v81, v81, v205, v206 bitop3:0x80
  v_bitop3_b32 v81, v81, v207, v208 bitop3:0x80
  v_bitop3_b32 v81, v81, v209, v210 bitop3:0x80
  v_bitop3_b32 v81, v81, v211, v212 bitop3:0x80
  v_bitop3_b32 v81, v81, v213, v214 bitop3:0x80
  v_bitop3_b32 v81, v81, v215, v216 bitop3:0x80
  v_bitop3_b32 v81, v81, v217, v218 bitop3:0x80
  v_bitop3_b32 v81, v81, v219, v220 bitop3:0x80
  v_bitop3_b32 v81, v81, v221, v222 bitop3:0x80
  v_bitop3_b32 v81, v81, v223, 1 bitop3:0x80
  v_cmp_eq_u32 vcc, 0, v81
  s_sub_u32 s46, s46, 1
  s_cbranch_scc1 K2_retry3_ret
  s_cmp_lg_u64 vcc, 0
  s_cbranch_scc1 K2_retry3_l
  s_branch K2_retry3_ret
K2_retry4:
  s_mov_b32 s46, 20000
  s_add_u32 s38, s44, 16384
K2_retry4_l:
  s_sleep 4
  buffer_load_dwordx4 v[96:99], v12, s[16:19], s38 offen offset:0 sc1
  buffer_load_dwordx4 v[100:103], v12, s[16:19], s38 offen offset:512 sc1
  buffer_load_dwordx4 v[104:107], v12, s[16:19], s38 offen offset:1024 sc1
  buffer_load_dwordx4 v[108:111], v12, s[16:19], s38 offen offset:1536 sc1
  buffer_load_dwordx4 v[112:115], v12, s[16:19], s38 offen offset:2048 sc1
  buffer_load_dwordx4 v[116:119], v12, s[16:19], s38 offen offset:2560 sc1
  buffer_load_dwordx4 v[120:123], v12, s[16:19], s38 offen offset:3072 sc1
  buffer_load_dwordx4 v[124:127], v12, s[16:19], s38 offen offset:3584 sc1
  s_waitcnt vmcnt(0)
  v_bitop3_b32 v81, v96, v97, v98 bitop3:0x80
  v_bitop3_b32 v81, v81, v99, v100 bitop3:0x80
  v_bitop3_b32 v81, v81, v101, v102 bitop3:0x80
  v_bitop3_b32 v81, v81, v103, v104 bitop3:0x80
  v_bitop3_b32 v81, v81, v105, v106 bitop3:0x80
  v_bitop3_b32 v81, v81, v107, v108 bitop3:0x80
  v_bitop3_b32 v81, v81, v109, v110 bitop3:0x80
  v_bitop3_b32 v81, v81, v111, v112 bitop3:0x80
  v_bitop3_b32 v81, v81, v113, v114 bitop3:0x80
  v_bitop3_b32 v81, v81, v115, v116 bitop3:0x80
  v_bitop3_b32 v81, v81, v117, v118 bitop3:0x80
  v_bitop3_b32 v81, v81, v119, v120 bitop3:0x80
  v_bitop3_b32 v81, v81, v121, v122 bitop3:0x80
  v_bitop3_b32 v81, v81, v123, v124 bitop3:0x80
  v_bitop3_b32 v81, v81, v125, v126 bitop3:0x80
  v_bitop3_b32 v81, v81, v127, 1 bitop3:0x80
  v_cmp_eq_u32 vcc, 0, v81
  s_sub_u32 s46, s46, 1
  s_cbranch_scc1 K2_retry4_ret
  s_cmp_lg_u64 vcc, 0
  s_cbranch_scc1 K2_retry4_l
  s_branch K2_retry4_ret
K2_retry5:
  s_mov_b32 s46, 20000
  s_add_u32 s38, s44, 20480
K2_retry5_l:
  s_sleep 4
  buffer_load_dwordx4 v[128:131], v12, s[16:19], s38 offen offset:0 sc1
  buffer_load_dwordx4 v[132:135], v12, s[16:19], s38 offen offset:512 sc1
  buffer_load_dwordx4 v[136:139], v12, s[16:19], s38 offen offset:1024 sc1
  buffer_load_dwordx4 v[140:143], v12, s[16:19], s38 offen offset:1536 sc1
  buffer_load_dwordx4 v[144:147], v12, s[16:19], s38 offen offset:2048 sc1
  buffer_load_dwordx4 v[148:151], v12, s[16:19], s38 offen offset:2560 sc1
  buffer_load_dwordx4 v[152:155], v12, s[16:19], s38 offen offset:3072 sc1
  buffer_load_dwordx4 v[156:159], v12, s[16:19], s38 offen offset:3584 sc1
  s_waitcnt vmcnt(0)
  v_bitop3_b32 v81, v128, v129, v130 bitop3:0x80
  v_bitop3_b32 v81, v81, v131, v132 bitop3:0x80
  v_bitop3_b32 v81, v81, v133, v134 bitop3:0x80
  v_bitop3_b32 v81, v81, v135, v136 bitop3:0x80
  v_bitop3_b32 v81, v81, v137, v138 bitop3:0x80
  v_bitop3_b32 v81, v81, v139, v140 bitop3:0x80
  v_bitop3_b32 v81, v81, v141, v142 bitop3:0x80
  v_bitop3_b32 v81, v81, v143, v144 bitop3:0x80
  v_bitop3_b32 v81, v81, v145, v146 bitop3:0x80
  v_bitop3_b32 v81, v81, v147, v148 bitop3:0x80
  v_bitop3_b32 v81, v81, v149, v150 bitop3:0x80
  v_bitop3_b32 v81, v81, v151, v152 bitop3:0x80
  v_bitop3_b32 v81, v81, v153, v154 bitop3:0x80
  v_bitop3_b32 v81, v81, v155, v156 bitop3:0x80
  v_bitop3_b32 v81, v81, v157, v158 bitop3:0x80
  v_bitop3_b32 v81, v81, v159, 1 bitop3:0x80
  v_cmp_eq_u32 vcc, 0, v81
  s_sub_u32 s46, s46, 1
  s_cbranch_scc1 K2_retry5_ret
  s_cmp_lg_u64 vcc, 0
  s_cbranch_scc1 K2_retry5_l
  s_branch K2_retry5_ret
K2_retry6:
  s_mov_b32 s46, 20000
  s_add_u32 s38, s44, 24576
K2_retry6_l:
  s_sleep 4
  buffer_load_dwordx4 v[160:163], v12, s[16:19], s38 offen offset:0 sc1
  buffer_load_dwordx4 v[164:167], v12, s[16:19], s38 offen offset:512 sc1
  buffer_load_dwordx4 v[168:171], v12, s[16:19], s38 offen offset:1024 sc1
  buffer_load_dwordx4 v[172:175], v12, s[16:19], s38 offen offset:1536 sc1
  buffer_load_dwordx4 v[176:179], v12, s[16:19], s38 offen offset:2048 sc1
  buffer_load_dwordx4 v[180:183], v12, s[16:19], s38 offen offset:2560 sc1
  buffer_load_dwordx4 v[184:187], v12, s[16:19], s38 offen offset:3072 sc1
  buffer_load_dwordx4 v[188:191], v12, s[16:19], s38 offen offset:3584 sc1
  s_waitcnt vmcnt(0)
  v_bitop3_b32 v81, v160, v161, v162 bitop3:0x80
  v_bitop3_b32 v81, v81, v163, v164 bitop3:0x80
  v_bitop3_b32 v81, v81, v165, v166 bitop3:0x80
  v_bitop3_b32 v81, v81, v167, v168 bitop3:0x80
  v_bitop3_b32 v81, v81, v169, v170 bitop3:0x80
  v_bitop3_b32 v81, v81, v171, v172 bitop3:0x80
  v_bitop3_b32 v81, v81, v173, v174 bitop3:0x80
  v_bitop3_b32 v81, v81, v175, v176 bitop3:0x80
  v_bitop3_b32 v81, v81, v177, v178 bitop3:0x80
  v_bitop3_b32 v81, v81, v179, v180 bitop3:0x80
  v_bitop3_b32 v81, v81, v181, v182 bitop3:0x80
  v_bitop3_b32 v81, v81, v183, v184 bitop3:0x80
  v_bitop3_b32 v81, v81, v185, v186 bitop3:0x80
  v_bitop3_b32 v81, v81, v187, v188 bitop3:0x80
  v_bitop3_b32 v81, v81, v189, v190 bitop3:0x80
  v_bitop3_b32 v81, v81, v191, 1 bitop3:0x80
  v_cmp_eq_u32 vcc, 0, v81
  s_sub_u32 s46, s46, 1
  s_cbranch_scc1 K2_retry6_ret
  s_cmp_lg_u64 vcc, 0
  s_cbranch_scc1 K2_retry6_l
  s_branch K2_retry6_ret
K2_retry7:
  s_mov_b32 s46, 20000
  s_add_u32 s38, s44, 28672
K2_retry7_l:
  s_sleep 4
  buffer_load_dwordx4 v[192:195], v12, s[16:19], s38 offen offset:0 sc1
  buffer_load_dwordx4 v[196:199], v12, s[16:19], s38 offen offset:512 sc1
  buffer_load_dwordx4 v[200:203], v12, s[16:19], s38 offen offset:1024 sc1
  buffer_load_dwordx4 v[204:207], v12, s[16:19], s38 offen offset:1536 sc1
  buffer_load_dwordx4 v[208:211], v12, s[16:19], s38 offen offset:2048 sc1
  buffer_load_dwordx4 v[212:215], v12, s[16:19], s38 offen offset:2560 sc1
  buffer_load_dwordx4 v[216:219], v12, s[16:19], s38 offen offset:3072 sc1
  buffer_load_dwordx4 v[220:223], v12, s[16:19], s38 offen offset:3584 sc1
  s_waitcnt vmcnt(0)
  v_bitop3_b32 v81, v192, v193, v194 bitop3:0x80
  v_bitop3_b32 v81, v81, v195, v196 bitop3:0x80
  v_bitop3_b32 v81, v81, v197, v198 bitop3:0x80
  v_bitop3_b32 v81, v81, v199, v200 bitop3:0x80
  v_bitop3_b32 v81, v81, v201, v202 bitop3:0x80
  v_bitop3_b32 v81, v81, v203, v204 bitop3:0x80
  v_bitop3_b32 v81, v81, v205, v206 bitop3:0x80
  v_bitop3_b32 v81, v81, v207, v208 bitop3:0x80
  v_bitop3_b32 v81, v81, v209, v210 bitop3:0x80
  v_bitop3_b32 v81, v81, v211, v212 bitop3:0x80
  v_bitop3_b32 v81, v81, v213, v214 bitop3:0x80
  v_bitop3_b32 v81, v81, v215, v216 bitop3:0x80
  v_bitop3_b32 v81, v81, v217, v218 bitop3:0x80
  v_bitop3_b32 v81, v81, v219, v220 bitop3:0x80
  v_bitop3_b32 v81, v81, v221, v222 bitop3:0x80
  v_bitop3_b32 v81, v81, v223, 1 bitop3:0x80
  v_cmp_eq_u32 vcc, 0, v81
  s_sub_u32 s46, s46, 1
  s_cbranch_scc1 K2_retry7_ret
  s_cmp_lg_u64 vcc, 0
  s_cbranch_scc1 K2_retry7_l
  s_branch K2_retry7_ret
K2_L:
  s_sub_u32 s36, s3, 4
  s_lshl_b32 s37, s12, 6
  s_lshl_b32 s38, s13, 2
  s_add_u32 s37, s37, s38
  s_add_u32 s37, s37, s36
  s_mul_i32 s38, s36, 8704
  s_add_u32 s38, s38, 114688
  s_lshl_b32 s39, s37, 12
  s_lshl_b32 s40, s37, 1
  v_mov_b32 v4, 0
  s_waitcnt lgkmcnt(0)
  s_mov_b32 s16, s52
  s_mov_b32 s17, s53
  s_mov_b32 s18, 4194304
  s_mov_b32 s19, 0x20000
  s_add_u32 s24, s8, 16777216
  s_addc_u32 s25, s9, 0
  s_mov_b32 s26, 4194304
  s_mov_b32 s27, 0x20000
  s_mov_b32 s20, s54
  s_mov_b32 s21, s55
  s_mov_b32 s22, 2048
  s_mov_b32 s23, 0x20000
  s_add_u32 m0, s38, 4384
  s_nop 0
  buffer_load_dwordx4 v3, s[24:27], s39 offen offset:0 lds
  buffer_load_ushort v5, v4, s[20:23], s40 offen
  s_add_u32 m0, s38, 32
  s_nop 0
  buffer_load_dwordx4 v3, s[16:19], s39 offen offset:0 lds
  s_add_u32 m0, s38, 4384
  s_nop 0
  buffer_load_dwordx4 v3, s[24:27], s39 offen offset:1024 lds
  s_add_u32 m0, s38, 32
  s_nop 0
  buffer_load_dwordx4 v3, s[16:19], s39 offen offset:1024 lds
  s_add_u32 m0, s38, 4384
  s_nop 0
  buffer_load_dwordx4 v3, s[24:27], s39 offen offset:2048 lds
  s_add_u32 m0, s38, 32
  s_nop 0
  buffer_load_dwordx4 v3, s[16:19], s39 offen offset:2048 lds
  s_add_u32 m0, s38, 4384
  s_nop 0
  buffer_load_dwordx4 v3, s[24:27], s39 offen offset:3072 lds
  s_add_u32 m0, s38, 32
  s_nop 0
  buffer_load_dwordx4 v3, s[16:19], s39 offen offset:3072 lds
  s_barrier
  v_lshrrev_b32 v6, 5, v2
  v_bfe_u32 v7, v2, 2, 2
  v_lshl_add_u32 v7, v6, 2, v7
  v_lshlrev_b32 v7, 11, v7
  v_bfe_u32 v8, v2, 4, 1
  v_lshl_add_u32 v7, v8, 6, v7
  v_and_b32 v8, 3, v2
  v_lshlrev_b32 v6, 1, v6
  v_xor_b32 v8, v8, v6
  v_lshl_add_u32 v7, v8, 4, v7
  v_add_u32 v240, 0, v7
  v_add_u32 v241, 15360, v7
  v_add_u32 v242, 30720, v7
  v_add_u32 v243, 46080, v7
  s_lshl_b32 s41, s36, 16
  s_lshr_b32 s42, s10, 2
  s_lshl_b32 s42, s42, 3
  s_lshr_b32 s43, s11, 2
  s_add_u32 s42, s42, s43
  s_lshl_b32 s42, s42, 7
  s_add_u32 s41, s41, s42
  s_add_u32 s41, s41, 1835008
  v_mov_b32 v6, 0
  v_lshlrev_b32 v7, 2, v2
  v_add_u32 v7, s38, v7
  ds_write_b32 v7, v6 offset:4128
  v_and_b32 v8, 7, v2
  v_lshlrev_b32 v8, 2, v8
  v_add_u32 v8, s38, v8
  ds_write_b32 v8, v6
  v_and_b32 v8, 3, v2
  v_bfe_u32 v9, v2, 2, 2
  v_add_u32 v12, v8, v9
  v_lshlrev_b32 v12, 3, v12
  v_lshl_add_u32 v12, v14, 6, v12
  s_add_u32 s43, s38, 8
  v_add_u32 v12, s43, v12
  v_lshlrev_b32 v13, 5, v8
  v_lshlrev_b32 v9, 3, v9
  v_sub_u32 v13, v13, v9
  v_lshlrev_b32 v9, 6, v14
  v_sub_u32 v13, v13, v9
  s_add_u32 s43, s38, 4376
  v_add_u32 v13, s43, v13
  v_mov_b32 v9, s38
  s_add_u32 s28, s8, 16777216
  s_addc_u32 s29, s9, 0
  s_mov_b32 s30, 4194304
  s_mov_b32 s31, 0x20000
  s_mov_b32 s32, s4
  s_mov_b32 s33, s5
  s_mov_b32 s34, 2097152
  s_mov_b32 s35, 0x20000
  s_mov_b32 s44, s56
  s_mov_b32 s45, s57
  s_mov_b32 s46, 4194304
  s_mov_b32 s47, 0x20000
  s_mov_b32 s48, s6
  s_mov_b32 s49, s7
  s_mov_b32 s50, 8388608
  s_mov_b32 s51, 0x20000
  s_setprio 1
  s_waitcnt vmcnt(6)
  ds_read_u16 v6, v9 offset:32
  v_lshlrev_b32 v5, 16, v5
  s_waitcnt lgkmcnt(0)
  v_lshlrev_b32 v6, 16, v6
  v_add_f32 v6, v6, v5
  v_cvt_pk_bf16_f32 v6, v6, v6
  ds_write_b16 v9, v6 offset:32
  s_waitcnt lgkmcnt(0)
  ds_read_b64_tr_b16 v[96:97], v13 offset:32
  ds_read_b64_tr_b16 v[98:99], v13 offset:0
  ds_read_b64_tr_b16 v[32:33], v12 offset:0
  ds_read_b64_tr_b16 v[34:35], v12 offset:32
  ds_read_b64_tr_b16 v[100:101], v13 offset:160
  ds_read_b64_tr_b16 v[102:103], v13 offset:128
  ds_read_b64_tr_b16 v[104:105], v13 offset:288
  ds_read_b64_tr_b16 v[106:107], v13 offset:256
  ds_read_b64_tr_b16 v[36:37], v12 offset:256
  ds_read_b64_tr_b16 v[38:39], v12 offset:288
  s_waitcnt lgkmcnt(6)
  v_mfma_f32_16x16x32_bf16 v[16:19], v[96:99], v[32:35], 0
  ds_read_b64_tr_b16 v[108:109], v13 offset:416
  ds_read_b64_tr_b16 v[110:111], v13 offset:384
  s_waitcnt lgkmcnt(6)
  v_mfma_f32_16x16x32_bf16 v[20:23], v[100:103], v[32:35], 0
  ds_read_b64_tr_b16 v[112:113], v13 offset:544
  ds_read_b64_tr_b16 v[114:115], v13 offset:512
  ds_read_b64_tr_b16 v[40:41], v12 offset:512
  ds_read_b64_tr_b16 v[42:43], v12 offset:544
  s_waitcnt lgkmcnt(8)
  v_mfma_f32_16x16x32_bf16 v[24:27], v[104:107], v[32:35], 0
  ds_read_b64_tr_b16 v[116:117], v13 offset:672
  ds_read_b64_tr_b16 v[118:119], v13 offset:640
  v_add_f32_dpp v224, v19, v18 wave_shr:1 row_mask:0xf bank_mask:0xf bound_ctrl:0
  s_nop 1
  v_add_f32_dpp v226, v224, v17 wave_shr:1 row_mask:0xf bank_mask:0xf bound_ctrl:0
  s_waitcnt lgkmcnt(8)
  v_mfma_f32_16x16x32_bf16 v[24:27], v[96:99], v[36:39], v[24:27]
  v_add_f32_dpp v228, v226, v16 wave_shr:1 row_mask:0xf bank_mask:0xf bound_ctrl:0
  s_waitcnt lgkmcnt(6)
  v_mfma_f32_16x16x32_bf16 v[28:31], v[108:111], v[32:35], 0
  ds_read_b64_tr_b16 v[120:121], v13 offset:800
  ds_read_b64_tr_b16 v[122:123], v13 offset:768
  ds_read_b64_tr_b16 v[44:45], v12 offset:768
  ds_read_b64_tr_b16 v[46:47], v12 offset:800
  v_add_f32_dpp v225, v19, v22 wave_ror:1 row_mask:0xf bank_mask:0xf
  v_add_f32_dpp v227, v224, v21 wave_ror:1 row_mask:0xf bank_mask:0xf
  v_add_f32_dpp v229, v226, v20 wave_ror:1 row_mask:0xf bank_mask:0xf
  v_add_f32_dpp v225, v23, v22 wave_shr:1 row_mask:0xf bank_mask:0xf
  v_mfma_f32_16x16x32_bf16 v[28:31], v[100:103], v[36:39], v[28:31]
  s_nop 0
  v_add_f32_dpp v227, v225, v21 wave_shr:1 row_mask:0xf bank_mask:0xf
  s_nop 1
  v_add_f32_dpp v229, v227, v20 wave_shr:1 row_mask:0xf bank_mask:0xf
  v_cvt_pk_bf16_f32 v232, v228, v229
  v_or_b32 v232, 1, v232
  s_waitcnt lgkmcnt(8)
  v_mfma_f32_16x16x32_bf16 v[16:19], v[112:115], v[32:35], 0
  ds_read_b64_tr_b16 v[124:125], v13 offset:928
  ds_read_b64_tr_b16 v[126:127], v13 offset:896
  v_add_f32_dpp v224, v23, v26 wave_ror:1 row_mask:0xf bank_mask:0xf
  v_add_f32_dpp v226, v225, v25 wave_ror:1 row_mask:0xf bank_mask:0xf
  v_mfma_f32_16x16x32_bf16 v[16:19], v[104:107], v[36:39], v[16:19]
  v_add_f32_dpp v228, v227, v24 wave_ror:1 row_mask:0xf bank_mask:0xf
  v_add_f32_dpp v224, v27, v26 wave_shr:1 row_mask:0xf bank_mask:0xf
  s_waitcnt lgkmcnt(8)
  v_mfma_f32_16x16x32_bf16 v[16:19], v[96:99], v[40:43], v[16:19]
  v_add_f32_dpp v226, v224, v25 wave_shr:1 row_mask:0xf bank_mask:0xf
  s_nop 1
  v_add_f32_dpp v228, v226, v24 wave_shr:1 row_mask:0xf bank_mask:0xf
  s_waitcnt lgkmcnt(6)
  v_mfma_f32_16x16x32_bf16 v[20:23], v[116:119], v[32:35], 0
  s_waitcnt vmcnt(5)
  ds_read_b64_tr_b16 v[128:129], v13 offset:1056
  ds_read_b64_tr_b16 v[130:131], v13 offset:1024
  s_waitcnt vmcnt(4)
  ds_read_b64_tr_b16 v[48:49], v12 offset:1024
  ds_read_b64_tr_b16 v[50:51], v12 offset:1056
  v_add_f32_dpp v225, v27, v30 wave_ror:1 row_mask:0xf bank_mask:0xf
  v_add_f32_dpp v227, v224, v29 wave_ror:1 row_mask:0xf bank_mask:0xf
  v_add_f32_dpp v229, v226, v28 wave_ror:1 row_mask:0xf bank_mask:0xf
  v_mfma_f32_16x16x32_bf16 v[20:23], v[108:111], v[36:39], v[20:23]
  v_add_f32_dpp v225, v31, v30 wave_shr:1 row_mask:0xf bank_mask:0xf
  s_nop 1
  v_add_f32_dpp v227, v225, v29 wave_shr:1 row_mask:0xf bank_mask:0xf
  s_nop 1
  v_add_f32_dpp v229, v227, v28 wave_shr:1 row_mask:0xf bank_mask:0xf
  v_mfma_f32_16x16x32_bf16 v[20:23], v[100:103], v[40:43], v[20:23]
  v_cvt_pk_bf16_f32 v233, v228, v229
  v_or_b32 v233, 1, v233
  s_waitcnt lgkmcnt(8)
  v_mfma_f32_16x16x32_bf16 v[24:27], v[120:123], v[32:35], 0
  ds_read_b64_tr_b16 v[132:133], v13 offset:1184
  ds_read_b64_tr_b16 v[134:135], v13 offset:1152
  v_add_f32_dpp v224, v31, v18 wave_ror:1 row_mask:0xf bank_mask:0xf
  v_add_f32_dpp v226, v225, v17 wave_ror:1 row_mask:0xf bank_mask:0xf
  v_mfma_f32_16x16x32_bf16 v[24:27], v[112:115], v[36:39], v[24:27]
  v_add_f32_dpp v228, v227, v16 wave_ror:1 row_mask:0xf bank_mask:0xf
  v_add_f32_dpp v224, v19, v18 wave_shr:1 row_mask:0xf bank_mask:0xf
  v_mfma_f32_16x16x32_bf16 v[24:27], v[104:107], v[40:43], v[24:27]
  s_nop 0
  v_add_f32_dpp v226, v224, v17 wave_shr:1 row_mask:0xf bank_mask:0xf
  s_waitcnt lgkmcnt(8)
  v_mfma_f32_16x16x32_bf16 v[24:27], v[96:99], v[44:47], v[24:27]
  v_add_f32_dpp v228, v226, v16 wave_shr:1 row_mask:0xf bank_mask:0xf
  s_waitcnt lgkmcnt(6)
  v_mfma_f32_16x16x32_bf16 v[28:31], v[124:127], v[32:35], 0
  ds_read_b64_tr_b16 v[136:137], v13 offset:1312
  ds_read_b64_tr_b16 v[138:139], v13 offset:1280
  ds_read_b64_tr_b16 v[52:53], v12 offset:1280
  ds_read_b64_tr_b16 v[54:55], v12 offset:1312
  v_add_f32_dpp v225, v19, v22 wave_ror:1 row_mask:0xf bank_mask:0xf
  v_add_f32_dpp v227, v224, v21 wave_ror:1 row_mask:0xf bank_mask:0xf
  v_mfma_f32_16x16x32_bf16 v[28:31], v[116:119], v[36:39], v[28:31]
  v_add_f32_dpp v229, v226, v20 wave_ror:1 row_mask:0xf bank_mask:0xf
  v_add_f32_dpp v225, v23, v22 wave_shr:1 row_mask:0xf bank_mask:0xf
  v_mfma_f32_16x16x32_bf16 v[28:31], v[108:111], v[40:43], v[28:31]
  s_nop 0
  v_add_f32_dpp v227, v225, v21 wave_shr:1 row_mask:0xf bank_mask:0xf
  s_nop 1
  v_add_f32_dpp v229, v227, v20 wave_shr:1 row_mask:0xf bank_mask:0xf
  v_mfma_f32_16x16x32_bf16 v[28:31], v[100:103], v[44:47], v[28:31]
  v_cvt_pk_bf16_f32 v234, v228, v229
  v_or_b32 v234, 1, v234
  s_waitcnt lgkmcnt(8)
  v_mfma_f32_16x16x32_bf16 v[16:19], v[128:131], v[32:35], 0
  ds_read_b64_tr_b16 v[140:141], v13 offset:1440
  ds_read_b64_tr_b16 v[142:143], v13 offset:1408
  v_add_f32_dpp v224, v23, v26 wave_ror:1 row_mask:0xf bank_mask:0xf
  v_add_f32_dpp v226, v225, v25 wave_ror:1 row_mask:0xf bank_mask:0xf
  v_mfma_f32_16x16x32_bf16 v[16:19], v[120:123], v[36:39], v[16:19]
  v_add_f32_dpp v228, v227, v24 wave_ror:1 row_mask:0xf bank_mask:0xf
  v_mfma_f32_16x16x32_bf16 v[16:19], v[112:115], v[40:43], v[16:19]
  v_add_f32_dpp v224, v27, v26 wave_shr:1 row_mask:0xf bank_mask:0xf
  v_mfma_f32_16x16x32_bf16 v[16:19], v[104:107], v[44:47], v[16:19]
  s_nop 0
  v_add_f32_dpp v226, v224, v25 wave_shr:1 row_mask:0xf bank_mask:0xf
  s_waitcnt lgkmcnt(8)
  v_mfma_f32_16x16x32_bf16 v[16:19], v[96:99], v[48:51], v[16:19]
  v_add_f32_dpp v228, v226, v24 wave_shr:1 row_mask:0xf bank_mask:0xf
  s_waitcnt lgkmcnt(6)
  v_mfma_f32_16x16x32_bf16 v[20:23], v[132:135], v[32:35], 0
  ds_read_b64_tr_b16 v[144:145], v13 offset:1568
  ds_read_b64_tr_b16 v[146:147], v13 offset:1536
  ds_read_b64_tr_b16 v[56:57], v12 offset:1536
  ds_read_b64_tr_b16 v[58:59], v12 offset:1568
  v_add_f32_dpp v225, v27, v30 wave_ror:1 row_mask:0xf bank_mask:0xf
  v_add_f32_dpp v227, v224, v29 wave_ror:1 row_mask:0xf bank_mask:0xf
  v_mfma_f32_16x16x32_bf16 v[20:23], v[124:127], v[36:39], v[20:23]
  v_add_f32_dpp v229, v226, v28 wave_ror:1 row_mask:0xf bank_mask:0xf
  v_add_f32_dpp v225, v31, v30 wave_shr:1 row_mask:0xf bank_mask:0xf
  v_mfma_f32_16x16x32_bf16 v[20:23], v[116:119], v[40:43], v[20:23]
  s_nop 0
  v_add_f32_dpp v227, v225, v29 wave_shr:1 row_mask:0xf bank_mask:0xf
  s_nop 1
  v_add_f32_dpp v229, v227, v28 wave_shr:1 row_mask:0xf bank_mask:0xf
  v_mfma_f32_16x16x32_bf16 v[20:23], v[108:111], v[44:47], v[20:23]
  v_cvt_pk_bf16_f32 v235, v228, v229
  v_or_b32 v235, 1, v235
  v_mfma_f32_16x16x32_bf16 v[20:23], v[100:103], v[48:51], v[20:23]
  s_waitcnt vmcnt(1)
  buffer_store_dwordx4 v[232:235], v3, s[28:31], s39 offen offset:0 sc1
  s_waitcnt lgkmcnt(8)
  v_mfma_f32_16x16x32_bf16 v[24:27], v[136:139], v[32:35], 0
  ds_read_b64_tr_b16 v[148:149], v13 offset:1696
  ds_read_b64_tr_b16 v[150:151], v13 offset:1664
  v_add_f32_dpp v224, v31, v18 wave_ror:1 row_mask:0xf bank_mask:0xf
  v_mfma_f32_16x16x32_bf16 v[24:27], v[128:131], v[36:39], v[24:27]
  v_add_f32_dpp v226, v225, v17 wave_ror:1 row_mask:0xf bank_mask:0xf
  v_mfma_f32_16x16x32_bf16 v[24:27], v[120:123], v[40:43], v[24:27]
  v_add_f32_dpp v228, v227, v16 wave_ror:1 row_mask:0xf bank_mask:0xf
  v_mfma_f32_16x16x32_bf16 v[24:27], v[112:115], v[44:47], v[24:27]
  v_add_f32_dpp v224, v19, v18 wave_shr:1 row_mask:0xf bank_mask:0xf
  v_mfma_f32_16x16x32_bf16 v[24:27], v[104:107], v[48:51], v[24:27]
  s_nop 0
  v_add_f32_dpp v226, v224, v17 wave_shr:1 row_mask:0xf bank_mask:0xf
  s_waitcnt lgkmcnt(8)
  v_mfma_f32_16x16x32_bf16 v[24:27], v[96:99], v[52:55], v[24:27]
  v_add_f32_dpp v228, v226, v16 wave_shr:1 row_mask:0xf bank_mask:0xf
  s_waitcnt lgkmcnt(6)
  v_mfma_f32_16x16x32_bf16 v[28:31], v[140:143], v[32:35], 0
  ds_read_b64_tr_b16 v[152:153], v13 offset:1824
  ds_read_b64_tr_b16 v[154:155], v13 offset:1792
  ds_read_b64_tr_b16 v[60:61], v12 offset:1792
  ds_read_b64_tr_b16 v[62:63], v12 offset:1824
  v_add_f32_dpp v225, v19, v22 wave_ror:1 row_mask:0xf bank_mask:0xf
  v_add_f32_dpp v227, v224, v21 wave_ror:1 row_mask:0xf bank_mask:0xf
  v_mfma_f32_16x16x32_bf16 v[28:31], v[132:135], v[36:39], v[28:31]
  v_add_f32_dpp v229, v226, v20 wave_ror:1 row_mask:0xf bank_mask:0xf
  v_add_f32_dpp v225, v23, v22 wave_shr:1 row_mask:0xf bank_mask:0xf
  v_mfma_f32_16x16x32_bf16 v[28:31], v[124:127], v[40:43], v[28:31]
  s_nop 0
  v_add_f32_dpp v227, v225, v21 wave_shr:1 row_mask:0xf bank_mask:0xf
  v_mfma_f32_16x16x32_bf16 v[28:31], v[116:119], v[44:47], v[28:31]
  s_nop 0
  v_add_f32_dpp v229, v227, v20 wave_shr:1 row_mask:0xf bank_mask:0xf
  v_mfma_f32_16x16x32_bf16 v[28:31], v[108:111], v[48:51], v[28:31]
  v_cvt_pk_bf16_f32 v236, v228, v229
  v_mfma_f32_16x16x32_bf16 v[28:31], v[100:103], v[52:55], v[28:31]
  v_or_b32 v236, 1, v236
  s_waitcnt lgkmcnt(8)
  v_mfma_f32_16x16x32_bf16 v[16:19], v[144:147], v[32:35], 0
  ds_read_b64_tr_b16 v[156:157], v13 offset:1952
  ds_read_b64_tr_b16 v[158:159], v13 offset:1920
  v_add_f32_dpp v224, v23, v26 wave_ror:1 row_mask:0xf bank_mask:0xf
  v_mfma_f32_16x16x32_bf16 v[16:19], v[136:139], v[36:39], v[16:19]
  v_add_f32_dpp v226, v225, v25 wave_ror:1 row_mask:0xf bank_mask:0xf
  v_mfma_f32_16x16x32_bf16 v[16:19], v[128:131], v[40:43], v[16:19]
  v_add_f32_dpp v228, v227, v24 wave_ror:1 row_mask:0xf bank_mask:0xf
  v_mfma_f32_16x16x32_bf16 v[16:19], v[120:123], v[44:47], v[16:19]
  v_add_f32_dpp v224, v27, v26 wave_shr:1 row_mask:0xf bank_mask:0xf
  v_mfma_f32_16x16x32_bf16 v[16:19], v[112:115], v[48:51], v[16:19]
  s_nop 0
  v_add_f32_dpp v226, v224, v25 wave_shr:1 row_mask:0xf bank_mask:0xf
  v_mfma_f32_16x16x32_bf16 v[16:19], v[104:107], v[52:55], v[16:19]
  s_nop 0
  v_add_f32_dpp v228, v226, v24 wave_shr:1 row_mask:0xf bank_mask:0xf
  s_waitcnt lgkmcnt(8)
  v_mfma_f32_16x16x32_bf16 v[16:19], v[96:99], v[56:59], v[16:19]
  s_waitcnt lgkmcnt(6)
  v_mfma_f32_16x16x32_bf16 v[20:23], v[148:151], v[32:35], 0
  ds_read_b64_tr_b16 v[160:161], v13 offset:2080
  ds_read_b64_tr_b16 v[162:163], v13 offset:2048
  ds_read_b64_tr_b16 v[64:65], v12 offset:2048
  ds_read_b64_tr_b16 v[66:67], v12 offset:2080
  v_add_f32_dpp v225, v27, v30 wave_ror:1 row_mask:0xf bank_mask:0xf
  v_add_f32_dpp v227, v224, v29 wave_ror:1 row_mask:0xf bank_mask:0xf
  v_mfma_f32_16x16x32_bf16 v[20:23], v[140:143], v[36:39], v[20:23]
  v_add_f32_dpp v229, v226, v28 wave_ror:1 row_mask:0xf bank_mask:0xf
  v_mfma_f32_16x16x32_bf16 v[20:23], v[132:135], v[40:43], v[20:23]
  v_add_f32_dpp v225, v31, v30 wave_shr:1 row_mask:0xf bank_mask:0xf
  v_mfma_f32_16x16x32_bf16 v[20:23], v[124:127], v[44:47], v[20:23]
  s_nop 0
  v_add_f32_dpp v227, v225, v29 wave_shr:1 row_mask:0xf bank_mask:0xf
  v_mfma_f32_16x16x32_bf16 v[20:23], v[116:119], v[48:51], v[20:23]
  s_nop 0
  v_add_f32_dpp v229, v227, v28 wave_shr:1 row_mask:0xf bank_mask:0xf
  v_mfma_f32_16x16x32_bf16 v[20:23], v[108:111], v[52:55], v[20:23]
  v_cvt_pk_bf16_f32 v237, v228, v229
  v_mfma_f32_16x16x32_bf16 v[20:23], v[100:103], v[56:59], v[20:23]
  v_or_b32 v237, 1, v237
  s_waitcnt lgkmcnt(8)
  v_mfma_f32_16x16x32_bf16 v[24:27], v[152:155], v[32:35], 0
  ds_read_b64_tr_b16 v[164:165], v13 offset:2208
  ds_read_b64_tr_b16 v[166:167], v13 offset:2176
  v_add_f32_dpp v224, v31, v18 wave_ror:1 row_mask:0xf bank_mask:0xf
  v_mfma_f32_16x16x32_bf16 v[24:27], v[144:147], v[36:39], v[24:27]
  v_add_f32_dpp v226, v225, v17 wave_ror:1 row_mask:0xf bank_mask:0xf
  v_mfma_f32_16x16x32_bf16 v[24:27], v[136:139], v[40:43], v[24:27]
  v_add_f32_dpp v228, v227, v16 wave_ror:1 row_mask:0xf bank_mask:0xf
  v_mfma_f32_16x16x32_bf16 v[24:27], v[128:131], v[44:47], v[24:27]
  v_add_f32_dpp v224, v19, v18 wave_shr:1 row_mask:0xf bank_mask:0xf
  v_mfma_f32_16x16x32_bf16 v[24:27], v[120:123], v[48:51], v[24:27]
  s_nop 0
  v_add_f32_dpp v226, v224, v17 wave_shr:1 row_mask:0xf bank_mask:0xf
  v_mfma_f32_16x16x32_bf16 v[24:27], v[112:115], v[52:55], v[24:27]
  s_nop 0
  v_add_f32_dpp v228, v226, v16 wave_shr:1 row_mask:0xf bank_mask:0xf
  v_mfma_f32_16x16x32_bf16 v[24:27], v[104:107], v[56:59], v[24:27]
  s_waitcnt lgkmcnt(8)
  v_mfma_f32_16x16x32_bf16 v[24:27], v[96:99], v[60:63], v[24:27]
  s_waitcnt lgkmcnt(6)
  v_mfma_f32_16x16x32_bf16 v[28:31], v[156:159], v[32:35], 0
  ds_read_b64_tr_b16 v[168:169], v13 offset:2336
  ds_read_b64_tr_b16 v[170:171], v13 offset:2304
  ds_read_b64_tr_b16 v[68:69], v12 offset:2304
  ds_read_b64_tr_b16 v[70:71], v12 offset:2336
  v_add_f32_dpp v225, v19, v22 wave_ror:1 row_mask:0xf bank_mask:0xf
  v_mfma_f32_16x16x32_bf16 v[28:31], v[148:151], v[36:39], v[28:31]
  v_add_f32_dpp v227, v224, v21 wave_ror:1 row_mask:0xf bank_mask:0xf
  v_mfma_f32_16x16x32_bf16 v[28:31], v[140:143], v[40:43], v[28:31]
  v_add_f32_dpp v229, v226, v20 wave_ror:1 row_mask:0xf bank_mask:0xf
  v_mfma_f32_16x16x32_bf16 v[28:31], v[132:135], v[44:47], v[28:31]
  v_add_f32_dpp v225, v23, v22 wave_shr:1 row_mask:0xf bank_mask:0xf
  v_mfma_f32_16x16x32_bf16 v[28:31], v[124:127], v[48:51], v[28:31]
  s_nop 0
  v_add_f32_dpp v227, v225, v21 wave_shr:1 row_mask:0xf bank_mask:0xf
  v_mfma_f32_16x16x32_bf16 v[28:31], v[116:119], v[52:55], v[28:31]
  s_nop 0
  v_add_f32_dpp v229, v227, v20 wave_shr:1 row_mask:0xf bank_mask:0xf
  v_mfma_f32_16x16x32_bf16 v[28:31], v[108:111], v[56:59], v[28:31]
  v_cvt_pk_bf16_f32 v238, v228, v229
  v_mfma_f32_16x16x32_bf16 v[28:31], v[100:103], v[60:63], v[28:31]
  v_or_b32 v238, 1, v238
  s_waitcnt lgkmcnt(8)
  v_mfma_f32_16x16x32_bf16 v[16:19], v[160:163], v[32:35], 0
  ds_read_b64_tr_b16 v[172:173], v13 offset:2464
  ds_read_b64_tr_b16 v[174:175], v13 offset:2432
  v_add_f32_dpp v224, v23, v26 wave_ror:1 row_mask:0xf bank_mask:0xf
  v_mfma_f32_16x16x32_bf16 v[16:19], v[152:155], v[36:39], v[16:19]
  v_add_f32_dpp v226, v225, v25 wave_ror:1 row_mask:0xf bank_mask:0xf
  v_mfma_f32_16x16x32_bf16 v[16:19], v[144:147], v[40:43], v[16:19]
  v_add_f32_dpp v228, v227, v24 wave_ror:1 row_mask:0xf bank_mask:0xf
  v_mfma_f32_16x16x32_bf16 v[16:19], v[136:139], v[44:47], v[16:19]
  v_add_f32_dpp v224, v27, v26 wave_shr:1 row_mask:0xf bank_mask:0xf
  v_mfma_f32_16x16x32_bf16 v[16:19], v[128:131], v[48:51], v[16:19]
  s_nop 0
  v_add_f32_dpp v226, v224, v25 wave_shr:1 row_mask:0xf bank_mask:0xf
  v_mfma_f32_16x16x32_bf16 v[16:19], v[120:123], v[52:55], v[16:19]
  s_nop 0
  v_add_f32_dpp v228, v226, v24 wave_shr:1 row_mask:0xf bank_mask:0xf
  v_mfma_f32_16x16x32_bf16 v[16:19], v[112:115], v[56:59], v[16:19]
  v_mfma_f32_16x16x32_bf16 v[16:19], v[104:107], v[60:63], v[16:19]
  s_waitcnt lgkmcnt(8)
  v_mfma_f32_16x16x32_bf16 v[16:19], v[96:99], v[64:67], v[16:19]
  s_waitcnt lgkmcnt(6)
  v_mfma_f32_16x16x32_bf16 v[20:23], v[164:167], v[32:35], 0
  ds_read_b64_tr_b16 v[176:177], v13 offset:2592
  ds_read_b64_tr_b16 v[178:179], v13 offset:2560
  ds_read_b64_tr_b16 v[72:73], v12 offset:2560
  ds_read_b64_tr_b16 v[74:75], v12 offset:2592
  v_add_f32_dpp v225, v27, v30 wave_ror:1 row_mask:0xf bank_mask:0xf
  v_mfma_f32_16x16x32_bf16 v[20:23], v[156:159], v[36:39], v[20:23]
  v_add_f32_dpp v227, v224, v29 wave_ror:1 row_mask:0xf bank_mask:0xf
  v_mfma_f32_16x16x32_bf16 v[20:23], v[148:151], v[40:43], v[20:23]
  v_add_f32_dpp v229, v226, v28 wave_ror:1 row_mask:0xf bank_mask:0xf
  v_mfma_f32_16x16x32_bf16 v[20:23], v[140:143], v[44:47], v[20:23]
  v_add_f32_dpp v225, v31, v30 wave_shr:1 row_mask:0xf bank_mask:0xf
  v_mfma_f32_16x16x32_bf16 v[20:23], v[132:135], v[48:51], v[20:23]
  s_nop 0
  v_add_f32_dpp v227, v225, v29 wave_shr:1 row_mask:0xf bank_mask:0xf
  v_mfma_f32_16x16x32_bf16 v[20:23], v[124:127], v[52:55], v[20:23]
  s_nop 0
  v_add_f32_dpp v229, v227, v28 wave_shr:1 row_mask:0xf bank_mask:0xf
  v_mfma_f32_16x16x32_bf16 v[20:23], v[116:119], v[56:59], v[20:23]
  v_cvt_pk_bf16_f32 v239, v228, v229
  v_mfma_f32_16x16x32_bf16 v[20:23], v[108:111], v[60:63], v[20:23]
  v_or_b32 v239, 1, v239
  v_mfma_f32_16x16x32_bf16 v[20:23], v[100:103], v[64:67], v[20:23]
  buffer_store_dwordx4 v[236:239], v3, s[28:31], s39 offen offset:1024 sc1
  s_waitcnt lgkmcnt(8)
  v_mfma_f32_16x16x32_bf16 v[24:27], v[168:171], v[32:35], 0
  ds_read_b64_tr_b16 v[180:181], v13 offset:2720
  ds_read_b64_tr_b16 v[182:183], v13 offset:2688
  v_add_f32_dpp v224, v31, v18 wave_ror:1 row_mask:0xf bank_mask:0xf
  v_mfma_f32_16x16x32_bf16 v[24:27], v[160:163], v[36:39], v[24:27]
  v_add_f32_dpp v226, v225, v17 wave_ror:1 row_mask:0xf bank_mask:0xf
  v_mfma_f32_16x16x32_bf16 v[24:27], v[152:155], v[40:43], v[24:27]
  v_add_f32_dpp v228, v227, v16 wave_ror:1 row_mask:0xf bank_mask:0xf
  v_mfma_f32_16x16x32_bf16 v[24:27], v[144:147], v[44:47], v[24:27]
  v_add_f32_dpp v224, v19, v18 wave_shr:1 row_mask:0xf bank_mask:0xf
  v_mfma_f32_16x16x32_bf16 v[24:27], v[136:139], v[48:51], v[24:27]
  s_nop 0
  v_add_f32_dpp v226, v224, v17 wave_shr:1 row_mask:0xf bank_mask:0xf
  v_mfma_f32_16x16x32_bf16 v[24:27], v[128:131], v[52:55], v[24:27]
  s_nop 0
  v_add_f32_dpp v228, v226, v16 wave_shr:1 row_mask:0xf bank_mask:0xf
  v_mfma_f32_16x16x32_bf16 v[24:27], v[120:123], v[56:59], v[24:27]
  v_mfma_f32_16x16x32_bf16 v[24:27], v[112:115], v[60:63], v[24:27]
  v_mfma_f32_16x16x32_bf16 v[24:27], v[104:107], v[64:67], v[24:27]
  s_waitcnt lgkmcnt(8)
  v_mfma_f32_16x16x32_bf16 v[24:27], v[96:99], v[68:71], v[24:27]
  s_waitcnt lgkmcnt(6)
  v_mfma_f32_16x16x32_bf16 v[28:31], v[172:175], v[32:35], 0
  ds_read_b64_tr_b16 v[184:185], v13 offset:2848
  ds_read_b64_tr_b16 v[186:187], v13 offset:2816
  ds_read_b64_tr_b16 v[76:77], v12 offset:2816
  ds_read_b64_tr_b16 v[78:79], v12 offset:2848
  v_add_f32_dpp v225, v19, v22 wave_ror:1 row_mask:0xf bank_mask:0xf
  v_mfma_f32_16x16x32_bf16 v[28:31], v[164:167], v[36:39], v[28:31]
  v_add_f32_dpp v227, v224, v21 wave_ror:1 row_mask:0xf bank_mask:0xf
  v_mfma_f32_16x16x32_bf16 v[28:31], v[156:159], v[40:43], v[28:31]
  v_add_f32_dpp v229, v226, v20 wave_ror:1 row_mask:0xf bank_mask:0xf
  v_mfma_f32_16x16x32_bf16 v[28:31], v[148:151], v[44:47], v[28:31]
  v_add_f32_dpp v225, v23, v22 wave_shr:1 row_mask:0xf bank_mask:0xf
  v_mfma_f32_16x16x32_bf16 v[28:31], v[140:143], v[48:51], v[28:31]
  s_nop 0
  v_add_f32_dpp v227, v225, v21 wave_shr:1 row_mask:0xf bank_mask:0xf
  v_mfma_f32_16x16x32_bf16 v[28:31], v[132:135], v[52:55], v[28:31]
  s_nop 0
  v_add_f32_dpp v229, v227, v20 wave_shr:1 row_mask:0xf bank_mask:0xf
  v_mfma_f32_16x16x32_bf16 v[28:31], v[124:127], v[56:59], v[28:31]
  v_cvt_pk_bf16_f32 v232, v228, v229
  v_mfma_f32_16x16x32_bf16 v[28:31], v[116:119], v[60:63], v[28:31]
  v_or_b32 v232, 1, v232
  v_mfma_f32_16x16x32_bf16 v[28:31], v[108:111], v[64:67], v[28:31]
  v_mfma_f32_16x16x32_bf16 v[28:31], v[100:103], v[68:71], v[28:31]
  s_waitcnt lgkmcnt(8)
  v_mfma_f32_16x16x32_bf16 v[16:19], v[176:179], v[32:35], 0
  ds_read_b64_tr_b16 v[188:189], v13 offset:2976
  ds_read_b64_tr_b16 v[190:191], v13 offset:2944
  v_add_f32_dpp v224, v23, v26 wave_ror:1 row_mask:0xf bank_mask:0xf
  v_mfma_f32_16x16x32_bf16 v[16:19], v[168:171], v[36:39], v[16:19]
  v_add_f32_dpp v226, v225, v25 wave_ror:1 row_mask:0xf bank_mask:0xf
  v_mfma_f32_16x16x32_bf16 v[16:19], v[160:163], v[40:43], v[16:19]
  v_add_f32_dpp v228, v227, v24 wave_ror:1 row_mask:0xf bank_mask:0xf
  v_mfma_f32_16x16x32_bf16 v[16:19], v[152:155], v[44:47], v[16:19]
  v_add_f32_dpp v224, v27, v26 wave_shr:1 row_mask:0xf bank_mask:0xf
  v_mfma_f32_16x16x32_bf16 v[16:19], v[144:147], v[48:51], v[16:19]
  s_nop 0
  v_add_f32_dpp v226, v224, v25 wave_shr:1 row_mask:0xf bank_mask:0xf
  v_mfma_f32_16x16x32_bf16 v[16:19], v[136:139], v[52:55], v[16:19]
  s_nop 0
  v_add_f32_dpp v228, v226, v24 wave_shr:1 row_mask:0xf bank_mask:0xf
  v_mfma_f32_16x16x32_bf16 v[16:19], v[128:131], v[56:59], v[16:19]
  v_mfma_f32_16x16x32_bf16 v[16:19], v[120:123], v[60:63], v[16:19]
  v_mfma_f32_16x16x32_bf16 v[16:19], v[112:115], v[64:67], v[16:19]
  v_mfma_f32_16x16x32_bf16 v[16:19], v[104:107], v[68:71], v[16:19]
  s_waitcnt lgkmcnt(8)
  v_mfma_f32_16x16x32_bf16 v[16:19], v[96:99], v[72:75], v[16:19]
  s_waitcnt lgkmcnt(6)
  v_mfma_f32_16x16x32_bf16 v[20:23], v[180:183], v[32:35], 0
  ds_read_b64_tr_b16 v[192:193], v13 offset:3104
  ds_read_b64_tr_b16 v[194:195], v13 offset:3072
  s_waitcnt vmcnt(2)
  ds_read_b64_tr_b16 v[80:81], v12 offset:3072
  ds_read_b64_tr_b16 v[82:83], v12 offset:3104
  v_add_f32_dpp v225, v27, v30 wave_ror:1 row_mask:0xf bank_mask:0xf
  v_mfma_f32_16x16x32_bf16 v[20:23], v[172:175], v[36:39], v[20:23]
  v_add_f32_dpp v227, v224, v29 wave_ror:1 row_mask:0xf bank_mask:0xf
  v_mfma_f32_16x16x32_bf16 v[20:23], v[164:167], v[40:43], v[20:23]
  v_add_f32_dpp v229, v226, v28 wave_ror:1 row_mask:0xf bank_mask:0xf
  v_mfma_f32_16x16x32_bf16 v[20:23], v[156:159], v[44:47], v[20:23]
  v_add_f32_dpp v225, v31, v30 wave_shr:1 row_mask:0xf bank_mask:0xf
  v_mfma_f32_16x16x32_bf16 v[20:23], v[148:151], v[48:51], v[20:23]
  s_nop 0
  v_add_f32_dpp v227, v225, v29 wave_shr:1 row_mask:0xf bank_mask:0xf
  v_mfma_f32_16x16x32_bf16 v[20:23], v[140:143], v[52:55], v[20:23]
  s_nop 0
  v_add_f32_dpp v229, v227, v28 wave_shr:1 row_mask:0xf bank_mask:0xf
  v_mfma_f32_16x16x32_bf16 v[20:23], v[132:135], v[56:59], v[20:23]
  v_cvt_pk_bf16_f32 v233, v228, v229
  v_mfma_f32_16x16x32_bf16 v[20:23], v[124:127], v[60:63], v[20:23]
  v_or_b32 v233, 1, v233
  v_mfma_f32_16x16x32_bf16 v[20:23], v[116:119], v[64:67], v[20:23]
  v_mfma_f32_16x16x32_bf16 v[20:23], v[108:111], v[68:71], v[20:23]
  v_mfma_f32_16x16x32_bf16 v[20:23], v[100:103], v[72:75], v[20:23]
  s_waitcnt lgkmcnt(8)
  v_mfma_f32_16x16x32_bf16 v[24:27], v[184:187], v[32:35], 0
  ds_read_b64_tr_b16 v[196:197], v13 offset:3232
  ds_read_b64_tr_b16 v[198:199], v13 offset:3200
  v_add_f32_dpp v224, v31, v18 wave_ror:1 row_mask:0xf bank_mask:0xf
  v_mfma_f32_16x16x32_bf16 v[24:27], v[176:179], v[36:39], v[24:27]
  v_add_f32_dpp v226, v225, v17 wave_ror:1 row_mask:0xf bank_mask:0xf
  v_mfma_f32_16x16x32_bf16 v[24:27], v[168:171], v[40:43], v[24:27]
  v_add_f32_dpp v228, v227, v16 wave_ror:1 row_mask:0xf bank_mask:0xf
  v_mfma_f32_16x16x32_bf16 v[24:27], v[160:163], v[44:47], v[24:27]
  v_add_f32_dpp v224, v19, v18 wave_shr:1 row_mask:0xf bank_mask:0xf
  v_mfma_f32_16x16x32_bf16 v[24:27], v[152:155], v[48:51], v[24:27]
  s_nop 0
  v_add_f32_dpp v226, v224, v17 wave_shr:1 row_mask:0xf bank_mask:0xf
  v_mfma_f32_16x16x32_bf16 v[24:27], v[144:147], v[52:55], v[24:27]
  s_nop 0
  v_add_f32_dpp v228, v226, v16 wave_shr:1 row_mask:0xf bank_mask:0xf
  v_mfma_f32_16x16x32_bf16 v[24:27], v[136:139], v[56:59], v[24:27]
  v_mfma_f32_16x16x32_bf16 v[24:27], v[128:131], v[60:63], v[24:27]
  v_mfma_f32_16x16x32_bf16 v[24:27], v[120:123], v[64:67], v[24:27]
  v_mfma_f32_16x16x32_bf16 v[24:27], v[112:115], v[68:71], v[24:27]
  v_mfma_f32_16x16x32_bf16 v[24:27], v[104:107], v[72:75], v[24:27]
  s_waitcnt lgkmcnt(8)
  v_mfma_f32_16x16x32_bf16 v[24:27], v[96:99], v[76:79], v[24:27]
  s_waitcnt lgkmcnt(6)
  v_mfma_f32_16x16x32_bf16 v[28:31], v[188:191], v[32:35], 0
  ds_read_b64_tr_b16 v[200:201], v13 offset:3360
  ds_read_b64_tr_b16 v[202:203], v13 offset:3328
  ds_read_b64_tr_b16 v[84:85], v12 offset:3328
  ds_read_b64_tr_b16 v[86:87], v12 offset:3360
  v_add_f32_dpp v225, v19, v22 wave_ror:1 row_mask:0xf bank_mask:0xf
  v_mfma_f32_16x16x32_bf16 v[28:31], v[180:183], v[36:39], v[28:31]
  v_add_f32_dpp v227, v224, v21 wave_ror:1 row_mask:0xf bank_mask:0xf
  v_mfma_f32_16x16x32_bf16 v[28:31], v[172:175], v[40:43], v[28:31]
  v_add_f32_dpp v229, v226, v20 wave_ror:1 row_mask:0xf bank_mask:0xf
  v_mfma_f32_16x16x32_bf16 v[28:31], v[164:167], v[44:47], v[28:31]
  v_add_f32_dpp v225, v23, v22 wave_shr:1 row_mask:0xf bank_mask:0xf
  v_mfma_f32_16x16x32_bf16 v[28:31], v[156:159], v[48:51], v[28:31]
  s_nop 0
  v_add_f32_dpp v227, v225, v21 wave_shr:1 row_mask:0xf bank_mask:0xf
  v_mfma_f32_16x16x32_bf16 v[28:31], v[148:151], v[52:55], v[28:31]
  s_nop 0
  v_add_f32_dpp v229, v227, v20 wave_shr:1 row_mask:0xf bank_mask:0xf
  v_mfma_f32_16x16x32_bf16 v[28:31], v[140:143], v[56:59], v[28:31]
  v_cvt_pk_bf16_f32 v234, v228, v229
  v_mfma_f32_16x16x32_bf16 v[28:31], v[132:135], v[60:63], v[28:31]
  v_or_b32 v234, 1, v234
  v_mfma_f32_16x16x32_bf16 v[28:31], v[124:127], v[64:67], v[28:31]
  v_mfma_f32_16x16x32_bf16 v[28:31], v[116:119], v[68:71], v[28:31]
  v_mfma_f32_16x16x32_bf16 v[28:31], v[108:111], v[72:75], v[28:31]
  v_mfma_f32_16x16x32_bf16 v[28:31], v[100:103], v[76:79], v[28:31]
  s_waitcnt lgkmcnt(8)
  v_mfma_f32_16x16x32_bf16 v[16:19], v[192:195], v[32:35], 0
  ds_read_b64_tr_b16 v[204:205], v13 offset:3488
  ds_read_b64_tr_b16 v[206:207], v13 offset:3456
  v_add_f32_dpp v224, v23, v26 wave_ror:1 row_mask:0xf bank_mask:0xf
  v_mfma_f32_16x16x32_bf16 v[16:19], v[184:187], v[36:39], v[16:19]
  v_add_f32_dpp v226, v225, v25 wave_ror:1 row_mask:0xf bank_mask:0xf
  v_mfma_f32_16x16x32_bf16 v[16:19], v[176:179], v[40:43], v[16:19]
  v_add_f32_dpp v228, v227, v24 wave_ror:1 row_mask:0xf bank_mask:0xf
  v_mfma_f32_16x16x32_bf16 v[16:19], v[168:171], v[44:47], v[16:19]
  v_add_f32_dpp v224, v27, v26 wave_shr:1 row_mask:0xf bank_mask:0xf
  v_mfma_f32_16x16x32_bf16 v[16:19], v[160:163], v[48:51], v[16:19]
  s_nop 0
  v_add_f32_dpp v226, v224, v25 wave_shr:1 row_mask:0xf bank_mask:0xf
  v_mfma_f32_16x16x32_bf16 v[16:19], v[152:155], v[52:55], v[16:19]
  s_nop 0
  v_add_f32_dpp v228, v226, v24 wave_shr:1 row_mask:0xf bank_mask:0xf
  v_mfma_f32_16x16x32_bf16 v[16:19], v[144:147], v[56:59], v[16:19]
  v_mfma_f32_16x16x32_bf16 v[16:19], v[136:139], v[60:63], v[16:19]
  v_mfma_f32_16x16x32_bf16 v[16:19], v[128:131], v[64:67], v[16:19]
  v_mfma_f32_16x16x32_bf16 v[16:19], v[120:123], v[68:71], v[16:19]
  v_mfma_f32_16x16x32_bf16 v[16:19], v[112:115], v[72:75], v[16:19]
  v_mfma_f32_16x16x32_bf16 v[16:19], v[104:107], v[76:79], v[16:19]
  s_waitcnt lgkmcnt(8)
  v_mfma_f32_16x16x32_bf16 v[16:19], v[96:99], v[80:83], v[16:19]
  s_waitcnt lgkmcnt(6)
  v_mfma_f32_16x16x32_bf16 v[20:23], v[196:199], v[32:35], 0
  ds_read_b64_tr_b16 v[208:209], v13 offset:3616
  ds_read_b64_tr_b16 v[210:211], v13 offset:3584
  ds_read_b64_tr_b16 v[88:89], v12 offset:3584
  ds_read_b64_tr_b16 v[90:91], v12 offset:3616
  v_add_f32_dpp v225, v27, v30 wave_ror:1 row_mask:0xf bank_mask:0xf
  v_mfma_f32_16x16x32_bf16 v[20:23], v[188:191], v[36:39], v[20:23]
  v_add_f32_dpp v227, v224, v29 wave_ror:1 row_mask:0xf bank_mask:0xf
  v_mfma_f32_16x16x32_bf16 v[20:23], v[180:183], v[40:43], v[20:23]
  v_add_f32_dpp v229, v226, v28 wave_ror:1 row_mask:0xf bank_mask:0xf
  v_mfma_f32_16x16x32_bf16 v[20:23], v[172:175], v[44:47], v[20:23]
  v_add_f32_dpp v225, v31, v30 wave_shr:1 row_mask:0xf bank_mask:0xf
  v_mfma_f32_16x16x32_bf16 v[20:23], v[164:167], v[48:51], v[20:23]
  s_nop 0
  v_add_f32_dpp v227, v225, v29 wave_shr:1 row_mask:0xf bank_mask:0xf
  v_mfma_f32_16x16x32_bf16 v[20:23], v[156:159], v[52:55], v[20:23]
  s_nop 0
  v_add_f32_dpp v229, v227, v28 wave_shr:1 row_mask:0xf bank_mask:0xf
  v_mfma_f32_16x16x32_bf16 v[20:23], v[148:151], v[56:59], v[20:23]
  v_cvt_pk_bf16_f32 v235, v228, v229
  v_mfma_f32_16x16x32_bf16 v[20:23], v[140:143], v[60:63], v[20:23]
  v_or_b32 v235, 1, v235
  v_mfma_f32_16x16x32_bf16 v[20:23], v[132:135], v[64:67], v[20:23]
  buffer_store_dwordx4 v[232:235], v3, s[28:31], s39 offen offset:2048 sc1
  v_mfma_f32_16x16x32_bf16 v[20:23], v[124:127], v[68:71], v[20:23]
  v_mfma_f32_16x16x32_bf16 v[20:23], v[116:119], v[72:75], v[20:23]
  v_mfma_f32_16x16x32_bf16 v[20:23], v[108:111], v[76:79], v[20:23]
  v_mfma_f32_16x16x32_bf16 v[20:23], v[100:103], v[80:83], v[20:23]
  s_waitcnt lgkmcnt(8)
  v_mfma_f32_16x16x32_bf16 v[24:27], v[200:203], v[32:35], 0
  ds_read_b64_tr_b16 v[212:213], v13 offset:3744
  ds_read_b64_tr_b16 v[214:215], v13 offset:3712
  v_add_f32_dpp v224, v31, v18 wave_ror:1 row_mask:0xf bank_mask:0xf
  v_mfma_f32_16x16x32_bf16 v[24:27], v[192:195], v[36:39], v[24:27]
  v_add_f32_dpp v226, v225, v17 wave_ror:1 row_mask:0xf bank_mask:0xf
  v_mfma_f32_16x16x32_bf16 v[24:27], v[184:187], v[40:43], v[24:27]
  v_add_f32_dpp v228, v227, v16 wave_ror:1 row_mask:0xf bank_mask:0xf
  v_mfma_f32_16x16x32_bf16 v[24:27], v[176:179], v[44:47], v[24:27]
  v_add_f32_dpp v224, v19, v18 wave_shr:1 row_mask:0xf bank_mask:0xf
  v_mfma_f32_16x16x32_bf16 v[24:27], v[168:171], v[48:51], v[24:27]
  s_nop 0
  v_add_f32_dpp v226, v224, v17 wave_shr:1 row_mask:0xf bank_mask:0xf
  v_mfma_f32_16x16x32_bf16 v[24:27], v[160:163], v[52:55], v[24:27]
  s_nop 0
  v_add_f32_dpp v228, v226, v16 wave_shr:1 row_mask:0xf bank_mask:0xf
  v_mfma_f32_16x16x32_bf16 v[24:27], v[152:155], v[56:59], v[24:27]
  v_mfma_f32_16x16x32_bf16 v[24:27], v[144:147], v[60:63], v[24:27]
  v_mfma_f32_16x16x32_bf16 v[24:27], v[136:139], v[64:67], v[24:27]
  v_mfma_f32_16x16x32_bf16 v[24:27], v[128:131], v[68:71], v[24:27]
  v_mfma_f32_16x16x32_bf16 v[24:27], v[120:123], v[72:75], v[24:27]
  v_mfma_f32_16x16x32_bf16 v[24:27], v[112:115], v[76:79], v[24:27]
  v_mfma_f32_16x16x32_bf16 v[24:27], v[104:107], v[80:83], v[24:27]
  s_waitcnt lgkmcnt(8)
  v_mfma_f32_16x16x32_bf16 v[24:27], v[96:99], v[84:87], v[24:27]
  s_waitcnt lgkmcnt(6)
  v_mfma_f32_16x16x32_bf16 v[28:31], v[204:207], v[32:35], 0
  ds_read_b64_tr_b16 v[216:217], v13 offset:3872
  ds_read_b64_tr_b16 v[218:219], v13 offset:3840
  ds_read_b64_tr_b16 v[92:93], v12 offset:3840
  ds_read_b64_tr_b16 v[94:95], v12 offset:3872
  v_add_f32_dpp v225, v19, v22 wave_ror:1 row_mask:0xf bank_mask:0xf
  v_mfma_f32_16x16x32_bf16 v[28:31], v[196:199], v[36:39], v[28:31]
  v_add_f32_dpp v227, v224, v21 wave_ror:1 row_mask:0xf bank_mask:0xf
  v_mfma_f32_16x16x32_bf16 v[28:31], v[188:191], v[40:43], v[28:31]
  v_add_f32_dpp v229, v226, v20 wave_ror:1 row_mask:0xf bank_mask:0xf
  v_mfma_f32_16x16x32_bf16 v[28:31], v[180:183], v[44:47], v[28:31]
  v_add_f32_dpp v225, v23, v22 wave_shr:1 row_mask:0xf bank_mask:0xf
  v_mfma_f32_16x16x32_bf16 v[28:31], v[172:175], v[48:51], v[28:31]
  s_nop 0
  v_add_f32_dpp v227, v225, v21 wave_shr:1 row_mask:0xf bank_mask:0xf
  v_mfma_f32_16x16x32_bf16 v[28:31], v[164:167], v[52:55], v[28:31]
  s_nop 0
  v_add_f32_dpp v229, v227, v20 wave_shr:1 row_mask:0xf bank_mask:0xf
  v_mfma_f32_16x16x32_bf16 v[28:31], v[156:159], v[56:59], v[28:31]
  v_cvt_pk_bf16_f32 v236, v228, v229
  v_mfma_f32_16x16x32_bf16 v[28:31], v[148:151], v[60:63], v[28:31]
  v_or_b32 v236, 1, v236
  v_mfma_f32_16x16x32_bf16 v[28:31], v[140:143], v[64:67], v[28:31]
  v_mfma_f32_16x16x32_bf16 v[28:31], v[132:135], v[68:71], v[28:31]
  v_mfma_f32_16x16x32_bf16 v[28:31], v[124:127], v[72:75], v[28:31]
  v_mfma_f32_16x16x32_bf16 v[28:31], v[116:119], v[76:79], v[28:31]
  v_mfma_f32_16x16x32_bf16 v[28:31], v[108:111], v[80:83], v[28:31]
  v_mfma_f32_16x16x32_bf16 v[28:31], v[100:103], v[84:87], v[28:31]
  s_waitcnt lgkmcnt(8)
  v_mfma_f32_16x16x32_bf16 v[16:19], v[208:211], v[32:35], 0
  ds_read_b64_tr_b16 v[220:221], v13 offset:4000
  ds_read_b64_tr_b16 v[222:223], v13 offset:3968
  v_add_f32_dpp v224, v23, v26 wave_ror:1 row_mask:0xf bank_mask:0xf
  v_mfma_f32_16x16x32_bf16 v[16:19], v[200:203], v[36:39], v[16:19]
  v_add_f32_dpp v226, v225, v25 wave_ror:1 row_mask:0xf bank_mask:0xf
  v_mfma_f32_16x16x32_bf16 v[16:19], v[192:195], v[40:43], v[16:19]
  v_add_f32_dpp v228, v227, v24 wave_ror:1 row_mask:0xf bank_mask:0xf
  v_mfma_f32_16x16x32_bf16 v[16:19], v[184:187], v[44:47], v[16:19]
  v_add_f32_dpp v224, v27, v26 wave_shr:1 row_mask:0xf bank_mask:0xf
  v_mfma_f32_16x16x32_bf16 v[16:19], v[176:179], v[48:51], v[16:19]
  s_nop 0
  v_add_f32_dpp v226, v224, v25 wave_shr:1 row_mask:0xf bank_mask:0xf
  v_mfma_f32_16x16x32_bf16 v[16:19], v[168:171], v[52:55], v[16:19]
  s_nop 0
  v_add_f32_dpp v228, v226, v24 wave_shr:1 row_mask:0xf bank_mask:0xf
  v_mfma_f32_16x16x32_bf16 v[16:19], v[160:163], v[56:59], v[16:19]
  v_mfma_f32_16x16x32_bf16 v[16:19], v[152:155], v[60:63], v[16:19]
  v_mfma_f32_16x16x32_bf16 v[16:19], v[144:147], v[64:67], v[16:19]
  v_mfma_f32_16x16x32_bf16 v[16:19], v[136:139], v[68:71], v[16:19]
  v_mfma_f32_16x16x32_bf16 v[16:19], v[128:131], v[72:75], v[16:19]
  v_mfma_f32_16x16x32_bf16 v[16:19], v[120:123], v[76:79], v[16:19]
  v_mfma_f32_16x16x32_bf16 v[16:19], v[112:115], v[80:83], v[16:19]
  v_mfma_f32_16x16x32_bf16 v[16:19], v[104:107], v[84:87], v[16:19]
  s_waitcnt lgkmcnt(8)
  v_mfma_f32_16x16x32_bf16 v[16:19], v[96:99], v[88:91], v[16:19]
  s_waitcnt lgkmcnt(6)
  v_mfma_f32_16x16x32_bf16 v[20:23], v[212:215], v[32:35], 0
  v_add_f32_dpp v225, v27, v30 wave_ror:1 row_mask:0xf bank_mask:0xf
  v_mfma_f32_16x16x32_bf16 v[20:23], v[204:207], v[36:39], v[20:23]
  v_add_f32_dpp v227, v224, v29 wave_ror:1 row_mask:0xf bank_mask:0xf
  v_mfma_f32_16x16x32_bf16 v[20:23], v[196:199], v[40:43], v[20:23]
  v_add_f32_dpp v229, v226, v28 wave_ror:1 row_mask:0xf bank_mask:0xf
  v_mfma_f32_16x16x32_bf16 v[20:23], v[188:191], v[44:47], v[20:23]
  v_add_f32_dpp v225, v31, v30 wave_shr:1 row_mask:0xf bank_mask:0xf
  v_mfma_f32_16x16x32_bf16 v[20:23], v[180:183], v[48:51], v[20:23]
  s_nop 0
  v_add_f32_dpp v227, v225, v29 wave_shr:1 row_mask:0xf bank_mask:0xf
  v_mfma_f32_16x16x32_bf16 v[20:23], v[172:175], v[52:55], v[20:23]
  s_nop 0
  v_add_f32_dpp v229, v227, v28 wave_shr:1 row_mask:0xf bank_mask:0xf
  v_mfma_f32_16x16x32_bf16 v[20:23], v[164:167], v[56:59], v[20:23]
  v_cvt_pk_bf16_f32 v237, v228, v229
  v_mfma_f32_16x16x32_bf16 v[20:23], v[156:159], v[60:63], v[20:23]
  v_or_b32 v237, 1, v237
  v_mfma_f32_16x16x32_bf16 v[20:23], v[148:151], v[64:67], v[20:23]
  v_mfma_f32_16x16x32_bf16 v[20:23], v[140:143], v[68:71], v[20:23]
  v_mfma_f32_16x16x32_bf16 v[20:23], v[132:135], v[72:75], v[20:23]
  v_mfma_f32_16x16x32_bf16 v[20:23], v[124:127], v[76:79], v[20:23]
  v_mfma_f32_16x16x32_bf16 v[20:23], v[116:119], v[80:83], v[20:23]
  v_mfma_f32_16x16x32_bf16 v[20:23], v[108:111], v[84:87], v[20:23]
  v_mfma_f32_16x16x32_bf16 v[20:23], v[100:103], v[88:91], v[20:23]
  s_waitcnt lgkmcnt(4)
  v_mfma_f32_16x16x32_bf16 v[24:27], v[216:219], v[32:35], 0
  v_add_f32_dpp v224, v31, v18 wave_ror:1 row_mask:0xf bank_mask:0xf
  v_mfma_f32_16x16x32_bf16 v[24:27], v[208:211], v[36:39], v[24:27]
  v_add_f32_dpp v226, v225, v17 wave_ror:1 row_mask:0xf bank_mask:0xf
  v_mfma_f32_16x16x32_bf16 v[24:27], v[200:203], v[40:43], v[24:27]
  v_add_f32_dpp v228, v227, v16 wave_ror:1 row_mask:0xf bank_mask:0xf
  v_mfma_f32_16x16x32_bf16 v[24:27], v[192:195], v[44:47], v[24:27]
  v_add_f32_dpp v224, v19, v18 wave_shr:1 row_mask:0xf bank_mask:0xf
  v_mfma_f32_16x16x32_bf16 v[24:27], v[184:187], v[48:51], v[24:27]
  s_nop 0
  v_add_f32_dpp v226, v224, v17 wave_shr:1 row_mask:0xf bank_mask:0xf
  v_mfma_f32_16x16x32_bf16 v[24:27], v[176:179], v[52:55], v[24:27]
  s_nop 0
  v_add_f32_dpp v228, v226, v16 wave_shr:1 row_mask:0xf bank_mask:0xf
  v_mfma_f32_16x16x32_bf16 v[24:27], v[168:171], v[56:59], v[24:27]
  v_mfma_f32_16x16x32_bf16 v[24:27], v[160:163], v[60:63], v[24:27]
  v_mfma_f32_16x16x32_bf16 v[24:27], v[152:155], v[64:67], v[24:27]
  v_mfma_f32_16x16x32_bf16 v[24:27], v[144:147], v[68:71], v[24:27]
  v_mfma_f32_16x16x32_bf16 v[24:27], v[136:139], v[72:75], v[24:27]
  v_mfma_f32_16x16x32_bf16 v[24:27], v[128:131], v[76:79], v[24:27]
  v_mfma_f32_16x16x32_bf16 v[24:27], v[120:123], v[80:83], v[24:27]
  v_mfma_f32_16x16x32_bf16 v[24:27], v[112:115], v[84:87], v[24:27]
  v_mfma_f32_16x16x32_bf16 v[24:27], v[104:107], v[88:91], v[24:27]
  s_waitcnt lgkmcnt(2)
  v_mfma_f32_16x16x32_bf16 v[24:27], v[96:99], v[92:95], v[24:27]
  s_waitcnt lgkmcnt(0)
  v_mfma_f32_16x16x32_bf16 v[28:31], v[220:223], v[32:35], 0
  v_add_f32_dpp v225, v19, v22 wave_ror:1 row_mask:0xf bank_mask:0xf
  v_mfma_f32_16x16x32_bf16 v[28:31], v[212:215], v[36:39], v[28:31]
  v_add_f32_dpp v227, v224, v21 wave_ror:1 row_mask:0xf bank_mask:0xf
  v_mfma_f32_16x16x32_bf16 v[28:31], v[204:207], v[40:43], v[28:31]
  v_add_f32_dpp v229, v226, v20 wave_ror:1 row_mask:0xf bank_mask:0xf
  v_mfma_f32_16x16x32_bf16 v[28:31], v[196:199], v[44:47], v[28:31]
  v_add_f32_dpp v225, v23, v22 wave_shr:1 row_mask:0xf bank_mask:0xf
  v_mfma_f32_16x16x32_bf16 v[28:31], v[188:191], v[48:51], v[28:31]
  s_nop 0
  v_add_f32_dpp v227, v225, v21 wave_shr:1 row_mask:0xf bank_mask:0xf
  v_mfma_f32_16x16x32_bf16 v[28:31], v[180:183], v[52:55], v[28:31]
  s_nop 0
  v_add_f32_dpp v229, v227, v20 wave_shr:1 row_mask:0xf bank_mask:0xf
  v_mfma_f32_16x16x32_bf16 v[28:31], v[172:175], v[56:59], v[28:31]
  v_cvt_pk_bf16_f32 v238, v228, v229
  v_mfma_f32_16x16x32_bf16 v[28:31], v[164:167], v[60:63], v[28:31]
  v_or_b32 v238, 1, v238
  v_mfma_f32_16x16x32_bf16 v[28:31], v[156:159], v[64:67], v[28:31]
  v_mfma_f32_16x16x32_bf16 v[28:31], v[148:151], v[68:71], v[28:31]
  v_mfma_f32_16x16x32_bf16 v[28:31], v[140:143], v[72:75], v[28:31]
  v_mfma_f32_16x16x32_bf16 v[28:31], v[132:135], v[76:79], v[28:31]
  v_mfma_f32_16x16x32_bf16 v[28:31], v[124:127], v[80:83], v[28:31]
  v_mfma_f32_16x16x32_bf16 v[28:31], v[116:119], v[84:87], v[28:31]
  v_mfma_f32_16x16x32_bf16 v[28:31], v[108:111], v[88:91], v[28:31]
  v_mfma_f32_16x16x32_bf16 v[28:31], v[100:103], v[92:95], v[28:31]
  v_add_f32_dpp v224, v23, v26 wave_ror:1 row_mask:0xf bank_mask:0xf
  v_add_f32_dpp v226, v225, v25 wave_ror:1 row_mask:0xf bank_mask:0xf
  v_add_f32_dpp v228, v227, v24 wave_ror:1 row_mask:0xf bank_mask:0xf
  v_add_f32_dpp v224, v27, v26 wave_shr:1 row_mask:0xf bank_mask:0xf
  s_nop 1
  v_add_f32_dpp v226, v224, v25 wave_shr:1 row_mask:0xf bank_mask:0xf
  s_nop 1
  v_add_f32_dpp v228, v226, v24 wave_shr:1 row_mask:0xf bank_mask:0xf
  v_add_f32_dpp v225, v27, v30 wave_ror:1 row_mask:0xf bank_mask:0xf
  v_add_f32_dpp v227, v224, v29 wave_ror:1 row_mask:0xf bank_mask:0xf
  v_add_f32_dpp v229, v226, v28 wave_ror:1 row_mask:0xf bank_mask:0xf
  v_add_f32_dpp v225, v31, v30 wave_shr:1 row_mask:0xf bank_mask:0xf
  s_nop 1
  v_add_f32_dpp v227, v225, v29 wave_shr:1 row_mask:0xf bank_mask:0xf
  s_nop 1
  v_add_f32_dpp v229, v227, v28 wave_shr:1 row_mask:0xf bank_mask:0xf
  v_cvt_pk_bf16_f32 v239, v228, v229
  v_or_b32 v239, 1, v239
  buffer_store_dwordx4 v[236:239], v3, s[28:31], s39 offen offset:3072 sc1
  s_waitcnt lgkmcnt(0)
  s_mov_b32 m0, s38
  s_nop 0
  buffer_load_dwordx4 v240, s[32:35], s41 offen offset:0 lds
  buffer_load_dwordx4 v241, s[32:35], s41 offen offset:1024 lds
  buffer_load_dwordx4 v242, s[32:35], s41 offen offset:2048 lds
  buffer_load_dwordx4 v243, s[32:35], s41 offen offset:3072 lds
  s_setprio 0
  s_lshl_b32 s40, s13, 2
  s_add_u32 s40, s40, s36
  s_lshr_b32 s41, s40, 4
  s_and_b32 s40, s40, 15
  s_lshl_b32 s42, s41, 9
  s_lshl_b32 s43, s40, 2
  s_add_u32 s42, s42, s43
  s_lshl_b32 s43, s42, 11
  s_lshl_b32 s58, s12, 7
  s_add_u32 s43, s43, s58
  s_lshl_b32 s59, s42, 12
  s_add_u32 s59, s59, s58
  v_lshlrev_b32 v4, 11, v14
  v_lshl_add_u32 v4, v15, 3, v4
  v_lshlrev_b32 v5, 12, v14
  v_lshl_add_u32 v5, v15, 3, v5
  v_lshlrev_b32 v7, 14, v15
  v_lshl_add_u32 v7, v14, 4, v7
  s_lshl_b32 s42, s12, 18
  s_lshl_b32 s58, s41, 10
  s_add_u32 s42, s42, s58
  s_lshl_b32 s58, s40, 6
  s_add_u32 s42, s42, s58
  buffer_load_dwordx2 v[32:33], v4, s[44:47], s43 offen
  s_add_u32 s43, s43, 131072
  buffer_load_dwordx2 v[34:35], v4, s[44:47], s43 offen
  s_add_u32 s43, s43, 131072
  buffer_load_dwordx2 v[36:37], v4, s[44:47], s43 offen
  s_add_u32 s43, s43, 131072
  buffer_load_dwordx2 v[38:39], v4, s[44:47], s43 offen
  s_add_u32 s43, s43, 131072
  buffer_load_dwordx2 v[40:41], v4, s[44:47], s43 offen
  s_add_u32 s43, s43, 131072
  buffer_load_dwordx2 v[42:43], v4, s[44:47], s43 offen
  s_add_u32 s43, s43, 131072
  buffer_load_dwordx2 v[44:45], v4, s[44:47], s43 offen
  s_add_u32 s43, s43, 131072
  buffer_load_dwordx2 v[46:47], v4, s[44:47], s43 offen
  s_add_u32 s43, s43, 131072
  v_mov_b32 v6, 1
  s_waitcnt vmcnt(8)
  s_mov_b64 exec, 1
  ds_add_u32 v10, v6 offset:28
  s_mov_b64 exec, -1
  s_add_u32 s40, s42, 4096
  s_add_u32 s41, s42, 8192
  s_add_u32 s43, s42, 12288
  s_mov_b32 s58, 20000
K2_yl:
  buffer_load_dwordx4 v[16:19], v7, s[28:31], s42 offen sc1
  buffer_load_dwordx4 v[20:23], v7, s[28:31], s40 offen sc1
  buffer_load_dwordx4 v[24:27], v7, s[28:31], s41 offen sc1
  buffer_load_dwordx4 v[28:31], v7, s[28:31], s43 offen sc1
  s_waitcnt vmcnt(0)
  v_bitop3_b32 v9, v16, v17, v18 bitop3:0x80
  v_bitop3_b32 v9, v9, v19, v20 bitop3:0x80
  v_bitop3_b32 v9, v9, v21, v22 bitop3:0x80
  v_bitop3_b32 v9, v9, v23, v24 bitop3:0x80
  v_bitop3_b32 v9, v9, v25, v26 bitop3:0x80
  v_bitop3_b32 v9, v9, v27, v28 bitop3:0x80
  v_bitop3_b32 v9, v9, v29, v30 bitop3:0x80
  v_bitop3_b32 v9, v9, v31, 1 bitop3:0x80
  v_cmp_eq_u32 vcc, 0, v9
  s_sub_u32 s58, s58, 1
  s_cbranch_scc1 K2_yok
  s_cmp_eq_u64 vcc, 0
  s_cbranch_scc1 K2_yok
  s_sleep 8
  s_branch K2_yl
K2_yok:
  v_lshlrev_b32 v48, 16, v16
  v_lshlrev_b32 v49, 16, v20
  v_lshlrev_b32 v50, 16, v24
  v_lshlrev_b32 v51, 16, v28
  v_lshlrev_b32 v52, 16, v32
  v_and_b32 v53, 0xffff0000, v32
  v_lshlrev_b32 v54, 16, v33
  v_and_b32 v55, 0xffff0000, v33
  v_mul_f32 v48, v48, v52
  v_mul_f32 v49, v49, v53
  v_mul_f32 v50, v50, v54
  v_mul_f32 v51, v51, v55
  v_cvt_pk_bf16_f32 v64, v48, v49
  v_cvt_pk_bf16_f32 v65, v50, v51
  buffer_store_dwordx2 v[64:65], v5, s[48:51], s59 offen
  s_add_u32 s59, s59, 262144
  v_and_b32 v56, 0xffff0000, v16
  v_and_b32 v57, 0xffff0000, v20
  v_and_b32 v58, 0xffff0000, v24
  v_and_b32 v59, 0xffff0000, v28
  v_lshlrev_b32 v60, 16, v34
  v_and_b32 v61, 0xffff0000, v34
  v_lshlrev_b32 v62, 16, v35
  v_and_b32 v63, 0xffff0000, v35
  v_mul_f32 v56, v56, v60
  v_mul_f32 v57, v57, v61
  v_mul_f32 v58, v58, v62
  v_mul_f32 v59, v59, v63
  v_cvt_pk_bf16_f32 v66, v56, v57
  v_cvt_pk_bf16_f32 v67, v58, v59
  buffer_store_dwordx2 v[66:67], v5, s[48:51], s59 offen
  s_add_u32 s59, s59, 262144
  v_lshlrev_b32 v48, 16, v17
  v_lshlrev_b32 v49, 16, v21
  v_lshlrev_b32 v50, 16, v25
  v_lshlrev_b32 v51, 16, v29
  v_lshlrev_b32 v52, 16, v36
  v_and_b32 v53, 0xffff0000, v36
  v_lshlrev_b32 v54, 16, v37
  v_and_b32 v55, 0xffff0000, v37
  v_mul_f32 v48, v48, v52
  v_mul_f32 v49, v49, v53
  v_mul_f32 v50, v50, v54
  v_mul_f32 v51, v51, v55
  v_cvt_pk_bf16_f32 v68, v48, v49
  v_cvt_pk_bf16_f32 v69, v50, v51
  buffer_store_dwordx2 v[68:69], v5, s[48:51], s59 offen
  s_add_u32 s59, s59, 262144
  v_and_b32 v56, 0xffff0000, v17
  v_and_b32 v57, 0xffff0000, v21
  v_and_b32 v58, 0xffff0000, v25
  v_and_b32 v59, 0xffff0000, v29
  v_lshlrev_b32 v60, 16, v38
  v_and_b32 v61, 0xffff0000, v38
  v_lshlrev_b32 v62, 16, v39
  v_and_b32 v63, 0xffff0000, v39
  v_mul_f32 v56, v56, v60
  v_mul_f32 v57, v57, v61
  v_mul_f32 v58, v58, v62
  v_mul_f32 v59, v59, v63
  v_cvt_pk_bf16_f32 v70, v56, v57
  v_cvt_pk_bf16_f32 v71, v58, v59
  buffer_store_dwordx2 v[70:71], v5, s[48:51], s59 offen
  s_add_u32 s59, s59, 262144
  v_lshlrev_b32 v48, 16, v18
  v_lshlrev_b32 v49, 16, v22
  v_lshlrev_b32 v50, 16, v26
  v_lshlrev_b32 v51, 16, v30
  v_lshlrev_b32 v52, 16, v40
  v_and_b32 v53, 0xffff0000, v40
  v_lshlrev_b32 v54, 16, v41
  v_and_b32 v55, 0xffff0000, v41
  v_mul_f32 v48, v48, v52
  v_mul_f32 v49, v49, v53
  v_mul_f32 v50, v50, v54
  v_mul_f32 v51, v51, v55
  v_cvt_pk_bf16_f32 v72, v48, v49
  v_cvt_pk_bf16_f32 v73, v50, v51
  buffer_store_dwordx2 v[72:73], v5, s[48:51], s59 offen
  s_add_u32 s59, s59, 262144
  v_and_b32 v56, 0xffff0000, v18
  v_and_b32 v57, 0xffff0000, v22
  v_and_b32 v58, 0xffff0000, v26
  v_and_b32 v59, 0xffff0000, v30
  v_lshlrev_b32 v60, 16, v42
  v_and_b32 v61, 0xffff0000, v42
  v_lshlrev_b32 v62, 16, v43
  v_and_b32 v63, 0xffff0000, v43
  v_mul_f32 v56, v56, v60
  v_mul_f32 v57, v57, v61
  v_mul_f32 v58, v58, v62
  v_mul_f32 v59, v59, v63
  v_cvt_pk_bf16_f32 v74, v56, v57
  v_cvt_pk_bf16_f32 v75, v58, v59
  buffer_store_dwordx2 v[74:75], v5, s[48:51], s59 offen
  s_add_u32 s59, s59, 262144
  v_lshlrev_b32 v48, 16, v19
  v_lshlrev_b32 v49, 16, v23
  v_lshlrev_b32 v50, 16, v27
  v_lshlrev_b32 v51, 16, v31
  v_lshlrev_b32 v52, 16, v44
  v_and_b32 v53, 0xffff0000, v44
  v_lshlrev_b32 v54, 16, v45
  v_and_b32 v55, 0xffff0000, v45
  v_mul_f32 v48, v48, v52
  v_mul_f32 v49, v49, v53
  v_mul_f32 v50, v50, v54
  v_mul_f32 v51, v51, v55
  v_cvt_pk_bf16_f32 v76, v48, v49
  v_cvt_pk_bf16_f32 v77, v50, v51
  buffer_store_dwordx2 v[76:77], v5, s[48:51], s59 offen
  s_add_u32 s59, s59, 262144
  v_and_b32 v56, 0xffff0000, v19
  v_and_b32 v57, 0xffff0000, v23
  v_and_b32 v58, 0xffff0000, v27
  v_and_b32 v59, 0xffff0000, v31
  v_lshlrev_b32 v60, 16, v46
  v_and_b32 v61, 0xffff0000, v46
  v_lshlrev_b32 v62, 16, v47
  v_and_b32 v63, 0xffff0000, v47
  v_mul_f32 v56, v56, v60
  v_mul_f32 v57, v57, v61
  v_mul_f32 v58, v58, v62
  v_mul_f32 v59, v59, v63
  v_cvt_pk_bf16_f32 v78, v56, v57
  v_cvt_pk_bf16_f32 v79, v58, v59
  buffer_store_dwordx2 v[78:79], v5, s[48:51], s59 offen
  s_add_u32 s59, s59, 262144
K2_end:
  s_endpgm
K2_code_end:
.section .rodata,"a"
.p2align 6
.amdhsa_kernel k1_kernel
  .amdhsa_next_free_vgpr 196
  .amdhsa_next_free_sgpr 96
  .amdhsa_accum_offset 196
  .amdhsa_group_segment_fixed_size 0
  .amdhsa_kernarg_size 96
  .amdhsa_user_sgpr_count 2
  .amdhsa_user_sgpr_kernarg_segment_ptr 1
  .amdhsa_system_sgpr_workgroup_id_x 1
.end_amdhsa_kernel
.p2align 6
.amdhsa_kernel k2_kernel
  .amdhsa_next_free_vgpr 244
  .amdhsa_next_free_sgpr 96
  .amdhsa_accum_offset 244
  .amdhsa_group_segment_fixed_size 0
  .amdhsa_kernarg_size 96
  .amdhsa_user_sgpr_count 2
  .amdhsa_user_sgpr_kernarg_segment_ptr 1
  .amdhsa_system_sgpr_workgroup_id_x 1
.end_amdhsa_kernel
```

```asm
; @launch grid=(256,1,1) block=(512,1,1) lds=163840
.amdgcn_target "amdgcn-amd-amdhsa--gfx950"
.text
.globl concat_heads__ssm_conv_h3__linear_attn_block__prompt_kernel
.p2align 8
.type concat_heads__ssm_conv_h3__linear_attn_block__prompt_kernel,@function
concat_heads__ssm_conv_h3__linear_attn_block__prompt_kernel:
  s_cmp_ge_u32 s2, 256
  s_cbranch_scc1 K3_end
  s_load_dwordx8 s[84:91], s[0:1], 32
  s_load_dwordx8 s[92:99], s[0:1], 64
  s_load_dwordx8 s[76:83], s[0:1], 0
  v_lshrrev_b32 v1, 6, v0
  v_and_b32 v2, 63, v0
  s_and_b32 s10, s2, 7
  v_readfirstlane_b32 s3, v1
  s_lshr_b32 s11, s2, 3
  s_and_b32 s12, s10, 1
  s_lshl_b32 s12, s12, 3
  s_and_b32 s13, s11, 7
  s_add_u32 s12, s12, s13
  s_lshr_b32 s13, s10, 1
  s_lshl_b32 s13, s13, 2
  s_lshr_b32 s14, s11, 3
  s_add_u32 s13, s13, s14
  s_mov_b32 s75, 0
  s_and_b32 s4, s3, 3
  s_and_b32 s36, s3, 1
  s_bfe_u32 s37, s3, 0x10001
  s_lshl_b32 s5, s13, 1
  s_add_u32 s5, s5, s37
  s_lshl_b32 s6, s10, 7
  s_lshl_b32 s7, s11, 2
  s_add_u32 s6, s6, s7
  s_add_u32 s6, s6, s4
  s_mul_i32 s7, s4, 8704
  v_lshlrev_b32 v3, 4, v2
  v_lshrrev_b32 v14, 4, v2
  v_and_b32 v15, 15, v2
  s_waitcnt lgkmcnt(0)
  s_lshl_b32 s16, s2, 2
  s_add_u32 s16, s16, s4
  s_and_b32 s17, s16, 15
  s_lshr_b32 s16, s16, 4
  s_lshl_b32 s16, s16, 16
  s_lshl_b32 s17, s17, 7
  s_add_u32 s16, s16, s17
  s_add_u32 s8, s78, s16
  s_addc_u32 s9, s79, 0
  s_add_u32 s14, s80, s16
  s_addc_u32 s15, s81, 0
  s_cmp_ge_u32 s3, 4
  s_cbranch_scc1 K3_L
  s_cmp_lg_u32 s3, 0
  s_cbranch_scc1 K3_pfw
  s_mov_b32 s40, s88
  s_mov_b32 s41, s89
  s_mov_b32 s42, 4194304
  s_mov_b32 s43, 0x20000
  v_lshrrev_b32 v192, 3, v2
  v_lshlrev_b32 v192, 11, v192
  v_and_b32 v16, 7, v2
  v_lshl_add_u32 v192, v16, 7, v192
  s_lshl_b32 s45, s2, 14
  s_add_u32 s44, s45, 1024
  s_branch K3_pfd
K3_pfw:
  s_mov_b32 s40, s90
  s_mov_b32 s41, s91
  s_mov_b32 s42, 6291456
  s_mov_b32 s43, 0x20000
  v_lshlrev_b32 v192, 7, v2
  s_mul_i32 s45, s2, 12288
  s_sub_u32 s44, s3, 1
  s_lshl_b32 s44, s44, 12
  s_add_u32 s45, s45, s44
  s_add_u32 s44, s45, 3145728
  s_cmp_eq_u32 s3, 3
  s_cselect_b32 s45, 8388608, s45
  s_cselect_b32 s44, 8388608, s44
K3_pfd:
  buffer_load_dword v195, v192, s[40:43], s45 offen
  s_mov_b32 s56, s96
  s_mov_b32 s57, s97
  s_mov_b32 s58, 256
  s_mov_b32 s59, 0x20000
  s_add_u32 s60, s98, 13631488
  s_addc_u32 s61, s99, 0
  s_mov_b32 s62, 4096
  s_mov_b32 s63, 0x20000
  s_memrealtime s[16:17]
  v_mov_b32 v199, 0
  s_waitcnt lgkmcnt(0)
  s_or_b32 s16, s16, 1
  v_mov_b32 v198, s16
  s_cmp_lg_u32 s3, 3
  s_cbranch_scc1 K3_noseed
  s_cmp_lg_u32 s11, 0
  s_cbranch_scc1 K3_noseed
  v_mov_b32 v196, s16
  v_mov_b32 v197, 0
  s_mov_b64 exec, 1
  buffer_atomic_cmpswap v[196:197], v199, s[56:59], 0 offen sc1
  s_mov_b64 exec, -1
K3_noseed:
  s_lshl_b32 s46, s11, 7
  s_lshl_b32 s47, s10, 2
  s_add_u32 s47, s47, s46
  s_cmp_ge_u32 s3, 2
  s_cselect_b32 s48, s80, s78
  s_cselect_b32 s49, s81, s79
  s_mov_b32 s50, 4194304
  s_mov_b32 s51, 0x20000
  v_lshrrev_b32 v193, 2, v2
  v_lshlrev_b32 v193, 11, v193
  v_and_b32 v16, 3, v2
  v_lshl_add_u32 v193, v16, 7, v193
  s_lshr_b32 s45, s2, 2
  s_lshl_b32 s45, s45, 16
  s_lshl_b32 s46, s36, 15
  s_add_u32 s45, s45, s46
  s_and_b32 s46, s2, 3
  s_lshl_b32 s46, s46, 9
  s_add_u32 s45, s45, s46
  s_mov_b32 s45, 16777216
  s_and_b32 s55, s11, 3
  s_add_u32 s55, s55, 0
  s_and_b32 s52, s11, 1
  s_add_u32 s52, s52, 4
  s_sub_u32 s53, 7, s52
  s_cmp_eq_u32 s3, 3
  s_cselect_b32 s53, s53, 1000
  s_sub_u32 s52, s52, s55
  s_sub_u32 s52, s52, 1
  s_mov_b32 s54, 0
  s_lshl_b32 s38, s36, 6
  v_add_u32 v16, s38, v15
  v_lshrrev_b32 v17, 1, v15
  v_lshlrev_b32 v16, 7, v16
  v_xor_b32 v17, v14, v17
  v_lshl_add_u32 v4, v17, 4, v16
  v_xor_b32 v5, 64, v4
  v_add_u32 v6, 81920, v4
  v_add_u32 v7, 81920, v5
  v_bfe_u32 v17, v2, 2, 2
  v_and_b32 v18, 3, v2
  v_lshlrev_b32 v17, 6, v17
  v_lshl_add_u32 v17, v18, 3, v17
  v_and_b32 v18, 1, v14
  v_lshl_add_u32 v17, v18, 10, v17
  v_lshl_add_u32 v17, v18, 5, v17
  v_lshrrev_b32 v18, 1, v14
  v_mul_u32_u24 v18, 6144, v18
  v_add_u32 v17, v17, v18
  s_lshl_b32 s38, s37, 8
  s_add_u32 s38, s38, 16384
  v_add_u32 v8, s38, v17
  v_xor_b32 v9, 32, v8
  v_add_u32 v10, 81920, v8
  v_add_u32 v11, 81920, v9
  v_mov_b32 v96, 0
  v_mov_b32 v97, 0
  v_mov_b32 v98, 0
  v_mov_b32 v99, 0
  v_mov_b32 v100, 0
  v_mov_b32 v101, 0
  v_mov_b32 v102, 0
  v_mov_b32 v103, 0
  v_mov_b32 v104, 0
  v_mov_b32 v105, 0
  v_mov_b32 v106, 0
  v_mov_b32 v107, 0
  v_mov_b32 v108, 0
  v_mov_b32 v109, 0
  v_mov_b32 v110, 0
  v_mov_b32 v111, 0
  v_mov_b32 v112, 0
  v_mov_b32 v113, 0
  v_mov_b32 v114, 0
  v_mov_b32 v115, 0
  v_mov_b32 v116, 0
  v_mov_b32 v117, 0
  v_mov_b32 v118, 0
  v_mov_b32 v119, 0
  v_mov_b32 v120, 0
  v_mov_b32 v121, 0
  v_mov_b32 v122, 0
  v_mov_b32 v123, 0
  v_mov_b32 v124, 0
  v_mov_b32 v125, 0
  v_mov_b32 v126, 0
  v_mov_b32 v127, 0
  v_mov_b32 v128, 0
  v_mov_b32 v129, 0
  v_mov_b32 v130, 0
  v_mov_b32 v131, 0
  v_mov_b32 v132, 0
  v_mov_b32 v133, 0
  v_mov_b32 v134, 0
  v_mov_b32 v135, 0
  v_mov_b32 v136, 0
  v_mov_b32 v137, 0
  v_mov_b32 v138, 0
  v_mov_b32 v139, 0
  v_mov_b32 v140, 0
  v_mov_b32 v141, 0
  v_mov_b32 v142, 0
  v_mov_b32 v143, 0
  v_mov_b32 v144, 0
  v_mov_b32 v145, 0
  v_mov_b32 v146, 0
  v_mov_b32 v147, 0
  v_mov_b32 v148, 0
  v_mov_b32 v149, 0
  v_mov_b32 v150, 0
  v_mov_b32 v151, 0
  v_mov_b32 v152, 0
  v_mov_b32 v153, 0
  v_mov_b32 v154, 0
  v_mov_b32 v155, 0
  v_mov_b32 v156, 0
  v_mov_b32 v157, 0
  v_mov_b32 v158, 0
  v_mov_b32 v159, 0
  v_mov_b32 v160, 0
  v_mov_b32 v161, 0
  v_mov_b32 v162, 0
  v_mov_b32 v163, 0
  v_mov_b32 v164, 0
  v_mov_b32 v165, 0
  v_mov_b32 v166, 0
  v_mov_b32 v167, 0
  v_mov_b32 v168, 0
  v_mov_b32 v169, 0
  v_mov_b32 v170, 0
  v_mov_b32 v171, 0
  v_mov_b32 v172, 0
  v_mov_b32 v173, 0
  v_mov_b32 v174, 0
  v_mov_b32 v175, 0
  v_mov_b32 v176, 0
  v_mov_b32 v177, 0
  v_mov_b32 v178, 0
  v_mov_b32 v179, 0
  v_mov_b32 v180, 0
  v_mov_b32 v181, 0
  v_mov_b32 v182, 0
  v_mov_b32 v183, 0
  v_mov_b32 v184, 0
  v_mov_b32 v185, 0
  v_mov_b32 v186, 0
  v_mov_b32 v187, 0
  v_mov_b32 v188, 0
  v_mov_b32 v189, 0
  v_mov_b32 v190, 0
  v_mov_b32 v191, 0
  s_waitcnt lgkmcnt(0)
  s_add_u32 s28, s98, 8388608
  s_addc_u32 s29, s99, 0
  s_mov_b32 s30, 2097152
  s_mov_b32 s31, 0x20000
  s_add_u32 s32, s98, 12582912
  s_addc_u32 s33, s99, 0
  s_mov_b32 s34, 65536
  s_mov_b32 s35, 0x20000
  s_barrier
  ds_read_b128 v[16:19], v4 offset:0
  ds_read_b64_tr_b16 v[32:33], v8 offset:0
  ds_read_b64_tr_b16 v[34:35], v8 offset:512
  ds_read_b128 v[20:23], v4 offset:2048
  ds_read_b128 v[24:27], v4 offset:4096
  ds_read_b128 v[28:31], v4 offset:6144
  ds_read_b64_tr_b16 v[36:37], v9 offset:0
  ds_read_b64_tr_b16 v[38:39], v9 offset:512
  ds_read_b64_tr_b16 v[40:41], v8 offset:2048
  ds_read_b64_tr_b16 v[42:43], v8 offset:2560
  ds_read_b64_tr_b16 v[44:45], v9 offset:2048
  ds_read_b64_tr_b16 v[46:47], v9 offset:2560
  ds_read_b64_tr_b16 v[48:49], v8 offset:4096
  ds_read_b64_tr_b16 v[50:51], v8 offset:4608
  ds_read_b64_tr_b16 v[52:53], v9 offset:4096
  ds_read_b64_tr_b16 v[54:55], v9 offset:4608
  s_waitcnt lgkmcnt(0)
  s_mov_b32 s39, 4
K3_loop:
  v_mfma_f32_16x16x32_bf16 v[96:99], v[32:35], v[16:19], v[96:99]
  ds_read_b128 v[56:59], v5 offset:0
  v_mfma_f32_16x16x32_bf16 v[104:107], v[32:35], v[20:23], v[104:107]
  ds_read_b64_tr_b16 v[72:73], v8 offset:12288
  v_mfma_f32_16x16x32_bf16 v[112:115], v[32:35], v[24:27], v[112:115]
  ds_read_b64_tr_b16 v[74:75], v8 offset:12800
  v_mfma_f32_16x16x32_bf16 v[120:123], v[32:35], v[28:31], v[120:123]
  ds_read_b128 v[60:63], v5 offset:2048
  v_mfma_f32_16x16x32_bf16 v[100:103], v[36:39], v[16:19], v[100:103]
  ds_read_b128 v[64:67], v5 offset:4096
  v_mfma_f32_16x16x32_bf16 v[108:111], v[36:39], v[20:23], v[108:111]
  ds_read_b128 v[68:71], v5 offset:6144
  v_mfma_f32_16x16x32_bf16 v[116:119], v[36:39], v[24:27], v[116:119]
  ds_read_b64_tr_b16 v[76:77], v9 offset:12288
  v_mfma_f32_16x16x32_bf16 v[124:127], v[36:39], v[28:31], v[124:127]
  ds_read_b64_tr_b16 v[78:79], v9 offset:12800
  v_mfma_f32_16x16x32_bf16 v[128:131], v[16:19], v[40:43], v[128:131]
  ds_read_b64_tr_b16 v[80:81], v8 offset:14336
  v_mfma_f32_16x16x32_bf16 v[136:139], v[20:23], v[40:43], v[136:139]
  ds_read_b64_tr_b16 v[82:83], v8 offset:14848
  v_mfma_f32_16x16x32_bf16 v[144:147], v[24:27], v[40:43], v[144:147]
  ds_read_b64_tr_b16 v[84:85], v9 offset:14336
  v_mfma_f32_16x16x32_bf16 v[152:155], v[28:31], v[40:43], v[152:155]
  ds_read_b64_tr_b16 v[86:87], v9 offset:14848
  v_mfma_f32_16x16x32_bf16 v[132:135], v[16:19], v[44:47], v[132:135]
  ds_read_b64_tr_b16 v[88:89], v8 offset:16384
  v_mfma_f32_16x16x32_bf16 v[140:143], v[20:23], v[44:47], v[140:143]
  ds_read_b64_tr_b16 v[90:91], v8 offset:16896
  v_mfma_f32_16x16x32_bf16 v[148:151], v[24:27], v[44:47], v[148:151]
  ds_read_b64_tr_b16 v[92:93], v9 offset:16384
  v_mfma_f32_16x16x32_bf16 v[156:159], v[28:31], v[44:47], v[156:159]
  ds_read_b64_tr_b16 v[94:95], v9 offset:16896
  v_mfma_f32_16x16x32_bf16 v[160:163], v[16:19], v[48:51], v[160:163]
  v_mfma_f32_16x16x32_bf16 v[168:171], v[20:23], v[48:51], v[168:171]
  v_mfma_f32_16x16x32_bf16 v[176:179], v[24:27], v[48:51], v[176:179]
  v_mfma_f32_16x16x32_bf16 v[184:187], v[28:31], v[48:51], v[184:187]
  v_mfma_f32_16x16x32_bf16 v[164:167], v[16:19], v[52:55], v[164:167]
  v_mfma_f32_16x16x32_bf16 v[172:175], v[20:23], v[52:55], v[172:175]
  v_mfma_f32_16x16x32_bf16 v[180:183], v[24:27], v[52:55], v[180:183]
  v_mfma_f32_16x16x32_bf16 v[188:191], v[28:31], v[52:55], v[188:191]
  s_waitcnt lgkmcnt(0)
  s_barrier
  s_sub_u32 s55, s55, 1
  s_cbranch_scc1 K3_event0
K3_noev0:
  v_mfma_f32_16x16x32_bf16 v[96:99], v[72:75], v[56:59], v[96:99]
  ds_read_b128 v[16:19], v4 offset:40960
  v_mfma_f32_16x16x32_bf16 v[104:107], v[72:75], v[60:63], v[104:107]
  ds_read_b64_tr_b16 v[32:33], v8 offset:40960
  v_mfma_f32_16x16x32_bf16 v[112:115], v[72:75], v[64:67], v[112:115]
  ds_read_b64_tr_b16 v[34:35], v8 offset:41472
  v_mfma_f32_16x16x32_bf16 v[120:123], v[72:75], v[68:71], v[120:123]
  ds_read_b128 v[20:23], v4 offset:43008
  v_mfma_f32_16x16x32_bf16 v[100:103], v[76:79], v[56:59], v[100:103]
  ds_read_b128 v[24:27], v4 offset:45056
  v_mfma_f32_16x16x32_bf16 v[108:111], v[76:79], v[60:63], v[108:111]
  ds_read_b128 v[28:31], v4 offset:47104
  v_mfma_f32_16x16x32_bf16 v[116:119], v[76:79], v[64:67], v[116:119]
  ds_read_b64_tr_b16 v[36:37], v9 offset:40960
  v_mfma_f32_16x16x32_bf16 v[124:127], v[76:79], v[68:71], v[124:127]
  ds_read_b64_tr_b16 v[38:39], v9 offset:41472
  v_mfma_f32_16x16x32_bf16 v[128:131], v[56:59], v[80:83], v[128:131]
  ds_read_b64_tr_b16 v[40:41], v8 offset:43008
  v_mfma_f32_16x16x32_bf16 v[136:139], v[60:63], v[80:83], v[136:139]
  ds_read_b64_tr_b16 v[42:43], v8 offset:43520
  v_mfma_f32_16x16x32_bf16 v[144:147], v[64:67], v[80:83], v[144:147]
  ds_read_b64_tr_b16 v[44:45], v9 offset:43008
  v_mfma_f32_16x16x32_bf16 v[152:155], v[68:71], v[80:83], v[152:155]
  ds_read_b64_tr_b16 v[46:47], v9 offset:43520
  v_mfma_f32_16x16x32_bf16 v[132:135], v[56:59], v[84:87], v[132:135]
  ds_read_b64_tr_b16 v[48:49], v8 offset:45056
  v_mfma_f32_16x16x32_bf16 v[140:143], v[60:63], v[84:87], v[140:143]
  ds_read_b64_tr_b16 v[50:51], v8 offset:45568
  v_mfma_f32_16x16x32_bf16 v[148:151], v[64:67], v[84:87], v[148:151]
  ds_read_b64_tr_b16 v[52:53], v9 offset:45056
  v_mfma_f32_16x16x32_bf16 v[156:159], v[68:71], v[84:87], v[156:159]
  ds_read_b64_tr_b16 v[54:55], v9 offset:45568
  v_mfma_f32_16x16x32_bf16 v[160:163], v[56:59], v[88:91], v[160:163]
  v_mfma_f32_16x16x32_bf16 v[168:171], v[60:63], v[88:91], v[168:171]
  v_mfma_f32_16x16x32_bf16 v[176:179], v[64:67], v[88:91], v[176:179]
  v_mfma_f32_16x16x32_bf16 v[184:187], v[68:71], v[88:91], v[184:187]
  v_mfma_f32_16x16x32_bf16 v[164:167], v[56:59], v[92:95], v[164:167]
  v_mfma_f32_16x16x32_bf16 v[172:175], v[60:63], v[92:95], v[172:175]
  v_mfma_f32_16x16x32_bf16 v[180:183], v[64:67], v[92:95], v[180:183]
  v_mfma_f32_16x16x32_bf16 v[188:191], v[68:71], v[92:95], v[188:191]
  s_waitcnt lgkmcnt(13)
  v_mfma_f32_16x16x32_bf16 v[96:99], v[32:35], v[16:19], v[96:99]
  ds_read_b128 v[56:59], v5 offset:40960
  s_waitcnt lgkmcnt(13)
  v_mfma_f32_16x16x32_bf16 v[104:107], v[32:35], v[20:23], v[104:107]
  ds_read_b64_tr_b16 v[72:73], v8 offset:53248
  s_waitcnt lgkmcnt(13)
  v_mfma_f32_16x16x32_bf16 v[112:115], v[32:35], v[24:27], v[112:115]
  ds_read_b64_tr_b16 v[74:75], v8 offset:53760
  s_waitcnt lgkmcnt(13)
  v_mfma_f32_16x16x32_bf16 v[120:123], v[32:35], v[28:31], v[120:123]
  ds_read_b128 v[60:63], v5 offset:43008
  s_waitcnt lgkmcnt(12)
  v_mfma_f32_16x16x32_bf16 v[100:103], v[36:39], v[16:19], v[100:103]
  ds_read_b128 v[64:67], v5 offset:45056
  v_mfma_f32_16x16x32_bf16 v[108:111], v[36:39], v[20:23], v[108:111]
  ds_read_b128 v[68:71], v5 offset:47104
  v_mfma_f32_16x16x32_bf16 v[116:119], v[36:39], v[24:27], v[116:119]
  ds_read_b64_tr_b16 v[76:77], v9 offset:53248
  v_mfma_f32_16x16x32_bf16 v[124:127], v[36:39], v[28:31], v[124:127]
  ds_read_b64_tr_b16 v[78:79], v9 offset:53760
  s_waitcnt lgkmcnt(14)
  v_mfma_f32_16x16x32_bf16 v[128:131], v[16:19], v[40:43], v[128:131]
  ds_read_b64_tr_b16 v[80:81], v8 offset:55296
  v_mfma_f32_16x16x32_bf16 v[136:139], v[20:23], v[40:43], v[136:139]
  ds_read_b64_tr_b16 v[82:83], v8 offset:55808
  v_mfma_f32_16x16x32_bf16 v[144:147], v[24:27], v[40:43], v[144:147]
  ds_read_b64_tr_b16 v[84:85], v9 offset:55296
  v_mfma_f32_16x16x32_bf16 v[152:155], v[28:31], v[40:43], v[152:155]
  ds_read_b64_tr_b16 v[86:87], v9 offset:55808
  s_waitcnt lgkmcnt(15)
  v_mfma_f32_16x16x32_bf16 v[132:135], v[16:19], v[44:47], v[132:135]
  ds_read_b64_tr_b16 v[88:89], v8 offset:57344
  v_mfma_f32_16x16x32_bf16 v[140:143], v[20:23], v[44:47], v[140:143]
  ds_read_b64_tr_b16 v[90:91], v8 offset:57856
  v_mfma_f32_16x16x32_bf16 v[148:151], v[24:27], v[44:47], v[148:151]
  ds_read_b64_tr_b16 v[92:93], v9 offset:57344
  v_mfma_f32_16x16x32_bf16 v[156:159], v[28:31], v[44:47], v[156:159]
  ds_read_b64_tr_b16 v[94:95], v9 offset:57856
  s_waitcnt lgkmcnt(15)
  v_mfma_f32_16x16x32_bf16 v[160:163], v[16:19], v[48:51], v[160:163]
  v_mfma_f32_16x16x32_bf16 v[168:171], v[20:23], v[48:51], v[168:171]
  v_mfma_f32_16x16x32_bf16 v[176:179], v[24:27], v[48:51], v[176:179]
  v_mfma_f32_16x16x32_bf16 v[184:187], v[28:31], v[48:51], v[184:187]
  v_mfma_f32_16x16x32_bf16 v[164:167], v[16:19], v[52:55], v[164:167]
  v_mfma_f32_16x16x32_bf16 v[172:175], v[20:23], v[52:55], v[172:175]
  v_mfma_f32_16x16x32_bf16 v[180:183], v[24:27], v[52:55], v[180:183]
  v_mfma_f32_16x16x32_bf16 v[188:191], v[28:31], v[52:55], v[188:191]
  s_waitcnt lgkmcnt(0)
  s_barrier
  s_sub_u32 s55, s55, 1
  s_cbranch_scc1 K3_event1
K3_noev1:
  v_mfma_f32_16x16x32_bf16 v[96:99], v[72:75], v[56:59], v[96:99]
  ds_read_b128 v[16:19], v6 offset:0
  v_mfma_f32_16x16x32_bf16 v[104:107], v[72:75], v[60:63], v[104:107]
  ds_read_b64_tr_b16 v[32:33], v10 offset:0
  v_mfma_f32_16x16x32_bf16 v[112:115], v[72:75], v[64:67], v[112:115]
  ds_read_b64_tr_b16 v[34:35], v10 offset:512
  v_mfma_f32_16x16x32_bf16 v[120:123], v[72:75], v[68:71], v[120:123]
  ds_read_b128 v[20:23], v6 offset:2048
  v_mfma_f32_16x16x32_bf16 v[100:103], v[76:79], v[56:59], v[100:103]
  ds_read_b128 v[24:27], v6 offset:4096
  v_mfma_f32_16x16x32_bf16 v[108:111], v[76:79], v[60:63], v[108:111]
  ds_read_b128 v[28:31], v6 offset:6144
  v_mfma_f32_16x16x32_bf16 v[116:119], v[76:79], v[64:67], v[116:119]
  ds_read_b64_tr_b16 v[36:37], v11 offset:0
  v_mfma_f32_16x16x32_bf16 v[124:127], v[76:79], v[68:71], v[124:127]
  ds_read_b64_tr_b16 v[38:39], v11 offset:512
  v_mfma_f32_16x16x32_bf16 v[128:131], v[56:59], v[80:83], v[128:131]
  ds_read_b64_tr_b16 v[40:41], v10 offset:2048
  v_mfma_f32_16x16x32_bf16 v[136:139], v[60:63], v[80:83], v[136:139]
  ds_read_b64_tr_b16 v[42:43], v10 offset:2560
  v_mfma_f32_16x16x32_bf16 v[144:147], v[64:67], v[80:83], v[144:147]
  ds_read_b64_tr_b16 v[44:45], v11 offset:2048
  v_mfma_f32_16x16x32_bf16 v[152:155], v[68:71], v[80:83], v[152:155]
  ds_read_b64_tr_b16 v[46:47], v11 offset:2560
  v_mfma_f32_16x16x32_bf16 v[132:135], v[56:59], v[84:87], v[132:135]
  ds_read_b64_tr_b16 v[48:49], v10 offset:4096
  v_mfma_f32_16x16x32_bf16 v[140:143], v[60:63], v[84:87], v[140:143]
  ds_read_b64_tr_b16 v[50:51], v10 offset:4608
  v_mfma_f32_16x16x32_bf16 v[148:151], v[64:67], v[84:87], v[148:151]
  ds_read_b64_tr_b16 v[52:53], v11 offset:4096
  v_mfma_f32_16x16x32_bf16 v[156:159], v[68:71], v[84:87], v[156:159]
  ds_read_b64_tr_b16 v[54:55], v11 offset:4608
  v_mfma_f32_16x16x32_bf16 v[160:163], v[56:59], v[88:91], v[160:163]
  v_mfma_f32_16x16x32_bf16 v[168:171], v[60:63], v[88:91], v[168:171]
  v_mfma_f32_16x16x32_bf16 v[176:179], v[64:67], v[88:91], v[176:179]
  v_mfma_f32_16x16x32_bf16 v[184:187], v[68:71], v[88:91], v[184:187]
  v_mfma_f32_16x16x32_bf16 v[164:167], v[56:59], v[92:95], v[164:167]
  v_mfma_f32_16x16x32_bf16 v[172:175], v[60:63], v[92:95], v[172:175]
  v_mfma_f32_16x16x32_bf16 v[180:183], v[64:67], v[92:95], v[180:183]
  v_mfma_f32_16x16x32_bf16 v[188:191], v[68:71], v[92:95], v[188:191]
  s_waitcnt lgkmcnt(13)
  v_mfma_f32_16x16x32_bf16 v[96:99], v[32:35], v[16:19], v[96:99]
  ds_read_b128 v[56:59], v7 offset:0
  s_waitcnt lgkmcnt(13)
  v_mfma_f32_16x16x32_bf16 v[104:107], v[32:35], v[20:23], v[104:107]
  ds_read_b64_tr_b16 v[72:73], v10 offset:12288
  s_waitcnt lgkmcnt(13)
  v_mfma_f32_16x16x32_bf16 v[112:115], v[32:35], v[24:27], v[112:115]
  ds_read_b64_tr_b16 v[74:75], v10 offset:12800
  s_waitcnt lgkmcnt(13)
  v_mfma_f32_16x16x32_bf16 v[120:123], v[32:35], v[28:31], v[120:123]
  ds_read_b128 v[60:63], v7 offset:2048
  s_waitcnt lgkmcnt(12)
  v_mfma_f32_16x16x32_bf16 v[100:103], v[36:39], v[16:19], v[100:103]
  ds_read_b128 v[64:67], v7 offset:4096
  v_mfma_f32_16x16x32_bf16 v[108:111], v[36:39], v[20:23], v[108:111]
  ds_read_b128 v[68:71], v7 offset:6144
  v_mfma_f32_16x16x32_bf16 v[116:119], v[36:39], v[24:27], v[116:119]
  ds_read_b64_tr_b16 v[76:77], v11 offset:12288
  v_mfma_f32_16x16x32_bf16 v[124:127], v[36:39], v[28:31], v[124:127]
  ds_read_b64_tr_b16 v[78:79], v11 offset:12800
  s_waitcnt lgkmcnt(14)
  v_mfma_f32_16x16x32_bf16 v[128:131], v[16:19], v[40:43], v[128:131]
  ds_read_b64_tr_b16 v[80:81], v10 offset:14336
  v_mfma_f32_16x16x32_bf16 v[136:139], v[20:23], v[40:43], v[136:139]
  ds_read_b64_tr_b16 v[82:83], v10 offset:14848
  v_mfma_f32_16x16x32_bf16 v[144:147], v[24:27], v[40:43], v[144:147]
  ds_read_b64_tr_b16 v[84:85], v11 offset:14336
  v_mfma_f32_16x16x32_bf16 v[152:155], v[28:31], v[40:43], v[152:155]
  ds_read_b64_tr_b16 v[86:87], v11 offset:14848
  s_waitcnt lgkmcnt(15)
  v_mfma_f32_16x16x32_bf16 v[132:135], v[16:19], v[44:47], v[132:135]
  ds_read_b64_tr_b16 v[88:89], v10 offset:16384
  v_mfma_f32_16x16x32_bf16 v[140:143], v[20:23], v[44:47], v[140:143]
  ds_read_b64_tr_b16 v[90:91], v10 offset:16896
  v_mfma_f32_16x16x32_bf16 v[148:151], v[24:27], v[44:47], v[148:151]
  ds_read_b64_tr_b16 v[92:93], v11 offset:16384
  v_mfma_f32_16x16x32_bf16 v[156:159], v[28:31], v[44:47], v[156:159]
  ds_read_b64_tr_b16 v[94:95], v11 offset:16896
  s_waitcnt lgkmcnt(15)
  v_mfma_f32_16x16x32_bf16 v[160:163], v[16:19], v[48:51], v[160:163]
  v_mfma_f32_16x16x32_bf16 v[168:171], v[20:23], v[48:51], v[168:171]
  v_mfma_f32_16x16x32_bf16 v[176:179], v[24:27], v[48:51], v[176:179]
  v_mfma_f32_16x16x32_bf16 v[184:187], v[28:31], v[48:51], v[184:187]
  v_mfma_f32_16x16x32_bf16 v[164:167], v[16:19], v[52:55], v[164:167]
  v_mfma_f32_16x16x32_bf16 v[172:175], v[20:23], v[52:55], v[172:175]
  v_mfma_f32_16x16x32_bf16 v[180:183], v[24:27], v[52:55], v[180:183]
  v_mfma_f32_16x16x32_bf16 v[188:191], v[28:31], v[52:55], v[188:191]
  s_waitcnt lgkmcnt(0)
  s_barrier
  s_sub_u32 s55, s55, 1
  s_cbranch_scc1 K3_event2
K3_noev2:
  v_mfma_f32_16x16x32_bf16 v[96:99], v[72:75], v[56:59], v[96:99]
  ds_read_b128 v[16:19], v6 offset:40960
  v_mfma_f32_16x16x32_bf16 v[104:107], v[72:75], v[60:63], v[104:107]
  ds_read_b64_tr_b16 v[32:33], v10 offset:40960
  v_mfma_f32_16x16x32_bf16 v[112:115], v[72:75], v[64:67], v[112:115]
  ds_read_b64_tr_b16 v[34:35], v10 offset:41472
  v_mfma_f32_16x16x32_bf16 v[120:123], v[72:75], v[68:71], v[120:123]
  ds_read_b128 v[20:23], v6 offset:43008
  v_mfma_f32_16x16x32_bf16 v[100:103], v[76:79], v[56:59], v[100:103]
  ds_read_b128 v[24:27], v6 offset:45056
  v_mfma_f32_16x16x32_bf16 v[108:111], v[76:79], v[60:63], v[108:111]
  ds_read_b128 v[28:31], v6 offset:47104
  v_mfma_f32_16x16x32_bf16 v[116:119], v[76:79], v[64:67], v[116:119]
  ds_read_b64_tr_b16 v[36:37], v11 offset:40960
  v_mfma_f32_16x16x32_bf16 v[124:127], v[76:79], v[68:71], v[124:127]
  ds_read_b64_tr_b16 v[38:39], v11 offset:41472
  v_mfma_f32_16x16x32_bf16 v[128:131], v[56:59], v[80:83], v[128:131]
  ds_read_b64_tr_b16 v[40:41], v10 offset:43008
  v_mfma_f32_16x16x32_bf16 v[136:139], v[60:63], v[80:83], v[136:139]
  ds_read_b64_tr_b16 v[42:43], v10 offset:43520
  v_mfma_f32_16x16x32_bf16 v[144:147], v[64:67], v[80:83], v[144:147]
  ds_read_b64_tr_b16 v[44:45], v11 offset:43008
  v_mfma_f32_16x16x32_bf16 v[152:155], v[68:71], v[80:83], v[152:155]
  ds_read_b64_tr_b16 v[46:47], v11 offset:43520
  v_mfma_f32_16x16x32_bf16 v[132:135], v[56:59], v[84:87], v[132:135]
  ds_read_b64_tr_b16 v[48:49], v10 offset:45056
  v_mfma_f32_16x16x32_bf16 v[140:143], v[60:63], v[84:87], v[140:143]
  ds_read_b64_tr_b16 v[50:51], v10 offset:45568
  v_mfma_f32_16x16x32_bf16 v[148:151], v[64:67], v[84:87], v[148:151]
  ds_read_b64_tr_b16 v[52:53], v11 offset:45056
  v_mfma_f32_16x16x32_bf16 v[156:159], v[68:71], v[84:87], v[156:159]
  ds_read_b64_tr_b16 v[54:55], v11 offset:45568
  v_mfma_f32_16x16x32_bf16 v[160:163], v[56:59], v[88:91], v[160:163]
  v_mfma_f32_16x16x32_bf16 v[168:171], v[60:63], v[88:91], v[168:171]
  v_mfma_f32_16x16x32_bf16 v[176:179], v[64:67], v[88:91], v[176:179]
  v_mfma_f32_16x16x32_bf16 v[184:187], v[68:71], v[88:91], v[184:187]
  v_mfma_f32_16x16x32_bf16 v[164:167], v[56:59], v[92:95], v[164:167]
  v_mfma_f32_16x16x32_bf16 v[172:175], v[60:63], v[92:95], v[172:175]
  v_mfma_f32_16x16x32_bf16 v[180:183], v[64:67], v[92:95], v[180:183]
  v_mfma_f32_16x16x32_bf16 v[188:191], v[68:71], v[92:95], v[188:191]
  s_waitcnt lgkmcnt(13)
  v_mfma_f32_16x16x32_bf16 v[96:99], v[32:35], v[16:19], v[96:99]
  ds_read_b128 v[56:59], v7 offset:40960
  s_waitcnt lgkmcnt(13)
  v_mfma_f32_16x16x32_bf16 v[104:107], v[32:35], v[20:23], v[104:107]
  ds_read_b64_tr_b16 v[72:73], v10 offset:53248
  s_waitcnt lgkmcnt(13)
  v_mfma_f32_16x16x32_bf16 v[112:115], v[32:35], v[24:27], v[112:115]
  ds_read_b64_tr_b16 v[74:75], v10 offset:53760
  s_waitcnt lgkmcnt(13)
  v_mfma_f32_16x16x32_bf16 v[120:123], v[32:35], v[28:31], v[120:123]
  ds_read_b128 v[60:63], v7 offset:43008
  s_waitcnt lgkmcnt(12)
  v_mfma_f32_16x16x32_bf16 v[100:103], v[36:39], v[16:19], v[100:103]
  ds_read_b128 v[64:67], v7 offset:45056
  v_mfma_f32_16x16x32_bf16 v[108:111], v[36:39], v[20:23], v[108:111]
  ds_read_b128 v[68:71], v7 offset:47104
  v_mfma_f32_16x16x32_bf16 v[116:119], v[36:39], v[24:27], v[116:119]
  ds_read_b64_tr_b16 v[76:77], v11 offset:53248
  v_mfma_f32_16x16x32_bf16 v[124:127], v[36:39], v[28:31], v[124:127]
  ds_read_b64_tr_b16 v[78:79], v11 offset:53760
  s_waitcnt lgkmcnt(14)
  v_mfma_f32_16x16x32_bf16 v[128:131], v[16:19], v[40:43], v[128:131]
  ds_read_b64_tr_b16 v[80:81], v10 offset:55296
  v_mfma_f32_16x16x32_bf16 v[136:139], v[20:23], v[40:43], v[136:139]
  ds_read_b64_tr_b16 v[82:83], v10 offset:55808
  v_mfma_f32_16x16x32_bf16 v[144:147], v[24:27], v[40:43], v[144:147]
  ds_read_b64_tr_b16 v[84:85], v11 offset:55296
  v_mfma_f32_16x16x32_bf16 v[152:155], v[28:31], v[40:43], v[152:155]
  ds_read_b64_tr_b16 v[86:87], v11 offset:55808
  s_waitcnt lgkmcnt(15)
  v_mfma_f32_16x16x32_bf16 v[132:135], v[16:19], v[44:47], v[132:135]
  ds_read_b64_tr_b16 v[88:89], v10 offset:57344
  v_mfma_f32_16x16x32_bf16 v[140:143], v[20:23], v[44:47], v[140:143]
  ds_read_b64_tr_b16 v[90:91], v10 offset:57856
  v_mfma_f32_16x16x32_bf16 v[148:151], v[24:27], v[44:47], v[148:151]
  ds_read_b64_tr_b16 v[92:93], v11 offset:57344
  v_mfma_f32_16x16x32_bf16 v[156:159], v[28:31], v[44:47], v[156:159]
  ds_read_b64_tr_b16 v[94:95], v11 offset:57856
  s_waitcnt lgkmcnt(15)
  v_mfma_f32_16x16x32_bf16 v[160:163], v[16:19], v[48:51], v[160:163]
  v_mfma_f32_16x16x32_bf16 v[168:171], v[20:23], v[48:51], v[168:171]
  v_mfma_f32_16x16x32_bf16 v[176:179], v[24:27], v[48:51], v[176:179]
  v_mfma_f32_16x16x32_bf16 v[184:187], v[28:31], v[48:51], v[184:187]
  v_mfma_f32_16x16x32_bf16 v[164:167], v[16:19], v[52:55], v[164:167]
  v_mfma_f32_16x16x32_bf16 v[172:175], v[20:23], v[52:55], v[172:175]
  v_mfma_f32_16x16x32_bf16 v[180:183], v[24:27], v[52:55], v[180:183]
  v_mfma_f32_16x16x32_bf16 v[188:191], v[28:31], v[52:55], v[188:191]
  s_waitcnt lgkmcnt(0)
  s_barrier
  s_sub_u32 s55, s55, 1
  s_cbranch_scc1 K3_event3
K3_noev3:
  v_mfma_f32_16x16x32_bf16 v[96:99], v[72:75], v[56:59], v[96:99]
  ds_read_b128 v[16:19], v4 offset:0
  v_mfma_f32_16x16x32_bf16 v[104:107], v[72:75], v[60:63], v[104:107]
  ds_read_b64_tr_b16 v[32:33], v8 offset:0
  v_mfma_f32_16x16x32_bf16 v[112:115], v[72:75], v[64:67], v[112:115]
  ds_read_b64_tr_b16 v[34:35], v8 offset:512
  v_mfma_f32_16x16x32_bf16 v[120:123], v[72:75], v[68:71], v[120:123]
  ds_read_b128 v[20:23], v4 offset:2048
  v_mfma_f32_16x16x32_bf16 v[100:103], v[76:79], v[56:59], v[100:103]
  ds_read_b128 v[24:27], v4 offset:4096
  v_mfma_f32_16x16x32_bf16 v[108:111], v[76:79], v[60:63], v[108:111]
  ds_read_b128 v[28:31], v4 offset:6144
  v_mfma_f32_16x16x32_bf16 v[116:119], v[76:79], v[64:67], v[116:119]
  ds_read_b64_tr_b16 v[36:37], v9 offset:0
  v_mfma_f32_16x16x32_bf16 v[124:127], v[76:79], v[68:71], v[124:127]
  ds_read_b64_tr_b16 v[38:39], v9 offset:512
  v_mfma_f32_16x16x32_bf16 v[128:131], v[56:59], v[80:83], v[128:131]
  ds_read_b64_tr_b16 v[40:41], v8 offset:2048
  v_mfma_f32_16x16x32_bf16 v[136:139], v[60:63], v[80:83], v[136:139]
  ds_read_b64_tr_b16 v[42:43], v8 offset:2560
  v_mfma_f32_16x16x32_bf16 v[144:147], v[64:67], v[80:83], v[144:147]
  ds_read_b64_tr_b16 v[44:45], v9 offset:2048
  v_mfma_f32_16x16x32_bf16 v[152:155], v[68:71], v[80:83], v[152:155]
  ds_read_b64_tr_b16 v[46:47], v9 offset:2560
  v_mfma_f32_16x16x32_bf16 v[132:135], v[56:59], v[84:87], v[132:135]
  ds_read_b64_tr_b16 v[48:49], v8 offset:4096
  v_mfma_f32_16x16x32_bf16 v[140:143], v[60:63], v[84:87], v[140:143]
  ds_read_b64_tr_b16 v[50:51], v8 offset:4608
  v_mfma_f32_16x16x32_bf16 v[148:151], v[64:67], v[84:87], v[148:151]
  ds_read_b64_tr_b16 v[52:53], v9 offset:4096
  v_mfma_f32_16x16x32_bf16 v[156:159], v[68:71], v[84:87], v[156:159]
  ds_read_b64_tr_b16 v[54:55], v9 offset:4608
  v_mfma_f32_16x16x32_bf16 v[160:163], v[56:59], v[88:91], v[160:163]
  v_mfma_f32_16x16x32_bf16 v[168:171], v[60:63], v[88:91], v[168:171]
  v_mfma_f32_16x16x32_bf16 v[176:179], v[64:67], v[88:91], v[176:179]
  v_mfma_f32_16x16x32_bf16 v[184:187], v[68:71], v[88:91], v[184:187]
  v_mfma_f32_16x16x32_bf16 v[164:167], v[56:59], v[92:95], v[164:167]
  v_mfma_f32_16x16x32_bf16 v[172:175], v[60:63], v[92:95], v[172:175]
  v_mfma_f32_16x16x32_bf16 v[180:183], v[64:67], v[92:95], v[180:183]
  v_mfma_f32_16x16x32_bf16 v[188:191], v[68:71], v[92:95], v[188:191]
  s_sub_u32 s39, s39, 1
  s_cmp_lg_u32 s39, 0
  s_waitcnt lgkmcnt(0)
  s_cbranch_scc1 K3_loop
  s_mov_b32 s44, 1069066811
  s_mov_b32 s45, 1069066811
  s_mov_b32 s46, 897988541
  s_mov_b32 s47, 897988541
  v_mov_b32 v10, 39168
  v_mov_b32 v11, 1
  v_cvt_pk_bf16_f32 v16, v160, v161
  v_cvt_pk_bf16_f32 v17, v162, v163
  v_cvt_pk_bf16_f32 v18, v168, v169
  v_cvt_pk_bf16_f32 v19, v170, v171
  v_cvt_pk_bf16_f32 v20, v176, v177
  v_cvt_pk_bf16_f32 v21, v178, v179
  v_cvt_pk_bf16_f32 v22, v184, v185
  v_cvt_pk_bf16_f32 v23, v186, v187
  v_cvt_pk_bf16_f32 v24, v164, v165
  v_cvt_pk_bf16_f32 v25, v166, v167
  v_cvt_pk_bf16_f32 v26, v172, v173
  v_cvt_pk_bf16_f32 v27, v174, v175
  v_cvt_pk_bf16_f32 v28, v180, v181
  v_cvt_pk_bf16_f32 v29, v182, v183
  v_cvt_pk_bf16_f32 v30, v188, v189
  v_cvt_pk_bf16_f32 v31, v190, v191
  v_mov_b32 v48, 0x3f803f80
  v_mov_b32 v49, 0x3f803f80
  v_mov_b32 v50, 0x3f803f80
  v_mov_b32 v51, 0x3f803f80
  v_cvt_pk_bf16_f32 v52, v128, v129
  v_cvt_pk_bf16_f32 v53, v130, v131
  v_cvt_pk_bf16_f32 v54, v136, v137
  v_cvt_pk_bf16_f32 v55, v138, v139
  v_lshlrev_b32 v56, 16, v52
  v_and_b32 v57, 0xffff0000, v52
  v_lshlrev_b32 v58, 16, v53
  v_and_b32 v59, 0xffff0000, v53
  v_lshlrev_b32 v60, 16, v54
  v_and_b32 v61, 0xffff0000, v54
  v_lshlrev_b32 v62, 16, v55
  v_and_b32 v63, 0xffff0000, v55
  v_min_f32 v64, 0, v56
  v_min_f32 v65, 0, v57
  v_min_f32 v66, 0, v58
  v_min_f32 v67, 0, v59
  v_min_f32 v68, 0, v60
  v_min_f32 v69, 0, v61
  v_min_f32 v70, 0, v62
  v_min_f32 v71, 0, v63
  v_pk_mul_f32 v[72:73], v[64:65], s[44:45]
  v_pk_mul_f32 v[74:75], v[66:67], s[44:45]
  v_pk_mul_f32 v[76:77], v[68:69], s[44:45]
  v_pk_mul_f32 v[78:79], v[70:71], s[44:45]
  v_exp_f32 v72, v72
  v_exp_f32 v73, v73
  v_exp_f32 v74, v74
  v_exp_f32 v75, v75
  v_exp_f32 v76, v76
  v_exp_f32 v77, v77
  v_exp_f32 v78, v78
  v_exp_f32 v79, v79
  v_pk_add_f32 v[56:57], v[56:57], v[64:65] neg_lo:[0,1] neg_hi:[0,1]
  v_pk_add_f32 v[58:59], v[58:59], v[66:67] neg_lo:[0,1] neg_hi:[0,1]
  v_pk_add_f32 v[60:61], v[60:61], v[68:69] neg_lo:[0,1] neg_hi:[0,1]
  v_pk_add_f32 v[62:63], v[62:63], v[70:71] neg_lo:[0,1] neg_hi:[0,1]
  v_pk_add_f32 v[56:57], v[56:57], v[72:73]
  v_pk_add_f32 v[58:59], v[58:59], v[74:75]
  v_pk_add_f32 v[60:61], v[60:61], v[76:77]
  v_pk_add_f32 v[62:63], v[62:63], v[78:79]
  v_pk_add_f32 v[56:57], v[56:57], s[46:47]
  v_pk_add_f32 v[58:59], v[58:59], s[46:47]
  v_pk_add_f32 v[60:61], v[60:61], s[46:47]
  v_pk_add_f32 v[62:63], v[62:63], s[46:47]
  v_cvt_pk_bf16_f32 v32, v56, v57
  v_cvt_pk_bf16_f32 v33, v58, v59
  v_cvt_pk_bf16_f32 v34, v60, v61
  v_cvt_pk_bf16_f32 v35, v62, v63
  s_nop 1
  v_mfma_f32_16x16x32_bf16 v[160:163], v[32:35], v[16:19], 0
  v_mfma_f32_16x16x32_bf16 v[168:171], v[32:35], v[24:27], 0
  v_mfma_f32_16x16x32_bf16 v[176:179], v[32:35], v[48:51], 0
  v_cvt_pk_bf16_f32 v52, v132, v133
  v_cvt_pk_bf16_f32 v53, v134, v135
  v_cvt_pk_bf16_f32 v54, v140, v141
  v_cvt_pk_bf16_f32 v55, v142, v143
  v_lshlrev_b32 v56, 16, v52
  v_and_b32 v57, 0xffff0000, v52
  v_lshlrev_b32 v58, 16, v53
  v_and_b32 v59, 0xffff0000, v53
  v_lshlrev_b32 v60, 16, v54
  v_and_b32 v61, 0xffff0000, v54
  v_lshlrev_b32 v62, 16, v55
  v_and_b32 v63, 0xffff0000, v55
  v_min_f32 v64, 0, v56
  v_min_f32 v65, 0, v57
  v_min_f32 v66, 0, v58
  v_min_f32 v67, 0, v59
  v_min_f32 v68, 0, v60
  v_min_f32 v69, 0, v61
  v_min_f32 v70, 0, v62
  v_min_f32 v71, 0, v63
  v_pk_mul_f32 v[72:73], v[64:65], s[44:45]
  v_pk_mul_f32 v[74:75], v[66:67], s[44:45]
  v_pk_mul_f32 v[76:77], v[68:69], s[44:45]
  v_pk_mul_f32 v[78:79], v[70:71], s[44:45]
  v_exp_f32 v72, v72
  v_exp_f32 v73, v73
  v_exp_f32 v74, v74
  v_exp_f32 v75, v75
  v_exp_f32 v76, v76
  v_exp_f32 v77, v77
  v_exp_f32 v78, v78
  v_exp_f32 v79, v79
  v_pk_add_f32 v[56:57], v[56:57], v[64:65] neg_lo:[0,1] neg_hi:[0,1]
  v_pk_add_f32 v[58:59], v[58:59], v[66:67] neg_lo:[0,1] neg_hi:[0,1]
  v_pk_add_f32 v[60:61], v[60:61], v[68:69] neg_lo:[0,1] neg_hi:[0,1]
  v_pk_add_f32 v[62:63], v[62:63], v[70:71] neg_lo:[0,1] neg_hi:[0,1]
  v_pk_add_f32 v[56:57], v[56:57], v[72:73]
  v_pk_add_f32 v[58:59], v[58:59], v[74:75]
  v_pk_add_f32 v[60:61], v[60:61], v[76:77]
  v_pk_add_f32 v[62:63], v[62:63], v[78:79]
  v_pk_add_f32 v[56:57], v[56:57], s[46:47]
  v_pk_add_f32 v[58:59], v[58:59], s[46:47]
  v_pk_add_f32 v[60:61], v[60:61], s[46:47]
  v_pk_add_f32 v[62:63], v[62:63], s[46:47]
  v_cvt_pk_bf16_f32 v40, v56, v57
  v_cvt_pk_bf16_f32 v41, v58, v59
  v_cvt_pk_bf16_f32 v42, v60, v61
  v_cvt_pk_bf16_f32 v43, v62, v63
  s_nop 1
  v_mfma_f32_16x16x32_bf16 v[164:167], v[40:43], v[16:19], 0
  v_mfma_f32_16x16x32_bf16 v[172:175], v[40:43], v[24:27], 0
  v_mfma_f32_16x16x32_bf16 v[180:183], v[40:43], v[48:51], 0
  v_cvt_pk_bf16_f32 v52, v144, v145
  v_cvt_pk_bf16_f32 v53, v146, v147
  v_cvt_pk_bf16_f32 v54, v152, v153
  v_cvt_pk_bf16_f32 v55, v154, v155
  v_lshlrev_b32 v56, 16, v52
  v_and_b32 v57, 0xffff0000, v52
  v_lshlrev_b32 v58, 16, v53
  v_and_b32 v59, 0xffff0000, v53
  v_lshlrev_b32 v60, 16, v54
  v_and_b32 v61, 0xffff0000, v54
  v_lshlrev_b32 v62, 16, v55
  v_and_b32 v63, 0xffff0000, v55
  v_min_f32 v64, 0, v56
  v_min_f32 v65, 0, v57
  v_min_f32 v66, 0, v58
  v_min_f32 v67, 0, v59
  v_min_f32 v68, 0, v60
  v_min_f32 v69, 0, v61
  v_min_f32 v70, 0, v62
  v_min_f32 v71, 0, v63
  v_pk_mul_f32 v[72:73], v[64:65], s[44:45]
  v_pk_mul_f32 v[74:75], v[66:67], s[44:45]
  v_pk_mul_f32 v[76:77], v[68:69], s[44:45]
  v_pk_mul_f32 v[78:79], v[70:71], s[44:45]
  v_exp_f32 v72, v72
  v_exp_f32 v73, v73
  v_exp_f32 v74, v74
  v_exp_f32 v75, v75
  v_exp_f32 v76, v76
  v_exp_f32 v77, v77
  v_exp_f32 v78, v78
  v_exp_f32 v79, v79
  v_pk_add_f32 v[56:57], v[56:57], v[64:65] neg_lo:[0,1] neg_hi:[0,1]
  v_pk_add_f32 v[58:59], v[58:59], v[66:67] neg_lo:[0,1] neg_hi:[0,1]
  v_pk_add_f32 v[60:61], v[60:61], v[68:69] neg_lo:[0,1] neg_hi:[0,1]
  v_pk_add_f32 v[62:63], v[62:63], v[70:71] neg_lo:[0,1] neg_hi:[0,1]
  v_pk_add_f32 v[56:57], v[56:57], v[72:73]
  v_pk_add_f32 v[58:59], v[58:59], v[74:75]
  v_pk_add_f32 v[60:61], v[60:61], v[76:77]
  v_pk_add_f32 v[62:63], v[62:63], v[78:79]
  v_pk_add_f32 v[56:57], v[56:57], s[46:47]
  v_pk_add_f32 v[58:59], v[58:59], s[46:47]
  v_pk_add_f32 v[60:61], v[60:61], s[46:47]
  v_pk_add_f32 v[62:63], v[62:63], s[46:47]
  v_cvt_pk_bf16_f32 v36, v56, v57
  v_cvt_pk_bf16_f32 v37, v58, v59
  v_cvt_pk_bf16_f32 v38, v60, v61
  v_cvt_pk_bf16_f32 v39, v62, v63
  s_nop 1
  v_mfma_f32_16x16x32_bf16 v[160:163], v[36:39], v[20:23], v[160:163]
  v_mfma_f32_16x16x32_bf16 v[168:171], v[36:39], v[28:31], v[168:171]
  v_mfma_f32_16x16x32_bf16 v[176:179], v[36:39], v[48:51], v[176:179]
  v_cvt_pk_bf16_f32 v52, v148, v149
  v_cvt_pk_bf16_f32 v53, v150, v151
  v_cvt_pk_bf16_f32 v54, v156, v157
  v_cvt_pk_bf16_f32 v55, v158, v159
  v_lshlrev_b32 v56, 16, v52
  v_and_b32 v57, 0xffff0000, v52
  v_lshlrev_b32 v58, 16, v53
  v_and_b32 v59, 0xffff0000, v53
  v_lshlrev_b32 v60, 16, v54
  v_and_b32 v61, 0xffff0000, v54
  v_lshlrev_b32 v62, 16, v55
  v_and_b32 v63, 0xffff0000, v55
  v_min_f32 v64, 0, v56
  v_min_f32 v65, 0, v57
  v_min_f32 v66, 0, v58
  v_min_f32 v67, 0, v59
  v_min_f32 v68, 0, v60
  v_min_f32 v69, 0, v61
  v_min_f32 v70, 0, v62
  v_min_f32 v71, 0, v63
  v_pk_mul_f32 v[72:73], v[64:65], s[44:45]
  v_pk_mul_f32 v[74:75], v[66:67], s[44:45]
  v_pk_mul_f32 v[76:77], v[68:69], s[44:45]
  v_pk_mul_f32 v[78:79], v[70:71], s[44:45]
  v_exp_f32 v72, v72
  v_exp_f32 v73, v73
  v_exp_f32 v74, v74
  v_exp_f32 v75, v75
  v_exp_f32 v76, v76
  v_exp_f32 v77, v77
  v_exp_f32 v78, v78
  v_exp_f32 v79, v79
  v_pk_add_f32 v[56:57], v[56:57], v[64:65] neg_lo:[0,1] neg_hi:[0,1]
  v_pk_add_f32 v[58:59], v[58:59], v[66:67] neg_lo:[0,1] neg_hi:[0,1]
  v_pk_add_f32 v[60:61], v[60:61], v[68:69] neg_lo:[0,1] neg_hi:[0,1]
  v_pk_add_f32 v[62:63], v[62:63], v[70:71] neg_lo:[0,1] neg_hi:[0,1]
  v_pk_add_f32 v[56:57], v[56:57], v[72:73]
  v_pk_add_f32 v[58:59], v[58:59], v[74:75]
  v_pk_add_f32 v[60:61], v[60:61], v[76:77]
  v_pk_add_f32 v[62:63], v[62:63], v[78:79]
  v_pk_add_f32 v[56:57], v[56:57], s[46:47]
  v_pk_add_f32 v[58:59], v[58:59], s[46:47]
  v_pk_add_f32 v[60:61], v[60:61], s[46:47]
  v_pk_add_f32 v[62:63], v[62:63], s[46:47]
  v_cvt_pk_bf16_f32 v44, v56, v57
  v_cvt_pk_bf16_f32 v45, v58, v59
  v_cvt_pk_bf16_f32 v46, v60, v61
  v_cvt_pk_bf16_f32 v47, v62, v63
  s_nop 1
  v_mfma_f32_16x16x32_bf16 v[164:167], v[44:47], v[20:23], v[164:167]
  v_mfma_f32_16x16x32_bf16 v[172:175], v[44:47], v[28:31], v[172:175]
  v_mfma_f32_16x16x32_bf16 v[180:183], v[44:47], v[48:51], v[180:183]
  s_lshl_b32 s43, s37, 12
  s_add_u32 s43, s43, 155648
  v_add_u32 v4, s43, v3
  s_lshl_b32 s43, s37, 7
  s_add_u32 s43, s43, 39424
  v_lshlrev_b32 v5, 5, v14
  v_add_u32 v5, s43, v5
  s_lshl_b32 s43, s37, 2
  v_add_u32 v6, s43, v10
  s_cmp_eq_u32 s36, 0
  s_cbranch_scc1 K3_wr0
  ds_write_b128 v4, v[160:163] offset:0
  ds_write_b128 v4, v[164:167] offset:1024
  ds_write_b128 v4, v[168:171] offset:2048
  ds_write_b128 v4, v[172:175] offset:3072
  ds_write_b128 v5, v[176:179] offset:0
  ds_write_b128 v5, v[180:183] offset:16
  s_waitcnt lgkmcnt(0)
  s_mov_b64 exec, 1
  ds_add_u32 v6, v11 offset:0
  s_mov_b64 exec, -1
  s_branch K3_q
K3_wr0:
  s_lshl_b32 s48, s5, 4
  s_add_u32 s48, s48, s12
  s_lshl_b32 s49, s48, 12
  s_lshl_b32 s50, s48, 7
  v_lshlrev_b32 v7, 4, v14
  s_mov_b32 s43, 131072
K3_wx:
  ds_read_b32 v8, v6 offset:0
  s_waitcnt lgkmcnt(0)
  v_readfirstlane_b32 s42, v8
  s_sub_u32 s43, s43, 1
  s_cbranch_scc1 K3_wx_ok
  s_cmp_lt_u32 s42, 1
  s_cbranch_scc1 K3_wx
K3_wx_ok:
  ds_read_b128 v[16:19], v4 offset:0
  ds_read_b128 v[20:23], v4 offset:1024
  ds_read_b128 v[24:27], v4 offset:2048
  ds_read_b128 v[28:31], v4 offset:3072
  ds_read_b128 v[32:35], v5 offset:0
  ds_read_b128 v[36:39], v5 offset:16
  s_waitcnt lgkmcnt(5)
  v_pk_add_f32 v[160:161], v[160:161], v[16:17]
  v_pk_add_f32 v[162:163], v[162:163], v[18:19]
  v_or_b32 v160, 1, v160
  v_or_b32 v161, 1, v161
  v_or_b32 v162, 1, v162
  v_or_b32 v163, 1, v163
  buffer_store_dwordx4 v[160:163], v3, s[28:31], s49 offen offset:0 sc1
  s_waitcnt lgkmcnt(4)
  v_pk_add_f32 v[164:165], v[164:165], v[20:21]
  v_pk_add_f32 v[166:167], v[166:167], v[22:23]
  v_or_b32 v164, 1, v164
  v_or_b32 v165, 1, v165
  v_or_b32 v166, 1, v166
  v_or_b32 v167, 1, v167
  buffer_store_dwordx4 v[164:167], v3, s[28:31], s49 offen offset:1024 sc1
  s_waitcnt lgkmcnt(3)
  v_pk_add_f32 v[168:169], v[168:169], v[24:25]
  v_pk_add_f32 v[170:171], v[170:171], v[26:27]
  v_or_b32 v168, 1, v168
  v_or_b32 v169, 1, v169
  v_or_b32 v170, 1, v170
  v_or_b32 v171, 1, v171
  buffer_store_dwordx4 v[168:171], v3, s[28:31], s49 offen offset:2048 sc1
  s_waitcnt lgkmcnt(2)
  v_pk_add_f32 v[172:173], v[172:173], v[28:29]
  v_pk_add_f32 v[174:175], v[174:175], v[30:31]
  v_or_b32 v172, 1, v172
  v_or_b32 v173, 1, v173
  v_or_b32 v174, 1, v174
  v_or_b32 v175, 1, v175
  buffer_store_dwordx4 v[172:175], v3, s[28:31], s49 offen offset:3072 sc1
  s_waitcnt lgkmcnt(1)
  v_pk_add_f32 v[176:177], v[176:177], v[32:33]
  v_pk_add_f32 v[178:179], v[178:179], v[34:35]
  v_or_b32 v176, 1, v176
  v_or_b32 v177, 1, v177
  v_or_b32 v178, 1, v178
  v_or_b32 v179, 1, v179
  s_waitcnt lgkmcnt(0)
  v_pk_add_f32 v[180:181], v[180:181], v[36:37]
  v_pk_add_f32 v[182:183], v[182:183], v[38:39]
  v_or_b32 v180, 1, v180
  v_or_b32 v181, 1, v181
  v_or_b32 v182, 1, v182
  v_or_b32 v183, 1, v183
  s_mov_b32 exec_lo, 0x00010001
  s_mov_b32 exec_hi, 0x00010001
  buffer_store_dwordx4 v[176:179], v7, s[32:35], s50 offen offset:0 sc1
  buffer_store_dwordx4 v[180:183], v7, s[32:35], s50 offen offset:64 sc1
  s_mov_b64 exec, -1
  s_mov_b64 exec, 1
  ds_add_u32 v10, v11 offset:84
  s_mov_b64 exec, -1
K3_q:
  s_lshl_b32 s43, s3, 12
  s_add_u32 s43, s43, 139264
  v_add_u32 v4, s43, v3
  v_cvt_pk_bf16_f32 v52, v96, v97
  v_cvt_pk_bf16_f32 v53, v98, v99
  v_cvt_pk_bf16_f32 v54, v100, v101
  v_cvt_pk_bf16_f32 v55, v102, v103
  v_lshlrev_b32 v56, 16, v52
  v_and_b32 v57, 0xffff0000, v52
  v_lshlrev_b32 v58, 16, v53
  v_and_b32 v59, 0xffff0000, v53
  v_lshlrev_b32 v60, 16, v54
  v_and_b32 v61, 0xffff0000, v54
  v_lshlrev_b32 v62, 16, v55
  v_and_b32 v63, 0xffff0000, v55
  v_min_f32 v64, 0, v56
  v_min_f32 v65, 0, v57
  v_min_f32 v66, 0, v58
  v_min_f32 v67, 0, v59
  v_min_f32 v68, 0, v60
  v_min_f32 v69, 0, v61
  v_min_f32 v70, 0, v62
  v_min_f32 v71, 0, v63
  v_pk_mul_f32 v[72:73], v[64:65], s[44:45]
  v_pk_mul_f32 v[74:75], v[66:67], s[44:45]
  v_pk_mul_f32 v[76:77], v[68:69], s[44:45]
  v_pk_mul_f32 v[78:79], v[70:71], s[44:45]
  v_exp_f32 v72, v72
  v_exp_f32 v73, v73
  v_exp_f32 v74, v74
  v_exp_f32 v75, v75
  v_exp_f32 v76, v76
  v_exp_f32 v77, v77
  v_exp_f32 v78, v78
  v_exp_f32 v79, v79
  v_pk_add_f32 v[56:57], v[56:57], v[64:65] neg_lo:[0,1] neg_hi:[0,1]
  v_pk_add_f32 v[58:59], v[58:59], v[66:67] neg_lo:[0,1] neg_hi:[0,1]
  v_pk_add_f32 v[60:61], v[60:61], v[68:69] neg_lo:[0,1] neg_hi:[0,1]
  v_pk_add_f32 v[62:63], v[62:63], v[70:71] neg_lo:[0,1] neg_hi:[0,1]
  v_pk_add_f32 v[56:57], v[56:57], v[72:73]
  v_pk_add_f32 v[58:59], v[58:59], v[74:75]
  v_pk_add_f32 v[60:61], v[60:61], v[76:77]
  v_pk_add_f32 v[62:63], v[62:63], v[78:79]
  v_pk_add_f32 v[56:57], v[56:57], s[46:47]
  v_pk_add_f32 v[58:59], v[58:59], s[46:47]
  v_pk_add_f32 v[60:61], v[60:61], s[46:47]
  v_pk_add_f32 v[62:63], v[62:63], s[46:47]
  v_cvt_pk_bf16_f32 v80, v56, v57
  v_cvt_pk_bf16_f32 v81, v58, v59
  v_cvt_pk_bf16_f32 v82, v60, v61
  v_cvt_pk_bf16_f32 v83, v62, v63
  ds_write_b128 v4, v[80:83] offset:0
  v_cvt_pk_bf16_f32 v52, v104, v105
  v_cvt_pk_bf16_f32 v53, v106, v107
  v_cvt_pk_bf16_f32 v54, v108, v109
  v_cvt_pk_bf16_f32 v55, v110, v111
  v_lshlrev_b32 v56, 16, v52
  v_and_b32 v57, 0xffff0000, v52
  v_lshlrev_b32 v58, 16, v53
  v_and_b32 v59, 0xffff0000, v53
  v_lshlrev_b32 v60, 16, v54
  v_and_b32 v61, 0xffff0000, v54
  v_lshlrev_b32 v62, 16, v55
  v_and_b32 v63, 0xffff0000, v55
  v_min_f32 v64, 0, v56
  v_min_f32 v65, 0, v57
  v_min_f32 v66, 0, v58
  v_min_f32 v67, 0, v59
  v_min_f32 v68, 0, v60
  v_min_f32 v69, 0, v61
  v_min_f32 v70, 0, v62
  v_min_f32 v71, 0, v63
  v_pk_mul_f32 v[72:73], v[64:65], s[44:45]
  v_pk_mul_f32 v[74:75], v[66:67], s[44:45]
  v_pk_mul_f32 v[76:77], v[68:69], s[44:45]
  v_pk_mul_f32 v[78:79], v[70:71], s[44:45]
  v_exp_f32 v72, v72
  v_exp_f32 v73, v73
  v_exp_f32 v74, v74
  v_exp_f32 v75, v75
  v_exp_f32 v76, v76
  v_exp_f32 v77, v77
  v_exp_f32 v78, v78
  v_exp_f32 v79, v79
  v_pk_add_f32 v[56:57], v[56:57], v[64:65] neg_lo:[0,1] neg_hi:[0,1]
  v_pk_add_f32 v[58:59], v[58:59], v[66:67] neg_lo:[0,1] neg_hi:[0,1]
  v_pk_add_f32 v[60:61], v[60:61], v[68:69] neg_lo:[0,1] neg_hi:[0,1]
  v_pk_add_f32 v[62:63], v[62:63], v[70:71] neg_lo:[0,1] neg_hi:[0,1]
  v_pk_add_f32 v[56:57], v[56:57], v[72:73]
  v_pk_add_f32 v[58:59], v[58:59], v[74:75]
  v_pk_add_f32 v[60:61], v[60:61], v[76:77]
  v_pk_add_f32 v[62:63], v[62:63], v[78:79]
  v_pk_add_f32 v[56:57], v[56:57], s[46:47]
  v_pk_add_f32 v[58:59], v[58:59], s[46:47]
  v_pk_add_f32 v[60:61], v[60:61], s[46:47]
  v_pk_add_f32 v[62:63], v[62:63], s[46:47]
  v_cvt_pk_bf16_f32 v84, v56, v57
  v_cvt_pk_bf16_f32 v85, v58, v59
  v_cvt_pk_bf16_f32 v86, v60, v61
  v_cvt_pk_bf16_f32 v87, v62, v63
  ds_write_b128 v4, v[84:87] offset:1024
  v_cvt_pk_bf16_f32 v52, v112, v113
  v_cvt_pk_bf16_f32 v53, v114, v115
  v_cvt_pk_bf16_f32 v54, v116, v117
  v_cvt_pk_bf16_f32 v55, v118, v119
  v_lshlrev_b32 v56, 16, v52
  v_and_b32 v57, 0xffff0000, v52
  v_lshlrev_b32 v58, 16, v53
  v_and_b32 v59, 0xffff0000, v53
  v_lshlrev_b32 v60, 16, v54
  v_and_b32 v61, 0xffff0000, v54
  v_lshlrev_b32 v62, 16, v55
  v_and_b32 v63, 0xffff0000, v55
  v_min_f32 v64, 0, v56
  v_min_f32 v65, 0, v57
  v_min_f32 v66, 0, v58
  v_min_f32 v67, 0, v59
  v_min_f32 v68, 0, v60
  v_min_f32 v69, 0, v61
  v_min_f32 v70, 0, v62
  v_min_f32 v71, 0, v63
  v_pk_mul_f32 v[72:73], v[64:65], s[44:45]
  v_pk_mul_f32 v[74:75], v[66:67], s[44:45]
  v_pk_mul_f32 v[76:77], v[68:69], s[44:45]
  v_pk_mul_f32 v[78:79], v[70:71], s[44:45]
  v_exp_f32 v72, v72
  v_exp_f32 v73, v73
  v_exp_f32 v74, v74
  v_exp_f32 v75, v75
  v_exp_f32 v76, v76
  v_exp_f32 v77, v77
  v_exp_f32 v78, v78
  v_exp_f32 v79, v79
  v_pk_add_f32 v[56:57], v[56:57], v[64:65] neg_lo:[0,1] neg_hi:[0,1]
  v_pk_add_f32 v[58:59], v[58:59], v[66:67] neg_lo:[0,1] neg_hi:[0,1]
  v_pk_add_f32 v[60:61], v[60:61], v[68:69] neg_lo:[0,1] neg_hi:[0,1]
  v_pk_add_f32 v[62:63], v[62:63], v[70:71] neg_lo:[0,1] neg_hi:[0,1]
  v_pk_add_f32 v[56:57], v[56:57], v[72:73]
  v_pk_add_f32 v[58:59], v[58:59], v[74:75]
  v_pk_add_f32 v[60:61], v[60:61], v[76:77]
  v_pk_add_f32 v[62:63], v[62:63], v[78:79]
  v_pk_add_f32 v[56:57], v[56:57], s[46:47]
  v_pk_add_f32 v[58:59], v[58:59], s[46:47]
  v_pk_add_f32 v[60:61], v[60:61], s[46:47]
  v_pk_add_f32 v[62:63], v[62:63], s[46:47]
  v_cvt_pk_bf16_f32 v88, v56, v57
  v_cvt_pk_bf16_f32 v89, v58, v59
  v_cvt_pk_bf16_f32 v90, v60, v61
  v_cvt_pk_bf16_f32 v91, v62, v63
  ds_write_b128 v4, v[88:91] offset:2048
  v_cvt_pk_bf16_f32 v52, v120, v121
  v_cvt_pk_bf16_f32 v53, v122, v123
  v_cvt_pk_bf16_f32 v54, v124, v125
  v_cvt_pk_bf16_f32 v55, v126, v127
  v_lshlrev_b32 v56, 16, v52
  v_and_b32 v57, 0xffff0000, v52
  v_lshlrev_b32 v58, 16, v53
  v_and_b32 v59, 0xffff0000, v53
  v_lshlrev_b32 v60, 16, v54
  v_and_b32 v61, 0xffff0000, v54
  v_lshlrev_b32 v62, 16, v55
  v_and_b32 v63, 0xffff0000, v55
  v_min_f32 v64, 0, v56
  v_min_f32 v65, 0, v57
  v_min_f32 v66, 0, v58
  v_min_f32 v67, 0, v59
  v_min_f32 v68, 0, v60
  v_min_f32 v69, 0, v61
  v_min_f32 v70, 0, v62
  v_min_f32 v71, 0, v63
  v_pk_mul_f32 v[72:73], v[64:65], s[44:45]
  v_pk_mul_f32 v[74:75], v[66:67], s[44:45]
  v_pk_mul_f32 v[76:77], v[68:69], s[44:45]
  v_pk_mul_f32 v[78:79], v[70:71], s[44:45]
  v_exp_f32 v72, v72
  v_exp_f32 v73, v73
  v_exp_f32 v74, v74
  v_exp_f32 v75, v75
  v_exp_f32 v76, v76
  v_exp_f32 v77, v77
  v_exp_f32 v78, v78
  v_exp_f32 v79, v79
  v_pk_add_f32 v[56:57], v[56:57], v[64:65] neg_lo:[0,1] neg_hi:[0,1]
  v_pk_add_f32 v[58:59], v[58:59], v[66:67] neg_lo:[0,1] neg_hi:[0,1]
  v_pk_add_f32 v[60:61], v[60:61], v[68:69] neg_lo:[0,1] neg_hi:[0,1]
  v_pk_add_f32 v[62:63], v[62:63], v[70:71] neg_lo:[0,1] neg_hi:[0,1]
  v_pk_add_f32 v[56:57], v[56:57], v[72:73]
  v_pk_add_f32 v[58:59], v[58:59], v[74:75]
  v_pk_add_f32 v[60:61], v[60:61], v[76:77]
  v_pk_add_f32 v[62:63], v[62:63], v[78:79]
  v_pk_add_f32 v[56:57], v[56:57], s[46:47]
  v_pk_add_f32 v[58:59], v[58:59], s[46:47]
  v_pk_add_f32 v[60:61], v[60:61], s[46:47]
  v_pk_add_f32 v[62:63], v[62:63], s[46:47]
  v_cvt_pk_bf16_f32 v92, v56, v57
  v_cvt_pk_bf16_f32 v93, v58, v59
  v_cvt_pk_bf16_f32 v94, v60, v61
  v_cvt_pk_bf16_f32 v95, v62, v63
  ds_write_b128 v4, v[92:95] offset:3072
  s_lshl_b32 s43, s3, 2
  v_add_u32 v9, s43, v10
  v_and_b32 v6, 3, v2
  v_bfe_u32 v7, v2, 2, 2
  v_add_u32 v12, v6, v7
  v_lshlrev_b32 v12, 3, v12
  v_lshl_add_u32 v12, v14, 6, v12
  s_add_u32 s43, s7, 8
  v_add_u32 v12, s43, v12
  v_lshlrev_b32 v13, 5, v6
  v_lshlrev_b32 v7, 3, v7
  v_sub_u32 v13, v13, v7
  v_lshlrev_b32 v7, 6, v14
  v_sub_u32 v13, v13, v7
  s_add_u32 s43, s7, 4376
  v_add_u32 v13, s43, v13
  s_add_u32 s43, s7, 4384
  v_add_u32 v8, s43, v3
  s_waitcnt lgkmcnt(0)
  s_mov_b64 exec, 1
  ds_add_u32 v9, v11 offset:24
  s_mov_b64 exec, -1
  s_mov_b32 s43, 131072
K3_whu:
  ds_read_b32 v16, v9 offset:8
  s_waitcnt lgkmcnt(0)
  v_readfirstlane_b32 s42, v16
  s_sub_u32 s43, s43, 1
  s_cbranch_scc1 K3_whu_ok
  s_cmp_lt_u32 s42, 1
  s_cbranch_scc1 K3_whu
K3_whu_ok:
  ds_read_b64_tr_b16 v[96:97], v13 offset:32
  ds_read_b64_tr_b16 v[98:99], v13 offset:0
  ds_read_b64_tr_b16 v[32:33], v12 offset:0
  ds_read_b64_tr_b16 v[34:35], v12 offset:32
  ds_read_b64_tr_b16 v[100:101], v13 offset:160
  ds_read_b64_tr_b16 v[102:103], v13 offset:128
  ds_read_b64_tr_b16 v[104:105], v13 offset:288
  ds_read_b64_tr_b16 v[106:107], v13 offset:256
  ds_read_b64_tr_b16 v[36:37], v12 offset:256
  ds_read_b64_tr_b16 v[38:39], v12 offset:288
  s_waitcnt lgkmcnt(6)
  v_mfma_f32_16x16x32_bf16 v[16:19], v[96:99], v[32:35], 0
  ds_read_b64_tr_b16 v[108:109], v13 offset:416
  ds_read_b64_tr_b16 v[110:111], v13 offset:384
  s_waitcnt lgkmcnt(6)
  v_mfma_f32_16x16x32_bf16 v[20:23], v[100:103], v[32:35], 0
  ds_read_b64_tr_b16 v[112:113], v13 offset:544
  ds_read_b64_tr_b16 v[114:115], v13 offset:512
  ds_read_b64_tr_b16 v[40:41], v12 offset:512
  ds_read_b64_tr_b16 v[42:43], v12 offset:544
  s_waitcnt lgkmcnt(8)
  v_mfma_f32_16x16x32_bf16 v[24:27], v[104:107], v[32:35], 0
  ds_read_b64_tr_b16 v[116:117], v13 offset:672
  ds_read_b64_tr_b16 v[118:119], v13 offset:640
  v_add_f32_dpp v224, v19, v18 wave_shr:1 row_mask:0xf bank_mask:0xf bound_ctrl:0
  s_nop 1
  v_add_f32_dpp v226, v224, v17 wave_shr:1 row_mask:0xf bank_mask:0xf bound_ctrl:0
  s_waitcnt lgkmcnt(8)
  v_mfma_f32_16x16x32_bf16 v[24:27], v[96:99], v[36:39], v[24:27]
  v_add_f32_dpp v228, v226, v16 wave_shr:1 row_mask:0xf bank_mask:0xf bound_ctrl:0
  s_waitcnt lgkmcnt(6)
  v_mfma_f32_16x16x32_bf16 v[28:31], v[108:111], v[32:35], 0
  ds_read_b64_tr_b16 v[120:121], v13 offset:800
  ds_read_b64_tr_b16 v[122:123], v13 offset:768
  ds_read_b64_tr_b16 v[44:45], v12 offset:768
  ds_read_b64_tr_b16 v[46:47], v12 offset:800
  v_add_f32_dpp v225, v19, v22 wave_ror:1 row_mask:0xf bank_mask:0xf
  v_add_f32_dpp v227, v224, v21 wave_ror:1 row_mask:0xf bank_mask:0xf
  v_add_f32_dpp v229, v226, v20 wave_ror:1 row_mask:0xf bank_mask:0xf
  v_add_f32_dpp v225, v23, v22 wave_shr:1 row_mask:0xf bank_mask:0xf
  v_mfma_f32_16x16x32_bf16 v[28:31], v[100:103], v[36:39], v[28:31]
  s_nop 0
  v_add_f32_dpp v227, v225, v21 wave_shr:1 row_mask:0xf bank_mask:0xf
  s_nop 1
  v_add_f32_dpp v229, v227, v20 wave_shr:1 row_mask:0xf bank_mask:0xf
  v_cvt_pk_bf16_f32 v232, v228, v229
  v_or_b32 v232, 1, v232
  s_waitcnt lgkmcnt(8)
  v_mfma_f32_16x16x32_bf16 v[16:19], v[112:115], v[32:35], 0
  ds_read_b64_tr_b16 v[124:125], v13 offset:928
  ds_read_b64_tr_b16 v[126:127], v13 offset:896
  v_add_f32_dpp v224, v23, v26 wave_ror:1 row_mask:0xf bank_mask:0xf
  v_add_f32_dpp v226, v225, v25 wave_ror:1 row_mask:0xf bank_mask:0xf
  v_mfma_f32_16x16x32_bf16 v[16:19], v[104:107], v[36:39], v[16:19]
  v_add_f32_dpp v228, v227, v24 wave_ror:1 row_mask:0xf bank_mask:0xf
  v_add_f32_dpp v224, v27, v26 wave_shr:1 row_mask:0xf bank_mask:0xf
  s_waitcnt lgkmcnt(8)
  v_mfma_f32_16x16x32_bf16 v[16:19], v[96:99], v[40:43], v[16:19]
  v_add_f32_dpp v226, v224, v25 wave_shr:1 row_mask:0xf bank_mask:0xf
  s_nop 1
  v_add_f32_dpp v228, v226, v24 wave_shr:1 row_mask:0xf bank_mask:0xf
  s_waitcnt lgkmcnt(6)
  v_mfma_f32_16x16x32_bf16 v[20:23], v[116:119], v[32:35], 0
  ds_read_b64_tr_b16 v[128:129], v13 offset:1056
  ds_read_b64_tr_b16 v[130:131], v13 offset:1024
  ds_read_b64_tr_b16 v[48:49], v12 offset:1024
  ds_read_b64_tr_b16 v[50:51], v12 offset:1056
  v_add_f32_dpp v225, v27, v30 wave_ror:1 row_mask:0xf bank_mask:0xf
  v_add_f32_dpp v227, v224, v29 wave_ror:1 row_mask:0xf bank_mask:0xf
  v_add_f32_dpp v229, v226, v28 wave_ror:1 row_mask:0xf bank_mask:0xf
  v_mfma_f32_16x16x32_bf16 v[20:23], v[108:111], v[36:39], v[20:23]
  v_add_f32_dpp v225, v31, v30 wave_shr:1 row_mask:0xf bank_mask:0xf
  s_nop 1
  v_add_f32_dpp v227, v225, v29 wave_shr:1 row_mask:0xf bank_mask:0xf
  s_nop 1
  v_add_f32_dpp v229, v227, v28 wave_shr:1 row_mask:0xf bank_mask:0xf
  v_mfma_f32_16x16x32_bf16 v[20:23], v[100:103], v[40:43], v[20:23]
  v_cvt_pk_bf16_f32 v233, v228, v229
  v_or_b32 v233, 1, v233
  s_waitcnt lgkmcnt(8)
  v_mfma_f32_16x16x32_bf16 v[24:27], v[120:123], v[32:35], 0
  ds_read_b64_tr_b16 v[132:133], v13 offset:1184
  ds_read_b64_tr_b16 v[134:135], v13 offset:1152
  v_add_f32_dpp v224, v31, v18 wave_ror:1 row_mask:0xf bank_mask:0xf
  v_add_f32_dpp v226, v225, v17 wave_ror:1 row_mask:0xf bank_mask:0xf
  v_mfma_f32_16x16x32_bf16 v[24:27], v[112:115], v[36:39], v[24:27]
  v_add_f32_dpp v228, v227, v16 wave_ror:1 row_mask:0xf bank_mask:0xf
  v_add_f32_dpp v224, v19, v18 wave_shr:1 row_mask:0xf bank_mask:0xf
  v_mfma_f32_16x16x32_bf16 v[24:27], v[104:107], v[40:43], v[24:27]
  s_nop 0
  v_add_f32_dpp v226, v224, v17 wave_shr:1 row_mask:0xf bank_mask:0xf
  s_waitcnt lgkmcnt(8)
  v_mfma_f32_16x16x32_bf16 v[24:27], v[96:99], v[44:47], v[24:27]
  v_add_f32_dpp v228, v226, v16 wave_shr:1 row_mask:0xf bank_mask:0xf
  s_waitcnt lgkmcnt(6)
  v_mfma_f32_16x16x32_bf16 v[28:31], v[124:127], v[32:35], 0
  ds_read_b64_tr_b16 v[136:137], v13 offset:1312
  ds_read_b64_tr_b16 v[138:139], v13 offset:1280
  ds_read_b64_tr_b16 v[52:53], v12 offset:1280
  ds_read_b64_tr_b16 v[54:55], v12 offset:1312
  v_add_f32_dpp v225, v19, v22 wave_ror:1 row_mask:0xf bank_mask:0xf
  v_add_f32_dpp v227, v224, v21 wave_ror:1 row_mask:0xf bank_mask:0xf
  v_mfma_f32_16x16x32_bf16 v[28:31], v[116:119], v[36:39], v[28:31]
  v_add_f32_dpp v229, v226, v20 wave_ror:1 row_mask:0xf bank_mask:0xf
  v_add_f32_dpp v225, v23, v22 wave_shr:1 row_mask:0xf bank_mask:0xf
  v_mfma_f32_16x16x32_bf16 v[28:31], v[108:111], v[40:43], v[28:31]
  s_nop 0
  v_add_f32_dpp v227, v225, v21 wave_shr:1 row_mask:0xf bank_mask:0xf
  s_nop 1
  v_add_f32_dpp v229, v227, v20 wave_shr:1 row_mask:0xf bank_mask:0xf
  v_mfma_f32_16x16x32_bf16 v[28:31], v[100:103], v[44:47], v[28:31]
  v_cvt_pk_bf16_f32 v234, v228, v229
  v_or_b32 v234, 1, v234
  s_waitcnt lgkmcnt(8)
  v_mfma_f32_16x16x32_bf16 v[16:19], v[128:131], v[32:35], 0
  ds_read_b64_tr_b16 v[140:141], v13 offset:1440
  ds_read_b64_tr_b16 v[142:143], v13 offset:1408
  v_add_f32_dpp v224, v23, v26 wave_ror:1 row_mask:0xf bank_mask:0xf
  v_add_f32_dpp v226, v225, v25 wave_ror:1 row_mask:0xf bank_mask:0xf
  v_mfma_f32_16x16x32_bf16 v[16:19], v[120:123], v[36:39], v[16:19]
  v_add_f32_dpp v228, v227, v24 wave_ror:1 row_mask:0xf bank_mask:0xf
  v_mfma_f32_16x16x32_bf16 v[16:19], v[112:115], v[40:43], v[16:19]
  v_add_f32_dpp v224, v27, v26 wave_shr:1 row_mask:0xf bank_mask:0xf
  v_mfma_f32_16x16x32_bf16 v[16:19], v[104:107], v[44:47], v[16:19]
  s_nop 0
  v_add_f32_dpp v226, v224, v25 wave_shr:1 row_mask:0xf bank_mask:0xf
  s_waitcnt lgkmcnt(8)
  v_mfma_f32_16x16x32_bf16 v[16:19], v[96:99], v[48:51], v[16:19]
  v_add_f32_dpp v228, v226, v24 wave_shr:1 row_mask:0xf bank_mask:0xf
  s_waitcnt lgkmcnt(6)
  v_mfma_f32_16x16x32_bf16 v[20:23], v[132:135], v[32:35], 0
  ds_read_b64_tr_b16 v[144:145], v13 offset:1568
  ds_read_b64_tr_b16 v[146:147], v13 offset:1536
  ds_read_b64_tr_b16 v[56:57], v12 offset:1536
  ds_read_b64_tr_b16 v[58:59], v12 offset:1568
  v_add_f32_dpp v225, v27, v30 wave_ror:1 row_mask:0xf bank_mask:0xf
  v_add_f32_dpp v227, v224, v29 wave_ror:1 row_mask:0xf bank_mask:0xf
  v_mfma_f32_16x16x32_bf16 v[20:23], v[124:127], v[36:39], v[20:23]
  v_add_f32_dpp v229, v226, v28 wave_ror:1 row_mask:0xf bank_mask:0xf
  v_add_f32_dpp v225, v31, v30 wave_shr:1 row_mask:0xf bank_mask:0xf
  v_mfma_f32_16x16x32_bf16 v[20:23], v[116:119], v[40:43], v[20:23]
  s_nop 0
  v_add_f32_dpp v227, v225, v29 wave_shr:1 row_mask:0xf bank_mask:0xf
  s_nop 1
  v_add_f32_dpp v229, v227, v28 wave_shr:1 row_mask:0xf bank_mask:0xf
  v_mfma_f32_16x16x32_bf16 v[20:23], v[108:111], v[44:47], v[20:23]
  v_cvt_pk_bf16_f32 v235, v228, v229
  v_mfma_f32_16x16x32_bf16 v[20:23], v[100:103], v[48:51], v[20:23]
  v_or_b32 v235, 1, v235
  s_waitcnt lgkmcnt(8)
  v_mfma_f32_16x16x32_bf16 v[24:27], v[136:139], v[32:35], 0
  ds_read_b64_tr_b16 v[148:149], v13 offset:1696
  ds_read_b64_tr_b16 v[150:151], v13 offset:1664
  v_add_f32_dpp v224, v31, v18 wave_ror:1 row_mask:0xf bank_mask:0xf
  v_mfma_f32_16x16x32_bf16 v[24:27], v[128:131], v[36:39], v[24:27]
  v_add_f32_dpp v226, v225, v17 wave_ror:1 row_mask:0xf bank_mask:0xf
  v_mfma_f32_16x16x32_bf16 v[24:27], v[120:123], v[40:43], v[24:27]
  v_add_f32_dpp v228, v227, v16 wave_ror:1 row_mask:0xf bank_mask:0xf
  v_mfma_f32_16x16x32_bf16 v[24:27], v[112:115], v[44:47], v[24:27]
  v_add_f32_dpp v224, v19, v18 wave_shr:1 row_mask:0xf bank_mask:0xf
  v_mfma_f32_16x16x32_bf16 v[24:27], v[104:107], v[48:51], v[24:27]
  s_nop 0
  v_add_f32_dpp v226, v224, v17 wave_shr:1 row_mask:0xf bank_mask:0xf
  s_waitcnt lgkmcnt(8)
  v_mfma_f32_16x16x32_bf16 v[24:27], v[96:99], v[52:55], v[24:27]
  v_add_f32_dpp v228, v226, v16 wave_shr:1 row_mask:0xf bank_mask:0xf
  s_waitcnt lgkmcnt(6)
  v_mfma_f32_16x16x32_bf16 v[28:31], v[140:143], v[32:35], 0
  ds_read_b64_tr_b16 v[152:153], v13 offset:1824
  ds_read_b64_tr_b16 v[154:155], v13 offset:1792
  ds_read_b64_tr_b16 v[60:61], v12 offset:1792
  ds_read_b64_tr_b16 v[62:63], v12 offset:1824
  v_add_f32_dpp v225, v19, v22 wave_ror:1 row_mask:0xf bank_mask:0xf
  v_add_f32_dpp v227, v224, v21 wave_ror:1 row_mask:0xf bank_mask:0xf
  v_mfma_f32_16x16x32_bf16 v[28:31], v[132:135], v[36:39], v[28:31]
  v_add_f32_dpp v229, v226, v20 wave_ror:1 row_mask:0xf bank_mask:0xf
  v_add_f32_dpp v225, v23, v22 wave_shr:1 row_mask:0xf bank_mask:0xf
  v_mfma_f32_16x16x32_bf16 v[28:31], v[124:127], v[40:43], v[28:31]
  s_nop 0
  v_add_f32_dpp v227, v225, v21 wave_shr:1 row_mask:0xf bank_mask:0xf
  v_mfma_f32_16x16x32_bf16 v[28:31], v[116:119], v[44:47], v[28:31]
  s_nop 0
  v_add_f32_dpp v229, v227, v20 wave_shr:1 row_mask:0xf bank_mask:0xf
  v_mfma_f32_16x16x32_bf16 v[28:31], v[108:111], v[48:51], v[28:31]
  v_cvt_pk_bf16_f32 v236, v228, v229
  v_mfma_f32_16x16x32_bf16 v[28:31], v[100:103], v[52:55], v[28:31]
  v_or_b32 v236, 1, v236
  s_waitcnt lgkmcnt(8)
  v_mfma_f32_16x16x32_bf16 v[16:19], v[144:147], v[32:35], 0
  ds_read_b64_tr_b16 v[156:157], v13 offset:1952
  ds_read_b64_tr_b16 v[158:159], v13 offset:1920
  v_add_f32_dpp v224, v23, v26 wave_ror:1 row_mask:0xf bank_mask:0xf
  v_mfma_f32_16x16x32_bf16 v[16:19], v[136:139], v[36:39], v[16:19]
  v_add_f32_dpp v226, v225, v25 wave_ror:1 row_mask:0xf bank_mask:0xf
  v_mfma_f32_16x16x32_bf16 v[16:19], v[128:131], v[40:43], v[16:19]
  v_add_f32_dpp v228, v227, v24 wave_ror:1 row_mask:0xf bank_mask:0xf
  v_mfma_f32_16x16x32_bf16 v[16:19], v[120:123], v[44:47], v[16:19]
  v_add_f32_dpp v224, v27, v26 wave_shr:1 row_mask:0xf bank_mask:0xf
  v_mfma_f32_16x16x32_bf16 v[16:19], v[112:115], v[48:51], v[16:19]
  s_nop 0
  v_add_f32_dpp v226, v224, v25 wave_shr:1 row_mask:0xf bank_mask:0xf
  v_mfma_f32_16x16x32_bf16 v[16:19], v[104:107], v[52:55], v[16:19]
  s_nop 0
  v_add_f32_dpp v228, v226, v24 wave_shr:1 row_mask:0xf bank_mask:0xf
  s_waitcnt lgkmcnt(8)
  v_mfma_f32_16x16x32_bf16 v[16:19], v[96:99], v[56:59], v[16:19]
  s_waitcnt lgkmcnt(6)
  v_mfma_f32_16x16x32_bf16 v[20:23], v[148:151], v[32:35], 0
  ds_read_b64_tr_b16 v[160:161], v13 offset:2080
  ds_read_b64_tr_b16 v[162:163], v13 offset:2048
  ds_read_b64_tr_b16 v[64:65], v12 offset:2048
  ds_read_b64_tr_b16 v[66:67], v12 offset:2080
  v_add_f32_dpp v225, v27, v30 wave_ror:1 row_mask:0xf bank_mask:0xf
  v_add_f32_dpp v227, v224, v29 wave_ror:1 row_mask:0xf bank_mask:0xf
  v_mfma_f32_16x16x32_bf16 v[20:23], v[140:143], v[36:39], v[20:23]
  v_add_f32_dpp v229, v226, v28 wave_ror:1 row_mask:0xf bank_mask:0xf
  v_mfma_f32_16x16x32_bf16 v[20:23], v[132:135], v[40:43], v[20:23]
  v_add_f32_dpp v225, v31, v30 wave_shr:1 row_mask:0xf bank_mask:0xf
  v_mfma_f32_16x16x32_bf16 v[20:23], v[124:127], v[44:47], v[20:23]
  s_nop 0
  v_add_f32_dpp v227, v225, v29 wave_shr:1 row_mask:0xf bank_mask:0xf
  v_mfma_f32_16x16x32_bf16 v[20:23], v[116:119], v[48:51], v[20:23]
  s_nop 0
  v_add_f32_dpp v229, v227, v28 wave_shr:1 row_mask:0xf bank_mask:0xf
  v_mfma_f32_16x16x32_bf16 v[20:23], v[108:111], v[52:55], v[20:23]
  v_cvt_pk_bf16_f32 v237, v228, v229
  v_mfma_f32_16x16x32_bf16 v[20:23], v[100:103], v[56:59], v[20:23]
  v_or_b32 v237, 1, v237
  s_waitcnt lgkmcnt(8)
  v_mfma_f32_16x16x32_bf16 v[24:27], v[152:155], v[32:35], 0
  ds_read_b64_tr_b16 v[164:165], v13 offset:2208
  ds_read_b64_tr_b16 v[166:167], v13 offset:2176
  v_add_f32_dpp v224, v31, v18 wave_ror:1 row_mask:0xf bank_mask:0xf
  v_mfma_f32_16x16x32_bf16 v[24:27], v[144:147], v[36:39], v[24:27]
  v_add_f32_dpp v226, v225, v17 wave_ror:1 row_mask:0xf bank_mask:0xf
  v_mfma_f32_16x16x32_bf16 v[24:27], v[136:139], v[40:43], v[24:27]
  v_add_f32_dpp v228, v227, v16 wave_ror:1 row_mask:0xf bank_mask:0xf
  v_mfma_f32_16x16x32_bf16 v[24:27], v[128:131], v[44:47], v[24:27]
  v_add_f32_dpp v224, v19, v18 wave_shr:1 row_mask:0xf bank_mask:0xf
  v_mfma_f32_16x16x32_bf16 v[24:27], v[120:123], v[48:51], v[24:27]
  s_nop 0
  v_add_f32_dpp v226, v224, v17 wave_shr:1 row_mask:0xf bank_mask:0xf
  v_mfma_f32_16x16x32_bf16 v[24:27], v[112:115], v[52:55], v[24:27]
  s_nop 0
  v_add_f32_dpp v228, v226, v16 wave_shr:1 row_mask:0xf bank_mask:0xf
  v_mfma_f32_16x16x32_bf16 v[24:27], v[104:107], v[56:59], v[24:27]
  s_waitcnt lgkmcnt(8)
  v_mfma_f32_16x16x32_bf16 v[24:27], v[96:99], v[60:63], v[24:27]
  s_waitcnt lgkmcnt(6)
  v_mfma_f32_16x16x32_bf16 v[28:31], v[156:159], v[32:35], 0
  ds_read_b64_tr_b16 v[168:169], v13 offset:2336
  ds_read_b64_tr_b16 v[170:171], v13 offset:2304
  ds_read_b64_tr_b16 v[68:69], v12 offset:2304
  ds_read_b64_tr_b16 v[70:71], v12 offset:2336
  v_add_f32_dpp v225, v19, v22 wave_ror:1 row_mask:0xf bank_mask:0xf
  v_mfma_f32_16x16x32_bf16 v[28:31], v[148:151], v[36:39], v[28:31]
  v_add_f32_dpp v227, v224, v21 wave_ror:1 row_mask:0xf bank_mask:0xf
  v_mfma_f32_16x16x32_bf16 v[28:31], v[140:143], v[40:43], v[28:31]
  v_add_f32_dpp v229, v226, v20 wave_ror:1 row_mask:0xf bank_mask:0xf
  v_mfma_f32_16x16x32_bf16 v[28:31], v[132:135], v[44:47], v[28:31]
  v_add_f32_dpp v225, v23, v22 wave_shr:1 row_mask:0xf bank_mask:0xf
  v_mfma_f32_16x16x32_bf16 v[28:31], v[124:127], v[48:51], v[28:31]
  s_nop 0
  v_add_f32_dpp v227, v225, v21 wave_shr:1 row_mask:0xf bank_mask:0xf
  v_mfma_f32_16x16x32_bf16 v[28:31], v[116:119], v[52:55], v[28:31]
  s_nop 0
  v_add_f32_dpp v229, v227, v20 wave_shr:1 row_mask:0xf bank_mask:0xf
  v_mfma_f32_16x16x32_bf16 v[28:31], v[108:111], v[56:59], v[28:31]
  v_cvt_pk_bf16_f32 v238, v228, v229
  v_mfma_f32_16x16x32_bf16 v[28:31], v[100:103], v[60:63], v[28:31]
  v_or_b32 v238, 1, v238
  s_waitcnt lgkmcnt(8)
  v_mfma_f32_16x16x32_bf16 v[16:19], v[160:163], v[32:35], 0
  ds_read_b64_tr_b16 v[172:173], v13 offset:2464
  ds_read_b64_tr_b16 v[174:175], v13 offset:2432
  v_add_f32_dpp v224, v23, v26 wave_ror:1 row_mask:0xf bank_mask:0xf
  v_mfma_f32_16x16x32_bf16 v[16:19], v[152:155], v[36:39], v[16:19]
  v_add_f32_dpp v226, v225, v25 wave_ror:1 row_mask:0xf bank_mask:0xf
  v_mfma_f32_16x16x32_bf16 v[16:19], v[144:147], v[40:43], v[16:19]
  v_add_f32_dpp v228, v227, v24 wave_ror:1 row_mask:0xf bank_mask:0xf
  v_mfma_f32_16x16x32_bf16 v[16:19], v[136:139], v[44:47], v[16:19]
  v_add_f32_dpp v224, v27, v26 wave_shr:1 row_mask:0xf bank_mask:0xf
  v_mfma_f32_16x16x32_bf16 v[16:19], v[128:131], v[48:51], v[16:19]
  s_nop 0
  v_add_f32_dpp v226, v224, v25 wave_shr:1 row_mask:0xf bank_mask:0xf
  v_mfma_f32_16x16x32_bf16 v[16:19], v[120:123], v[52:55], v[16:19]
  s_nop 0
  v_add_f32_dpp v228, v226, v24 wave_shr:1 row_mask:0xf bank_mask:0xf
  v_mfma_f32_16x16x32_bf16 v[16:19], v[112:115], v[56:59], v[16:19]
  v_mfma_f32_16x16x32_bf16 v[16:19], v[104:107], v[60:63], v[16:19]
  s_waitcnt lgkmcnt(8)
  v_mfma_f32_16x16x32_bf16 v[16:19], v[96:99], v[64:67], v[16:19]
  s_waitcnt lgkmcnt(6)
  v_mfma_f32_16x16x32_bf16 v[20:23], v[164:167], v[32:35], 0
  ds_read_b64_tr_b16 v[176:177], v13 offset:2592
  ds_read_b64_tr_b16 v[178:179], v13 offset:2560
  ds_read_b64_tr_b16 v[72:73], v12 offset:2560
  ds_read_b64_tr_b16 v[74:75], v12 offset:2592
  v_add_f32_dpp v225, v27, v30 wave_ror:1 row_mask:0xf bank_mask:0xf
  v_mfma_f32_16x16x32_bf16 v[20:23], v[156:159], v[36:39], v[20:23]
  v_add_f32_dpp v227, v224, v29 wave_ror:1 row_mask:0xf bank_mask:0xf
  v_mfma_f32_16x16x32_bf16 v[20:23], v[148:151], v[40:43], v[20:23]
  v_add_f32_dpp v229, v226, v28 wave_ror:1 row_mask:0xf bank_mask:0xf
  v_mfma_f32_16x16x32_bf16 v[20:23], v[140:143], v[44:47], v[20:23]
  v_add_f32_dpp v225, v31, v30 wave_shr:1 row_mask:0xf bank_mask:0xf
  v_mfma_f32_16x16x32_bf16 v[20:23], v[132:135], v[48:51], v[20:23]
  s_nop 0
  v_add_f32_dpp v227, v225, v29 wave_shr:1 row_mask:0xf bank_mask:0xf
  v_mfma_f32_16x16x32_bf16 v[20:23], v[124:127], v[52:55], v[20:23]
  s_nop 0
  v_add_f32_dpp v229, v227, v28 wave_shr:1 row_mask:0xf bank_mask:0xf
  v_mfma_f32_16x16x32_bf16 v[20:23], v[116:119], v[56:59], v[20:23]
  v_cvt_pk_bf16_f32 v239, v228, v229
  v_mfma_f32_16x16x32_bf16 v[20:23], v[108:111], v[60:63], v[20:23]
  v_or_b32 v239, 1, v239
  v_mfma_f32_16x16x32_bf16 v[20:23], v[100:103], v[64:67], v[20:23]
  s_waitcnt lgkmcnt(8)
  v_mfma_f32_16x16x32_bf16 v[24:27], v[168:171], v[32:35], 0
  ds_read_b64_tr_b16 v[180:181], v13 offset:2720
  ds_read_b64_tr_b16 v[182:183], v13 offset:2688
  v_add_f32_dpp v224, v31, v18 wave_ror:1 row_mask:0xf bank_mask:0xf
  v_mfma_f32_16x16x32_bf16 v[24:27], v[160:163], v[36:39], v[24:27]
  v_add_f32_dpp v226, v225, v17 wave_ror:1 row_mask:0xf bank_mask:0xf
  v_mfma_f32_16x16x32_bf16 v[24:27], v[152:155], v[40:43], v[24:27]
  v_add_f32_dpp v228, v227, v16 wave_ror:1 row_mask:0xf bank_mask:0xf
  v_mfma_f32_16x16x32_bf16 v[24:27], v[144:147], v[44:47], v[24:27]
  v_add_f32_dpp v224, v19, v18 wave_shr:1 row_mask:0xf bank_mask:0xf
  v_mfma_f32_16x16x32_bf16 v[24:27], v[136:139], v[48:51], v[24:27]
  s_nop 0
  v_add_f32_dpp v226, v224, v17 wave_shr:1 row_mask:0xf bank_mask:0xf
  v_mfma_f32_16x16x32_bf16 v[24:27], v[128:131], v[52:55], v[24:27]
  s_nop 0
  v_add_f32_dpp v228, v226, v16 wave_shr:1 row_mask:0xf bank_mask:0xf
  v_mfma_f32_16x16x32_bf16 v[24:27], v[120:123], v[56:59], v[24:27]
  v_mfma_f32_16x16x32_bf16 v[24:27], v[112:115], v[60:63], v[24:27]
  v_mfma_f32_16x16x32_bf16 v[24:27], v[104:107], v[64:67], v[24:27]
  s_waitcnt lgkmcnt(8)
  v_mfma_f32_16x16x32_bf16 v[24:27], v[96:99], v[68:71], v[24:27]
  s_waitcnt lgkmcnt(6)
  v_mfma_f32_16x16x32_bf16 v[28:31], v[172:175], v[32:35], 0
  ds_read_b64_tr_b16 v[184:185], v13 offset:2848
  ds_read_b64_tr_b16 v[186:187], v13 offset:2816
  ds_read_b64_tr_b16 v[76:77], v12 offset:2816
  ds_read_b64_tr_b16 v[78:79], v12 offset:2848
  v_add_f32_dpp v225, v19, v22 wave_ror:1 row_mask:0xf bank_mask:0xf
  v_mfma_f32_16x16x32_bf16 v[28:31], v[164:167], v[36:39], v[28:31]
  v_add_f32_dpp v227, v224, v21 wave_ror:1 row_mask:0xf bank_mask:0xf
  v_mfma_f32_16x16x32_bf16 v[28:31], v[156:159], v[40:43], v[28:31]
  v_add_f32_dpp v229, v226, v20 wave_ror:1 row_mask:0xf bank_mask:0xf
  v_mfma_f32_16x16x32_bf16 v[28:31], v[148:151], v[44:47], v[28:31]
  v_add_f32_dpp v225, v23, v22 wave_shr:1 row_mask:0xf bank_mask:0xf
  v_mfma_f32_16x16x32_bf16 v[28:31], v[140:143], v[48:51], v[28:31]
  s_nop 0
  v_add_f32_dpp v227, v225, v21 wave_shr:1 row_mask:0xf bank_mask:0xf
  v_mfma_f32_16x16x32_bf16 v[28:31], v[132:135], v[52:55], v[28:31]
  s_nop 0
  v_add_f32_dpp v229, v227, v20 wave_shr:1 row_mask:0xf bank_mask:0xf
  v_mfma_f32_16x16x32_bf16 v[28:31], v[124:127], v[56:59], v[28:31]
  v_cvt_pk_bf16_f32 v240, v228, v229
  v_mfma_f32_16x16x32_bf16 v[28:31], v[116:119], v[60:63], v[28:31]
  v_or_b32 v240, 1, v240
  v_mfma_f32_16x16x32_bf16 v[28:31], v[108:111], v[64:67], v[28:31]
  v_mfma_f32_16x16x32_bf16 v[28:31], v[100:103], v[68:71], v[28:31]
  s_waitcnt lgkmcnt(8)
  v_mfma_f32_16x16x32_bf16 v[16:19], v[176:179], v[32:35], 0
  ds_read_b64_tr_b16 v[188:189], v13 offset:2976
  ds_read_b64_tr_b16 v[190:191], v13 offset:2944
  v_add_f32_dpp v224, v23, v26 wave_ror:1 row_mask:0xf bank_mask:0xf
  v_mfma_f32_16x16x32_bf16 v[16:19], v[168:171], v[36:39], v[16:19]
  v_add_f32_dpp v226, v225, v25 wave_ror:1 row_mask:0xf bank_mask:0xf
  v_mfma_f32_16x16x32_bf16 v[16:19], v[160:163], v[40:43], v[16:19]
  v_add_f32_dpp v228, v227, v24 wave_ror:1 row_mask:0xf bank_mask:0xf
  v_mfma_f32_16x16x32_bf16 v[16:19], v[152:155], v[44:47], v[16:19]
  v_add_f32_dpp v224, v27, v26 wave_shr:1 row_mask:0xf bank_mask:0xf
  v_mfma_f32_16x16x32_bf16 v[16:19], v[144:147], v[48:51], v[16:19]
  s_nop 0
  v_add_f32_dpp v226, v224, v25 wave_shr:1 row_mask:0xf bank_mask:0xf
  v_mfma_f32_16x16x32_bf16 v[16:19], v[136:139], v[52:55], v[16:19]
  s_nop 0
  v_add_f32_dpp v228, v226, v24 wave_shr:1 row_mask:0xf bank_mask:0xf
  v_mfma_f32_16x16x32_bf16 v[16:19], v[128:131], v[56:59], v[16:19]
  v_mfma_f32_16x16x32_bf16 v[16:19], v[120:123], v[60:63], v[16:19]
  v_mfma_f32_16x16x32_bf16 v[16:19], v[112:115], v[64:67], v[16:19]
  v_mfma_f32_16x16x32_bf16 v[16:19], v[104:107], v[68:71], v[16:19]
  s_waitcnt lgkmcnt(8)
  v_mfma_f32_16x16x32_bf16 v[16:19], v[96:99], v[72:75], v[16:19]
  s_waitcnt lgkmcnt(6)
  v_mfma_f32_16x16x32_bf16 v[20:23], v[180:183], v[32:35], 0
  ds_read_b64_tr_b16 v[192:193], v13 offset:3104
  ds_read_b64_tr_b16 v[194:195], v13 offset:3072
  ds_read_b64_tr_b16 v[80:81], v12 offset:3072
  ds_read_b64_tr_b16 v[82:83], v12 offset:3104
  v_add_f32_dpp v225, v27, v30 wave_ror:1 row_mask:0xf bank_mask:0xf
  v_mfma_f32_16x16x32_bf16 v[20:23], v[172:175], v[36:39], v[20:23]
  v_add_f32_dpp v227, v224, v29 wave_ror:1 row_mask:0xf bank_mask:0xf
  v_mfma_f32_16x16x32_bf16 v[20:23], v[164:167], v[40:43], v[20:23]
  v_add_f32_dpp v229, v226, v28 wave_ror:1 row_mask:0xf bank_mask:0xf
  v_mfma_f32_16x16x32_bf16 v[20:23], v[156:159], v[44:47], v[20:23]
  v_add_f32_dpp v225, v31, v30 wave_shr:1 row_mask:0xf bank_mask:0xf
  v_mfma_f32_16x16x32_bf16 v[20:23], v[148:151], v[48:51], v[20:23]
  s_nop 0
  v_add_f32_dpp v227, v225, v29 wave_shr:1 row_mask:0xf bank_mask:0xf
  v_mfma_f32_16x16x32_bf16 v[20:23], v[140:143], v[52:55], v[20:23]
  s_nop 0
  v_add_f32_dpp v229, v227, v28 wave_shr:1 row_mask:0xf bank_mask:0xf
  v_mfma_f32_16x16x32_bf16 v[20:23], v[132:135], v[56:59], v[20:23]
  v_cvt_pk_bf16_f32 v241, v228, v229
  v_mfma_f32_16x16x32_bf16 v[20:23], v[124:127], v[60:63], v[20:23]
  v_or_b32 v241, 1, v241
  v_mfma_f32_16x16x32_bf16 v[20:23], v[116:119], v[64:67], v[20:23]
  v_mfma_f32_16x16x32_bf16 v[20:23], v[108:111], v[68:71], v[20:23]
  v_mfma_f32_16x16x32_bf16 v[20:23], v[100:103], v[72:75], v[20:23]
  s_waitcnt lgkmcnt(8)
  v_mfma_f32_16x16x32_bf16 v[24:27], v[184:187], v[32:35], 0
  ds_read_b64_tr_b16 v[196:197], v13 offset:3232
  ds_read_b64_tr_b16 v[198:199], v13 offset:3200
  v_add_f32_dpp v224, v31, v18 wave_ror:1 row_mask:0xf bank_mask:0xf
  v_mfma_f32_16x16x32_bf16 v[24:27], v[176:179], v[36:39], v[24:27]
  v_add_f32_dpp v226, v225, v17 wave_ror:1 row_mask:0xf bank_mask:0xf
  v_mfma_f32_16x16x32_bf16 v[24:27], v[168:171], v[40:43], v[24:27]
  v_add_f32_dpp v228, v227, v16 wave_ror:1 row_mask:0xf bank_mask:0xf
  v_mfma_f32_16x16x32_bf16 v[24:27], v[160:163], v[44:47], v[24:27]
  v_add_f32_dpp v224, v19, v18 wave_shr:1 row_mask:0xf bank_mask:0xf
  v_mfma_f32_16x16x32_bf16 v[24:27], v[152:155], v[48:51], v[24:27]
  s_nop 0
  v_add_f32_dpp v226, v224, v17 wave_shr:1 row_mask:0xf bank_mask:0xf
  v_mfma_f32_16x16x32_bf16 v[24:27], v[144:147], v[52:55], v[24:27]
  s_nop 0
  v_add_f32_dpp v228, v226, v16 wave_shr:1 row_mask:0xf bank_mask:0xf
  v_mfma_f32_16x16x32_bf16 v[24:27], v[136:139], v[56:59], v[24:27]
  v_mfma_f32_16x16x32_bf16 v[24:27], v[128:131], v[60:63], v[24:27]
  v_mfma_f32_16x16x32_bf16 v[24:27], v[120:123], v[64:67], v[24:27]
  v_mfma_f32_16x16x32_bf16 v[24:27], v[112:115], v[68:71], v[24:27]
  v_mfma_f32_16x16x32_bf16 v[24:27], v[104:107], v[72:75], v[24:27]
  s_waitcnt lgkmcnt(8)
  v_mfma_f32_16x16x32_bf16 v[24:27], v[96:99], v[76:79], v[24:27]
  s_waitcnt lgkmcnt(6)
  v_mfma_f32_16x16x32_bf16 v[28:31], v[188:191], v[32:35], 0
  ds_read_b64_tr_b16 v[200:201], v13 offset:3360
  ds_read_b64_tr_b16 v[202:203], v13 offset:3328
  ds_read_b64_tr_b16 v[84:85], v12 offset:3328
  ds_read_b64_tr_b16 v[86:87], v12 offset:3360
  v_add_f32_dpp v225, v19, v22 wave_ror:1 row_mask:0xf bank_mask:0xf
  v_mfma_f32_16x16x32_bf16 v[28:31], v[180:183], v[36:39], v[28:31]
  v_add_f32_dpp v227, v224, v21 wave_ror:1 row_mask:0xf bank_mask:0xf
  v_mfma_f32_16x16x32_bf16 v[28:31], v[172:175], v[40:43], v[28:31]
  v_add_f32_dpp v229, v226, v20 wave_ror:1 row_mask:0xf bank_mask:0xf
  v_mfma_f32_16x16x32_bf16 v[28:31], v[164:167], v[44:47], v[28:31]
  v_add_f32_dpp v225, v23, v22 wave_shr:1 row_mask:0xf bank_mask:0xf
  v_mfma_f32_16x16x32_bf16 v[28:31], v[156:159], v[48:51], v[28:31]
  s_nop 0
  v_add_f32_dpp v227, v225, v21 wave_shr:1 row_mask:0xf bank_mask:0xf
  v_mfma_f32_16x16x32_bf16 v[28:31], v[148:151], v[52:55], v[28:31]
  s_nop 0
  v_add_f32_dpp v229, v227, v20 wave_shr:1 row_mask:0xf bank_mask:0xf
  v_mfma_f32_16x16x32_bf16 v[28:31], v[140:143], v[56:59], v[28:31]
  v_cvt_pk_bf16_f32 v242, v228, v229
  v_mfma_f32_16x16x32_bf16 v[28:31], v[132:135], v[60:63], v[28:31]
  v_or_b32 v242, 1, v242
  v_mfma_f32_16x16x32_bf16 v[28:31], v[124:127], v[64:67], v[28:31]
  v_mfma_f32_16x16x32_bf16 v[28:31], v[116:119], v[68:71], v[28:31]
  v_mfma_f32_16x16x32_bf16 v[28:31], v[108:111], v[72:75], v[28:31]
  v_mfma_f32_16x16x32_bf16 v[28:31], v[100:103], v[76:79], v[28:31]
  s_waitcnt lgkmcnt(8)
  v_mfma_f32_16x16x32_bf16 v[16:19], v[192:195], v[32:35], 0
  ds_read_b64_tr_b16 v[204:205], v13 offset:3488
  ds_read_b64_tr_b16 v[206:207], v13 offset:3456
  v_add_f32_dpp v224, v23, v26 wave_ror:1 row_mask:0xf bank_mask:0xf
  v_mfma_f32_16x16x32_bf16 v[16:19], v[184:187], v[36:39], v[16:19]
  v_add_f32_dpp v226, v225, v25 wave_ror:1 row_mask:0xf bank_mask:0xf
  v_mfma_f32_16x16x32_bf16 v[16:19], v[176:179], v[40:43], v[16:19]
  v_add_f32_dpp v228, v227, v24 wave_ror:1 row_mask:0xf bank_mask:0xf
  v_mfma_f32_16x16x32_bf16 v[16:19], v[168:171], v[44:47], v[16:19]
  v_add_f32_dpp v224, v27, v26 wave_shr:1 row_mask:0xf bank_mask:0xf
  v_mfma_f32_16x16x32_bf16 v[16:19], v[160:163], v[48:51], v[16:19]
  s_nop 0
  v_add_f32_dpp v226, v224, v25 wave_shr:1 row_mask:0xf bank_mask:0xf
  v_mfma_f32_16x16x32_bf16 v[16:19], v[152:155], v[52:55], v[16:19]
  s_nop 0
  v_add_f32_dpp v228, v226, v24 wave_shr:1 row_mask:0xf bank_mask:0xf
  v_mfma_f32_16x16x32_bf16 v[16:19], v[144:147], v[56:59], v[16:19]
  v_mfma_f32_16x16x32_bf16 v[16:19], v[136:139], v[60:63], v[16:19]
  v_mfma_f32_16x16x32_bf16 v[16:19], v[128:131], v[64:67], v[16:19]
  v_mfma_f32_16x16x32_bf16 v[16:19], v[120:123], v[68:71], v[16:19]
  v_mfma_f32_16x16x32_bf16 v[16:19], v[112:115], v[72:75], v[16:19]
  v_mfma_f32_16x16x32_bf16 v[16:19], v[104:107], v[76:79], v[16:19]
  s_waitcnt lgkmcnt(8)
  v_mfma_f32_16x16x32_bf16 v[16:19], v[96:99], v[80:83], v[16:19]
  s_waitcnt lgkmcnt(6)
  v_mfma_f32_16x16x32_bf16 v[20:23], v[196:199], v[32:35], 0
  ds_read_b64_tr_b16 v[208:209], v13 offset:3616
  ds_read_b64_tr_b16 v[210:211], v13 offset:3584
  ds_read_b64_tr_b16 v[88:89], v12 offset:3584
  ds_read_b64_tr_b16 v[90:91], v12 offset:3616
  v_add_f32_dpp v225, v27, v30 wave_ror:1 row_mask:0xf bank_mask:0xf
  v_mfma_f32_16x16x32_bf16 v[20:23], v[188:191], v[36:39], v[20:23]
  v_add_f32_dpp v227, v224, v29 wave_ror:1 row_mask:0xf bank_mask:0xf
  v_mfma_f32_16x16x32_bf16 v[20:23], v[180:183], v[40:43], v[20:23]
  v_add_f32_dpp v229, v226, v28 wave_ror:1 row_mask:0xf bank_mask:0xf
  v_mfma_f32_16x16x32_bf16 v[20:23], v[172:175], v[44:47], v[20:23]
  v_add_f32_dpp v225, v31, v30 wave_shr:1 row_mask:0xf bank_mask:0xf
  v_mfma_f32_16x16x32_bf16 v[20:23], v[164:167], v[48:51], v[20:23]
  s_nop 0
  v_add_f32_dpp v227, v225, v29 wave_shr:1 row_mask:0xf bank_mask:0xf
  v_mfma_f32_16x16x32_bf16 v[20:23], v[156:159], v[52:55], v[20:23]
  s_nop 0
  v_add_f32_dpp v229, v227, v28 wave_shr:1 row_mask:0xf bank_mask:0xf
  v_mfma_f32_16x16x32_bf16 v[20:23], v[148:151], v[56:59], v[20:23]
  v_cvt_pk_bf16_f32 v243, v228, v229
  v_mfma_f32_16x16x32_bf16 v[20:23], v[140:143], v[60:63], v[20:23]
  v_or_b32 v243, 1, v243
  v_mfma_f32_16x16x32_bf16 v[20:23], v[132:135], v[64:67], v[20:23]
  v_mfma_f32_16x16x32_bf16 v[20:23], v[124:127], v[68:71], v[20:23]
  v_mfma_f32_16x16x32_bf16 v[20:23], v[116:119], v[72:75], v[20:23]
  v_mfma_f32_16x16x32_bf16 v[20:23], v[108:111], v[76:79], v[20:23]
  v_mfma_f32_16x16x32_bf16 v[20:23], v[100:103], v[80:83], v[20:23]
  s_waitcnt lgkmcnt(8)
  v_mfma_f32_16x16x32_bf16 v[24:27], v[200:203], v[32:35], 0
  ds_read_b64_tr_b16 v[212:213], v13 offset:3744
  ds_read_b64_tr_b16 v[214:215], v13 offset:3712
  v_add_f32_dpp v224, v31, v18 wave_ror:1 row_mask:0xf bank_mask:0xf
  v_mfma_f32_16x16x32_bf16 v[24:27], v[192:195], v[36:39], v[24:27]
  v_add_f32_dpp v226, v225, v17 wave_ror:1 row_mask:0xf bank_mask:0xf
  v_mfma_f32_16x16x32_bf16 v[24:27], v[184:187], v[40:43], v[24:27]
  v_add_f32_dpp v228, v227, v16 wave_ror:1 row_mask:0xf bank_mask:0xf
  v_mfma_f32_16x16x32_bf16 v[24:27], v[176:179], v[44:47], v[24:27]
  v_add_f32_dpp v224, v19, v18 wave_shr:1 row_mask:0xf bank_mask:0xf
  v_mfma_f32_16x16x32_bf16 v[24:27], v[168:171], v[48:51], v[24:27]
  s_nop 0
  v_add_f32_dpp v226, v224, v17 wave_shr:1 row_mask:0xf bank_mask:0xf
  v_mfma_f32_16x16x32_bf16 v[24:27], v[160:163], v[52:55], v[24:27]
  s_nop 0
  v_add_f32_dpp v228, v226, v16 wave_shr:1 row_mask:0xf bank_mask:0xf
  v_mfma_f32_16x16x32_bf16 v[24:27], v[152:155], v[56:59], v[24:27]
  v_mfma_f32_16x16x32_bf16 v[24:27], v[144:147], v[60:63], v[24:27]
  v_mfma_f32_16x16x32_bf16 v[24:27], v[136:139], v[64:67], v[24:27]
  v_mfma_f32_16x16x32_bf16 v[24:27], v[128:131], v[68:71], v[24:27]
  v_mfma_f32_16x16x32_bf16 v[24:27], v[120:123], v[72:75], v[24:27]
  v_mfma_f32_16x16x32_bf16 v[24:27], v[112:115], v[76:79], v[24:27]
  v_mfma_f32_16x16x32_bf16 v[24:27], v[104:107], v[80:83], v[24:27]
  s_waitcnt lgkmcnt(8)
  v_mfma_f32_16x16x32_bf16 v[24:27], v[96:99], v[84:87], v[24:27]
  s_waitcnt lgkmcnt(6)
  v_mfma_f32_16x16x32_bf16 v[28:31], v[204:207], v[32:35], 0
  ds_read_b64_tr_b16 v[216:217], v13 offset:3872
  ds_read_b64_tr_b16 v[218:219], v13 offset:3840
  ds_read_b64_tr_b16 v[92:93], v12 offset:3840
  ds_read_b64_tr_b16 v[94:95], v12 offset:3872
  v_add_f32_dpp v225, v19, v22 wave_ror:1 row_mask:0xf bank_mask:0xf
  v_mfma_f32_16x16x32_bf16 v[28:31], v[196:199], v[36:39], v[28:31]
  v_add_f32_dpp v227, v224, v21 wave_ror:1 row_mask:0xf bank_mask:0xf
  v_mfma_f32_16x16x32_bf16 v[28:31], v[188:191], v[40:43], v[28:31]
  v_add_f32_dpp v229, v226, v20 wave_ror:1 row_mask:0xf bank_mask:0xf
  v_mfma_f32_16x16x32_bf16 v[28:31], v[180:183], v[44:47], v[28:31]
  v_add_f32_dpp v225, v23, v22 wave_shr:1 row_mask:0xf bank_mask:0xf
  v_mfma_f32_16x16x32_bf16 v[28:31], v[172:175], v[48:51], v[28:31]
  s_nop 0
  v_add_f32_dpp v227, v225, v21 wave_shr:1 row_mask:0xf bank_mask:0xf
  v_mfma_f32_16x16x32_bf16 v[28:31], v[164:167], v[52:55], v[28:31]
  s_nop 0
  v_add_f32_dpp v229, v227, v20 wave_shr:1 row_mask:0xf bank_mask:0xf
  v_mfma_f32_16x16x32_bf16 v[28:31], v[156:159], v[56:59], v[28:31]
  v_cvt_pk_bf16_f32 v244, v228, v229
  v_mfma_f32_16x16x32_bf16 v[28:31], v[148:151], v[60:63], v[28:31]
  v_or_b32 v244, 1, v244
  v_mfma_f32_16x16x32_bf16 v[28:31], v[140:143], v[64:67], v[28:31]
  v_mfma_f32_16x16x32_bf16 v[28:31], v[132:135], v[68:71], v[28:31]
  v_mfma_f32_16x16x32_bf16 v[28:31], v[124:127], v[72:75], v[28:31]
  v_mfma_f32_16x16x32_bf16 v[28:31], v[116:119], v[76:79], v[28:31]
  v_mfma_f32_16x16x32_bf16 v[28:31], v[108:111], v[80:83], v[28:31]
  v_mfma_f32_16x16x32_bf16 v[28:31], v[100:103], v[84:87], v[28:31]
  s_waitcnt lgkmcnt(8)
  v_mfma_f32_16x16x32_bf16 v[16:19], v[208:211], v[32:35], 0
  ds_read_b64_tr_b16 v[220:221], v13 offset:4000
  ds_read_b64_tr_b16 v[222:223], v13 offset:3968
  v_add_f32_dpp v224, v23, v26 wave_ror:1 row_mask:0xf bank_mask:0xf
  v_mfma_f32_16x16x32_bf16 v[16:19], v[200:203], v[36:39], v[16:19]
  v_add_f32_dpp v226, v225, v25 wave_ror:1 row_mask:0xf bank_mask:0xf
  v_mfma_f32_16x16x32_bf16 v[16:19], v[192:195], v[40:43], v[16:19]
  v_add_f32_dpp v228, v227, v24 wave_ror:1 row_mask:0xf bank_mask:0xf
  v_mfma_f32_16x16x32_bf16 v[16:19], v[184:187], v[44:47], v[16:19]
  v_add_f32_dpp v224, v27, v26 wave_shr:1 row_mask:0xf bank_mask:0xf
  v_mfma_f32_16x16x32_bf16 v[16:19], v[176:179], v[48:51], v[16:19]
  s_nop 0
  v_add_f32_dpp v226, v224, v25 wave_shr:1 row_mask:0xf bank_mask:0xf
  v_mfma_f32_16x16x32_bf16 v[16:19], v[168:171], v[52:55], v[16:19]
  s_nop 0
  v_add_f32_dpp v228, v226, v24 wave_shr:1 row_mask:0xf bank_mask:0xf
  v_mfma_f32_16x16x32_bf16 v[16:19], v[160:163], v[56:59], v[16:19]
  v_mfma_f32_16x16x32_bf16 v[16:19], v[152:155], v[60:63], v[16:19]
  v_mfma_f32_16x16x32_bf16 v[16:19], v[144:147], v[64:67], v[16:19]
  v_mfma_f32_16x16x32_bf16 v[16:19], v[136:139], v[68:71], v[16:19]
  v_mfma_f32_16x16x32_bf16 v[16:19], v[128:131], v[72:75], v[16:19]
  v_mfma_f32_16x16x32_bf16 v[16:19], v[120:123], v[76:79], v[16:19]
  v_mfma_f32_16x16x32_bf16 v[16:19], v[112:115], v[80:83], v[16:19]
  v_mfma_f32_16x16x32_bf16 v[16:19], v[104:107], v[84:87], v[16:19]
  s_waitcnt lgkmcnt(8)
  v_mfma_f32_16x16x32_bf16 v[16:19], v[96:99], v[88:91], v[16:19]
  s_waitcnt lgkmcnt(6)
  v_mfma_f32_16x16x32_bf16 v[20:23], v[212:215], v[32:35], 0
  v_add_f32_dpp v225, v27, v30 wave_ror:1 row_mask:0xf bank_mask:0xf
  v_mfma_f32_16x16x32_bf16 v[20:23], v[204:207], v[36:39], v[20:23]
  v_add_f32_dpp v227, v224, v29 wave_ror:1 row_mask:0xf bank_mask:0xf
  v_mfma_f32_16x16x32_bf16 v[20:23], v[196:199], v[40:43], v[20:23]
  v_add_f32_dpp v229, v226, v28 wave_ror:1 row_mask:0xf bank_mask:0xf
  v_mfma_f32_16x16x32_bf16 v[20:23], v[188:191], v[44:47], v[20:23]
  v_add_f32_dpp v225, v31, v30 wave_shr:1 row_mask:0xf bank_mask:0xf
  v_mfma_f32_16x16x32_bf16 v[20:23], v[180:183], v[48:51], v[20:23]
  s_nop 0
  v_add_f32_dpp v227, v225, v29 wave_shr:1 row_mask:0xf bank_mask:0xf
  v_mfma_f32_16x16x32_bf16 v[20:23], v[172:175], v[52:55], v[20:23]
  s_nop 0
  v_add_f32_dpp v229, v227, v28 wave_shr:1 row_mask:0xf bank_mask:0xf
  v_mfma_f32_16x16x32_bf16 v[20:23], v[164:167], v[56:59], v[20:23]
  v_cvt_pk_bf16_f32 v245, v228, v229
  v_mfma_f32_16x16x32_bf16 v[20:23], v[156:159], v[60:63], v[20:23]
  v_or_b32 v245, 1, v245
  v_mfma_f32_16x16x32_bf16 v[20:23], v[148:151], v[64:67], v[20:23]
  v_mfma_f32_16x16x32_bf16 v[20:23], v[140:143], v[68:71], v[20:23]
  v_mfma_f32_16x16x32_bf16 v[20:23], v[132:135], v[72:75], v[20:23]
  v_mfma_f32_16x16x32_bf16 v[20:23], v[124:127], v[76:79], v[20:23]
  v_mfma_f32_16x16x32_bf16 v[20:23], v[116:119], v[80:83], v[20:23]
  v_mfma_f32_16x16x32_bf16 v[20:23], v[108:111], v[84:87], v[20:23]
  v_mfma_f32_16x16x32_bf16 v[20:23], v[100:103], v[88:91], v[20:23]
  s_waitcnt lgkmcnt(4)
  v_mfma_f32_16x16x32_bf16 v[24:27], v[216:219], v[32:35], 0
  v_add_f32_dpp v224, v31, v18 wave_ror:1 row_mask:0xf bank_mask:0xf
  v_mfma_f32_16x16x32_bf16 v[24:27], v[208:211], v[36:39], v[24:27]
  v_add_f32_dpp v226, v225, v17 wave_ror:1 row_mask:0xf bank_mask:0xf
  v_mfma_f32_16x16x32_bf16 v[24:27], v[200:203], v[40:43], v[24:27]
  v_add_f32_dpp v228, v227, v16 wave_ror:1 row_mask:0xf bank_mask:0xf
  v_mfma_f32_16x16x32_bf16 v[24:27], v[192:195], v[44:47], v[24:27]
  v_add_f32_dpp v224, v19, v18 wave_shr:1 row_mask:0xf bank_mask:0xf
  v_mfma_f32_16x16x32_bf16 v[24:27], v[184:187], v[48:51], v[24:27]
  s_nop 0
  v_add_f32_dpp v226, v224, v17 wave_shr:1 row_mask:0xf bank_mask:0xf
  v_mfma_f32_16x16x32_bf16 v[24:27], v[176:179], v[52:55], v[24:27]
  s_nop 0
  v_add_f32_dpp v228, v226, v16 wave_shr:1 row_mask:0xf bank_mask:0xf
  v_mfma_f32_16x16x32_bf16 v[24:27], v[168:171], v[56:59], v[24:27]
  v_mfma_f32_16x16x32_bf16 v[24:27], v[160:163], v[60:63], v[24:27]
  v_mfma_f32_16x16x32_bf16 v[24:27], v[152:155], v[64:67], v[24:27]
  v_mfma_f32_16x16x32_bf16 v[24:27], v[144:147], v[68:71], v[24:27]
  v_mfma_f32_16x16x32_bf16 v[24:27], v[136:139], v[72:75], v[24:27]
  v_mfma_f32_16x16x32_bf16 v[24:27], v[128:131], v[76:79], v[24:27]
  v_mfma_f32_16x16x32_bf16 v[24:27], v[120:123], v[80:83], v[24:27]
  v_mfma_f32_16x16x32_bf16 v[24:27], v[112:115], v[84:87], v[24:27]
  v_mfma_f32_16x16x32_bf16 v[24:27], v[104:107], v[88:91], v[24:27]
  s_waitcnt lgkmcnt(2)
  v_mfma_f32_16x16x32_bf16 v[24:27], v[96:99], v[92:95], v[24:27]
  s_waitcnt lgkmcnt(0)
  v_mfma_f32_16x16x32_bf16 v[28:31], v[220:223], v[32:35], 0
  v_add_f32_dpp v225, v19, v22 wave_ror:1 row_mask:0xf bank_mask:0xf
  v_mfma_f32_16x16x32_bf16 v[28:31], v[212:215], v[36:39], v[28:31]
  v_add_f32_dpp v227, v224, v21 wave_ror:1 row_mask:0xf bank_mask:0xf
  v_mfma_f32_16x16x32_bf16 v[28:31], v[204:207], v[40:43], v[28:31]
  v_add_f32_dpp v229, v226, v20 wave_ror:1 row_mask:0xf bank_mask:0xf
  v_mfma_f32_16x16x32_bf16 v[28:31], v[196:199], v[44:47], v[28:31]
  v_add_f32_dpp v225, v23, v22 wave_shr:1 row_mask:0xf bank_mask:0xf
  v_mfma_f32_16x16x32_bf16 v[28:31], v[188:191], v[48:51], v[28:31]
  s_nop 0
  v_add_f32_dpp v227, v225, v21 wave_shr:1 row_mask:0xf bank_mask:0xf
  v_mfma_f32_16x16x32_bf16 v[28:31], v[180:183], v[52:55], v[28:31]
  s_nop 0
  v_add_f32_dpp v229, v227, v20 wave_shr:1 row_mask:0xf bank_mask:0xf
  v_mfma_f32_16x16x32_bf16 v[28:31], v[172:175], v[56:59], v[28:31]
  v_cvt_pk_bf16_f32 v246, v228, v229
  v_mfma_f32_16x16x32_bf16 v[28:31], v[164:167], v[60:63], v[28:31]
  v_or_b32 v246, 1, v246
  v_mfma_f32_16x16x32_bf16 v[28:31], v[156:159], v[64:67], v[28:31]
  v_mfma_f32_16x16x32_bf16 v[28:31], v[148:151], v[68:71], v[28:31]
  v_mfma_f32_16x16x32_bf16 v[28:31], v[140:143], v[72:75], v[28:31]
  v_mfma_f32_16x16x32_bf16 v[28:31], v[132:135], v[76:79], v[28:31]
  v_mfma_f32_16x16x32_bf16 v[28:31], v[124:127], v[80:83], v[28:31]
  v_mfma_f32_16x16x32_bf16 v[28:31], v[116:119], v[84:87], v[28:31]
  v_mfma_f32_16x16x32_bf16 v[28:31], v[108:111], v[88:91], v[28:31]
  v_mfma_f32_16x16x32_bf16 v[28:31], v[100:103], v[92:95], v[28:31]
  v_add_f32_dpp v224, v23, v26 wave_ror:1 row_mask:0xf bank_mask:0xf
  v_add_f32_dpp v226, v225, v25 wave_ror:1 row_mask:0xf bank_mask:0xf
  v_add_f32_dpp v228, v227, v24 wave_ror:1 row_mask:0xf bank_mask:0xf
  v_add_f32_dpp v224, v27, v26 wave_shr:1 row_mask:0xf bank_mask:0xf
  s_nop 1
  v_add_f32_dpp v226, v224, v25 wave_shr:1 row_mask:0xf bank_mask:0xf
  s_nop 1
  v_add_f32_dpp v228, v226, v24 wave_shr:1 row_mask:0xf bank_mask:0xf
  v_add_f32_dpp v225, v27, v30 wave_ror:1 row_mask:0xf bank_mask:0xf
  v_add_f32_dpp v227, v224, v29 wave_ror:1 row_mask:0xf bank_mask:0xf
  v_add_f32_dpp v229, v226, v28 wave_ror:1 row_mask:0xf bank_mask:0xf
  v_add_f32_dpp v225, v31, v30 wave_shr:1 row_mask:0xf bank_mask:0xf
  s_nop 1
  v_add_f32_dpp v227, v225, v29 wave_shr:1 row_mask:0xf bank_mask:0xf
  s_nop 1
  v_add_f32_dpp v229, v227, v28 wave_shr:1 row_mask:0xf bank_mask:0xf
  v_cvt_pk_bf16_f32 v247, v228, v229
  v_or_b32 v247, 1, v247
  s_add_u32 s28, s98, 16777216
  s_addc_u32 s29, s99, 0
  s_mov_b32 s30, 4194304
  s_mov_b32 s31, 0x20000
  s_lshl_b32 s40, s6, 12
  buffer_store_dwordx4 v[232:235], v3, s[28:31], s40 offen offset:0 sc1
  buffer_store_dwordx4 v[236:239], v3, s[28:31], s40 offen offset:1024 sc1
  buffer_store_dwordx4 v[240:243], v3, s[28:31], s40 offen offset:2048 sc1
  buffer_store_dwordx4 v[244:247], v3, s[28:31], s40 offen offset:3072 sc1
  s_and_b32 s40, s10, 3
  s_lshl_b32 s40, s40, 2
  s_and_b32 s41, s11, 3
  s_add_u32 s40, s40, s41
  s_lshl_b32 s41, s40, 3
  s_lshl_b32 s42, s3, 1
  s_add_u32 s41, s41, s42
  s_lshl_b32 s48, s41, 15
  s_mov_b32 s47, s48
  v_lshrrev_b32 v5, 5, v2
  v_and_b32 v6, 1, v14
  v_lshlrev_b32 v12, 15, v6
  v_lshl_add_u32 v12, v5, 8, v12
  v_lshl_add_u32 v12, v15, 4, v12
  s_add_u32 s28, s98, 0
  s_addc_u32 s29, s99, 0
  s_mov_b32 s30, 4194304
  s_mov_b32 s31, 0x20000
  s_mov_b32 s32, s94
  s_mov_b32 s33, s95
  s_mov_b32 s34, 8388608
  s_mov_b32 s35, 0x20000
  s_waitcnt lgkmcnt(0)
  s_mov_b64 exec, 1
  ds_add_u32 v9, v11 offset:56
  s_mov_b64 exec, -1
  s_mov_b32 s43, 131072
K3_wwo:
  ds_read_b32 v80, v10 offset:48
  s_waitcnt lgkmcnt(0)
  v_readfirstlane_b32 s42, v80
  s_sub_u32 s43, s43, 1
  s_cbranch_scc1 K3_wwo_ok
  s_cmp_lt_u32 s42, 4
  s_cbranch_scc1 K3_wwo
K3_wwo_ok:
  buffer_load_dwordx4 v[96:99], v12, s[28:31], s48 offen offset:0
  buffer_load_dwordx4 v[100:103], v12, s[28:31], s48 offen offset:512
  buffer_load_dwordx4 v[104:107], v12, s[28:31], s48 offen offset:1024
  buffer_load_dwordx4 v[108:111], v12, s[28:31], s48 offen offset:1536
  buffer_load_dwordx4 v[112:115], v12, s[28:31], s48 offen offset:2048
  buffer_load_dwordx4 v[116:119], v12, s[28:31], s48 offen offset:2560
  buffer_load_dwordx4 v[120:123], v12, s[28:31], s48 offen offset:3072
  buffer_load_dwordx4 v[124:127], v12, s[28:31], s48 offen offset:3584
  s_add_u32 s48, s48, 4096
  buffer_load_dwordx4 v[128:131], v12, s[28:31], s48 offen offset:0
  buffer_load_dwordx4 v[132:135], v12, s[28:31], s48 offen offset:512
  buffer_load_dwordx4 v[136:139], v12, s[28:31], s48 offen offset:1024
  buffer_load_dwordx4 v[140:143], v12, s[28:31], s48 offen offset:1536
  buffer_load_dwordx4 v[144:147], v12, s[28:31], s48 offen offset:2048
  buffer_load_dwordx4 v[148:151], v12, s[28:31], s48 offen offset:2560
  buffer_load_dwordx4 v[152:155], v12, s[28:31], s48 offen offset:3072
  buffer_load_dwordx4 v[156:159], v12, s[28:31], s48 offen offset:3584
  s_add_u32 s48, s48, 4096
  v_bfe_u32 v4, v2, 2, 2
  v_and_b32 v7, 3, v2
  v_lshlrev_b32 v4, 6, v4
  v_lshl_add_u32 v4, v7, 3, v4
  v_lshl_add_u32 v4, v5, 9, v4
  v_xor_b32 v7, v6, v5
  v_lshl_add_u32 v13, v7, 5, v4
  v_add_u32 v4, 40960, v13
  v_add_u32 v8, 106496, v13
  ds_read_b64_tr_b16 v[48:49], v4 offset:0
  ds_read_b64_tr_b16 v[50:51], v4 offset:2048
  ds_read_b64_tr_b16 v[52:53], v4 offset:256
  ds_read_b64_tr_b16 v[54:55], v4 offset:2304
  ds_read_b64_tr_b16 v[56:57], v4 offset:1024
  ds_read_b64_tr_b16 v[58:59], v4 offset:3072
  ds_read_b64_tr_b16 v[60:61], v4 offset:1280
  ds_read_b64_tr_b16 v[62:63], v4 offset:3328
  s_waitcnt vmcnt(8)
  v_bitop3_b32 v81, v96, v97, v98 bitop3:0x80
  v_bitop3_b32 v81, v81, v99, v100 bitop3:0x80
  v_bitop3_b32 v81, v81, v101, v102 bitop3:0x80
  v_bitop3_b32 v81, v81, v103, v104 bitop3:0x80
  v_bitop3_b32 v81, v81, v105, v106 bitop3:0x80
  v_bitop3_b32 v81, v81, v107, v108 bitop3:0x80
  v_bitop3_b32 v81, v81, v109, v110 bitop3:0x80
  v_bitop3_b32 v81, v81, v111, v112 bitop3:0x80
  v_bitop3_b32 v81, v81, v113, v114 bitop3:0x80
  v_bitop3_b32 v81, v81, v115, v116 bitop3:0x80
  v_bitop3_b32 v81, v81, v117, v118 bitop3:0x80
  v_bitop3_b32 v81, v81, v119, v120 bitop3:0x80
  v_bitop3_b32 v81, v81, v121, v122 bitop3:0x80
  v_bitop3_b32 v81, v81, v123, v124 bitop3:0x80
  v_bitop3_b32 v81, v81, v125, v126 bitop3:0x80
  v_bitop3_b32 v81, v81, v127, 1 bitop3:0x80
  v_cmp_eq_u32 vcc, 0, v81
  s_nop 0
  s_cmp_lg_u64 vcc, 0
  s_cbranch_scc1 K3_retry0
K3_retry0_ret:
  s_waitcnt lgkmcnt(6)
  v_mfma_f32_32x32x16_bf16 v[16:31], v[48:51], v[96:99], 0
  ds_read_b64_tr_b16 v[64:65], v4 offset:4096
  ds_read_b64_tr_b16 v[66:67], v4 offset:6144
  s_waitcnt lgkmcnt(6)
  v_mfma_f32_32x32x16_bf16 v[32:47], v[52:55], v[96:99], 0
  ds_read_b64_tr_b16 v[68:69], v4 offset:4352
  ds_read_b64_tr_b16 v[70:71], v4 offset:6400
  s_waitcnt lgkmcnt(6)
  v_mfma_f32_32x32x16_bf16 v[16:31], v[56:59], v[100:103], v[16:31]
  ds_read_b64_tr_b16 v[72:73], v4 offset:5120
  ds_read_b64_tr_b16 v[74:75], v4 offset:7168
  s_waitcnt lgkmcnt(6)
  v_mfma_f32_32x32x16_bf16 v[32:47], v[60:63], v[100:103], v[32:47]
  ds_read_b64_tr_b16 v[76:77], v4 offset:5376
  ds_read_b64_tr_b16 v[78:79], v4 offset:7424
  buffer_load_dwordx4 v[160:163], v12, s[28:31], s48 offen offset:0
  buffer_load_dwordx4 v[164:167], v12, s[28:31], s48 offen offset:512
  buffer_load_dwordx4 v[168:171], v12, s[28:31], s48 offen offset:1024
  buffer_load_dwordx4 v[172:175], v12, s[28:31], s48 offen offset:1536
  s_waitcnt lgkmcnt(6)
  v_mfma_f32_32x32x16_bf16 v[16:31], v[64:67], v[104:107], v[16:31]
  ds_read_b64_tr_b16 v[48:49], v4 offset:8192
  ds_read_b64_tr_b16 v[50:51], v4 offset:10240
  s_waitcnt lgkmcnt(6)
  v_mfma_f32_32x32x16_bf16 v[32:47], v[68:71], v[104:107], v[32:47]
  ds_read_b64_tr_b16 v[52:53], v4 offset:8448
  ds_read_b64_tr_b16 v[54:55], v4 offset:10496
  s_waitcnt lgkmcnt(6)
  v_mfma_f32_32x32x16_bf16 v[16:31], v[72:75], v[108:111], v[16:31]
  ds_read_b64_tr_b16 v[56:57], v4 offset:9216
  ds_read_b64_tr_b16 v[58:59], v4 offset:11264
  s_waitcnt lgkmcnt(6)
  v_mfma_f32_32x32x16_bf16 v[32:47], v[76:79], v[108:111], v[32:47]
  ds_read_b64_tr_b16 v[60:61], v4 offset:9472
  ds_read_b64_tr_b16 v[62:63], v4 offset:11520
  buffer_load_dwordx4 v[176:179], v12, s[28:31], s48 offen offset:2048
  buffer_load_dwordx4 v[180:183], v12, s[28:31], s48 offen offset:2560
  buffer_load_dwordx4 v[184:187], v12, s[28:31], s48 offen offset:3072
  buffer_load_dwordx4 v[188:191], v12, s[28:31], s48 offen offset:3584
  s_add_u32 s48, s48, 4096
  s_waitcnt vmcnt(8)
  s_waitcnt lgkmcnt(6)
  v_mfma_f32_32x32x16_bf16 v[16:31], v[48:51], v[112:115], v[16:31]
  ds_read_b64_tr_b16 v[64:65], v4 offset:12288
  v_bitop3_b32 v81, v128, v129, v130 bitop3:0x80
  ds_read_b64_tr_b16 v[66:67], v4 offset:14336
  v_bitop3_b32 v81, v81, v131, v132 bitop3:0x80
  s_waitcnt lgkmcnt(6)
  v_mfma_f32_32x32x16_bf16 v[32:47], v[52:55], v[112:115], v[32:47]
  ds_read_b64_tr_b16 v[68:69], v4 offset:12544
  v_bitop3_b32 v81, v81, v133, v134 bitop3:0x80
  ds_read_b64_tr_b16 v[70:71], v4 offset:14592
  v_bitop3_b32 v81, v81, v135, v136 bitop3:0x80
  s_waitcnt lgkmcnt(6)
  v_mfma_f32_32x32x16_bf16 v[16:31], v[56:59], v[116:119], v[16:31]
  ds_read_b64_tr_b16 v[72:73], v4 offset:13312
  v_bitop3_b32 v81, v81, v137, v138 bitop3:0x80
  ds_read_b64_tr_b16 v[74:75], v4 offset:15360
  v_bitop3_b32 v81, v81, v139, v140 bitop3:0x80
  s_waitcnt lgkmcnt(6)
  v_mfma_f32_32x32x16_bf16 v[32:47], v[60:63], v[116:119], v[32:47]
  ds_read_b64_tr_b16 v[76:77], v4 offset:13568
  v_bitop3_b32 v81, v81, v141, v142 bitop3:0x80
  ds_read_b64_tr_b16 v[78:79], v4 offset:15616
  v_bitop3_b32 v81, v81, v143, v144 bitop3:0x80
  buffer_load_dwordx4 v[192:195], v12, s[28:31], s48 offen offset:0
  buffer_load_dwordx4 v[196:199], v12, s[28:31], s48 offen offset:512
  buffer_load_dwordx4 v[200:203], v12, s[28:31], s48 offen offset:1024
  buffer_load_dwordx4 v[204:207], v12, s[28:31], s48 offen offset:1536
  s_waitcnt lgkmcnt(6)
  v_mfma_f32_32x32x16_bf16 v[16:31], v[64:67], v[120:123], v[16:31]
  ds_read_b64_tr_b16 v[48:49], v4 offset:16384
  v_bitop3_b32 v81, v81, v145, v146 bitop3:0x80
  ds_read_b64_tr_b16 v[50:51], v4 offset:18432
  v_bitop3_b32 v81, v81, v147, v148 bitop3:0x80
  s_waitcnt lgkmcnt(6)
  v_mfma_f32_32x32x16_bf16 v[32:47], v[68:71], v[120:123], v[32:47]
  ds_read_b64_tr_b16 v[52:53], v4 offset:16640
  v_bitop3_b32 v81, v81, v149, v150 bitop3:0x80
  ds_read_b64_tr_b16 v[54:55], v4 offset:18688
  v_bitop3_b32 v81, v81, v151, v152 bitop3:0x80
  s_waitcnt lgkmcnt(6)
  v_mfma_f32_32x32x16_bf16 v[16:31], v[72:75], v[124:127], v[16:31]
  ds_read_b64_tr_b16 v[56:57], v4 offset:17408
  v_bitop3_b32 v81, v81, v153, v154 bitop3:0x80
  ds_read_b64_tr_b16 v[58:59], v4 offset:19456
  v_bitop3_b32 v81, v81, v155, v156 bitop3:0x80
  s_waitcnt lgkmcnt(6)
  v_mfma_f32_32x32x16_bf16 v[32:47], v[76:79], v[124:127], v[32:47]
  ds_read_b64_tr_b16 v[60:61], v4 offset:17664
  v_bitop3_b32 v81, v81, v157, v158 bitop3:0x80
  ds_read_b64_tr_b16 v[62:63], v4 offset:19712
  v_bitop3_b32 v81, v81, v159, 1 bitop3:0x80
  v_cmp_eq_u32 vcc, 0, v81
  s_nop 0
  s_cmp_lg_u64 vcc, 0
  s_cbranch_scc1 K3_retry1
K3_retry1_ret:
  buffer_load_dwordx4 v[208:211], v12, s[28:31], s48 offen offset:2048
  buffer_load_dwordx4 v[212:215], v12, s[28:31], s48 offen offset:2560
  buffer_load_dwordx4 v[216:219], v12, s[28:31], s48 offen offset:3072
  buffer_load_dwordx4 v[220:223], v12, s[28:31], s48 offen offset:3584
  s_add_u32 s48, s48, 4096
  s_waitcnt lgkmcnt(6)
  v_mfma_f32_32x32x16_bf16 v[16:31], v[48:51], v[128:131], v[16:31]
  ds_read_b64_tr_b16 v[64:65], v4 offset:20480
  ds_read_b64_tr_b16 v[66:67], v4 offset:22528
  s_waitcnt lgkmcnt(6)
  v_mfma_f32_32x32x16_bf16 v[32:47], v[52:55], v[128:131], v[32:47]
  ds_read_b64_tr_b16 v[68:69], v4 offset:20736
  ds_read_b64_tr_b16 v[70:71], v4 offset:22784
  s_waitcnt lgkmcnt(6)
  v_mfma_f32_32x32x16_bf16 v[16:31], v[56:59], v[132:135], v[16:31]
  ds_read_b64_tr_b16 v[72:73], v4 offset:21504
  ds_read_b64_tr_b16 v[74:75], v4 offset:23552
  s_waitcnt lgkmcnt(6)
  v_mfma_f32_32x32x16_bf16 v[32:47], v[60:63], v[132:135], v[32:47]
  ds_read_b64_tr_b16 v[76:77], v4 offset:21760
  ds_read_b64_tr_b16 v[78:79], v4 offset:23808
  buffer_load_dwordx4 v[96:99], v12, s[28:31], s48 offen offset:0
  buffer_load_dwordx4 v[100:103], v12, s[28:31], s48 offen offset:512
  buffer_load_dwordx4 v[104:107], v12, s[28:31], s48 offen offset:1024
  buffer_load_dwordx4 v[108:111], v12, s[28:31], s48 offen offset:1536
  s_waitcnt lgkmcnt(6)
  v_mfma_f32_32x32x16_bf16 v[16:31], v[64:67], v[136:139], v[16:31]
  ds_read_b64_tr_b16 v[48:49], v4 offset:24576
  ds_read_b64_tr_b16 v[50:51], v4 offset:26624
  s_waitcnt lgkmcnt(6)
  v_mfma_f32_32x32x16_bf16 v[32:47], v[68:71], v[136:139], v[32:47]
  ds_read_b64_tr_b16 v[52:53], v4 offset:24832
  ds_read_b64_tr_b16 v[54:55], v4 offset:26880
  s_waitcnt lgkmcnt(6)
  v_mfma_f32_32x32x16_bf16 v[16:31], v[72:75], v[140:143], v[16:31]
  ds_read_b64_tr_b16 v[56:57], v4 offset:25600
  ds_read_b64_tr_b16 v[58:59], v4 offset:27648
  s_waitcnt lgkmcnt(6)
  v_mfma_f32_32x32x16_bf16 v[32:47], v[76:79], v[140:143], v[32:47]
  ds_read_b64_tr_b16 v[60:61], v4 offset:25856
  ds_read_b64_tr_b16 v[62:63], v4 offset:27904
  buffer_load_dwordx4 v[112:115], v12, s[28:31], s48 offen offset:2048
  buffer_load_dwordx4 v[116:119], v12, s[28:31], s48 offen offset:2560
  buffer_load_dwordx4 v[120:123], v12, s[28:31], s48 offen offset:3072
  buffer_load_dwordx4 v[124:127], v12, s[28:31], s48 offen offset:3584
  s_add_u32 s48, s48, 4096
  s_waitcnt vmcnt(16)
  s_waitcnt lgkmcnt(6)
  v_mfma_f32_32x32x16_bf16 v[16:31], v[48:51], v[144:147], v[16:31]
  ds_read_b64_tr_b16 v[64:65], v4 offset:28672
  v_bitop3_b32 v81, v160, v161, v162 bitop3:0x80
  ds_read_b64_tr_b16 v[66:67], v4 offset:30720
  v_bitop3_b32 v81, v81, v163, v164 bitop3:0x80
  s_waitcnt lgkmcnt(6)
  v_mfma_f32_32x32x16_bf16 v[32:47], v[52:55], v[144:147], v[32:47]
  ds_read_b64_tr_b16 v[68:69], v4 offset:28928
  v_bitop3_b32 v81, v81, v165, v166 bitop3:0x80
  ds_read_b64_tr_b16 v[70:71], v4 offset:30976
  v_bitop3_b32 v81, v81, v167, v168 bitop3:0x80
  s_waitcnt lgkmcnt(6)
  v_mfma_f32_32x32x16_bf16 v[16:31], v[56:59], v[148:151], v[16:31]
  ds_read_b64_tr_b16 v[72:73], v4 offset:29696
  v_bitop3_b32 v81, v81, v169, v170 bitop3:0x80
  ds_read_b64_tr_b16 v[74:75], v4 offset:31744
  v_bitop3_b32 v81, v81, v171, v172 bitop3:0x80
  s_waitcnt lgkmcnt(6)
  v_mfma_f32_32x32x16_bf16 v[32:47], v[60:63], v[148:151], v[32:47]
  ds_read_b64_tr_b16 v[76:77], v4 offset:29952
  v_bitop3_b32 v81, v81, v173, v174 bitop3:0x80
  ds_read_b64_tr_b16 v[78:79], v4 offset:32000
  v_bitop3_b32 v81, v81, v175, v176 bitop3:0x80
  buffer_load_dwordx4 v[128:131], v12, s[28:31], s48 offen offset:0
  buffer_load_dwordx4 v[132:135], v12, s[28:31], s48 offen offset:512
  buffer_load_dwordx4 v[136:139], v12, s[28:31], s48 offen offset:1024
  buffer_load_dwordx4 v[140:143], v12, s[28:31], s48 offen offset:1536
  s_waitcnt lgkmcnt(6)
  v_mfma_f32_32x32x16_bf16 v[16:31], v[64:67], v[152:155], v[16:31]
  ds_read_b64_tr_b16 v[48:49], v4 offset:32768
  v_bitop3_b32 v81, v81, v177, v178 bitop3:0x80
  ds_read_b64_tr_b16 v[50:51], v4 offset:34816
  v_bitop3_b32 v81, v81, v179, v180 bitop3:0x80
  s_waitcnt lgkmcnt(6)
  v_mfma_f32_32x32x16_bf16 v[32:47], v[68:71], v[152:155], v[32:47]
  ds_read_b64_tr_b16 v[52:53], v4 offset:33024
  v_bitop3_b32 v81, v81, v181, v182 bitop3:0x80
  ds_read_b64_tr_b16 v[54:55], v4 offset:35072
  v_bitop3_b32 v81, v81, v183, v184 bitop3:0x80
  s_waitcnt lgkmcnt(6)
  v_mfma_f32_32x32x16_bf16 v[16:31], v[72:75], v[156:159], v[16:31]
  ds_read_b64_tr_b16 v[56:57], v4 offset:33792
  v_bitop3_b32 v81, v81, v185, v186 bitop3:0x80
  ds_read_b64_tr_b16 v[58:59], v4 offset:35840
  v_bitop3_b32 v81, v81, v187, v188 bitop3:0x80
  s_waitcnt lgkmcnt(6)
  v_mfma_f32_32x32x16_bf16 v[32:47], v[76:79], v[156:159], v[32:47]
  ds_read_b64_tr_b16 v[60:61], v4 offset:34048
  v_bitop3_b32 v81, v81, v189, v190 bitop3:0x80
  ds_read_b64_tr_b16 v[62:63], v4 offset:36096
  v_bitop3_b32 v81, v81, v191, 1 bitop3:0x80
  v_cmp_eq_u32 vcc, 0, v81
  s_nop 0
  s_cmp_lg_u64 vcc, 0
  s_cbranch_scc1 K3_retry2
K3_retry2_ret:
  buffer_load_dwordx4 v[144:147], v12, s[28:31], s48 offen offset:2048
  buffer_load_dwordx4 v[148:151], v12, s[28:31], s48 offen offset:2560
  buffer_load_dwordx4 v[152:155], v12, s[28:31], s48 offen offset:3072
  buffer_load_dwordx4 v[156:159], v12, s[28:31], s48 offen offset:3584
  s_add_u32 s48, s48, 4096
  s_waitcnt lgkmcnt(6)
  v_mfma_f32_32x32x16_bf16 v[16:31], v[48:51], v[160:163], v[16:31]
  ds_read_b64_tr_b16 v[64:65], v4 offset:36864
  ds_read_b64_tr_b16 v[66:67], v4 offset:38912
  s_waitcnt lgkmcnt(6)
  v_mfma_f32_32x32x16_bf16 v[32:47], v[52:55], v[160:163], v[32:47]
  ds_read_b64_tr_b16 v[68:69], v4 offset:37120
  ds_read_b64_tr_b16 v[70:71], v4 offset:39168
  s_waitcnt lgkmcnt(6)
  v_mfma_f32_32x32x16_bf16 v[16:31], v[56:59], v[164:167], v[16:31]
  ds_read_b64_tr_b16 v[72:73], v4 offset:37888
  ds_read_b64_tr_b16 v[74:75], v4 offset:39936
  s_waitcnt lgkmcnt(6)
  v_mfma_f32_32x32x16_bf16 v[32:47], v[60:63], v[164:167], v[32:47]
  ds_read_b64_tr_b16 v[76:77], v4 offset:38144
  ds_read_b64_tr_b16 v[78:79], v4 offset:40192
  buffer_load_dwordx4 v[160:163], v12, s[28:31], s48 offen offset:0
  buffer_load_dwordx4 v[164:167], v12, s[28:31], s48 offen offset:512
  s_waitcnt lgkmcnt(6)
  v_mfma_f32_32x32x16_bf16 v[16:31], v[64:67], v[168:171], v[16:31]
  ds_read_b64_tr_b16 v[48:49], v4 offset:40960
  ds_read_b64_tr_b16 v[50:51], v4 offset:43008
  s_waitcnt lgkmcnt(6)
  v_mfma_f32_32x32x16_bf16 v[32:47], v[68:71], v[168:171], v[32:47]
  ds_read_b64_tr_b16 v[52:53], v4 offset:41216
  ds_read_b64_tr_b16 v[54:55], v4 offset:43264
  s_waitcnt lgkmcnt(6)
  v_mfma_f32_32x32x16_bf16 v[16:31], v[72:75], v[172:175], v[16:31]
  ds_read_b64_tr_b16 v[56:57], v4 offset:41984
  ds_read_b64_tr_b16 v[58:59], v4 offset:44032
  s_waitcnt lgkmcnt(6)
  v_mfma_f32_32x32x16_bf16 v[32:47], v[76:79], v[172:175], v[32:47]
  ds_read_b64_tr_b16 v[60:61], v4 offset:42240
  ds_read_b64_tr_b16 v[62:63], v4 offset:44288
  buffer_load_dwordx4 v[168:171], v12, s[28:31], s48 offen offset:1024
  buffer_load_dwordx4 v[172:175], v12, s[28:31], s48 offen offset:1536
  s_waitcnt vmcnt(20)
  s_waitcnt lgkmcnt(6)
  v_mfma_f32_32x32x16_bf16 v[16:31], v[48:51], v[176:179], v[16:31]
  ds_read_b64_tr_b16 v[64:65], v4 offset:45056
  v_bitop3_b32 v81, v192, v193, v194 bitop3:0x80
  ds_read_b64_tr_b16 v[66:67], v4 offset:47104
  v_bitop3_b32 v81, v81, v195, v196 bitop3:0x80
  s_waitcnt lgkmcnt(6)
  v_mfma_f32_32x32x16_bf16 v[32:47], v[52:55], v[176:179], v[32:47]
  ds_read_b64_tr_b16 v[68:69], v4 offset:45312
  v_bitop3_b32 v81, v81, v197, v198 bitop3:0x80
  ds_read_b64_tr_b16 v[70:71], v4 offset:47360
  v_bitop3_b32 v81, v81, v199, v200 bitop3:0x80
  s_waitcnt lgkmcnt(6)
  v_mfma_f32_32x32x16_bf16 v[16:31], v[56:59], v[180:183], v[16:31]
  ds_read_b64_tr_b16 v[72:73], v4 offset:46080
  v_bitop3_b32 v81, v81, v201, v202 bitop3:0x80
  ds_read_b64_tr_b16 v[74:75], v4 offset:48128
  v_bitop3_b32 v81, v81, v203, v204 bitop3:0x80
  s_waitcnt lgkmcnt(6)
  v_mfma_f32_32x32x16_bf16 v[32:47], v[60:63], v[180:183], v[32:47]
  ds_read_b64_tr_b16 v[76:77], v4 offset:46336
  v_bitop3_b32 v81, v81, v205, v206 bitop3:0x80
  ds_read_b64_tr_b16 v[78:79], v4 offset:48384
  v_bitop3_b32 v81, v81, v207, v208 bitop3:0x80
  buffer_load_dwordx4 v[176:179], v12, s[28:31], s48 offen offset:2048
  buffer_load_dwordx4 v[180:183], v12, s[28:31], s48 offen offset:2560
  s_waitcnt lgkmcnt(6)
  v_mfma_f32_32x32x16_bf16 v[16:31], v[64:67], v[184:187], v[16:31]
  ds_read_b64_tr_b16 v[48:49], v4 offset:49152
  v_bitop3_b32 v81, v81, v209, v210 bitop3:0x80
  ds_read_b64_tr_b16 v[50:51], v4 offset:51200
  v_bitop3_b32 v81, v81, v211, v212 bitop3:0x80
  s_waitcnt lgkmcnt(6)
  v_mfma_f32_32x32x16_bf16 v[32:47], v[68:71], v[184:187], v[32:47]
  ds_read_b64_tr_b16 v[52:53], v4 offset:49408
  v_bitop3_b32 v81, v81, v213, v214 bitop3:0x80
  ds_read_b64_tr_b16 v[54:55], v4 offset:51456
  v_bitop3_b32 v81, v81, v215, v216 bitop3:0x80
  s_waitcnt lgkmcnt(6)
  v_mfma_f32_32x32x16_bf16 v[16:31], v[72:75], v[188:191], v[16:31]
  ds_read_b64_tr_b16 v[56:57], v4 offset:50176
  v_bitop3_b32 v81, v81, v217, v218 bitop3:0x80
  ds_read_b64_tr_b16 v[58:59], v4 offset:52224
  v_bitop3_b32 v81, v81, v219, v220 bitop3:0x80
  s_waitcnt lgkmcnt(6)
  v_mfma_f32_32x32x16_bf16 v[32:47], v[76:79], v[188:191], v[32:47]
  ds_read_b64_tr_b16 v[60:61], v4 offset:50432
  v_bitop3_b32 v81, v81, v221, v222 bitop3:0x80
  ds_read_b64_tr_b16 v[62:63], v4 offset:52480
  v_bitop3_b32 v81, v81, v223, 1 bitop3:0x80
  v_cmp_eq_u32 vcc, 0, v81
  s_nop 0
  s_cmp_lg_u64 vcc, 0
  s_cbranch_scc1 K3_retry3
K3_retry3_ret:
  buffer_load_dwordx4 v[184:187], v12, s[28:31], s48 offen offset:3072
  buffer_load_dwordx4 v[188:191], v12, s[28:31], s48 offen offset:3584
  s_add_u32 s48, s48, 4096
  s_waitcnt lgkmcnt(6)
  v_mfma_f32_32x32x16_bf16 v[16:31], v[48:51], v[192:195], v[16:31]
  ds_read_b64_tr_b16 v[64:65], v4 offset:53248
  ds_read_b64_tr_b16 v[66:67], v4 offset:55296
  s_waitcnt lgkmcnt(6)
  v_mfma_f32_32x32x16_bf16 v[32:47], v[52:55], v[192:195], v[32:47]
  ds_read_b64_tr_b16 v[68:69], v4 offset:53504
  ds_read_b64_tr_b16 v[70:71], v4 offset:55552
  s_waitcnt lgkmcnt(6)
  v_mfma_f32_32x32x16_bf16 v[16:31], v[56:59], v[196:199], v[16:31]
  ds_read_b64_tr_b16 v[72:73], v4 offset:54272
  ds_read_b64_tr_b16 v[74:75], v4 offset:56320
  s_waitcnt lgkmcnt(6)
  v_mfma_f32_32x32x16_bf16 v[32:47], v[60:63], v[196:199], v[32:47]
  ds_read_b64_tr_b16 v[76:77], v4 offset:54528
  ds_read_b64_tr_b16 v[78:79], v4 offset:56576
  buffer_load_dwordx4 v[192:195], v12, s[28:31], s48 offen offset:0
  buffer_load_dwordx4 v[196:199], v12, s[28:31], s48 offen offset:512
  s_waitcnt lgkmcnt(6)
  v_mfma_f32_32x32x16_bf16 v[16:31], v[64:67], v[200:203], v[16:31]
  ds_read_b64_tr_b16 v[48:49], v4 offset:57344
  ds_read_b64_tr_b16 v[50:51], v4 offset:59392
  s_waitcnt lgkmcnt(6)
  v_mfma_f32_32x32x16_bf16 v[32:47], v[68:71], v[200:203], v[32:47]
  ds_read_b64_tr_b16 v[52:53], v4 offset:57600
  ds_read_b64_tr_b16 v[54:55], v4 offset:59648
  s_waitcnt lgkmcnt(6)
  v_mfma_f32_32x32x16_bf16 v[16:31], v[72:75], v[204:207], v[16:31]
  ds_read_b64_tr_b16 v[56:57], v4 offset:58368
  ds_read_b64_tr_b16 v[58:59], v4 offset:60416
  s_waitcnt lgkmcnt(6)
  v_mfma_f32_32x32x16_bf16 v[32:47], v[76:79], v[204:207], v[32:47]
  ds_read_b64_tr_b16 v[60:61], v4 offset:58624
  ds_read_b64_tr_b16 v[62:63], v4 offset:60672
  buffer_load_dwordx4 v[200:203], v12, s[28:31], s48 offen offset:1024
  buffer_load_dwordx4 v[204:207], v12, s[28:31], s48 offen offset:1536
  s_waitcnt vmcnt(20)
  s_waitcnt lgkmcnt(6)
  v_mfma_f32_32x32x16_bf16 v[16:31], v[48:51], v[208:211], v[16:31]
  ds_read_b64_tr_b16 v[64:65], v4 offset:61440
  v_bitop3_b32 v81, v96, v97, v98 bitop3:0x80
  ds_read_b64_tr_b16 v[66:67], v4 offset:63488
  v_bitop3_b32 v81, v81, v99, v100 bitop3:0x80
  s_waitcnt lgkmcnt(6)
  v_mfma_f32_32x32x16_bf16 v[32:47], v[52:55], v[208:211], v[32:47]
  ds_read_b64_tr_b16 v[68:69], v4 offset:61696
  v_bitop3_b32 v81, v81, v101, v102 bitop3:0x80
  ds_read_b64_tr_b16 v[70:71], v4 offset:63744
  v_bitop3_b32 v81, v81, v103, v104 bitop3:0x80
  s_waitcnt lgkmcnt(6)
  v_mfma_f32_32x32x16_bf16 v[16:31], v[56:59], v[212:215], v[16:31]
  ds_read_b64_tr_b16 v[72:73], v4 offset:62464
  v_bitop3_b32 v81, v81, v105, v106 bitop3:0x80
  ds_read_b64_tr_b16 v[74:75], v4 offset:64512
  v_bitop3_b32 v81, v81, v107, v108 bitop3:0x80
  s_waitcnt lgkmcnt(6)
  v_mfma_f32_32x32x16_bf16 v[32:47], v[60:63], v[212:215], v[32:47]
  ds_read_b64_tr_b16 v[76:77], v4 offset:62720
  v_bitop3_b32 v81, v81, v109, v110 bitop3:0x80
  ds_read_b64_tr_b16 v[78:79], v4 offset:64768
  v_bitop3_b32 v81, v81, v111, v112 bitop3:0x80
  buffer_load_dwordx4 v[208:211], v12, s[28:31], s48 offen offset:2048
  buffer_load_dwordx4 v[212:215], v12, s[28:31], s48 offen offset:2560
  s_waitcnt lgkmcnt(6)
  v_mfma_f32_32x32x16_bf16 v[16:31], v[64:67], v[216:219], v[16:31]
  ds_read_b64_tr_b16 v[48:49], v8 offset:0
  v_bitop3_b32 v81, v81, v113, v114 bitop3:0x80
  ds_read_b64_tr_b16 v[50:51], v8 offset:2048
  v_bitop3_b32 v81, v81, v115, v116 bitop3:0x80
  s_waitcnt lgkmcnt(6)
  v_mfma_f32_32x32x16_bf16 v[32:47], v[68:71], v[216:219], v[32:47]
  ds_read_b64_tr_b16 v[52:53], v8 offset:256
  v_bitop3_b32 v81, v81, v117, v118 bitop3:0x80
  ds_read_b64_tr_b16 v[54:55], v8 offset:2304
  v_bitop3_b32 v81, v81, v119, v120 bitop3:0x80
  s_waitcnt lgkmcnt(6)
  v_mfma_f32_32x32x16_bf16 v[16:31], v[72:75], v[220:223], v[16:31]
  ds_read_b64_tr_b16 v[56:57], v8 offset:1024
  v_bitop3_b32 v81, v81, v121, v122 bitop3:0x80
  ds_read_b64_tr_b16 v[58:59], v8 offset:3072
  v_bitop3_b32 v81, v81, v123, v124 bitop3:0x80
  s_waitcnt lgkmcnt(6)
  v_mfma_f32_32x32x16_bf16 v[32:47], v[76:79], v[220:223], v[32:47]
  ds_read_b64_tr_b16 v[60:61], v8 offset:1280
  v_bitop3_b32 v81, v81, v125, v126 bitop3:0x80
  ds_read_b64_tr_b16 v[62:63], v8 offset:3328
  v_bitop3_b32 v81, v81, v127, 1 bitop3:0x80
  v_cmp_eq_u32 vcc, 0, v81
  s_nop 0
  s_cmp_lg_u64 vcc, 0
  s_cbranch_scc1 K3_retry4
K3_retry4_ret:
  buffer_load_dwordx4 v[216:219], v12, s[28:31], s48 offen offset:3072
  buffer_load_dwordx4 v[220:223], v12, s[28:31], s48 offen offset:3584
  s_add_u32 s48, s48, 4096
  s_waitcnt lgkmcnt(6)
  v_mfma_f32_32x32x16_bf16 v[16:31], v[48:51], v[96:99], v[16:31]
  ds_read_b64_tr_b16 v[64:65], v8 offset:4096
  ds_read_b64_tr_b16 v[66:67], v8 offset:6144
  s_waitcnt lgkmcnt(6)
  v_mfma_f32_32x32x16_bf16 v[32:47], v[52:55], v[96:99], v[32:47]
  ds_read_b64_tr_b16 v[68:69], v8 offset:4352
  ds_read_b64_tr_b16 v[70:71], v8 offset:6400
  s_waitcnt lgkmcnt(6)
  v_mfma_f32_32x32x16_bf16 v[16:31], v[56:59], v[100:103], v[16:31]
  ds_read_b64_tr_b16 v[72:73], v8 offset:5120
  ds_read_b64_tr_b16 v[74:75], v8 offset:7168
  s_waitcnt lgkmcnt(6)
  v_mfma_f32_32x32x16_bf16 v[32:47], v[60:63], v[100:103], v[32:47]
  ds_read_b64_tr_b16 v[76:77], v8 offset:5376
  ds_read_b64_tr_b16 v[78:79], v8 offset:7424
  s_waitcnt lgkmcnt(6)
  v_mfma_f32_32x32x16_bf16 v[16:31], v[64:67], v[104:107], v[16:31]
  ds_read_b64_tr_b16 v[48:49], v8 offset:8192
  ds_read_b64_tr_b16 v[50:51], v8 offset:10240
  s_waitcnt lgkmcnt(6)
  v_mfma_f32_32x32x16_bf16 v[32:47], v[68:71], v[104:107], v[32:47]
  ds_read_b64_tr_b16 v[52:53], v8 offset:8448
  ds_read_b64_tr_b16 v[54:55], v8 offset:10496
  s_waitcnt lgkmcnt(6)
  v_mfma_f32_32x32x16_bf16 v[16:31], v[72:75], v[108:111], v[16:31]
  ds_read_b64_tr_b16 v[56:57], v8 offset:9216
  ds_read_b64_tr_b16 v[58:59], v8 offset:11264
  s_waitcnt lgkmcnt(6)
  v_mfma_f32_32x32x16_bf16 v[32:47], v[76:79], v[108:111], v[32:47]
  ds_read_b64_tr_b16 v[60:61], v8 offset:9472
  ds_read_b64_tr_b16 v[62:63], v8 offset:11520
  s_waitcnt vmcnt(16)
  s_waitcnt lgkmcnt(6)
  v_mfma_f32_32x32x16_bf16 v[16:31], v[48:51], v[112:115], v[16:31]
  ds_read_b64_tr_b16 v[64:65], v8 offset:12288
  v_bitop3_b32 v81, v128, v129, v130 bitop3:0x80
  ds_read_b64_tr_b16 v[66:67], v8 offset:14336
  v_bitop3_b32 v81, v81, v131, v132 bitop3:0x80
  s_waitcnt lgkmcnt(6)
  v_mfma_f32_32x32x16_bf16 v[32:47], v[52:55], v[112:115], v[32:47]
  ds_read_b64_tr_b16 v[68:69], v8 offset:12544
  v_bitop3_b32 v81, v81, v133, v134 bitop3:0x80
  ds_read_b64_tr_b16 v[70:71], v8 offset:14592
  v_bitop3_b32 v81, v81, v135, v136 bitop3:0x80
  s_waitcnt lgkmcnt(6)
  v_mfma_f32_32x32x16_bf16 v[16:31], v[56:59], v[116:119], v[16:31]
  ds_read_b64_tr_b16 v[72:73], v8 offset:13312
  v_bitop3_b32 v81, v81, v137, v138 bitop3:0x80
  ds_read_b64_tr_b16 v[74:75], v8 offset:15360
  v_bitop3_b32 v81, v81, v139, v140 bitop3:0x80
  s_waitcnt lgkmcnt(6)
  v_mfma_f32_32x32x16_bf16 v[32:47], v[60:63], v[116:119], v[32:47]
  ds_read_b64_tr_b16 v[76:77], v8 offset:13568
  v_bitop3_b32 v81, v81, v141, v142 bitop3:0x80
  ds_read_b64_tr_b16 v[78:79], v8 offset:15616
  v_bitop3_b32 v81, v81, v143, v144 bitop3:0x80
  s_waitcnt lgkmcnt(6)
  v_mfma_f32_32x32x16_bf16 v[16:31], v[64:67], v[120:123], v[16:31]
  ds_read_b64_tr_b16 v[48:49], v8 offset:16384
  v_bitop3_b32 v81, v81, v145, v146 bitop3:0x80
  ds_read_b64_tr_b16 v[50:51], v8 offset:18432
  v_bitop3_b32 v81, v81, v147, v148 bitop3:0x80
  s_waitcnt lgkmcnt(6)
  v_mfma_f32_32x32x16_bf16 v[32:47], v[68:71], v[120:123], v[32:47]
  ds_read_b64_tr_b16 v[52:53], v8 offset:16640
  v_bitop3_b32 v81, v81, v149, v150 bitop3:0x80
  ds_read_b64_tr_b16 v[54:55], v8 offset:18688
  v_bitop3_b32 v81, v81, v151, v152 bitop3:0x80
  s_waitcnt lgkmcnt(6)
  v_mfma_f32_32x32x16_bf16 v[16:31], v[72:75], v[124:127], v[16:31]
  ds_read_b64_tr_b16 v[56:57], v8 offset:17408
  v_bitop3_b32 v81, v81, v153, v154 bitop3:0x80
  ds_read_b64_tr_b16 v[58:59], v8 offset:19456
  v_bitop3_b32 v81, v81, v155, v156 bitop3:0x80
  s_waitcnt lgkmcnt(6)
  v_mfma_f32_32x32x16_bf16 v[32:47], v[76:79], v[124:127], v[32:47]
  ds_read_b64_tr_b16 v[60:61], v8 offset:17664
  v_bitop3_b32 v81, v81, v157, v158 bitop3:0x80
  ds_read_b64_tr_b16 v[62:63], v8 offset:19712
  v_bitop3_b32 v81, v81, v159, 1 bitop3:0x80
  v_cmp_eq_u32 vcc, 0, v81
  s_nop 0
  s_cmp_lg_u64 vcc, 0
  s_cbranch_scc1 K3_retry5
K3_retry5_ret:
  s_waitcnt lgkmcnt(6)
  v_mfma_f32_32x32x16_bf16 v[16:31], v[48:51], v[128:131], v[16:31]
  ds_read_b64_tr_b16 v[64:65], v8 offset:20480
  ds_read_b64_tr_b16 v[66:67], v8 offset:22528
  s_waitcnt lgkmcnt(6)
  v_mfma_f32_32x32x16_bf16 v[32:47], v[52:55], v[128:131], v[32:47]
  ds_read_b64_tr_b16 v[68:69], v8 offset:20736
  ds_read_b64_tr_b16 v[70:71], v8 offset:22784
  s_waitcnt lgkmcnt(6)
  v_mfma_f32_32x32x16_bf16 v[16:31], v[56:59], v[132:135], v[16:31]
  ds_read_b64_tr_b16 v[72:73], v8 offset:21504
  ds_read_b64_tr_b16 v[74:75], v8 offset:23552
  s_waitcnt lgkmcnt(6)
  v_mfma_f32_32x32x16_bf16 v[32:47], v[60:63], v[132:135], v[32:47]
  ds_read_b64_tr_b16 v[76:77], v8 offset:21760
  ds_read_b64_tr_b16 v[78:79], v8 offset:23808
  s_waitcnt lgkmcnt(6)
  v_mfma_f32_32x32x16_bf16 v[16:31], v[64:67], v[136:139], v[16:31]
  ds_read_b64_tr_b16 v[48:49], v8 offset:24576
  ds_read_b64_tr_b16 v[50:51], v8 offset:26624
  s_waitcnt lgkmcnt(6)
  v_mfma_f32_32x32x16_bf16 v[32:47], v[68:71], v[136:139], v[32:47]
  ds_read_b64_tr_b16 v[52:53], v8 offset:24832
  ds_read_b64_tr_b16 v[54:55], v8 offset:26880
  s_waitcnt lgkmcnt(6)
  v_mfma_f32_32x32x16_bf16 v[16:31], v[72:75], v[140:143], v[16:31]
  ds_read_b64_tr_b16 v[56:57], v8 offset:25600
  ds_read_b64_tr_b16 v[58:59], v8 offset:27648
  s_waitcnt lgkmcnt(6)
  v_mfma_f32_32x32x16_bf16 v[32:47], v[76:79], v[140:143], v[32:47]
  ds_read_b64_tr_b16 v[60:61], v8 offset:25856
  ds_read_b64_tr_b16 v[62:63], v8 offset:27904
  s_waitcnt vmcnt(8)
  s_waitcnt lgkmcnt(6)
  v_mfma_f32_32x32x16_bf16 v[16:31], v[48:51], v[144:147], v[16:31]
  ds_read_b64_tr_b16 v[64:65], v8 offset:28672
  v_bitop3_b32 v81, v160, v161, v162 bitop3:0x80
  ds_read_b64_tr_b16 v[66:67], v8 offset:30720
  v_bitop3_b32 v81, v81, v163, v164 bitop3:0x80
  s_waitcnt lgkmcnt(6)
  v_mfma_f32_32x32x16_bf16 v[32:47], v[52:55], v[144:147], v[32:47]
  ds_read_b64_tr_b16 v[68:69], v8 offset:28928
  v_bitop3_b32 v81, v81, v165, v166 bitop3:0x80
  ds_read_b64_tr_b16 v[70:71], v8 offset:30976
  v_bitop3_b32 v81, v81, v167, v168 bitop3:0x80
  s_waitcnt lgkmcnt(6)
  v_mfma_f32_32x32x16_bf16 v[16:31], v[56:59], v[148:151], v[16:31]
  ds_read_b64_tr_b16 v[72:73], v8 offset:29696
  v_bitop3_b32 v81, v81, v169, v170 bitop3:0x80
  ds_read_b64_tr_b16 v[74:75], v8 offset:31744
  v_bitop3_b32 v81, v81, v171, v172 bitop3:0x80
  s_waitcnt lgkmcnt(6)
  v_mfma_f32_32x32x16_bf16 v[32:47], v[60:63], v[148:151], v[32:47]
  ds_read_b64_tr_b16 v[76:77], v8 offset:29952
  v_bitop3_b32 v81, v81, v173, v174 bitop3:0x80
  ds_read_b64_tr_b16 v[78:79], v8 offset:32000
  v_bitop3_b32 v81, v81, v175, v176 bitop3:0x80
  s_waitcnt lgkmcnt(6)
  v_mfma_f32_32x32x16_bf16 v[16:31], v[64:67], v[152:155], v[16:31]
  ds_read_b64_tr_b16 v[48:49], v8 offset:32768
  v_bitop3_b32 v81, v81, v177, v178 bitop3:0x80
  ds_read_b64_tr_b16 v[50:51], v8 offset:34816
  v_bitop3_b32 v81, v81, v179, v180 bitop3:0x80
  s_waitcnt lgkmcnt(6)
  v_mfma_f32_32x32x16_bf16 v[32:47], v[68:71], v[152:155], v[32:47]
  ds_read_b64_tr_b16 v[52:53], v8 offset:33024
  v_bitop3_b32 v81, v81, v181, v182 bitop3:0x80
  ds_read_b64_tr_b16 v[54:55], v8 offset:35072
  v_bitop3_b32 v81, v81, v183, v184 bitop3:0x80
  s_waitcnt lgkmcnt(6)
  v_mfma_f32_32x32x16_bf16 v[16:31], v[72:75], v[156:159], v[16:31]
  ds_read_b64_tr_b16 v[56:57], v8 offset:33792
  v_bitop3_b32 v81, v81, v185, v186 bitop3:0x80
  ds_read_b64_tr_b16 v[58:59], v8 offset:35840
  v_bitop3_b32 v81, v81, v187, v188 bitop3:0x80
  s_waitcnt lgkmcnt(6)
  v_mfma_f32_32x32x16_bf16 v[32:47], v[76:79], v[156:159], v[32:47]
  ds_read_b64_tr_b16 v[60:61], v8 offset:34048
  v_bitop3_b32 v81, v81, v189, v190 bitop3:0x80
  ds_read_b64_tr_b16 v[62:63], v8 offset:36096
  v_bitop3_b32 v81, v81, v191, 1 bitop3:0x80
  v_cmp_eq_u32 vcc, 0, v81
  s_nop 0
  s_cmp_lg_u64 vcc, 0
  s_cbranch_scc1 K3_retry6
K3_retry6_ret:
  s_waitcnt lgkmcnt(6)
  v_mfma_f32_32x32x16_bf16 v[16:31], v[48:51], v[160:163], v[16:31]
  ds_read_b64_tr_b16 v[64:65], v8 offset:36864
  ds_read_b64_tr_b16 v[66:67], v8 offset:38912
  s_waitcnt lgkmcnt(6)
  v_mfma_f32_32x32x16_bf16 v[32:47], v[52:55], v[160:163], v[32:47]
  ds_read_b64_tr_b16 v[68:69], v8 offset:37120
  ds_read_b64_tr_b16 v[70:71], v8 offset:39168
  s_waitcnt lgkmcnt(6)
  v_mfma_f32_32x32x16_bf16 v[16:31], v[56:59], v[164:167], v[16:31]
  ds_read_b64_tr_b16 v[72:73], v8 offset:37888
  ds_read_b64_tr_b16 v[74:75], v8 offset:39936
  s_waitcnt lgkmcnt(6)
  v_mfma_f32_32x32x16_bf16 v[32:47], v[60:63], v[164:167], v[32:47]
  ds_read_b64_tr_b16 v[76:77], v8 offset:38144
  ds_read_b64_tr_b16 v[78:79], v8 offset:40192
  s_waitcnt lgkmcnt(6)
  v_mfma_f32_32x32x16_bf16 v[16:31], v[64:67], v[168:171], v[16:31]
  ds_read_b64_tr_b16 v[48:49], v8 offset:40960
  ds_read_b64_tr_b16 v[50:51], v8 offset:43008
  s_waitcnt lgkmcnt(6)
  v_mfma_f32_32x32x16_bf16 v[32:47], v[68:71], v[168:171], v[32:47]
  ds_read_b64_tr_b16 v[52:53], v8 offset:41216
  ds_read_b64_tr_b16 v[54:55], v8 offset:43264
  s_waitcnt lgkmcnt(6)
  v_mfma_f32_32x32x16_bf16 v[16:31], v[72:75], v[172:175], v[16:31]
  ds_read_b64_tr_b16 v[56:57], v8 offset:41984
  ds_read_b64_tr_b16 v[58:59], v8 offset:44032
  s_waitcnt lgkmcnt(6)
  v_mfma_f32_32x32x16_bf16 v[32:47], v[76:79], v[172:175], v[32:47]
  ds_read_b64_tr_b16 v[60:61], v8 offset:42240
  ds_read_b64_tr_b16 v[62:63], v8 offset:44288
  s_waitcnt vmcnt(0)
  s_waitcnt lgkmcnt(6)
  v_mfma_f32_32x32x16_bf16 v[16:31], v[48:51], v[176:179], v[16:31]
  ds_read_b64_tr_b16 v[64:65], v8 offset:45056
  v_bitop3_b32 v81, v192, v193, v194 bitop3:0x80
  ds_read_b64_tr_b16 v[66:67], v8 offset:47104
  v_bitop3_b32 v81, v81, v195, v196 bitop3:0x80
  s_waitcnt lgkmcnt(6)
  v_mfma_f32_32x32x16_bf16 v[32:47], v[52:55], v[176:179], v[32:47]
  ds_read_b64_tr_b16 v[68:69], v8 offset:45312
  v_bitop3_b32 v81, v81, v197, v198 bitop3:0x80
  ds_read_b64_tr_b16 v[70:71], v8 offset:47360
  v_bitop3_b32 v81, v81, v199, v200 bitop3:0x80
  s_waitcnt lgkmcnt(6)
  v_mfma_f32_32x32x16_bf16 v[16:31], v[56:59], v[180:183], v[16:31]
  ds_read_b64_tr_b16 v[72:73], v8 offset:46080
  v_bitop3_b32 v81, v81, v201, v202 bitop3:0x80
  ds_read_b64_tr_b16 v[74:75], v8 offset:48128
  v_bitop3_b32 v81, v81, v203, v204 bitop3:0x80
  s_waitcnt lgkmcnt(6)
  v_mfma_f32_32x32x16_bf16 v[32:47], v[60:63], v[180:183], v[32:47]
  ds_read_b64_tr_b16 v[76:77], v8 offset:46336
  v_bitop3_b32 v81, v81, v205, v206 bitop3:0x80
  ds_read_b64_tr_b16 v[78:79], v8 offset:48384
  v_bitop3_b32 v81, v81, v207, v208 bitop3:0x80
  s_waitcnt lgkmcnt(6)
  v_mfma_f32_32x32x16_bf16 v[16:31], v[64:67], v[184:187], v[16:31]
  ds_read_b64_tr_b16 v[48:49], v13 offset:0
  v_bitop3_b32 v81, v81, v209, v210 bitop3:0x80
  ds_read_b64_tr_b16 v[50:51], v13 offset:2048
  v_bitop3_b32 v81, v81, v211, v212 bitop3:0x80
  s_waitcnt lgkmcnt(6)
  v_mfma_f32_32x32x16_bf16 v[32:47], v[68:71], v[184:187], v[32:47]
  ds_read_b64_tr_b16 v[52:53], v13 offset:256
  v_bitop3_b32 v81, v81, v213, v214 bitop3:0x80
  ds_read_b64_tr_b16 v[54:55], v13 offset:2304
  v_bitop3_b32 v81, v81, v215, v216 bitop3:0x80
  s_waitcnt lgkmcnt(6)
  v_mfma_f32_32x32x16_bf16 v[16:31], v[72:75], v[188:191], v[16:31]
  ds_read_b64_tr_b16 v[56:57], v13 offset:1024
  v_bitop3_b32 v81, v81, v217, v218 bitop3:0x80
  ds_read_b64_tr_b16 v[58:59], v13 offset:3072
  v_bitop3_b32 v81, v81, v219, v220 bitop3:0x80
  s_waitcnt lgkmcnt(6)
  v_mfma_f32_32x32x16_bf16 v[32:47], v[76:79], v[188:191], v[32:47]
  ds_read_b64_tr_b16 v[60:61], v13 offset:1280
  v_bitop3_b32 v81, v81, v221, v222 bitop3:0x80
  ds_read_b64_tr_b16 v[62:63], v13 offset:3328
  v_bitop3_b32 v81, v81, v223, 1 bitop3:0x80
  v_cmp_eq_u32 vcc, 0, v81
  s_nop 0
  s_cmp_lg_u64 vcc, 0
  s_cbranch_scc1 K3_retry7
K3_retry7_ret:
  s_waitcnt lgkmcnt(6)
  v_mfma_f32_32x32x16_bf16 v[16:31], v[48:51], v[192:195], v[16:31]
  ds_read_b64_tr_b16 v[64:65], v13 offset:8704
  ds_read_b64_tr_b16 v[66:67], v13 offset:10752
  s_waitcnt lgkmcnt(6)
  v_mfma_f32_32x32x16_bf16 v[32:47], v[52:55], v[192:195], v[32:47]
  ds_read_b64_tr_b16 v[68:69], v13 offset:8960
  ds_read_b64_tr_b16 v[70:71], v13 offset:11008
  s_waitcnt lgkmcnt(6)
  v_mfma_f32_32x32x16_bf16 v[16:31], v[56:59], v[196:199], v[16:31]
  ds_read_b64_tr_b16 v[72:73], v13 offset:9728
  ds_read_b64_tr_b16 v[74:75], v13 offset:11776
  s_waitcnt lgkmcnt(6)
  v_mfma_f32_32x32x16_bf16 v[32:47], v[60:63], v[196:199], v[32:47]
  ds_read_b64_tr_b16 v[76:77], v13 offset:9984
  ds_read_b64_tr_b16 v[78:79], v13 offset:12032
  s_waitcnt lgkmcnt(6)
  v_mfma_f32_32x32x16_bf16 v[16:31], v[64:67], v[200:203], v[16:31]
  ds_read_b64_tr_b16 v[48:49], v13 offset:17408
  ds_read_b64_tr_b16 v[50:51], v13 offset:19456
  s_waitcnt lgkmcnt(6)
  v_mfma_f32_32x32x16_bf16 v[32:47], v[68:71], v[200:203], v[32:47]
  ds_read_b64_tr_b16 v[52:53], v13 offset:17664
  ds_read_b64_tr_b16 v[54:55], v13 offset:19712
  s_waitcnt lgkmcnt(6)
  v_mfma_f32_32x32x16_bf16 v[16:31], v[72:75], v[204:207], v[16:31]
  ds_read_b64_tr_b16 v[56:57], v13 offset:18432
  ds_read_b64_tr_b16 v[58:59], v13 offset:20480
  s_waitcnt lgkmcnt(6)
  v_mfma_f32_32x32x16_bf16 v[32:47], v[76:79], v[204:207], v[32:47]
  ds_read_b64_tr_b16 v[60:61], v13 offset:18688
  ds_read_b64_tr_b16 v[62:63], v13 offset:20736
  s_waitcnt lgkmcnt(6)
  v_mfma_f32_32x32x16_bf16 v[16:31], v[48:51], v[208:211], v[16:31]
  ds_read_b64_tr_b16 v[64:65], v13 offset:26112
  ds_read_b64_tr_b16 v[66:67], v13 offset:28160
  s_waitcnt lgkmcnt(6)
  v_mfma_f32_32x32x16_bf16 v[32:47], v[52:55], v[208:211], v[32:47]
  ds_read_b64_tr_b16 v[68:69], v13 offset:26368
  ds_read_b64_tr_b16 v[70:71], v13 offset:28416
  s_waitcnt lgkmcnt(6)
  v_mfma_f32_32x32x16_bf16 v[16:31], v[56:59], v[212:215], v[16:31]
  ds_read_b64_tr_b16 v[72:73], v13 offset:27136
  ds_read_b64_tr_b16 v[74:75], v13 offset:29184
  s_waitcnt lgkmcnt(6)
  v_mfma_f32_32x32x16_bf16 v[32:47], v[60:63], v[212:215], v[32:47]
  ds_read_b64_tr_b16 v[76:77], v13 offset:27392
  ds_read_b64_tr_b16 v[78:79], v13 offset:29440
  s_waitcnt lgkmcnt(6)
  v_mfma_f32_32x32x16_bf16 v[16:31], v[64:67], v[216:219], v[16:31]
  s_waitcnt lgkmcnt(4)
  v_mfma_f32_32x32x16_bf16 v[32:47], v[68:71], v[216:219], v[32:47]
  s_waitcnt lgkmcnt(2)
  v_mfma_f32_32x32x16_bf16 v[16:31], v[72:75], v[220:223], v[16:31]
  s_waitcnt lgkmcnt(0)
  v_mfma_f32_32x32x16_bf16 v[32:47], v[76:79], v[220:223], v[32:47]
  v_and_b32 v4, 31, v2
  v_lshlrev_b32 v4, 12, v4
  v_lshl_add_u32 v4, v5, 4, v4
  s_lshr_b32 s36, s10, 2
  s_lshl_b32 s36, s36, 3
  s_lshr_b32 s37, s11, 2
  s_add_u32 s36, s36, s37
  s_lshl_b32 s38, s41, 16
  s_lshl_b32 s39, s36, 7
  s_add_u32 s38, s38, s39
  s_add_u32 s38, s38, 2048
  v_cvt_pk_bf16_f32 v80, v16, v17
  v_cvt_pk_bf16_f32 v81, v18, v19
  v_cvt_pk_bf16_f32 v82, v20, v21
  v_cvt_pk_bf16_f32 v83, v22, v23
  s_nop 0
  v_permlane32_swap_b32 v80, v82
  v_permlane32_swap_b32 v81, v83
  buffer_store_dwordx4 v[80:83], v4, s[32:35], s38 offen offset:0
  v_cvt_pk_bf16_f32 v84, v24, v25
  v_cvt_pk_bf16_f32 v85, v26, v27
  v_cvt_pk_bf16_f32 v86, v28, v29
  v_cvt_pk_bf16_f32 v87, v30, v31
  s_nop 0
  v_permlane32_swap_b32 v84, v86
  v_permlane32_swap_b32 v85, v87
  buffer_store_dwordx4 v[84:87], v4, s[32:35], s38 offen offset:32
  v_cvt_pk_bf16_f32 v88, v32, v33
  v_cvt_pk_bf16_f32 v89, v34, v35
  v_cvt_pk_bf16_f32 v90, v36, v37
  v_cvt_pk_bf16_f32 v91, v38, v39
  s_nop 0
  v_permlane32_swap_b32 v88, v90
  v_permlane32_swap_b32 v89, v91
  buffer_store_dwordx4 v[88:91], v4, s[32:35], s38 offen offset:64
  v_cvt_pk_bf16_f32 v92, v40, v41
  v_cvt_pk_bf16_f32 v93, v42, v43
  v_cvt_pk_bf16_f32 v94, v44, v45
  v_cvt_pk_bf16_f32 v95, v46, v47
  s_nop 0
  v_permlane32_swap_b32 v92, v94
  v_permlane32_swap_b32 v93, v95
  buffer_store_dwordx4 v[92:95], v4, s[32:35], s38 offen offset:96
  s_endpgm
K3_retry0:
  s_mov_b32 s46, 4000
  s_add_u32 s44, s47, 0
K3_retry0_l:
  s_add_u32 s75, s75, 1
  s_sleep 4
  buffer_load_dwordx4 v[96:99], v12, s[28:31], s44 offen offset:0 sc1
  buffer_load_dwordx4 v[100:103], v12, s[28:31], s44 offen offset:512 sc1
  buffer_load_dwordx4 v[104:107], v12, s[28:31], s44 offen offset:1024 sc1
  buffer_load_dwordx4 v[108:111], v12, s[28:31], s44 offen offset:1536 sc1
  buffer_load_dwordx4 v[112:115], v12, s[28:31], s44 offen offset:2048 sc1
  buffer_load_dwordx4 v[116:119], v12, s[28:31], s44 offen offset:2560 sc1
  buffer_load_dwordx4 v[120:123], v12, s[28:31], s44 offen offset:3072 sc1
  buffer_load_dwordx4 v[124:127], v12, s[28:31], s44 offen offset:3584 sc1
  s_waitcnt vmcnt(0)
  v_bitop3_b32 v81, v96, v97, v98 bitop3:0x80
  v_bitop3_b32 v81, v81, v99, v100 bitop3:0x80
  v_bitop3_b32 v81, v81, v101, v102 bitop3:0x80
  v_bitop3_b32 v81, v81, v103, v104 bitop3:0x80
  v_bitop3_b32 v81, v81, v105, v106 bitop3:0x80
  v_bitop3_b32 v81, v81, v107, v108 bitop3:0x80
  v_bitop3_b32 v81, v81, v109, v110 bitop3:0x80
  v_bitop3_b32 v81, v81, v111, v112 bitop3:0x80
  v_bitop3_b32 v81, v81, v113, v114 bitop3:0x80
  v_bitop3_b32 v81, v81, v115, v116 bitop3:0x80
  v_bitop3_b32 v81, v81, v117, v118 bitop3:0x80
  v_bitop3_b32 v81, v81, v119, v120 bitop3:0x80
  v_bitop3_b32 v81, v81, v121, v122 bitop3:0x80
  v_bitop3_b32 v81, v81, v123, v124 bitop3:0x80
  v_bitop3_b32 v81, v81, v125, v126 bitop3:0x80
  v_bitop3_b32 v81, v81, v127, 1 bitop3:0x80
  v_cmp_eq_u32 vcc, 0, v81
  s_sub_u32 s46, s46, 1
  s_cbranch_scc1 K3_retry0_ret
  s_cmp_lg_u64 vcc, 0
  s_cbranch_scc1 K3_retry0_l
  s_branch K3_retry0_ret
K3_retry1:
  s_mov_b32 s46, 4000
  s_add_u32 s44, s47, 4096
K3_retry1_l:
  s_add_u32 s75, s75, 1
  s_sleep 4
  buffer_load_dwordx4 v[128:131], v12, s[28:31], s44 offen offset:0 sc1
  buffer_load_dwordx4 v[132:135], v12, s[28:31], s44 offen offset:512 sc1
  buffer_load_dwordx4 v[136:139], v12, s[28:31], s44 offen offset:1024 sc1
  buffer_load_dwordx4 v[140:143], v12, s[28:31], s44 offen offset:1536 sc1
  buffer_load_dwordx4 v[144:147], v12, s[28:31], s44 offen offset:2048 sc1
  buffer_load_dwordx4 v[148:151], v12, s[28:31], s44 offen offset:2560 sc1
  buffer_load_dwordx4 v[152:155], v12, s[28:31], s44 offen offset:3072 sc1
  buffer_load_dwordx4 v[156:159], v12, s[28:31], s44 offen offset:3584 sc1
  s_waitcnt vmcnt(0)
  v_bitop3_b32 v81, v128, v129, v130 bitop3:0x80
  v_bitop3_b32 v81, v81, v131, v132 bitop3:0x80
  v_bitop3_b32 v81, v81, v133, v134 bitop3:0x80
  v_bitop3_b32 v81, v81, v135, v136 bitop3:0x80
  v_bitop3_b32 v81, v81, v137, v138 bitop3:0x80
  v_bitop3_b32 v81, v81, v139, v140 bitop3:0x80
  v_bitop3_b32 v81, v81, v141, v142 bitop3:0x80
  v_bitop3_b32 v81, v81, v143, v144 bitop3:0x80
  v_bitop3_b32 v81, v81, v145, v146 bitop3:0x80
  v_bitop3_b32 v81, v81, v147, v148 bitop3:0x80
  v_bitop3_b32 v81, v81, v149, v150 bitop3:0x80
  v_bitop3_b32 v81, v81, v151, v152 bitop3:0x80
  v_bitop3_b32 v81, v81, v153, v154 bitop3:0x80
  v_bitop3_b32 v81, v81, v155, v156 bitop3:0x80
  v_bitop3_b32 v81, v81, v157, v158 bitop3:0x80
  v_bitop3_b32 v81, v81, v159, 1 bitop3:0x80
  v_cmp_eq_u32 vcc, 0, v81
  s_sub_u32 s46, s46, 1
  s_cbranch_scc1 K3_retry1_ret
  s_cmp_lg_u64 vcc, 0
  s_cbranch_scc1 K3_retry1_l
  s_branch K3_retry1_ret
K3_retry2:
  s_mov_b32 s46, 4000
  s_add_u32 s44, s47, 8192
K3_retry2_l:
  s_add_u32 s75, s75, 1
  s_sleep 4
  buffer_load_dwordx4 v[160:163], v12, s[28:31], s44 offen offset:0 sc1
  buffer_load_dwordx4 v[164:167], v12, s[28:31], s44 offen offset:512 sc1
  buffer_load_dwordx4 v[168:171], v12, s[28:31], s44 offen offset:1024 sc1
  buffer_load_dwordx4 v[172:175], v12, s[28:31], s44 offen offset:1536 sc1
  buffer_load_dwordx4 v[176:179], v12, s[28:31], s44 offen offset:2048 sc1
  buffer_load_dwordx4 v[180:183], v12, s[28:31], s44 offen offset:2560 sc1
  buffer_load_dwordx4 v[184:187], v12, s[28:31], s44 offen offset:3072 sc1
  buffer_load_dwordx4 v[188:191], v12, s[28:31], s44 offen offset:3584 sc1
  s_waitcnt vmcnt(0)
  v_bitop3_b32 v81, v160, v161, v162 bitop3:0x80
  v_bitop3_b32 v81, v81, v163, v164 bitop3:0x80
  v_bitop3_b32 v81, v81, v165, v166 bitop3:0x80
  v_bitop3_b32 v81, v81, v167, v168 bitop3:0x80
  v_bitop3_b32 v81, v81, v169, v170 bitop3:0x80
  v_bitop3_b32 v81, v81, v171, v172 bitop3:0x80
  v_bitop3_b32 v81, v81, v173, v174 bitop3:0x80
  v_bitop3_b32 v81, v81, v175, v176 bitop3:0x80
  v_bitop3_b32 v81, v81, v177, v178 bitop3:0x80
  v_bitop3_b32 v81, v81, v179, v180 bitop3:0x80
  v_bitop3_b32 v81, v81, v181, v182 bitop3:0x80
  v_bitop3_b32 v81, v81, v183, v184 bitop3:0x80
  v_bitop3_b32 v81, v81, v185, v186 bitop3:0x80
  v_bitop3_b32 v81, v81, v187, v188 bitop3:0x80
  v_bitop3_b32 v81, v81, v189, v190 bitop3:0x80
  v_bitop3_b32 v81, v81, v191, 1 bitop3:0x80
  v_cmp_eq_u32 vcc, 0, v81
  s_sub_u32 s46, s46, 1
  s_cbranch_scc1 K3_retry2_ret
  s_cmp_lg_u64 vcc, 0
  s_cbranch_scc1 K3_retry2_l
  s_branch K3_retry2_ret
K3_retry3:
  s_mov_b32 s46, 4000
  s_add_u32 s44, s47, 12288
K3_retry3_l:
  s_add_u32 s75, s75, 1
  s_sleep 4
  buffer_load_dwordx4 v[192:195], v12, s[28:31], s44 offen offset:0 sc1
  buffer_load_dwordx4 v[196:199], v12, s[28:31], s44 offen offset:512 sc1
  buffer_load_dwordx4 v[200:203], v12, s[28:31], s44 offen offset:1024 sc1
  buffer_load_dwordx4 v[204:207], v12, s[28:31], s44 offen offset:1536 sc1
  buffer_load_dwordx4 v[208:211], v12, s[28:31], s44 offen offset:2048 sc1
  buffer_load_dwordx4 v[212:215], v12, s[28:31], s44 offen offset:2560 sc1
  buffer_load_dwordx4 v[216:219], v12, s[28:31], s44 offen offset:3072 sc1
  buffer_load_dwordx4 v[220:223], v12, s[28:31], s44 offen offset:3584 sc1
  s_waitcnt vmcnt(0)
  v_bitop3_b32 v81, v192, v193, v194 bitop3:0x80
  v_bitop3_b32 v81, v81, v195, v196 bitop3:0x80
  v_bitop3_b32 v81, v81, v197, v198 bitop3:0x80
  v_bitop3_b32 v81, v81, v199, v200 bitop3:0x80
  v_bitop3_b32 v81, v81, v201, v202 bitop3:0x80
  v_bitop3_b32 v81, v81, v203, v204 bitop3:0x80
  v_bitop3_b32 v81, v81, v205, v206 bitop3:0x80
  v_bitop3_b32 v81, v81, v207, v208 bitop3:0x80
  v_bitop3_b32 v81, v81, v209, v210 bitop3:0x80
  v_bitop3_b32 v81, v81, v211, v212 bitop3:0x80
  v_bitop3_b32 v81, v81, v213, v214 bitop3:0x80
  v_bitop3_b32 v81, v81, v215, v216 bitop3:0x80
  v_bitop3_b32 v81, v81, v217, v218 bitop3:0x80
  v_bitop3_b32 v81, v81, v219, v220 bitop3:0x80
  v_bitop3_b32 v81, v81, v221, v222 bitop3:0x80
  v_bitop3_b32 v81, v81, v223, 1 bitop3:0x80
  v_cmp_eq_u32 vcc, 0, v81
  s_sub_u32 s46, s46, 1
  s_cbranch_scc1 K3_retry3_ret
  s_cmp_lg_u64 vcc, 0
  s_cbranch_scc1 K3_retry3_l
  s_branch K3_retry3_ret
K3_retry4:
  s_mov_b32 s46, 4000
  s_add_u32 s44, s47, 16384
K3_retry4_l:
  s_add_u32 s75, s75, 1
  s_sleep 4
  buffer_load_dwordx4 v[96:99], v12, s[28:31], s44 offen offset:0 sc1
  buffer_load_dwordx4 v[100:103], v12, s[28:31], s44 offen offset:512 sc1
  buffer_load_dwordx4 v[104:107], v12, s[28:31], s44 offen offset:1024 sc1
  buffer_load_dwordx4 v[108:111], v12, s[28:31], s44 offen offset:1536 sc1
  buffer_load_dwordx4 v[112:115], v12, s[28:31], s44 offen offset:2048 sc1
  buffer_load_dwordx4 v[116:119], v12, s[28:31], s44 offen offset:2560 sc1
  buffer_load_dwordx4 v[120:123], v12, s[28:31], s44 offen offset:3072 sc1
  buffer_load_dwordx4 v[124:127], v12, s[28:31], s44 offen offset:3584 sc1
  s_waitcnt vmcnt(0)
  v_bitop3_b32 v81, v96, v97, v98 bitop3:0x80
  v_bitop3_b32 v81, v81, v99, v100 bitop3:0x80
  v_bitop3_b32 v81, v81, v101, v102 bitop3:0x80
  v_bitop3_b32 v81, v81, v103, v104 bitop3:0x80
  v_bitop3_b32 v81, v81, v105, v106 bitop3:0x80
  v_bitop3_b32 v81, v81, v107, v108 bitop3:0x80
  v_bitop3_b32 v81, v81, v109, v110 bitop3:0x80
  v_bitop3_b32 v81, v81, v111, v112 bitop3:0x80
  v_bitop3_b32 v81, v81, v113, v114 bitop3:0x80
  v_bitop3_b32 v81, v81, v115, v116 bitop3:0x80
  v_bitop3_b32 v81, v81, v117, v118 bitop3:0x80
  v_bitop3_b32 v81, v81, v119, v120 bitop3:0x80
  v_bitop3_b32 v81, v81, v121, v122 bitop3:0x80
  v_bitop3_b32 v81, v81, v123, v124 bitop3:0x80
  v_bitop3_b32 v81, v81, v125, v126 bitop3:0x80
  v_bitop3_b32 v81, v81, v127, 1 bitop3:0x80
  v_cmp_eq_u32 vcc, 0, v81
  s_sub_u32 s46, s46, 1
  s_cbranch_scc1 K3_retry4_ret
  s_cmp_lg_u64 vcc, 0
  s_cbranch_scc1 K3_retry4_l
  s_branch K3_retry4_ret
K3_retry5:
  s_mov_b32 s46, 4000
  s_add_u32 s44, s47, 20480
K3_retry5_l:
  s_add_u32 s75, s75, 1
  s_sleep 4
  buffer_load_dwordx4 v[128:131], v12, s[28:31], s44 offen offset:0 sc1
  buffer_load_dwordx4 v[132:135], v12, s[28:31], s44 offen offset:512 sc1
  buffer_load_dwordx4 v[136:139], v12, s[28:31], s44 offen offset:1024 sc1
  buffer_load_dwordx4 v[140:143], v12, s[28:31], s44 offen offset:1536 sc1
  buffer_load_dwordx4 v[144:147], v12, s[28:31], s44 offen offset:2048 sc1
  buffer_load_dwordx4 v[148:151], v12, s[28:31], s44 offen offset:2560 sc1
  buffer_load_dwordx4 v[152:155], v12, s[28:31], s44 offen offset:3072 sc1
  buffer_load_dwordx4 v[156:159], v12, s[28:31], s44 offen offset:3584 sc1
  s_waitcnt vmcnt(0)
  v_bitop3_b32 v81, v128, v129, v130 bitop3:0x80
  v_bitop3_b32 v81, v81, v131, v132 bitop3:0x80
  v_bitop3_b32 v81, v81, v133, v134 bitop3:0x80
  v_bitop3_b32 v81, v81, v135, v136 bitop3:0x80
  v_bitop3_b32 v81, v81, v137, v138 bitop3:0x80
  v_bitop3_b32 v81, v81, v139, v140 bitop3:0x80
  v_bitop3_b32 v81, v81, v141, v142 bitop3:0x80
  v_bitop3_b32 v81, v81, v143, v144 bitop3:0x80
  v_bitop3_b32 v81, v81, v145, v146 bitop3:0x80
  v_bitop3_b32 v81, v81, v147, v148 bitop3:0x80
  v_bitop3_b32 v81, v81, v149, v150 bitop3:0x80
  v_bitop3_b32 v81, v81, v151, v152 bitop3:0x80
  v_bitop3_b32 v81, v81, v153, v154 bitop3:0x80
  v_bitop3_b32 v81, v81, v155, v156 bitop3:0x80
  v_bitop3_b32 v81, v81, v157, v158 bitop3:0x80
  v_bitop3_b32 v81, v81, v159, 1 bitop3:0x80
  v_cmp_eq_u32 vcc, 0, v81
  s_sub_u32 s46, s46, 1
  s_cbranch_scc1 K3_retry5_ret
  s_cmp_lg_u64 vcc, 0
  s_cbranch_scc1 K3_retry5_l
  s_branch K3_retry5_ret
K3_retry6:
  s_mov_b32 s46, 4000
  s_add_u32 s44, s47, 24576
K3_retry6_l:
  s_add_u32 s75, s75, 1
  s_sleep 4
  buffer_load_dwordx4 v[160:163], v12, s[28:31], s44 offen offset:0 sc1
  buffer_load_dwordx4 v[164:167], v12, s[28:31], s44 offen offset:512 sc1
  buffer_load_dwordx4 v[168:171], v12, s[28:31], s44 offen offset:1024 sc1
  buffer_load_dwordx4 v[172:175], v12, s[28:31], s44 offen offset:1536 sc1
  buffer_load_dwordx4 v[176:179], v12, s[28:31], s44 offen offset:2048 sc1
  buffer_load_dwordx4 v[180:183], v12, s[28:31], s44 offen offset:2560 sc1
  buffer_load_dwordx4 v[184:187], v12, s[28:31], s44 offen offset:3072 sc1
  buffer_load_dwordx4 v[188:191], v12, s[28:31], s44 offen offset:3584 sc1
  s_waitcnt vmcnt(0)
  v_bitop3_b32 v81, v160, v161, v162 bitop3:0x80
  v_bitop3_b32 v81, v81, v163, v164 bitop3:0x80
  v_bitop3_b32 v81, v81, v165, v166 bitop3:0x80
  v_bitop3_b32 v81, v81, v167, v168 bitop3:0x80
  v_bitop3_b32 v81, v81, v169, v170 bitop3:0x80
  v_bitop3_b32 v81, v81, v171, v172 bitop3:0x80
  v_bitop3_b32 v81, v81, v173, v174 bitop3:0x80
  v_bitop3_b32 v81, v81, v175, v176 bitop3:0x80
  v_bitop3_b32 v81, v81, v177, v178 bitop3:0x80
  v_bitop3_b32 v81, v81, v179, v180 bitop3:0x80
  v_bitop3_b32 v81, v81, v181, v182 bitop3:0x80
  v_bitop3_b32 v81, v81, v183, v184 bitop3:0x80
  v_bitop3_b32 v81, v81, v185, v186 bitop3:0x80
  v_bitop3_b32 v81, v81, v187, v188 bitop3:0x80
  v_bitop3_b32 v81, v81, v189, v190 bitop3:0x80
  v_bitop3_b32 v81, v81, v191, 1 bitop3:0x80
  v_cmp_eq_u32 vcc, 0, v81
  s_sub_u32 s46, s46, 1
  s_cbranch_scc1 K3_retry6_ret
  s_cmp_lg_u64 vcc, 0
  s_cbranch_scc1 K3_retry6_l
  s_branch K3_retry6_ret
K3_retry7:
  s_mov_b32 s46, 4000
  s_add_u32 s44, s47, 28672
K3_retry7_l:
  s_add_u32 s75, s75, 1
  s_sleep 4
  buffer_load_dwordx4 v[192:195], v12, s[28:31], s44 offen offset:0 sc1
  buffer_load_dwordx4 v[196:199], v12, s[28:31], s44 offen offset:512 sc1
  buffer_load_dwordx4 v[200:203], v12, s[28:31], s44 offen offset:1024 sc1
  buffer_load_dwordx4 v[204:207], v12, s[28:31], s44 offen offset:1536 sc1
  buffer_load_dwordx4 v[208:211], v12, s[28:31], s44 offen offset:2048 sc1
  buffer_load_dwordx4 v[212:215], v12, s[28:31], s44 offen offset:2560 sc1
  buffer_load_dwordx4 v[216:219], v12, s[28:31], s44 offen offset:3072 sc1
  buffer_load_dwordx4 v[220:223], v12, s[28:31], s44 offen offset:3584 sc1
  s_waitcnt vmcnt(0)
  v_bitop3_b32 v81, v192, v193, v194 bitop3:0x80
  v_bitop3_b32 v81, v81, v195, v196 bitop3:0x80
  v_bitop3_b32 v81, v81, v197, v198 bitop3:0x80
  v_bitop3_b32 v81, v81, v199, v200 bitop3:0x80
  v_bitop3_b32 v81, v81, v201, v202 bitop3:0x80
  v_bitop3_b32 v81, v81, v203, v204 bitop3:0x80
  v_bitop3_b32 v81, v81, v205, v206 bitop3:0x80
  v_bitop3_b32 v81, v81, v207, v208 bitop3:0x80
  v_bitop3_b32 v81, v81, v209, v210 bitop3:0x80
  v_bitop3_b32 v81, v81, v211, v212 bitop3:0x80
  v_bitop3_b32 v81, v81, v213, v214 bitop3:0x80
  v_bitop3_b32 v81, v81, v215, v216 bitop3:0x80
  v_bitop3_b32 v81, v81, v217, v218 bitop3:0x80
  v_bitop3_b32 v81, v81, v219, v220 bitop3:0x80
  v_bitop3_b32 v81, v81, v221, v222 bitop3:0x80
  v_bitop3_b32 v81, v81, v223, 1 bitop3:0x80
  v_cmp_eq_u32 vcc, 0, v81
  s_sub_u32 s46, s46, 1
  s_cbranch_scc1 K3_retry7_ret
  s_cmp_lg_u64 vcc, 0
  s_cbranch_scc1 K3_retry7_l
  s_branch K3_retry7_ret
K3_event0:
  s_add_u32 s54, s54, 1
  s_cmp_lg_u32 s54, 1
  s_cbranch_scc1 K3_ev2_0
  buffer_load_dword v195, v192, s[40:43], s44 offen
  s_mov_b32 s55, s52
  s_branch K3_noev0
K3_ev2_0:
  s_cmp_lg_u32 s54, 2
  s_cbranch_scc1 K3_ev3_0
  buffer_load_dword v195, v193, s[48:51], s45 offen
  s_mov_b32 s55, s53
  s_branch K3_noev0
K3_ev3_0:
  s_cmp_lg_u32 s54, 3
  s_cbranch_scc1 K3_ev4_0
  buffer_load_dword v196, v199, s[56:59], 0 offen sc1
  s_mov_b32 s55, 1
  s_branch K3_noev0
K3_ev4_0:
  s_waitcnt vmcnt(0)
  v_readfirstlane_b32 s46, v196
  s_mov_b64 exec, 1
  s_cmp_lg_u32 s46, 0
  s_cbranch_scc1 K3_ev5_0
  v_mov_b32 v196, v198
  v_mov_b32 v197, 0
  buffer_atomic_cmpswap v[196:197], v199, s[56:59], 0 offen sc0 sc1
  s_waitcnt vmcnt(0)
  v_cmp_eq_u32 vcc, 0, v196
  s_nop 1
  v_cndmask_b32 v196, v196, v198, vcc
K3_ev5_0:
  buffer_store_dword v196, v199, s[60:63], s47 offen sc1
  s_mov_b64 exec, -1
  s_mov_b32 s55, 1000
  s_branch K3_noev0
K3_event1:
  s_add_u32 s54, s54, 1
  s_cmp_lg_u32 s54, 1
  s_cbranch_scc1 K3_ev2_1
  buffer_load_dword v195, v192, s[40:43], s44 offen
  s_mov_b32 s55, s52
  s_branch K3_noev1
K3_ev2_1:
  s_cmp_lg_u32 s54, 2
  s_cbranch_scc1 K3_ev3_1
  buffer_load_dword v195, v193, s[48:51], s45 offen
  s_mov_b32 s55, s53
  s_branch K3_noev1
K3_ev3_1:
  s_cmp_lg_u32 s54, 3
  s_cbranch_scc1 K3_ev4_1
  buffer_load_dword v196, v199, s[56:59], 0 offen sc1
  s_mov_b32 s55, 1
  s_branch K3_noev1
K3_ev4_1:
  s_waitcnt vmcnt(0)
  v_readfirstlane_b32 s46, v196
  s_mov_b64 exec, 1
  s_cmp_lg_u32 s46, 0
  s_cbranch_scc1 K3_ev5_1
  v_mov_b32 v196, v198
  v_mov_b32 v197, 0
  buffer_atomic_cmpswap v[196:197], v199, s[56:59], 0 offen sc0 sc1
  s_waitcnt vmcnt(0)
  v_cmp_eq_u32 vcc, 0, v196
  s_nop 1
  v_cndmask_b32 v196, v196, v198, vcc
K3_ev5_1:
  buffer_store_dword v196, v199, s[60:63], s47 offen sc1
  s_mov_b64 exec, -1
  s_mov_b32 s55, 1000
  s_branch K3_noev1
K3_event2:
  s_add_u32 s54, s54, 1
  s_cmp_lg_u32 s54, 1
  s_cbranch_scc1 K3_ev2_2
  buffer_load_dword v195, v192, s[40:43], s44 offen
  s_mov_b32 s55, s52
  s_branch K3_noev2
K3_ev2_2:
  s_cmp_lg_u32 s54, 2
  s_cbranch_scc1 K3_ev3_2
  buffer_load_dword v195, v193, s[48:51], s45 offen
  s_mov_b32 s55, s53
  s_branch K3_noev2
K3_ev3_2:
  s_cmp_lg_u32 s54, 3
  s_cbranch_scc1 K3_ev4_2
  buffer_load_dword v196, v199, s[56:59], 0 offen sc1
  s_mov_b32 s55, 1
  s_branch K3_noev2
K3_ev4_2:
  s_waitcnt vmcnt(0)
  v_readfirstlane_b32 s46, v196
  s_mov_b64 exec, 1
  s_cmp_lg_u32 s46, 0
  s_cbranch_scc1 K3_ev5_2
  v_mov_b32 v196, v198
  v_mov_b32 v197, 0
  buffer_atomic_cmpswap v[196:197], v199, s[56:59], 0 offen sc0 sc1
  s_waitcnt vmcnt(0)
  v_cmp_eq_u32 vcc, 0, v196
  s_nop 1
  v_cndmask_b32 v196, v196, v198, vcc
K3_ev5_2:
  buffer_store_dword v196, v199, s[60:63], s47 offen sc1
  s_mov_b64 exec, -1
  s_mov_b32 s55, 1000
  s_branch K3_noev2
K3_event3:
  s_add_u32 s54, s54, 1
  s_cmp_lg_u32 s54, 1
  s_cbranch_scc1 K3_ev2_3
  buffer_load_dword v195, v192, s[40:43], s44 offen
  s_mov_b32 s55, s52
  s_branch K3_noev3
K3_ev2_3:
  s_cmp_lg_u32 s54, 2
  s_cbranch_scc1 K3_ev3_3
  buffer_load_dword v195, v193, s[48:51], s45 offen
  s_mov_b32 s55, s53
  s_branch K3_noev3
K3_ev3_3:
  s_cmp_lg_u32 s54, 3
  s_cbranch_scc1 K3_ev4_3
  buffer_load_dword v196, v199, s[56:59], 0 offen sc1
  s_mov_b32 s55, 1
  s_branch K3_noev3
K3_ev4_3:
  s_waitcnt vmcnt(0)
  v_readfirstlane_b32 s46, v196
  s_mov_b64 exec, 1
  s_cmp_lg_u32 s46, 0
  s_cbranch_scc1 K3_ev5_3
  v_mov_b32 v196, v198
  v_mov_b32 v197, 0
  buffer_atomic_cmpswap v[196:197], v199, s[56:59], 0 offen sc0 sc1
  s_waitcnt vmcnt(0)
  v_cmp_eq_u32 vcc, 0, v196
  s_nop 1
  v_cndmask_b32 v196, v196, v198, vcc
K3_ev5_3:
  buffer_store_dword v196, v199, s[60:63], s47 offen sc1
  s_mov_b64 exec, -1
  s_mov_b32 s55, 1000
  s_branch K3_noev3
K3_L:
  v_lshrrev_b32 v4, 3, v2
  v_and_b32 v5, 7, v2
  v_add_u32 v6, 0, v14
  v_xor_b32 v6, v6, v5
  v_lshlrev_b32 v6, 4, v6
  v_lshl_add_u32 v6, v4, 11, v6
  v_add_u32 v240, 0, v6
  v_add_u32 v6, 4, v14
  v_xor_b32 v6, v6, v5
  v_lshlrev_b32 v6, 4, v6
  v_lshl_add_u32 v6, v4, 11, v6
  v_add_u32 v241, 15360, v6
  v_add_u32 v6, 0, v14
  v_xor_b32 v6, v6, v5
  v_lshlrev_b32 v6, 4, v6
  v_lshl_add_u32 v6, v4, 11, v6
  v_add_u32 v242, 30720, v6
  v_add_u32 v6, 4, v14
  v_xor_b32 v6, v6, v5
  v_lshlrev_b32 v6, 4, v6
  v_lshl_add_u32 v6, v4, 11, v6
  v_add_u32 v243, 46080, v6
  v_lshrrev_b32 v6, 5, v2
  v_bfe_u32 v7, v2, 2, 2
  v_lshl_add_u32 v6, v6, 2, v7
  v_mul_u32_u24 v6, 6144, v6
  v_bfe_u32 v7, v2, 4, 1
  v_lshl_add_u32 v6, v7, 6, v6
  v_and_b32 v7, 3, v2
  v_lshl_add_u32 v6, v7, 4, v6
  v_xor_b32 v7, 32, v6
  v_add_u32 v244, 0, v6
  v_add_u32 v245, 48128, v7
  v_add_u32 v246, 0, v6
  v_add_u32 v247, 48128, v7
  v_add_u32 v248, 4096, v6
  v_add_u32 v249, 52224, v7
  s_lshl_b32 s38, s12, 7
  s_lshl_b32 s40, s4, 5
  s_add_u32 s38, s38, s40
  s_lshl_b32 s38, s38, 11
  s_mul_i32 s39, s4, 98304
  s_lshl_b32 s40, s13, 7
  s_add_u32 s39, s39, s40
  s_lshl_b32 s41, s4, 12
  s_mul_i32 s42, s4, 6144
  s_add_u32 s42, s42, 16384
  s_mov_b32 s16, s88
  s_mov_b32 s17, s89
  s_mov_b32 s18, 4194304
  s_mov_b32 s19, 0x20000
  s_mov_b32 s20, s90
  s_mov_b32 s21, s91
  s_mov_b32 s22, 6291456
  s_mov_b32 s23, 0x20000
  s_add_u32 m0, s41, 0
  s_nop 0
  buffer_load_dwordx4 v240, s[16:19], s38 offen offset:0 lds
  buffer_load_dwordx4 v241, s[16:19], s38 offen offset:1024 lds
  buffer_load_dwordx4 v242, s[16:19], s38 offen offset:2048 lds
  buffer_load_dwordx4 v243, s[16:19], s38 offen offset:3072 lds
  s_add_u32 m0, s42, 0
  s_nop 0
  buffer_load_dwordx4 v244, s[20:23], s39 offen offset:0 lds
  buffer_load_dwordx4 v245, s[20:23], s39 offen offset:1024 lds
  buffer_load_dwordx4 v246, s[20:23], s39 offen offset:2048 lds
  buffer_load_dwordx4 v247, s[20:23], s39 offen offset:3072 lds
  s_add_u32 m0, s42, 4096
  s_nop 0
  buffer_load_dwordx4 v248, s[20:23], s39 offen offset:0 lds
  buffer_load_dwordx4 v249, s[20:23], s39 offen offset:1024 lds
  s_add_u32 s38, s38, 128
  s_add_u32 s39, s39, 393216
  s_add_u32 m0, s41, 40960
  s_nop 0
  buffer_load_dwordx4 v240, s[16:19], s38 offen offset:0 lds
  buffer_load_dwordx4 v241, s[16:19], s38 offen offset:1024 lds
  buffer_load_dwordx4 v242, s[16:19], s38 offen offset:2048 lds
  buffer_load_dwordx4 v243, s[16:19], s38 offen offset:3072 lds
  s_add_u32 m0, s42, 40960
  s_nop 0
  buffer_load_dwordx4 v244, s[20:23], s39 offen offset:0 lds
  buffer_load_dwordx4 v245, s[20:23], s39 offen offset:1024 lds
  buffer_load_dwordx4 v246, s[20:23], s39 offen offset:2048 lds
  buffer_load_dwordx4 v247, s[20:23], s39 offen offset:3072 lds
  s_add_u32 m0, s42, 45056
  s_nop 0
  buffer_load_dwordx4 v248, s[20:23], s39 offen offset:0 lds
  buffer_load_dwordx4 v249, s[20:23], s39 offen offset:1024 lds
  s_add_u32 s38, s38, 128
  s_add_u32 s39, s39, 393216
  s_add_u32 m0, s41, 81920
  s_nop 0
  buffer_load_dwordx4 v240, s[16:19], s38 offen offset:0 lds
  buffer_load_dwordx4 v241, s[16:19], s38 offen offset:1024 lds
  buffer_load_dwordx4 v242, s[16:19], s38 offen offset:2048 lds
  buffer_load_dwordx4 v243, s[16:19], s38 offen offset:3072 lds
  s_add_u32 m0, s42, 81920
  s_nop 0
  buffer_load_dwordx4 v244, s[20:23], s39 offen offset:0 lds
  buffer_load_dwordx4 v245, s[20:23], s39 offen offset:1024 lds
  buffer_load_dwordx4 v246, s[20:23], s39 offen offset:2048 lds
  buffer_load_dwordx4 v247, s[20:23], s39 offen offset:3072 lds
  s_add_u32 m0, s42, 86016
  s_nop 0
  buffer_load_dwordx4 v248, s[20:23], s39 offen offset:0 lds
  buffer_load_dwordx4 v249, s[20:23], s39 offen offset:1024 lds
  s_add_u32 s38, s38, 128
  s_add_u32 s39, s39, 393216
  s_mov_b32 s24, s78
  s_mov_b32 s25, s79
  s_mov_b32 s26, 4194304
  s_mov_b32 s27, 0x20000
  s_mov_b32 s28, s80
  s_mov_b32 s29, s81
  s_mov_b32 s30, 4194304
  s_mov_b32 s31, 0x20000
  s_mov_b32 s32, s82
  s_mov_b32 s33, s83
  s_mov_b32 s34, 8192
  s_mov_b32 s35, 0x20000
  s_add_u32 s44, s98, 16777216
  s_addc_u32 s45, s99, 0
  s_mov_b32 s46, 4194304
  s_mov_b32 s47, 0x20000
  s_add_u32 s48, s98, 0
  s_addc_u32 s49, s99, 0
  s_mov_b32 s50, 4194304
  s_mov_b32 s51, 0x20000
  s_add_u32 s52, s98, 8388608
  s_addc_u32 s53, s99, 0
  s_mov_b32 s54, 2097152
  s_mov_b32 s55, 0x20000
  s_add_u32 s56, s98, 12582912
  s_addc_u32 s57, s99, 0
  s_mov_b32 s58, 65536
  s_mov_b32 s59, 0x20000
  s_lshl_b32 s60, s2, 2
  s_add_u32 s60, s60, s4
  s_and_b32 s61, s60, 15
  s_lshr_b32 s60, s60, 4
  s_lshl_b32 s62, s60, 16
  s_lshl_b32 s63, s61, 7
  s_add_u32 s62, s62, s63
  v_lshlrev_b32 v21, 14, v14
  v_lshl_add_u32 v21, v15, 3, v21
  v_add_u32 v21, s62, v21
  s_lshl_b32 s63, s61, 9
  v_lshlrev_b32 v22, 5, v15
  s_lshl_b32 s62, s61, 18
  s_lshl_b32 s64, s60, 6
  s_add_u32 s62, s62, s64
  v_lshlrev_b32 v19, 14, v15
  v_lshl_add_u32 v19, v14, 4, v19
  s_lshl_b32 s64, s12, 3
  s_lshl_b32 s65, s4, 1
  s_add_u32 s64, s64, s65
  s_lshl_b32 s64, s64, 15
  s_lshl_b32 s65, s13, 11
  s_add_u32 s64, s64, s65
  s_add_u32 s65, s64, 32768
  s_lshl_b32 s66, s5, 4
  s_add_u32 s66, s66, s12
  s_lshl_b32 s67, s66, 7
  s_lshl_b32 s66, s66, 12
  s_lshl_b32 s68, s36, 11
  s_add_u32 s66, s66, s68
  v_mov_b32 v160, 0
  v_mov_b32 v161, 0
  v_mov_b32 v162, 0
  v_mov_b32 v163, 0
  v_and_b32 v18, 7, v2
  v_lshlrev_b32 v18, 4, v18
  v_lshrrev_b32 v6, 5, v2
  v_bfe_u32 v7, v2, 2, 2
  v_lshl_add_u32 v7, v6, 2, v7
  v_lshlrev_b32 v7, 11, v7
  v_bfe_u32 v8, v2, 4, 1
  v_lshl_add_u32 v7, v8, 6, v7
  v_and_b32 v8, 3, v2
  v_lshlrev_b32 v6, 1, v6
  v_xor_b32 v8, v8, v6
  v_lshl_add_u32 v7, v8, 4, v7
  v_add_u32 v232, 0, v7
  v_add_u32 v233, 15360, v7
  v_add_u32 v234, 30720, v7
  v_add_u32 v235, 46080, v7
  s_lshl_b32 s69, s4, 16
  s_lshr_b32 s70, s10, 2
  s_lshl_b32 s70, s70, 3
  s_lshr_b32 s71, s11, 2
  s_add_u32 s70, s70, s71
  s_lshl_b32 s70, s70, 7
  s_add_u32 s69, s69, s70
  s_lshl_b32 s70, s4, 12
  s_add_u32 s70, s70, 40960
  s_lshl_b32 s71, s6, 12
  v_mov_b32 v10, 39168
  v_mov_b32 v11, 1
  s_lshl_b32 s43, s4, 2
  v_add_u32 v9, s43, v10
  s_waitcnt vmcnt(20)
  s_barrier
  s_add_u32 m0, s41, 122880
  s_nop 0
  buffer_load_dwordx4 v240, s[16:19], s38 offen offset:0 lds
  buffer_load_dwordx4 v241, s[16:19], s38 offen offset:1024 lds
  buffer_load_dwordx4 v242, s[16:19], s38 offen offset:2048 lds
  buffer_load_dwordx4 v243, s[16:19], s38 offen offset:3072 lds
  s_add_u32 m0, s42, 122880
  s_nop 0
  buffer_load_dwordx4 v244, s[20:23], s39 offen offset:0 lds
  buffer_load_dwordx4 v245, s[20:23], s39 offen offset:1024 lds
  buffer_load_dwordx4 v246, s[20:23], s39 offen offset:2048 lds
  buffer_load_dwordx4 v247, s[20:23], s39 offen offset:3072 lds
  s_add_u32 m0, s42, 126976
  s_nop 0
  buffer_load_dwordx4 v248, s[20:23], s39 offen offset:0 lds
  buffer_load_dwordx4 v249, s[20:23], s39 offen offset:1024 lds
  s_add_u32 s38, s38, 128
  s_add_u32 s39, s39, 393216
  buffer_store_dwordx4 v[160:163], v3, s[48:51], s64 offen sc1
  s_waitcnt vmcnt(21)
  s_barrier
  s_add_u32 m0, s41, 0
  s_nop 0
  buffer_load_dwordx4 v240, s[16:19], s38 offen offset:0 lds
  buffer_load_dwordx4 v241, s[16:19], s38 offen offset:1024 lds
  buffer_load_dwordx4 v242, s[16:19], s38 offen offset:2048 lds
  buffer_load_dwordx4 v243, s[16:19], s38 offen offset:3072 lds
  s_add_u32 m0, s42, 0
  s_nop 0
  buffer_load_dwordx4 v244, s[20:23], s39 offen offset:0 lds
  buffer_load_dwordx4 v245, s[20:23], s39 offen offset:1024 lds
  buffer_load_dwordx4 v246, s[20:23], s39 offen offset:2048 lds
  buffer_load_dwordx4 v247, s[20:23], s39 offen offset:3072 lds
  s_add_u32 m0, s42, 4096
  s_nop 0
  buffer_load_dwordx4 v248, s[20:23], s39 offen offset:0 lds
  buffer_load_dwordx4 v249, s[20:23], s39 offen offset:1024 lds
  s_add_u32 s38, s38, 128
  s_add_u32 s39, s39, 393216
  buffer_store_dwordx4 v[160:163], v3, s[48:51], s64 offen offset:1024 sc1
  s_waitcnt vmcnt(22)
  s_barrier
  s_add_u32 m0, s41, 40960
  s_nop 0
  buffer_load_dwordx4 v240, s[16:19], s38 offen offset:0 lds
  buffer_load_dwordx4 v241, s[16:19], s38 offen offset:1024 lds
  buffer_load_dwordx4 v242, s[16:19], s38 offen offset:2048 lds
  buffer_load_dwordx4 v243, s[16:19], s38 offen offset:3072 lds
  s_add_u32 m0, s42, 40960
  s_nop 0
  buffer_load_dwordx4 v244, s[20:23], s39 offen offset:0 lds
  buffer_load_dwordx4 v245, s[20:23], s39 offen offset:1024 lds
  buffer_load_dwordx4 v246, s[20:23], s39 offen offset:2048 lds
  buffer_load_dwordx4 v247, s[20:23], s39 offen offset:3072 lds
  s_add_u32 m0, s42, 45056
  s_nop 0
  buffer_load_dwordx4 v248, s[20:23], s39 offen offset:0 lds
  buffer_load_dwordx4 v249, s[20:23], s39 offen offset:1024 lds
  s_add_u32 s38, s38, 128
  s_add_u32 s39, s39, 393216
  buffer_store_dwordx4 v[160:163], v3, s[48:51], s65 offen sc1
  s_waitcnt vmcnt(23)
  s_barrier
  s_add_u32 m0, s41, 81920
  s_nop 0
  buffer_load_dwordx4 v240, s[16:19], s38 offen offset:0 lds
  buffer_load_dwordx4 v241, s[16:19], s38 offen offset:1024 lds
  buffer_load_dwordx4 v242, s[16:19], s38 offen offset:2048 lds
  buffer_load_dwordx4 v243, s[16:19], s38 offen offset:3072 lds
  s_add_u32 m0, s42, 81920
  s_nop 0
  buffer_load_dwordx4 v244, s[20:23], s39 offen offset:0 lds
  buffer_load_dwordx4 v245, s[20:23], s39 offen offset:1024 lds
  buffer_load_dwordx4 v246, s[20:23], s39 offen offset:2048 lds
  buffer_load_dwordx4 v247, s[20:23], s39 offen offset:3072 lds
  s_add_u32 m0, s42, 86016
  s_nop 0
  buffer_load_dwordx4 v248, s[20:23], s39 offen offset:0 lds
  buffer_load_dwordx4 v249, s[20:23], s39 offen offset:1024 lds
  s_add_u32 s38, s38, 128
  s_add_u32 s39, s39, 393216
  buffer_store_dwordx4 v[160:163], v3, s[48:51], s65 offen offset:1024 sc1
  s_waitcnt vmcnt(23)
  s_barrier
  s_add_u32 m0, s41, 122880
  s_nop 0
  buffer_load_dwordx4 v240, s[16:19], s38 offen offset:0 lds
  buffer_load_dwordx4 v241, s[16:19], s38 offen offset:1024 lds
  buffer_load_dwordx4 v242, s[16:19], s38 offen offset:2048 lds
  buffer_load_dwordx4 v243, s[16:19], s38 offen offset:3072 lds
  s_add_u32 m0, s42, 122880
  s_nop 0
  buffer_load_dwordx4 v244, s[20:23], s39 offen offset:0 lds
  buffer_load_dwordx4 v245, s[20:23], s39 offen offset:1024 lds
  buffer_load_dwordx4 v246, s[20:23], s39 offen offset:2048 lds
  buffer_load_dwordx4 v247, s[20:23], s39 offen offset:3072 lds
  s_add_u32 m0, s42, 126976
  s_nop 0
  buffer_load_dwordx4 v248, s[20:23], s39 offen offset:0 lds
  buffer_load_dwordx4 v249, s[20:23], s39 offen offset:1024 lds
  s_add_u32 s38, s38, 128
  s_add_u32 s39, s39, 393216
  buffer_store_dwordx4 v[160:163], v3, s[52:55], s66 offen sc1
  buffer_load_dwordx4 v[24:27], v22, s[32:35], s63 offen offset:0
  buffer_load_dwordx4 v[28:31], v22, s[32:35], s63 offen offset:16
  v_add_u32 v23, 4294961152, v21
  buffer_load_dwordx2 v[32:33], v23, s[24:27], 0 offen
  v_add_u32 v23, 4294963200, v21
  buffer_load_dwordx2 v[34:35], v23, s[24:27], 0 offen
  v_add_u32 v23, 4294965248, v21
  buffer_load_dwordx2 v[36:37], v23, s[24:27], 0 offen
  v_add_u32 v23, 0, v21
  buffer_load_dwordx2 v[38:39], v23, s[24:27], 0 offen
  v_add_u32 v23, 2048, v21
  buffer_load_dwordx2 v[40:41], v23, s[24:27], 0 offen
  v_add_u32 v23, 4096, v21
  buffer_load_dwordx2 v[42:43], v23, s[24:27], 0 offen
  v_add_u32 v23, 6144, v21
  buffer_load_dwordx2 v[44:45], v23, s[24:27], 0 offen
  v_add_u32 v23, 8192, v21
  buffer_load_dwordx2 v[46:47], v23, s[24:27], 0 offen
  v_add_u32 v23, 10240, v21
  buffer_load_dwordx2 v[48:49], v23, s[24:27], 0 offen
  s_waitcnt vmcnt(34)
  s_barrier
  s_add_u32 m0, s41, 0
  s_nop 0
  buffer_load_dwordx4 v240, s[16:19], s38 offen offset:0 lds
  buffer_load_dwordx4 v241, s[16:19], s38 offen offset:1024 lds
  buffer_load_dwordx4 v242, s[16:19], s38 offen offset:2048 lds
  buffer_load_dwordx4 v243, s[16:19], s38 offen offset:3072 lds
  s_add_u32 m0, s42, 0
  s_nop 0
  buffer_load_dwordx4 v244, s[20:23], s39 offen offset:0 lds
  buffer_load_dwordx4 v245, s[20:23], s39 offen offset:1024 lds
  buffer_load_dwordx4 v246, s[20:23], s39 offen offset:2048 lds
  buffer_load_dwordx4 v247, s[20:23], s39 offen offset:3072 lds
  s_add_u32 m0, s42, 4096
  s_nop 0
  buffer_load_dwordx4 v248, s[20:23], s39 offen offset:0 lds
  buffer_load_dwordx4 v249, s[20:23], s39 offen offset:1024 lds
  s_add_u32 s38, s38, 128
  s_add_u32 s39, s39, 393216
  buffer_store_dwordx4 v[160:163], v3, s[52:55], s66 offen offset:1024 sc1
  v_add_u32 v23, 12288, v21
  buffer_load_dwordx2 v[50:51], v23, s[24:27], 0 offen
  v_add_u32 v23, 14336, v21
  buffer_load_dwordx2 v[52:53], v23, s[24:27], 0 offen
  v_add_u32 v23, 0, v21
  buffer_load_dwordx2 v[54:55], v23, s[28:31], 0 offen
  v_add_u32 v23, 2048, v21
  buffer_load_dwordx2 v[56:57], v23, s[28:31], 0 offen
  v_add_u32 v23, 4096, v21
  buffer_load_dwordx2 v[58:59], v23, s[28:31], 0 offen
  v_add_u32 v23, 6144, v21
  buffer_load_dwordx2 v[60:61], v23, s[28:31], 0 offen
  v_add_u32 v23, 8192, v21
  buffer_load_dwordx2 v[62:63], v23, s[28:31], 0 offen
  v_add_u32 v23, 10240, v21
  buffer_load_dwordx2 v[64:65], v23, s[28:31], 0 offen
  v_add_u32 v23, 12288, v21
  buffer_load_dwordx2 v[66:67], v23, s[28:31], 0 offen
  v_add_u32 v23, 14336, v21
  buffer_load_dwordx2 v[68:69], v23, s[28:31], 0 offen
  s_waitcnt vmcnt(44)
  s_barrier
  s_add_u32 m0, s41, 40960
  s_nop 0
  buffer_load_dwordx4 v240, s[16:19], s38 offen offset:0 lds
  buffer_load_dwordx4 v241, s[16:19], s38 offen offset:1024 lds
  buffer_load_dwordx4 v242, s[16:19], s38 offen offset:2048 lds
  buffer_load_dwordx4 v243, s[16:19], s38 offen offset:3072 lds
  s_add_u32 m0, s42, 40960
  s_nop 0
  buffer_load_dwordx4 v244, s[20:23], s39 offen offset:0 lds
  buffer_load_dwordx4 v245, s[20:23], s39 offen offset:1024 lds
  buffer_load_dwordx4 v246, s[20:23], s39 offen offset:2048 lds
  buffer_load_dwordx4 v247, s[20:23], s39 offen offset:3072 lds
  s_add_u32 m0, s42, 45056
  s_nop 0
  buffer_load_dwordx4 v248, s[20:23], s39 offen offset:0 lds
  buffer_load_dwordx4 v249, s[20:23], s39 offen offset:1024 lds
  s_add_u32 s38, s38, 128
  s_add_u32 s39, s39, 393216
  buffer_store_dwordx4 v[160:163], v18, s[56:59], s67 offen sc1
  s_waitcnt vmcnt(11)
  v_lshlrev_b32 v72, 16, v24
  v_and_b32 v76, 0xffff0000, v24
  v_lshlrev_b32 v80, 16, v25
  v_and_b32 v84, 0xffff0000, v25
  v_lshlrev_b32 v73, 16, v26
  v_and_b32 v77, 0xffff0000, v26
  v_lshlrev_b32 v81, 16, v27
  v_and_b32 v85, 0xffff0000, v27
  v_lshlrev_b32 v74, 16, v28
  v_and_b32 v78, 0xffff0000, v28
  v_lshlrev_b32 v82, 16, v29
  v_and_b32 v86, 0xffff0000, v29
  v_lshlrev_b32 v75, 16, v30
  v_and_b32 v79, 0xffff0000, v30
  v_lshlrev_b32 v83, 16, v31
  v_and_b32 v87, 0xffff0000, v31
  v_lshlrev_b32 v88, 16, v32
  v_and_b32 v89, 0xffff0000, v32
  v_lshlrev_b32 v90, 16, v34
  v_and_b32 v91, 0xffff0000, v34
  v_lshlrev_b32 v92, 16, v36
  v_and_b32 v93, 0xffff0000, v36
  v_lshlrev_b32 v94, 16, v38
  v_and_b32 v95, 0xffff0000, v38
  v_lshlrev_b32 v96, 16, v40
  v_and_b32 v97, 0xffff0000, v40
  v_lshlrev_b32 v98, 16, v42
  v_and_b32 v99, 0xffff0000, v42
  v_lshlrev_b32 v100, 16, v44
  v_and_b32 v101, 0xffff0000, v44
  v_lshlrev_b32 v102, 16, v46
  v_and_b32 v103, 0xffff0000, v46
  v_lshlrev_b32 v104, 16, v48
  v_and_b32 v105, 0xffff0000, v48
  v_lshlrev_b32 v106, 16, v50
  v_and_b32 v107, 0xffff0000, v50
  v_lshlrev_b32 v108, 16, v52
  v_and_b32 v109, 0xffff0000, v52
  v_lshlrev_b32 v110, 16, v54
  v_and_b32 v111, 0xffff0000, v54
  v_lshlrev_b32 v112, 16, v56
  v_and_b32 v113, 0xffff0000, v56
  v_lshlrev_b32 v114, 16, v58
  v_and_b32 v115, 0xffff0000, v58
  v_lshlrev_b32 v116, 16, v60
  v_and_b32 v117, 0xffff0000, v60
  v_lshlrev_b32 v118, 16, v62
  v_and_b32 v119, 0xffff0000, v62
  v_lshlrev_b32 v120, 16, v64
  v_and_b32 v121, 0xffff0000, v64
  v_lshlrev_b32 v122, 16, v66
  v_and_b32 v123, 0xffff0000, v66
  v_lshlrev_b32 v124, 16, v68
  v_and_b32 v125, 0xffff0000, v68
  v_mul_f32 v126, v88, v84
  v_mul_f32 v127, v89, v85
  v_mul_f32 v128, v90, v84
  v_mul_f32 v129, v91, v85
  v_mul_f32 v130, v92, v84
  v_mul_f32 v131, v93, v85
  v_mul_f32 v132, v94, v84
  v_mul_f32 v133, v95, v85
  v_mul_f32 v134, v96, v84
  v_mul_f32 v135, v97, v85
  v_mul_f32 v136, v98, v84
  v_mul_f32 v137, v99, v85
  v_mul_f32 v138, v100, v84
  v_mul_f32 v139, v101, v85
  v_mul_f32 v140, v102, v84
  v_mul_f32 v141, v103, v85
  v_fmac_f32 v126, v90, v80
  v_fmac_f32 v127, v91, v81
  v_fmac_f32 v128, v92, v80
  s_barrier
  s_add_u32 m0, s41, 81920
  s_nop 0
  buffer_load_dwordx4 v240, s[16:19], s38 offen offset:0 lds
  buffer_load_dwordx4 v241, s[16:19], s38 offen offset:1024 lds
  buffer_load_dwordx4 v242, s[16:19], s38 offen offset:2048 lds
  buffer_load_dwordx4 v243, s[16:19], s38 offen offset:3072 lds
  s_add_u32 m0, s42, 81920
  s_nop 0
  buffer_load_dwordx4 v244, s[20:23], s39 offen offset:0 lds
  buffer_load_dwordx4 v245, s[20:23], s39 offen offset:1024 lds
  buffer_load_dwordx4 v246, s[20:23], s39 offen offset:2048 lds
  buffer_load_dwordx4 v247, s[20:23], s39 offen offset:3072 lds
  s_add_u32 m0, s42, 86016
  s_nop 0
  buffer_load_dwordx4 v248, s[20:23], s39 offen offset:0 lds
  buffer_load_dwordx4 v249, s[20:23], s39 offen offset:1024 lds
  s_add_u32 s38, s38, 128
  s_add_u32 s39, s39, 393216
  v_fmac_f32 v129, v93, v81
  v_fmac_f32 v130, v94, v80
  v_fmac_f32 v131, v95, v81
  v_fmac_f32 v132, v96, v80
  v_fmac_f32 v133, v97, v81
  v_fmac_f32 v134, v98, v80
  v_fmac_f32 v135, v99, v81
  v_fmac_f32 v136, v100, v80
  v_fmac_f32 v137, v101, v81
  v_fmac_f32 v138, v102, v80
  v_fmac_f32 v139, v103, v81
  v_fmac_f32 v140, v104, v80
  v_fmac_f32 v141, v105, v81
  v_fmac_f32 v126, v92, v76
  v_fmac_f32 v127, v93, v77
  v_fmac_f32 v128, v94, v76
  v_fmac_f32 v129, v95, v77
  v_fmac_f32 v130, v96, v76
  v_fmac_f32 v131, v97, v77
  v_fmac_f32 v132, v98, v76
  v_fmac_f32 v133, v99, v77
  v_fmac_f32 v134, v100, v76
  v_fmac_f32 v135, v101, v77
  v_fmac_f32 v136, v102, v76
  v_fmac_f32 v137, v103, v77
  v_fmac_f32 v138, v104, v76
  v_fmac_f32 v139, v105, v77
  v_fmac_f32 v140, v106, v76
  v_fmac_f32 v141, v107, v77
  v_fmac_f32 v126, v94, v72
  v_fmac_f32 v127, v95, v73
  v_fmac_f32 v128, v96, v72
  v_fmac_f32 v129, v97, v73
  v_fmac_f32 v130, v98, v72
  v_fmac_f32 v131, v99, v73
  v_fmac_f32 v132, v100, v72
  v_fmac_f32 v133, v101, v73
  v_fmac_f32 v134, v102, v72
  v_fmac_f32 v135, v103, v73
  v_fmac_f32 v136, v104, v72
  v_fmac_f32 v137, v105, v73
  v_fmac_f32 v138, v106, v72
  v_fmac_f32 v139, v107, v73
  v_fmac_f32 v140, v108, v72
  v_fmac_f32 v141, v109, v73
  v_mul_f32 v126, v126, v110
  v_mul_f32 v127, v127, v111
  v_mul_f32 v128, v128, v112
  v_mul_f32 v129, v129, v113
  v_mul_f32 v130, v130, v114
  v_mul_f32 v131, v131, v115
  v_mul_f32 v132, v132, v116
  v_mul_f32 v133, v133, v117
  v_mul_f32 v134, v134, v118
  v_mul_f32 v135, v135, v119
  v_mul_f32 v136, v136, v120
  v_mul_f32 v137, v137, v121
  v_mul_f32 v138, v138, v122
  v_mul_f32 v139, v139, v123
  v_mul_f32 v140, v140, v124
  v_mul_f32 v141, v141, v125
  v_cvt_pk_bf16_f32 v144, v126, v128
  v_cvt_pk_bf16_f32 v145, v130, v132
  v_cvt_pk_bf16_f32 v146, v134, v136
  v_cvt_pk_bf16_f32 v147, v138, v140
  v_cvt_pk_bf16_f32 v148, v127, v129
  v_cvt_pk_bf16_f32 v149, v131, v133
  v_cvt_pk_bf16_f32 v150, v135, v137
  v_cvt_pk_bf16_f32 v151, v139, v141
  v_and_b32 v144, -2, v144
  v_and_b32 v145, -2, v145
  v_and_b32 v146, -2, v146
  v_and_b32 v147, -2, v147
  s_barrier
  s_add_u32 m0, s41, 122880
  s_nop 0
  buffer_load_dwordx4 v240, s[16:19], s38 offen offset:0 lds
  buffer_load_dwordx4 v241, s[16:19], s38 offen offset:1024 lds
  buffer_load_dwordx4 v242, s[16:19], s38 offen offset:2048 lds
  buffer_load_dwordx4 v243, s[16:19], s38 offen offset:3072 lds
  s_add_u32 m0, s42, 122880
  s_nop 0
  buffer_load_dwordx4 v244, s[20:23], s39 offen offset:0 lds
  buffer_load_dwordx4 v245, s[20:23], s39 offen offset:1024 lds
  buffer_load_dwordx4 v246, s[20:23], s39 offen offset:2048 lds
  buffer_load_dwordx4 v247, s[20:23], s39 offen offset:3072 lds
  s_add_u32 m0, s42, 126976
  s_nop 0
  buffer_load_dwordx4 v248, s[20:23], s39 offen offset:0 lds
  buffer_load_dwordx4 v249, s[20:23], s39 offen offset:1024 lds
  s_add_u32 s38, s38, 128
  s_add_u32 s39, s39, 393216
  v_and_b32 v148, -2, v148
  v_and_b32 v149, -2, v149
  v_and_b32 v150, -2, v150
  v_and_b32 v151, -2, v151
  buffer_store_dwordx4 v[144:147], v19, s[44:47], s62 offen sc1
  s_add_u32 s62, s62, 4096
  buffer_store_dwordx4 v[148:151], v19, s[44:47], s62 offen sc1
  s_add_u32 s62, s62, 4096
  v_lshlrev_b32 v88, 16, v33
  v_and_b32 v89, 0xffff0000, v33
  v_lshlrev_b32 v90, 16, v35
  v_and_b32 v91, 0xffff0000, v35
  v_lshlrev_b32 v92, 16, v37
  v_and_b32 v93, 0xffff0000, v37
  v_lshlrev_b32 v94, 16, v39
  v_and_b32 v95, 0xffff0000, v39
  v_lshlrev_b32 v96, 16, v41
  v_and_b32 v97, 0xffff0000, v41
  v_lshlrev_b32 v98, 16, v43
  v_and_b32 v99, 0xffff0000, v43
  v_lshlrev_b32 v100, 16, v45
  v_and_b32 v101, 0xffff0000, v45
  v_lshlrev_b32 v102, 16, v47
  v_and_b32 v103, 0xffff0000, v47
  v_lshlrev_b32 v104, 16, v49
  v_and_b32 v105, 0xffff0000, v49
  v_lshlrev_b32 v106, 16, v51
  v_and_b32 v107, 0xffff0000, v51
  v_lshlrev_b32 v108, 16, v53
  v_and_b32 v109, 0xffff0000, v53
  v_lshlrev_b32 v110, 16, v55
  v_and_b32 v111, 0xffff0000, v55
  v_lshlrev_b32 v112, 16, v57
  v_and_b32 v113, 0xffff0000, v57
  v_lshlrev_b32 v114, 16, v59
  v_and_b32 v115, 0xffff0000, v59
  v_lshlrev_b32 v116, 16, v61
  v_and_b32 v117, 0xffff0000, v61
  v_lshlrev_b32 v118, 16, v63
  v_and_b32 v119, 0xffff0000, v63
  v_lshlrev_b32 v120, 16, v65
  v_and_b32 v121, 0xffff0000, v65
  v_lshlrev_b32 v122, 16, v67
  v_and_b32 v123, 0xffff0000, v67
  v_lshlrev_b32 v124, 16, v69
  v_and_b32 v125, 0xffff0000, v69
  v_mul_f32 v126, v88, v86
  v_mul_f32 v127, v89, v87
  v_mul_f32 v128, v90, v86
  v_mul_f32 v129, v91, v87
  v_mul_f32 v130, v92, v86
  v_mul_f32 v131, v93, v87
  v_mul_f32 v132, v94, v86
  v_mul_f32 v133, v95, v87
  v_mul_f32 v134, v96, v86
  v_mul_f32 v135, v97, v87
  v_mul_f32 v136, v98, v86
  v_mul_f32 v137, v99, v87
  v_mul_f32 v138, v100, v86
  v_mul_f32 v139, v101, v87
  v_mul_f32 v140, v102, v86
  v_mul_f32 v141, v103, v87
  v_fmac_f32 v126, v90, v82
  v_fmac_f32 v127, v91, v83
  v_fmac_f32 v128, v92, v82
  v_fmac_f32 v129, v93, v83
  v_fmac_f32 v130, v94, v82
  v_fmac_f32 v131, v95, v83
  v_fmac_f32 v132, v96, v82
  v_fmac_f32 v133, v97, v83
  v_fmac_f32 v134, v98, v82
  v_fmac_f32 v135, v99, v83
  v_fmac_f32 v136, v100, v82
  s_waitcnt vmcnt(23)
  s_barrier
  s_add_u32 m0, s41, 0
  s_nop 0
  buffer_load_dwordx4 v240, s[16:19], s38 offen offset:0 lds
  buffer_load_dwordx4 v241, s[16:19], s38 offen offset:1024 lds
  buffer_load_dwordx4 v242, s[16:19], s38 offen offset:2048 lds
  buffer_load_dwordx4 v243, s[16:19], s38 offen offset:3072 lds
  s_add_u32 m0, s42, 0
  s_nop 0
  buffer_load_dwordx4 v244, s[20:23], s39 offen offset:0 lds
  buffer_load_dwordx4 v245, s[20:23], s39 offen offset:1024 lds
  buffer_load_dwordx4 v246, s[20:23], s39 offen offset:2048 lds
  buffer_load_dwordx4 v247, s[20:23], s39 offen offset:3072 lds
  s_add_u32 m0, s42, 4096
  s_nop 0
  buffer_load_dwordx4 v248, s[20:23], s39 offen offset:0 lds
  buffer_load_dwordx4 v249, s[20:23], s39 offen offset:1024 lds
  s_add_u32 s38, s38, 128
  s_add_u32 s39, s39, 393216
  v_fmac_f32 v137, v101, v83
  v_fmac_f32 v138, v102, v82
  v_fmac_f32 v139, v103, v83
  v_fmac_f32 v140, v104, v82
  v_fmac_f32 v141, v105, v83
  v_fmac_f32 v126, v92, v78
  v_fmac_f32 v127, v93, v79
  v_fmac_f32 v128, v94, v78
  v_fmac_f32 v129, v95, v79
  v_fmac_f32 v130, v96, v78
  v_fmac_f32 v131, v97, v79
  v_fmac_f32 v132, v98, v78
  v_fmac_f32 v133, v99, v79
  v_fmac_f32 v134, v100, v78
  v_fmac_f32 v135, v101, v79
  v_fmac_f32 v136, v102, v78
  v_fmac_f32 v137, v103, v79
  v_fmac_f32 v138, v104, v78
  v_fmac_f32 v139, v105, v79
  v_fmac_f32 v140, v106, v78
  v_fmac_f32 v141, v107, v79
  v_fmac_f32 v126, v94, v74
  v_fmac_f32 v127, v95, v75
  v_fmac_f32 v128, v96, v74
  v_fmac_f32 v129, v97, v75
  v_fmac_f32 v130, v98, v74
  v_fmac_f32 v131, v99, v75
  v_fmac_f32 v132, v100, v74
  v_fmac_f32 v133, v101, v75
  v_fmac_f32 v134, v102, v74
  v_fmac_f32 v135, v103, v75
  v_fmac_f32 v136, v104, v74
  v_fmac_f32 v137, v105, v75
  v_fmac_f32 v138, v106, v74
  v_fmac_f32 v139, v107, v75
  v_fmac_f32 v140, v108, v74
  v_fmac_f32 v141, v109, v75
  v_mul_f32 v126, v126, v110
  v_mul_f32 v127, v127, v111
  v_mul_f32 v128, v128, v112
  v_mul_f32 v129, v129, v113
  v_mul_f32 v130, v130, v114
  v_mul_f32 v131, v131, v115
  v_mul_f32 v132, v132, v116
  v_mul_f32 v133, v133, v117
  v_mul_f32 v134, v134, v118
  v_mul_f32 v135, v135, v119
  v_mul_f32 v136, v136, v120
  v_mul_f32 v137, v137, v121
  v_mul_f32 v138, v138, v122
  v_mul_f32 v139, v139, v123
  v_mul_f32 v140, v140, v124
  v_mul_f32 v141, v141, v125
  v_cvt_pk_bf16_f32 v152, v126, v128
  v_cvt_pk_bf16_f32 v153, v130, v132
  v_cvt_pk_bf16_f32 v154, v134, v136
  v_cvt_pk_bf16_f32 v155, v138, v140
  v_cvt_pk_bf16_f32 v156, v127, v129
  v_cvt_pk_bf16_f32 v157, v131, v133
  v_cvt_pk_bf16_f32 v158, v135, v137
  v_cvt_pk_bf16_f32 v159, v139, v141
  v_and_b32 v152, -2, v152
  v_and_b32 v153, -2, v153
  v_and_b32 v154, -2, v154
  v_and_b32 v155, -2, v155
  v_and_b32 v156, -2, v156
  v_and_b32 v157, -2, v157
  v_and_b32 v158, -2, v158
  v_and_b32 v159, -2, v159
  buffer_store_dwordx4 v[152:155], v19, s[44:47], s62 offen sc1
  s_add_u32 s62, s62, 4096
  buffer_store_dwordx4 v[156:159], v19, s[44:47], s62 offen sc1
  s_add_u32 s62, s62, 4096
  s_waitcnt vmcnt(24)
  s_barrier
  s_add_u32 m0, s41, 40960
  s_nop 0
  buffer_load_dwordx4 v240, s[16:19], s38 offen offset:0 lds
  buffer_load_dwordx4 v241, s[16:19], s38 offen offset:1024 lds
  buffer_load_dwordx4 v242, s[16:19], s38 offen offset:2048 lds
  buffer_load_dwordx4 v243, s[16:19], s38 offen offset:3072 lds
  s_add_u32 m0, s42, 40960
  s_nop 0
  buffer_load_dwordx4 v244, s[20:23], s39 offen offset:0 lds
  buffer_load_dwordx4 v245, s[20:23], s39 offen offset:1024 lds
  buffer_load_dwordx4 v246, s[20:23], s39 offen offset:2048 lds
  buffer_load_dwordx4 v247, s[20:23], s39 offen offset:3072 lds
  s_add_u32 m0, s42, 45056
  s_nop 0
  buffer_load_dwordx4 v248, s[20:23], s39 offen offset:0 lds
  buffer_load_dwordx4 v249, s[20:23], s39 offen offset:1024 lds
  s_add_u32 s38, s38, 128
  s_add_u32 s39, s39, 393216
  s_waitcnt vmcnt(10)
  s_barrier
  s_add_u32 m0, s41, 81920
  s_nop 0
  buffer_load_dwordx4 v240, s[16:19], s38 offen offset:0 lds
  buffer_load_dwordx4 v241, s[16:19], s38 offen offset:1024 lds
  buffer_load_dwordx4 v242, s[16:19], s38 offen offset:2048 lds
  buffer_load_dwordx4 v243, s[16:19], s38 offen offset:3072 lds
  s_add_u32 m0, s42, 81920
  s_nop 0
  buffer_load_dwordx4 v244, s[20:23], s39 offen offset:0 lds
  buffer_load_dwordx4 v245, s[20:23], s39 offen offset:1024 lds
  buffer_load_dwordx4 v246, s[20:23], s39 offen offset:2048 lds
  buffer_load_dwordx4 v247, s[20:23], s39 offen offset:3072 lds
  s_add_u32 m0, s42, 86016
  s_nop 0
  buffer_load_dwordx4 v248, s[20:23], s39 offen offset:0 lds
  buffer_load_dwordx4 v249, s[20:23], s39 offen offset:1024 lds
  s_add_u32 s38, s38, 128
  s_add_u32 s39, s39, 393216
  s_barrier
  s_add_u32 m0, s41, 122880
  s_nop 0
  buffer_load_dwordx4 v240, s[16:19], s38 offen offset:0 lds
  buffer_load_dwordx4 v241, s[16:19], s38 offen offset:1024 lds
  buffer_load_dwordx4 v242, s[16:19], s38 offen offset:2048 lds
  buffer_load_dwordx4 v243, s[16:19], s38 offen offset:3072 lds
  s_add_u32 m0, s42, 122880
  s_nop 0
  buffer_load_dwordx4 v244, s[20:23], s39 offen offset:0 lds
  buffer_load_dwordx4 v245, s[20:23], s39 offen offset:1024 lds
  buffer_load_dwordx4 v246, s[20:23], s39 offen offset:2048 lds
  buffer_load_dwordx4 v247, s[20:23], s39 offen offset:3072 lds
  s_add_u32 m0, s42, 126976
  s_nop 0
  buffer_load_dwordx4 v248, s[20:23], s39 offen offset:0 lds
  buffer_load_dwordx4 v249, s[20:23], s39 offen offset:1024 lds
  s_add_u32 s38, s38, 128
  s_add_u32 s39, s39, 393216
  s_waitcnt vmcnt(20)
  s_barrier
  s_mov_b32 s16, s84
  s_mov_b32 s17, s85
  s_mov_b32 s18, 4194304
  s_mov_b32 s19, 0x20000
  s_mov_b32 s20, s86
  s_mov_b32 s21, s87
  s_mov_b32 s22, 2048
  s_mov_b32 s23, 0x20000
  v_mov_b32 v4, 0
  v_lshlrev_b32 v5, 2, v2
  v_add_u32 v6, 39168, v5
  ds_write_b32 v6, v4
  v_add_u32 v6, s7, v5
  ds_write_b32 v6, v4 offset:4128
  v_and_b32 v6, 7, v2
  v_lshlrev_b32 v6, 2, v6
  v_add_u32 v6, s7, v6
  ds_write_b32 v6, v4
  s_add_u32 m0, s7, 32
  s_nop 0
  buffer_load_dwordx4 v3, s[16:19], s71 offen offset:0 lds
  buffer_load_dwordx4 v3, s[16:19], s71 offen offset:1024 lds
  buffer_load_dwordx4 v3, s[16:19], s71 offen offset:2048 lds
  buffer_load_dwordx4 v3, s[16:19], s71 offen offset:3072 lds
  s_lshl_b32 s43, s6, 1
  v_mov_b32 v4, 0
  buffer_load_ushort v164, v4, s[20:23], s43 offen
  s_mov_b32 s20, s92
  s_mov_b32 s21, s93
  s_mov_b32 s22, 2097152
  s_mov_b32 s23, 0x20000
  s_waitcnt vmcnt(15)
  s_waitcnt lgkmcnt(0)
  s_barrier
  s_add_u32 m0, s70, 0
  s_nop 0
  buffer_load_dwordx4 v232, s[20:23], s69 offen offset:0 lds
  buffer_load_dwordx4 v233, s[20:23], s69 offen offset:1024 lds
  buffer_load_dwordx4 v234, s[20:23], s69 offen offset:2048 lds
  buffer_load_dwordx4 v235, s[20:23], s69 offen offset:3072 lds
  s_add_u32 s69, s69, 262144
  s_add_u32 m0, s70, 16384
  s_nop 0
  buffer_load_dwordx4 v232, s[20:23], s69 offen offset:0 lds
  buffer_load_dwordx4 v233, s[20:23], s69 offen offset:1024 lds
  buffer_load_dwordx4 v234, s[20:23], s69 offen offset:2048 lds
  buffer_load_dwordx4 v235, s[20:23], s69 offen offset:3072 lds
  s_add_u32 s69, s69, 262144
  s_waitcnt vmcnt(13)
  s_barrier
  s_add_u32 m0, s70, 32768
  s_nop 0
  buffer_load_dwordx4 v232, s[20:23], s69 offen offset:0 lds
  buffer_load_dwordx4 v233, s[20:23], s69 offen offset:1024 lds
  buffer_load_dwordx4 v234, s[20:23], s69 offen offset:2048 lds
  buffer_load_dwordx4 v235, s[20:23], s69 offen offset:3072 lds
  s_add_u32 s69, s69, 262144
  s_add_u32 m0, s70, 49152
  s_nop 0
  buffer_load_dwordx4 v232, s[20:23], s69 offen offset:0 lds
  buffer_load_dwordx4 v233, s[20:23], s69 offen offset:1024 lds
  buffer_load_dwordx4 v234, s[20:23], s69 offen offset:2048 lds
  buffer_load_dwordx4 v235, s[20:23], s69 offen offset:3072 lds
  s_add_u32 s69, s69, 262144
  s_barrier
  s_lshl_b32 s60, s10, 1
  s_lshr_b32 s61, s11, 4
  s_add_u32 s60, s60, s61
  s_and_b32 s61, s11, 15
  s_lshl_b32 s61, s61, 2
  s_add_u32 s61, s61, s4
  s_lshr_b32 s62, s61, 4
  s_and_b32 s61, s61, 15
  s_lshl_b32 s63, s62, 9
  s_lshl_b32 s64, s61, 2
  s_add_u32 s63, s63, s64
  s_lshl_b32 s64, s63, 11
  s_lshl_b32 s65, s60, 7
  s_add_u32 s64, s64, s65
  s_lshl_b32 s72, s63, 12
  s_add_u32 s72, s72, s65
  s_lshl_b32 s73, s60, 18
  s_lshl_b32 s65, s62, 10
  s_add_u32 s73, s73, s65
  s_lshl_b32 s65, s61, 6
  s_add_u32 s73, s73, s65
  s_add_u32 s65, s73, 4096
  s_add_u32 s66, s73, 8192
  s_add_u32 s67, s73, 12288
  v_lshlrev_b32 v224, 12, v14
  v_lshl_add_u32 v224, v15, 3, v224
  v_lshlrev_b32 v225, 14, v15
  v_lshl_add_u32 v225, v14, 4, v225
  s_mov_b32 s24, s96
  s_mov_b32 s25, s97
  s_mov_b32 s26, 256
  s_mov_b32 s27, 0x20000
  s_mov_b32 s28, s76
  s_mov_b32 s29, s77
  s_mov_b32 s30, 4194304
  s_mov_b32 s31, 0x20000
  s_mov_b32 s32, s94
  s_mov_b32 s33, s95
  s_mov_b32 s34, 8388608
  s_mov_b32 s35, 0x20000
  s_lshl_b32 s62, s4, 17
  s_lshl_b32 s63, s4, 16
  s_sub_u32 s63, s69, s63
  s_sub_u32 s63, s63, 1048576
  s_add_u32 s62, s62, s63
  s_add_u32 s62, s62, 1572864
  s_mov_b32 s68, 2
  s_add_u32 s74, s70, 65536
  s_mov_b32 s40, 0
  v_lshrrev_b32 v5, 1, v2
  v_lshlrev_b32 v5, 7, v5
  v_and_b32 v4, 1, v2
  v_lshl_add_u32 v5, v4, 4, v5
  v_mov_b32 v4, 0
  buffer_load_dword v16, v4, s[24:27], 0 offen sc1
  s_add_u32 s24, s98, 13631488
  s_addc_u32 s25, s99, 0
  s_mov_b32 s26, 4096
  s_mov_b32 s27, 0x20000
  s_mov_b32 s43, 4000
K3_fp:
  buffer_load_dwordx4 v[24:27], v5, s[24:27], 0 offen sc1
  s_waitcnt vmcnt(0)
  v_xor_b32 v24, v24, v16
  v_xor_b32 v25, v25, v16
  v_xor_b32 v26, v26, v16
  v_xor_b32 v27, v27, v16
  v_or3_b32 v24, v24, v25, v26
  v_or_b32 v24, v24, v27
  v_cmp_ne_u32 vcc, 0, v24
  s_sub_u32 s43, s43, 1
  s_cbranch_scc1 K3_fp_ok
  s_cmp_eq_u64 vcc, 0
  s_cbranch_scc1 K3_fp_ok
  s_add_u32 s75, s75, 1
  s_sleep 8
  s_branch K3_fp
K3_fp_ok:
  s_add_u32 m0, s7, 4384
  s_nop 0
  buffer_load_dwordx4 v3, s[44:47], s71 offen offset:0 sc1 lds
  buffer_load_dwordx4 v3, s[44:47], s71 offen offset:1024 sc1 lds
  buffer_load_dwordx4 v3, s[44:47], s71 offen offset:2048 sc1 lds
  buffer_load_dwordx4 v3, s[44:47], s71 offen offset:3072 sc1 lds
  v_mov_b32 v4, s7
  ds_read_u16 v5, v4 offset:32
  v_lshlrev_b32 v164, 16, v164
  s_waitcnt lgkmcnt(0)
  v_lshlrev_b32 v5, 16, v5
  v_add_f32 v5, v5, v164
  v_cvt_pk_bf16_f32 v5, v5, v5
  ds_write_b16 v4, v5 offset:32
  v_lshlrev_b32 v4, 11, v14
  v_lshl_add_u32 v4, v15, 3, v4
  s_waitcnt vmcnt(0)
  s_waitcnt lgkmcnt(0)
  s_mov_b64 exec, 1
  ds_add_u32 v9, v11 offset:8
  s_mov_b64 exec, -1
  s_mov_b32 s61, 131072
K3_wkvs:
  s_sleep 1
  ds_read_b32 v16, v10 offset:84
  s_waitcnt lgkmcnt(0)
  v_readfirstlane_b32 s60, v16
  s_sub_u32 s61, s61, 1
  s_cbranch_scc1 K3_wkvs_ok
  s_cmp_lt_u32 s60, 2
  s_cbranch_scc1 K3_wkvs
K3_wkvs_ok:
  buffer_load_dwordx2 v[208:209], v4, s[28:31], s64 offen
  s_add_u32 s64, s64, 131072
  buffer_load_dwordx2 v[210:211], v4, s[28:31], s64 offen
  s_add_u32 s64, s64, 131072
  buffer_load_dwordx2 v[212:213], v4, s[28:31], s64 offen
  s_add_u32 s64, s64, 131072
  buffer_load_dwordx2 v[214:215], v4, s[28:31], s64 offen
  s_add_u32 s64, s64, 131072
  buffer_load_dwordx2 v[216:217], v4, s[28:31], s64 offen
  s_add_u32 s64, s64, 131072
  buffer_load_dwordx2 v[218:219], v4, s[28:31], s64 offen
  s_add_u32 s64, s64, 131072
  buffer_load_dwordx2 v[220:221], v4, s[28:31], s64 offen
  s_add_u32 s64, s64, 131072
  buffer_load_dwordx2 v[222:223], v4, s[28:31], s64 offen
  s_add_u32 s64, s64, 131072
  v_lshlrev_b32 v7, 11, v2
  buffer_load_dword v60, v7, s[20:23], s62 offen
K3_bulk:
  s_cmp_eq_u32 s68, 0
  s_cbranch_scc1 K3_bulk_done
  s_mov_b32 m0, s74
  s_nop 0
  buffer_load_dwordx4 v232, s[20:23], s69 offen offset:0 lds
  buffer_load_dwordx4 v233, s[20:23], s69 offen offset:1024 lds
  buffer_load_dwordx4 v234, s[20:23], s69 offen offset:2048 lds
  buffer_load_dwordx4 v235, s[20:23], s69 offen offset:3072 lds
  s_add_u32 s69, s69, 262144
  s_add_u32 s74, s74, 16384
  s_sub_u32 s68, s68, 1
  s_branch K3_bulk
K3_bulk_done:
  v_lshlrev_b32 v6, 7, v15
  v_lshl_add_u32 v6, v14, 4, v6
  s_lshl_b32 s60, s5, 11
  s_lshl_b32 s61, s5, 16
  s_lshl_b32 s62, s36, 11
  s_add_u32 s61, s61, s62
  s_mov_b32 s43, 4000
K3_zp:
  buffer_load_dwordx4 v[32:35], v6, s[56:59], s60 offen offset:0 sc1
  buffer_load_dwordx4 v[36:39], v6, s[56:59], s60 offen offset:64 sc1
  ds_read_b32 v17, v9 offset:56
  s_waitcnt vmcnt(0) lgkmcnt(0)
  v_bitop3_b32 v16, v32, v33, 1 bitop3:0x80
  v_bitop3_b32 v16, v16, v34, v35 bitop3:0x80
  v_bitop3_b32 v16, v16, v36, v37 bitop3:0x80
  v_bitop3_b32 v16, v16, v38, v39 bitop3:0x80
  v_readfirstlane_b32 s41, v17
  v_cmp_eq_u32 vcc, 0, v16
  s_sub_u32 s43, s43, 1
  s_cbranch_scc1 K3_zp_ok
  s_cmp_eq_u64 vcc, 0
  s_cbranch_scc1 K3_zp_ok
  s_cmp_eq_u32 s68, 0
  s_cbranch_scc1 K3_zp_sl
  s_mov_b32 m0, s74
  s_nop 0
  buffer_load_dwordx4 v232, s[20:23], s69 offen offset:0 lds
  buffer_load_dwordx4 v233, s[20:23], s69 offen offset:1024 lds
  buffer_load_dwordx4 v234, s[20:23], s69 offen offset:2048 lds
  buffer_load_dwordx4 v235, s[20:23], s69 offen offset:3072 lds
  s_add_u32 s69, s69, 262144
  s_add_u32 s74, s74, 16384
  s_sub_u32 s68, s68, 1
  s_branch K3_zp
K3_zp_sl:
  s_cmp_lg_u32 s40, 0
  s_cbranch_scc1 K3_zp_s2
  s_cmp_lg_u32 s41, 0
  s_cbranch_scc1 K3_post
K3_zp_s2:
  s_sleep 4
  s_branch K3_zp
K3_zp_ok:
  s_setprio 2
  s_mov_b32 s43, 4000
K3_gl:
  s_mov_b32 s62, s61
  buffer_load_dwordx4 v[64:67], v3, s[52:55], s62 offen offset:0 sc1
  buffer_load_dwordx4 v[68:71], v3, s[52:55], s62 offen offset:1024 sc1
  s_add_u32 s62, s62, 4096
  buffer_load_dwordx4 v[72:75], v3, s[52:55], s62 offen offset:0 sc1
  buffer_load_dwordx4 v[76:79], v3, s[52:55], s62 offen offset:1024 sc1
  s_add_u32 s62, s62, 4096
  buffer_load_dwordx4 v[80:83], v3, s[52:55], s62 offen offset:0 sc1
  buffer_load_dwordx4 v[84:87], v3, s[52:55], s62 offen offset:1024 sc1
  s_add_u32 s62, s62, 4096
  buffer_load_dwordx4 v[88:91], v3, s[52:55], s62 offen offset:0 sc1
  buffer_load_dwordx4 v[92:95], v3, s[52:55], s62 offen offset:1024 sc1
  s_add_u32 s62, s62, 4096
  buffer_load_dwordx4 v[96:99], v3, s[52:55], s62 offen offset:0 sc1
  buffer_load_dwordx4 v[100:103], v3, s[52:55], s62 offen offset:1024 sc1
  s_add_u32 s62, s62, 4096
  buffer_load_dwordx4 v[104:107], v3, s[52:55], s62 offen offset:0 sc1
  buffer_load_dwordx4 v[108:111], v3, s[52:55], s62 offen offset:1024 sc1
  s_add_u32 s62, s62, 4096
  buffer_load_dwordx4 v[112:115], v3, s[52:55], s62 offen offset:0 sc1
  buffer_load_dwordx4 v[116:119], v3, s[52:55], s62 offen offset:1024 sc1
  s_add_u32 s62, s62, 4096
  buffer_load_dwordx4 v[120:123], v3, s[52:55], s62 offen offset:0 sc1
  buffer_load_dwordx4 v[124:127], v3, s[52:55], s62 offen offset:1024 sc1
  s_add_u32 s62, s62, 4096
  buffer_load_dwordx4 v[128:131], v3, s[52:55], s62 offen offset:0 sc1
  buffer_load_dwordx4 v[132:135], v3, s[52:55], s62 offen offset:1024 sc1
  s_add_u32 s62, s62, 4096
  buffer_load_dwordx4 v[136:139], v3, s[52:55], s62 offen offset:0 sc1
  buffer_load_dwordx4 v[140:143], v3, s[52:55], s62 offen offset:1024 sc1
  s_add_u32 s62, s62, 4096
  buffer_load_dwordx4 v[144:147], v3, s[52:55], s62 offen offset:0 sc1
  buffer_load_dwordx4 v[148:151], v3, s[52:55], s62 offen offset:1024 sc1
  s_add_u32 s62, s62, 4096
  buffer_load_dwordx4 v[152:155], v3, s[52:55], s62 offen offset:0 sc1
  buffer_load_dwordx4 v[156:159], v3, s[52:55], s62 offen offset:1024 sc1
  s_add_u32 s62, s62, 4096
  buffer_load_dwordx4 v[160:163], v3, s[52:55], s62 offen offset:0 sc1
  buffer_load_dwordx4 v[164:167], v3, s[52:55], s62 offen offset:1024 sc1
  s_add_u32 s62, s62, 4096
  buffer_load_dwordx4 v[168:171], v3, s[52:55], s62 offen offset:0 sc1
  buffer_load_dwordx4 v[172:175], v3, s[52:55], s62 offen offset:1024 sc1
  s_add_u32 s62, s62, 4096
  buffer_load_dwordx4 v[176:179], v3, s[52:55], s62 offen offset:0 sc1
  buffer_load_dwordx4 v[180:183], v3, s[52:55], s62 offen offset:1024 sc1
  s_add_u32 s62, s62, 4096
  buffer_load_dwordx4 v[184:187], v3, s[52:55], s62 offen offset:0 sc1
  buffer_load_dwordx4 v[188:191], v3, s[52:55], s62 offen offset:1024 sc1
  s_add_u32 s62, s62, 4096
  v_add_f32_dpp v40, v32, v32 row_ror:8 row_mask:0xf bank_mask:0xf
  v_add_f32_dpp v41, v33, v33 row_ror:8 row_mask:0xf bank_mask:0xf
  v_add_f32_dpp v42, v34, v34 row_ror:8 row_mask:0xf bank_mask:0xf
  v_add_f32_dpp v43, v35, v35 row_ror:8 row_mask:0xf bank_mask:0xf
  v_add_f32_dpp v44, v36, v36 row_ror:8 row_mask:0xf bank_mask:0xf
  v_add_f32_dpp v45, v37, v37 row_ror:8 row_mask:0xf bank_mask:0xf
  v_add_f32_dpp v46, v38, v38 row_ror:8 row_mask:0xf bank_mask:0xf
  v_add_f32_dpp v47, v39, v39 row_ror:8 row_mask:0xf bank_mask:0xf
  v_add_f32_dpp v40, v40, v40 row_ror:4 row_mask:0xf bank_mask:0xf
  v_add_f32_dpp v41, v41, v41 row_ror:4 row_mask:0xf bank_mask:0xf
  v_add_f32_dpp v42, v42, v42 row_ror:4 row_mask:0xf bank_mask:0xf
  v_add_f32_dpp v43, v43, v43 row_ror:4 row_mask:0xf bank_mask:0xf
  v_add_f32_dpp v44, v44, v44 row_ror:4 row_mask:0xf bank_mask:0xf
  v_add_f32_dpp v45, v45, v45 row_ror:4 row_mask:0xf bank_mask:0xf
  v_add_f32_dpp v46, v46, v46 row_ror:4 row_mask:0xf bank_mask:0xf
  v_add_f32_dpp v47, v47, v47 row_ror:4 row_mask:0xf bank_mask:0xf
  v_add_f32_dpp v40, v40, v40 row_ror:2 row_mask:0xf bank_mask:0xf
  v_add_f32_dpp v41, v41, v41 row_ror:2 row_mask:0xf bank_mask:0xf
  v_add_f32_dpp v42, v42, v42 row_ror:2 row_mask:0xf bank_mask:0xf
  v_add_f32_dpp v43, v43, v43 row_ror:2 row_mask:0xf bank_mask:0xf
  v_add_f32_dpp v44, v44, v44 row_ror:2 row_mask:0xf bank_mask:0xf
  v_add_f32_dpp v45, v45, v45 row_ror:2 row_mask:0xf bank_mask:0xf
  v_add_f32_dpp v46, v46, v46 row_ror:2 row_mask:0xf bank_mask:0xf
  v_add_f32_dpp v47, v47, v47 row_ror:2 row_mask:0xf bank_mask:0xf
  v_add_f32_dpp v40, v40, v40 row_ror:1 row_mask:0xf bank_mask:0xf
  v_add_f32_dpp v41, v41, v41 row_ror:1 row_mask:0xf bank_mask:0xf
  v_add_f32_dpp v42, v42, v42 row_ror:1 row_mask:0xf bank_mask:0xf
  v_add_f32_dpp v43, v43, v43 row_ror:1 row_mask:0xf bank_mask:0xf
  v_add_f32_dpp v44, v44, v44 row_ror:1 row_mask:0xf bank_mask:0xf
  v_add_f32_dpp v45, v45, v45 row_ror:1 row_mask:0xf bank_mask:0xf
  v_add_f32_dpp v46, v46, v46 row_ror:1 row_mask:0xf bank_mask:0xf
  v_add_f32_dpp v47, v47, v47 row_ror:1 row_mask:0xf bank_mask:0xf
  v_cvt_pk_bf16_f32 v48, v40, v41
  v_cvt_pk_bf16_f32 v49, v42, v43
  v_cvt_pk_bf16_f32 v50, v44, v45
  v_cvt_pk_bf16_f32 v51, v46, v47
  v_mov_b32 v16, 1
  s_waitcnt vmcnt(30)
  v_bitop3_b32 v16, v16, v64, v65 bitop3:0x80
  v_bitop3_b32 v16, v16, v66, v67 bitop3:0x80
  v_bitop3_b32 v16, v16, v68, v69 bitop3:0x80
  v_bitop3_b32 v16, v16, v70, v71 bitop3:0x80
  s_waitcnt vmcnt(28)
  v_bitop3_b32 v16, v16, v72, v73 bitop3:0x80
  v_bitop3_b32 v16, v16, v74, v75 bitop3:0x80
  v_bitop3_b32 v16, v16, v76, v77 bitop3:0x80
  v_bitop3_b32 v16, v16, v78, v79 bitop3:0x80
  v_add_f32 v64, v64, v72
  v_add_f32 v65, v65, v73
  v_add_f32 v66, v66, v74
  v_add_f32 v67, v67, v75
  v_add_f32 v68, v68, v76
  v_add_f32 v69, v69, v77
  v_add_f32 v70, v70, v78
  v_add_f32 v71, v71, v79
  s_waitcnt vmcnt(26)
  v_bitop3_b32 v16, v16, v80, v81 bitop3:0x80
  v_bitop3_b32 v16, v16, v82, v83 bitop3:0x80
  v_bitop3_b32 v16, v16, v84, v85 bitop3:0x80
  v_bitop3_b32 v16, v16, v86, v87 bitop3:0x80
  v_add_f32 v64, v64, v80
  v_add_f32 v65, v65, v81
  v_add_f32 v66, v66, v82
  v_add_f32 v67, v67, v83
  v_add_f32 v68, v68, v84
  v_add_f32 v69, v69, v85
  v_add_f32 v70, v70, v86
  v_add_f32 v71, v71, v87
  s_waitcnt vmcnt(24)
  v_bitop3_b32 v16, v16, v88, v89 bitop3:0x80
  v_bitop3_b32 v16, v16, v90, v91 bitop3:0x80
  v_bitop3_b32 v16, v16, v92, v93 bitop3:0x80
  v_bitop3_b32 v16, v16, v94, v95 bitop3:0x80
  v_add_f32 v64, v64, v88
  v_add_f32 v65, v65, v89
  v_add_f32 v66, v66, v90
  v_add_f32 v67, v67, v91
  v_add_f32 v68, v68, v92
  v_add_f32 v69, v69, v93
  v_add_f32 v70, v70, v94
  v_add_f32 v71, v71, v95
  s_waitcnt vmcnt(22)
  v_bitop3_b32 v16, v16, v96, v97 bitop3:0x80
  v_bitop3_b32 v16, v16, v98, v99 bitop3:0x80
  v_bitop3_b32 v16, v16, v100, v101 bitop3:0x80
  v_bitop3_b32 v16, v16, v102, v103 bitop3:0x80
  v_add_f32 v64, v64, v96
  v_add_f32 v65, v65, v97
  v_add_f32 v66, v66, v98
  v_add_f32 v67, v67, v99
  v_add_f32 v68, v68, v100
  v_add_f32 v69, v69, v101
  v_add_f32 v70, v70, v102
  v_add_f32 v71, v71, v103
  s_waitcnt vmcnt(20)
  v_bitop3_b32 v16, v16, v104, v105 bitop3:0x80
  v_bitop3_b32 v16, v16, v106, v107 bitop3:0x80
  v_bitop3_b32 v16, v16, v108, v109 bitop3:0x80
  v_bitop3_b32 v16, v16, v110, v111 bitop3:0x80
  v_add_f32 v64, v64, v104
  v_add_f32 v65, v65, v105
  v_add_f32 v66, v66, v106
  v_add_f32 v67, v67, v107
  v_add_f32 v68, v68, v108
  v_add_f32 v69, v69, v109
  v_add_f32 v70, v70, v110
  v_add_f32 v71, v71, v111
  s_waitcnt vmcnt(18)
  v_bitop3_b32 v16, v16, v112, v113 bitop3:0x80
  v_bitop3_b32 v16, v16, v114, v115 bitop3:0x80
  v_bitop3_b32 v16, v16, v116, v117 bitop3:0x80
  v_bitop3_b32 v16, v16, v118, v119 bitop3:0x80
  v_add_f32 v64, v64, v112
  v_add_f32 v65, v65, v113
  v_add_f32 v66, v66, v114
  v_add_f32 v67, v67, v115
  v_add_f32 v68, v68, v116
  v_add_f32 v69, v69, v117
  v_add_f32 v70, v70, v118
  v_add_f32 v71, v71, v119
  s_waitcnt vmcnt(16)
  v_bitop3_b32 v16, v16, v120, v121 bitop3:0x80
  v_bitop3_b32 v16, v16, v122, v123 bitop3:0x80
  v_bitop3_b32 v16, v16, v124, v125 bitop3:0x80
  v_bitop3_b32 v16, v16, v126, v127 bitop3:0x80
  v_add_f32 v64, v64, v120
  v_add_f32 v65, v65, v121
  v_add_f32 v66, v66, v122
  v_add_f32 v67, v67, v123
  v_add_f32 v68, v68, v124
  v_add_f32 v69, v69, v125
  v_add_f32 v70, v70, v126
  v_add_f32 v71, v71, v127
  s_waitcnt vmcnt(14)
  v_bitop3_b32 v16, v16, v128, v129 bitop3:0x80
  v_bitop3_b32 v16, v16, v130, v131 bitop3:0x80
  v_bitop3_b32 v16, v16, v132, v133 bitop3:0x80
  v_bitop3_b32 v16, v16, v134, v135 bitop3:0x80
  v_add_f32 v64, v64, v128
  v_add_f32 v65, v65, v129
  v_add_f32 v66, v66, v130
  v_add_f32 v67, v67, v131
  v_add_f32 v68, v68, v132
  v_add_f32 v69, v69, v133
  v_add_f32 v70, v70, v134
  v_add_f32 v71, v71, v135
  s_waitcnt vmcnt(12)
  v_bitop3_b32 v16, v16, v136, v137 bitop3:0x80
  v_bitop3_b32 v16, v16, v138, v139 bitop3:0x80
  v_bitop3_b32 v16, v16, v140, v141 bitop3:0x80
  v_bitop3_b32 v16, v16, v142, v143 bitop3:0x80
  v_add_f32 v64, v64, v136
  v_add_f32 v65, v65, v137
  v_add_f32 v66, v66, v138
  v_add_f32 v67, v67, v139
  v_add_f32 v68, v68, v140
  v_add_f32 v69, v69, v141
  v_add_f32 v70, v70, v142
  v_add_f32 v71, v71, v143
  s_waitcnt vmcnt(10)
  v_bitop3_b32 v16, v16, v144, v145 bitop3:0x80
  v_bitop3_b32 v16, v16, v146, v147 bitop3:0x80
  v_bitop3_b32 v16, v16, v148, v149 bitop3:0x80
  v_bitop3_b32 v16, v16, v150, v151 bitop3:0x80
  v_add_f32 v64, v64, v144
  v_add_f32 v65, v65, v145
  v_add_f32 v66, v66, v146
  v_add_f32 v67, v67, v147
  v_add_f32 v68, v68, v148
  v_add_f32 v69, v69, v149
  v_add_f32 v70, v70, v150
  v_add_f32 v71, v71, v151
  s_waitcnt vmcnt(8)
  v_bitop3_b32 v16, v16, v152, v153 bitop3:0x80
  v_bitop3_b32 v16, v16, v154, v155 bitop3:0x80
  v_bitop3_b32 v16, v16, v156, v157 bitop3:0x80
  v_bitop3_b32 v16, v16, v158, v159 bitop3:0x80
  v_add_f32 v64, v64, v152
  v_add_f32 v65, v65, v153
  v_add_f32 v66, v66, v154
  v_add_f32 v67, v67, v155
  v_add_f32 v68, v68, v156
  v_add_f32 v69, v69, v157
  v_add_f32 v70, v70, v158
  v_add_f32 v71, v71, v159
  s_waitcnt vmcnt(6)
  v_bitop3_b32 v16, v16, v160, v161 bitop3:0x80
  v_bitop3_b32 v16, v16, v162, v163 bitop3:0x80
  v_bitop3_b32 v16, v16, v164, v165 bitop3:0x80
  v_bitop3_b32 v16, v16, v166, v167 bitop3:0x80
  v_add_f32 v64, v64, v160
  v_add_f32 v65, v65, v161
  v_add_f32 v66, v66, v162
  v_add_f32 v67, v67, v163
  v_add_f32 v68, v68, v164
  v_add_f32 v69, v69, v165
  v_add_f32 v70, v70, v166
  v_add_f32 v71, v71, v167
  s_waitcnt vmcnt(4)
  v_bitop3_b32 v16, v16, v168, v169 bitop3:0x80
  v_bitop3_b32 v16, v16, v170, v171 bitop3:0x80
  v_bitop3_b32 v16, v16, v172, v173 bitop3:0x80
  v_bitop3_b32 v16, v16, v174, v175 bitop3:0x80
  v_add_f32 v64, v64, v168
  v_add_f32 v65, v65, v169
  v_add_f32 v66, v66, v170
  v_add_f32 v67, v67, v171
  v_add_f32 v68, v68, v172
  v_add_f32 v69, v69, v173
  v_add_f32 v70, v70, v174
  v_add_f32 v71, v71, v175
  s_waitcnt vmcnt(2)
  v_bitop3_b32 v16, v16, v176, v177 bitop3:0x80
  v_bitop3_b32 v16, v16, v178, v179 bitop3:0x80
  v_bitop3_b32 v16, v16, v180, v181 bitop3:0x80
  v_bitop3_b32 v16, v16, v182, v183 bitop3:0x80
  v_add_f32 v64, v64, v176
  v_add_f32 v65, v65, v177
  v_add_f32 v66, v66, v178
  v_add_f32 v67, v67, v179
  v_add_f32 v68, v68, v180
  v_add_f32 v69, v69, v181
  v_add_f32 v70, v70, v182
  v_add_f32 v71, v71, v183
  s_waitcnt vmcnt(0)
  v_bitop3_b32 v16, v16, v184, v185 bitop3:0x80
  v_bitop3_b32 v16, v16, v186, v187 bitop3:0x80
  v_bitop3_b32 v16, v16, v188, v189 bitop3:0x80
  v_bitop3_b32 v16, v16, v190, v191 bitop3:0x80
  v_add_f32 v64, v64, v184
  v_add_f32 v65, v65, v185
  v_add_f32 v66, v66, v186
  v_add_f32 v67, v67, v187
  v_add_f32 v68, v68, v188
  v_add_f32 v69, v69, v189
  v_add_f32 v70, v70, v190
  v_add_f32 v71, v71, v191
  v_cmp_eq_u32 vcc, 0, v16
  s_sub_u32 s43, s43, 1
  s_cbranch_scc1 K3_gl_ok
  s_cmp_eq_u64 vcc, 0
  s_cbranch_scc1 K3_gl_ok
  s_add_u32 s75, s75, 1
  s_sleep 4
  s_branch K3_gl
K3_gl_ok:
  v_cvt_pk_bf16_f32 v40, v64, v65
  v_cvt_pk_bf16_f32 v41, v66, v67
  v_cvt_pk_bf16_f32 v42, v68, v69
  v_cvt_pk_bf16_f32 v43, v70, v71
  s_lshl_b32 s43, s4, 10
  s_add_u32 s43, s43, 34816
  v_add_u32 v5, s43, v3
  ds_write_b128 v5, v[40:43]
  s_lshl_b32 s43, s37, 2
  v_add_u32 v7, s43, v10
  s_lshl_b32 s43, s37, 11
  s_add_u32 s43, s43, 34816
  v_add_u32 v5, s43, v3
  s_lshl_b32 s43, s4, 12
  s_add_u32 s43, s43, 139264
  v_add_u32 v8, s43, v3
  s_waitcnt lgkmcnt(0)
  s_mov_b64 exec, 1
  ds_add_u32 v7, v11 offset:40
  s_mov_b64 exec, -1
  s_mov_b32 s61, 131072
K3_wpq:
  ds_read_b32 v16, v9 offset:24
  s_waitcnt lgkmcnt(0)
  v_readfirstlane_b32 s60, v16
  s_sub_u32 s61, s61, 1
  s_cbranch_scc1 K3_wpq_ok
  s_cmp_lt_u32 s60, 1
  s_cbranch_scc1 K3_wpq
K3_wpq_ok:
  ds_read_b128 v[16:19], v8 offset:0
  ds_read_b128 v[20:23], v8 offset:1024
  ds_read_b128 v[24:27], v8 offset:2048
  ds_read_b128 v[28:31], v8 offset:3072
  s_mov_b32 s61, 131072
K3_wkt:
  ds_read_b32 v52, v7 offset:40
  s_waitcnt lgkmcnt(0)
  v_readfirstlane_b32 s60, v52
  s_sub_u32 s61, s61, 1
  s_cbranch_scc1 K3_wkt_ok
  s_cmp_lt_u32 s60, 2
  s_cbranch_scc1 K3_wkt
K3_wkt_ok:
  ds_read_b128 v[40:43], v5
  ds_read_b128 v[44:47], v5 offset:1024
  s_waitcnt lgkmcnt(0)
  v_mfma_f32_16x16x32_bf16 v[72:75], v[48:51], v[16:19], 0
  v_mfma_f32_16x16x32_bf16 v[64:67], v[40:43], v[16:19], 0
  v_mfma_f32_16x16x32_bf16 v[68:71], v[44:47], v[16:19], 0
  v_mfma_f32_16x16x32_bf16 v[84:87], v[48:51], v[20:23], 0
  v_mfma_f32_16x16x32_bf16 v[76:79], v[40:43], v[20:23], 0
  v_mfma_f32_16x16x32_bf16 v[80:83], v[44:47], v[20:23], 0
  v_mfma_f32_16x16x32_bf16 v[96:99], v[48:51], v[24:27], 0
  v_mfma_f32_16x16x32_bf16 v[88:91], v[40:43], v[24:27], 0
  v_mfma_f32_16x16x32_bf16 v[92:95], v[44:47], v[24:27], 0
  v_mfma_f32_16x16x32_bf16 v[108:111], v[48:51], v[28:31], 0
  v_mfma_f32_16x16x32_bf16 v[100:103], v[40:43], v[28:31], 0
  v_mfma_f32_16x16x32_bf16 v[104:107], v[44:47], v[28:31], 0
  s_lshl_b32 s60, s12, 3
  s_lshl_b32 s61, s36, 2
  s_add_u32 s60, s60, s61
  s_lshl_b32 s60, s60, 5
  s_add_u32 s60, s60, s5
  s_lshl_b32 s60, s60, 10
  s_mov_b32 s61, 897988541
  v_add_f32 v112, s61, v72
  v_rcp_f32 v112, v112
  v_add_f32 v113, s61, v84
  v_rcp_f32 v113, v113
  v_add_f32 v114, s61, v96
  v_rcp_f32 v114, v114
  v_add_f32 v115, s61, v108
  v_rcp_f32 v115, v115
  v_mul_f32 v64, v64, v112
  v_mul_f32 v65, v65, v112
  v_mul_f32 v66, v66, v112
  v_mul_f32 v67, v67, v112
  v_mul_f32 v68, v68, v112
  v_mul_f32 v69, v69, v112
  v_mul_f32 v70, v70, v112
  v_mul_f32 v71, v71, v112
  v_cvt_pk_bf16_f32 v120, v64, v65
  v_cvt_pk_bf16_f32 v121, v66, v67
  v_cvt_pk_bf16_f32 v122, v68, v69
  v_cvt_pk_bf16_f32 v123, v70, v71
  v_or_b32 v120, 1, v120
  v_or_b32 v121, 1, v121
  v_or_b32 v122, 1, v122
  v_or_b32 v123, 1, v123
  buffer_store_dwordx4 v[120:123], v3, s[48:51], s60 offen sc1
  s_add_u32 s60, s60, 32768
  v_mul_f32 v76, v76, v113
  v_mul_f32 v77, v77, v113
  v_mul_f32 v78, v78, v113
  v_mul_f32 v79, v79, v113
  v_mul_f32 v80, v80, v113
  v_mul_f32 v81, v81, v113
  v_mul_f32 v82, v82, v113
  v_mul_f32 v83, v83, v113
  v_cvt_pk_bf16_f32 v124, v76, v77
  v_cvt_pk_bf16_f32 v125, v78, v79
  v_cvt_pk_bf16_f32 v126, v80, v81
  v_cvt_pk_bf16_f32 v127, v82, v83
  v_or_b32 v124, 1, v124
  v_or_b32 v125, 1, v125
  v_or_b32 v126, 1, v126
  v_or_b32 v127, 1, v127
  buffer_store_dwordx4 v[124:127], v3, s[48:51], s60 offen sc1
  s_add_u32 s60, s60, 32768
  v_mul_f32 v88, v88, v114
  v_mul_f32 v89, v89, v114
  v_mul_f32 v90, v90, v114
  v_mul_f32 v91, v91, v114
  v_mul_f32 v92, v92, v114
  v_mul_f32 v93, v93, v114
  v_mul_f32 v94, v94, v114
  v_mul_f32 v95, v95, v114
  v_cvt_pk_bf16_f32 v128, v88, v89
  v_cvt_pk_bf16_f32 v129, v90, v91
  v_cvt_pk_bf16_f32 v130, v92, v93
  v_cvt_pk_bf16_f32 v131, v94, v95
  v_or_b32 v128, 1, v128
  v_or_b32 v129, 1, v129
  v_or_b32 v130, 1, v130
  v_or_b32 v131, 1, v131
  buffer_store_dwordx4 v[128:131], v3, s[48:51], s60 offen sc1
  s_add_u32 s60, s60, 32768
  v_mul_f32 v100, v100, v115
  v_mul_f32 v101, v101, v115
  v_mul_f32 v102, v102, v115
  v_mul_f32 v103, v103, v115
  v_mul_f32 v104, v104, v115
  v_mul_f32 v105, v105, v115
  v_mul_f32 v106, v106, v115
  v_mul_f32 v107, v107, v115
  v_cvt_pk_bf16_f32 v132, v100, v101
  v_cvt_pk_bf16_f32 v133, v102, v103
  v_cvt_pk_bf16_f32 v134, v104, v105
  v_cvt_pk_bf16_f32 v135, v106, v107
  v_or_b32 v132, 1, v132
  v_or_b32 v133, 1, v133
  v_or_b32 v134, 1, v134
  v_or_b32 v135, 1, v135
  buffer_store_dwordx4 v[132:135], v3, s[48:51], s60 offen sc1
  s_add_u32 s60, s60, 32768
  s_setprio 0
K3_wor:
  s_cmp_eq_u32 s68, 0
  s_cbranch_scc1 K3_wor_done
  s_mov_b32 m0, s74
  s_nop 0
  buffer_load_dwordx4 v232, s[20:23], s69 offen offset:0 lds
  buffer_load_dwordx4 v233, s[20:23], s69 offen offset:1024 lds
  buffer_load_dwordx4 v234, s[20:23], s69 offen offset:2048 lds
  buffer_load_dwordx4 v235, s[20:23], s69 offen offset:3072 lds
  s_add_u32 s69, s69, 262144
  s_add_u32 s74, s74, 16384
  s_sub_u32 s68, s68, 1
  s_branch K3_wor
K3_wor_done:
  s_add_u32 m0, s70, 98304
  s_nop 0
  buffer_load_dwordx4 v232, s[20:23], s69 offen offset:0 lds
  buffer_load_dwordx4 v233, s[20:23], s69 offen offset:1024 lds
  buffer_load_dwordx4 v234, s[20:23], s69 offen offset:2048 lds
  buffer_load_dwordx4 v235, s[20:23], s69 offen offset:3072 lds
  s_add_u32 s69, s69, 262144
  s_mov_b32 s61, 131072
K3_wcd:
  s_sleep 1
  ds_read_b32 v16, v9 offset:56
  s_waitcnt lgkmcnt(0)
  v_readfirstlane_b32 s60, v16
  s_sub_u32 s61, s61, 1
  s_cbranch_scc1 K3_wcd_ok
  s_cmp_lt_u32 s60, 1
  s_cbranch_scc1 K3_wcd
K3_wcd_ok:
  s_mov_b32 m0, s7
  s_nop 0
  buffer_load_dwordx4 v232, s[20:23], s69 offen offset:0 lds
  buffer_load_dwordx4 v233, s[20:23], s69 offen offset:1024 lds
  buffer_load_dwordx4 v234, s[20:23], s69 offen offset:2048 lds
  buffer_load_dwordx4 v235, s[20:23], s69 offen offset:3072 lds
  s_add_u32 s69, s69, 262144
  s_and_b32 s60, s10, 3
  s_lshl_b32 s60, s60, 2
  s_and_b32 s61, s11, 3
  s_add_u32 s60, s60, s61
  s_lshl_b32 s60, s60, 18
  s_lshr_b32 s61, s11, 2
  s_lshl_b32 s61, s61, 2
  s_add_u32 s61, s61, s4
  s_lshl_b32 s61, s61, 13
  s_add_u32 s60, s60, s61
  v_lshlrev_b32 v8, 7, v2
  s_waitcnt vmcnt(0)
  buffer_load_dword v60, v8, s[48:51], s60 offen
  s_waitcnt vmcnt(0)
  s_mov_b64 exec, 1
  ds_add_u32 v10, v11 offset:48
  s_mov_b64 exec, -1
  s_cmp_eq_u32 s40, 1
  s_cbranch_scc1 K3_fin
  s_mov_b32 s40, 2
  s_mov_b32 s43, 4000
K3_post:
  buffer_load_dwordx4 v[16:19], v225, s[44:47], s73 offen sc1
  buffer_load_dwordx4 v[20:23], v225, s[44:47], s65 offen sc1
  buffer_load_dwordx4 v[24:27], v225, s[44:47], s66 offen sc1
  buffer_load_dwordx4 v[28:31], v225, s[44:47], s67 offen sc1
  s_waitcnt vmcnt(0)
  v_bitop3_b32 v48, v16, v17, 1 bitop3:0x80
  v_bitop3_b32 v48, v48, v18, v19 bitop3:0x80
  v_bitop3_b32 v48, v48, v20, v21 bitop3:0x80
  v_bitop3_b32 v48, v48, v22, v23 bitop3:0x80
  v_bitop3_b32 v48, v48, v24, v25 bitop3:0x80
  v_bitop3_b32 v48, v48, v26, v27 bitop3:0x80
  v_bitop3_b32 v48, v48, v28, v29 bitop3:0x80
  v_bitop3_b32 v48, v48, v30, v31 bitop3:0x80
  v_cmp_eq_u32 vcc, 0, v48
  s_nop 0
  s_cmp_eq_u64 vcc, 0
  s_cbranch_scc1 K3_yok
  s_add_u32 s75, s75, 1
  s_cmp_eq_u32 s40, 0
  s_cbranch_scc1 K3_zp_s2
  s_sub_u32 s43, s43, 1
  s_cbranch_scc1 K3_yok
  s_sleep 8
  s_branch K3_post
K3_yok:
  v_lshlrev_b32 v48, 16, v16
  v_lshlrev_b32 v49, 16, v20
  v_lshlrev_b32 v50, 16, v24
  v_lshlrev_b32 v51, 16, v28
  v_lshlrev_b32 v52, 16, v208
  v_and_b32 v53, 0xffff0000, v208
  v_lshlrev_b32 v54, 16, v209
  v_and_b32 v55, 0xffff0000, v209
  v_mul_f32 v48, v48, v52
  v_mul_f32 v49, v49, v53
  v_mul_f32 v50, v50, v54
  v_mul_f32 v51, v51, v55
  v_cvt_pk_bf16_f32 v64, v48, v49
  v_cvt_pk_bf16_f32 v65, v50, v51
  buffer_store_dwordx2 v[64:65], v224, s[32:35], s72 offen
  s_add_u32 s72, s72, 262144
  v_and_b32 v56, 0xffff0000, v16
  v_and_b32 v57, 0xffff0000, v20
  v_and_b32 v58, 0xffff0000, v24
  v_and_b32 v59, 0xffff0000, v28
  v_lshlrev_b32 v60, 16, v210
  v_and_b32 v61, 0xffff0000, v210
  v_lshlrev_b32 v62, 16, v211
  v_and_b32 v63, 0xffff0000, v211
  v_mul_f32 v56, v56, v60
  v_mul_f32 v57, v57, v61
  v_mul_f32 v58, v58, v62
  v_mul_f32 v59, v59, v63
  v_cvt_pk_bf16_f32 v66, v56, v57
  v_cvt_pk_bf16_f32 v67, v58, v59
  buffer_store_dwordx2 v[66:67], v224, s[32:35], s72 offen
  s_add_u32 s72, s72, 262144
  v_lshlrev_b32 v48, 16, v17
  v_lshlrev_b32 v49, 16, v21
  v_lshlrev_b32 v50, 16, v25
  v_lshlrev_b32 v51, 16, v29
  v_lshlrev_b32 v52, 16, v212
  v_and_b32 v53, 0xffff0000, v212
  v_lshlrev_b32 v54, 16, v213
  v_and_b32 v55, 0xffff0000, v213
  v_mul_f32 v48, v48, v52
  v_mul_f32 v49, v49, v53
  v_mul_f32 v50, v50, v54
  v_mul_f32 v51, v51, v55
  v_cvt_pk_bf16_f32 v68, v48, v49
  v_cvt_pk_bf16_f32 v69, v50, v51
  buffer_store_dwordx2 v[68:69], v224, s[32:35], s72 offen
  s_add_u32 s72, s72, 262144
  v_and_b32 v56, 0xffff0000, v17
  v_and_b32 v57, 0xffff0000, v21
  v_and_b32 v58, 0xffff0000, v25
  v_and_b32 v59, 0xffff0000, v29
  v_lshlrev_b32 v60, 16, v214
  v_and_b32 v61, 0xffff0000, v214
  v_lshlrev_b32 v62, 16, v215
  v_and_b32 v63, 0xffff0000, v215
  v_mul_f32 v56, v56, v60
  v_mul_f32 v57, v57, v61
  v_mul_f32 v58, v58, v62
  v_mul_f32 v59, v59, v63
  v_cvt_pk_bf16_f32 v70, v56, v57
  v_cvt_pk_bf16_f32 v71, v58, v59
  buffer_store_dwordx2 v[70:71], v224, s[32:35], s72 offen
  s_add_u32 s72, s72, 262144
  v_lshlrev_b32 v48, 16, v18
  v_lshlrev_b32 v49, 16, v22
  v_lshlrev_b32 v50, 16, v26
  v_lshlrev_b32 v51, 16, v30
  v_lshlrev_b32 v52, 16, v216
  v_and_b32 v53, 0xffff0000, v216
  v_lshlrev_b32 v54, 16, v217
  v_and_b32 v55, 0xffff0000, v217
  v_mul_f32 v48, v48, v52
  v_mul_f32 v49, v49, v53
  v_mul_f32 v50, v50, v54
  v_mul_f32 v51, v51, v55
  v_cvt_pk_bf16_f32 v72, v48, v49
  v_cvt_pk_bf16_f32 v73, v50, v51
  buffer_store_dwordx2 v[72:73], v224, s[32:35], s72 offen
  s_add_u32 s72, s72, 262144
  v_and_b32 v56, 0xffff0000, v18
  v_and_b32 v57, 0xffff0000, v22
  v_and_b32 v58, 0xffff0000, v26
  v_and_b32 v59, 0xffff0000, v30
  v_lshlrev_b32 v60, 16, v218
  v_and_b32 v61, 0xffff0000, v218
  v_lshlrev_b32 v62, 16, v219
  v_and_b32 v63, 0xffff0000, v219
  v_mul_f32 v56, v56, v60
  v_mul_f32 v57, v57, v61
  v_mul_f32 v58, v58, v62
  v_mul_f32 v59, v59, v63
  v_cvt_pk_bf16_f32 v74, v56, v57
  v_cvt_pk_bf16_f32 v75, v58, v59
  buffer_store_dwordx2 v[74:75], v224, s[32:35], s72 offen
  s_add_u32 s72, s72, 262144
  v_lshlrev_b32 v48, 16, v19
  v_lshlrev_b32 v49, 16, v23
  v_lshlrev_b32 v50, 16, v27
  v_lshlrev_b32 v51, 16, v31
  v_lshlrev_b32 v52, 16, v220
  v_and_b32 v53, 0xffff0000, v220
  v_lshlrev_b32 v54, 16, v221
  v_and_b32 v55, 0xffff0000, v221
  v_mul_f32 v48, v48, v52
  v_mul_f32 v49, v49, v53
  v_mul_f32 v50, v50, v54
  v_mul_f32 v51, v51, v55
  v_cvt_pk_bf16_f32 v76, v48, v49
  v_cvt_pk_bf16_f32 v77, v50, v51
  buffer_store_dwordx2 v[76:77], v224, s[32:35], s72 offen
  s_add_u32 s72, s72, 262144
  v_and_b32 v56, 0xffff0000, v19
  v_and_b32 v57, 0xffff0000, v23
  v_and_b32 v58, 0xffff0000, v27
  v_and_b32 v59, 0xffff0000, v31
  v_lshlrev_b32 v60, 16, v222
  v_and_b32 v61, 0xffff0000, v222
  v_lshlrev_b32 v62, 16, v223
  v_and_b32 v63, 0xffff0000, v223
  v_mul_f32 v56, v56, v60
  v_mul_f32 v57, v57, v61
  v_mul_f32 v58, v58, v62
  v_mul_f32 v59, v59, v63
  v_cvt_pk_bf16_f32 v78, v56, v57
  v_cvt_pk_bf16_f32 v79, v58, v59
  buffer_store_dwordx2 v[78:79], v224, s[32:35], s72 offen
  s_add_u32 s72, s72, 262144
  s_mov_b32 s41, s40
  s_mov_b32 s40, 1
  s_cmp_eq_u32 s41, 0
  s_cbranch_scc1 K3_zp
K3_fin:
K3_end:
  s_endpgm
.section .rodata,"a"
.p2align 6
.amdhsa_kernel concat_heads__ssm_conv_h3__linear_attn_block__prompt_kernel
  .amdhsa_next_free_vgpr 252
  .amdhsa_next_free_sgpr 102
  .amdhsa_accum_offset 252
  .amdhsa_group_segment_fixed_size 0
  .amdhsa_kernarg_size 96
  .amdhsa_user_sgpr_count 2
  .amdhsa_user_sgpr_kernarg_segment_ptr 1
  .amdhsa_system_sgpr_workgroup_id_x 1
.end_amdhsa_kernel
```

```asm
; @launch grid=(256,1,1) block=(512,1,1) lds=163840
.amdgcn_target "amdgcn-amd-amdhsa--gfx950"
.text
.globl concat_heads__ssm_conv_h3__linear_attn_block__prompt_kernel
.p2align 8
.type concat_heads__ssm_conv_h3__linear_attn_block__prompt_kernel,@function
concat_heads__ssm_conv_h3__linear_attn_block__prompt_kernel:
  s_cmp_ge_u32 s2, 256
  s_cbranch_scc1 K3_end
  s_load_dwordx8 s[84:91], s[0:1], 32
  s_load_dwordx8 s[92:99], s[0:1], 64
  s_load_dwordx8 s[76:83], s[0:1], 0
  v_lshrrev_b32 v1, 6, v0
  v_and_b32 v2, 63, v0
  s_and_b32 s10, s2, 7
  v_readfirstlane_b32 s3, v1
  s_lshr_b32 s11, s2, 3
  s_and_b32 s12, s10, 1
  s_lshl_b32 s12, s12, 3
  s_and_b32 s13, s11, 7
  s_add_u32 s12, s12, s13
  s_lshr_b32 s13, s10, 1
  s_lshl_b32 s13, s13, 2
  s_lshr_b32 s14, s11, 3
  s_add_u32 s13, s13, s14
  s_mov_b32 s75, 0
  s_and_b32 s4, s3, 3
  s_and_b32 s36, s3, 1
  s_bfe_u32 s37, s3, 0x10001
  s_lshl_b32 s5, s13, 1
  s_add_u32 s5, s5, s37
  s_xor_b32 s15, s5, 2
  s_lshl_b32 s6, s10, 7
  s_lshl_b32 s7, s11, 2
  s_add_u32 s6, s6, s7
  s_add_u32 s6, s6, s4
  s_mul_i32 s7, s4, 8704
  v_lshlrev_b32 v3, 4, v2
  v_lshrrev_b32 v14, 4, v2
  v_and_b32 v15, 15, v2
  s_waitcnt lgkmcnt(0)
  s_cmp_ge_u32 s3, 4
  s_cbranch_scc1 K3_L
  s_cmp_lg_u32 s3, 0
  s_cbranch_scc1 K3_pfw
  s_mov_b32 s40, s88
  s_mov_b32 s41, s89
  s_mov_b32 s42, 4194304
  s_mov_b32 s43, 0x20000
  v_lshrrev_b32 v192, 3, v2
  v_lshlrev_b32 v192, 11, v192
  v_and_b32 v16, 7, v2
  v_lshl_add_u32 v192, v16, 7, v192
  s_lshl_b32 s45, s2, 14
  s_add_u32 s44, s45, 1024
  s_branch K3_pfd
K3_pfw:
  s_mov_b32 s40, s90
  s_mov_b32 s41, s91
  s_mov_b32 s42, 6291456
  s_mov_b32 s43, 0x20000
  v_lshlrev_b32 v192, 7, v2
  s_mul_i32 s45, s2, 12288
  s_sub_u32 s44, s3, 1
  s_lshl_b32 s44, s44, 12
  s_add_u32 s45, s45, s44
  s_add_u32 s44, s45, 3145728
  s_cmp_eq_u32 s3, 3
  s_cselect_b32 s45, 8388608, s45
  s_cselect_b32 s44, 8388608, s44
K3_pfd:
  buffer_load_dword v195, v192, s[40:43], s45 offen
  s_mov_b32 s56, s96
  s_mov_b32 s57, s97
  s_mov_b32 s58, 256
  s_mov_b32 s59, 0x20000
  s_add_u32 s60, s98, 13631488
  s_addc_u32 s61, s99, 0
  s_mov_b32 s62, 4096
  s_mov_b32 s63, 0x20000
  s_memrealtime s[16:17]
  v_mov_b32 v199, 0
  s_waitcnt lgkmcnt(0)
  s_or_b32 s16, s16, 1
  v_mov_b32 v198, s16
  s_cmp_lg_u32 s3, 3
  s_cbranch_scc1 K3_noseed
  s_cmp_lg_u32 s11, 0
  s_cbranch_scc1 K3_noseed
  v_mov_b32 v196, s16
  v_mov_b32 v197, 0
  s_mov_b64 exec, 1
  buffer_atomic_cmpswap v[196:197], v199, s[56:59], 0 offen sc1
  s_mov_b64 exec, -1
K3_noseed:
  s_lshl_b32 s46, s11, 7
  s_lshl_b32 s47, s10, 2
  s_add_u32 s47, s47, s46
  s_cmp_ge_u32 s3, 2
  s_cselect_b32 s48, s80, s78
  s_cselect_b32 s49, s81, s79
  s_mov_b32 s50, 4194304
  s_mov_b32 s51, 0x20000
  v_lshrrev_b32 v193, 2, v2
  v_lshlrev_b32 v193, 11, v193
  v_and_b32 v16, 3, v2
  v_lshl_add_u32 v193, v16, 7, v193
  s_lshr_b32 s45, s2, 2
  s_lshl_b32 s45, s45, 16
  s_lshl_b32 s46, s36, 15
  s_add_u32 s45, s45, s46
  s_and_b32 s46, s2, 3
  s_lshl_b32 s46, s46, 9
  s_add_u32 s45, s45, s46
  s_mov_b32 s45, 16777216
  v_mov_b32 v200, v15
  s_cmp_lg_u32 s3, 0
  s_cbranch_scc1 K3_e3_1
  s_mov_b32 s64, s84
  s_mov_b32 s65, s85
  s_mov_b32 s66, 4194304
  s_mov_b32 s67, 0x20000
  s_lshl_b32 s68, s10, 19
  s_lshl_b32 s69, s11, 14
  s_add_u32 s68, s68, s69
  s_add_u32 s69, s68, 8192
  v_lshlrev_b32 v194, 7, v2
  s_branch K3_e3_done
K3_e3_1:
  s_cmp_lg_u32 s3, 1
  s_cbranch_scc1 K3_e3_2
  s_mov_b32 s64, s76
  s_mov_b32 s65, s77
  s_mov_b32 s66, 4194304
  s_mov_b32 s67, 0x20000
  s_lshl_b32 s68, s11, 17
  s_lshl_b32 s69, s10, 8
  s_add_u32 s68, s68, s69
  s_add_u32 s69, s68, 65536
  v_lshrrev_b32 v194, 1, v2
  v_lshlrev_b32 v194, 11, v194
  v_and_b32 v15, 1, v2
  v_lshl_add_u32 v194, v15, 7, v194
  s_branch K3_e3_done
K3_e3_2:
  s_cmp_lg_u32 s3, 2
  s_cbranch_scc1 K3_e3_3
  s_mov_b32 s64, s92
  s_mov_b32 s65, s93
  s_mov_b32 s66, 2097152
  s_mov_b32 s67, 0x20000
  s_lshl_b32 s68, s11, 16
  s_lshr_b32 s69, s10, 2
  s_lshl_b32 s69, s69, 10
  s_add_u32 s68, s68, s69
  s_add_u32 s69, s68, 16384
  v_lshrrev_b32 v194, 3, v2
  v_lshlrev_b32 v194, 11, v194
  v_and_b32 v15, 7, v2
  v_lshl_add_u32 v194, v15, 7, v194
  s_branch K3_e3_done
K3_e3_3:
  s_mov_b32 s64, s92
  s_mov_b32 s65, s93
  s_mov_b32 s66, 2097152
  s_mov_b32 s67, 0x20000
  s_lshl_b32 s68, s11, 16
  s_lshr_b32 s69, s10, 2
  s_lshl_b32 s69, s69, 10
  s_add_u32 s68, s68, s69
  s_add_u32 s68, s68, 32768
  s_add_u32 s69, s68, 16384
  v_lshrrev_b32 v194, 3, v2
  v_lshlrev_b32 v194, 11, v194
  v_and_b32 v15, 7, v2
  v_lshl_add_u32 v194, v15, 7, v194
K3_e3_done:
  v_mov_b32 v15, v200
  s_and_b32 s55, s11, 3
  s_add_u32 s55, s55, 0
  s_and_b32 s52, s11, 3
  s_add_u32 s52, s52, 4
  s_sub_u32 s52, s52, s55
  s_sub_u32 s52, s52, 1
  s_mov_b32 s54, 0
  s_lshr_b32 s70, s11, 2
  s_and_b32 s70, s70, 3
  s_add_u32 s70, s70, 1000
  s_cmp_lt_u32 s3, 2
  s_cselect_b32 s70, 1000, s70
  s_cmp_eq_u32 s3, 3
  s_cselect_b32 s71, 7, 1000
  s_mov_b32 s53, 0
  s_lshl_b32 s38, s36, 6
  v_add_u32 v16, s38, v15
  v_lshrrev_b32 v17, 1, v15
  v_lshlrev_b32 v16, 7, v16
  v_xor_b32 v17, v14, v17
  v_lshl_add_u32 v4, v17, 4, v16
  v_xor_b32 v5, 64, v4
  v_add_u32 v6, 81920, v4
  v_add_u32 v7, 81920, v5
  v_bfe_u32 v17, v2, 2, 2
  v_and_b32 v18, 3, v2
  v_lshlrev_b32 v17, 6, v17
  v_lshl_add_u32 v17, v18, 3, v17
  v_and_b32 v18, 1, v14
  v_lshl_add_u32 v17, v18, 10, v17
  v_lshl_add_u32 v17, v18, 5, v17
  v_lshrrev_b32 v18, 1, v14
  v_mul_u32_u24 v18, 6144, v18
  v_add_u32 v17, v17, v18
  s_lshl_b32 s38, s37, 8
  s_add_u32 s38, s38, 16384
  v_add_u32 v8, s38, v17
  v_xor_b32 v9, 32, v8
  v_add_u32 v10, 81920, v8
  v_add_u32 v11, 81920, v9
  v_mov_b32 v96, 0
  v_mov_b32 v97, 0
  v_mov_b32 v98, 0
  v_mov_b32 v99, 0
  v_mov_b32 v100, 0
  v_mov_b32 v101, 0
  v_mov_b32 v102, 0
  v_mov_b32 v103, 0
  v_mov_b32 v104, 0
  v_mov_b32 v105, 0
  v_mov_b32 v106, 0
  v_mov_b32 v107, 0
  v_mov_b32 v108, 0
  v_mov_b32 v109, 0
  v_mov_b32 v110, 0
  v_mov_b32 v111, 0
  v_mov_b32 v112, 0
  v_mov_b32 v113, 0
  v_mov_b32 v114, 0
  v_mov_b32 v115, 0
  v_mov_b32 v116, 0
  v_mov_b32 v117, 0
  v_mov_b32 v118, 0
  v_mov_b32 v119, 0
  v_mov_b32 v120, 0
  v_mov_b32 v121, 0
  v_mov_b32 v122, 0
  v_mov_b32 v123, 0
  v_mov_b32 v124, 0
  v_mov_b32 v125, 0
  v_mov_b32 v126, 0
  v_mov_b32 v127, 0
  v_mov_b32 v128, 0
  v_mov_b32 v129, 0
  v_mov_b32 v130, 0
  v_mov_b32 v131, 0
  v_mov_b32 v132, 0
  v_mov_b32 v133, 0
  v_mov_b32 v134, 0
  v_mov_b32 v135, 0
  v_mov_b32 v136, 0
  v_mov_b32 v137, 0
  v_mov_b32 v138, 0
  v_mov_b32 v139, 0
  v_mov_b32 v140, 0
  v_mov_b32 v141, 0
  v_mov_b32 v142, 0
  v_mov_b32 v143, 0
  v_mov_b32 v144, 0
  v_mov_b32 v145, 0
  v_mov_b32 v146, 0
  v_mov_b32 v147, 0
  v_mov_b32 v148, 0
  v_mov_b32 v149, 0
  v_mov_b32 v150, 0
  v_mov_b32 v151, 0
  v_mov_b32 v152, 0
  v_mov_b32 v153, 0
  v_mov_b32 v154, 0
  v_mov_b32 v155, 0
  v_mov_b32 v156, 0
  v_mov_b32 v157, 0
  v_mov_b32 v158, 0
  v_mov_b32 v159, 0
  v_mov_b32 v160, 0
  v_mov_b32 v161, 0
  v_mov_b32 v162, 0
  v_mov_b32 v163, 0
  v_mov_b32 v164, 0
  v_mov_b32 v165, 0
  v_mov_b32 v166, 0
  v_mov_b32 v167, 0
  v_mov_b32 v168, 0
  v_mov_b32 v169, 0
  v_mov_b32 v170, 0
  v_mov_b32 v171, 0
  v_mov_b32 v172, 0
  v_mov_b32 v173, 0
  v_mov_b32 v174, 0
  v_mov_b32 v175, 0
  v_mov_b32 v176, 0
  v_mov_b32 v177, 0
  v_mov_b32 v178, 0
  v_mov_b32 v179, 0
  v_mov_b32 v180, 0
  v_mov_b32 v181, 0
  v_mov_b32 v182, 0
  v_mov_b32 v183, 0
  v_mov_b32 v184, 0
  v_mov_b32 v185, 0
  v_mov_b32 v186, 0
  v_mov_b32 v187, 0
  v_mov_b32 v188, 0
  v_mov_b32 v189, 0
  v_mov_b32 v190, 0
  v_mov_b32 v191, 0
  s_waitcnt lgkmcnt(0)
  s_add_u32 s28, s98, 8388608
  s_addc_u32 s29, s99, 0
  s_mov_b32 s30, 2097152
  s_mov_b32 s31, 0x20000
  s_add_u32 s32, s98, 12582912
  s_addc_u32 s33, s99, 0
  s_mov_b32 s34, 65536
  s_mov_b32 s35, 0x20000
  s_barrier
  ds_read_b128 v[16:19], v4 offset:0
  ds_read_b64_tr_b16 v[32:33], v8 offset:0
  ds_read_b64_tr_b16 v[34:35], v8 offset:512
  ds_read_b128 v[20:23], v4 offset:2048
  ds_read_b128 v[24:27], v4 offset:4096
  ds_read_b128 v[28:31], v4 offset:6144
  ds_read_b64_tr_b16 v[36:37], v9 offset:0
  ds_read_b64_tr_b16 v[38:39], v9 offset:512
  ds_read_b64_tr_b16 v[40:41], v8 offset:2048
  ds_read_b64_tr_b16 v[42:43], v8 offset:2560
  ds_read_b64_tr_b16 v[44:45], v9 offset:2048
  ds_read_b64_tr_b16 v[46:47], v9 offset:2560
  ds_read_b64_tr_b16 v[48:49], v8 offset:4096
  ds_read_b64_tr_b16 v[50:51], v8 offset:4608
  ds_read_b64_tr_b16 v[52:53], v9 offset:4096
  ds_read_b64_tr_b16 v[54:55], v9 offset:4608
  s_waitcnt lgkmcnt(0)
  s_mov_b32 s39, 4
K3_loop:
  v_mfma_f32_16x16x32_bf16 v[96:99], v[32:35], v[16:19], v[96:99]
  ds_read_b128 v[56:59], v5 offset:0
  v_mfma_f32_16x16x32_bf16 v[104:107], v[32:35], v[20:23], v[104:107]
  ds_read_b64_tr_b16 v[72:73], v8 offset:12288
  v_mfma_f32_16x16x32_bf16 v[112:115], v[32:35], v[24:27], v[112:115]
  ds_read_b64_tr_b16 v[74:75], v8 offset:12800
  v_mfma_f32_16x16x32_bf16 v[120:123], v[32:35], v[28:31], v[120:123]
  ds_read_b128 v[60:63], v5 offset:2048
  v_mfma_f32_16x16x32_bf16 v[100:103], v[36:39], v[16:19], v[100:103]
  ds_read_b128 v[64:67], v5 offset:4096
  v_mfma_f32_16x16x32_bf16 v[108:111], v[36:39], v[20:23], v[108:111]
  ds_read_b128 v[68:71], v5 offset:6144
  v_mfma_f32_16x16x32_bf16 v[116:119], v[36:39], v[24:27], v[116:119]
  ds_read_b64_tr_b16 v[76:77], v9 offset:12288
  v_mfma_f32_16x16x32_bf16 v[124:127], v[36:39], v[28:31], v[124:127]
  ds_read_b64_tr_b16 v[78:79], v9 offset:12800
  v_mfma_f32_16x16x32_bf16 v[128:131], v[16:19], v[40:43], v[128:131]
  ds_read_b64_tr_b16 v[80:81], v8 offset:14336
  v_mfma_f32_16x16x32_bf16 v[136:139], v[20:23], v[40:43], v[136:139]
  ds_read_b64_tr_b16 v[82:83], v8 offset:14848
  v_mfma_f32_16x16x32_bf16 v[144:147], v[24:27], v[40:43], v[144:147]
  ds_read_b64_tr_b16 v[84:85], v9 offset:14336
  v_mfma_f32_16x16x32_bf16 v[152:155], v[28:31], v[40:43], v[152:155]
  ds_read_b64_tr_b16 v[86:87], v9 offset:14848
  v_mfma_f32_16x16x32_bf16 v[132:135], v[16:19], v[44:47], v[132:135]
  ds_read_b64_tr_b16 v[88:89], v8 offset:16384
  v_mfma_f32_16x16x32_bf16 v[140:143], v[20:23], v[44:47], v[140:143]
  ds_read_b64_tr_b16 v[90:91], v8 offset:16896
  v_mfma_f32_16x16x32_bf16 v[148:151], v[24:27], v[44:47], v[148:151]
  ds_read_b64_tr_b16 v[92:93], v9 offset:16384
  v_mfma_f32_16x16x32_bf16 v[156:159], v[28:31], v[44:47], v[156:159]
  ds_read_b64_tr_b16 v[94:95], v9 offset:16896
  v_mfma_f32_16x16x32_bf16 v[160:163], v[16:19], v[48:51], v[160:163]
  v_mfma_f32_16x16x32_bf16 v[168:171], v[20:23], v[48:51], v[168:171]
  v_mfma_f32_16x16x32_bf16 v[176:179], v[24:27], v[48:51], v[176:179]
  v_mfma_f32_16x16x32_bf16 v[184:187], v[28:31], v[48:51], v[184:187]
  v_mfma_f32_16x16x32_bf16 v[164:167], v[16:19], v[52:55], v[164:167]
  v_mfma_f32_16x16x32_bf16 v[172:175], v[20:23], v[52:55], v[172:175]
  v_mfma_f32_16x16x32_bf16 v[180:183], v[24:27], v[52:55], v[180:183]
  v_mfma_f32_16x16x32_bf16 v[188:191], v[28:31], v[52:55], v[188:191]
  s_waitcnt lgkmcnt(0)
  s_barrier
  s_sub_u32 s55, s55, 1
  s_cbranch_scc1 K3_event0
K3_noev0:
  s_sub_u32 s70, s70, 1
  s_cbranch_scc1 K3_evB0
K3_noevB0:
  s_sub_u32 s71, s71, 1
  s_cbranch_scc1 K3_evC0
K3_noevC0:
  v_mfma_f32_16x16x32_bf16 v[96:99], v[72:75], v[56:59], v[96:99]
  ds_read_b128 v[16:19], v4 offset:40960
  v_mfma_f32_16x16x32_bf16 v[104:107], v[72:75], v[60:63], v[104:107]
  ds_read_b64_tr_b16 v[32:33], v8 offset:40960
  v_mfma_f32_16x16x32_bf16 v[112:115], v[72:75], v[64:67], v[112:115]
  ds_read_b64_tr_b16 v[34:35], v8 offset:41472
  v_mfma_f32_16x16x32_bf16 v[120:123], v[72:75], v[68:71], v[120:123]
  ds_read_b128 v[20:23], v4 offset:43008
  v_mfma_f32_16x16x32_bf16 v[100:103], v[76:79], v[56:59], v[100:103]
  ds_read_b128 v[24:27], v4 offset:45056
  v_mfma_f32_16x16x32_bf16 v[108:111], v[76:79], v[60:63], v[108:111]
  ds_read_b128 v[28:31], v4 offset:47104
  v_mfma_f32_16x16x32_bf16 v[116:119], v[76:79], v[64:67], v[116:119]
  ds_read_b64_tr_b16 v[36:37], v9 offset:40960
  v_mfma_f32_16x16x32_bf16 v[124:127], v[76:79], v[68:71], v[124:127]
  ds_read_b64_tr_b16 v[38:39], v9 offset:41472
  v_mfma_f32_16x16x32_bf16 v[128:131], v[56:59], v[80:83], v[128:131]
  ds_read_b64_tr_b16 v[40:41], v8 offset:43008
  v_mfma_f32_16x16x32_bf16 v[136:139], v[60:63], v[80:83], v[136:139]
  ds_read_b64_tr_b16 v[42:43], v8 offset:43520
  v_mfma_f32_16x16x32_bf16 v[144:147], v[64:67], v[80:83], v[144:147]
  ds_read_b64_tr_b16 v[44:45], v9 offset:43008
  v_mfma_f32_16x16x32_bf16 v[152:155], v[68:71], v[80:83], v[152:155]
  ds_read_b64_tr_b16 v[46:47], v9 offset:43520
  v_mfma_f32_16x16x32_bf16 v[132:135], v[56:59], v[84:87], v[132:135]
  ds_read_b64_tr_b16 v[48:49], v8 offset:45056
  v_mfma_f32_16x16x32_bf16 v[140:143], v[60:63], v[84:87], v[140:143]
  ds_read_b64_tr_b16 v[50:51], v8 offset:45568
  v_mfma_f32_16x16x32_bf16 v[148:151], v[64:67], v[84:87], v[148:151]
  ds_read_b64_tr_b16 v[52:53], v9 offset:45056
  v_mfma_f32_16x16x32_bf16 v[156:159], v[68:71], v[84:87], v[156:159]
  ds_read_b64_tr_b16 v[54:55], v9 offset:45568
  v_mfma_f32_16x16x32_bf16 v[160:163], v[56:59], v[88:91], v[160:163]
  v_mfma_f32_16x16x32_bf16 v[168:171], v[60:63], v[88:91], v[168:171]
  v_mfma_f32_16x16x32_bf16 v[176:179], v[64:67], v[88:91], v[176:179]
  v_mfma_f32_16x16x32_bf16 v[184:187], v[68:71], v[88:91], v[184:187]
  v_mfma_f32_16x16x32_bf16 v[164:167], v[56:59], v[92:95], v[164:167]
  v_mfma_f32_16x16x32_bf16 v[172:175], v[60:63], v[92:95], v[172:175]
  v_mfma_f32_16x16x32_bf16 v[180:183], v[64:67], v[92:95], v[180:183]
  v_mfma_f32_16x16x32_bf16 v[188:191], v[68:71], v[92:95], v[188:191]
  s_waitcnt lgkmcnt(13)
  v_mfma_f32_16x16x32_bf16 v[96:99], v[32:35], v[16:19], v[96:99]
  ds_read_b128 v[56:59], v5 offset:40960
  s_waitcnt lgkmcnt(13)
  v_mfma_f32_16x16x32_bf16 v[104:107], v[32:35], v[20:23], v[104:107]
  ds_read_b64_tr_b16 v[72:73], v8 offset:53248
  s_waitcnt lgkmcnt(13)
  v_mfma_f32_16x16x32_bf16 v[112:115], v[32:35], v[24:27], v[112:115]
  ds_read_b64_tr_b16 v[74:75], v8 offset:53760
  s_waitcnt lgkmcnt(13)
  v_mfma_f32_16x16x32_bf16 v[120:123], v[32:35], v[28:31], v[120:123]
  ds_read_b128 v[60:63], v5 offset:43008
  s_waitcnt lgkmcnt(12)
  v_mfma_f32_16x16x32_bf16 v[100:103], v[36:39], v[16:19], v[100:103]
  ds_read_b128 v[64:67], v5 offset:45056
  v_mfma_f32_16x16x32_bf16 v[108:111], v[36:39], v[20:23], v[108:111]
  ds_read_b128 v[68:71], v5 offset:47104
  v_mfma_f32_16x16x32_bf16 v[116:119], v[36:39], v[24:27], v[116:119]
  ds_read_b64_tr_b16 v[76:77], v9 offset:53248
  v_mfma_f32_16x16x32_bf16 v[124:127], v[36:39], v[28:31], v[124:127]
  ds_read_b64_tr_b16 v[78:79], v9 offset:53760
  s_waitcnt lgkmcnt(14)
  v_mfma_f32_16x16x32_bf16 v[128:131], v[16:19], v[40:43], v[128:131]
  ds_read_b64_tr_b16 v[80:81], v8 offset:55296
  v_mfma_f32_16x16x32_bf16 v[136:139], v[20:23], v[40:43], v[136:139]
  ds_read_b64_tr_b16 v[82:83], v8 offset:55808
  v_mfma_f32_16x16x32_bf16 v[144:147], v[24:27], v[40:43], v[144:147]
  ds_read_b64_tr_b16 v[84:85], v9 offset:55296
  v_mfma_f32_16x16x32_bf16 v[152:155], v[28:31], v[40:43], v[152:155]
  ds_read_b64_tr_b16 v[86:87], v9 offset:55808
  s_waitcnt lgkmcnt(15)
  v_mfma_f32_16x16x32_bf16 v[132:135], v[16:19], v[44:47], v[132:135]
  ds_read_b64_tr_b16 v[88:89], v8 offset:57344
  v_mfma_f32_16x16x32_bf16 v[140:143], v[20:23], v[44:47], v[140:143]
  ds_read_b64_tr_b16 v[90:91], v8 offset:57856
  v_mfma_f32_16x16x32_bf16 v[148:151], v[24:27], v[44:47], v[148:151]
  ds_read_b64_tr_b16 v[92:93], v9 offset:57344
  v_mfma_f32_16x16x32_bf16 v[156:159], v[28:31], v[44:47], v[156:159]
  ds_read_b64_tr_b16 v[94:95], v9 offset:57856
  s_waitcnt lgkmcnt(15)
  v_mfma_f32_16x16x32_bf16 v[160:163], v[16:19], v[48:51], v[160:163]
  v_mfma_f32_16x16x32_bf16 v[168:171], v[20:23], v[48:51], v[168:171]
  v_mfma_f32_16x16x32_bf16 v[176:179], v[24:27], v[48:51], v[176:179]
  v_mfma_f32_16x16x32_bf16 v[184:187], v[28:31], v[48:51], v[184:187]
  v_mfma_f32_16x16x32_bf16 v[164:167], v[16:19], v[52:55], v[164:167]
  v_mfma_f32_16x16x32_bf16 v[172:175], v[20:23], v[52:55], v[172:175]
  v_mfma_f32_16x16x32_bf16 v[180:183], v[24:27], v[52:55], v[180:183]
  v_mfma_f32_16x16x32_bf16 v[188:191], v[28:31], v[52:55], v[188:191]
  s_waitcnt lgkmcnt(0)
  s_barrier
  s_sub_u32 s55, s55, 1
  s_cbranch_scc1 K3_event1
K3_noev1:
  s_sub_u32 s70, s70, 1
  s_cbranch_scc1 K3_evB1
K3_noevB1:
  s_sub_u32 s71, s71, 1
  s_cbranch_scc1 K3_evC1
K3_noevC1:
  v_mfma_f32_16x16x32_bf16 v[96:99], v[72:75], v[56:59], v[96:99]
  ds_read_b128 v[16:19], v6 offset:0
  v_mfma_f32_16x16x32_bf16 v[104:107], v[72:75], v[60:63], v[104:107]
  ds_read_b64_tr_b16 v[32:33], v10 offset:0
  v_mfma_f32_16x16x32_bf16 v[112:115], v[72:75], v[64:67], v[112:115]
  ds_read_b64_tr_b16 v[34:35], v10 offset:512
  v_mfma_f32_16x16x32_bf16 v[120:123], v[72:75], v[68:71], v[120:123]
  ds_read_b128 v[20:23], v6 offset:2048
  v_mfma_f32_16x16x32_bf16 v[100:103], v[76:79], v[56:59], v[100:103]
  ds_read_b128 v[24:27], v6 offset:4096
  v_mfma_f32_16x16x32_bf16 v[108:111], v[76:79], v[60:63], v[108:111]
  ds_read_b128 v[28:31], v6 offset:6144
  v_mfma_f32_16x16x32_bf16 v[116:119], v[76:79], v[64:67], v[116:119]
  ds_read_b64_tr_b16 v[36:37], v11 offset:0
  v_mfma_f32_16x16x32_bf16 v[124:127], v[76:79], v[68:71], v[124:127]
  ds_read_b64_tr_b16 v[38:39], v11 offset:512
  v_mfma_f32_16x16x32_bf16 v[128:131], v[56:59], v[80:83], v[128:131]
  ds_read_b64_tr_b16 v[40:41], v10 offset:2048
  v_mfma_f32_16x16x32_bf16 v[136:139], v[60:63], v[80:83], v[136:139]
  ds_read_b64_tr_b16 v[42:43], v10 offset:2560
  v_mfma_f32_16x16x32_bf16 v[144:147], v[64:67], v[80:83], v[144:147]
  ds_read_b64_tr_b16 v[44:45], v11 offset:2048
  v_mfma_f32_16x16x32_bf16 v[152:155], v[68:71], v[80:83], v[152:155]
  ds_read_b64_tr_b16 v[46:47], v11 offset:2560
  v_mfma_f32_16x16x32_bf16 v[132:135], v[56:59], v[84:87], v[132:135]
  ds_read_b64_tr_b16 v[48:49], v10 offset:4096
  v_mfma_f32_16x16x32_bf16 v[140:143], v[60:63], v[84:87], v[140:143]
  ds_read_b64_tr_b16 v[50:51], v10 offset:4608
  v_mfma_f32_16x16x32_bf16 v[148:151], v[64:67], v[84:87], v[148:151]
  ds_read_b64_tr_b16 v[52:53], v11 offset:4096
  v_mfma_f32_16x16x32_bf16 v[156:159], v[68:71], v[84:87], v[156:159]
  ds_read_b64_tr_b16 v[54:55], v11 offset:4608
  v_mfma_f32_16x16x32_bf16 v[160:163], v[56:59], v[88:91], v[160:163]
  v_mfma_f32_16x16x32_bf16 v[168:171], v[60:63], v[88:91], v[168:171]
  v_mfma_f32_16x16x32_bf16 v[176:179], v[64:67], v[88:91], v[176:179]
  v_mfma_f32_16x16x32_bf16 v[184:187], v[68:71], v[88:91], v[184:187]
  v_mfma_f32_16x16x32_bf16 v[164:167], v[56:59], v[92:95], v[164:167]
  v_mfma_f32_16x16x32_bf16 v[172:175], v[60:63], v[92:95], v[172:175]
  v_mfma_f32_16x16x32_bf16 v[180:183], v[64:67], v[92:95], v[180:183]
  v_mfma_f32_16x16x32_bf16 v[188:191], v[68:71], v[92:95], v[188:191]
  s_waitcnt lgkmcnt(13)
  v_mfma_f32_16x16x32_bf16 v[96:99], v[32:35], v[16:19], v[96:99]
  ds_read_b128 v[56:59], v7 offset:0
  s_waitcnt lgkmcnt(13)
  v_mfma_f32_16x16x32_bf16 v[104:107], v[32:35], v[20:23], v[104:107]
  ds_read_b64_tr_b16 v[72:73], v10 offset:12288
  s_waitcnt lgkmcnt(13)
  v_mfma_f32_16x16x32_bf16 v[112:115], v[32:35], v[24:27], v[112:115]
  ds_read_b64_tr_b16 v[74:75], v10 offset:12800
  s_waitcnt lgkmcnt(13)
  v_mfma_f32_16x16x32_bf16 v[120:123], v[32:35], v[28:31], v[120:123]
  ds_read_b128 v[60:63], v7 offset:2048
  s_waitcnt lgkmcnt(12)
  v_mfma_f32_16x16x32_bf16 v[100:103], v[36:39], v[16:19], v[100:103]
  ds_read_b128 v[64:67], v7 offset:4096
  v_mfma_f32_16x16x32_bf16 v[108:111], v[36:39], v[20:23], v[108:111]
  ds_read_b128 v[68:71], v7 offset:6144
  v_mfma_f32_16x16x32_bf16 v[116:119], v[36:39], v[24:27], v[116:119]
  ds_read_b64_tr_b16 v[76:77], v11 offset:12288
  v_mfma_f32_16x16x32_bf16 v[124:127], v[36:39], v[28:31], v[124:127]
  ds_read_b64_tr_b16 v[78:79], v11 offset:12800
  s_waitcnt lgkmcnt(14)
  v_mfma_f32_16x16x32_bf16 v[128:131], v[16:19], v[40:43], v[128:131]
  ds_read_b64_tr_b16 v[80:81], v10 offset:14336
  v_mfma_f32_16x16x32_bf16 v[136:139], v[20:23], v[40:43], v[136:139]
  ds_read_b64_tr_b16 v[82:83], v10 offset:14848
  v_mfma_f32_16x16x32_bf16 v[144:147], v[24:27], v[40:43], v[144:147]
  ds_read_b64_tr_b16 v[84:85], v11 offset:14336
  v_mfma_f32_16x16x32_bf16 v[152:155], v[28:31], v[40:43], v[152:155]
  ds_read_b64_tr_b16 v[86:87], v11 offset:14848
  s_waitcnt lgkmcnt(15)
  v_mfma_f32_16x16x32_bf16 v[132:135], v[16:19], v[44:47], v[132:135]
  ds_read_b64_tr_b16 v[88:89], v10 offset:16384
  v_mfma_f32_16x16x32_bf16 v[140:143], v[20:23], v[44:47], v[140:143]
  ds_read_b64_tr_b16 v[90:91], v10 offset:16896
  v_mfma_f32_16x16x32_bf16 v[148:151], v[24:27], v[44:47], v[148:151]
  ds_read_b64_tr_b16 v[92:93], v11 offset:16384
  v_mfma_f32_16x16x32_bf16 v[156:159], v[28:31], v[44:47], v[156:159]
  ds_read_b64_tr_b16 v[94:95], v11 offset:16896
  s_waitcnt lgkmcnt(15)
  v_mfma_f32_16x16x32_bf16 v[160:163], v[16:19], v[48:51], v[160:163]
  v_mfma_f32_16x16x32_bf16 v[168:171], v[20:23], v[48:51], v[168:171]
  v_mfma_f32_16x16x32_bf16 v[176:179], v[24:27], v[48:51], v[176:179]
  v_mfma_f32_16x16x32_bf16 v[184:187], v[28:31], v[48:51], v[184:187]
  v_mfma_f32_16x16x32_bf16 v[164:167], v[16:19], v[52:55], v[164:167]
  v_mfma_f32_16x16x32_bf16 v[172:175], v[20:23], v[52:55], v[172:175]
  v_mfma_f32_16x16x32_bf16 v[180:183], v[24:27], v[52:55], v[180:183]
  v_mfma_f32_16x16x32_bf16 v[188:191], v[28:31], v[52:55], v[188:191]
  s_waitcnt lgkmcnt(0)
  s_barrier
  s_sub_u32 s55, s55, 1
  s_cbranch_scc1 K3_event2
K3_noev2:
  s_sub_u32 s70, s70, 1
  s_cbranch_scc1 K3_evB2
K3_noevB2:
  s_sub_u32 s71, s71, 1
  s_cbranch_scc1 K3_evC2
K3_noevC2:
  v_mfma_f32_16x16x32_bf16 v[96:99], v[72:75], v[56:59], v[96:99]
  ds_read_b128 v[16:19], v6 offset:40960
  v_mfma_f32_16x16x32_bf16 v[104:107], v[72:75], v[60:63], v[104:107]
  ds_read_b64_tr_b16 v[32:33], v10 offset:40960
  v_mfma_f32_16x16x32_bf16 v[112:115], v[72:75], v[64:67], v[112:115]
  ds_read_b64_tr_b16 v[34:35], v10 offset:41472
  v_mfma_f32_16x16x32_bf16 v[120:123], v[72:75], v[68:71], v[120:123]
  ds_read_b128 v[20:23], v6 offset:43008
  v_mfma_f32_16x16x32_bf16 v[100:103], v[76:79], v[56:59], v[100:103]
  ds_read_b128 v[24:27], v6 offset:45056
  v_mfma_f32_16x16x32_bf16 v[108:111], v[76:79], v[60:63], v[108:111]
  ds_read_b128 v[28:31], v6 offset:47104
  v_mfma_f32_16x16x32_bf16 v[116:119], v[76:79], v[64:67], v[116:119]
  ds_read_b64_tr_b16 v[36:37], v11 offset:40960
  v_mfma_f32_16x16x32_bf16 v[124:127], v[76:79], v[68:71], v[124:127]
  ds_read_b64_tr_b16 v[38:39], v11 offset:41472
  v_mfma_f32_16x16x32_bf16 v[128:131], v[56:59], v[80:83], v[128:131]
  ds_read_b64_tr_b16 v[40:41], v10 offset:43008
  v_mfma_f32_16x16x32_bf16 v[136:139], v[60:63], v[80:83], v[136:139]
  ds_read_b64_tr_b16 v[42:43], v10 offset:43520
  v_mfma_f32_16x16x32_bf16 v[144:147], v[64:67], v[80:83], v[144:147]
  ds_read_b64_tr_b16 v[44:45], v11 offset:43008
  v_mfma_f32_16x16x32_bf16 v[152:155], v[68:71], v[80:83], v[152:155]
  ds_read_b64_tr_b16 v[46:47], v11 offset:43520
  v_mfma_f32_16x16x32_bf16 v[132:135], v[56:59], v[84:87], v[132:135]
  ds_read_b64_tr_b16 v[48:49], v10 offset:45056
  v_mfma_f32_16x16x32_bf16 v[140:143], v[60:63], v[84:87], v[140:143]
  ds_read_b64_tr_b16 v[50:51], v10 offset:45568
  v_mfma_f32_16x16x32_bf16 v[148:151], v[64:67], v[84:87], v[148:151]
  ds_read_b64_tr_b16 v[52:53], v11 offset:45056
  v_mfma_f32_16x16x32_bf16 v[156:159], v[68:71], v[84:87], v[156:159]
  ds_read_b64_tr_b16 v[54:55], v11 offset:45568
  v_mfma_f32_16x16x32_bf16 v[160:163], v[56:59], v[88:91], v[160:163]
  v_mfma_f32_16x16x32_bf16 v[168:171], v[60:63], v[88:91], v[168:171]
  v_mfma_f32_16x16x32_bf16 v[176:179], v[64:67], v[88:91], v[176:179]
  v_mfma_f32_16x16x32_bf16 v[184:187], v[68:71], v[88:91], v[184:187]
  v_mfma_f32_16x16x32_bf16 v[164:167], v[56:59], v[92:95], v[164:167]
  v_mfma_f32_16x16x32_bf16 v[172:175], v[60:63], v[92:95], v[172:175]
  v_mfma_f32_16x16x32_bf16 v[180:183], v[64:67], v[92:95], v[180:183]
  v_mfma_f32_16x16x32_bf16 v[188:191], v[68:71], v[92:95], v[188:191]
  s_waitcnt lgkmcnt(13)
  v_mfma_f32_16x16x32_bf16 v[96:99], v[32:35], v[16:19], v[96:99]
  ds_read_b128 v[56:59], v7 offset:40960
  s_waitcnt lgkmcnt(13)
  v_mfma_f32_16x16x32_bf16 v[104:107], v[32:35], v[20:23], v[104:107]
  ds_read_b64_tr_b16 v[72:73], v10 offset:53248
  s_waitcnt lgkmcnt(13)
  v_mfma_f32_16x16x32_bf16 v[112:115], v[32:35], v[24:27], v[112:115]
  ds_read_b64_tr_b16 v[74:75], v10 offset:53760
  s_waitcnt lgkmcnt(13)
  v_mfma_f32_16x16x32_bf16 v[120:123], v[32:35], v[28:31], v[120:123]
  ds_read_b128 v[60:63], v7 offset:43008
  s_waitcnt lgkmcnt(12)
  v_mfma_f32_16x16x32_bf16 v[100:103], v[36:39], v[16:19], v[100:103]
  ds_read_b128 v[64:67], v7 offset:45056
  v_mfma_f32_16x16x32_bf16 v[108:111], v[36:39], v[20:23], v[108:111]
  ds_read_b128 v[68:71], v7 offset:47104
  v_mfma_f32_16x16x32_bf16 v[116:119], v[36:39], v[24:27], v[116:119]
  ds_read_b64_tr_b16 v[76:77], v11 offset:53248
  v_mfma_f32_16x16x32_bf16 v[124:127], v[36:39], v[28:31], v[124:127]
  ds_read_b64_tr_b16 v[78:79], v11 offset:53760
  s_waitcnt lgkmcnt(14)
  v_mfma_f32_16x16x32_bf16 v[128:131], v[16:19], v[40:43], v[128:131]
  ds_read_b64_tr_b16 v[80:81], v10 offset:55296
  v_mfma_f32_16x16x32_bf16 v[136:139], v[20:23], v[40:43], v[136:139]
  ds_read_b64_tr_b16 v[82:83], v10 offset:55808
  v_mfma_f32_16x16x32_bf16 v[144:147], v[24:27], v[40:43], v[144:147]
  ds_read_b64_tr_b16 v[84:85], v11 offset:55296
  v_mfma_f32_16x16x32_bf16 v[152:155], v[28:31], v[40:43], v[152:155]
  ds_read_b64_tr_b16 v[86:87], v11 offset:55808
  s_waitcnt lgkmcnt(15)
  v_mfma_f32_16x16x32_bf16 v[132:135], v[16:19], v[44:47], v[132:135]
  ds_read_b64_tr_b16 v[88:89], v10 offset:57344
  v_mfma_f32_16x16x32_bf16 v[140:143], v[20:23], v[44:47], v[140:143]
  ds_read_b64_tr_b16 v[90:91], v10 offset:57856
  v_mfma_f32_16x16x32_bf16 v[148:151], v[24:27], v[44:47], v[148:151]
  ds_read_b64_tr_b16 v[92:93], v11 offset:57344
  v_mfma_f32_16x16x32_bf16 v[156:159], v[28:31], v[44:47], v[156:159]
  ds_read_b64_tr_b16 v[94:95], v11 offset:57856
  s_waitcnt lgkmcnt(15)
  v_mfma_f32_16x16x32_bf16 v[160:163], v[16:19], v[48:51], v[160:163]
  v_mfma_f32_16x16x32_bf16 v[168:171], v[20:23], v[48:51], v[168:171]
  v_mfma_f32_16x16x32_bf16 v[176:179], v[24:27], v[48:51], v[176:179]
  v_mfma_f32_16x16x32_bf16 v[184:187], v[28:31], v[48:51], v[184:187]
  v_mfma_f32_16x16x32_bf16 v[164:167], v[16:19], v[52:55], v[164:167]
  v_mfma_f32_16x16x32_bf16 v[172:175], v[20:23], v[52:55], v[172:175]
  v_mfma_f32_16x16x32_bf16 v[180:183], v[24:27], v[52:55], v[180:183]
  v_mfma_f32_16x16x32_bf16 v[188:191], v[28:31], v[52:55], v[188:191]
  s_waitcnt lgkmcnt(0)
  s_barrier
  s_sub_u32 s55, s55, 1
  s_cbranch_scc1 K3_event3
K3_noev3:
  s_sub_u32 s70, s70, 1
  s_cbranch_scc1 K3_evB3
K3_noevB3:
  s_sub_u32 s71, s71, 1
  s_cbranch_scc1 K3_evC3
K3_noevC3:
  v_mfma_f32_16x16x32_bf16 v[96:99], v[72:75], v[56:59], v[96:99]
  ds_read_b128 v[16:19], v4 offset:0
  v_mfma_f32_16x16x32_bf16 v[104:107], v[72:75], v[60:63], v[104:107]
  ds_read_b64_tr_b16 v[32:33], v8 offset:0
  v_mfma_f32_16x16x32_bf16 v[112:115], v[72:75], v[64:67], v[112:115]
  ds_read_b64_tr_b16 v[34:35], v8 offset:512
  v_mfma_f32_16x16x32_bf16 v[120:123], v[72:75], v[68:71], v[120:123]
  ds_read_b128 v[20:23], v4 offset:2048
  v_mfma_f32_16x16x32_bf16 v[100:103], v[76:79], v[56:59], v[100:103]
  ds_read_b128 v[24:27], v4 offset:4096
  v_mfma_f32_16x16x32_bf16 v[108:111], v[76:79], v[60:63], v[108:111]
  ds_read_b128 v[28:31], v4 offset:6144
  v_mfma_f32_16x16x32_bf16 v[116:119], v[76:79], v[64:67], v[116:119]
  ds_read_b64_tr_b16 v[36:37], v9 offset:0
  v_mfma_f32_16x16x32_bf16 v[124:127], v[76:79], v[68:71], v[124:127]
  ds_read_b64_tr_b16 v[38:39], v9 offset:512
  v_mfma_f32_16x16x32_bf16 v[128:131], v[56:59], v[80:83], v[128:131]
  ds_read_b64_tr_b16 v[40:41], v8 offset:2048
  v_mfma_f32_16x16x32_bf16 v[136:139], v[60:63], v[80:83], v[136:139]
  ds_read_b64_tr_b16 v[42:43], v8 offset:2560
  v_mfma_f32_16x16x32_bf16 v[144:147], v[64:67], v[80:83], v[144:147]
  ds_read_b64_tr_b16 v[44:45], v9 offset:2048
  v_mfma_f32_16x16x32_bf16 v[152:155], v[68:71], v[80:83], v[152:155]
  ds_read_b64_tr_b16 v[46:47], v9 offset:2560
  v_mfma_f32_16x16x32_bf16 v[132:135], v[56:59], v[84:87], v[132:135]
  ds_read_b64_tr_b16 v[48:49], v8 offset:4096
  v_mfma_f32_16x16x32_bf16 v[140:143], v[60:63], v[84:87], v[140:143]
  ds_read_b64_tr_b16 v[50:51], v8 offset:4608
  v_mfma_f32_16x16x32_bf16 v[148:151], v[64:67], v[84:87], v[148:151]
  ds_read_b64_tr_b16 v[52:53], v9 offset:4096
  v_mfma_f32_16x16x32_bf16 v[156:159], v[68:71], v[84:87], v[156:159]
  ds_read_b64_tr_b16 v[54:55], v9 offset:4608
  v_mfma_f32_16x16x32_bf16 v[160:163], v[56:59], v[88:91], v[160:163]
  v_mfma_f32_16x16x32_bf16 v[168:171], v[60:63], v[88:91], v[168:171]
  v_mfma_f32_16x16x32_bf16 v[176:179], v[64:67], v[88:91], v[176:179]
  v_mfma_f32_16x16x32_bf16 v[184:187], v[68:71], v[88:91], v[184:187]
  v_mfma_f32_16x16x32_bf16 v[164:167], v[56:59], v[92:95], v[164:167]
  v_mfma_f32_16x16x32_bf16 v[172:175], v[60:63], v[92:95], v[172:175]
  v_mfma_f32_16x16x32_bf16 v[180:183], v[64:67], v[92:95], v[180:183]
  v_mfma_f32_16x16x32_bf16 v[188:191], v[68:71], v[92:95], v[188:191]
  s_sub_u32 s39, s39, 1
  s_cmp_lg_u32 s39, 0
  s_waitcnt lgkmcnt(0)
  s_cbranch_scc1 K3_loop
  s_mov_b32 s44, 1069066811
  s_mov_b32 s45, 1069066811
  s_mov_b32 s46, 897988541
  s_mov_b32 s47, 897988541
  v_mov_b32 v10, 39168
  v_mov_b32 v11, 1
  v_cvt_pk_bf16_f32 v16, v160, v161
  v_cvt_pk_bf16_f32 v17, v162, v163
  v_cvt_pk_bf16_f32 v18, v168, v169
  v_cvt_pk_bf16_f32 v19, v170, v171
  v_cvt_pk_bf16_f32 v20, v176, v177
  v_cvt_pk_bf16_f32 v21, v178, v179
  v_cvt_pk_bf16_f32 v22, v184, v185
  v_cvt_pk_bf16_f32 v23, v186, v187
  v_cvt_pk_bf16_f32 v24, v164, v165
  v_cvt_pk_bf16_f32 v25, v166, v167
  v_cvt_pk_bf16_f32 v26, v172, v173
  v_cvt_pk_bf16_f32 v27, v174, v175
  v_cvt_pk_bf16_f32 v28, v180, v181
  v_cvt_pk_bf16_f32 v29, v182, v183
  v_cvt_pk_bf16_f32 v30, v188, v189
  v_cvt_pk_bf16_f32 v31, v190, v191
  v_mov_b32 v48, 0x3f803f80
  v_mov_b32 v49, 0x3f803f80
  v_mov_b32 v50, 0x3f803f80
  v_mov_b32 v51, 0x3f803f80
  v_cvt_pk_bf16_f32 v52, v128, v129
  v_cvt_pk_bf16_f32 v53, v130, v131
  v_cvt_pk_bf16_f32 v54, v136, v137
  v_cvt_pk_bf16_f32 v55, v138, v139
  v_lshlrev_b32 v56, 16, v52
  v_and_b32 v57, 0xffff0000, v52
  v_lshlrev_b32 v58, 16, v53
  v_and_b32 v59, 0xffff0000, v53
  v_lshlrev_b32 v60, 16, v54
  v_and_b32 v61, 0xffff0000, v54
  v_lshlrev_b32 v62, 16, v55
  v_and_b32 v63, 0xffff0000, v55
  v_min_f32 v64, 0, v56
  v_min_f32 v65, 0, v57
  v_min_f32 v66, 0, v58
  v_min_f32 v67, 0, v59
  v_min_f32 v68, 0, v60
  v_min_f32 v69, 0, v61
  v_min_f32 v70, 0, v62
  v_min_f32 v71, 0, v63
  v_pk_mul_f32 v[72:73], v[64:65], s[44:45]
  v_pk_mul_f32 v[74:75], v[66:67], s[44:45]
  v_pk_mul_f32 v[76:77], v[68:69], s[44:45]
  v_pk_mul_f32 v[78:79], v[70:71], s[44:45]
  v_exp_f32 v72, v72
  v_exp_f32 v73, v73
  v_exp_f32 v74, v74
  v_exp_f32 v75, v75
  v_exp_f32 v76, v76
  v_exp_f32 v77, v77
  v_exp_f32 v78, v78
  v_exp_f32 v79, v79
  v_pk_add_f32 v[56:57], v[56:57], v[64:65] neg_lo:[0,1] neg_hi:[0,1]
  v_pk_add_f32 v[58:59], v[58:59], v[66:67] neg_lo:[0,1] neg_hi:[0,1]
  v_pk_add_f32 v[60:61], v[60:61], v[68:69] neg_lo:[0,1] neg_hi:[0,1]
  v_pk_add_f32 v[62:63], v[62:63], v[70:71] neg_lo:[0,1] neg_hi:[0,1]
  v_pk_add_f32 v[56:57], v[56:57], v[72:73]
  v_pk_add_f32 v[58:59], v[58:59], v[74:75]
  v_pk_add_f32 v[60:61], v[60:61], v[76:77]
  v_pk_add_f32 v[62:63], v[62:63], v[78:79]
  v_pk_add_f32 v[56:57], v[56:57], s[46:47]
  v_pk_add_f32 v[58:59], v[58:59], s[46:47]
  v_pk_add_f32 v[60:61], v[60:61], s[46:47]
  v_pk_add_f32 v[62:63], v[62:63], s[46:47]
  v_cvt_pk_bf16_f32 v32, v56, v57
  v_cvt_pk_bf16_f32 v33, v58, v59
  v_cvt_pk_bf16_f32 v34, v60, v61
  v_cvt_pk_bf16_f32 v35, v62, v63
  s_nop 1
  v_mfma_f32_16x16x32_bf16 v[160:163], v[32:35], v[16:19], 0
  v_mfma_f32_16x16x32_bf16 v[168:171], v[32:35], v[24:27], 0
  v_mfma_f32_16x16x32_bf16 v[176:179], v[32:35], v[48:51], 0
  v_cvt_pk_bf16_f32 v52, v132, v133
  v_cvt_pk_bf16_f32 v53, v134, v135
  v_cvt_pk_bf16_f32 v54, v140, v141
  v_cvt_pk_bf16_f32 v55, v142, v143
  v_lshlrev_b32 v56, 16, v52
  v_and_b32 v57, 0xffff0000, v52
  v_lshlrev_b32 v58, 16, v53
  v_and_b32 v59, 0xffff0000, v53
  v_lshlrev_b32 v60, 16, v54
  v_and_b32 v61, 0xffff0000, v54
  v_lshlrev_b32 v62, 16, v55
  v_and_b32 v63, 0xffff0000, v55
  v_min_f32 v64, 0, v56
  v_min_f32 v65, 0, v57
  v_min_f32 v66, 0, v58
  v_min_f32 v67, 0, v59
  v_min_f32 v68, 0, v60
  v_min_f32 v69, 0, v61
  v_min_f32 v70, 0, v62
  v_min_f32 v71, 0, v63
  v_pk_mul_f32 v[72:73], v[64:65], s[44:45]
  v_pk_mul_f32 v[74:75], v[66:67], s[44:45]
  v_pk_mul_f32 v[76:77], v[68:69], s[44:45]
  v_pk_mul_f32 v[78:79], v[70:71], s[44:45]
  v_exp_f32 v72, v72
  v_exp_f32 v73, v73
  v_exp_f32 v74, v74
  v_exp_f32 v75, v75
  v_exp_f32 v76, v76
  v_exp_f32 v77, v77
  v_exp_f32 v78, v78
  v_exp_f32 v79, v79
  v_pk_add_f32 v[56:57], v[56:57], v[64:65] neg_lo:[0,1] neg_hi:[0,1]
  v_pk_add_f32 v[58:59], v[58:59], v[66:67] neg_lo:[0,1] neg_hi:[0,1]
  v_pk_add_f32 v[60:61], v[60:61], v[68:69] neg_lo:[0,1] neg_hi:[0,1]
  v_pk_add_f32 v[62:63], v[62:63], v[70:71] neg_lo:[0,1] neg_hi:[0,1]
  v_pk_add_f32 v[56:57], v[56:57], v[72:73]
  v_pk_add_f32 v[58:59], v[58:59], v[74:75]
  v_pk_add_f32 v[60:61], v[60:61], v[76:77]
  v_pk_add_f32 v[62:63], v[62:63], v[78:79]
  v_pk_add_f32 v[56:57], v[56:57], s[46:47]
  v_pk_add_f32 v[58:59], v[58:59], s[46:47]
  v_pk_add_f32 v[60:61], v[60:61], s[46:47]
  v_pk_add_f32 v[62:63], v[62:63], s[46:47]
  v_cvt_pk_bf16_f32 v40, v56, v57
  v_cvt_pk_bf16_f32 v41, v58, v59
  v_cvt_pk_bf16_f32 v42, v60, v61
  v_cvt_pk_bf16_f32 v43, v62, v63
  s_nop 1
  v_mfma_f32_16x16x32_bf16 v[164:167], v[40:43], v[16:19], 0
  v_mfma_f32_16x16x32_bf16 v[172:175], v[40:43], v[24:27], 0
  v_mfma_f32_16x16x32_bf16 v[180:183], v[40:43], v[48:51], 0
  v_cvt_pk_bf16_f32 v52, v144, v145
  v_cvt_pk_bf16_f32 v53, v146, v147
  v_cvt_pk_bf16_f32 v54, v152, v153
  v_cvt_pk_bf16_f32 v55, v154, v155
  v_lshlrev_b32 v56, 16, v52
  v_and_b32 v57, 0xffff0000, v52
  v_lshlrev_b32 v58, 16, v53
  v_and_b32 v59, 0xffff0000, v53
  v_lshlrev_b32 v60, 16, v54
  v_and_b32 v61, 0xffff0000, v54
  v_lshlrev_b32 v62, 16, v55
  v_and_b32 v63, 0xffff0000, v55
  v_min_f32 v64, 0, v56
  v_min_f32 v65, 0, v57
  v_min_f32 v66, 0, v58
  v_min_f32 v67, 0, v59
  v_min_f32 v68, 0, v60
  v_min_f32 v69, 0, v61
  v_min_f32 v70, 0, v62
  v_min_f32 v71, 0, v63
  v_pk_mul_f32 v[72:73], v[64:65], s[44:45]
  v_pk_mul_f32 v[74:75], v[66:67], s[44:45]
  v_pk_mul_f32 v[76:77], v[68:69], s[44:45]
  v_pk_mul_f32 v[78:79], v[70:71], s[44:45]
  v_exp_f32 v72, v72
  v_exp_f32 v73, v73
  v_exp_f32 v74, v74
  v_exp_f32 v75, v75
  v_exp_f32 v76, v76
  v_exp_f32 v77, v77
  v_exp_f32 v78, v78
  v_exp_f32 v79, v79
  v_pk_add_f32 v[56:57], v[56:57], v[64:65] neg_lo:[0,1] neg_hi:[0,1]
  v_pk_add_f32 v[58:59], v[58:59], v[66:67] neg_lo:[0,1] neg_hi:[0,1]
  v_pk_add_f32 v[60:61], v[60:61], v[68:69] neg_lo:[0,1] neg_hi:[0,1]
  v_pk_add_f32 v[62:63], v[62:63], v[70:71] neg_lo:[0,1] neg_hi:[0,1]
  v_pk_add_f32 v[56:57], v[56:57], v[72:73]
  v_pk_add_f32 v[58:59], v[58:59], v[74:75]
  v_pk_add_f32 v[60:61], v[60:61], v[76:77]
  v_pk_add_f32 v[62:63], v[62:63], v[78:79]
  v_pk_add_f32 v[56:57], v[56:57], s[46:47]
  v_pk_add_f32 v[58:59], v[58:59], s[46:47]
  v_pk_add_f32 v[60:61], v[60:61], s[46:47]
  v_pk_add_f32 v[62:63], v[62:63], s[46:47]
  v_cvt_pk_bf16_f32 v36, v56, v57
  v_cvt_pk_bf16_f32 v37, v58, v59
  v_cvt_pk_bf16_f32 v38, v60, v61
  v_cvt_pk_bf16_f32 v39, v62, v63
  s_nop 1
  v_mfma_f32_16x16x32_bf16 v[160:163], v[36:39], v[20:23], v[160:163]
  v_mfma_f32_16x16x32_bf16 v[168:171], v[36:39], v[28:31], v[168:171]
  v_mfma_f32_16x16x32_bf16 v[176:179], v[36:39], v[48:51], v[176:179]
  v_cvt_pk_bf16_f32 v52, v148, v149
  v_cvt_pk_bf16_f32 v53, v150, v151
  v_cvt_pk_bf16_f32 v54, v156, v157
  v_cvt_pk_bf16_f32 v55, v158, v159
  v_lshlrev_b32 v56, 16, v52
  v_and_b32 v57, 0xffff0000, v52
  v_lshlrev_b32 v58, 16, v53
  v_and_b32 v59, 0xffff0000, v53
  v_lshlrev_b32 v60, 16, v54
  v_and_b32 v61, 0xffff0000, v54
  v_lshlrev_b32 v62, 16, v55
  v_and_b32 v63, 0xffff0000, v55
  v_min_f32 v64, 0, v56
  v_min_f32 v65, 0, v57
  v_min_f32 v66, 0, v58
  v_min_f32 v67, 0, v59
  v_min_f32 v68, 0, v60
  v_min_f32 v69, 0, v61
  v_min_f32 v70, 0, v62
  v_min_f32 v71, 0, v63
  v_pk_mul_f32 v[72:73], v[64:65], s[44:45]
  v_pk_mul_f32 v[74:75], v[66:67], s[44:45]
  v_pk_mul_f32 v[76:77], v[68:69], s[44:45]
  v_pk_mul_f32 v[78:79], v[70:71], s[44:45]
  v_exp_f32 v72, v72
  v_exp_f32 v73, v73
  v_exp_f32 v74, v74
  v_exp_f32 v75, v75
  v_exp_f32 v76, v76
  v_exp_f32 v77, v77
  v_exp_f32 v78, v78
  v_exp_f32 v79, v79
  v_pk_add_f32 v[56:57], v[56:57], v[64:65] neg_lo:[0,1] neg_hi:[0,1]
  v_pk_add_f32 v[58:59], v[58:59], v[66:67] neg_lo:[0,1] neg_hi:[0,1]
  v_pk_add_f32 v[60:61], v[60:61], v[68:69] neg_lo:[0,1] neg_hi:[0,1]
  v_pk_add_f32 v[62:63], v[62:63], v[70:71] neg_lo:[0,1] neg_hi:[0,1]
  v_pk_add_f32 v[56:57], v[56:57], v[72:73]
  v_pk_add_f32 v[58:59], v[58:59], v[74:75]
  v_pk_add_f32 v[60:61], v[60:61], v[76:77]
  v_pk_add_f32 v[62:63], v[62:63], v[78:79]
  v_pk_add_f32 v[56:57], v[56:57], s[46:47]
  v_pk_add_f32 v[58:59], v[58:59], s[46:47]
  v_pk_add_f32 v[60:61], v[60:61], s[46:47]
  v_pk_add_f32 v[62:63], v[62:63], s[46:47]
  v_cvt_pk_bf16_f32 v44, v56, v57
  v_cvt_pk_bf16_f32 v45, v58, v59
  v_cvt_pk_bf16_f32 v46, v60, v61
  v_cvt_pk_bf16_f32 v47, v62, v63
  s_nop 1
  v_mfma_f32_16x16x32_bf16 v[164:167], v[44:47], v[20:23], v[164:167]
  v_mfma_f32_16x16x32_bf16 v[172:175], v[44:47], v[28:31], v[172:175]
  v_mfma_f32_16x16x32_bf16 v[180:183], v[44:47], v[48:51], v[180:183]
  s_lshl_b32 s43, s37, 12
  s_add_u32 s43, s43, 155648
  v_add_u32 v4, s43, v3
  s_lshl_b32 s43, s37, 7
  s_add_u32 s43, s43, 39424
  v_lshlrev_b32 v5, 5, v14
  v_add_u32 v5, s43, v5
  s_lshl_b32 s43, s37, 2
  v_add_u32 v6, s43, v10
  s_cmp_eq_u32 s36, 0
  s_cbranch_scc1 K3_wr0
  ds_write_b128 v4, v[160:163] offset:0
  ds_write_b128 v4, v[164:167] offset:1024
  ds_write_b128 v4, v[168:171] offset:2048
  ds_write_b128 v4, v[172:175] offset:3072
  ds_write_b128 v5, v[176:179] offset:0
  ds_write_b128 v5, v[180:183] offset:16
  s_waitcnt lgkmcnt(0)
  s_mov_b64 exec, 1
  ds_add_u32 v6, v11 offset:0
  s_mov_b64 exec, -1
  s_branch K3_q
K3_wr0:
  s_lshl_b32 s48, s5, 4
  s_add_u32 s48, s48, s12
  s_lshl_b32 s49, s48, 12
  s_lshl_b32 s50, s48, 7
  v_lshlrev_b32 v7, 4, v14
  s_mov_b32 s43, 131072
K3_wx:
  ds_read_b32 v8, v6 offset:0
  s_waitcnt lgkmcnt(0)
  v_readfirstlane_b32 s42, v8
  s_sub_u32 s43, s43, 1
  s_cbranch_scc1 K3_wx_ok
  s_cmp_lt_u32 s42, 1
  s_cbranch_scc1 K3_wx
K3_wx_ok:
  ds_read_b128 v[16:19], v4 offset:0
  ds_read_b128 v[20:23], v4 offset:1024
  ds_read_b128 v[24:27], v4 offset:2048
  ds_read_b128 v[28:31], v4 offset:3072
  ds_read_b128 v[32:35], v5 offset:0
  ds_read_b128 v[36:39], v5 offset:16
  s_waitcnt lgkmcnt(5)
  v_pk_add_f32 v[160:161], v[160:161], v[16:17]
  v_pk_add_f32 v[162:163], v[162:163], v[18:19]
  v_or_b32 v160, 1, v160
  v_or_b32 v161, 1, v161
  v_or_b32 v162, 1, v162
  v_or_b32 v163, 1, v163
  buffer_store_dwordx4 v[160:163], v3, s[28:31], s49 offen offset:0 sc1
  s_waitcnt lgkmcnt(4)
  v_pk_add_f32 v[164:165], v[164:165], v[20:21]
  v_pk_add_f32 v[166:167], v[166:167], v[22:23]
  v_or_b32 v164, 1, v164
  v_or_b32 v165, 1, v165
  v_or_b32 v166, 1, v166
  v_or_b32 v167, 1, v167
  buffer_store_dwordx4 v[164:167], v3, s[28:31], s49 offen offset:1024 sc1
  s_waitcnt lgkmcnt(3)
  v_pk_add_f32 v[168:169], v[168:169], v[24:25]
  v_pk_add_f32 v[170:171], v[170:171], v[26:27]
  v_or_b32 v168, 1, v168
  v_or_b32 v169, 1, v169
  v_or_b32 v170, 1, v170
  v_or_b32 v171, 1, v171
  buffer_store_dwordx4 v[168:171], v3, s[28:31], s49 offen offset:2048 sc1
  s_waitcnt lgkmcnt(2)
  v_pk_add_f32 v[172:173], v[172:173], v[28:29]
  v_pk_add_f32 v[174:175], v[174:175], v[30:31]
  v_or_b32 v172, 1, v172
  v_or_b32 v173, 1, v173
  v_or_b32 v174, 1, v174
  v_or_b32 v175, 1, v175
  buffer_store_dwordx4 v[172:175], v3, s[28:31], s49 offen offset:3072 sc1
  s_waitcnt lgkmcnt(1)
  v_pk_add_f32 v[176:177], v[176:177], v[32:33]
  v_pk_add_f32 v[178:179], v[178:179], v[34:35]
  v_or_b32 v176, 1, v176
  v_or_b32 v177, 1, v177
  v_or_b32 v178, 1, v178
  v_or_b32 v179, 1, v179
  s_waitcnt lgkmcnt(0)
  v_pk_add_f32 v[180:181], v[180:181], v[36:37]
  v_pk_add_f32 v[182:183], v[182:183], v[38:39]
  v_or_b32 v180, 1, v180
  v_or_b32 v181, 1, v181
  v_or_b32 v182, 1, v182
  v_or_b32 v183, 1, v183
  s_mov_b32 exec_lo, 0x00010001
  s_mov_b32 exec_hi, 0x00010001
  buffer_store_dwordx4 v[176:179], v7, s[32:35], s50 offen offset:0 sc1
  buffer_store_dwordx4 v[180:183], v7, s[32:35], s50 offen offset:64 sc1
  s_mov_b64 exec, -1
  s_mov_b64 exec, 1
  ds_add_u32 v10, v11 offset:84
  s_mov_b64 exec, -1
K3_q:
  s_lshl_b32 s43, s3, 12
  s_add_u32 s43, s43, 139264
  v_add_u32 v4, s43, v3
  v_cvt_pk_bf16_f32 v52, v96, v97
  v_cvt_pk_bf16_f32 v53, v98, v99
  v_cvt_pk_bf16_f32 v54, v100, v101
  v_cvt_pk_bf16_f32 v55, v102, v103
  v_lshlrev_b32 v56, 16, v52
  v_and_b32 v57, 0xffff0000, v52
  v_lshlrev_b32 v58, 16, v53
  v_and_b32 v59, 0xffff0000, v53
  v_lshlrev_b32 v60, 16, v54
  v_and_b32 v61, 0xffff0000, v54
  v_lshlrev_b32 v62, 16, v55
  v_and_b32 v63, 0xffff0000, v55
  v_min_f32 v64, 0, v56
  v_min_f32 v65, 0, v57
  v_min_f32 v66, 0, v58
  v_min_f32 v67, 0, v59
  v_min_f32 v68, 0, v60
  v_min_f32 v69, 0, v61
  v_min_f32 v70, 0, v62
  v_min_f32 v71, 0, v63
  v_pk_mul_f32 v[72:73], v[64:65], s[44:45]
  v_pk_mul_f32 v[74:75], v[66:67], s[44:45]
  v_pk_mul_f32 v[76:77], v[68:69], s[44:45]
  v_pk_mul_f32 v[78:79], v[70:71], s[44:45]
  v_exp_f32 v72, v72
  v_exp_f32 v73, v73
  v_exp_f32 v74, v74
  v_exp_f32 v75, v75
  v_exp_f32 v76, v76
  v_exp_f32 v77, v77
  v_exp_f32 v78, v78
  v_exp_f32 v79, v79
  v_pk_add_f32 v[56:57], v[56:57], v[64:65] neg_lo:[0,1] neg_hi:[0,1]
  v_pk_add_f32 v[58:59], v[58:59], v[66:67] neg_lo:[0,1] neg_hi:[0,1]
  v_pk_add_f32 v[60:61], v[60:61], v[68:69] neg_lo:[0,1] neg_hi:[0,1]
  v_pk_add_f32 v[62:63], v[62:63], v[70:71] neg_lo:[0,1] neg_hi:[0,1]
  v_pk_add_f32 v[56:57], v[56:57], v[72:73]
  v_pk_add_f32 v[58:59], v[58:59], v[74:75]
  v_pk_add_f32 v[60:61], v[60:61], v[76:77]
  v_pk_add_f32 v[62:63], v[62:63], v[78:79]
  v_pk_add_f32 v[56:57], v[56:57], s[46:47]
  v_pk_add_f32 v[58:59], v[58:59], s[46:47]
  v_pk_add_f32 v[60:61], v[60:61], s[46:47]
  v_pk_add_f32 v[62:63], v[62:63], s[46:47]
  v_cvt_pk_bf16_f32 v80, v56, v57
  v_cvt_pk_bf16_f32 v81, v58, v59
  v_cvt_pk_bf16_f32 v82, v60, v61
  v_cvt_pk_bf16_f32 v83, v62, v63
  ds_write_b128 v4, v[80:83] offset:0
  v_cvt_pk_bf16_f32 v52, v104, v105
  v_cvt_pk_bf16_f32 v53, v106, v107
  v_cvt_pk_bf16_f32 v54, v108, v109
  v_cvt_pk_bf16_f32 v55, v110, v111
  v_lshlrev_b32 v56, 16, v52
  v_and_b32 v57, 0xffff0000, v52
  v_lshlrev_b32 v58, 16, v53
  v_and_b32 v59, 0xffff0000, v53
  v_lshlrev_b32 v60, 16, v54
  v_and_b32 v61, 0xffff0000, v54
  v_lshlrev_b32 v62, 16, v55
  v_and_b32 v63, 0xffff0000, v55
  v_min_f32 v64, 0, v56
  v_min_f32 v65, 0, v57
  v_min_f32 v66, 0, v58
  v_min_f32 v67, 0, v59
  v_min_f32 v68, 0, v60
  v_min_f32 v69, 0, v61
  v_min_f32 v70, 0, v62
  v_min_f32 v71, 0, v63
  v_pk_mul_f32 v[72:73], v[64:65], s[44:45]
  v_pk_mul_f32 v[74:75], v[66:67], s[44:45]
  v_pk_mul_f32 v[76:77], v[68:69], s[44:45]
  v_pk_mul_f32 v[78:79], v[70:71], s[44:45]
  v_exp_f32 v72, v72
  v_exp_f32 v73, v73
  v_exp_f32 v74, v74
  v_exp_f32 v75, v75
  v_exp_f32 v76, v76
  v_exp_f32 v77, v77
  v_exp_f32 v78, v78
  v_exp_f32 v79, v79
  v_pk_add_f32 v[56:57], v[56:57], v[64:65] neg_lo:[0,1] neg_hi:[0,1]
  v_pk_add_f32 v[58:59], v[58:59], v[66:67] neg_lo:[0,1] neg_hi:[0,1]
  v_pk_add_f32 v[60:61], v[60:61], v[68:69] neg_lo:[0,1] neg_hi:[0,1]
  v_pk_add_f32 v[62:63], v[62:63], v[70:71] neg_lo:[0,1] neg_hi:[0,1]
  v_pk_add_f32 v[56:57], v[56:57], v[72:73]
  v_pk_add_f32 v[58:59], v[58:59], v[74:75]
  v_pk_add_f32 v[60:61], v[60:61], v[76:77]
  v_pk_add_f32 v[62:63], v[62:63], v[78:79]
  v_pk_add_f32 v[56:57], v[56:57], s[46:47]
  v_pk_add_f32 v[58:59], v[58:59], s[46:47]
  v_pk_add_f32 v[60:61], v[60:61], s[46:47]
  v_pk_add_f32 v[62:63], v[62:63], s[46:47]
  v_cvt_pk_bf16_f32 v84, v56, v57
  v_cvt_pk_bf16_f32 v85, v58, v59
  v_cvt_pk_bf16_f32 v86, v60, v61
  v_cvt_pk_bf16_f32 v87, v62, v63
  ds_write_b128 v4, v[84:87] offset:1024
  v_cvt_pk_bf16_f32 v52, v112, v113
  v_cvt_pk_bf16_f32 v53, v114, v115
  v_cvt_pk_bf16_f32 v54, v116, v117
  v_cvt_pk_bf16_f32 v55, v118, v119
  v_lshlrev_b32 v56, 16, v52
  v_and_b32 v57, 0xffff0000, v52
  v_lshlrev_b32 v58, 16, v53
  v_and_b32 v59, 0xffff0000, v53
  v_lshlrev_b32 v60, 16, v54
  v_and_b32 v61, 0xffff0000, v54
  v_lshlrev_b32 v62, 16, v55
  v_and_b32 v63, 0xffff0000, v55
  v_min_f32 v64, 0, v56
  v_min_f32 v65, 0, v57
  v_min_f32 v66, 0, v58
  v_min_f32 v67, 0, v59
  v_min_f32 v68, 0, v60
  v_min_f32 v69, 0, v61
  v_min_f32 v70, 0, v62
  v_min_f32 v71, 0, v63
  v_pk_mul_f32 v[72:73], v[64:65], s[44:45]
  v_pk_mul_f32 v[74:75], v[66:67], s[44:45]
  v_pk_mul_f32 v[76:77], v[68:69], s[44:45]
  v_pk_mul_f32 v[78:79], v[70:71], s[44:45]
  v_exp_f32 v72, v72
  v_exp_f32 v73, v73
  v_exp_f32 v74, v74
  v_exp_f32 v75, v75
  v_exp_f32 v76, v76
  v_exp_f32 v77, v77
  v_exp_f32 v78, v78
  v_exp_f32 v79, v79
  v_pk_add_f32 v[56:57], v[56:57], v[64:65] neg_lo:[0,1] neg_hi:[0,1]
  v_pk_add_f32 v[58:59], v[58:59], v[66:67] neg_lo:[0,1] neg_hi:[0,1]
  v_pk_add_f32 v[60:61], v[60:61], v[68:69] neg_lo:[0,1] neg_hi:[0,1]
  v_pk_add_f32 v[62:63], v[62:63], v[70:71] neg_lo:[0,1] neg_hi:[0,1]
  v_pk_add_f32 v[56:57], v[56:57], v[72:73]
  v_pk_add_f32 v[58:59], v[58:59], v[74:75]
  v_pk_add_f32 v[60:61], v[60:61], v[76:77]
  v_pk_add_f32 v[62:63], v[62:63], v[78:79]
  v_pk_add_f32 v[56:57], v[56:57], s[46:47]
  v_pk_add_f32 v[58:59], v[58:59], s[46:47]
  v_pk_add_f32 v[60:61], v[60:61], s[46:47]
  v_pk_add_f32 v[62:63], v[62:63], s[46:47]
  v_cvt_pk_bf16_f32 v88, v56, v57
  v_cvt_pk_bf16_f32 v89, v58, v59
  v_cvt_pk_bf16_f32 v90, v60, v61
  v_cvt_pk_bf16_f32 v91, v62, v63
  ds_write_b128 v4, v[88:91] offset:2048
  v_cvt_pk_bf16_f32 v52, v120, v121
  v_cvt_pk_bf16_f32 v53, v122, v123
  v_cvt_pk_bf16_f32 v54, v124, v125
  v_cvt_pk_bf16_f32 v55, v126, v127
  v_lshlrev_b32 v56, 16, v52
  v_and_b32 v57, 0xffff0000, v52
  v_lshlrev_b32 v58, 16, v53
  v_and_b32 v59, 0xffff0000, v53
  v_lshlrev_b32 v60, 16, v54
  v_and_b32 v61, 0xffff0000, v54
  v_lshlrev_b32 v62, 16, v55
  v_and_b32 v63, 0xffff0000, v55
  v_min_f32 v64, 0, v56
  v_min_f32 v65, 0, v57
  v_min_f32 v66, 0, v58
  v_min_f32 v67, 0, v59
  v_min_f32 v68, 0, v60
  v_min_f32 v69, 0, v61
  v_min_f32 v70, 0, v62
  v_min_f32 v71, 0, v63
  v_pk_mul_f32 v[72:73], v[64:65], s[44:45]
  v_pk_mul_f32 v[74:75], v[66:67], s[44:45]
  v_pk_mul_f32 v[76:77], v[68:69], s[44:45]
  v_pk_mul_f32 v[78:79], v[70:71], s[44:45]
  v_exp_f32 v72, v72
  v_exp_f32 v73, v73
  v_exp_f32 v74, v74
  v_exp_f32 v75, v75
  v_exp_f32 v76, v76
  v_exp_f32 v77, v77
  v_exp_f32 v78, v78
  v_exp_f32 v79, v79
  v_pk_add_f32 v[56:57], v[56:57], v[64:65] neg_lo:[0,1] neg_hi:[0,1]
  v_pk_add_f32 v[58:59], v[58:59], v[66:67] neg_lo:[0,1] neg_hi:[0,1]
  v_pk_add_f32 v[60:61], v[60:61], v[68:69] neg_lo:[0,1] neg_hi:[0,1]
  v_pk_add_f32 v[62:63], v[62:63], v[70:71] neg_lo:[0,1] neg_hi:[0,1]
  v_pk_add_f32 v[56:57], v[56:57], v[72:73]
  v_pk_add_f32 v[58:59], v[58:59], v[74:75]
  v_pk_add_f32 v[60:61], v[60:61], v[76:77]
  v_pk_add_f32 v[62:63], v[62:63], v[78:79]
  v_pk_add_f32 v[56:57], v[56:57], s[46:47]
  v_pk_add_f32 v[58:59], v[58:59], s[46:47]
  v_pk_add_f32 v[60:61], v[60:61], s[46:47]
  v_pk_add_f32 v[62:63], v[62:63], s[46:47]
  v_cvt_pk_bf16_f32 v92, v56, v57
  v_cvt_pk_bf16_f32 v93, v58, v59
  v_cvt_pk_bf16_f32 v94, v60, v61
  v_cvt_pk_bf16_f32 v95, v62, v63
  ds_write_b128 v4, v[92:95] offset:3072
  s_lshl_b32 s43, s3, 2
  v_add_u32 v9, s43, v10
  v_and_b32 v6, 3, v2
  v_bfe_u32 v7, v2, 2, 2
  v_add_u32 v12, v6, v7
  v_lshlrev_b32 v12, 3, v12
  v_lshl_add_u32 v12, v14, 6, v12
  s_add_u32 s43, s7, 8
  v_add_u32 v12, s43, v12
  v_lshlrev_b32 v13, 5, v6
  v_lshlrev_b32 v7, 3, v7
  v_sub_u32 v13, v13, v7
  v_lshlrev_b32 v7, 6, v14
  v_sub_u32 v13, v13, v7
  s_add_u32 s43, s7, 4376
  v_add_u32 v13, s43, v13
  s_add_u32 s43, s7, 4384
  v_add_u32 v8, s43, v3
  s_waitcnt lgkmcnt(0)
  s_mov_b64 exec, 1
  ds_add_u32 v9, v11 offset:24
  s_mov_b64 exec, -1
  s_mov_b32 s43, 131072
K3_whu:
  ds_read_b32 v16, v9 offset:8
  s_waitcnt lgkmcnt(0)
  v_readfirstlane_b32 s42, v16
  s_sub_u32 s43, s43, 1
  s_cbranch_scc1 K3_whu_ok
  s_cmp_lt_u32 s42, 1
  s_cbranch_scc1 K3_whu
K3_whu_ok:
  ds_read_b64_tr_b16 v[96:97], v13 offset:32
  ds_read_b64_tr_b16 v[98:99], v13 offset:0
  ds_read_b64_tr_b16 v[32:33], v12 offset:0
  ds_read_b64_tr_b16 v[34:35], v12 offset:32
  ds_read_b64_tr_b16 v[100:101], v13 offset:160
  ds_read_b64_tr_b16 v[102:103], v13 offset:128
  ds_read_b64_tr_b16 v[104:105], v13 offset:288
  ds_read_b64_tr_b16 v[106:107], v13 offset:256
  ds_read_b64_tr_b16 v[36:37], v12 offset:256
  ds_read_b64_tr_b16 v[38:39], v12 offset:288
  s_waitcnt lgkmcnt(6)
  v_mfma_f32_16x16x32_bf16 v[16:19], v[96:99], v[32:35], 0
  ds_read_b64_tr_b16 v[108:109], v13 offset:416
  ds_read_b64_tr_b16 v[110:111], v13 offset:384
  s_waitcnt lgkmcnt(6)
  v_mfma_f32_16x16x32_bf16 v[20:23], v[100:103], v[32:35], 0
  ds_read_b64_tr_b16 v[112:113], v13 offset:544
  ds_read_b64_tr_b16 v[114:115], v13 offset:512
  ds_read_b64_tr_b16 v[40:41], v12 offset:512
  ds_read_b64_tr_b16 v[42:43], v12 offset:544
  s_waitcnt lgkmcnt(8)
  v_mfma_f32_16x16x32_bf16 v[24:27], v[104:107], v[32:35], 0
  ds_read_b64_tr_b16 v[116:117], v13 offset:672
  ds_read_b64_tr_b16 v[118:119], v13 offset:640
  v_add_f32_dpp v224, v19, v18 wave_shr:1 row_mask:0xf bank_mask:0xf bound_ctrl:0
  s_nop 1
  v_add_f32_dpp v226, v224, v17 wave_shr:1 row_mask:0xf bank_mask:0xf bound_ctrl:0
  s_waitcnt lgkmcnt(8)
  v_mfma_f32_16x16x32_bf16 v[24:27], v[96:99], v[36:39], v[24:27]
  v_add_f32_dpp v228, v226, v16 wave_shr:1 row_mask:0xf bank_mask:0xf bound_ctrl:0
  s_waitcnt lgkmcnt(6)
  v_mfma_f32_16x16x32_bf16 v[28:31], v[108:111], v[32:35], 0
  ds_read_b64_tr_b16 v[120:121], v13 offset:800
  ds_read_b64_tr_b16 v[122:123], v13 offset:768
  ds_read_b64_tr_b16 v[44:45], v12 offset:768
  ds_read_b64_tr_b16 v[46:47], v12 offset:800
  v_add_f32_dpp v225, v19, v22 wave_ror:1 row_mask:0xf bank_mask:0xf
  v_add_f32_dpp v227, v224, v21 wave_ror:1 row_mask:0xf bank_mask:0xf
  v_add_f32_dpp v229, v226, v20 wave_ror:1 row_mask:0xf bank_mask:0xf
  v_add_f32_dpp v225, v23, v22 wave_shr:1 row_mask:0xf bank_mask:0xf
  v_mfma_f32_16x16x32_bf16 v[28:31], v[100:103], v[36:39], v[28:31]
  s_nop 0
  v_add_f32_dpp v227, v225, v21 wave_shr:1 row_mask:0xf bank_mask:0xf
  s_nop 1
  v_add_f32_dpp v229, v227, v20 wave_shr:1 row_mask:0xf bank_mask:0xf
  v_cvt_pk_bf16_f32 v232, v228, v229
  v_or_b32 v232, 1, v232
  s_waitcnt lgkmcnt(8)
  v_mfma_f32_16x16x32_bf16 v[16:19], v[112:115], v[32:35], 0
  ds_read_b64_tr_b16 v[124:125], v13 offset:928
  ds_read_b64_tr_b16 v[126:127], v13 offset:896
  v_add_f32_dpp v224, v23, v26 wave_ror:1 row_mask:0xf bank_mask:0xf
  v_add_f32_dpp v226, v225, v25 wave_ror:1 row_mask:0xf bank_mask:0xf
  v_mfma_f32_16x16x32_bf16 v[16:19], v[104:107], v[36:39], v[16:19]
  v_add_f32_dpp v228, v227, v24 wave_ror:1 row_mask:0xf bank_mask:0xf
  v_add_f32_dpp v224, v27, v26 wave_shr:1 row_mask:0xf bank_mask:0xf
  s_waitcnt lgkmcnt(8)
  v_mfma_f32_16x16x32_bf16 v[16:19], v[96:99], v[40:43], v[16:19]
  v_add_f32_dpp v226, v224, v25 wave_shr:1 row_mask:0xf bank_mask:0xf
  s_nop 1
  v_add_f32_dpp v228, v226, v24 wave_shr:1 row_mask:0xf bank_mask:0xf
  s_waitcnt lgkmcnt(6)
  v_mfma_f32_16x16x32_bf16 v[20:23], v[116:119], v[32:35], 0
  ds_read_b64_tr_b16 v[128:129], v13 offset:1056
  ds_read_b64_tr_b16 v[130:131], v13 offset:1024
  ds_read_b64_tr_b16 v[48:49], v12 offset:1024
  ds_read_b64_tr_b16 v[50:51], v12 offset:1056
  v_add_f32_dpp v225, v27, v30 wave_ror:1 row_mask:0xf bank_mask:0xf
  v_add_f32_dpp v227, v224, v29 wave_ror:1 row_mask:0xf bank_mask:0xf
  v_add_f32_dpp v229, v226, v28 wave_ror:1 row_mask:0xf bank_mask:0xf
  v_mfma_f32_16x16x32_bf16 v[20:23], v[108:111], v[36:39], v[20:23]
  v_add_f32_dpp v225, v31, v30 wave_shr:1 row_mask:0xf bank_mask:0xf
  s_nop 1
  v_add_f32_dpp v227, v225, v29 wave_shr:1 row_mask:0xf bank_mask:0xf
  s_nop 1
  v_add_f32_dpp v229, v227, v28 wave_shr:1 row_mask:0xf bank_mask:0xf
  v_mfma_f32_16x16x32_bf16 v[20:23], v[100:103], v[40:43], v[20:23]
  v_cvt_pk_bf16_f32 v233, v228, v229
  v_or_b32 v233, 1, v233
  s_waitcnt lgkmcnt(8)
  v_mfma_f32_16x16x32_bf16 v[24:27], v[120:123], v[32:35], 0
  ds_read_b64_tr_b16 v[132:133], v13 offset:1184
  ds_read_b64_tr_b16 v[134:135], v13 offset:1152
  v_add_f32_dpp v224, v31, v18 wave_ror:1 row_mask:0xf bank_mask:0xf
  v_add_f32_dpp v226, v225, v17 wave_ror:1 row_mask:0xf bank_mask:0xf
  v_mfma_f32_16x16x32_bf16 v[24:27], v[112:115], v[36:39], v[24:27]
  v_add_f32_dpp v228, v227, v16 wave_ror:1 row_mask:0xf bank_mask:0xf
  v_add_f32_dpp v224, v19, v18 wave_shr:1 row_mask:0xf bank_mask:0xf
  v_mfma_f32_16x16x32_bf16 v[24:27], v[104:107], v[40:43], v[24:27]
  s_nop 0
  v_add_f32_dpp v226, v224, v17 wave_shr:1 row_mask:0xf bank_mask:0xf
  s_waitcnt lgkmcnt(8)
  v_mfma_f32_16x16x32_bf16 v[24:27], v[96:99], v[44:47], v[24:27]
  v_add_f32_dpp v228, v226, v16 wave_shr:1 row_mask:0xf bank_mask:0xf
  s_waitcnt lgkmcnt(6)
  v_mfma_f32_16x16x32_bf16 v[28:31], v[124:127], v[32:35], 0
  ds_read_b64_tr_b16 v[136:137], v13 offset:1312
  ds_read_b64_tr_b16 v[138:139], v13 offset:1280
  ds_read_b64_tr_b16 v[52:53], v12 offset:1280
  ds_read_b64_tr_b16 v[54:55], v12 offset:1312
  v_add_f32_dpp v225, v19, v22 wave_ror:1 row_mask:0xf bank_mask:0xf
  v_add_f32_dpp v227, v224, v21 wave_ror:1 row_mask:0xf bank_mask:0xf
  v_mfma_f32_16x16x32_bf16 v[28:31], v[116:119], v[36:39], v[28:31]
  v_add_f32_dpp v229, v226, v20 wave_ror:1 row_mask:0xf bank_mask:0xf
  v_add_f32_dpp v225, v23, v22 wave_shr:1 row_mask:0xf bank_mask:0xf
  v_mfma_f32_16x16x32_bf16 v[28:31], v[108:111], v[40:43], v[28:31]
  s_nop 0
  v_add_f32_dpp v227, v225, v21 wave_shr:1 row_mask:0xf bank_mask:0xf
  s_nop 1
  v_add_f32_dpp v229, v227, v20 wave_shr:1 row_mask:0xf bank_mask:0xf
  v_mfma_f32_16x16x32_bf16 v[28:31], v[100:103], v[44:47], v[28:31]
  v_cvt_pk_bf16_f32 v234, v228, v229
  v_or_b32 v234, 1, v234
  s_waitcnt lgkmcnt(8)
  v_mfma_f32_16x16x32_bf16 v[16:19], v[128:131], v[32:35], 0
  ds_read_b64_tr_b16 v[140:141], v13 offset:1440
  ds_read_b64_tr_b16 v[142:143], v13 offset:1408
  v_add_f32_dpp v224, v23, v26 wave_ror:1 row_mask:0xf bank_mask:0xf
  v_add_f32_dpp v226, v225, v25 wave_ror:1 row_mask:0xf bank_mask:0xf
  v_mfma_f32_16x16x32_bf16 v[16:19], v[120:123], v[36:39], v[16:19]
  v_add_f32_dpp v228, v227, v24 wave_ror:1 row_mask:0xf bank_mask:0xf
  v_mfma_f32_16x16x32_bf16 v[16:19], v[112:115], v[40:43], v[16:19]
  v_add_f32_dpp v224, v27, v26 wave_shr:1 row_mask:0xf bank_mask:0xf
  v_mfma_f32_16x16x32_bf16 v[16:19], v[104:107], v[44:47], v[16:19]
  s_nop 0
  v_add_f32_dpp v226, v224, v25 wave_shr:1 row_mask:0xf bank_mask:0xf
  s_waitcnt lgkmcnt(8)
  v_mfma_f32_16x16x32_bf16 v[16:19], v[96:99], v[48:51], v[16:19]
  v_add_f32_dpp v228, v226, v24 wave_shr:1 row_mask:0xf bank_mask:0xf
  s_waitcnt lgkmcnt(6)
  v_mfma_f32_16x16x32_bf16 v[20:23], v[132:135], v[32:35], 0
  ds_read_b64_tr_b16 v[144:145], v13 offset:1568
  ds_read_b64_tr_b16 v[146:147], v13 offset:1536
  ds_read_b64_tr_b16 v[56:57], v12 offset:1536
  ds_read_b64_tr_b16 v[58:59], v12 offset:1568
  v_add_f32_dpp v225, v27, v30 wave_ror:1 row_mask:0xf bank_mask:0xf
  v_add_f32_dpp v227, v224, v29 wave_ror:1 row_mask:0xf bank_mask:0xf
  v_mfma_f32_16x16x32_bf16 v[20:23], v[124:127], v[36:39], v[20:23]
  v_add_f32_dpp v229, v226, v28 wave_ror:1 row_mask:0xf bank_mask:0xf
  v_add_f32_dpp v225, v31, v30 wave_shr:1 row_mask:0xf bank_mask:0xf
  v_mfma_f32_16x16x32_bf16 v[20:23], v[116:119], v[40:43], v[20:23]
  s_nop 0
  v_add_f32_dpp v227, v225, v29 wave_shr:1 row_mask:0xf bank_mask:0xf
  s_nop 1
  v_add_f32_dpp v229, v227, v28 wave_shr:1 row_mask:0xf bank_mask:0xf
  v_mfma_f32_16x16x32_bf16 v[20:23], v[108:111], v[44:47], v[20:23]
  v_cvt_pk_bf16_f32 v235, v228, v229
  v_mfma_f32_16x16x32_bf16 v[20:23], v[100:103], v[48:51], v[20:23]
  v_or_b32 v235, 1, v235
  s_waitcnt lgkmcnt(8)
  v_mfma_f32_16x16x32_bf16 v[24:27], v[136:139], v[32:35], 0
  ds_read_b64_tr_b16 v[148:149], v13 offset:1696
  ds_read_b64_tr_b16 v[150:151], v13 offset:1664
  v_add_f32_dpp v224, v31, v18 wave_ror:1 row_mask:0xf bank_mask:0xf
  v_mfma_f32_16x16x32_bf16 v[24:27], v[128:131], v[36:39], v[24:27]
  v_add_f32_dpp v226, v225, v17 wave_ror:1 row_mask:0xf bank_mask:0xf
  v_mfma_f32_16x16x32_bf16 v[24:27], v[120:123], v[40:43], v[24:27]
  v_add_f32_dpp v228, v227, v16 wave_ror:1 row_mask:0xf bank_mask:0xf
  v_mfma_f32_16x16x32_bf16 v[24:27], v[112:115], v[44:47], v[24:27]
  v_add_f32_dpp v224, v19, v18 wave_shr:1 row_mask:0xf bank_mask:0xf
  v_mfma_f32_16x16x32_bf16 v[24:27], v[104:107], v[48:51], v[24:27]
  s_nop 0
  v_add_f32_dpp v226, v224, v17 wave_shr:1 row_mask:0xf bank_mask:0xf
  s_waitcnt lgkmcnt(8)
  v_mfma_f32_16x16x32_bf16 v[24:27], v[96:99], v[52:55], v[24:27]
  v_add_f32_dpp v228, v226, v16 wave_shr:1 row_mask:0xf bank_mask:0xf
  s_waitcnt lgkmcnt(6)
  v_mfma_f32_16x16x32_bf16 v[28:31], v[140:143], v[32:35], 0
  ds_read_b64_tr_b16 v[152:153], v13 offset:1824
  ds_read_b64_tr_b16 v[154:155], v13 offset:1792
  ds_read_b64_tr_b16 v[60:61], v12 offset:1792
  ds_read_b64_tr_b16 v[62:63], v12 offset:1824
  v_add_f32_dpp v225, v19, v22 wave_ror:1 row_mask:0xf bank_mask:0xf
  v_add_f32_dpp v227, v224, v21 wave_ror:1 row_mask:0xf bank_mask:0xf
  v_mfma_f32_16x16x32_bf16 v[28:31], v[132:135], v[36:39], v[28:31]
  v_add_f32_dpp v229, v226, v20 wave_ror:1 row_mask:0xf bank_mask:0xf
  v_add_f32_dpp v225, v23, v22 wave_shr:1 row_mask:0xf bank_mask:0xf
  v_mfma_f32_16x16x32_bf16 v[28:31], v[124:127], v[40:43], v[28:31]
  s_nop 0
  v_add_f32_dpp v227, v225, v21 wave_shr:1 row_mask:0xf bank_mask:0xf
  v_mfma_f32_16x16x32_bf16 v[28:31], v[116:119], v[44:47], v[28:31]
  s_nop 0
  v_add_f32_dpp v229, v227, v20 wave_shr:1 row_mask:0xf bank_mask:0xf
  v_mfma_f32_16x16x32_bf16 v[28:31], v[108:111], v[48:51], v[28:31]
  v_cvt_pk_bf16_f32 v236, v228, v229
  v_mfma_f32_16x16x32_bf16 v[28:31], v[100:103], v[52:55], v[28:31]
  v_or_b32 v236, 1, v236
  s_waitcnt lgkmcnt(8)
  v_mfma_f32_16x16x32_bf16 v[16:19], v[144:147], v[32:35], 0
  ds_read_b64_tr_b16 v[156:157], v13 offset:1952
  ds_read_b64_tr_b16 v[158:159], v13 offset:1920
  v_add_f32_dpp v224, v23, v26 wave_ror:1 row_mask:0xf bank_mask:0xf
  v_mfma_f32_16x16x32_bf16 v[16:19], v[136:139], v[36:39], v[16:19]
  v_add_f32_dpp v226, v225, v25 wave_ror:1 row_mask:0xf bank_mask:0xf
  v_mfma_f32_16x16x32_bf16 v[16:19], v[128:131], v[40:43], v[16:19]
  v_add_f32_dpp v228, v227, v24 wave_ror:1 row_mask:0xf bank_mask:0xf
  v_mfma_f32_16x16x32_bf16 v[16:19], v[120:123], v[44:47], v[16:19]
  v_add_f32_dpp v224, v27, v26 wave_shr:1 row_mask:0xf bank_mask:0xf
  v_mfma_f32_16x16x32_bf16 v[16:19], v[112:115], v[48:51], v[16:19]
  s_nop 0
  v_add_f32_dpp v226, v224, v25 wave_shr:1 row_mask:0xf bank_mask:0xf
  v_mfma_f32_16x16x32_bf16 v[16:19], v[104:107], v[52:55], v[16:19]
  s_nop 0
  v_add_f32_dpp v228, v226, v24 wave_shr:1 row_mask:0xf bank_mask:0xf
  s_waitcnt lgkmcnt(8)
  v_mfma_f32_16x16x32_bf16 v[16:19], v[96:99], v[56:59], v[16:19]
  s_waitcnt lgkmcnt(6)
  v_mfma_f32_16x16x32_bf16 v[20:23], v[148:151], v[32:35], 0
  ds_read_b64_tr_b16 v[160:161], v13 offset:2080
  ds_read_b64_tr_b16 v[162:163], v13 offset:2048
  ds_read_b64_tr_b16 v[64:65], v12 offset:2048
  ds_read_b64_tr_b16 v[66:67], v12 offset:2080
  v_add_f32_dpp v225, v27, v30 wave_ror:1 row_mask:0xf bank_mask:0xf
  v_add_f32_dpp v227, v224, v29 wave_ror:1 row_mask:0xf bank_mask:0xf
  v_mfma_f32_16x16x32_bf16 v[20:23], v[140:143], v[36:39], v[20:23]
  v_add_f32_dpp v229, v226, v28 wave_ror:1 row_mask:0xf bank_mask:0xf
  v_mfma_f32_16x16x32_bf16 v[20:23], v[132:135], v[40:43], v[20:23]
  v_add_f32_dpp v225, v31, v30 wave_shr:1 row_mask:0xf bank_mask:0xf
  v_mfma_f32_16x16x32_bf16 v[20:23], v[124:127], v[44:47], v[20:23]
  s_nop 0
  v_add_f32_dpp v227, v225, v29 wave_shr:1 row_mask:0xf bank_mask:0xf
  v_mfma_f32_16x16x32_bf16 v[20:23], v[116:119], v[48:51], v[20:23]
  s_nop 0
  v_add_f32_dpp v229, v227, v28 wave_shr:1 row_mask:0xf bank_mask:0xf
  v_mfma_f32_16x16x32_bf16 v[20:23], v[108:111], v[52:55], v[20:23]
  v_cvt_pk_bf16_f32 v237, v228, v229
  v_mfma_f32_16x16x32_bf16 v[20:23], v[100:103], v[56:59], v[20:23]
  v_or_b32 v237, 1, v237
  s_waitcnt lgkmcnt(8)
  v_mfma_f32_16x16x32_bf16 v[24:27], v[152:155], v[32:35], 0
  ds_read_b64_tr_b16 v[164:165], v13 offset:2208
  ds_read_b64_tr_b16 v[166:167], v13 offset:2176
  v_add_f32_dpp v224, v31, v18 wave_ror:1 row_mask:0xf bank_mask:0xf
  v_mfma_f32_16x16x32_bf16 v[24:27], v[144:147], v[36:39], v[24:27]
  v_add_f32_dpp v226, v225, v17 wave_ror:1 row_mask:0xf bank_mask:0xf
  v_mfma_f32_16x16x32_bf16 v[24:27], v[136:139], v[40:43], v[24:27]
  v_add_f32_dpp v228, v227, v16 wave_ror:1 row_mask:0xf bank_mask:0xf
  v_mfma_f32_16x16x32_bf16 v[24:27], v[128:131], v[44:47], v[24:27]
  v_add_f32_dpp v224, v19, v18 wave_shr:1 row_mask:0xf bank_mask:0xf
  v_mfma_f32_16x16x32_bf16 v[24:27], v[120:123], v[48:51], v[24:27]
  s_nop 0
  v_add_f32_dpp v226, v224, v17 wave_shr:1 row_mask:0xf bank_mask:0xf
  v_mfma_f32_16x16x32_bf16 v[24:27], v[112:115], v[52:55], v[24:27]
  s_nop 0
  v_add_f32_dpp v228, v226, v16 wave_shr:1 row_mask:0xf bank_mask:0xf
  v_mfma_f32_16x16x32_bf16 v[24:27], v[104:107], v[56:59], v[24:27]
  s_waitcnt lgkmcnt(8)
  v_mfma_f32_16x16x32_bf16 v[24:27], v[96:99], v[60:63], v[24:27]
  s_waitcnt lgkmcnt(6)
  v_mfma_f32_16x16x32_bf16 v[28:31], v[156:159], v[32:35], 0
  ds_read_b64_tr_b16 v[168:169], v13 offset:2336
  ds_read_b64_tr_b16 v[170:171], v13 offset:2304
  ds_read_b64_tr_b16 v[68:69], v12 offset:2304
  ds_read_b64_tr_b16 v[70:71], v12 offset:2336
  v_add_f32_dpp v225, v19, v22 wave_ror:1 row_mask:0xf bank_mask:0xf
  v_mfma_f32_16x16x32_bf16 v[28:31], v[148:151], v[36:39], v[28:31]
  v_add_f32_dpp v227, v224, v21 wave_ror:1 row_mask:0xf bank_mask:0xf
  v_mfma_f32_16x16x32_bf16 v[28:31], v[140:143], v[40:43], v[28:31]
  v_add_f32_dpp v229, v226, v20 wave_ror:1 row_mask:0xf bank_mask:0xf
  v_mfma_f32_16x16x32_bf16 v[28:31], v[132:135], v[44:47], v[28:31]
  v_add_f32_dpp v225, v23, v22 wave_shr:1 row_mask:0xf bank_mask:0xf
  v_mfma_f32_16x16x32_bf16 v[28:31], v[124:127], v[48:51], v[28:31]
  s_nop 0
  v_add_f32_dpp v227, v225, v21 wave_shr:1 row_mask:0xf bank_mask:0xf
  v_mfma_f32_16x16x32_bf16 v[28:31], v[116:119], v[52:55], v[28:31]
  s_nop 0
  v_add_f32_dpp v229, v227, v20 wave_shr:1 row_mask:0xf bank_mask:0xf
  v_mfma_f32_16x16x32_bf16 v[28:31], v[108:111], v[56:59], v[28:31]
  v_cvt_pk_bf16_f32 v238, v228, v229
  v_mfma_f32_16x16x32_bf16 v[28:31], v[100:103], v[60:63], v[28:31]
  v_or_b32 v238, 1, v238
  s_waitcnt lgkmcnt(8)
  v_mfma_f32_16x16x32_bf16 v[16:19], v[160:163], v[32:35], 0
  ds_read_b64_tr_b16 v[172:173], v13 offset:2464
  ds_read_b64_tr_b16 v[174:175], v13 offset:2432
  v_add_f32_dpp v224, v23, v26 wave_ror:1 row_mask:0xf bank_mask:0xf
  v_mfma_f32_16x16x32_bf16 v[16:19], v[152:155], v[36:39], v[16:19]
  v_add_f32_dpp v226, v225, v25 wave_ror:1 row_mask:0xf bank_mask:0xf
  v_mfma_f32_16x16x32_bf16 v[16:19], v[144:147], v[40:43], v[16:19]
  v_add_f32_dpp v228, v227, v24 wave_ror:1 row_mask:0xf bank_mask:0xf
  v_mfma_f32_16x16x32_bf16 v[16:19], v[136:139], v[44:47], v[16:19]
  v_add_f32_dpp v224, v27, v26 wave_shr:1 row_mask:0xf bank_mask:0xf
  v_mfma_f32_16x16x32_bf16 v[16:19], v[128:131], v[48:51], v[16:19]
  s_nop 0
  v_add_f32_dpp v226, v224, v25 wave_shr:1 row_mask:0xf bank_mask:0xf
  v_mfma_f32_16x16x32_bf16 v[16:19], v[120:123], v[52:55], v[16:19]
  s_nop 0
  v_add_f32_dpp v228, v226, v24 wave_shr:1 row_mask:0xf bank_mask:0xf
  v_mfma_f32_16x16x32_bf16 v[16:19], v[112:115], v[56:59], v[16:19]
  v_mfma_f32_16x16x32_bf16 v[16:19], v[104:107], v[60:63], v[16:19]
  s_waitcnt lgkmcnt(8)
  v_mfma_f32_16x16x32_bf16 v[16:19], v[96:99], v[64:67], v[16:19]
  s_waitcnt lgkmcnt(6)
  v_mfma_f32_16x16x32_bf16 v[20:23], v[164:167], v[32:35], 0
  ds_read_b64_tr_b16 v[176:177], v13 offset:2592
  ds_read_b64_tr_b16 v[178:179], v13 offset:2560
  ds_read_b64_tr_b16 v[72:73], v12 offset:2560
  ds_read_b64_tr_b16 v[74:75], v12 offset:2592
  v_add_f32_dpp v225, v27, v30 wave_ror:1 row_mask:0xf bank_mask:0xf
  v_mfma_f32_16x16x32_bf16 v[20:23], v[156:159], v[36:39], v[20:23]
  v_add_f32_dpp v227, v224, v29 wave_ror:1 row_mask:0xf bank_mask:0xf
  v_mfma_f32_16x16x32_bf16 v[20:23], v[148:151], v[40:43], v[20:23]
  v_add_f32_dpp v229, v226, v28 wave_ror:1 row_mask:0xf bank_mask:0xf
  v_mfma_f32_16x16x32_bf16 v[20:23], v[140:143], v[44:47], v[20:23]
  v_add_f32_dpp v225, v31, v30 wave_shr:1 row_mask:0xf bank_mask:0xf
  v_mfma_f32_16x16x32_bf16 v[20:23], v[132:135], v[48:51], v[20:23]
  s_nop 0
  v_add_f32_dpp v227, v225, v29 wave_shr:1 row_mask:0xf bank_mask:0xf
  v_mfma_f32_16x16x32_bf16 v[20:23], v[124:127], v[52:55], v[20:23]
  s_nop 0
  v_add_f32_dpp v229, v227, v28 wave_shr:1 row_mask:0xf bank_mask:0xf
  v_mfma_f32_16x16x32_bf16 v[20:23], v[116:119], v[56:59], v[20:23]
  v_cvt_pk_bf16_f32 v239, v228, v229
  v_mfma_f32_16x16x32_bf16 v[20:23], v[108:111], v[60:63], v[20:23]
  v_or_b32 v239, 1, v239
  v_mfma_f32_16x16x32_bf16 v[20:23], v[100:103], v[64:67], v[20:23]
  s_waitcnt lgkmcnt(8)
  v_mfma_f32_16x16x32_bf16 v[24:27], v[168:171], v[32:35], 0
  ds_read_b64_tr_b16 v[180:181], v13 offset:2720
  ds_read_b64_tr_b16 v[182:183], v13 offset:2688
  v_add_f32_dpp v224, v31, v18 wave_ror:1 row_mask:0xf bank_mask:0xf
  v_mfma_f32_16x16x32_bf16 v[24:27], v[160:163], v[36:39], v[24:27]
  v_add_f32_dpp v226, v225, v17 wave_ror:1 row_mask:0xf bank_mask:0xf
  v_mfma_f32_16x16x32_bf16 v[24:27], v[152:155], v[40:43], v[24:27]
  v_add_f32_dpp v228, v227, v16 wave_ror:1 row_mask:0xf bank_mask:0xf
  v_mfma_f32_16x16x32_bf16 v[24:27], v[144:147], v[44:47], v[24:27]
  v_add_f32_dpp v224, v19, v18 wave_shr:1 row_mask:0xf bank_mask:0xf
  v_mfma_f32_16x16x32_bf16 v[24:27], v[136:139], v[48:51], v[24:27]
  s_nop 0
  v_add_f32_dpp v226, v224, v17 wave_shr:1 row_mask:0xf bank_mask:0xf
  v_mfma_f32_16x16x32_bf16 v[24:27], v[128:131], v[52:55], v[24:27]
  s_nop 0
  v_add_f32_dpp v228, v226, v16 wave_shr:1 row_mask:0xf bank_mask:0xf
  v_mfma_f32_16x16x32_bf16 v[24:27], v[120:123], v[56:59], v[24:27]
  v_mfma_f32_16x16x32_bf16 v[24:27], v[112:115], v[60:63], v[24:27]
  v_mfma_f32_16x16x32_bf16 v[24:27], v[104:107], v[64:67], v[24:27]
  s_waitcnt lgkmcnt(8)
  v_mfma_f32_16x16x32_bf16 v[24:27], v[96:99], v[68:71], v[24:27]
  s_waitcnt lgkmcnt(6)
  v_mfma_f32_16x16x32_bf16 v[28:31], v[172:175], v[32:35], 0
  ds_read_b64_tr_b16 v[184:185], v13 offset:2848
  ds_read_b64_tr_b16 v[186:187], v13 offset:2816
  ds_read_b64_tr_b16 v[76:77], v12 offset:2816
  ds_read_b64_tr_b16 v[78:79], v12 offset:2848
  v_add_f32_dpp v225, v19, v22 wave_ror:1 row_mask:0xf bank_mask:0xf
  v_mfma_f32_16x16x32_bf16 v[28:31], v[164:167], v[36:39], v[28:31]
  v_add_f32_dpp v227, v224, v21 wave_ror:1 row_mask:0xf bank_mask:0xf
  v_mfma_f32_16x16x32_bf16 v[28:31], v[156:159], v[40:43], v[28:31]
  v_add_f32_dpp v229, v226, v20 wave_ror:1 row_mask:0xf bank_mask:0xf
  v_mfma_f32_16x16x32_bf16 v[28:31], v[148:151], v[44:47], v[28:31]
  v_add_f32_dpp v225, v23, v22 wave_shr:1 row_mask:0xf bank_mask:0xf
  v_mfma_f32_16x16x32_bf16 v[28:31], v[140:143], v[48:51], v[28:31]
  s_nop 0
  v_add_f32_dpp v227, v225, v21 wave_shr:1 row_mask:0xf bank_mask:0xf
  v_mfma_f32_16x16x32_bf16 v[28:31], v[132:135], v[52:55], v[28:31]
  s_nop 0
  v_add_f32_dpp v229, v227, v20 wave_shr:1 row_mask:0xf bank_mask:0xf
  v_mfma_f32_16x16x32_bf16 v[28:31], v[124:127], v[56:59], v[28:31]
  v_cvt_pk_bf16_f32 v240, v228, v229
  v_mfma_f32_16x16x32_bf16 v[28:31], v[116:119], v[60:63], v[28:31]
  v_or_b32 v240, 1, v240
  v_mfma_f32_16x16x32_bf16 v[28:31], v[108:111], v[64:67], v[28:31]
  v_mfma_f32_16x16x32_bf16 v[28:31], v[100:103], v[68:71], v[28:31]
  s_waitcnt lgkmcnt(8)
  v_mfma_f32_16x16x32_bf16 v[16:19], v[176:179], v[32:35], 0
  ds_read_b64_tr_b16 v[188:189], v13 offset:2976
  ds_read_b64_tr_b16 v[190:191], v13 offset:2944
  v_add_f32_dpp v224, v23, v26 wave_ror:1 row_mask:0xf bank_mask:0xf
  v_mfma_f32_16x16x32_bf16 v[16:19], v[168:171], v[36:39], v[16:19]
  v_add_f32_dpp v226, v225, v25 wave_ror:1 row_mask:0xf bank_mask:0xf
  v_mfma_f32_16x16x32_bf16 v[16:19], v[160:163], v[40:43], v[16:19]
  v_add_f32_dpp v228, v227, v24 wave_ror:1 row_mask:0xf bank_mask:0xf
  v_mfma_f32_16x16x32_bf16 v[16:19], v[152:155], v[44:47], v[16:19]
  v_add_f32_dpp v224, v27, v26 wave_shr:1 row_mask:0xf bank_mask:0xf
  v_mfma_f32_16x16x32_bf16 v[16:19], v[144:147], v[48:51], v[16:19]
  s_nop 0
  v_add_f32_dpp v226, v224, v25 wave_shr:1 row_mask:0xf bank_mask:0xf
  v_mfma_f32_16x16x32_bf16 v[16:19], v[136:139], v[52:55], v[16:19]
  s_nop 0
  v_add_f32_dpp v228, v226, v24 wave_shr:1 row_mask:0xf bank_mask:0xf
  v_mfma_f32_16x16x32_bf16 v[16:19], v[128:131], v[56:59], v[16:19]
  v_mfma_f32_16x16x32_bf16 v[16:19], v[120:123], v[60:63], v[16:19]
  v_mfma_f32_16x16x32_bf16 v[16:19], v[112:115], v[64:67], v[16:19]
  v_mfma_f32_16x16x32_bf16 v[16:19], v[104:107], v[68:71], v[16:19]
  s_waitcnt lgkmcnt(8)
  v_mfma_f32_16x16x32_bf16 v[16:19], v[96:99], v[72:75], v[16:19]
  s_waitcnt lgkmcnt(6)
  v_mfma_f32_16x16x32_bf16 v[20:23], v[180:183], v[32:35], 0
  ds_read_b64_tr_b16 v[192:193], v13 offset:3104
  ds_read_b64_tr_b16 v[194:195], v13 offset:3072
  ds_read_b64_tr_b16 v[80:81], v12 offset:3072
  ds_read_b64_tr_b16 v[82:83], v12 offset:3104
  v_add_f32_dpp v225, v27, v30 wave_ror:1 row_mask:0xf bank_mask:0xf
  v_mfma_f32_16x16x32_bf16 v[20:23], v[172:175], v[36:39], v[20:23]
  v_add_f32_dpp v227, v224, v29 wave_ror:1 row_mask:0xf bank_mask:0xf
  v_mfma_f32_16x16x32_bf16 v[20:23], v[164:167], v[40:43], v[20:23]
  v_add_f32_dpp v229, v226, v28 wave_ror:1 row_mask:0xf bank_mask:0xf
  v_mfma_f32_16x16x32_bf16 v[20:23], v[156:159], v[44:47], v[20:23]
  v_add_f32_dpp v225, v31, v30 wave_shr:1 row_mask:0xf bank_mask:0xf
  v_mfma_f32_16x16x32_bf16 v[20:23], v[148:151], v[48:51], v[20:23]
  s_nop 0
  v_add_f32_dpp v227, v225, v29 wave_shr:1 row_mask:0xf bank_mask:0xf
  v_mfma_f32_16x16x32_bf16 v[20:23], v[140:143], v[52:55], v[20:23]
  s_nop 0
  v_add_f32_dpp v229, v227, v28 wave_shr:1 row_mask:0xf bank_mask:0xf
  v_mfma_f32_16x16x32_bf16 v[20:23], v[132:135], v[56:59], v[20:23]
  v_cvt_pk_bf16_f32 v241, v228, v229
  v_mfma_f32_16x16x32_bf16 v[20:23], v[124:127], v[60:63], v[20:23]
  v_or_b32 v241, 1, v241
  v_mfma_f32_16x16x32_bf16 v[20:23], v[116:119], v[64:67], v[20:23]
  v_mfma_f32_16x16x32_bf16 v[20:23], v[108:111], v[68:71], v[20:23]
  v_mfma_f32_16x16x32_bf16 v[20:23], v[100:103], v[72:75], v[20:23]
  s_waitcnt lgkmcnt(8)
  v_mfma_f32_16x16x32_bf16 v[24:27], v[184:187], v[32:35], 0
  ds_read_b64_tr_b16 v[196:197], v13 offset:3232
  ds_read_b64_tr_b16 v[198:199], v13 offset:3200
  v_add_f32_dpp v224, v31, v18 wave_ror:1 row_mask:0xf bank_mask:0xf
  v_mfma_f32_16x16x32_bf16 v[24:27], v[176:179], v[36:39], v[24:27]
  v_add_f32_dpp v226, v225, v17 wave_ror:1 row_mask:0xf bank_mask:0xf
  v_mfma_f32_16x16x32_bf16 v[24:27], v[168:171], v[40:43], v[24:27]
  v_add_f32_dpp v228, v227, v16 wave_ror:1 row_mask:0xf bank_mask:0xf
  v_mfma_f32_16x16x32_bf16 v[24:27], v[160:163], v[44:47], v[24:27]
  v_add_f32_dpp v224, v19, v18 wave_shr:1 row_mask:0xf bank_mask:0xf
  v_mfma_f32_16x16x32_bf16 v[24:27], v[152:155], v[48:51], v[24:27]
  s_nop 0
  v_add_f32_dpp v226, v224, v17 wave_shr:1 row_mask:0xf bank_mask:0xf
  v_mfma_f32_16x16x32_bf16 v[24:27], v[144:147], v[52:55], v[24:27]
  s_nop 0
  v_add_f32_dpp v228, v226, v16 wave_shr:1 row_mask:0xf bank_mask:0xf
  v_mfma_f32_16x16x32_bf16 v[24:27], v[136:139], v[56:59], v[24:27]
  v_mfma_f32_16x16x32_bf16 v[24:27], v[128:131], v[60:63], v[24:27]
  v_mfma_f32_16x16x32_bf16 v[24:27], v[120:123], v[64:67], v[24:27]
  v_mfma_f32_16x16x32_bf16 v[24:27], v[112:115], v[68:71], v[24:27]
  v_mfma_f32_16x16x32_bf16 v[24:27], v[104:107], v[72:75], v[24:27]
  s_waitcnt lgkmcnt(8)
  v_mfma_f32_16x16x32_bf16 v[24:27], v[96:99], v[76:79], v[24:27]
  s_waitcnt lgkmcnt(6)
  v_mfma_f32_16x16x32_bf16 v[28:31], v[188:191], v[32:35], 0
  ds_read_b64_tr_b16 v[200:201], v13 offset:3360
  ds_read_b64_tr_b16 v[202:203], v13 offset:3328
  ds_read_b64_tr_b16 v[84:85], v12 offset:3328
  ds_read_b64_tr_b16 v[86:87], v12 offset:3360
  v_add_f32_dpp v225, v19, v22 wave_ror:1 row_mask:0xf bank_mask:0xf
  v_mfma_f32_16x16x32_bf16 v[28:31], v[180:183], v[36:39], v[28:31]
  v_add_f32_dpp v227, v224, v21 wave_ror:1 row_mask:0xf bank_mask:0xf
  v_mfma_f32_16x16x32_bf16 v[28:31], v[172:175], v[40:43], v[28:31]
  v_add_f32_dpp v229, v226, v20 wave_ror:1 row_mask:0xf bank_mask:0xf
  v_mfma_f32_16x16x32_bf16 v[28:31], v[164:167], v[44:47], v[28:31]
  v_add_f32_dpp v225, v23, v22 wave_shr:1 row_mask:0xf bank_mask:0xf
  v_mfma_f32_16x16x32_bf16 v[28:31], v[156:159], v[48:51], v[28:31]
  s_nop 0
  v_add_f32_dpp v227, v225, v21 wave_shr:1 row_mask:0xf bank_mask:0xf
  v_mfma_f32_16x16x32_bf16 v[28:31], v[148:151], v[52:55], v[28:31]
  s_nop 0
  v_add_f32_dpp v229, v227, v20 wave_shr:1 row_mask:0xf bank_mask:0xf
  v_mfma_f32_16x16x32_bf16 v[28:31], v[140:143], v[56:59], v[28:31]
  v_cvt_pk_bf16_f32 v242, v228, v229
  v_mfma_f32_16x16x32_bf16 v[28:31], v[132:135], v[60:63], v[28:31]
  v_or_b32 v242, 1, v242
  v_mfma_f32_16x16x32_bf16 v[28:31], v[124:127], v[64:67], v[28:31]
  v_mfma_f32_16x16x32_bf16 v[28:31], v[116:119], v[68:71], v[28:31]
  v_mfma_f32_16x16x32_bf16 v[28:31], v[108:111], v[72:75], v[28:31]
  v_mfma_f32_16x16x32_bf16 v[28:31], v[100:103], v[76:79], v[28:31]
  s_waitcnt lgkmcnt(8)
  v_mfma_f32_16x16x32_bf16 v[16:19], v[192:195], v[32:35], 0
  ds_read_b64_tr_b16 v[204:205], v13 offset:3488
  ds_read_b64_tr_b16 v[206:207], v13 offset:3456
  v_add_f32_dpp v224, v23, v26 wave_ror:1 row_mask:0xf bank_mask:0xf
  v_mfma_f32_16x16x32_bf16 v[16:19], v[184:187], v[36:39], v[16:19]
  v_add_f32_dpp v226, v225, v25 wave_ror:1 row_mask:0xf bank_mask:0xf
  v_mfma_f32_16x16x32_bf16 v[16:19], v[176:179], v[40:43], v[16:19]
  v_add_f32_dpp v228, v227, v24 wave_ror:1 row_mask:0xf bank_mask:0xf
  v_mfma_f32_16x16x32_bf16 v[16:19], v[168:171], v[44:47], v[16:19]
  v_add_f32_dpp v224, v27, v26 wave_shr:1 row_mask:0xf bank_mask:0xf
  v_mfma_f32_16x16x32_bf16 v[16:19], v[160:163], v[48:51], v[16:19]
  s_nop 0
  v_add_f32_dpp v226, v224, v25 wave_shr:1 row_mask:0xf bank_mask:0xf
  v_mfma_f32_16x16x32_bf16 v[16:19], v[152:155], v[52:55], v[16:19]
  s_nop 0
  v_add_f32_dpp v228, v226, v24 wave_shr:1 row_mask:0xf bank_mask:0xf
  v_mfma_f32_16x16x32_bf16 v[16:19], v[144:147], v[56:59], v[16:19]
  v_mfma_f32_16x16x32_bf16 v[16:19], v[136:139], v[60:63], v[16:19]
  v_mfma_f32_16x16x32_bf16 v[16:19], v[128:131], v[64:67], v[16:19]
  v_mfma_f32_16x16x32_bf16 v[16:19], v[120:123], v[68:71], v[16:19]
  v_mfma_f32_16x16x32_bf16 v[16:19], v[112:115], v[72:75], v[16:19]
  v_mfma_f32_16x16x32_bf16 v[16:19], v[104:107], v[76:79], v[16:19]
  s_waitcnt lgkmcnt(8)
  v_mfma_f32_16x16x32_bf16 v[16:19], v[96:99], v[80:83], v[16:19]
  s_waitcnt lgkmcnt(6)
  v_mfma_f32_16x16x32_bf16 v[20:23], v[196:199], v[32:35], 0
  ds_read_b64_tr_b16 v[208:209], v13 offset:3616
  ds_read_b64_tr_b16 v[210:211], v13 offset:3584
  ds_read_b64_tr_b16 v[88:89], v12 offset:3584
  ds_read_b64_tr_b16 v[90:91], v12 offset:3616
  v_add_f32_dpp v225, v27, v30 wave_ror:1 row_mask:0xf bank_mask:0xf
  v_mfma_f32_16x16x32_bf16 v[20:23], v[188:191], v[36:39], v[20:23]
  v_add_f32_dpp v227, v224, v29 wave_ror:1 row_mask:0xf bank_mask:0xf
  v_mfma_f32_16x16x32_bf16 v[20:23], v[180:183], v[40:43], v[20:23]
  v_add_f32_dpp v229, v226, v28 wave_ror:1 row_mask:0xf bank_mask:0xf
  v_mfma_f32_16x16x32_bf16 v[20:23], v[172:175], v[44:47], v[20:23]
  v_add_f32_dpp v225, v31, v30 wave_shr:1 row_mask:0xf bank_mask:0xf
  v_mfma_f32_16x16x32_bf16 v[20:23], v[164:167], v[48:51], v[20:23]
  s_nop 0
  v_add_f32_dpp v227, v225, v29 wave_shr:1 row_mask:0xf bank_mask:0xf
  v_mfma_f32_16x16x32_bf16 v[20:23], v[156:159], v[52:55], v[20:23]
  s_nop 0
  v_add_f32_dpp v229, v227, v28 wave_shr:1 row_mask:0xf bank_mask:0xf
  v_mfma_f32_16x16x32_bf16 v[20:23], v[148:151], v[56:59], v[20:23]
  v_cvt_pk_bf16_f32 v243, v228, v229
  v_mfma_f32_16x16x32_bf16 v[20:23], v[140:143], v[60:63], v[20:23]
  v_or_b32 v243, 1, v243
  v_mfma_f32_16x16x32_bf16 v[20:23], v[132:135], v[64:67], v[20:23]
  v_mfma_f32_16x16x32_bf16 v[20:23], v[124:127], v[68:71], v[20:23]
  v_mfma_f32_16x16x32_bf16 v[20:23], v[116:119], v[72:75], v[20:23]
  v_mfma_f32_16x16x32_bf16 v[20:23], v[108:111], v[76:79], v[20:23]
  v_mfma_f32_16x16x32_bf16 v[20:23], v[100:103], v[80:83], v[20:23]
  s_waitcnt lgkmcnt(8)
  v_mfma_f32_16x16x32_bf16 v[24:27], v[200:203], v[32:35], 0
  ds_read_b64_tr_b16 v[212:213], v13 offset:3744
  ds_read_b64_tr_b16 v[214:215], v13 offset:3712
  v_add_f32_dpp v224, v31, v18 wave_ror:1 row_mask:0xf bank_mask:0xf
  v_mfma_f32_16x16x32_bf16 v[24:27], v[192:195], v[36:39], v[24:27]
  v_add_f32_dpp v226, v225, v17 wave_ror:1 row_mask:0xf bank_mask:0xf
  v_mfma_f32_16x16x32_bf16 v[24:27], v[184:187], v[40:43], v[24:27]
  v_add_f32_dpp v228, v227, v16 wave_ror:1 row_mask:0xf bank_mask:0xf
  v_mfma_f32_16x16x32_bf16 v[24:27], v[176:179], v[44:47], v[24:27]
  v_add_f32_dpp v224, v19, v18 wave_shr:1 row_mask:0xf bank_mask:0xf
  v_mfma_f32_16x16x32_bf16 v[24:27], v[168:171], v[48:51], v[24:27]
  s_nop 0
  v_add_f32_dpp v226, v224, v17 wave_shr:1 row_mask:0xf bank_mask:0xf
  v_mfma_f32_16x16x32_bf16 v[24:27], v[160:163], v[52:55], v[24:27]
  s_nop 0
  v_add_f32_dpp v228, v226, v16 wave_shr:1 row_mask:0xf bank_mask:0xf
  v_mfma_f32_16x16x32_bf16 v[24:27], v[152:155], v[56:59], v[24:27]
  v_mfma_f32_16x16x32_bf16 v[24:27], v[144:147], v[60:63], v[24:27]
  v_mfma_f32_16x16x32_bf16 v[24:27], v[136:139], v[64:67], v[24:27]
  v_mfma_f32_16x16x32_bf16 v[24:27], v[128:131], v[68:71], v[24:27]
  v_mfma_f32_16x16x32_bf16 v[24:27], v[120:123], v[72:75], v[24:27]
  v_mfma_f32_16x16x32_bf16 v[24:27], v[112:115], v[76:79], v[24:27]
  v_mfma_f32_16x16x32_bf16 v[24:27], v[104:107], v[80:83], v[24:27]
  s_waitcnt lgkmcnt(8)
  v_mfma_f32_16x16x32_bf16 v[24:27], v[96:99], v[84:87], v[24:27]
  s_waitcnt lgkmcnt(6)
  v_mfma_f32_16x16x32_bf16 v[28:31], v[204:207], v[32:35], 0
  ds_read_b64_tr_b16 v[216:217], v13 offset:3872
  ds_read_b64_tr_b16 v[218:219], v13 offset:3840
  ds_read_b64_tr_b16 v[92:93], v12 offset:3840
  ds_read_b64_tr_b16 v[94:95], v12 offset:3872
  v_add_f32_dpp v225, v19, v22 wave_ror:1 row_mask:0xf bank_mask:0xf
  v_mfma_f32_16x16x32_bf16 v[28:31], v[196:199], v[36:39], v[28:31]
  v_add_f32_dpp v227, v224, v21 wave_ror:1 row_mask:0xf bank_mask:0xf
  v_mfma_f32_16x16x32_bf16 v[28:31], v[188:191], v[40:43], v[28:31]
  v_add_f32_dpp v229, v226, v20 wave_ror:1 row_mask:0xf bank_mask:0xf
  v_mfma_f32_16x16x32_bf16 v[28:31], v[180:183], v[44:47], v[28:31]
  v_add_f32_dpp v225, v23, v22 wave_shr:1 row_mask:0xf bank_mask:0xf
  v_mfma_f32_16x16x32_bf16 v[28:31], v[172:175], v[48:51], v[28:31]
  s_nop 0
  v_add_f32_dpp v227, v225, v21 wave_shr:1 row_mask:0xf bank_mask:0xf
  v_mfma_f32_16x16x32_bf16 v[28:31], v[164:167], v[52:55], v[28:31]
  s_nop 0
  v_add_f32_dpp v229, v227, v20 wave_shr:1 row_mask:0xf bank_mask:0xf
  v_mfma_f32_16x16x32_bf16 v[28:31], v[156:159], v[56:59], v[28:31]
  v_cvt_pk_bf16_f32 v244, v228, v229
  v_mfma_f32_16x16x32_bf16 v[28:31], v[148:151], v[60:63], v[28:31]
  v_or_b32 v244, 1, v244
  v_mfma_f32_16x16x32_bf16 v[28:31], v[140:143], v[64:67], v[28:31]
  v_mfma_f32_16x16x32_bf16 v[28:31], v[132:135], v[68:71], v[28:31]
  v_mfma_f32_16x16x32_bf16 v[28:31], v[124:127], v[72:75], v[28:31]
  v_mfma_f32_16x16x32_bf16 v[28:31], v[116:119], v[76:79], v[28:31]
  v_mfma_f32_16x16x32_bf16 v[28:31], v[108:111], v[80:83], v[28:31]
  v_mfma_f32_16x16x32_bf16 v[28:31], v[100:103], v[84:87], v[28:31]
  s_waitcnt lgkmcnt(8)
  v_mfma_f32_16x16x32_bf16 v[16:19], v[208:211], v[32:35], 0
  ds_read_b64_tr_b16 v[220:221], v13 offset:4000
  ds_read_b64_tr_b16 v[222:223], v13 offset:3968
  v_add_f32_dpp v224, v23, v26 wave_ror:1 row_mask:0xf bank_mask:0xf
  v_mfma_f32_16x16x32_bf16 v[16:19], v[200:203], v[36:39], v[16:19]
  v_add_f32_dpp v226, v225, v25 wave_ror:1 row_mask:0xf bank_mask:0xf
  v_mfma_f32_16x16x32_bf16 v[16:19], v[192:195], v[40:43], v[16:19]
  v_add_f32_dpp v228, v227, v24 wave_ror:1 row_mask:0xf bank_mask:0xf
  v_mfma_f32_16x16x32_bf16 v[16:19], v[184:187], v[44:47], v[16:19]
  v_add_f32_dpp v224, v27, v26 wave_shr:1 row_mask:0xf bank_mask:0xf
  v_mfma_f32_16x16x32_bf16 v[16:19], v[176:179], v[48:51], v[16:19]
  s_nop 0
  v_add_f32_dpp v226, v224, v25 wave_shr:1 row_mask:0xf bank_mask:0xf
  v_mfma_f32_16x16x32_bf16 v[16:19], v[168:171], v[52:55], v[16:19]
  s_nop 0
  v_add_f32_dpp v228, v226, v24 wave_shr:1 row_mask:0xf bank_mask:0xf
  v_mfma_f32_16x16x32_bf16 v[16:19], v[160:163], v[56:59], v[16:19]
  v_mfma_f32_16x16x32_bf16 v[16:19], v[152:155], v[60:63], v[16:19]
  v_mfma_f32_16x16x32_bf16 v[16:19], v[144:147], v[64:67], v[16:19]
  v_mfma_f32_16x16x32_bf16 v[16:19], v[136:139], v[68:71], v[16:19]
  v_mfma_f32_16x16x32_bf16 v[16:19], v[128:131], v[72:75], v[16:19]
  v_mfma_f32_16x16x32_bf16 v[16:19], v[120:123], v[76:79], v[16:19]
  v_mfma_f32_16x16x32_bf16 v[16:19], v[112:115], v[80:83], v[16:19]
  v_mfma_f32_16x16x32_bf16 v[16:19], v[104:107], v[84:87], v[16:19]
  s_waitcnt lgkmcnt(8)
  v_mfma_f32_16x16x32_bf16 v[16:19], v[96:99], v[88:91], v[16:19]
  s_waitcnt lgkmcnt(6)
  v_mfma_f32_16x16x32_bf16 v[20:23], v[212:215], v[32:35], 0
  v_add_f32_dpp v225, v27, v30 wave_ror:1 row_mask:0xf bank_mask:0xf
  v_mfma_f32_16x16x32_bf16 v[20:23], v[204:207], v[36:39], v[20:23]
  v_add_f32_dpp v227, v224, v29 wave_ror:1 row_mask:0xf bank_mask:0xf
  v_mfma_f32_16x16x32_bf16 v[20:23], v[196:199], v[40:43], v[20:23]
  v_add_f32_dpp v229, v226, v28 wave_ror:1 row_mask:0xf bank_mask:0xf
  v_mfma_f32_16x16x32_bf16 v[20:23], v[188:191], v[44:47], v[20:23]
  v_add_f32_dpp v225, v31, v30 wave_shr:1 row_mask:0xf bank_mask:0xf
  v_mfma_f32_16x16x32_bf16 v[20:23], v[180:183], v[48:51], v[20:23]
  s_nop 0
  v_add_f32_dpp v227, v225, v29 wave_shr:1 row_mask:0xf bank_mask:0xf
  v_mfma_f32_16x16x32_bf16 v[20:23], v[172:175], v[52:55], v[20:23]
  s_nop 0
  v_add_f32_dpp v229, v227, v28 wave_shr:1 row_mask:0xf bank_mask:0xf
  v_mfma_f32_16x16x32_bf16 v[20:23], v[164:167], v[56:59], v[20:23]
  v_cvt_pk_bf16_f32 v245, v228, v229
  v_mfma_f32_16x16x32_bf16 v[20:23], v[156:159], v[60:63], v[20:23]
  v_or_b32 v245, 1, v245
  v_mfma_f32_16x16x32_bf16 v[20:23], v[148:151], v[64:67], v[20:23]
  v_mfma_f32_16x16x32_bf16 v[20:23], v[140:143], v[68:71], v[20:23]
  v_mfma_f32_16x16x32_bf16 v[20:23], v[132:135], v[72:75], v[20:23]
  v_mfma_f32_16x16x32_bf16 v[20:23], v[124:127], v[76:79], v[20:23]
  v_mfma_f32_16x16x32_bf16 v[20:23], v[116:119], v[80:83], v[20:23]
  v_mfma_f32_16x16x32_bf16 v[20:23], v[108:111], v[84:87], v[20:23]
  v_mfma_f32_16x16x32_bf16 v[20:23], v[100:103], v[88:91], v[20:23]
  s_waitcnt lgkmcnt(4)
  v_mfma_f32_16x16x32_bf16 v[24:27], v[216:219], v[32:35], 0
  v_add_f32_dpp v224, v31, v18 wave_ror:1 row_mask:0xf bank_mask:0xf
  v_mfma_f32_16x16x32_bf16 v[24:27], v[208:211], v[36:39], v[24:27]
  v_add_f32_dpp v226, v225, v17 wave_ror:1 row_mask:0xf bank_mask:0xf
  v_mfma_f32_16x16x32_bf16 v[24:27], v[200:203], v[40:43], v[24:27]
  v_add_f32_dpp v228, v227, v16 wave_ror:1 row_mask:0xf bank_mask:0xf
  v_mfma_f32_16x16x32_bf16 v[24:27], v[192:195], v[44:47], v[24:27]
  v_add_f32_dpp v224, v19, v18 wave_shr:1 row_mask:0xf bank_mask:0xf
  v_mfma_f32_16x16x32_bf16 v[24:27], v[184:187], v[48:51], v[24:27]
  s_nop 0
  v_add_f32_dpp v226, v224, v17 wave_shr:1 row_mask:0xf bank_mask:0xf
  v_mfma_f32_16x16x32_bf16 v[24:27], v[176:179], v[52:55], v[24:27]
  s_nop 0
  v_add_f32_dpp v228, v226, v16 wave_shr:1 row_mask:0xf bank_mask:0xf
  v_mfma_f32_16x16x32_bf16 v[24:27], v[168:171], v[56:59], v[24:27]
  v_mfma_f32_16x16x32_bf16 v[24:27], v[160:163], v[60:63], v[24:27]
  v_mfma_f32_16x16x32_bf16 v[24:27], v[152:155], v[64:67], v[24:27]
  v_mfma_f32_16x16x32_bf16 v[24:27], v[144:147], v[68:71], v[24:27]
  v_mfma_f32_16x16x32_bf16 v[24:27], v[136:139], v[72:75], v[24:27]
  v_mfma_f32_16x16x32_bf16 v[24:27], v[128:131], v[76:79], v[24:27]
  v_mfma_f32_16x16x32_bf16 v[24:27], v[120:123], v[80:83], v[24:27]
  v_mfma_f32_16x16x32_bf16 v[24:27], v[112:115], v[84:87], v[24:27]
  v_mfma_f32_16x16x32_bf16 v[24:27], v[104:107], v[88:91], v[24:27]
  s_waitcnt lgkmcnt(2)
  v_mfma_f32_16x16x32_bf16 v[24:27], v[96:99], v[92:95], v[24:27]
  s_waitcnt lgkmcnt(0)
  v_mfma_f32_16x16x32_bf16 v[28:31], v[220:223], v[32:35], 0
  v_add_f32_dpp v225, v19, v22 wave_ror:1 row_mask:0xf bank_mask:0xf
  v_mfma_f32_16x16x32_bf16 v[28:31], v[212:215], v[36:39], v[28:31]
  v_add_f32_dpp v227, v224, v21 wave_ror:1 row_mask:0xf bank_mask:0xf
  v_mfma_f32_16x16x32_bf16 v[28:31], v[204:207], v[40:43], v[28:31]
  v_add_f32_dpp v229, v226, v20 wave_ror:1 row_mask:0xf bank_mask:0xf
  v_mfma_f32_16x16x32_bf16 v[28:31], v[196:199], v[44:47], v[28:31]
  v_add_f32_dpp v225, v23, v22 wave_shr:1 row_mask:0xf bank_mask:0xf
  v_mfma_f32_16x16x32_bf16 v[28:31], v[188:191], v[48:51], v[28:31]
  s_nop 0
  v_add_f32_dpp v227, v225, v21 wave_shr:1 row_mask:0xf bank_mask:0xf
  v_mfma_f32_16x16x32_bf16 v[28:31], v[180:183], v[52:55], v[28:31]
  s_nop 0
  v_add_f32_dpp v229, v227, v20 wave_shr:1 row_mask:0xf bank_mask:0xf
  v_mfma_f32_16x16x32_bf16 v[28:31], v[172:175], v[56:59], v[28:31]
  v_cvt_pk_bf16_f32 v246, v228, v229
  v_mfma_f32_16x16x32_bf16 v[28:31], v[164:167], v[60:63], v[28:31]
  v_or_b32 v246, 1, v246
  v_mfma_f32_16x16x32_bf16 v[28:31], v[156:159], v[64:67], v[28:31]
  v_mfma_f32_16x16x32_bf16 v[28:31], v[148:151], v[68:71], v[28:31]
  v_mfma_f32_16x16x32_bf16 v[28:31], v[140:143], v[72:75], v[28:31]
  v_mfma_f32_16x16x32_bf16 v[28:31], v[132:135], v[76:79], v[28:31]
  v_mfma_f32_16x16x32_bf16 v[28:31], v[124:127], v[80:83], v[28:31]
  v_mfma_f32_16x16x32_bf16 v[28:31], v[116:119], v[84:87], v[28:31]
  v_mfma_f32_16x16x32_bf16 v[28:31], v[108:111], v[88:91], v[28:31]
  v_mfma_f32_16x16x32_bf16 v[28:31], v[100:103], v[92:95], v[28:31]
  v_add_f32_dpp v224, v23, v26 wave_ror:1 row_mask:0xf bank_mask:0xf
  v_add_f32_dpp v226, v225, v25 wave_ror:1 row_mask:0xf bank_mask:0xf
  v_add_f32_dpp v228, v227, v24 wave_ror:1 row_mask:0xf bank_mask:0xf
  v_add_f32_dpp v224, v27, v26 wave_shr:1 row_mask:0xf bank_mask:0xf
  s_nop 1
  v_add_f32_dpp v226, v224, v25 wave_shr:1 row_mask:0xf bank_mask:0xf
  s_nop 1
  v_add_f32_dpp v228, v226, v24 wave_shr:1 row_mask:0xf bank_mask:0xf
  v_add_f32_dpp v225, v27, v30 wave_ror:1 row_mask:0xf bank_mask:0xf
  v_add_f32_dpp v227, v224, v29 wave_ror:1 row_mask:0xf bank_mask:0xf
  v_add_f32_dpp v229, v226, v28 wave_ror:1 row_mask:0xf bank_mask:0xf
  v_add_f32_dpp v225, v31, v30 wave_shr:1 row_mask:0xf bank_mask:0xf
  s_nop 1
  v_add_f32_dpp v227, v225, v29 wave_shr:1 row_mask:0xf bank_mask:0xf
  s_nop 1
  v_add_f32_dpp v229, v227, v28 wave_shr:1 row_mask:0xf bank_mask:0xf
  v_cvt_pk_bf16_f32 v247, v228, v229
  v_or_b32 v247, 1, v247
  s_add_u32 s28, s98, 16777216
  s_addc_u32 s29, s99, 0
  s_mov_b32 s30, 4194304
  s_mov_b32 s31, 0x20000
  s_lshl_b32 s40, s6, 12
  buffer_store_dwordx4 v[232:235], v3, s[28:31], s40 offen offset:0 sc1
  buffer_store_dwordx4 v[236:239], v3, s[28:31], s40 offen offset:1024 sc1
  buffer_store_dwordx4 v[240:243], v3, s[28:31], s40 offen offset:2048 sc1
  buffer_store_dwordx4 v[244:247], v3, s[28:31], s40 offen offset:3072 sc1
  s_and_b32 s40, s10, 3
  s_lshl_b32 s40, s40, 2
  s_and_b32 s41, s11, 3
  s_add_u32 s40, s40, s41
  s_lshl_b32 s41, s40, 3
  s_lshl_b32 s42, s3, 1
  s_add_u32 s41, s41, s42
  s_lshl_b32 s48, s41, 15
  s_mov_b32 s47, s48
  v_lshrrev_b32 v5, 5, v2
  v_and_b32 v6, 1, v14
  v_lshlrev_b32 v12, 15, v6
  v_lshl_add_u32 v12, v5, 8, v12
  v_lshl_add_u32 v12, v15, 4, v12
  s_add_u32 s28, s98, 0
  s_addc_u32 s29, s99, 0
  s_mov_b32 s30, 4194304
  s_mov_b32 s31, 0x20000
  s_mov_b32 s32, s94
  s_mov_b32 s33, s95
  s_mov_b32 s34, 8388608
  s_mov_b32 s35, 0x20000
  s_waitcnt lgkmcnt(0)
  s_mov_b64 exec, 1
  ds_add_u32 v9, v11 offset:56
  s_mov_b64 exec, -1
  s_mov_b32 s43, 131072
K3_wwo:
  ds_read_b32 v80, v10 offset:48
  s_waitcnt lgkmcnt(0)
  v_readfirstlane_b32 s42, v80
  s_sub_u32 s43, s43, 1
  s_cbranch_scc1 K3_wwo_ok
  s_cmp_lt_u32 s42, 4
  s_cbranch_scc1 K3_wwo
K3_wwo_ok:
  buffer_load_dwordx4 v[96:99], v12, s[28:31], s48 offen offset:0
  buffer_load_dwordx4 v[100:103], v12, s[28:31], s48 offen offset:512
  buffer_load_dwordx4 v[104:107], v12, s[28:31], s48 offen offset:1024
  buffer_load_dwordx4 v[108:111], v12, s[28:31], s48 offen offset:1536
  buffer_load_dwordx4 v[112:115], v12, s[28:31], s48 offen offset:2048
  buffer_load_dwordx4 v[116:119], v12, s[28:31], s48 offen offset:2560
  buffer_load_dwordx4 v[120:123], v12, s[28:31], s48 offen offset:3072
  buffer_load_dwordx4 v[124:127], v12, s[28:31], s48 offen offset:3584
  s_add_u32 s48, s48, 4096
  buffer_load_dwordx4 v[128:131], v12, s[28:31], s48 offen offset:0
  buffer_load_dwordx4 v[132:135], v12, s[28:31], s48 offen offset:512
  buffer_load_dwordx4 v[136:139], v12, s[28:31], s48 offen offset:1024
  buffer_load_dwordx4 v[140:143], v12, s[28:31], s48 offen offset:1536
  buffer_load_dwordx4 v[144:147], v12, s[28:31], s48 offen offset:2048
  buffer_load_dwordx4 v[148:151], v12, s[28:31], s48 offen offset:2560
  buffer_load_dwordx4 v[152:155], v12, s[28:31], s48 offen offset:3072
  buffer_load_dwordx4 v[156:159], v12, s[28:31], s48 offen offset:3584
  s_add_u32 s48, s48, 4096
  v_bfe_u32 v4, v2, 2, 2
  v_and_b32 v7, 3, v2
  v_lshlrev_b32 v4, 6, v4
  v_lshl_add_u32 v4, v7, 3, v4
  v_lshl_add_u32 v4, v5, 9, v4
  v_xor_b32 v7, v6, v5
  v_lshl_add_u32 v13, v7, 5, v4
  v_add_u32 v4, 40960, v13
  v_add_u32 v8, 106496, v13
  ds_read_b64_tr_b16 v[48:49], v4 offset:0
  ds_read_b64_tr_b16 v[50:51], v4 offset:2048
  ds_read_b64_tr_b16 v[52:53], v4 offset:256
  ds_read_b64_tr_b16 v[54:55], v4 offset:2304
  ds_read_b64_tr_b16 v[56:57], v4 offset:1024
  ds_read_b64_tr_b16 v[58:59], v4 offset:3072
  ds_read_b64_tr_b16 v[60:61], v4 offset:1280
  ds_read_b64_tr_b16 v[62:63], v4 offset:3328
  s_waitcnt vmcnt(8)
  v_bitop3_b32 v81, v96, v97, v98 bitop3:0x80
  v_bitop3_b32 v81, v81, v99, v100 bitop3:0x80
  v_bitop3_b32 v81, v81, v101, v102 bitop3:0x80
  v_bitop3_b32 v81, v81, v103, v104 bitop3:0x80
  v_bitop3_b32 v81, v81, v105, v106 bitop3:0x80
  v_bitop3_b32 v81, v81, v107, v108 bitop3:0x80
  v_bitop3_b32 v81, v81, v109, v110 bitop3:0x80
  v_bitop3_b32 v81, v81, v111, v112 bitop3:0x80
  v_bitop3_b32 v81, v81, v113, v114 bitop3:0x80
  v_bitop3_b32 v81, v81, v115, v116 bitop3:0x80
  v_bitop3_b32 v81, v81, v117, v118 bitop3:0x80
  v_bitop3_b32 v81, v81, v119, v120 bitop3:0x80
  v_bitop3_b32 v81, v81, v121, v122 bitop3:0x80
  v_bitop3_b32 v81, v81, v123, v124 bitop3:0x80
  v_bitop3_b32 v81, v81, v125, v126 bitop3:0x80
  v_bitop3_b32 v81, v81, v127, 1 bitop3:0x80
  v_cmp_eq_u32 vcc, 0, v81
  s_nop 0
  s_cmp_lg_u64 vcc, 0
  s_cbranch_scc1 K3_retry0
K3_retry0_ret:
  s_waitcnt lgkmcnt(6)
  v_mfma_f32_32x32x16_bf16 v[16:31], v[48:51], v[96:99], 0
  ds_read_b64_tr_b16 v[64:65], v4 offset:4096
  ds_read_b64_tr_b16 v[66:67], v4 offset:6144
  s_waitcnt lgkmcnt(6)
  v_mfma_f32_32x32x16_bf16 v[32:47], v[52:55], v[96:99], 0
  ds_read_b64_tr_b16 v[68:69], v4 offset:4352
  ds_read_b64_tr_b16 v[70:71], v4 offset:6400
  s_waitcnt lgkmcnt(6)
  v_mfma_f32_32x32x16_bf16 v[16:31], v[56:59], v[100:103], v[16:31]
  ds_read_b64_tr_b16 v[72:73], v4 offset:5120
  ds_read_b64_tr_b16 v[74:75], v4 offset:7168
  s_waitcnt lgkmcnt(6)
  v_mfma_f32_32x32x16_bf16 v[32:47], v[60:63], v[100:103], v[32:47]
  ds_read_b64_tr_b16 v[76:77], v4 offset:5376
  ds_read_b64_tr_b16 v[78:79], v4 offset:7424
  buffer_load_dwordx4 v[160:163], v12, s[28:31], s48 offen offset:0
  buffer_load_dwordx4 v[164:167], v12, s[28:31], s48 offen offset:512
  buffer_load_dwordx4 v[168:171], v12, s[28:31], s48 offen offset:1024
  buffer_load_dwordx4 v[172:175], v12, s[28:31], s48 offen offset:1536
  s_waitcnt lgkmcnt(6)
  v_mfma_f32_32x32x16_bf16 v[16:31], v[64:67], v[104:107], v[16:31]
  ds_read_b64_tr_b16 v[48:49], v4 offset:8192
  ds_read_b64_tr_b16 v[50:51], v4 offset:10240
  s_waitcnt lgkmcnt(6)
  v_mfma_f32_32x32x16_bf16 v[32:47], v[68:71], v[104:107], v[32:47]
  ds_read_b64_tr_b16 v[52:53], v4 offset:8448
  ds_read_b64_tr_b16 v[54:55], v4 offset:10496
  s_waitcnt lgkmcnt(6)
  v_mfma_f32_32x32x16_bf16 v[16:31], v[72:75], v[108:111], v[16:31]
  ds_read_b64_tr_b16 v[56:57], v4 offset:9216
  ds_read_b64_tr_b16 v[58:59], v4 offset:11264
  s_waitcnt lgkmcnt(6)
  v_mfma_f32_32x32x16_bf16 v[32:47], v[76:79], v[108:111], v[32:47]
  ds_read_b64_tr_b16 v[60:61], v4 offset:9472
  ds_read_b64_tr_b16 v[62:63], v4 offset:11520
  buffer_load_dwordx4 v[176:179], v12, s[28:31], s48 offen offset:2048
  buffer_load_dwordx4 v[180:183], v12, s[28:31], s48 offen offset:2560
  buffer_load_dwordx4 v[184:187], v12, s[28:31], s48 offen offset:3072
  buffer_load_dwordx4 v[188:191], v12, s[28:31], s48 offen offset:3584
  s_add_u32 s48, s48, 4096
  s_waitcnt vmcnt(8)
  s_waitcnt lgkmcnt(6)
  v_mfma_f32_32x32x16_bf16 v[16:31], v[48:51], v[112:115], v[16:31]
  ds_read_b64_tr_b16 v[64:65], v4 offset:12288
  v_bitop3_b32 v81, v128, v129, v130 bitop3:0x80
  ds_read_b64_tr_b16 v[66:67], v4 offset:14336
  v_bitop3_b32 v81, v81, v131, v132 bitop3:0x80
  s_waitcnt lgkmcnt(6)
  v_mfma_f32_32x32x16_bf16 v[32:47], v[52:55], v[112:115], v[32:47]
  ds_read_b64_tr_b16 v[68:69], v4 offset:12544
  v_bitop3_b32 v81, v81, v133, v134 bitop3:0x80
  ds_read_b64_tr_b16 v[70:71], v4 offset:14592
  v_bitop3_b32 v81, v81, v135, v136 bitop3:0x80
  s_waitcnt lgkmcnt(6)
  v_mfma_f32_32x32x16_bf16 v[16:31], v[56:59], v[116:119], v[16:31]
  ds_read_b64_tr_b16 v[72:73], v4 offset:13312
  v_bitop3_b32 v81, v81, v137, v138 bitop3:0x80
  ds_read_b64_tr_b16 v[74:75], v4 offset:15360
  v_bitop3_b32 v81, v81, v139, v140 bitop3:0x80
  s_waitcnt lgkmcnt(6)
  v_mfma_f32_32x32x16_bf16 v[32:47], v[60:63], v[116:119], v[32:47]
  ds_read_b64_tr_b16 v[76:77], v4 offset:13568
  v_bitop3_b32 v81, v81, v141, v142 bitop3:0x80
  ds_read_b64_tr_b16 v[78:79], v4 offset:15616
  v_bitop3_b32 v81, v81, v143, v144 bitop3:0x80
  buffer_load_dwordx4 v[192:195], v12, s[28:31], s48 offen offset:0
  buffer_load_dwordx4 v[196:199], v12, s[28:31], s48 offen offset:512
  buffer_load_dwordx4 v[200:203], v12, s[28:31], s48 offen offset:1024
  buffer_load_dwordx4 v[204:207], v12, s[28:31], s48 offen offset:1536
  s_waitcnt lgkmcnt(6)
  v_mfma_f32_32x32x16_bf16 v[16:31], v[64:67], v[120:123], v[16:31]
  ds_read_b64_tr_b16 v[48:49], v4 offset:16384
  v_bitop3_b32 v81, v81, v145, v146 bitop3:0x80
  ds_read_b64_tr_b16 v[50:51], v4 offset:18432
  v_bitop3_b32 v81, v81, v147, v148 bitop3:0x80
  s_waitcnt lgkmcnt(6)
  v_mfma_f32_32x32x16_bf16 v[32:47], v[68:71], v[120:123], v[32:47]
  ds_read_b64_tr_b16 v[52:53], v4 offset:16640
  v_bitop3_b32 v81, v81, v149, v150 bitop3:0x80
  ds_read_b64_tr_b16 v[54:55], v4 offset:18688
  v_bitop3_b32 v81, v81, v151, v152 bitop3:0x80
  s_waitcnt lgkmcnt(6)
  v_mfma_f32_32x32x16_bf16 v[16:31], v[72:75], v[124:127], v[16:31]
  ds_read_b64_tr_b16 v[56:57], v4 offset:17408
  v_bitop3_b32 v81, v81, v153, v154 bitop3:0x80
  ds_read_b64_tr_b16 v[58:59], v4 offset:19456
  v_bitop3_b32 v81, v81, v155, v156 bitop3:0x80
  s_waitcnt lgkmcnt(6)
  v_mfma_f32_32x32x16_bf16 v[32:47], v[76:79], v[124:127], v[32:47]
  ds_read_b64_tr_b16 v[60:61], v4 offset:17664
  v_bitop3_b32 v81, v81, v157, v158 bitop3:0x80
  ds_read_b64_tr_b16 v[62:63], v4 offset:19712
  v_bitop3_b32 v81, v81, v159, 1 bitop3:0x80
  v_cmp_eq_u32 vcc, 0, v81
  s_nop 0
  s_cmp_lg_u64 vcc, 0
  s_cbranch_scc1 K3_retry1
K3_retry1_ret:
  buffer_load_dwordx4 v[208:211], v12, s[28:31], s48 offen offset:2048
  buffer_load_dwordx4 v[212:215], v12, s[28:31], s48 offen offset:2560
  buffer_load_dwordx4 v[216:219], v12, s[28:31], s48 offen offset:3072
  buffer_load_dwordx4 v[220:223], v12, s[28:31], s48 offen offset:3584
  s_add_u32 s48, s48, 4096
  s_waitcnt lgkmcnt(6)
  v_mfma_f32_32x32x16_bf16 v[16:31], v[48:51], v[128:131], v[16:31]
  ds_read_b64_tr_b16 v[64:65], v4 offset:20480
  ds_read_b64_tr_b16 v[66:67], v4 offset:22528
  s_waitcnt lgkmcnt(6)
  v_mfma_f32_32x32x16_bf16 v[32:47], v[52:55], v[128:131], v[32:47]
  ds_read_b64_tr_b16 v[68:69], v4 offset:20736
  ds_read_b64_tr_b16 v[70:71], v4 offset:22784
  s_waitcnt lgkmcnt(6)
  v_mfma_f32_32x32x16_bf16 v[16:31], v[56:59], v[132:135], v[16:31]
  ds_read_b64_tr_b16 v[72:73], v4 offset:21504
  ds_read_b64_tr_b16 v[74:75], v4 offset:23552
  s_waitcnt lgkmcnt(6)
  v_mfma_f32_32x32x16_bf16 v[32:47], v[60:63], v[132:135], v[32:47]
  ds_read_b64_tr_b16 v[76:77], v4 offset:21760
  ds_read_b64_tr_b16 v[78:79], v4 offset:23808
  buffer_load_dwordx4 v[96:99], v12, s[28:31], s48 offen offset:0
  buffer_load_dwordx4 v[100:103], v12, s[28:31], s48 offen offset:512
  buffer_load_dwordx4 v[104:107], v12, s[28:31], s48 offen offset:1024
  buffer_load_dwordx4 v[108:111], v12, s[28:31], s48 offen offset:1536
  s_waitcnt lgkmcnt(6)
  v_mfma_f32_32x32x16_bf16 v[16:31], v[64:67], v[136:139], v[16:31]
  ds_read_b64_tr_b16 v[48:49], v4 offset:24576
  ds_read_b64_tr_b16 v[50:51], v4 offset:26624
  s_waitcnt lgkmcnt(6)
  v_mfma_f32_32x32x16_bf16 v[32:47], v[68:71], v[136:139], v[32:47]
  ds_read_b64_tr_b16 v[52:53], v4 offset:24832
  ds_read_b64_tr_b16 v[54:55], v4 offset:26880
  s_waitcnt lgkmcnt(6)
  v_mfma_f32_32x32x16_bf16 v[16:31], v[72:75], v[140:143], v[16:31]
  ds_read_b64_tr_b16 v[56:57], v4 offset:25600
  ds_read_b64_tr_b16 v[58:59], v4 offset:27648
  s_waitcnt lgkmcnt(6)
  v_mfma_f32_32x32x16_bf16 v[32:47], v[76:79], v[140:143], v[32:47]
  ds_read_b64_tr_b16 v[60:61], v4 offset:25856
  ds_read_b64_tr_b16 v[62:63], v4 offset:27904
  buffer_load_dwordx4 v[112:115], v12, s[28:31], s48 offen offset:2048
  buffer_load_dwordx4 v[116:119], v12, s[28:31], s48 offen offset:2560
  buffer_load_dwordx4 v[120:123], v12, s[28:31], s48 offen offset:3072
  buffer_load_dwordx4 v[124:127], v12, s[28:31], s48 offen offset:3584
  s_add_u32 s48, s48, 4096
  s_waitcnt vmcnt(16)
  s_waitcnt lgkmcnt(6)
  v_mfma_f32_32x32x16_bf16 v[16:31], v[48:51], v[144:147], v[16:31]
  ds_read_b64_tr_b16 v[64:65], v4 offset:28672
  v_bitop3_b32 v81, v160, v161, v162 bitop3:0x80
  ds_read_b64_tr_b16 v[66:67], v4 offset:30720
  v_bitop3_b32 v81, v81, v163, v164 bitop3:0x80
  s_waitcnt lgkmcnt(6)
  v_mfma_f32_32x32x16_bf16 v[32:47], v[52:55], v[144:147], v[32:47]
  ds_read_b64_tr_b16 v[68:69], v4 offset:28928
  v_bitop3_b32 v81, v81, v165, v166 bitop3:0x80
  ds_read_b64_tr_b16 v[70:71], v4 offset:30976
  v_bitop3_b32 v81, v81, v167, v168 bitop3:0x80
  s_waitcnt lgkmcnt(6)
  v_mfma_f32_32x32x16_bf16 v[16:31], v[56:59], v[148:151], v[16:31]
  ds_read_b64_tr_b16 v[72:73], v4 offset:29696
  v_bitop3_b32 v81, v81, v169, v170 bitop3:0x80
  ds_read_b64_tr_b16 v[74:75], v4 offset:31744
  v_bitop3_b32 v81, v81, v171, v172 bitop3:0x80
  s_waitcnt lgkmcnt(6)
  v_mfma_f32_32x32x16_bf16 v[32:47], v[60:63], v[148:151], v[32:47]
  ds_read_b64_tr_b16 v[76:77], v4 offset:29952
  v_bitop3_b32 v81, v81, v173, v174 bitop3:0x80
  ds_read_b64_tr_b16 v[78:79], v4 offset:32000
  v_bitop3_b32 v81, v81, v175, v176 bitop3:0x80
  buffer_load_dwordx4 v[128:131], v12, s[28:31], s48 offen offset:0
  buffer_load_dwordx4 v[132:135], v12, s[28:31], s48 offen offset:512
  buffer_load_dwordx4 v[136:139], v12, s[28:31], s48 offen offset:1024
  buffer_load_dwordx4 v[140:143], v12, s[28:31], s48 offen offset:1536
  s_waitcnt lgkmcnt(6)
  v_mfma_f32_32x32x16_bf16 v[16:31], v[64:67], v[152:155], v[16:31]
  ds_read_b64_tr_b16 v[48:49], v4 offset:32768
  v_bitop3_b32 v81, v81, v177, v178 bitop3:0x80
  ds_read_b64_tr_b16 v[50:51], v4 offset:34816
  v_bitop3_b32 v81, v81, v179, v180 bitop3:0x80
  s_waitcnt lgkmcnt(6)
  v_mfma_f32_32x32x16_bf16 v[32:47], v[68:71], v[152:155], v[32:47]
  ds_read_b64_tr_b16 v[52:53], v4 offset:33024
  v_bitop3_b32 v81, v81, v181, v182 bitop3:0x80
  ds_read_b64_tr_b16 v[54:55], v4 offset:35072
  v_bitop3_b32 v81, v81, v183, v184 bitop3:0x80
  s_waitcnt lgkmcnt(6)
  v_mfma_f32_32x32x16_bf16 v[16:31], v[72:75], v[156:159], v[16:31]
  ds_read_b64_tr_b16 v[56:57], v4 offset:33792
  v_bitop3_b32 v81, v81, v185, v186 bitop3:0x80
  ds_read_b64_tr_b16 v[58:59], v4 offset:35840
  v_bitop3_b32 v81, v81, v187, v188 bitop3:0x80
  s_waitcnt lgkmcnt(6)
  v_mfma_f32_32x32x16_bf16 v[32:47], v[76:79], v[156:159], v[32:47]
  ds_read_b64_tr_b16 v[60:61], v4 offset:34048
  v_bitop3_b32 v81, v81, v189, v190 bitop3:0x80
  ds_read_b64_tr_b16 v[62:63], v4 offset:36096
  v_bitop3_b32 v81, v81, v191, 1 bitop3:0x80
  v_cmp_eq_u32 vcc, 0, v81
  s_nop 0
  s_cmp_lg_u64 vcc, 0
  s_cbranch_scc1 K3_retry2
K3_retry2_ret:
  buffer_load_dwordx4 v[144:147], v12, s[28:31], s48 offen offset:2048
  buffer_load_dwordx4 v[148:151], v12, s[28:31], s48 offen offset:2560
  buffer_load_dwordx4 v[152:155], v12, s[28:31], s48 offen offset:3072
  buffer_load_dwordx4 v[156:159], v12, s[28:31], s48 offen offset:3584
  s_add_u32 s48, s48, 4096
  s_waitcnt lgkmcnt(6)
  v_mfma_f32_32x32x16_bf16 v[16:31], v[48:51], v[160:163], v[16:31]
  ds_read_b64_tr_b16 v[64:65], v4 offset:36864
  ds_read_b64_tr_b16 v[66:67], v4 offset:38912
  s_waitcnt lgkmcnt(6)
  v_mfma_f32_32x32x16_bf16 v[32:47], v[52:55], v[160:163], v[32:47]
  ds_read_b64_tr_b16 v[68:69], v4 offset:37120
  ds_read_b64_tr_b16 v[70:71], v4 offset:39168
  s_waitcnt lgkmcnt(6)
  v_mfma_f32_32x32x16_bf16 v[16:31], v[56:59], v[164:167], v[16:31]
  ds_read_b64_tr_b16 v[72:73], v4 offset:37888
  ds_read_b64_tr_b16 v[74:75], v4 offset:39936
  s_waitcnt lgkmcnt(6)
  v_mfma_f32_32x32x16_bf16 v[32:47], v[60:63], v[164:167], v[32:47]
  ds_read_b64_tr_b16 v[76:77], v4 offset:38144
  ds_read_b64_tr_b16 v[78:79], v4 offset:40192
  buffer_load_dwordx4 v[160:163], v12, s[28:31], s48 offen offset:0
  buffer_load_dwordx4 v[164:167], v12, s[28:31], s48 offen offset:512
  s_waitcnt lgkmcnt(6)
  v_mfma_f32_32x32x16_bf16 v[16:31], v[64:67], v[168:171], v[16:31]
  ds_read_b64_tr_b16 v[48:49], v4 offset:40960
  ds_read_b64_tr_b16 v[50:51], v4 offset:43008
  s_waitcnt lgkmcnt(6)
  v_mfma_f32_32x32x16_bf16 v[32:47], v[68:71], v[168:171], v[32:47]
  ds_read_b64_tr_b16 v[52:53], v4 offset:41216
  ds_read_b64_tr_b16 v[54:55], v4 offset:43264
  s_waitcnt lgkmcnt(6)
  v_mfma_f32_32x32x16_bf16 v[16:31], v[72:75], v[172:175], v[16:31]
  ds_read_b64_tr_b16 v[56:57], v4 offset:41984
  ds_read_b64_tr_b16 v[58:59], v4 offset:44032
  s_waitcnt lgkmcnt(6)
  v_mfma_f32_32x32x16_bf16 v[32:47], v[76:79], v[172:175], v[32:47]
  ds_read_b64_tr_b16 v[60:61], v4 offset:42240
  ds_read_b64_tr_b16 v[62:63], v4 offset:44288
  buffer_load_dwordx4 v[168:171], v12, s[28:31], s48 offen offset:1024
  buffer_load_dwordx4 v[172:175], v12, s[28:31], s48 offen offset:1536
  s_waitcnt vmcnt(20)
  s_waitcnt lgkmcnt(6)
  v_mfma_f32_32x32x16_bf16 v[16:31], v[48:51], v[176:179], v[16:31]
  ds_read_b64_tr_b16 v[64:65], v4 offset:45056
  v_bitop3_b32 v81, v192, v193, v194 bitop3:0x80
  ds_read_b64_tr_b16 v[66:67], v4 offset:47104
  v_bitop3_b32 v81, v81, v195, v196 bitop3:0x80
  s_waitcnt lgkmcnt(6)
  v_mfma_f32_32x32x16_bf16 v[32:47], v[52:55], v[176:179], v[32:47]
  ds_read_b64_tr_b16 v[68:69], v4 offset:45312
  v_bitop3_b32 v81, v81, v197, v198 bitop3:0x80
  ds_read_b64_tr_b16 v[70:71], v4 offset:47360
  v_bitop3_b32 v81, v81, v199, v200 bitop3:0x80
  s_waitcnt lgkmcnt(6)
  v_mfma_f32_32x32x16_bf16 v[16:31], v[56:59], v[180:183], v[16:31]
  ds_read_b64_tr_b16 v[72:73], v4 offset:46080
  v_bitop3_b32 v81, v81, v201, v202 bitop3:0x80
  ds_read_b64_tr_b16 v[74:75], v4 offset:48128
  v_bitop3_b32 v81, v81, v203, v204 bitop3:0x80
  s_waitcnt lgkmcnt(6)
  v_mfma_f32_32x32x16_bf16 v[32:47], v[60:63], v[180:183], v[32:47]
  ds_read_b64_tr_b16 v[76:77], v4 offset:46336
  v_bitop3_b32 v81, v81, v205, v206 bitop3:0x80
  ds_read_b64_tr_b16 v[78:79], v4 offset:48384
  v_bitop3_b32 v81, v81, v207, v208 bitop3:0x80
  buffer_load_dwordx4 v[176:179], v12, s[28:31], s48 offen offset:2048
  buffer_load_dwordx4 v[180:183], v12, s[28:31], s48 offen offset:2560
  s_waitcnt lgkmcnt(6)
  v_mfma_f32_32x32x16_bf16 v[16:31], v[64:67], v[184:187], v[16:31]
  ds_read_b64_tr_b16 v[48:49], v4 offset:49152
  v_bitop3_b32 v81, v81, v209, v210 bitop3:0x80
  ds_read_b64_tr_b16 v[50:51], v4 offset:51200
  v_bitop3_b32 v81, v81, v211, v212 bitop3:0x80
  s_waitcnt lgkmcnt(6)
  v_mfma_f32_32x32x16_bf16 v[32:47], v[68:71], v[184:187], v[32:47]
  ds_read_b64_tr_b16 v[52:53], v4 offset:49408
  v_bitop3_b32 v81, v81, v213, v214 bitop3:0x80
  ds_read_b64_tr_b16 v[54:55], v4 offset:51456
  v_bitop3_b32 v81, v81, v215, v216 bitop3:0x80
  s_waitcnt lgkmcnt(6)
  v_mfma_f32_32x32x16_bf16 v[16:31], v[72:75], v[188:191], v[16:31]
  ds_read_b64_tr_b16 v[56:57], v4 offset:50176
  v_bitop3_b32 v81, v81, v217, v218 bitop3:0x80
  ds_read_b64_tr_b16 v[58:59], v4 offset:52224
  v_bitop3_b32 v81, v81, v219, v220 bitop3:0x80
  s_waitcnt lgkmcnt(6)
  v_mfma_f32_32x32x16_bf16 v[32:47], v[76:79], v[188:191], v[32:47]
  ds_read_b64_tr_b16 v[60:61], v4 offset:50432
  v_bitop3_b32 v81, v81, v221, v222 bitop3:0x80
  ds_read_b64_tr_b16 v[62:63], v4 offset:52480
  v_bitop3_b32 v81, v81, v223, 1 bitop3:0x80
  v_cmp_eq_u32 vcc, 0, v81
  s_nop 0
  s_cmp_lg_u64 vcc, 0
  s_cbranch_scc1 K3_retry3
K3_retry3_ret:
  buffer_load_dwordx4 v[184:187], v12, s[28:31], s48 offen offset:3072
  buffer_load_dwordx4 v[188:191], v12, s[28:31], s48 offen offset:3584
  s_add_u32 s48, s48, 4096
  s_waitcnt lgkmcnt(6)
  v_mfma_f32_32x32x16_bf16 v[16:31], v[48:51], v[192:195], v[16:31]
  ds_read_b64_tr_b16 v[64:65], v4 offset:53248
  ds_read_b64_tr_b16 v[66:67], v4 offset:55296
  s_waitcnt lgkmcnt(6)
  v_mfma_f32_32x32x16_bf16 v[32:47], v[52:55], v[192:195], v[32:47]
  ds_read_b64_tr_b16 v[68:69], v4 offset:53504
  ds_read_b64_tr_b16 v[70:71], v4 offset:55552
  s_waitcnt lgkmcnt(6)
  v_mfma_f32_32x32x16_bf16 v[16:31], v[56:59], v[196:199], v[16:31]
  ds_read_b64_tr_b16 v[72:73], v4 offset:54272
  ds_read_b64_tr_b16 v[74:75], v4 offset:56320
  s_waitcnt lgkmcnt(6)
  v_mfma_f32_32x32x16_bf16 v[32:47], v[60:63], v[196:199], v[32:47]
  ds_read_b64_tr_b16 v[76:77], v4 offset:54528
  ds_read_b64_tr_b16 v[78:79], v4 offset:56576
  buffer_load_dwordx4 v[192:195], v12, s[28:31], s48 offen offset:0
  buffer_load_dwordx4 v[196:199], v12, s[28:31], s48 offen offset:512
  s_waitcnt lgkmcnt(6)
  v_mfma_f32_32x32x16_bf16 v[16:31], v[64:67], v[200:203], v[16:31]
  ds_read_b64_tr_b16 v[48:49], v4 offset:57344
  ds_read_b64_tr_b16 v[50:51], v4 offset:59392
  s_waitcnt lgkmcnt(6)
  v_mfma_f32_32x32x16_bf16 v[32:47], v[68:71], v[200:203], v[32:47]
  ds_read_b64_tr_b16 v[52:53], v4 offset:57600
  ds_read_b64_tr_b16 v[54:55], v4 offset:59648
  s_waitcnt lgkmcnt(6)
  v_mfma_f32_32x32x16_bf16 v[16:31], v[72:75], v[204:207], v[16:31]
  ds_read_b64_tr_b16 v[56:57], v4 offset:58368
  ds_read_b64_tr_b16 v[58:59], v4 offset:60416
  s_waitcnt lgkmcnt(6)
  v_mfma_f32_32x32x16_bf16 v[32:47], v[76:79], v[204:207], v[32:47]
  ds_read_b64_tr_b16 v[60:61], v4 offset:58624
  ds_read_b64_tr_b16 v[62:63], v4 offset:60672
  buffer_load_dwordx4 v[200:203], v12, s[28:31], s48 offen offset:1024
  buffer_load_dwordx4 v[204:207], v12, s[28:31], s48 offen offset:1536
  s_waitcnt vmcnt(20)
  s_waitcnt lgkmcnt(6)
  v_mfma_f32_32x32x16_bf16 v[16:31], v[48:51], v[208:211], v[16:31]
  ds_read_b64_tr_b16 v[64:65], v4 offset:61440
  v_bitop3_b32 v81, v96, v97, v98 bitop3:0x80
  ds_read_b64_tr_b16 v[66:67], v4 offset:63488
  v_bitop3_b32 v81, v81, v99, v100 bitop3:0x80
  s_waitcnt lgkmcnt(6)
  v_mfma_f32_32x32x16_bf16 v[32:47], v[52:55], v[208:211], v[32:47]
  ds_read_b64_tr_b16 v[68:69], v4 offset:61696
  v_bitop3_b32 v81, v81, v101, v102 bitop3:0x80
  ds_read_b64_tr_b16 v[70:71], v4 offset:63744
  v_bitop3_b32 v81, v81, v103, v104 bitop3:0x80
  s_waitcnt lgkmcnt(6)
  v_mfma_f32_32x32x16_bf16 v[16:31], v[56:59], v[212:215], v[16:31]
  ds_read_b64_tr_b16 v[72:73], v4 offset:62464
  v_bitop3_b32 v81, v81, v105, v106 bitop3:0x80
  ds_read_b64_tr_b16 v[74:75], v4 offset:64512
  v_bitop3_b32 v81, v81, v107, v108 bitop3:0x80
  s_waitcnt lgkmcnt(6)
  v_mfma_f32_32x32x16_bf16 v[32:47], v[60:63], v[212:215], v[32:47]
  ds_read_b64_tr_b16 v[76:77], v4 offset:62720
  v_bitop3_b32 v81, v81, v109, v110 bitop3:0x80
  ds_read_b64_tr_b16 v[78:79], v4 offset:64768
  v_bitop3_b32 v81, v81, v111, v112 bitop3:0x80
  buffer_load_dwordx4 v[208:211], v12, s[28:31], s48 offen offset:2048
  buffer_load_dwordx4 v[212:215], v12, s[28:31], s48 offen offset:2560
  s_waitcnt lgkmcnt(6)
  v_mfma_f32_32x32x16_bf16 v[16:31], v[64:67], v[216:219], v[16:31]
  ds_read_b64_tr_b16 v[48:49], v8 offset:0
  v_bitop3_b32 v81, v81, v113, v114 bitop3:0x80
  ds_read_b64_tr_b16 v[50:51], v8 offset:2048
  v_bitop3_b32 v81, v81, v115, v116 bitop3:0x80
  s_waitcnt lgkmcnt(6)
  v_mfma_f32_32x32x16_bf16 v[32:47], v[68:71], v[216:219], v[32:47]
  ds_read_b64_tr_b16 v[52:53], v8 offset:256
  v_bitop3_b32 v81, v81, v117, v118 bitop3:0x80
  ds_read_b64_tr_b16 v[54:55], v8 offset:2304
  v_bitop3_b32 v81, v81, v119, v120 bitop3:0x80
  s_waitcnt lgkmcnt(6)
  v_mfma_f32_32x32x16_bf16 v[16:31], v[72:75], v[220:223], v[16:31]
  ds_read_b64_tr_b16 v[56:57], v8 offset:1024
  v_bitop3_b32 v81, v81, v121, v122 bitop3:0x80
  ds_read_b64_tr_b16 v[58:59], v8 offset:3072
  v_bitop3_b32 v81, v81, v123, v124 bitop3:0x80
  s_waitcnt lgkmcnt(6)
  v_mfma_f32_32x32x16_bf16 v[32:47], v[76:79], v[220:223], v[32:47]
  ds_read_b64_tr_b16 v[60:61], v8 offset:1280
  v_bitop3_b32 v81, v81, v125, v126 bitop3:0x80
  ds_read_b64_tr_b16 v[62:63], v8 offset:3328
  v_bitop3_b32 v81, v81, v127, 1 bitop3:0x80
  v_cmp_eq_u32 vcc, 0, v81
  s_nop 0
  s_cmp_lg_u64 vcc, 0
  s_cbranch_scc1 K3_retry4
K3_retry4_ret:
  buffer_load_dwordx4 v[216:219], v12, s[28:31], s48 offen offset:3072
  buffer_load_dwordx4 v[220:223], v12, s[28:31], s48 offen offset:3584
  s_add_u32 s48, s48, 4096
  s_waitcnt lgkmcnt(6)
  v_mfma_f32_32x32x16_bf16 v[16:31], v[48:51], v[96:99], v[16:31]
  ds_read_b64_tr_b16 v[64:65], v8 offset:4096
  ds_read_b64_tr_b16 v[66:67], v8 offset:6144
  s_waitcnt lgkmcnt(6)
  v_mfma_f32_32x32x16_bf16 v[32:47], v[52:55], v[96:99], v[32:47]
  ds_read_b64_tr_b16 v[68:69], v8 offset:4352
  ds_read_b64_tr_b16 v[70:71], v8 offset:6400
  s_waitcnt lgkmcnt(6)
  v_mfma_f32_32x32x16_bf16 v[16:31], v[56:59], v[100:103], v[16:31]
  ds_read_b64_tr_b16 v[72:73], v8 offset:5120
  ds_read_b64_tr_b16 v[74:75], v8 offset:7168
  s_waitcnt lgkmcnt(6)
  v_mfma_f32_32x32x16_bf16 v[32:47], v[60:63], v[100:103], v[32:47]
  ds_read_b64_tr_b16 v[76:77], v8 offset:5376
  ds_read_b64_tr_b16 v[78:79], v8 offset:7424
  s_waitcnt lgkmcnt(6)
  v_mfma_f32_32x32x16_bf16 v[16:31], v[64:67], v[104:107], v[16:31]
  ds_read_b64_tr_b16 v[48:49], v8 offset:8192
  ds_read_b64_tr_b16 v[50:51], v8 offset:10240
  s_waitcnt lgkmcnt(6)
  v_mfma_f32_32x32x16_bf16 v[32:47], v[68:71], v[104:107], v[32:47]
  ds_read_b64_tr_b16 v[52:53], v8 offset:8448
  ds_read_b64_tr_b16 v[54:55], v8 offset:10496
  s_waitcnt lgkmcnt(6)
  v_mfma_f32_32x32x16_bf16 v[16:31], v[72:75], v[108:111], v[16:31]
  ds_read_b64_tr_b16 v[56:57], v8 offset:9216
  ds_read_b64_tr_b16 v[58:59], v8 offset:11264
  s_waitcnt lgkmcnt(6)
  v_mfma_f32_32x32x16_bf16 v[32:47], v[76:79], v[108:111], v[32:47]
  ds_read_b64_tr_b16 v[60:61], v8 offset:9472
  ds_read_b64_tr_b16 v[62:63], v8 offset:11520
  s_waitcnt vmcnt(16)
  s_waitcnt lgkmcnt(6)
  v_mfma_f32_32x32x16_bf16 v[16:31], v[48:51], v[112:115], v[16:31]
  ds_read_b64_tr_b16 v[64:65], v8 offset:12288
  v_bitop3_b32 v81, v128, v129, v130 bitop3:0x80
  ds_read_b64_tr_b16 v[66:67], v8 offset:14336
  v_bitop3_b32 v81, v81, v131, v132 bitop3:0x80
  s_waitcnt lgkmcnt(6)
  v_mfma_f32_32x32x16_bf16 v[32:47], v[52:55], v[112:115], v[32:47]
  ds_read_b64_tr_b16 v[68:69], v8 offset:12544
  v_bitop3_b32 v81, v81, v133, v134 bitop3:0x80
  ds_read_b64_tr_b16 v[70:71], v8 offset:14592
  v_bitop3_b32 v81, v81, v135, v136 bitop3:0x80
  s_waitcnt lgkmcnt(6)
  v_mfma_f32_32x32x16_bf16 v[16:31], v[56:59], v[116:119], v[16:31]
  ds_read_b64_tr_b16 v[72:73], v8 offset:13312
  v_bitop3_b32 v81, v81, v137, v138 bitop3:0x80
  ds_read_b64_tr_b16 v[74:75], v8 offset:15360
  v_bitop3_b32 v81, v81, v139, v140 bitop3:0x80
  s_waitcnt lgkmcnt(6)
  v_mfma_f32_32x32x16_bf16 v[32:47], v[60:63], v[116:119], v[32:47]
  ds_read_b64_tr_b16 v[76:77], v8 offset:13568
  v_bitop3_b32 v81, v81, v141, v142 bitop3:0x80
  ds_read_b64_tr_b16 v[78:79], v8 offset:15616
  v_bitop3_b32 v81, v81, v143, v144 bitop3:0x80
  s_waitcnt lgkmcnt(6)
  v_mfma_f32_32x32x16_bf16 v[16:31], v[64:67], v[120:123], v[16:31]
  ds_read_b64_tr_b16 v[48:49], v8 offset:16384
  v_bitop3_b32 v81, v81, v145, v146 bitop3:0x80
  ds_read_b64_tr_b16 v[50:51], v8 offset:18432
  v_bitop3_b32 v81, v81, v147, v148 bitop3:0x80
  s_waitcnt lgkmcnt(6)
  v_mfma_f32_32x32x16_bf16 v[32:47], v[68:71], v[120:123], v[32:47]
  ds_read_b64_tr_b16 v[52:53], v8 offset:16640
  v_bitop3_b32 v81, v81, v149, v150 bitop3:0x80
  ds_read_b64_tr_b16 v[54:55], v8 offset:18688
  v_bitop3_b32 v81, v81, v151, v152 bitop3:0x80
  s_waitcnt lgkmcnt(6)
  v_mfma_f32_32x32x16_bf16 v[16:31], v[72:75], v[124:127], v[16:31]
  ds_read_b64_tr_b16 v[56:57], v8 offset:17408
  v_bitop3_b32 v81, v81, v153, v154 bitop3:0x80
  ds_read_b64_tr_b16 v[58:59], v8 offset:19456
  v_bitop3_b32 v81, v81, v155, v156 bitop3:0x80
  s_waitcnt lgkmcnt(6)
  v_mfma_f32_32x32x16_bf16 v[32:47], v[76:79], v[124:127], v[32:47]
  ds_read_b64_tr_b16 v[60:61], v8 offset:17664
  v_bitop3_b32 v81, v81, v157, v158 bitop3:0x80
  ds_read_b64_tr_b16 v[62:63], v8 offset:19712
  v_bitop3_b32 v81, v81, v159, 1 bitop3:0x80
  v_cmp_eq_u32 vcc, 0, v81
  s_nop 0
  s_cmp_lg_u64 vcc, 0
  s_cbranch_scc1 K3_retry5
K3_retry5_ret:
  s_waitcnt lgkmcnt(6)
  v_mfma_f32_32x32x16_bf16 v[16:31], v[48:51], v[128:131], v[16:31]
  ds_read_b64_tr_b16 v[64:65], v8 offset:20480
  ds_read_b64_tr_b16 v[66:67], v8 offset:22528
  s_waitcnt lgkmcnt(6)
  v_mfma_f32_32x32x16_bf16 v[32:47], v[52:55], v[128:131], v[32:47]
  ds_read_b64_tr_b16 v[68:69], v8 offset:20736
  ds_read_b64_tr_b16 v[70:71], v8 offset:22784
  s_waitcnt lgkmcnt(6)
  v_mfma_f32_32x32x16_bf16 v[16:31], v[56:59], v[132:135], v[16:31]
  ds_read_b64_tr_b16 v[72:73], v8 offset:21504
  ds_read_b64_tr_b16 v[74:75], v8 offset:23552
  s_waitcnt lgkmcnt(6)
  v_mfma_f32_32x32x16_bf16 v[32:47], v[60:63], v[132:135], v[32:47]
  ds_read_b64_tr_b16 v[76:77], v8 offset:21760
  ds_read_b64_tr_b16 v[78:79], v8 offset:23808
  s_waitcnt lgkmcnt(6)
  v_mfma_f32_32x32x16_bf16 v[16:31], v[64:67], v[136:139], v[16:31]
  ds_read_b64_tr_b16 v[48:49], v8 offset:24576
  ds_read_b64_tr_b16 v[50:51], v8 offset:26624
  s_waitcnt lgkmcnt(6)
  v_mfma_f32_32x32x16_bf16 v[32:47], v[68:71], v[136:139], v[32:47]
  ds_read_b64_tr_b16 v[52:53], v8 offset:24832
  ds_read_b64_tr_b16 v[54:55], v8 offset:26880
  s_waitcnt lgkmcnt(6)
  v_mfma_f32_32x32x16_bf16 v[16:31], v[72:75], v[140:143], v[16:31]
  ds_read_b64_tr_b16 v[56:57], v8 offset:25600
  ds_read_b64_tr_b16 v[58:59], v8 offset:27648
  s_waitcnt lgkmcnt(6)
  v_mfma_f32_32x32x16_bf16 v[32:47], v[76:79], v[140:143], v[32:47]
  ds_read_b64_tr_b16 v[60:61], v8 offset:25856
  ds_read_b64_tr_b16 v[62:63], v8 offset:27904
  s_waitcnt vmcnt(8)
  s_waitcnt lgkmcnt(6)
  v_mfma_f32_32x32x16_bf16 v[16:31], v[48:51], v[144:147], v[16:31]
  ds_read_b64_tr_b16 v[64:65], v8 offset:28672
  v_bitop3_b32 v81, v160, v161, v162 bitop3:0x80
  ds_read_b64_tr_b16 v[66:67], v8 offset:30720
  v_bitop3_b32 v81, v81, v163, v164 bitop3:0x80
  s_waitcnt lgkmcnt(6)
  v_mfma_f32_32x32x16_bf16 v[32:47], v[52:55], v[144:147], v[32:47]
  ds_read_b64_tr_b16 v[68:69], v8 offset:28928
  v_bitop3_b32 v81, v81, v165, v166 bitop3:0x80
  ds_read_b64_tr_b16 v[70:71], v8 offset:30976
  v_bitop3_b32 v81, v81, v167, v168 bitop3:0x80
  s_waitcnt lgkmcnt(6)
  v_mfma_f32_32x32x16_bf16 v[16:31], v[56:59], v[148:151], v[16:31]
  ds_read_b64_tr_b16 v[72:73], v8 offset:29696
  v_bitop3_b32 v81, v81, v169, v170 bitop3:0x80
  ds_read_b64_tr_b16 v[74:75], v8 offset:31744
  v_bitop3_b32 v81, v81, v171, v172 bitop3:0x80
  s_waitcnt lgkmcnt(6)
  v_mfma_f32_32x32x16_bf16 v[32:47], v[60:63], v[148:151], v[32:47]
  ds_read_b64_tr_b16 v[76:77], v8 offset:29952
  v_bitop3_b32 v81, v81, v173, v174 bitop3:0x80
  ds_read_b64_tr_b16 v[78:79], v8 offset:32000
  v_bitop3_b32 v81, v81, v175, v176 bitop3:0x80
  s_waitcnt lgkmcnt(6)
  v_mfma_f32_32x32x16_bf16 v[16:31], v[64:67], v[152:155], v[16:31]
  ds_read_b64_tr_b16 v[48:49], v8 offset:32768
  v_bitop3_b32 v81, v81, v177, v178 bitop3:0x80
  ds_read_b64_tr_b16 v[50:51], v8 offset:34816
  v_bitop3_b32 v81, v81, v179, v180 bitop3:0x80
  s_waitcnt lgkmcnt(6)
  v_mfma_f32_32x32x16_bf16 v[32:47], v[68:71], v[152:155], v[32:47]
  ds_read_b64_tr_b16 v[52:53], v8 offset:33024
  v_bitop3_b32 v81, v81, v181, v182 bitop3:0x80
  ds_read_b64_tr_b16 v[54:55], v8 offset:35072
  v_bitop3_b32 v81, v81, v183, v184 bitop3:0x80
  s_waitcnt lgkmcnt(6)
  v_mfma_f32_32x32x16_bf16 v[16:31], v[72:75], v[156:159], v[16:31]
  ds_read_b64_tr_b16 v[56:57], v8 offset:33792
  v_bitop3_b32 v81, v81, v185, v186 bitop3:0x80
  ds_read_b64_tr_b16 v[58:59], v8 offset:35840
  v_bitop3_b32 v81, v81, v187, v188 bitop3:0x80
  s_waitcnt lgkmcnt(6)
  v_mfma_f32_32x32x16_bf16 v[32:47], v[76:79], v[156:159], v[32:47]
  ds_read_b64_tr_b16 v[60:61], v8 offset:34048
  v_bitop3_b32 v81, v81, v189, v190 bitop3:0x80
  ds_read_b64_tr_b16 v[62:63], v8 offset:36096
  v_bitop3_b32 v81, v81, v191, 1 bitop3:0x80
  v_cmp_eq_u32 vcc, 0, v81
  s_nop 0
  s_cmp_lg_u64 vcc, 0
  s_cbranch_scc1 K3_retry6
K3_retry6_ret:
  s_waitcnt lgkmcnt(6)
  v_mfma_f32_32x32x16_bf16 v[16:31], v[48:51], v[160:163], v[16:31]
  ds_read_b64_tr_b16 v[64:65], v8 offset:36864
  ds_read_b64_tr_b16 v[66:67], v8 offset:38912
  s_waitcnt lgkmcnt(6)
  v_mfma_f32_32x32x16_bf16 v[32:47], v[52:55], v[160:163], v[32:47]
  ds_read_b64_tr_b16 v[68:69], v8 offset:37120
  ds_read_b64_tr_b16 v[70:71], v8 offset:39168
  s_waitcnt lgkmcnt(6)
  v_mfma_f32_32x32x16_bf16 v[16:31], v[56:59], v[164:167], v[16:31]
  ds_read_b64_tr_b16 v[72:73], v8 offset:37888
  ds_read_b64_tr_b16 v[74:75], v8 offset:39936
  s_waitcnt lgkmcnt(6)
  v_mfma_f32_32x32x16_bf16 v[32:47], v[60:63], v[164:167], v[32:47]
  ds_read_b64_tr_b16 v[76:77], v8 offset:38144
  ds_read_b64_tr_b16 v[78:79], v8 offset:40192
  s_waitcnt lgkmcnt(6)
  v_mfma_f32_32x32x16_bf16 v[16:31], v[64:67], v[168:171], v[16:31]
  ds_read_b64_tr_b16 v[48:49], v8 offset:40960
  ds_read_b64_tr_b16 v[50:51], v8 offset:43008
  s_waitcnt lgkmcnt(6)
  v_mfma_f32_32x32x16_bf16 v[32:47], v[68:71], v[168:171], v[32:47]
  ds_read_b64_tr_b16 v[52:53], v8 offset:41216
  ds_read_b64_tr_b16 v[54:55], v8 offset:43264
  s_waitcnt lgkmcnt(6)
  v_mfma_f32_32x32x16_bf16 v[16:31], v[72:75], v[172:175], v[16:31]
  ds_read_b64_tr_b16 v[56:57], v8 offset:41984
  ds_read_b64_tr_b16 v[58:59], v8 offset:44032
  s_waitcnt lgkmcnt(6)
  v_mfma_f32_32x32x16_bf16 v[32:47], v[76:79], v[172:175], v[32:47]
  ds_read_b64_tr_b16 v[60:61], v8 offset:42240
  ds_read_b64_tr_b16 v[62:63], v8 offset:44288
  s_waitcnt vmcnt(0)
  s_waitcnt lgkmcnt(6)
  v_mfma_f32_32x32x16_bf16 v[16:31], v[48:51], v[176:179], v[16:31]
  ds_read_b64_tr_b16 v[64:65], v8 offset:45056
  v_bitop3_b32 v81, v192, v193, v194 bitop3:0x80
  ds_read_b64_tr_b16 v[66:67], v8 offset:47104
  v_bitop3_b32 v81, v81, v195, v196 bitop3:0x80
  s_waitcnt lgkmcnt(6)
  v_mfma_f32_32x32x16_bf16 v[32:47], v[52:55], v[176:179], v[32:47]
  ds_read_b64_tr_b16 v[68:69], v8 offset:45312
  v_bitop3_b32 v81, v81, v197, v198 bitop3:0x80
  ds_read_b64_tr_b16 v[70:71], v8 offset:47360
  v_bitop3_b32 v81, v81, v199, v200 bitop3:0x80
  s_waitcnt lgkmcnt(6)
  v_mfma_f32_32x32x16_bf16 v[16:31], v[56:59], v[180:183], v[16:31]
  ds_read_b64_tr_b16 v[72:73], v8 offset:46080
  v_bitop3_b32 v81, v81, v201, v202 bitop3:0x80
  ds_read_b64_tr_b16 v[74:75], v8 offset:48128
  v_bitop3_b32 v81, v81, v203, v204 bitop3:0x80
  s_waitcnt lgkmcnt(6)
  v_mfma_f32_32x32x16_bf16 v[32:47], v[60:63], v[180:183], v[32:47]
  ds_read_b64_tr_b16 v[76:77], v8 offset:46336
  v_bitop3_b32 v81, v81, v205, v206 bitop3:0x80
  ds_read_b64_tr_b16 v[78:79], v8 offset:48384
  v_bitop3_b32 v81, v81, v207, v208 bitop3:0x80
  s_waitcnt lgkmcnt(6)
  v_mfma_f32_32x32x16_bf16 v[16:31], v[64:67], v[184:187], v[16:31]
  ds_read_b64_tr_b16 v[48:49], v13 offset:0
  v_bitop3_b32 v81, v81, v209, v210 bitop3:0x80
  ds_read_b64_tr_b16 v[50:51], v13 offset:2048
  v_bitop3_b32 v81, v81, v211, v212 bitop3:0x80
  s_waitcnt lgkmcnt(6)
  v_mfma_f32_32x32x16_bf16 v[32:47], v[68:71], v[184:187], v[32:47]
  ds_read_b64_tr_b16 v[52:53], v13 offset:256
  v_bitop3_b32 v81, v81, v213, v214 bitop3:0x80
  ds_read_b64_tr_b16 v[54:55], v13 offset:2304
  v_bitop3_b32 v81, v81, v215, v216 bitop3:0x80
  s_waitcnt lgkmcnt(6)
  v_mfma_f32_32x32x16_bf16 v[16:31], v[72:75], v[188:191], v[16:31]
  ds_read_b64_tr_b16 v[56:57], v13 offset:1024
  v_bitop3_b32 v81, v81, v217, v218 bitop3:0x80
  ds_read_b64_tr_b16 v[58:59], v13 offset:3072
  v_bitop3_b32 v81, v81, v219, v220 bitop3:0x80
  s_waitcnt lgkmcnt(6)
  v_mfma_f32_32x32x16_bf16 v[32:47], v[76:79], v[188:191], v[32:47]
  ds_read_b64_tr_b16 v[60:61], v13 offset:1280
  v_bitop3_b32 v81, v81, v221, v222 bitop3:0x80
  ds_read_b64_tr_b16 v[62:63], v13 offset:3328
  v_bitop3_b32 v81, v81, v223, 1 bitop3:0x80
  v_cmp_eq_u32 vcc, 0, v81
  s_nop 0
  s_cmp_lg_u64 vcc, 0
  s_cbranch_scc1 K3_retry7
K3_retry7_ret:
  s_waitcnt lgkmcnt(6)
  v_mfma_f32_32x32x16_bf16 v[16:31], v[48:51], v[192:195], v[16:31]
  ds_read_b64_tr_b16 v[64:65], v13 offset:8704
  ds_read_b64_tr_b16 v[66:67], v13 offset:10752
  s_waitcnt lgkmcnt(6)
  v_mfma_f32_32x32x16_bf16 v[32:47], v[52:55], v[192:195], v[32:47]
  ds_read_b64_tr_b16 v[68:69], v13 offset:8960
  ds_read_b64_tr_b16 v[70:71], v13 offset:11008
  s_waitcnt lgkmcnt(6)
  v_mfma_f32_32x32x16_bf16 v[16:31], v[56:59], v[196:199], v[16:31]
  ds_read_b64_tr_b16 v[72:73], v13 offset:9728
  ds_read_b64_tr_b16 v[74:75], v13 offset:11776
  s_waitcnt lgkmcnt(6)
  v_mfma_f32_32x32x16_bf16 v[32:47], v[60:63], v[196:199], v[32:47]
  ds_read_b64_tr_b16 v[76:77], v13 offset:9984
  ds_read_b64_tr_b16 v[78:79], v13 offset:12032
  s_waitcnt lgkmcnt(6)
  v_mfma_f32_32x32x16_bf16 v[16:31], v[64:67], v[200:203], v[16:31]
  ds_read_b64_tr_b16 v[48:49], v13 offset:17408
  ds_read_b64_tr_b16 v[50:51], v13 offset:19456
  s_waitcnt lgkmcnt(6)
  v_mfma_f32_32x32x16_bf16 v[32:47], v[68:71], v[200:203], v[32:47]
  ds_read_b64_tr_b16 v[52:53], v13 offset:17664
  ds_read_b64_tr_b16 v[54:55], v13 offset:19712
  s_waitcnt lgkmcnt(6)
  v_mfma_f32_32x32x16_bf16 v[16:31], v[72:75], v[204:207], v[16:31]
  ds_read_b64_tr_b16 v[56:57], v13 offset:18432
  ds_read_b64_tr_b16 v[58:59], v13 offset:20480
  s_waitcnt lgkmcnt(6)
  v_mfma_f32_32x32x16_bf16 v[32:47], v[76:79], v[204:207], v[32:47]
  ds_read_b64_tr_b16 v[60:61], v13 offset:18688
  ds_read_b64_tr_b16 v[62:63], v13 offset:20736
  s_waitcnt lgkmcnt(6)
  v_mfma_f32_32x32x16_bf16 v[16:31], v[48:51], v[208:211], v[16:31]
  ds_read_b64_tr_b16 v[64:65], v13 offset:26112
  ds_read_b64_tr_b16 v[66:67], v13 offset:28160
  s_waitcnt lgkmcnt(6)
  v_mfma_f32_32x32x16_bf16 v[32:47], v[52:55], v[208:211], v[32:47]
  ds_read_b64_tr_b16 v[68:69], v13 offset:26368
  ds_read_b64_tr_b16 v[70:71], v13 offset:28416
  s_waitcnt lgkmcnt(6)
  v_mfma_f32_32x32x16_bf16 v[16:31], v[56:59], v[212:215], v[16:31]
  ds_read_b64_tr_b16 v[72:73], v13 offset:27136
  ds_read_b64_tr_b16 v[74:75], v13 offset:29184
  s_waitcnt lgkmcnt(6)
  v_mfma_f32_32x32x16_bf16 v[32:47], v[60:63], v[212:215], v[32:47]
  ds_read_b64_tr_b16 v[76:77], v13 offset:27392
  ds_read_b64_tr_b16 v[78:79], v13 offset:29440
  s_waitcnt lgkmcnt(6)
  v_mfma_f32_32x32x16_bf16 v[16:31], v[64:67], v[216:219], v[16:31]
  s_waitcnt lgkmcnt(4)
  v_mfma_f32_32x32x16_bf16 v[32:47], v[68:71], v[216:219], v[32:47]
  s_waitcnt lgkmcnt(2)
  v_mfma_f32_32x32x16_bf16 v[16:31], v[72:75], v[220:223], v[16:31]
  s_waitcnt lgkmcnt(0)
  v_mfma_f32_32x32x16_bf16 v[32:47], v[76:79], v[220:223], v[32:47]
  v_and_b32 v4, 31, v2
  v_lshlrev_b32 v4, 12, v4
  v_lshl_add_u32 v4, v5, 4, v4
  s_lshr_b32 s36, s10, 2
  s_lshl_b32 s36, s36, 3
  s_lshr_b32 s37, s11, 2
  s_add_u32 s36, s36, s37
  s_lshl_b32 s38, s41, 16
  s_lshl_b32 s39, s36, 7
  s_add_u32 s38, s38, s39
  s_add_u32 s38, s38, 2048
  v_cvt_pk_bf16_f32 v80, v16, v17
  v_cvt_pk_bf16_f32 v81, v18, v19
  v_cvt_pk_bf16_f32 v82, v20, v21
  v_cvt_pk_bf16_f32 v83, v22, v23
  s_nop 0
  v_permlane32_swap_b32 v80, v82
  v_permlane32_swap_b32 v81, v83
  buffer_store_dwordx4 v[80:83], v4, s[32:35], s38 offen offset:0 nt
  v_cvt_pk_bf16_f32 v84, v24, v25
  v_cvt_pk_bf16_f32 v85, v26, v27
  v_cvt_pk_bf16_f32 v86, v28, v29
  v_cvt_pk_bf16_f32 v87, v30, v31
  s_nop 0
  v_permlane32_swap_b32 v84, v86
  v_permlane32_swap_b32 v85, v87
  buffer_store_dwordx4 v[84:87], v4, s[32:35], s38 offen offset:32 nt
  v_cvt_pk_bf16_f32 v88, v32, v33
  v_cvt_pk_bf16_f32 v89, v34, v35
  v_cvt_pk_bf16_f32 v90, v36, v37
  v_cvt_pk_bf16_f32 v91, v38, v39
  s_nop 0
  v_permlane32_swap_b32 v88, v90
  v_permlane32_swap_b32 v89, v91
  buffer_store_dwordx4 v[88:91], v4, s[32:35], s38 offen offset:64 nt
  v_cvt_pk_bf16_f32 v92, v40, v41
  v_cvt_pk_bf16_f32 v93, v42, v43
  v_cvt_pk_bf16_f32 v94, v44, v45
  v_cvt_pk_bf16_f32 v95, v46, v47
  s_nop 0
  v_permlane32_swap_b32 v92, v94
  v_permlane32_swap_b32 v93, v95
  buffer_store_dwordx4 v[92:95], v4, s[32:35], s38 offen offset:96 nt
  s_endpgm
K3_retry0:
  s_mov_b32 s46, 4000
  s_add_u32 s44, s47, 0
K3_retry0_l:
  s_add_u32 s75, s75, 1
  s_sleep 4
  buffer_load_dwordx4 v[96:99], v12, s[28:31], s44 offen offset:0 sc1
  buffer_load_dwordx4 v[100:103], v12, s[28:31], s44 offen offset:512 sc1
  buffer_load_dwordx4 v[104:107], v12, s[28:31], s44 offen offset:1024 sc1
  buffer_load_dwordx4 v[108:111], v12, s[28:31], s44 offen offset:1536 sc1
  buffer_load_dwordx4 v[112:115], v12, s[28:31], s44 offen offset:2048 sc1
  buffer_load_dwordx4 v[116:119], v12, s[28:31], s44 offen offset:2560 sc1
  buffer_load_dwordx4 v[120:123], v12, s[28:31], s44 offen offset:3072 sc1
  buffer_load_dwordx4 v[124:127], v12, s[28:31], s44 offen offset:3584 sc1
  s_waitcnt vmcnt(0)
  v_bitop3_b32 v81, v96, v97, v98 bitop3:0x80
  v_bitop3_b32 v81, v81, v99, v100 bitop3:0x80
  v_bitop3_b32 v81, v81, v101, v102 bitop3:0x80
  v_bitop3_b32 v81, v81, v103, v104 bitop3:0x80
  v_bitop3_b32 v81, v81, v105, v106 bitop3:0x80
  v_bitop3_b32 v81, v81, v107, v108 bitop3:0x80
  v_bitop3_b32 v81, v81, v109, v110 bitop3:0x80
  v_bitop3_b32 v81, v81, v111, v112 bitop3:0x80
  v_bitop3_b32 v81, v81, v113, v114 bitop3:0x80
  v_bitop3_b32 v81, v81, v115, v116 bitop3:0x80
  v_bitop3_b32 v81, v81, v117, v118 bitop3:0x80
  v_bitop3_b32 v81, v81, v119, v120 bitop3:0x80
  v_bitop3_b32 v81, v81, v121, v122 bitop3:0x80
  v_bitop3_b32 v81, v81, v123, v124 bitop3:0x80
  v_bitop3_b32 v81, v81, v125, v126 bitop3:0x80
  v_bitop3_b32 v81, v81, v127, 1 bitop3:0x80
  v_cmp_eq_u32 vcc, 0, v81
  s_sub_u32 s46, s46, 1
  s_cbranch_scc1 K3_retry0_ret
  s_cmp_lg_u64 vcc, 0
  s_cbranch_scc1 K3_retry0_l
  s_branch K3_retry0_ret
K3_retry1:
  s_mov_b32 s46, 4000
  s_add_u32 s44, s47, 4096
K3_retry1_l:
  s_add_u32 s75, s75, 1
  s_sleep 4
  buffer_load_dwordx4 v[128:131], v12, s[28:31], s44 offen offset:0 sc1
  buffer_load_dwordx4 v[132:135], v12, s[28:31], s44 offen offset:512 sc1
  buffer_load_dwordx4 v[136:139], v12, s[28:31], s44 offen offset:1024 sc1
  buffer_load_dwordx4 v[140:143], v12, s[28:31], s44 offen offset:1536 sc1
  buffer_load_dwordx4 v[144:147], v12, s[28:31], s44 offen offset:2048 sc1
  buffer_load_dwordx4 v[148:151], v12, s[28:31], s44 offen offset:2560 sc1
  buffer_load_dwordx4 v[152:155], v12, s[28:31], s44 offen offset:3072 sc1
  buffer_load_dwordx4 v[156:159], v12, s[28:31], s44 offen offset:3584 sc1
  s_waitcnt vmcnt(0)
  v_bitop3_b32 v81, v128, v129, v130 bitop3:0x80
  v_bitop3_b32 v81, v81, v131, v132 bitop3:0x80
  v_bitop3_b32 v81, v81, v133, v134 bitop3:0x80
  v_bitop3_b32 v81, v81, v135, v136 bitop3:0x80
  v_bitop3_b32 v81, v81, v137, v138 bitop3:0x80
  v_bitop3_b32 v81, v81, v139, v140 bitop3:0x80
  v_bitop3_b32 v81, v81, v141, v142 bitop3:0x80
  v_bitop3_b32 v81, v81, v143, v144 bitop3:0x80
  v_bitop3_b32 v81, v81, v145, v146 bitop3:0x80
  v_bitop3_b32 v81, v81, v147, v148 bitop3:0x80
  v_bitop3_b32 v81, v81, v149, v150 bitop3:0x80
  v_bitop3_b32 v81, v81, v151, v152 bitop3:0x80
  v_bitop3_b32 v81, v81, v153, v154 bitop3:0x80
  v_bitop3_b32 v81, v81, v155, v156 bitop3:0x80
  v_bitop3_b32 v81, v81, v157, v158 bitop3:0x80
  v_bitop3_b32 v81, v81, v159, 1 bitop3:0x80
  v_cmp_eq_u32 vcc, 0, v81
  s_sub_u32 s46, s46, 1
  s_cbranch_scc1 K3_retry1_ret
  s_cmp_lg_u64 vcc, 0
  s_cbranch_scc1 K3_retry1_l
  s_branch K3_retry1_ret
K3_retry2:
  s_mov_b32 s46, 4000
  s_add_u32 s44, s47, 8192
K3_retry2_l:
  s_add_u32 s75, s75, 1
  s_sleep 4
  buffer_load_dwordx4 v[160:163], v12, s[28:31], s44 offen offset:0 sc1
  buffer_load_dwordx4 v[164:167], v12, s[28:31], s44 offen offset:512 sc1
  buffer_load_dwordx4 v[168:171], v12, s[28:31], s44 offen offset:1024 sc1
  buffer_load_dwordx4 v[172:175], v12, s[28:31], s44 offen offset:1536 sc1
  buffer_load_dwordx4 v[176:179], v12, s[28:31], s44 offen offset:2048 sc1
  buffer_load_dwordx4 v[180:183], v12, s[28:31], s44 offen offset:2560 sc1
  buffer_load_dwordx4 v[184:187], v12, s[28:31], s44 offen offset:3072 sc1
  buffer_load_dwordx4 v[188:191], v12, s[28:31], s44 offen offset:3584 sc1
  s_waitcnt vmcnt(0)
  v_bitop3_b32 v81, v160, v161, v162 bitop3:0x80
  v_bitop3_b32 v81, v81, v163, v164 bitop3:0x80
  v_bitop3_b32 v81, v81, v165, v166 bitop3:0x80
  v_bitop3_b32 v81, v81, v167, v168 bitop3:0x80
  v_bitop3_b32 v81, v81, v169, v170 bitop3:0x80
  v_bitop3_b32 v81, v81, v171, v172 bitop3:0x80
  v_bitop3_b32 v81, v81, v173, v174 bitop3:0x80
  v_bitop3_b32 v81, v81, v175, v176 bitop3:0x80
  v_bitop3_b32 v81, v81, v177, v178 bitop3:0x80
  v_bitop3_b32 v81, v81, v179, v180 bitop3:0x80
  v_bitop3_b32 v81, v81, v181, v182 bitop3:0x80
  v_bitop3_b32 v81, v81, v183, v184 bitop3:0x80
  v_bitop3_b32 v81, v81, v185, v186 bitop3:0x80
  v_bitop3_b32 v81, v81, v187, v188 bitop3:0x80
  v_bitop3_b32 v81, v81, v189, v190 bitop3:0x80
  v_bitop3_b32 v81, v81, v191, 1 bitop3:0x80
  v_cmp_eq_u32 vcc, 0, v81
  s_sub_u32 s46, s46, 1
  s_cbranch_scc1 K3_retry2_ret
  s_cmp_lg_u64 vcc, 0
  s_cbranch_scc1 K3_retry2_l
  s_branch K3_retry2_ret
K3_retry3:
  s_mov_b32 s46, 4000
  s_add_u32 s44, s47, 12288
K3_retry3_l:
  s_add_u32 s75, s75, 1
  s_sleep 4
  buffer_load_dwordx4 v[192:195], v12, s[28:31], s44 offen offset:0 sc1
  buffer_load_dwordx4 v[196:199], v12, s[28:31], s44 offen offset:512 sc1
  buffer_load_dwordx4 v[200:203], v12, s[28:31], s44 offen offset:1024 sc1
  buffer_load_dwordx4 v[204:207], v12, s[28:31], s44 offen offset:1536 sc1
  buffer_load_dwordx4 v[208:211], v12, s[28:31], s44 offen offset:2048 sc1
  buffer_load_dwordx4 v[212:215], v12, s[28:31], s44 offen offset:2560 sc1
  buffer_load_dwordx4 v[216:219], v12, s[28:31], s44 offen offset:3072 sc1
  buffer_load_dwordx4 v[220:223], v12, s[28:31], s44 offen offset:3584 sc1
  s_waitcnt vmcnt(0)
  v_bitop3_b32 v81, v192, v193, v194 bitop3:0x80
  v_bitop3_b32 v81, v81, v195, v196 bitop3:0x80
  v_bitop3_b32 v81, v81, v197, v198 bitop3:0x80
  v_bitop3_b32 v81, v81, v199, v200 bitop3:0x80
  v_bitop3_b32 v81, v81, v201, v202 bitop3:0x80
  v_bitop3_b32 v81, v81, v203, v204 bitop3:0x80
  v_bitop3_b32 v81, v81, v205, v206 bitop3:0x80
  v_bitop3_b32 v81, v81, v207, v208 bitop3:0x80
  v_bitop3_b32 v81, v81, v209, v210 bitop3:0x80
  v_bitop3_b32 v81, v81, v211, v212 bitop3:0x80
  v_bitop3_b32 v81, v81, v213, v214 bitop3:0x80
  v_bitop3_b32 v81, v81, v215, v216 bitop3:0x80
  v_bitop3_b32 v81, v81, v217, v218 bitop3:0x80
  v_bitop3_b32 v81, v81, v219, v220 bitop3:0x80
  v_bitop3_b32 v81, v81, v221, v222 bitop3:0x80
  v_bitop3_b32 v81, v81, v223, 1 bitop3:0x80
  v_cmp_eq_u32 vcc, 0, v81
  s_sub_u32 s46, s46, 1
  s_cbranch_scc1 K3_retry3_ret
  s_cmp_lg_u64 vcc, 0
  s_cbranch_scc1 K3_retry3_l
  s_branch K3_retry3_ret
K3_retry4:
  s_mov_b32 s46, 4000
  s_add_u32 s44, s47, 16384
K3_retry4_l:
  s_add_u32 s75, s75, 1
  s_sleep 4
  buffer_load_dwordx4 v[96:99], v12, s[28:31], s44 offen offset:0 sc1
  buffer_load_dwordx4 v[100:103], v12, s[28:31], s44 offen offset:512 sc1
  buffer_load_dwordx4 v[104:107], v12, s[28:31], s44 offen offset:1024 sc1
  buffer_load_dwordx4 v[108:111], v12, s[28:31], s44 offen offset:1536 sc1
  buffer_load_dwordx4 v[112:115], v12, s[28:31], s44 offen offset:2048 sc1
  buffer_load_dwordx4 v[116:119], v12, s[28:31], s44 offen offset:2560 sc1
  buffer_load_dwordx4 v[120:123], v12, s[28:31], s44 offen offset:3072 sc1
  buffer_load_dwordx4 v[124:127], v12, s[28:31], s44 offen offset:3584 sc1
  s_waitcnt vmcnt(0)
  v_bitop3_b32 v81, v96, v97, v98 bitop3:0x80
  v_bitop3_b32 v81, v81, v99, v100 bitop3:0x80
  v_bitop3_b32 v81, v81, v101, v102 bitop3:0x80
  v_bitop3_b32 v81, v81, v103, v104 bitop3:0x80
  v_bitop3_b32 v81, v81, v105, v106 bitop3:0x80
  v_bitop3_b32 v81, v81, v107, v108 bitop3:0x80
  v_bitop3_b32 v81, v81, v109, v110 bitop3:0x80
  v_bitop3_b32 v81, v81, v111, v112 bitop3:0x80
  v_bitop3_b32 v81, v81, v113, v114 bitop3:0x80
  v_bitop3_b32 v81, v81, v115, v116 bitop3:0x80
  v_bitop3_b32 v81, v81, v117, v118 bitop3:0x80
  v_bitop3_b32 v81, v81, v119, v120 bitop3:0x80
  v_bitop3_b32 v81, v81, v121, v122 bitop3:0x80
  v_bitop3_b32 v81, v81, v123, v124 bitop3:0x80
  v_bitop3_b32 v81, v81, v125, v126 bitop3:0x80
  v_bitop3_b32 v81, v81, v127, 1 bitop3:0x80
  v_cmp_eq_u32 vcc, 0, v81
  s_sub_u32 s46, s46, 1
  s_cbranch_scc1 K3_retry4_ret
  s_cmp_lg_u64 vcc, 0
  s_cbranch_scc1 K3_retry4_l
  s_branch K3_retry4_ret
K3_retry5:
  s_mov_b32 s46, 4000
  s_add_u32 s44, s47, 20480
K3_retry5_l:
  s_add_u32 s75, s75, 1
  s_sleep 4
  buffer_load_dwordx4 v[128:131], v12, s[28:31], s44 offen offset:0 sc1
  buffer_load_dwordx4 v[132:135], v12, s[28:31], s44 offen offset:512 sc1
  buffer_load_dwordx4 v[136:139], v12, s[28:31], s44 offen offset:1024 sc1
  buffer_load_dwordx4 v[140:143], v12, s[28:31], s44 offen offset:1536 sc1
  buffer_load_dwordx4 v[144:147], v12, s[28:31], s44 offen offset:2048 sc1
  buffer_load_dwordx4 v[148:151], v12, s[28:31], s44 offen offset:2560 sc1
  buffer_load_dwordx4 v[152:155], v12, s[28:31], s44 offen offset:3072 sc1
  buffer_load_dwordx4 v[156:159], v12, s[28:31], s44 offen offset:3584 sc1
  s_waitcnt vmcnt(0)
  v_bitop3_b32 v81, v128, v129, v130 bitop3:0x80
  v_bitop3_b32 v81, v81, v131, v132 bitop3:0x80
  v_bitop3_b32 v81, v81, v133, v134 bitop3:0x80
  v_bitop3_b32 v81, v81, v135, v136 bitop3:0x80
  v_bitop3_b32 v81, v81, v137, v138 bitop3:0x80
  v_bitop3_b32 v81, v81, v139, v140 bitop3:0x80
  v_bitop3_b32 v81, v81, v141, v142 bitop3:0x80
  v_bitop3_b32 v81, v81, v143, v144 bitop3:0x80
  v_bitop3_b32 v81, v81, v145, v146 bitop3:0x80
  v_bitop3_b32 v81, v81, v147, v148 bitop3:0x80
  v_bitop3_b32 v81, v81, v149, v150 bitop3:0x80
  v_bitop3_b32 v81, v81, v151, v152 bitop3:0x80
  v_bitop3_b32 v81, v81, v153, v154 bitop3:0x80
  v_bitop3_b32 v81, v81, v155, v156 bitop3:0x80
  v_bitop3_b32 v81, v81, v157, v158 bitop3:0x80
  v_bitop3_b32 v81, v81, v159, 1 bitop3:0x80
  v_cmp_eq_u32 vcc, 0, v81
  s_sub_u32 s46, s46, 1
  s_cbranch_scc1 K3_retry5_ret
  s_cmp_lg_u64 vcc, 0
  s_cbranch_scc1 K3_retry5_l
  s_branch K3_retry5_ret
K3_retry6:
  s_mov_b32 s46, 4000
  s_add_u32 s44, s47, 24576
K3_retry6_l:
  s_add_u32 s75, s75, 1
  s_sleep 4
  buffer_load_dwordx4 v[160:163], v12, s[28:31], s44 offen offset:0 sc1
  buffer_load_dwordx4 v[164:167], v12, s[28:31], s44 offen offset:512 sc1
  buffer_load_dwordx4 v[168:171], v12, s[28:31], s44 offen offset:1024 sc1
  buffer_load_dwordx4 v[172:175], v12, s[28:31], s44 offen offset:1536 sc1
  buffer_load_dwordx4 v[176:179], v12, s[28:31], s44 offen offset:2048 sc1
  buffer_load_dwordx4 v[180:183], v12, s[28:31], s44 offen offset:2560 sc1
  buffer_load_dwordx4 v[184:187], v12, s[28:31], s44 offen offset:3072 sc1
  buffer_load_dwordx4 v[188:191], v12, s[28:31], s44 offen offset:3584 sc1
  s_waitcnt vmcnt(0)
  v_bitop3_b32 v81, v160, v161, v162 bitop3:0x80
  v_bitop3_b32 v81, v81, v163, v164 bitop3:0x80
  v_bitop3_b32 v81, v81, v165, v166 bitop3:0x80
  v_bitop3_b32 v81, v81, v167, v168 bitop3:0x80
  v_bitop3_b32 v81, v81, v169, v170 bitop3:0x80
  v_bitop3_b32 v81, v81, v171, v172 bitop3:0x80
  v_bitop3_b32 v81, v81, v173, v174 bitop3:0x80
  v_bitop3_b32 v81, v81, v175, v176 bitop3:0x80
  v_bitop3_b32 v81, v81, v177, v178 bitop3:0x80
  v_bitop3_b32 v81, v81, v179, v180 bitop3:0x80
  v_bitop3_b32 v81, v81, v181, v182 bitop3:0x80
  v_bitop3_b32 v81, v81, v183, v184 bitop3:0x80
  v_bitop3_b32 v81, v81, v185, v186 bitop3:0x80
  v_bitop3_b32 v81, v81, v187, v188 bitop3:0x80
  v_bitop3_b32 v81, v81, v189, v190 bitop3:0x80
  v_bitop3_b32 v81, v81, v191, 1 bitop3:0x80
  v_cmp_eq_u32 vcc, 0, v81
  s_sub_u32 s46, s46, 1
  s_cbranch_scc1 K3_retry6_ret
  s_cmp_lg_u64 vcc, 0
  s_cbranch_scc1 K3_retry6_l
  s_branch K3_retry6_ret
K3_retry7:
  s_mov_b32 s46, 4000
  s_add_u32 s44, s47, 28672
K3_retry7_l:
  s_add_u32 s75, s75, 1
  s_sleep 4
  buffer_load_dwordx4 v[192:195], v12, s[28:31], s44 offen offset:0 sc1
  buffer_load_dwordx4 v[196:199], v12, s[28:31], s44 offen offset:512 sc1
  buffer_load_dwordx4 v[200:203], v12, s[28:31], s44 offen offset:1024 sc1
  buffer_load_dwordx4 v[204:207], v12, s[28:31], s44 offen offset:1536 sc1
  buffer_load_dwordx4 v[208:211], v12, s[28:31], s44 offen offset:2048 sc1
  buffer_load_dwordx4 v[212:215], v12, s[28:31], s44 offen offset:2560 sc1
  buffer_load_dwordx4 v[216:219], v12, s[28:31], s44 offen offset:3072 sc1
  buffer_load_dwordx4 v[220:223], v12, s[28:31], s44 offen offset:3584 sc1
  s_waitcnt vmcnt(0)
  v_bitop3_b32 v81, v192, v193, v194 bitop3:0x80
  v_bitop3_b32 v81, v81, v195, v196 bitop3:0x80
  v_bitop3_b32 v81, v81, v197, v198 bitop3:0x80
  v_bitop3_b32 v81, v81, v199, v200 bitop3:0x80
  v_bitop3_b32 v81, v81, v201, v202 bitop3:0x80
  v_bitop3_b32 v81, v81, v203, v204 bitop3:0x80
  v_bitop3_b32 v81, v81, v205, v206 bitop3:0x80
  v_bitop3_b32 v81, v81, v207, v208 bitop3:0x80
  v_bitop3_b32 v81, v81, v209, v210 bitop3:0x80
  v_bitop3_b32 v81, v81, v211, v212 bitop3:0x80
  v_bitop3_b32 v81, v81, v213, v214 bitop3:0x80
  v_bitop3_b32 v81, v81, v215, v216 bitop3:0x80
  v_bitop3_b32 v81, v81, v217, v218 bitop3:0x80
  v_bitop3_b32 v81, v81, v219, v220 bitop3:0x80
  v_bitop3_b32 v81, v81, v221, v222 bitop3:0x80
  v_bitop3_b32 v81, v81, v223, 1 bitop3:0x80
  v_cmp_eq_u32 vcc, 0, v81
  s_sub_u32 s46, s46, 1
  s_cbranch_scc1 K3_retry7_ret
  s_cmp_lg_u64 vcc, 0
  s_cbranch_scc1 K3_retry7_l
  s_branch K3_retry7_ret
K3_event0:
  s_add_u32 s54, s54, 1
  s_cmp_lg_u32 s54, 1
  s_cbranch_scc1 K3_ev2_0
  buffer_load_dword v195, v192, s[40:43], s44 offen
  s_mov_b32 s55, s52
  s_branch K3_noev0
K3_ev2_0:
  buffer_load_dword v195, v193, s[48:51], s45 offen
  s_mov_b32 s55, 1000
  s_branch K3_noev0
K3_evB0:
  buffer_load_dword v195, v194, s[64:67], s68 offen
  buffer_load_dword v195, v194, s[64:67], s69 offen
  s_branch K3_noevB0
K3_evC0:
  s_add_u32 s53, s53, 1
  s_cmp_lg_u32 s53, 1
  s_cbranch_scc1 K3_ev4_0
  buffer_load_dword v196, v199, s[56:59], 0 offen sc1
  s_mov_b32 s71, 1
  s_branch K3_noevC0
K3_ev4_0:
  s_cmp_lg_u32 s53, 2
  s_cbranch_scc1 K3_ev6_0
  s_waitcnt vmcnt(0)
  v_readfirstlane_b32 s46, v196
  s_mov_b64 exec, 1
  s_cmp_lg_u32 s46, 0
  s_cbranch_scc1 K3_ev5_0
  v_mov_b32 v196, v198
  v_mov_b32 v197, 0
  buffer_atomic_cmpswap v[196:197], v199, s[56:59], 0 offen sc0 sc1
  s_waitcnt vmcnt(0)
  v_cmp_eq_u32 vcc, 0, v196
  s_nop 1
  v_cndmask_b32 v196, v196, v198, vcc
K3_ev5_0:
  buffer_store_dword v196, v199, s[60:63], s47 offen sc1
  s_mov_b64 exec, -1
  s_mov_b32 s71, 0
  s_branch K3_noevC0
K3_ev6_0:
  s_mov_b64 exec, 1
  buffer_store_dword v196, v199, s[60:63], s47 offen offset:32 sc1
  s_mov_b64 exec, -1
  s_mov_b32 s71, 1000
  s_branch K3_noevC0
K3_event1:
  s_add_u32 s54, s54, 1
  s_cmp_lg_u32 s54, 1
  s_cbranch_scc1 K3_ev2_1
  buffer_load_dword v195, v192, s[40:43], s44 offen
  s_mov_b32 s55, s52
  s_branch K3_noev1
K3_ev2_1:
  buffer_load_dword v195, v193, s[48:51], s45 offen
  s_mov_b32 s55, 1000
  s_branch K3_noev1
K3_evB1:
  buffer_load_dword v195, v194, s[64:67], s68 offen
  buffer_load_dword v195, v194, s[64:67], s69 offen
  s_branch K3_noevB1
K3_evC1:
  s_add_u32 s53, s53, 1
  s_cmp_lg_u32 s53, 1
  s_cbranch_scc1 K3_ev4_1
  buffer_load_dword v196, v199, s[56:59], 0 offen sc1
  s_mov_b32 s71, 1
  s_branch K3_noevC1
K3_ev4_1:
  s_cmp_lg_u32 s53, 2
  s_cbranch_scc1 K3_ev6_1
  s_waitcnt vmcnt(0)
  v_readfirstlane_b32 s46, v196
  s_mov_b64 exec, 1
  s_cmp_lg_u32 s46, 0
  s_cbranch_scc1 K3_ev5_1
  v_mov_b32 v196, v198
  v_mov_b32 v197, 0
  buffer_atomic_cmpswap v[196:197], v199, s[56:59], 0 offen sc0 sc1
  s_waitcnt vmcnt(0)
  v_cmp_eq_u32 vcc, 0, v196
  s_nop 1
  v_cndmask_b32 v196, v196, v198, vcc
K3_ev5_1:
  buffer_store_dword v196, v199, s[60:63], s47 offen sc1
  s_mov_b64 exec, -1
  s_mov_b32 s71, 0
  s_branch K3_noevC1
K3_ev6_1:
  s_mov_b64 exec, 1
  buffer_store_dword v196, v199, s[60:63], s47 offen offset:32 sc1
  s_mov_b64 exec, -1
  s_mov_b32 s71, 1000
  s_branch K3_noevC1
K3_event2:
  s_add_u32 s54, s54, 1
  s_cmp_lg_u32 s54, 1
  s_cbranch_scc1 K3_ev2_2
  buffer_load_dword v195, v192, s[40:43], s44 offen
  s_mov_b32 s55, s52
  s_branch K3_noev2
K3_ev2_2:
  buffer_load_dword v195, v193, s[48:51], s45 offen
  s_mov_b32 s55, 1000
  s_branch K3_noev2
K3_evB2:
  buffer_load_dword v195, v194, s[64:67], s68 offen
  buffer_load_dword v195, v194, s[64:67], s69 offen
  s_branch K3_noevB2
K3_evC2:
  s_add_u32 s53, s53, 1
  s_cmp_lg_u32 s53, 1
  s_cbranch_scc1 K3_ev4_2
  buffer_load_dword v196, v199, s[56:59], 0 offen sc1
  s_mov_b32 s71, 1
  s_branch K3_noevC2
K3_ev4_2:
  s_cmp_lg_u32 s53, 2
  s_cbranch_scc1 K3_ev6_2
  s_waitcnt vmcnt(0)
  v_readfirstlane_b32 s46, v196
  s_mov_b64 exec, 1
  s_cmp_lg_u32 s46, 0
  s_cbranch_scc1 K3_ev5_2
  v_mov_b32 v196, v198
  v_mov_b32 v197, 0
  buffer_atomic_cmpswap v[196:197], v199, s[56:59], 0 offen sc0 sc1
  s_waitcnt vmcnt(0)
  v_cmp_eq_u32 vcc, 0, v196
  s_nop 1
  v_cndmask_b32 v196, v196, v198, vcc
K3_ev5_2:
  buffer_store_dword v196, v199, s[60:63], s47 offen sc1
  s_mov_b64 exec, -1
  s_mov_b32 s71, 0
  s_branch K3_noevC2
K3_ev6_2:
  s_mov_b64 exec, 1
  buffer_store_dword v196, v199, s[60:63], s47 offen offset:32 sc1
  s_mov_b64 exec, -1
  s_mov_b32 s71, 1000
  s_branch K3_noevC2
K3_event3:
  s_add_u32 s54, s54, 1
  s_cmp_lg_u32 s54, 1
  s_cbranch_scc1 K3_ev2_3
  buffer_load_dword v195, v192, s[40:43], s44 offen
  s_mov_b32 s55, s52
  s_branch K3_noev3
K3_ev2_3:
  buffer_load_dword v195, v193, s[48:51], s45 offen
  s_mov_b32 s55, 1000
  s_branch K3_noev3
K3_evB3:
  buffer_load_dword v195, v194, s[64:67], s68 offen
  buffer_load_dword v195, v194, s[64:67], s69 offen
  s_branch K3_noevB3
K3_evC3:
  s_add_u32 s53, s53, 1
  s_cmp_lg_u32 s53, 1
  s_cbranch_scc1 K3_ev4_3
  buffer_load_dword v196, v199, s[56:59], 0 offen sc1
  s_mov_b32 s71, 1
  s_branch K3_noevC3
K3_ev4_3:
  s_cmp_lg_u32 s53, 2
  s_cbranch_scc1 K3_ev6_3
  s_waitcnt vmcnt(0)
  v_readfirstlane_b32 s46, v196
  s_mov_b64 exec, 1
  s_cmp_lg_u32 s46, 0
  s_cbranch_scc1 K3_ev5_3
  v_mov_b32 v196, v198
  v_mov_b32 v197, 0
  buffer_atomic_cmpswap v[196:197], v199, s[56:59], 0 offen sc0 sc1
  s_waitcnt vmcnt(0)
  v_cmp_eq_u32 vcc, 0, v196
  s_nop 1
  v_cndmask_b32 v196, v196, v198, vcc
K3_ev5_3:
  buffer_store_dword v196, v199, s[60:63], s47 offen sc1
  s_mov_b64 exec, -1
  s_mov_b32 s71, 0
  s_branch K3_noevC3
K3_ev6_3:
  s_mov_b64 exec, 1
  buffer_store_dword v196, v199, s[60:63], s47 offen offset:32 sc1
  s_mov_b64 exec, -1
  s_mov_b32 s71, 1000
  s_branch K3_noevC3
K3_L:
  v_lshrrev_b32 v4, 3, v2
  v_and_b32 v5, 7, v2
  v_add_u32 v6, 0, v14
  v_xor_b32 v6, v6, v5
  v_lshlrev_b32 v6, 4, v6
  v_lshl_add_u32 v6, v4, 11, v6
  v_add_u32 v240, 0, v6
  v_add_u32 v6, 4, v14
  v_xor_b32 v6, v6, v5
  v_lshlrev_b32 v6, 4, v6
  v_lshl_add_u32 v6, v4, 11, v6
  v_add_u32 v241, 15360, v6
  v_add_u32 v6, 0, v14
  v_xor_b32 v6, v6, v5
  v_lshlrev_b32 v6, 4, v6
  v_lshl_add_u32 v6, v4, 11, v6
  v_add_u32 v242, 30720, v6
  v_add_u32 v6, 4, v14
  v_xor_b32 v6, v6, v5
  v_lshlrev_b32 v6, 4, v6
  v_lshl_add_u32 v6, v4, 11, v6
  v_add_u32 v243, 46080, v6
  v_lshrrev_b32 v6, 5, v2
  v_bfe_u32 v7, v2, 2, 2
  v_lshl_add_u32 v6, v6, 2, v7
  v_mul_u32_u24 v6, 6144, v6
  v_bfe_u32 v7, v2, 4, 1
  v_lshl_add_u32 v6, v7, 6, v6
  v_and_b32 v7, 3, v2
  v_lshl_add_u32 v6, v7, 4, v6
  v_xor_b32 v7, 32, v6
  s_and_b32 s40, s13, 1
  s_lshl_b32 s40, s40, 7
  s_xor_b32 s41, s40, 128
  v_add_u32 v244, 0, v6
  v_add_u32 v244, s41, v244
  v_add_u32 v245, 48128, v7
  v_add_u32 v245, s41, v245
  v_add_u32 v246, 0, v6
  v_add_u32 v246, s40, v246
  v_add_u32 v247, 48128, v7
  v_add_u32 v247, s40, v247
  v_add_u32 v248, 4096, v6
  v_add_u32 v248, s40, v248
  v_add_u32 v249, 52224, v7
  v_add_u32 v249, s40, v249
  s_lshl_b32 s38, s12, 7
  s_lshl_b32 s40, s4, 5
  s_add_u32 s38, s38, s40
  s_lshl_b32 s38, s38, 11
  s_mul_i32 s39, s4, 98304
  s_lshr_b32 s40, s13, 1
  s_lshl_b32 s40, s40, 8
  s_add_u32 s39, s39, s40
  s_lshl_b32 s41, s4, 12
  s_mul_i32 s42, s4, 6144
  s_add_u32 s42, s42, 16384
  s_mov_b32 s16, s88
  s_mov_b32 s17, s89
  s_mov_b32 s18, 4194304
  s_mov_b32 s19, 0x20000
  s_mov_b32 s20, s90
  s_mov_b32 s21, s91
  s_mov_b32 s22, 6291456
  s_mov_b32 s23, 0x20000
  s_add_u32 m0, s41, 0
  s_nop 0
  buffer_load_dwordx4 v240, s[16:19], s38 offen offset:0 lds
  buffer_load_dwordx4 v241, s[16:19], s38 offen offset:1024 lds
  buffer_load_dwordx4 v242, s[16:19], s38 offen offset:2048 lds
  buffer_load_dwordx4 v243, s[16:19], s38 offen offset:3072 lds
  s_add_u32 m0, s42, 0
  s_nop 0
  buffer_load_dwordx4 v244, s[20:23], s39 offen offset:0 lds
  buffer_load_dwordx4 v245, s[20:23], s39 offen offset:1024 lds
  buffer_load_dwordx4 v246, s[20:23], s39 offen offset:2048 lds
  buffer_load_dwordx4 v247, s[20:23], s39 offen offset:3072 lds
  s_add_u32 m0, s42, 4096
  s_nop 0
  buffer_load_dwordx4 v248, s[20:23], s39 offen offset:0 lds
  buffer_load_dwordx4 v249, s[20:23], s39 offen offset:1024 lds
  s_add_u32 s38, s38, 128
  s_add_u32 s39, s39, 393216
  s_add_u32 m0, s41, 40960
  s_nop 0
  buffer_load_dwordx4 v240, s[16:19], s38 offen offset:0 lds
  buffer_load_dwordx4 v241, s[16:19], s38 offen offset:1024 lds
  buffer_load_dwordx4 v242, s[16:19], s38 offen offset:2048 lds
  buffer_load_dwordx4 v243, s[16:19], s38 offen offset:3072 lds
  s_add_u32 m0, s42, 40960
  s_nop 0
  buffer_load_dwordx4 v244, s[20:23], s39 offen offset:0 lds
  buffer_load_dwordx4 v245, s[20:23], s39 offen offset:1024 lds
  buffer_load_dwordx4 v246, s[20:23], s39 offen offset:2048 lds
  buffer_load_dwordx4 v247, s[20:23], s39 offen offset:3072 lds
  s_add_u32 m0, s42, 45056
  s_nop 0
  buffer_load_dwordx4 v248, s[20:23], s39 offen offset:0 lds
  buffer_load_dwordx4 v249, s[20:23], s39 offen offset:1024 lds
  s_add_u32 s38, s38, 128
  s_add_u32 s39, s39, 393216
  s_add_u32 m0, s41, 81920
  s_nop 0
  buffer_load_dwordx4 v240, s[16:19], s38 offen offset:0 lds
  buffer_load_dwordx4 v241, s[16:19], s38 offen offset:1024 lds
  buffer_load_dwordx4 v242, s[16:19], s38 offen offset:2048 lds
  buffer_load_dwordx4 v243, s[16:19], s38 offen offset:3072 lds
  s_add_u32 m0, s42, 81920
  s_nop 0
  buffer_load_dwordx4 v244, s[20:23], s39 offen offset:0 lds
  buffer_load_dwordx4 v245, s[20:23], s39 offen offset:1024 lds
  buffer_load_dwordx4 v246, s[20:23], s39 offen offset:2048 lds
  buffer_load_dwordx4 v247, s[20:23], s39 offen offset:3072 lds
  s_add_u32 m0, s42, 86016
  s_nop 0
  buffer_load_dwordx4 v248, s[20:23], s39 offen offset:0 lds
  buffer_load_dwordx4 v249, s[20:23], s39 offen offset:1024 lds
  s_add_u32 s38, s38, 128
  s_add_u32 s39, s39, 393216
  s_mov_b32 s24, s78
  s_mov_b32 s25, s79
  s_mov_b32 s26, 4194304
  s_mov_b32 s27, 0x20000
  s_mov_b32 s28, s80
  s_mov_b32 s29, s81
  s_mov_b32 s30, 4194304
  s_mov_b32 s31, 0x20000
  s_mov_b32 s32, s82
  s_mov_b32 s33, s83
  s_mov_b32 s34, 8192
  s_mov_b32 s35, 0x20000
  s_add_u32 s44, s98, 16777216
  s_addc_u32 s45, s99, 0
  s_mov_b32 s46, 4194304
  s_mov_b32 s47, 0x20000
  s_add_u32 s48, s98, 0
  s_addc_u32 s49, s99, 0
  s_mov_b32 s50, 4194304
  s_mov_b32 s51, 0x20000
  s_add_u32 s52, s98, 8388608
  s_addc_u32 s53, s99, 0
  s_mov_b32 s54, 2097152
  s_mov_b32 s55, 0x20000
  s_add_u32 s56, s98, 12582912
  s_addc_u32 s57, s99, 0
  s_mov_b32 s58, 65536
  s_mov_b32 s59, 0x20000
  s_lshl_b32 s60, s2, 2
  s_add_u32 s60, s60, s4
  s_and_b32 s61, s60, 15
  s_lshr_b32 s60, s60, 4
  s_lshl_b32 s62, s60, 16
  s_lshl_b32 s63, s61, 7
  s_add_u32 s62, s62, s63
  v_lshlrev_b32 v21, 14, v14
  v_lshl_add_u32 v21, v15, 3, v21
  v_add_u32 v21, s62, v21
  s_lshl_b32 s63, s61, 9
  v_lshlrev_b32 v22, 5, v15
  s_lshl_b32 s62, s61, 18
  s_lshl_b32 s64, s60, 6
  s_add_u32 s62, s62, s64
  v_lshlrev_b32 v19, 14, v15
  v_lshl_add_u32 v19, v14, 4, v19
  s_lshl_b32 s64, s12, 3
  s_lshl_b32 s65, s4, 1
  s_add_u32 s64, s64, s65
  s_lshl_b32 s64, s64, 15
  s_lshr_b32 s65, s15, 1
  s_lshl_b32 s65, s65, 11
  s_add_u32 s64, s64, s65
  s_add_u32 s65, s64, 32768
  s_lshl_b32 s66, s5, 4
  s_add_u32 s66, s66, s12
  s_lshl_b32 s67, s66, 7
  s_lshl_b32 s66, s66, 12
  s_lshl_b32 s68, s36, 11
  s_add_u32 s66, s66, s68
  v_mov_b32 v160, 0
  v_mov_b32 v161, 0
  v_mov_b32 v162, 0
  v_mov_b32 v163, 0
  v_and_b32 v18, 7, v2
  v_lshlrev_b32 v18, 4, v18
  v_lshrrev_b32 v6, 5, v2
  v_bfe_u32 v7, v2, 2, 2
  v_lshl_add_u32 v7, v6, 2, v7
  v_lshlrev_b32 v7, 11, v7
  v_bfe_u32 v8, v2, 4, 1
  v_lshl_add_u32 v7, v8, 6, v7
  v_and_b32 v8, 3, v2
  v_lshlrev_b32 v6, 1, v6
  v_xor_b32 v8, v8, v6
  v_lshl_add_u32 v7, v8, 4, v7
  v_add_u32 v232, 0, v7
  v_add_u32 v233, 15360, v7
  v_add_u32 v234, 30720, v7
  v_add_u32 v235, 46080, v7
  s_lshl_b32 s69, s4, 16
  s_lshr_b32 s70, s10, 2
  s_lshl_b32 s70, s70, 3
  s_lshr_b32 s71, s11, 2
  s_add_u32 s70, s70, s71
  s_lshl_b32 s70, s70, 7
  s_add_u32 s69, s69, s70
  s_lshl_b32 s70, s4, 12
  s_add_u32 s70, s70, 40960
  s_lshl_b32 s71, s6, 12
  v_mov_b32 v10, 39168
  v_mov_b32 v11, 1
  s_lshl_b32 s43, s4, 2
  v_add_u32 v9, s43, v10
  s_waitcnt vmcnt(20)
  s_barrier
  s_add_u32 m0, s41, 122880
  s_nop 0
  buffer_load_dwordx4 v240, s[16:19], s38 offen offset:0 lds
  buffer_load_dwordx4 v241, s[16:19], s38 offen offset:1024 lds
  buffer_load_dwordx4 v242, s[16:19], s38 offen offset:2048 lds
  buffer_load_dwordx4 v243, s[16:19], s38 offen offset:3072 lds
  s_add_u32 m0, s42, 122880
  s_nop 0
  buffer_load_dwordx4 v244, s[20:23], s39 offen offset:0 lds
  buffer_load_dwordx4 v245, s[20:23], s39 offen offset:1024 lds
  buffer_load_dwordx4 v246, s[20:23], s39 offen offset:2048 lds
  buffer_load_dwordx4 v247, s[20:23], s39 offen offset:3072 lds
  s_add_u32 m0, s42, 126976
  s_nop 0
  buffer_load_dwordx4 v248, s[20:23], s39 offen offset:0 lds
  buffer_load_dwordx4 v249, s[20:23], s39 offen offset:1024 lds
  s_add_u32 s38, s38, 128
  s_add_u32 s39, s39, 393216
  buffer_store_dwordx4 v[160:163], v3, s[48:51], s64 offen sc1
  s_waitcnt vmcnt(21)
  s_barrier
  s_add_u32 m0, s41, 0
  s_nop 0
  buffer_load_dwordx4 v240, s[16:19], s38 offen offset:0 lds
  buffer_load_dwordx4 v241, s[16:19], s38 offen offset:1024 lds
  buffer_load_dwordx4 v242, s[16:19], s38 offen offset:2048 lds
  buffer_load_dwordx4 v243, s[16:19], s38 offen offset:3072 lds
  s_add_u32 m0, s42, 0
  s_nop 0
  buffer_load_dwordx4 v244, s[20:23], s39 offen offset:0 lds
  buffer_load_dwordx4 v245, s[20:23], s39 offen offset:1024 lds
  buffer_load_dwordx4 v246, s[20:23], s39 offen offset:2048 lds
  buffer_load_dwordx4 v247, s[20:23], s39 offen offset:3072 lds
  s_add_u32 m0, s42, 4096
  s_nop 0
  buffer_load_dwordx4 v248, s[20:23], s39 offen offset:0 lds
  buffer_load_dwordx4 v249, s[20:23], s39 offen offset:1024 lds
  s_add_u32 s38, s38, 128
  s_add_u32 s39, s39, 393216
  buffer_store_dwordx4 v[160:163], v3, s[48:51], s64 offen offset:1024 sc1
  s_waitcnt vmcnt(22)
  s_barrier
  s_add_u32 m0, s41, 40960
  s_nop 0
  buffer_load_dwordx4 v240, s[16:19], s38 offen offset:0 lds
  buffer_load_dwordx4 v241, s[16:19], s38 offen offset:1024 lds
  buffer_load_dwordx4 v242, s[16:19], s38 offen offset:2048 lds
  buffer_load_dwordx4 v243, s[16:19], s38 offen offset:3072 lds
  s_add_u32 m0, s42, 40960
  s_nop 0
  buffer_load_dwordx4 v244, s[20:23], s39 offen offset:0 lds
  buffer_load_dwordx4 v245, s[20:23], s39 offen offset:1024 lds
  buffer_load_dwordx4 v246, s[20:23], s39 offen offset:2048 lds
  buffer_load_dwordx4 v247, s[20:23], s39 offen offset:3072 lds
  s_add_u32 m0, s42, 45056
  s_nop 0
  buffer_load_dwordx4 v248, s[20:23], s39 offen offset:0 lds
  buffer_load_dwordx4 v249, s[20:23], s39 offen offset:1024 lds
  s_add_u32 s38, s38, 128
  s_add_u32 s39, s39, 393216
  buffer_store_dwordx4 v[160:163], v3, s[48:51], s65 offen sc1
  s_waitcnt vmcnt(23)
  s_barrier
  s_add_u32 m0, s41, 81920
  s_nop 0
  buffer_load_dwordx4 v240, s[16:19], s38 offen offset:0 lds
  buffer_load_dwordx4 v241, s[16:19], s38 offen offset:1024 lds
  buffer_load_dwordx4 v242, s[16:19], s38 offen offset:2048 lds
  buffer_load_dwordx4 v243, s[16:19], s38 offen offset:3072 lds
  s_add_u32 m0, s42, 81920
  s_nop 0
  buffer_load_dwordx4 v244, s[20:23], s39 offen offset:0 lds
  buffer_load_dwordx4 v245, s[20:23], s39 offen offset:1024 lds
  buffer_load_dwordx4 v246, s[20:23], s39 offen offset:2048 lds
  buffer_load_dwordx4 v247, s[20:23], s39 offen offset:3072 lds
  s_add_u32 m0, s42, 86016
  s_nop 0
  buffer_load_dwordx4 v248, s[20:23], s39 offen offset:0 lds
  buffer_load_dwordx4 v249, s[20:23], s39 offen offset:1024 lds
  s_add_u32 s38, s38, 128
  s_add_u32 s39, s39, 393216
  buffer_store_dwordx4 v[160:163], v3, s[48:51], s65 offen offset:1024 sc1
  s_waitcnt vmcnt(23)
  s_barrier
  s_add_u32 m0, s41, 122880
  s_nop 0
  buffer_load_dwordx4 v240, s[16:19], s38 offen offset:0 lds
  buffer_load_dwordx4 v241, s[16:19], s38 offen offset:1024 lds
  buffer_load_dwordx4 v242, s[16:19], s38 offen offset:2048 lds
  buffer_load_dwordx4 v243, s[16:19], s38 offen offset:3072 lds
  s_add_u32 m0, s42, 122880
  s_nop 0
  buffer_load_dwordx4 v244, s[20:23], s39 offen offset:0 lds
  buffer_load_dwordx4 v245, s[20:23], s39 offen offset:1024 lds
  buffer_load_dwordx4 v246, s[20:23], s39 offen offset:2048 lds
  buffer_load_dwordx4 v247, s[20:23], s39 offen offset:3072 lds
  s_add_u32 m0, s42, 126976
  s_nop 0
  buffer_load_dwordx4 v248, s[20:23], s39 offen offset:0 lds
  buffer_load_dwordx4 v249, s[20:23], s39 offen offset:1024 lds
  s_add_u32 s38, s38, 128
  s_add_u32 s39, s39, 393216
  buffer_store_dwordx4 v[160:163], v3, s[52:55], s66 offen sc1
  buffer_load_dwordx4 v[24:27], v22, s[32:35], s63 offen offset:0
  buffer_load_dwordx4 v[28:31], v22, s[32:35], s63 offen offset:16
  v_add_u32 v23, 4294961152, v21
  buffer_load_dwordx2 v[32:33], v23, s[24:27], 0 offen nt
  v_add_u32 v23, 4294963200, v21
  buffer_load_dwordx2 v[34:35], v23, s[24:27], 0 offen nt
  v_add_u32 v23, 4294965248, v21
  buffer_load_dwordx2 v[36:37], v23, s[24:27], 0 offen nt
  v_add_u32 v23, 0, v21
  buffer_load_dwordx2 v[38:39], v23, s[24:27], 0 offen nt
  v_add_u32 v23, 2048, v21
  buffer_load_dwordx2 v[40:41], v23, s[24:27], 0 offen nt
  v_add_u32 v23, 4096, v21
  buffer_load_dwordx2 v[42:43], v23, s[24:27], 0 offen nt
  v_add_u32 v23, 6144, v21
  buffer_load_dwordx2 v[44:45], v23, s[24:27], 0 offen nt
  v_add_u32 v23, 8192, v21
  buffer_load_dwordx2 v[46:47], v23, s[24:27], 0 offen nt
  v_add_u32 v23, 10240, v21
  buffer_load_dwordx2 v[48:49], v23, s[24:27], 0 offen nt
  s_waitcnt vmcnt(34)
  s_barrier
  s_add_u32 m0, s41, 0
  s_nop 0
  buffer_load_dwordx4 v240, s[16:19], s38 offen offset:0 lds
  buffer_load_dwordx4 v241, s[16:19], s38 offen offset:1024 lds
  buffer_load_dwordx4 v242, s[16:19], s38 offen offset:2048 lds
  buffer_load_dwordx4 v243, s[16:19], s38 offen offset:3072 lds
  s_add_u32 m0, s42, 0
  s_nop 0
  buffer_load_dwordx4 v244, s[20:23], s39 offen offset:0 lds
  buffer_load_dwordx4 v245, s[20:23], s39 offen offset:1024 lds
  buffer_load_dwordx4 v246, s[20:23], s39 offen offset:2048 lds
  buffer_load_dwordx4 v247, s[20:23], s39 offen offset:3072 lds
  s_add_u32 m0, s42, 4096
  s_nop 0
  buffer_load_dwordx4 v248, s[20:23], s39 offen offset:0 lds
  buffer_load_dwordx4 v249, s[20:23], s39 offen offset:1024 lds
  s_add_u32 s38, s38, 128
  s_add_u32 s39, s39, 393216
  buffer_store_dwordx4 v[160:163], v3, s[52:55], s66 offen offset:1024 sc1
  v_add_u32 v23, 12288, v21
  buffer_load_dwordx2 v[50:51], v23, s[24:27], 0 offen nt
  v_add_u32 v23, 14336, v21
  buffer_load_dwordx2 v[52:53], v23, s[24:27], 0 offen nt
  v_add_u32 v23, 0, v21
  buffer_load_dwordx2 v[54:55], v23, s[28:31], 0 offen nt
  v_add_u32 v23, 2048, v21
  buffer_load_dwordx2 v[56:57], v23, s[28:31], 0 offen nt
  v_add_u32 v23, 4096, v21
  buffer_load_dwordx2 v[58:59], v23, s[28:31], 0 offen nt
  v_add_u32 v23, 6144, v21
  buffer_load_dwordx2 v[60:61], v23, s[28:31], 0 offen nt
  v_add_u32 v23, 8192, v21
  buffer_load_dwordx2 v[62:63], v23, s[28:31], 0 offen nt
  v_add_u32 v23, 10240, v21
  buffer_load_dwordx2 v[64:65], v23, s[28:31], 0 offen nt
  v_add_u32 v23, 12288, v21
  buffer_load_dwordx2 v[66:67], v23, s[28:31], 0 offen nt
  v_add_u32 v23, 14336, v21
  buffer_load_dwordx2 v[68:69], v23, s[28:31], 0 offen nt
  s_waitcnt vmcnt(44)
  s_barrier
  s_add_u32 m0, s41, 40960
  s_nop 0
  buffer_load_dwordx4 v240, s[16:19], s38 offen offset:0 lds
  buffer_load_dwordx4 v241, s[16:19], s38 offen offset:1024 lds
  buffer_load_dwordx4 v242, s[16:19], s38 offen offset:2048 lds
  buffer_load_dwordx4 v243, s[16:19], s38 offen offset:3072 lds
  s_add_u32 m0, s42, 40960
  s_nop 0
  buffer_load_dwordx4 v244, s[20:23], s39 offen offset:0 lds
  buffer_load_dwordx4 v245, s[20:23], s39 offen offset:1024 lds
  buffer_load_dwordx4 v246, s[20:23], s39 offen offset:2048 lds
  buffer_load_dwordx4 v247, s[20:23], s39 offen offset:3072 lds
  s_add_u32 m0, s42, 45056
  s_nop 0
  buffer_load_dwordx4 v248, s[20:23], s39 offen offset:0 lds
  buffer_load_dwordx4 v249, s[20:23], s39 offen offset:1024 lds
  s_add_u32 s38, s38, 128
  s_add_u32 s39, s39, 393216
  buffer_store_dwordx4 v[160:163], v18, s[56:59], s67 offen sc1
  s_waitcnt vmcnt(11)
  v_lshlrev_b32 v72, 16, v24
  v_and_b32 v76, 0xffff0000, v24
  v_lshlrev_b32 v80, 16, v25
  v_and_b32 v84, 0xffff0000, v25
  v_lshlrev_b32 v73, 16, v26
  v_and_b32 v77, 0xffff0000, v26
  v_lshlrev_b32 v81, 16, v27
  v_and_b32 v85, 0xffff0000, v27
  v_lshlrev_b32 v74, 16, v28
  v_and_b32 v78, 0xffff0000, v28
  v_lshlrev_b32 v82, 16, v29
  v_and_b32 v86, 0xffff0000, v29
  v_lshlrev_b32 v75, 16, v30
  v_and_b32 v79, 0xffff0000, v30
  v_lshlrev_b32 v83, 16, v31
  v_and_b32 v87, 0xffff0000, v31
  v_lshlrev_b32 v88, 16, v32
  v_and_b32 v89, 0xffff0000, v32
  v_lshlrev_b32 v90, 16, v34
  v_and_b32 v91, 0xffff0000, v34
  v_lshlrev_b32 v92, 16, v36
  v_and_b32 v93, 0xffff0000, v36
  v_lshlrev_b32 v94, 16, v38
  v_and_b32 v95, 0xffff0000, v38
  v_lshlrev_b32 v96, 16, v40
  v_and_b32 v97, 0xffff0000, v40
  v_lshlrev_b32 v98, 16, v42
  v_and_b32 v99, 0xffff0000, v42
  v_lshlrev_b32 v100, 16, v44
  v_and_b32 v101, 0xffff0000, v44
  v_lshlrev_b32 v102, 16, v46
  v_and_b32 v103, 0xffff0000, v46
  v_lshlrev_b32 v104, 16, v48
  v_and_b32 v105, 0xffff0000, v48
  v_lshlrev_b32 v106, 16, v50
  v_and_b32 v107, 0xffff0000, v50
  v_lshlrev_b32 v108, 16, v52
  v_and_b32 v109, 0xffff0000, v52
  v_lshlrev_b32 v110, 16, v54
  v_and_b32 v111, 0xffff0000, v54
  v_lshlrev_b32 v112, 16, v56
  v_and_b32 v113, 0xffff0000, v56
  v_lshlrev_b32 v114, 16, v58
  v_and_b32 v115, 0xffff0000, v58
  v_lshlrev_b32 v116, 16, v60
  v_and_b32 v117, 0xffff0000, v60
  v_lshlrev_b32 v118, 16, v62
  v_and_b32 v119, 0xffff0000, v62
  v_lshlrev_b32 v120, 16, v64
  v_and_b32 v121, 0xffff0000, v64
  v_lshlrev_b32 v122, 16, v66
  v_and_b32 v123, 0xffff0000, v66
  v_lshlrev_b32 v124, 16, v68
  v_and_b32 v125, 0xffff0000, v68
  v_mul_f32 v126, v88, v84
  v_mul_f32 v127, v89, v85
  v_mul_f32 v128, v90, v84
  v_mul_f32 v129, v91, v85
  v_mul_f32 v130, v92, v84
  v_mul_f32 v131, v93, v85
  v_mul_f32 v132, v94, v84
  v_mul_f32 v133, v95, v85
  v_mul_f32 v134, v96, v84
  v_mul_f32 v135, v97, v85
  v_mul_f32 v136, v98, v84
  v_mul_f32 v137, v99, v85
  v_mul_f32 v138, v100, v84
  v_mul_f32 v139, v101, v85
  v_mul_f32 v140, v102, v84
  v_mul_f32 v141, v103, v85
  v_fmac_f32 v126, v90, v80
  v_fmac_f32 v127, v91, v81
  v_fmac_f32 v128, v92, v80
  s_barrier
  s_add_u32 m0, s41, 81920
  s_nop 0
  buffer_load_dwordx4 v240, s[16:19], s38 offen offset:0 lds
  buffer_load_dwordx4 v241, s[16:19], s38 offen offset:1024 lds
  buffer_load_dwordx4 v242, s[16:19], s38 offen offset:2048 lds
  buffer_load_dwordx4 v243, s[16:19], s38 offen offset:3072 lds
  s_add_u32 m0, s42, 81920
  s_nop 0
  buffer_load_dwordx4 v244, s[20:23], s39 offen offset:0 lds
  buffer_load_dwordx4 v245, s[20:23], s39 offen offset:1024 lds
  buffer_load_dwordx4 v246, s[20:23], s39 offen offset:2048 lds
  buffer_load_dwordx4 v247, s[20:23], s39 offen offset:3072 lds
  s_add_u32 m0, s42, 86016
  s_nop 0
  buffer_load_dwordx4 v248, s[20:23], s39 offen offset:0 lds
  buffer_load_dwordx4 v249, s[20:23], s39 offen offset:1024 lds
  s_add_u32 s38, s38, 128
  s_add_u32 s39, s39, 393216
  v_fmac_f32 v129, v93, v81
  v_fmac_f32 v130, v94, v80
  v_fmac_f32 v131, v95, v81
  v_fmac_f32 v132, v96, v80
  v_fmac_f32 v133, v97, v81
  v_fmac_f32 v134, v98, v80
  v_fmac_f32 v135, v99, v81
  v_fmac_f32 v136, v100, v80
  v_fmac_f32 v137, v101, v81
  v_fmac_f32 v138, v102, v80
  v_fmac_f32 v139, v103, v81
  v_fmac_f32 v140, v104, v80
  v_fmac_f32 v141, v105, v81
  v_fmac_f32 v126, v92, v76
  v_fmac_f32 v127, v93, v77
  v_fmac_f32 v128, v94, v76
  v_fmac_f32 v129, v95, v77
  v_fmac_f32 v130, v96, v76
  v_fmac_f32 v131, v97, v77
  v_fmac_f32 v132, v98, v76
  v_fmac_f32 v133, v99, v77
  v_fmac_f32 v134, v100, v76
  v_fmac_f32 v135, v101, v77
  v_fmac_f32 v136, v102, v76
  v_fmac_f32 v137, v103, v77
  v_fmac_f32 v138, v104, v76
  v_fmac_f32 v139, v105, v77
  v_fmac_f32 v140, v106, v76
  v_fmac_f32 v141, v107, v77
  v_fmac_f32 v126, v94, v72
  v_fmac_f32 v127, v95, v73
  v_fmac_f32 v128, v96, v72
  v_fmac_f32 v129, v97, v73
  v_fmac_f32 v130, v98, v72
  v_fmac_f32 v131, v99, v73
  v_fmac_f32 v132, v100, v72
  v_fmac_f32 v133, v101, v73
  v_fmac_f32 v134, v102, v72
  v_fmac_f32 v135, v103, v73
  v_fmac_f32 v136, v104, v72
  v_fmac_f32 v137, v105, v73
  v_fmac_f32 v138, v106, v72
  v_fmac_f32 v139, v107, v73
  v_fmac_f32 v140, v108, v72
  v_fmac_f32 v141, v109, v73
  v_mul_f32 v126, v126, v110
  v_mul_f32 v127, v127, v111
  v_mul_f32 v128, v128, v112
  v_mul_f32 v129, v129, v113
  v_mul_f32 v130, v130, v114
  v_mul_f32 v131, v131, v115
  v_mul_f32 v132, v132, v116
  v_mul_f32 v133, v133, v117
  v_mul_f32 v134, v134, v118
  v_mul_f32 v135, v135, v119
  v_mul_f32 v136, v136, v120
  v_mul_f32 v137, v137, v121
  v_mul_f32 v138, v138, v122
  v_mul_f32 v139, v139, v123
  v_mul_f32 v140, v140, v124
  v_mul_f32 v141, v141, v125
  v_cvt_pk_bf16_f32 v144, v126, v128
  v_cvt_pk_bf16_f32 v145, v130, v132
  v_cvt_pk_bf16_f32 v146, v134, v136
  v_cvt_pk_bf16_f32 v147, v138, v140
  v_cvt_pk_bf16_f32 v148, v127, v129
  v_cvt_pk_bf16_f32 v149, v131, v133
  v_cvt_pk_bf16_f32 v150, v135, v137
  v_cvt_pk_bf16_f32 v151, v139, v141
  v_and_b32 v144, -2, v144
  v_and_b32 v145, -2, v145
  v_and_b32 v146, -2, v146
  v_and_b32 v147, -2, v147
  s_barrier
  s_add_u32 m0, s41, 122880
  s_nop 0
  buffer_load_dwordx4 v240, s[16:19], s38 offen offset:0 lds
  buffer_load_dwordx4 v241, s[16:19], s38 offen offset:1024 lds
  buffer_load_dwordx4 v242, s[16:19], s38 offen offset:2048 lds
  buffer_load_dwordx4 v243, s[16:19], s38 offen offset:3072 lds
  s_add_u32 m0, s42, 122880
  s_nop 0
  buffer_load_dwordx4 v244, s[20:23], s39 offen offset:0 lds
  buffer_load_dwordx4 v245, s[20:23], s39 offen offset:1024 lds
  buffer_load_dwordx4 v246, s[20:23], s39 offen offset:2048 lds
  buffer_load_dwordx4 v247, s[20:23], s39 offen offset:3072 lds
  s_add_u32 m0, s42, 126976
  s_nop 0
  buffer_load_dwordx4 v248, s[20:23], s39 offen offset:0 lds
  buffer_load_dwordx4 v249, s[20:23], s39 offen offset:1024 lds
  s_add_u32 s38, s38, 128
  s_add_u32 s39, s39, 393216
  v_and_b32 v148, -2, v148
  v_and_b32 v149, -2, v149
  v_and_b32 v150, -2, v150
  v_and_b32 v151, -2, v151
  buffer_store_dwordx4 v[144:147], v19, s[44:47], s62 offen sc1
  s_add_u32 s62, s62, 4096
  buffer_store_dwordx4 v[148:151], v19, s[44:47], s62 offen sc1
  s_add_u32 s62, s62, 4096
  v_lshlrev_b32 v88, 16, v33
  v_and_b32 v89, 0xffff0000, v33
  v_lshlrev_b32 v90, 16, v35
  v_and_b32 v91, 0xffff0000, v35
  v_lshlrev_b32 v92, 16, v37
  v_and_b32 v93, 0xffff0000, v37
  v_lshlrev_b32 v94, 16, v39
  v_and_b32 v95, 0xffff0000, v39
  v_lshlrev_b32 v96, 16, v41
  v_and_b32 v97, 0xffff0000, v41
  v_lshlrev_b32 v98, 16, v43
  v_and_b32 v99, 0xffff0000, v43
  v_lshlrev_b32 v100, 16, v45
  v_and_b32 v101, 0xffff0000, v45
  v_lshlrev_b32 v102, 16, v47
  v_and_b32 v103, 0xffff0000, v47
  v_lshlrev_b32 v104, 16, v49
  v_and_b32 v105, 0xffff0000, v49
  v_lshlrev_b32 v106, 16, v51
  v_and_b32 v107, 0xffff0000, v51
  v_lshlrev_b32 v108, 16, v53
  v_and_b32 v109, 0xffff0000, v53
  v_lshlrev_b32 v110, 16, v55
  v_and_b32 v111, 0xffff0000, v55
  v_lshlrev_b32 v112, 16, v57
  v_and_b32 v113, 0xffff0000, v57
  v_lshlrev_b32 v114, 16, v59
  v_and_b32 v115, 0xffff0000, v59
  v_lshlrev_b32 v116, 16, v61
  v_and_b32 v117, 0xffff0000, v61
  v_lshlrev_b32 v118, 16, v63
  v_and_b32 v119, 0xffff0000, v63
  v_lshlrev_b32 v120, 16, v65
  v_and_b32 v121, 0xffff0000, v65
  v_lshlrev_b32 v122, 16, v67
  v_and_b32 v123, 0xffff0000, v67
  v_lshlrev_b32 v124, 16, v69
  v_and_b32 v125, 0xffff0000, v69
  v_mul_f32 v126, v88, v86
  v_mul_f32 v127, v89, v87
  v_mul_f32 v128, v90, v86
  v_mul_f32 v129, v91, v87
  v_mul_f32 v130, v92, v86
  v_mul_f32 v131, v93, v87
  v_mul_f32 v132, v94, v86
  v_mul_f32 v133, v95, v87
  v_mul_f32 v134, v96, v86
  v_mul_f32 v135, v97, v87
  v_mul_f32 v136, v98, v86
  v_mul_f32 v137, v99, v87
  v_mul_f32 v138, v100, v86
  v_mul_f32 v139, v101, v87
  v_mul_f32 v140, v102, v86
  v_mul_f32 v141, v103, v87
  v_fmac_f32 v126, v90, v82
  v_fmac_f32 v127, v91, v83
  v_fmac_f32 v128, v92, v82
  v_fmac_f32 v129, v93, v83
  v_fmac_f32 v130, v94, v82
  v_fmac_f32 v131, v95, v83
  v_fmac_f32 v132, v96, v82
  v_fmac_f32 v133, v97, v83
  v_fmac_f32 v134, v98, v82
  v_fmac_f32 v135, v99, v83
  v_fmac_f32 v136, v100, v82
  s_waitcnt vmcnt(23)
  s_barrier
  s_add_u32 m0, s41, 0
  s_nop 0
  buffer_load_dwordx4 v240, s[16:19], s38 offen offset:0 lds
  buffer_load_dwordx4 v241, s[16:19], s38 offen offset:1024 lds
  buffer_load_dwordx4 v242, s[16:19], s38 offen offset:2048 lds
  buffer_load_dwordx4 v243, s[16:19], s38 offen offset:3072 lds
  s_add_u32 m0, s42, 0
  s_nop 0
  buffer_load_dwordx4 v244, s[20:23], s39 offen offset:0 lds
  buffer_load_dwordx4 v245, s[20:23], s39 offen offset:1024 lds
  buffer_load_dwordx4 v246, s[20:23], s39 offen offset:2048 lds
  buffer_load_dwordx4 v247, s[20:23], s39 offen offset:3072 lds
  s_add_u32 m0, s42, 4096
  s_nop 0
  buffer_load_dwordx4 v248, s[20:23], s39 offen offset:0 lds
  buffer_load_dwordx4 v249, s[20:23], s39 offen offset:1024 lds
  s_add_u32 s38, s38, 128
  s_add_u32 s39, s39, 393216
  v_fmac_f32 v137, v101, v83
  v_fmac_f32 v138, v102, v82
  v_fmac_f32 v139, v103, v83
  v_fmac_f32 v140, v104, v82
  v_fmac_f32 v141, v105, v83
  v_fmac_f32 v126, v92, v78
  v_fmac_f32 v127, v93, v79
  v_fmac_f32 v128, v94, v78
  v_fmac_f32 v129, v95, v79
  v_fmac_f32 v130, v96, v78
  v_fmac_f32 v131, v97, v79
  v_fmac_f32 v132, v98, v78
  v_fmac_f32 v133, v99, v79
  v_fmac_f32 v134, v100, v78
  v_fmac_f32 v135, v101, v79
  v_fmac_f32 v136, v102, v78
  v_fmac_f32 v137, v103, v79
  v_fmac_f32 v138, v104, v78
  v_fmac_f32 v139, v105, v79
  v_fmac_f32 v140, v106, v78
  v_fmac_f32 v141, v107, v79
  v_fmac_f32 v126, v94, v74
  v_fmac_f32 v127, v95, v75
  v_fmac_f32 v128, v96, v74
  v_fmac_f32 v129, v97, v75
  v_fmac_f32 v130, v98, v74
  v_fmac_f32 v131, v99, v75
  v_fmac_f32 v132, v100, v74
  v_fmac_f32 v133, v101, v75
  v_fmac_f32 v134, v102, v74
  v_fmac_f32 v135, v103, v75
  v_fmac_f32 v136, v104, v74
  v_fmac_f32 v137, v105, v75
  v_fmac_f32 v138, v106, v74
  v_fmac_f32 v139, v107, v75
  v_fmac_f32 v140, v108, v74
  v_fmac_f32 v141, v109, v75
  v_mul_f32 v126, v126, v110
  v_mul_f32 v127, v127, v111
  v_mul_f32 v128, v128, v112
  v_mul_f32 v129, v129, v113
  v_mul_f32 v130, v130, v114
  v_mul_f32 v131, v131, v115
  v_mul_f32 v132, v132, v116
  v_mul_f32 v133, v133, v117
  v_mul_f32 v134, v134, v118
  v_mul_f32 v135, v135, v119
  v_mul_f32 v136, v136, v120
  v_mul_f32 v137, v137, v121
  v_mul_f32 v138, v138, v122
  v_mul_f32 v139, v139, v123
  v_mul_f32 v140, v140, v124
  v_mul_f32 v141, v141, v125
  v_cvt_pk_bf16_f32 v152, v126, v128
  v_cvt_pk_bf16_f32 v153, v130, v132
  v_cvt_pk_bf16_f32 v154, v134, v136
  v_cvt_pk_bf16_f32 v155, v138, v140
  v_cvt_pk_bf16_f32 v156, v127, v129
  v_cvt_pk_bf16_f32 v157, v131, v133
  v_cvt_pk_bf16_f32 v158, v135, v137
  v_cvt_pk_bf16_f32 v159, v139, v141
  v_and_b32 v152, -2, v152
  v_and_b32 v153, -2, v153
  v_and_b32 v154, -2, v154
  v_and_b32 v155, -2, v155
  v_and_b32 v156, -2, v156
  v_and_b32 v157, -2, v157
  v_and_b32 v158, -2, v158
  v_and_b32 v159, -2, v159
  buffer_store_dwordx4 v[152:155], v19, s[44:47], s62 offen sc1
  s_add_u32 s62, s62, 4096
  buffer_store_dwordx4 v[156:159], v19, s[44:47], s62 offen sc1
  s_add_u32 s62, s62, 4096
  s_waitcnt vmcnt(24)
  s_barrier
  s_add_u32 m0, s41, 40960
  s_nop 0
  buffer_load_dwordx4 v240, s[16:19], s38 offen offset:0 lds
  buffer_load_dwordx4 v241, s[16:19], s38 offen offset:1024 lds
  buffer_load_dwordx4 v242, s[16:19], s38 offen offset:2048 lds
  buffer_load_dwordx4 v243, s[16:19], s38 offen offset:3072 lds
  s_add_u32 m0, s42, 40960
  s_nop 0
  buffer_load_dwordx4 v244, s[20:23], s39 offen offset:0 lds
  buffer_load_dwordx4 v245, s[20:23], s39 offen offset:1024 lds
  buffer_load_dwordx4 v246, s[20:23], s39 offen offset:2048 lds
  buffer_load_dwordx4 v247, s[20:23], s39 offen offset:3072 lds
  s_add_u32 m0, s42, 45056
  s_nop 0
  buffer_load_dwordx4 v248, s[20:23], s39 offen offset:0 lds
  buffer_load_dwordx4 v249, s[20:23], s39 offen offset:1024 lds
  s_add_u32 s38, s38, 128
  s_add_u32 s39, s39, 393216
  s_waitcnt vmcnt(10)
  s_barrier
  s_add_u32 m0, s41, 81920
  s_nop 0
  buffer_load_dwordx4 v240, s[16:19], s38 offen offset:0 lds
  buffer_load_dwordx4 v241, s[16:19], s38 offen offset:1024 lds
  buffer_load_dwordx4 v242, s[16:19], s38 offen offset:2048 lds
  buffer_load_dwordx4 v243, s[16:19], s38 offen offset:3072 lds
  s_add_u32 m0, s42, 81920
  s_nop 0
  buffer_load_dwordx4 v244, s[20:23], s39 offen offset:0 lds
  buffer_load_dwordx4 v245, s[20:23], s39 offen offset:1024 lds
  buffer_load_dwordx4 v246, s[20:23], s39 offen offset:2048 lds
  buffer_load_dwordx4 v247, s[20:23], s39 offen offset:3072 lds
  s_add_u32 m0, s42, 86016
  s_nop 0
  buffer_load_dwordx4 v248, s[20:23], s39 offen offset:0 lds
  buffer_load_dwordx4 v249, s[20:23], s39 offen offset:1024 lds
  s_add_u32 s38, s38, 128
  s_add_u32 s39, s39, 393216
  s_barrier
  s_add_u32 m0, s41, 122880
  s_nop 0
  buffer_load_dwordx4 v240, s[16:19], s38 offen offset:0 lds
  buffer_load_dwordx4 v241, s[16:19], s38 offen offset:1024 lds
  buffer_load_dwordx4 v242, s[16:19], s38 offen offset:2048 lds
  buffer_load_dwordx4 v243, s[16:19], s38 offen offset:3072 lds
  s_add_u32 m0, s42, 122880
  s_nop 0
  buffer_load_dwordx4 v244, s[20:23], s39 offen offset:0 lds
  buffer_load_dwordx4 v245, s[20:23], s39 offen offset:1024 lds
  buffer_load_dwordx4 v246, s[20:23], s39 offen offset:2048 lds
  buffer_load_dwordx4 v247, s[20:23], s39 offen offset:3072 lds
  s_add_u32 m0, s42, 126976
  s_nop 0
  buffer_load_dwordx4 v248, s[20:23], s39 offen offset:0 lds
  buffer_load_dwordx4 v249, s[20:23], s39 offen offset:1024 lds
  s_add_u32 s38, s38, 128
  s_add_u32 s39, s39, 393216
  s_waitcnt vmcnt(20)
  s_barrier
  s_lshl_b32 s16, s10, 1
  s_lshr_b32 s17, s11, 4
  s_add_u32 s16, s16, s17
  s_and_b32 s17, s11, 15
  s_lshl_b32 s17, s17, 2
  s_add_u32 s17, s17, s4
  s_lshr_b32 s18, s17, 4
  s_and_b32 s17, s17, 15
  s_lshl_b32 s19, s18, 9
  s_lshl_b32 s64, s17, 2
  s_add_u32 s19, s19, s64
  s_lshl_b32 s64, s19, 11
  s_lshl_b32 s65, s16, 7
  s_add_u32 s64, s64, s65
  s_lshl_b32 s72, s19, 12
  s_add_u32 s72, s72, s65
  s_lshl_b32 s73, s16, 18
  s_lshl_b32 s65, s18, 10
  s_add_u32 s73, s73, s65
  s_lshl_b32 s65, s17, 6
  s_add_u32 s73, s73, s65
  s_add_u32 s65, s73, 4096
  s_add_u32 s66, s73, 8192
  s_add_u32 s67, s73, 12288
  v_lshlrev_b32 v224, 12, v14
  v_lshl_add_u32 v224, v15, 3, v224
  v_lshlrev_b32 v225, 14, v15
  v_lshl_add_u32 v225, v14, 4, v225
  s_mov_b32 s16, s84
  s_mov_b32 s17, s85
  s_mov_b32 s18, 4194304
  s_mov_b32 s19, 0x20000
  s_mov_b32 s20, s86
  s_mov_b32 s21, s87
  s_mov_b32 s22, 2048
  s_mov_b32 s23, 0x20000
  v_mov_b32 v4, 0
  v_lshlrev_b32 v5, 2, v2
  v_add_u32 v6, 39168, v5
  ds_write_b32 v6, v4
  v_add_u32 v6, s7, v5
  ds_write_b32 v6, v4 offset:4128
  v_and_b32 v6, 7, v2
  v_lshlrev_b32 v6, 2, v6
  v_add_u32 v6, s7, v6
  ds_write_b32 v6, v4
  s_add_u32 m0, s7, 32
  s_nop 0
  buffer_load_dwordx4 v3, s[16:19], s71 offen offset:0 nt lds
  buffer_load_dwordx4 v3, s[16:19], s71 offen offset:1024 nt lds
  buffer_load_dwordx4 v3, s[16:19], s71 offen offset:2048 nt lds
  buffer_load_dwordx4 v3, s[16:19], s71 offen offset:3072 nt lds
  s_lshl_b32 s43, s6, 1
  v_mov_b32 v4, 0
  buffer_load_ushort v164, v4, s[20:23], s43 offen
  s_mov_b32 s20, s92
  s_mov_b32 s21, s93
  s_mov_b32 s22, 2097152
  s_mov_b32 s23, 0x20000
  s_waitcnt vmcnt(15)
  s_waitcnt lgkmcnt(0)
  s_barrier
  s_add_u32 m0, s70, 0
  s_nop 0
  buffer_load_dwordx4 v232, s[20:23], s69 offen offset:0 lds
  buffer_load_dwordx4 v233, s[20:23], s69 offen offset:1024 lds
  buffer_load_dwordx4 v234, s[20:23], s69 offen offset:2048 lds
  buffer_load_dwordx4 v235, s[20:23], s69 offen offset:3072 lds
  s_add_u32 s69, s69, 262144
  s_add_u32 m0, s70, 16384
  s_nop 0
  buffer_load_dwordx4 v232, s[20:23], s69 offen offset:0 lds
  buffer_load_dwordx4 v233, s[20:23], s69 offen offset:1024 lds
  buffer_load_dwordx4 v234, s[20:23], s69 offen offset:2048 lds
  buffer_load_dwordx4 v235, s[20:23], s69 offen offset:3072 lds
  s_add_u32 s69, s69, 262144
  s_waitcnt vmcnt(13)
  s_barrier
  s_add_u32 m0, s70, 32768
  s_nop 0
  buffer_load_dwordx4 v232, s[20:23], s69 offen offset:0 lds
  buffer_load_dwordx4 v233, s[20:23], s69 offen offset:1024 lds
  buffer_load_dwordx4 v234, s[20:23], s69 offen offset:2048 lds
  buffer_load_dwordx4 v235, s[20:23], s69 offen offset:3072 lds
  s_add_u32 s69, s69, 262144
  s_add_u32 m0, s70, 49152
  s_nop 0
  buffer_load_dwordx4 v232, s[20:23], s69 offen offset:0 lds
  buffer_load_dwordx4 v233, s[20:23], s69 offen offset:1024 lds
  buffer_load_dwordx4 v234, s[20:23], s69 offen offset:2048 lds
  buffer_load_dwordx4 v235, s[20:23], s69 offen offset:3072 lds
  s_add_u32 s69, s69, 262144
  s_barrier
  s_mov_b32 s24, s96
  s_mov_b32 s25, s97
  s_mov_b32 s26, 256
  s_mov_b32 s27, 0x20000
  s_mov_b32 s32, s94
  s_mov_b32 s33, s95
  s_mov_b32 s34, 8388608
  s_mov_b32 s35, 0x20000
  s_mov_b32 s40, 0
  s_mov_b32 s42, 0
  v_lshrrev_b32 v5, 1, v2
  v_lshlrev_b32 v5, 7, v5
  v_and_b32 v4, 1, v2
  v_lshl_add_u32 v5, v4, 4, v5
  v_mov_b32 v4, 0
  buffer_load_dword v226, v4, s[24:27], 0 offen sc1
  s_add_u32 s24, s98, 13631488
  s_addc_u32 s25, s99, 0
  s_mov_b32 s26, 4096
  s_mov_b32 s27, 0x20000
  v_lshlrev_b32 v6, 7, v15
  v_lshl_add_u32 v6, v14, 4, v6
  s_lshl_b32 s60, s15, 11
  s_lshl_b32 s61, s15, 16
  s_lshl_b32 s62, s36, 11
  s_add_u32 s61, s61, s62
  s_mov_b32 s43, 4000
K3_fp:
  buffer_load_dwordx4 v[24:27], v5, s[24:27], 0 offen sc1
  buffer_load_dwordx4 v[28:31], v5, s[24:27], 0 offen offset:32 sc1
  s_waitcnt vmcnt(0)
  v_xor_b32 v24, v24, v226
  v_xor_b32 v25, v25, v226
  v_xor_b32 v26, v26, v226
  v_xor_b32 v27, v27, v226
  v_or3_b32 v24, v24, v25, v26
  v_or_b32 v24, v24, v27
  v_cmp_ne_u32 vcc, 0, v24
  s_sub_u32 s43, s43, 1
  s_cbranch_scc1 K3_fp_ok
  s_cmp_eq_u64 vcc, 0
  s_cbranch_scc1 K3_fp_ok
  s_add_u32 s75, s75, 1
  s_sleep 8
  s_branch K3_fp
K3_fp_ok:
  v_mov_b32 v4, s7
  ds_read_u16 v7, v4 offset:32
  v_lshlrev_b32 v164, 16, v164
  s_waitcnt lgkmcnt(0)
  v_lshlrev_b32 v7, 16, v7
  v_add_f32 v7, v7, v164
  v_cvt_pk_bf16_f32 v7, v7, v7
  ds_write_b16 v4, v7 offset:32
  v_xor_b32 v28, v28, v226
  v_xor_b32 v29, v29, v226
  v_xor_b32 v30, v30, v226
  v_xor_b32 v31, v31, v226
  v_or3_b32 v28, v28, v29, v30
  v_or_b32 v28, v28, v31
  v_cmp_ne_u32 vcc, 0, v28
  s_nop 0
  s_cmp_lg_u64 vcc, 0
  s_cbranch_scc1 K3_nou0
  s_add_u32 m0, s7, 4384
  s_nop 0
  buffer_load_dwordx4 v3, s[44:47], s71 offen offset:0 sc1 lds
  buffer_load_dwordx4 v3, s[44:47], s71 offen offset:1024 sc1 lds
  buffer_load_dwordx4 v3, s[44:47], s71 offen offset:2048 sc1 lds
  buffer_load_dwordx4 v3, s[44:47], s71 offen offset:3072 sc1 lds
  s_mov_b32 s42, 1
  s_waitcnt vmcnt(0) lgkmcnt(0)
  s_mov_b64 exec, 1
  ds_add_u32 v9, v11 offset:8
  s_mov_b64 exec, -1
K3_nou0:
  s_mov_b32 s63, 131072
K3_wkvs:
  s_sleep 1
  ds_read_b32 v16, v10 offset:84
  s_waitcnt lgkmcnt(0)
  v_readfirstlane_b32 s62, v16
  s_sub_u32 s63, s63, 1
  s_cbranch_scc1 K3_wkvs_ok
  s_cmp_lt_u32 s62, 2
  s_cbranch_scc1 K3_wkvs
K3_wkvs_ok:
  s_add_u32 m0, s70, 65536
  s_nop 0
  buffer_load_dwordx4 v232, s[20:23], s69 offen offset:0 lds
  buffer_load_dwordx4 v233, s[20:23], s69 offen offset:1024 lds
  buffer_load_dwordx4 v234, s[20:23], s69 offen offset:2048 lds
  buffer_load_dwordx4 v235, s[20:23], s69 offen offset:3072 lds
  s_add_u32 s69, s69, 262144
  s_add_u32 m0, s70, 81920
  s_nop 0
  buffer_load_dwordx4 v232, s[20:23], s69 offen offset:0 lds
  buffer_load_dwordx4 v233, s[20:23], s69 offen offset:1024 lds
  buffer_load_dwordx4 v234, s[20:23], s69 offen offset:2048 lds
  buffer_load_dwordx4 v235, s[20:23], s69 offen offset:3072 lds
  s_add_u32 s69, s69, 262144
  s_mov_b32 s43, 4000
K3_zp:
  buffer_load_dwordx4 v[32:35], v6, s[56:59], s60 offen offset:0 sc1
  buffer_load_dwordx4 v[36:39], v6, s[56:59], s60 offen offset:64 sc1
  s_cmp_lg_u32 s42, 0
  s_cbranch_scc1 K3_zp_nf
  buffer_load_dwordx4 v[28:31], v5, s[24:27], 0 offen offset:32 sc1
  s_waitcnt vmcnt(0)
  v_xor_b32 v28, v28, v226
  v_xor_b32 v29, v29, v226
  v_xor_b32 v30, v30, v226
  v_xor_b32 v31, v31, v226
  v_or3_b32 v28, v28, v29, v30
  v_or_b32 v28, v28, v31
  v_cmp_ne_u32 vcc, 0, v28
  s_nop 0
  s_cmp_lg_u64 vcc, 0
  s_cbranch_scc1 K3_zp_nf
  s_add_u32 m0, s7, 4384
  s_nop 0
  buffer_load_dwordx4 v3, s[44:47], s71 offen offset:0 sc1 lds
  buffer_load_dwordx4 v3, s[44:47], s71 offen offset:1024 sc1 lds
  buffer_load_dwordx4 v3, s[44:47], s71 offen offset:2048 sc1 lds
  buffer_load_dwordx4 v3, s[44:47], s71 offen offset:3072 sc1 lds
  s_mov_b32 s42, 1
  s_waitcnt vmcnt(0) lgkmcnt(0)
  s_mov_b64 exec, 1
  ds_add_u32 v9, v11 offset:8
  s_mov_b64 exec, -1
K3_zp_nf:
  ds_read_b32 v17, v9 offset:56
  s_waitcnt vmcnt(0) lgkmcnt(0)
  v_bitop3_b32 v16, v32, v33, 1 bitop3:0x80
  v_bitop3_b32 v16, v16, v34, v35 bitop3:0x80
  v_bitop3_b32 v16, v16, v36, v37 bitop3:0x80
  v_bitop3_b32 v16, v16, v38, v39 bitop3:0x80
  v_readfirstlane_b32 s41, v17
  v_cmp_eq_u32 vcc, 0, v16
  s_sub_u32 s43, s43, 1
  s_cbranch_scc1 K3_zp_ok
  s_cmp_eq_u64 vcc, 0
  s_cbranch_scc1 K3_zp_ok
  s_cmp_lg_u32 s40, 0
  s_cbranch_scc1 K3_zp_s2
K3_zp_s2:
  s_sleep 10
  s_branch K3_zp
K3_zp_ok:
  s_setprio 2
  s_mov_b32 s43, 4000
  s_mov_b32 s62, s61
  buffer_load_dwordx4 v[64:67], v3, s[52:55], s62 offen offset:0
  buffer_load_dwordx4 v[68:71], v3, s[52:55], s62 offen offset:1024
  s_add_u32 s62, s62, 4096
  buffer_load_dwordx4 v[72:75], v3, s[52:55], s62 offen offset:0
  buffer_load_dwordx4 v[76:79], v3, s[52:55], s62 offen offset:1024
  s_add_u32 s62, s62, 4096
  buffer_load_dwordx4 v[80:83], v3, s[52:55], s62 offen offset:0
  buffer_load_dwordx4 v[84:87], v3, s[52:55], s62 offen offset:1024
  s_add_u32 s62, s62, 4096
  buffer_load_dwordx4 v[88:91], v3, s[52:55], s62 offen offset:0
  buffer_load_dwordx4 v[92:95], v3, s[52:55], s62 offen offset:1024
  s_add_u32 s62, s62, 4096
  buffer_load_dwordx4 v[96:99], v3, s[52:55], s62 offen offset:0
  buffer_load_dwordx4 v[100:103], v3, s[52:55], s62 offen offset:1024
  s_add_u32 s62, s62, 4096
  buffer_load_dwordx4 v[104:107], v3, s[52:55], s62 offen offset:0
  buffer_load_dwordx4 v[108:111], v3, s[52:55], s62 offen offset:1024
  s_add_u32 s62, s62, 4096
  buffer_load_dwordx4 v[112:115], v3, s[52:55], s62 offen offset:0
  buffer_load_dwordx4 v[116:119], v3, s[52:55], s62 offen offset:1024
  s_add_u32 s62, s62, 4096
  buffer_load_dwordx4 v[120:123], v3, s[52:55], s62 offen offset:0
  buffer_load_dwordx4 v[124:127], v3, s[52:55], s62 offen offset:1024
  s_add_u32 s62, s62, 4096
  buffer_load_dwordx4 v[128:131], v3, s[52:55], s62 offen offset:0
  buffer_load_dwordx4 v[132:135], v3, s[52:55], s62 offen offset:1024
  s_add_u32 s62, s62, 4096
  buffer_load_dwordx4 v[136:139], v3, s[52:55], s62 offen offset:0
  buffer_load_dwordx4 v[140:143], v3, s[52:55], s62 offen offset:1024
  s_add_u32 s62, s62, 4096
  buffer_load_dwordx4 v[144:147], v3, s[52:55], s62 offen offset:0
  buffer_load_dwordx4 v[148:151], v3, s[52:55], s62 offen offset:1024
  s_add_u32 s62, s62, 4096
  buffer_load_dwordx4 v[152:155], v3, s[52:55], s62 offen offset:0
  buffer_load_dwordx4 v[156:159], v3, s[52:55], s62 offen offset:1024
  s_add_u32 s62, s62, 4096
  buffer_load_dwordx4 v[160:163], v3, s[52:55], s62 offen offset:0
  buffer_load_dwordx4 v[164:167], v3, s[52:55], s62 offen offset:1024
  s_add_u32 s62, s62, 4096
  buffer_load_dwordx4 v[168:171], v3, s[52:55], s62 offen offset:0
  buffer_load_dwordx4 v[172:175], v3, s[52:55], s62 offen offset:1024
  s_add_u32 s62, s62, 4096
  buffer_load_dwordx4 v[176:179], v3, s[52:55], s62 offen offset:0
  buffer_load_dwordx4 v[180:183], v3, s[52:55], s62 offen offset:1024
  s_add_u32 s62, s62, 4096
  buffer_load_dwordx4 v[184:187], v3, s[52:55], s62 offen offset:0
  buffer_load_dwordx4 v[188:191], v3, s[52:55], s62 offen offset:1024
  s_add_u32 s62, s62, 4096
  s_mov_b32 s16, s76
  s_mov_b32 s17, s77
  s_mov_b32 s18, 4194304
  s_mov_b32 s19, 0x20000
  v_lshlrev_b32 v4, 11, v14
  v_lshl_add_u32 v4, v15, 3, v4
  buffer_load_dwordx2 v[208:209], v4, s[16:19], s64 offen nt
  s_add_u32 s64, s64, 131072
  buffer_load_dwordx2 v[210:211], v4, s[16:19], s64 offen nt
  s_add_u32 s64, s64, 131072
  buffer_load_dwordx2 v[212:213], v4, s[16:19], s64 offen nt
  s_add_u32 s64, s64, 131072
  buffer_load_dwordx2 v[214:215], v4, s[16:19], s64 offen nt
  s_add_u32 s64, s64, 131072
  buffer_load_dwordx2 v[216:217], v4, s[16:19], s64 offen nt
  s_add_u32 s64, s64, 131072
  buffer_load_dwordx2 v[218:219], v4, s[16:19], s64 offen nt
  s_add_u32 s64, s64, 131072
  buffer_load_dwordx2 v[220:221], v4, s[16:19], s64 offen nt
  s_add_u32 s64, s64, 131072
  buffer_load_dwordx2 v[222:223], v4, s[16:19], s64 offen nt
  s_add_u32 s64, s64, 131072
K3_gl:
  v_add_f32_dpp v40, v32, v32 row_ror:8 row_mask:0xf bank_mask:0xf
  v_add_f32_dpp v41, v33, v33 row_ror:8 row_mask:0xf bank_mask:0xf
  v_add_f32_dpp v42, v34, v34 row_ror:8 row_mask:0xf bank_mask:0xf
  v_add_f32_dpp v43, v35, v35 row_ror:8 row_mask:0xf bank_mask:0xf
  v_add_f32_dpp v44, v36, v36 row_ror:8 row_mask:0xf bank_mask:0xf
  v_add_f32_dpp v45, v37, v37 row_ror:8 row_mask:0xf bank_mask:0xf
  v_add_f32_dpp v46, v38, v38 row_ror:8 row_mask:0xf bank_mask:0xf
  v_add_f32_dpp v47, v39, v39 row_ror:8 row_mask:0xf bank_mask:0xf
  v_add_f32_dpp v40, v40, v40 row_ror:4 row_mask:0xf bank_mask:0xf
  v_add_f32_dpp v41, v41, v41 row_ror:4 row_mask:0xf bank_mask:0xf
  v_add_f32_dpp v42, v42, v42 row_ror:4 row_mask:0xf bank_mask:0xf
  v_add_f32_dpp v43, v43, v43 row_ror:4 row_mask:0xf bank_mask:0xf
  v_add_f32_dpp v44, v44, v44 row_ror:4 row_mask:0xf bank_mask:0xf
  v_add_f32_dpp v45, v45, v45 row_ror:4 row_mask:0xf bank_mask:0xf
  v_add_f32_dpp v46, v46, v46 row_ror:4 row_mask:0xf bank_mask:0xf
  v_add_f32_dpp v47, v47, v47 row_ror:4 row_mask:0xf bank_mask:0xf
  v_add_f32_dpp v40, v40, v40 row_ror:2 row_mask:0xf bank_mask:0xf
  v_add_f32_dpp v41, v41, v41 row_ror:2 row_mask:0xf bank_mask:0xf
  v_add_f32_dpp v42, v42, v42 row_ror:2 row_mask:0xf bank_mask:0xf
  v_add_f32_dpp v43, v43, v43 row_ror:2 row_mask:0xf bank_mask:0xf
  v_add_f32_dpp v44, v44, v44 row_ror:2 row_mask:0xf bank_mask:0xf
  v_add_f32_dpp v45, v45, v45 row_ror:2 row_mask:0xf bank_mask:0xf
  v_add_f32_dpp v46, v46, v46 row_ror:2 row_mask:0xf bank_mask:0xf
  v_add_f32_dpp v47, v47, v47 row_ror:2 row_mask:0xf bank_mask:0xf
  v_add_f32_dpp v40, v40, v40 row_ror:1 row_mask:0xf bank_mask:0xf
  v_add_f32_dpp v41, v41, v41 row_ror:1 row_mask:0xf bank_mask:0xf
  v_add_f32_dpp v42, v42, v42 row_ror:1 row_mask:0xf bank_mask:0xf
  v_add_f32_dpp v43, v43, v43 row_ror:1 row_mask:0xf bank_mask:0xf
  v_add_f32_dpp v44, v44, v44 row_ror:1 row_mask:0xf bank_mask:0xf
  v_add_f32_dpp v45, v45, v45 row_ror:1 row_mask:0xf bank_mask:0xf
  v_add_f32_dpp v46, v46, v46 row_ror:1 row_mask:0xf bank_mask:0xf
  v_add_f32_dpp v47, v47, v47 row_ror:1 row_mask:0xf bank_mask:0xf
  v_cvt_pk_bf16_f32 v48, v40, v41
  v_cvt_pk_bf16_f32 v49, v42, v43
  v_cvt_pk_bf16_f32 v50, v44, v45
  v_cvt_pk_bf16_f32 v51, v46, v47
  v_mov_b32 v16, 1
  s_waitcnt vmcnt(38)
  v_bitop3_b32 v16, v16, v64, v65 bitop3:0x80
  v_bitop3_b32 v16, v16, v66, v67 bitop3:0x80
  v_bitop3_b32 v16, v16, v68, v69 bitop3:0x80
  v_bitop3_b32 v16, v16, v70, v71 bitop3:0x80
  s_waitcnt vmcnt(36)
  v_bitop3_b32 v16, v16, v72, v73 bitop3:0x80
  v_bitop3_b32 v16, v16, v74, v75 bitop3:0x80
  v_bitop3_b32 v16, v16, v76, v77 bitop3:0x80
  v_bitop3_b32 v16, v16, v78, v79 bitop3:0x80
  v_add_f32 v64, v64, v72
  v_add_f32 v65, v65, v73
  v_add_f32 v66, v66, v74
  v_add_f32 v67, v67, v75
  v_add_f32 v68, v68, v76
  v_add_f32 v69, v69, v77
  v_add_f32 v70, v70, v78
  v_add_f32 v71, v71, v79
  s_waitcnt vmcnt(34)
  v_bitop3_b32 v16, v16, v80, v81 bitop3:0x80
  v_bitop3_b32 v16, v16, v82, v83 bitop3:0x80
  v_bitop3_b32 v16, v16, v84, v85 bitop3:0x80
  v_bitop3_b32 v16, v16, v86, v87 bitop3:0x80
  v_add_f32 v64, v64, v80
  v_add_f32 v65, v65, v81
  v_add_f32 v66, v66, v82
  v_add_f32 v67, v67, v83
  v_add_f32 v68, v68, v84
  v_add_f32 v69, v69, v85
  v_add_f32 v70, v70, v86
  v_add_f32 v71, v71, v87
  s_waitcnt vmcnt(32)
  v_bitop3_b32 v16, v16, v88, v89 bitop3:0x80
  v_bitop3_b32 v16, v16, v90, v91 bitop3:0x80
  v_bitop3_b32 v16, v16, v92, v93 bitop3:0x80
  v_bitop3_b32 v16, v16, v94, v95 bitop3:0x80
  v_add_f32 v64, v64, v88
  v_add_f32 v65, v65, v89
  v_add_f32 v66, v66, v90
  v_add_f32 v67, v67, v91
  v_add_f32 v68, v68, v92
  v_add_f32 v69, v69, v93
  v_add_f32 v70, v70, v94
  v_add_f32 v71, v71, v95
  s_waitcnt vmcnt(30)
  v_bitop3_b32 v16, v16, v96, v97 bitop3:0x80
  v_bitop3_b32 v16, v16, v98, v99 bitop3:0x80
  v_bitop3_b32 v16, v16, v100, v101 bitop3:0x80
  v_bitop3_b32 v16, v16, v102, v103 bitop3:0x80
  v_add_f32 v64, v64, v96
  v_add_f32 v65, v65, v97
  v_add_f32 v66, v66, v98
  v_add_f32 v67, v67, v99
  v_add_f32 v68, v68, v100
  v_add_f32 v69, v69, v101
  v_add_f32 v70, v70, v102
  v_add_f32 v71, v71, v103
  s_waitcnt vmcnt(28)
  v_bitop3_b32 v16, v16, v104, v105 bitop3:0x80
  v_bitop3_b32 v16, v16, v106, v107 bitop3:0x80
  v_bitop3_b32 v16, v16, v108, v109 bitop3:0x80
  v_bitop3_b32 v16, v16, v110, v111 bitop3:0x80
  v_add_f32 v64, v64, v104
  v_add_f32 v65, v65, v105
  v_add_f32 v66, v66, v106
  v_add_f32 v67, v67, v107
  v_add_f32 v68, v68, v108
  v_add_f32 v69, v69, v109
  v_add_f32 v70, v70, v110
  v_add_f32 v71, v71, v111
  s_waitcnt vmcnt(26)
  v_bitop3_b32 v16, v16, v112, v113 bitop3:0x80
  v_bitop3_b32 v16, v16, v114, v115 bitop3:0x80
  v_bitop3_b32 v16, v16, v116, v117 bitop3:0x80
  v_bitop3_b32 v16, v16, v118, v119 bitop3:0x80
  v_add_f32 v64, v64, v112
  v_add_f32 v65, v65, v113
  v_add_f32 v66, v66, v114
  v_add_f32 v67, v67, v115
  v_add_f32 v68, v68, v116
  v_add_f32 v69, v69, v117
  v_add_f32 v70, v70, v118
  v_add_f32 v71, v71, v119
  s_waitcnt vmcnt(24)
  v_bitop3_b32 v16, v16, v120, v121 bitop3:0x80
  v_bitop3_b32 v16, v16, v122, v123 bitop3:0x80
  v_bitop3_b32 v16, v16, v124, v125 bitop3:0x80
  v_bitop3_b32 v16, v16, v126, v127 bitop3:0x80
  v_add_f32 v64, v64, v120
  v_add_f32 v65, v65, v121
  v_add_f32 v66, v66, v122
  v_add_f32 v67, v67, v123
  v_add_f32 v68, v68, v124
  v_add_f32 v69, v69, v125
  v_add_f32 v70, v70, v126
  v_add_f32 v71, v71, v127
  s_waitcnt vmcnt(22)
  v_bitop3_b32 v16, v16, v128, v129 bitop3:0x80
  v_bitop3_b32 v16, v16, v130, v131 bitop3:0x80
  v_bitop3_b32 v16, v16, v132, v133 bitop3:0x80
  v_bitop3_b32 v16, v16, v134, v135 bitop3:0x80
  v_add_f32 v64, v64, v128
  v_add_f32 v65, v65, v129
  v_add_f32 v66, v66, v130
  v_add_f32 v67, v67, v131
  v_add_f32 v68, v68, v132
  v_add_f32 v69, v69, v133
  v_add_f32 v70, v70, v134
  v_add_f32 v71, v71, v135
  s_waitcnt vmcnt(20)
  v_bitop3_b32 v16, v16, v136, v137 bitop3:0x80
  v_bitop3_b32 v16, v16, v138, v139 bitop3:0x80
  v_bitop3_b32 v16, v16, v140, v141 bitop3:0x80
  v_bitop3_b32 v16, v16, v142, v143 bitop3:0x80
  v_add_f32 v64, v64, v136
  v_add_f32 v65, v65, v137
  v_add_f32 v66, v66, v138
  v_add_f32 v67, v67, v139
  v_add_f32 v68, v68, v140
  v_add_f32 v69, v69, v141
  v_add_f32 v70, v70, v142
  v_add_f32 v71, v71, v143
  s_waitcnt vmcnt(18)
  v_bitop3_b32 v16, v16, v144, v145 bitop3:0x80
  v_bitop3_b32 v16, v16, v146, v147 bitop3:0x80
  v_bitop3_b32 v16, v16, v148, v149 bitop3:0x80
  v_bitop3_b32 v16, v16, v150, v151 bitop3:0x80
  v_add_f32 v64, v64, v144
  v_add_f32 v65, v65, v145
  v_add_f32 v66, v66, v146
  v_add_f32 v67, v67, v147
  v_add_f32 v68, v68, v148
  v_add_f32 v69, v69, v149
  v_add_f32 v70, v70, v150
  v_add_f32 v71, v71, v151
  s_waitcnt vmcnt(16)
  v_bitop3_b32 v16, v16, v152, v153 bitop3:0x80
  v_bitop3_b32 v16, v16, v154, v155 bitop3:0x80
  v_bitop3_b32 v16, v16, v156, v157 bitop3:0x80
  v_bitop3_b32 v16, v16, v158, v159 bitop3:0x80
  v_add_f32 v64, v64, v152
  v_add_f32 v65, v65, v153
  v_add_f32 v66, v66, v154
  v_add_f32 v67, v67, v155
  v_add_f32 v68, v68, v156
  v_add_f32 v69, v69, v157
  v_add_f32 v70, v70, v158
  v_add_f32 v71, v71, v159
  s_waitcnt vmcnt(14)
  v_bitop3_b32 v16, v16, v160, v161 bitop3:0x80
  v_bitop3_b32 v16, v16, v162, v163 bitop3:0x80
  v_bitop3_b32 v16, v16, v164, v165 bitop3:0x80
  v_bitop3_b32 v16, v16, v166, v167 bitop3:0x80
  v_add_f32 v64, v64, v160
  v_add_f32 v65, v65, v161
  v_add_f32 v66, v66, v162
  v_add_f32 v67, v67, v163
  v_add_f32 v68, v68, v164
  v_add_f32 v69, v69, v165
  v_add_f32 v70, v70, v166
  v_add_f32 v71, v71, v167
  s_waitcnt vmcnt(12)
  v_bitop3_b32 v16, v16, v168, v169 bitop3:0x80
  v_bitop3_b32 v16, v16, v170, v171 bitop3:0x80
  v_bitop3_b32 v16, v16, v172, v173 bitop3:0x80
  v_bitop3_b32 v16, v16, v174, v175 bitop3:0x80
  v_add_f32 v64, v64, v168
  v_add_f32 v65, v65, v169
  v_add_f32 v66, v66, v170
  v_add_f32 v67, v67, v171
  v_add_f32 v68, v68, v172
  v_add_f32 v69, v69, v173
  v_add_f32 v70, v70, v174
  v_add_f32 v71, v71, v175
  s_waitcnt vmcnt(10)
  v_bitop3_b32 v16, v16, v176, v177 bitop3:0x80
  v_bitop3_b32 v16, v16, v178, v179 bitop3:0x80
  v_bitop3_b32 v16, v16, v180, v181 bitop3:0x80
  v_bitop3_b32 v16, v16, v182, v183 bitop3:0x80
  v_add_f32 v64, v64, v176
  v_add_f32 v65, v65, v177
  v_add_f32 v66, v66, v178
  v_add_f32 v67, v67, v179
  v_add_f32 v68, v68, v180
  v_add_f32 v69, v69, v181
  v_add_f32 v70, v70, v182
  v_add_f32 v71, v71, v183
  s_waitcnt vmcnt(8)
  v_bitop3_b32 v16, v16, v184, v185 bitop3:0x80
  v_bitop3_b32 v16, v16, v186, v187 bitop3:0x80
  v_bitop3_b32 v16, v16, v188, v189 bitop3:0x80
  v_bitop3_b32 v16, v16, v190, v191 bitop3:0x80
  v_add_f32 v64, v64, v184
  v_add_f32 v65, v65, v185
  v_add_f32 v66, v66, v186
  v_add_f32 v67, v67, v187
  v_add_f32 v68, v68, v188
  v_add_f32 v69, v69, v189
  v_add_f32 v70, v70, v190
  v_add_f32 v71, v71, v191
  v_cmp_eq_u32 vcc, 0, v16
  s_sub_u32 s43, s43, 1
  s_cbranch_scc1 K3_gl_ok
  s_cmp_eq_u64 vcc, 0
  s_cbranch_scc1 K3_gl_ok
  s_add_u32 s75, s75, 1
  s_sleep 4
  s_mov_b32 s62, s61
  buffer_load_dwordx4 v[64:67], v3, s[52:55], s62 offen offset:0 sc1
  buffer_load_dwordx4 v[68:71], v3, s[52:55], s62 offen offset:1024 sc1
  s_add_u32 s62, s62, 4096
  buffer_load_dwordx4 v[72:75], v3, s[52:55], s62 offen offset:0 sc1
  buffer_load_dwordx4 v[76:79], v3, s[52:55], s62 offen offset:1024 sc1
  s_add_u32 s62, s62, 4096
  buffer_load_dwordx4 v[80:83], v3, s[52:55], s62 offen offset:0 sc1
  buffer_load_dwordx4 v[84:87], v3, s[52:55], s62 offen offset:1024 sc1
  s_add_u32 s62, s62, 4096
  buffer_load_dwordx4 v[88:91], v3, s[52:55], s62 offen offset:0 sc1
  buffer_load_dwordx4 v[92:95], v3, s[52:55], s62 offen offset:1024 sc1
  s_add_u32 s62, s62, 4096
  buffer_load_dwordx4 v[96:99], v3, s[52:55], s62 offen offset:0 sc1
  buffer_load_dwordx4 v[100:103], v3, s[52:55], s62 offen offset:1024 sc1
  s_add_u32 s62, s62, 4096
  buffer_load_dwordx4 v[104:107], v3, s[52:55], s62 offen offset:0 sc1
  buffer_load_dwordx4 v[108:111], v3, s[52:55], s62 offen offset:1024 sc1
  s_add_u32 s62, s62, 4096
  buffer_load_dwordx4 v[112:115], v3, s[52:55], s62 offen offset:0 sc1
  buffer_load_dwordx4 v[116:119], v3, s[52:55], s62 offen offset:1024 sc1
  s_add_u32 s62, s62, 4096
  buffer_load_dwordx4 v[120:123], v3, s[52:55], s62 offen offset:0 sc1
  buffer_load_dwordx4 v[124:127], v3, s[52:55], s62 offen offset:1024 sc1
  s_add_u32 s62, s62, 4096
  buffer_load_dwordx4 v[128:131], v3, s[52:55], s62 offen offset:0 sc1
  buffer_load_dwordx4 v[132:135], v3, s[52:55], s62 offen offset:1024 sc1
  s_add_u32 s62, s62, 4096
  buffer_load_dwordx4 v[136:139], v3, s[52:55], s62 offen offset:0 sc1
  buffer_load_dwordx4 v[140:143], v3, s[52:55], s62 offen offset:1024 sc1
  s_add_u32 s62, s62, 4096
  buffer_load_dwordx4 v[144:147], v3, s[52:55], s62 offen offset:0 sc1
  buffer_load_dwordx4 v[148:151], v3, s[52:55], s62 offen offset:1024 sc1
  s_add_u32 s62, s62, 4096
  buffer_load_dwordx4 v[152:155], v3, s[52:55], s62 offen offset:0 sc1
  buffer_load_dwordx4 v[156:159], v3, s[52:55], s62 offen offset:1024 sc1
  s_add_u32 s62, s62, 4096
  buffer_load_dwordx4 v[160:163], v3, s[52:55], s62 offen offset:0 sc1
  buffer_load_dwordx4 v[164:167], v3, s[52:55], s62 offen offset:1024 sc1
  s_add_u32 s62, s62, 4096
  buffer_load_dwordx4 v[168:171], v3, s[52:55], s62 offen offset:0 sc1
  buffer_load_dwordx4 v[172:175], v3, s[52:55], s62 offen offset:1024 sc1
  s_add_u32 s62, s62, 4096
  buffer_load_dwordx4 v[176:179], v3, s[52:55], s62 offen offset:0 sc1
  buffer_load_dwordx4 v[180:183], v3, s[52:55], s62 offen offset:1024 sc1
  s_add_u32 s62, s62, 4096
  buffer_load_dwordx4 v[184:187], v3, s[52:55], s62 offen offset:0 sc1
  buffer_load_dwordx4 v[188:191], v3, s[52:55], s62 offen offset:1024 sc1
  s_add_u32 s62, s62, 4096
  s_waitcnt vmcnt(0)
  s_branch K3_gl
K3_gl_ok:
  v_cvt_pk_bf16_f32 v40, v64, v65
  v_cvt_pk_bf16_f32 v41, v66, v67
  v_cvt_pk_bf16_f32 v42, v68, v69
  v_cvt_pk_bf16_f32 v43, v70, v71
  s_lshl_b32 s43, s4, 10
  s_add_u32 s43, s43, 34816
  v_add_u32 v5, s43, v3
  ds_write_b128 v5, v[40:43]
  s_lshl_b32 s43, s37, 2
  v_add_u32 v7, s43, v10
  s_lshl_b32 s43, s37, 11
  s_add_u32 s43, s43, 34816
  v_add_u32 v5, s43, v3
  s_lshl_b32 s43, s4, 12
  s_add_u32 s43, s43, 139264
  v_add_u32 v8, s43, v3
  s_waitcnt lgkmcnt(0)
  s_mov_b64 exec, 1
  ds_add_u32 v7, v11 offset:40
  s_mov_b64 exec, -1
  s_mov_b32 s61, 131072
K3_wpq:
  ds_read_b32 v16, v9 offset:24
  s_waitcnt lgkmcnt(0)
  v_readfirstlane_b32 s60, v16
  s_sub_u32 s61, s61, 1
  s_cbranch_scc1 K3_wpq_ok
  s_cmp_lt_u32 s60, 1
  s_cbranch_scc1 K3_wpq
K3_wpq_ok:
  ds_read_b128 v[16:19], v8 offset:0
  ds_read_b128 v[20:23], v8 offset:1024
  ds_read_b128 v[24:27], v8 offset:2048
  ds_read_b128 v[28:31], v8 offset:3072
  s_mov_b32 s61, 131072
K3_wkt:
  ds_read_b32 v52, v7 offset:40
  s_waitcnt lgkmcnt(0)
  v_readfirstlane_b32 s60, v52
  s_sub_u32 s61, s61, 1
  s_cbranch_scc1 K3_wkt_ok
  s_cmp_lt_u32 s60, 2
  s_cbranch_scc1 K3_wkt
K3_wkt_ok:
  ds_read_b128 v[40:43], v5
  ds_read_b128 v[44:47], v5 offset:1024
  s_waitcnt lgkmcnt(0)
  v_mfma_f32_16x16x32_bf16 v[72:75], v[48:51], v[16:19], 0
  v_mfma_f32_16x16x32_bf16 v[64:67], v[40:43], v[16:19], 0
  v_mfma_f32_16x16x32_bf16 v[68:71], v[44:47], v[16:19], 0
  v_mfma_f32_16x16x32_bf16 v[84:87], v[48:51], v[20:23], 0
  v_mfma_f32_16x16x32_bf16 v[76:79], v[40:43], v[20:23], 0
  v_mfma_f32_16x16x32_bf16 v[80:83], v[44:47], v[20:23], 0
  v_mfma_f32_16x16x32_bf16 v[96:99], v[48:51], v[24:27], 0
  v_mfma_f32_16x16x32_bf16 v[88:91], v[40:43], v[24:27], 0
  v_mfma_f32_16x16x32_bf16 v[92:95], v[44:47], v[24:27], 0
  v_mfma_f32_16x16x32_bf16 v[108:111], v[48:51], v[28:31], 0
  v_mfma_f32_16x16x32_bf16 v[100:103], v[40:43], v[28:31], 0
  v_mfma_f32_16x16x32_bf16 v[104:107], v[44:47], v[28:31], 0
  s_lshl_b32 s60, s12, 3
  s_lshl_b32 s61, s36, 2
  s_add_u32 s60, s60, s61
  s_lshl_b32 s60, s60, 5
  s_add_u32 s60, s60, s15
  s_lshl_b32 s60, s60, 10
  s_mov_b32 s61, 897988541
  v_add_f32 v112, s61, v72
  v_rcp_f32 v112, v112
  v_add_f32 v113, s61, v84
  v_rcp_f32 v113, v113
  v_add_f32 v114, s61, v96
  v_rcp_f32 v114, v114
  v_add_f32 v115, s61, v108
  v_rcp_f32 v115, v115
  v_mul_f32 v64, v64, v112
  v_mul_f32 v65, v65, v112
  v_mul_f32 v66, v66, v112
  v_mul_f32 v67, v67, v112
  v_mul_f32 v68, v68, v112
  v_mul_f32 v69, v69, v112
  v_mul_f32 v70, v70, v112
  v_mul_f32 v71, v71, v112
  v_cvt_pk_bf16_f32 v120, v64, v65
  v_cvt_pk_bf16_f32 v121, v66, v67
  v_cvt_pk_bf16_f32 v122, v68, v69
  v_cvt_pk_bf16_f32 v123, v70, v71
  v_or_b32 v120, 1, v120
  v_or_b32 v121, 1, v121
  v_or_b32 v122, 1, v122
  v_or_b32 v123, 1, v123
  buffer_store_dwordx4 v[120:123], v3, s[48:51], s60 offen sc1
  s_add_u32 s60, s60, 32768
  v_mul_f32 v76, v76, v113
  v_mul_f32 v77, v77, v113
  v_mul_f32 v78, v78, v113
  v_mul_f32 v79, v79, v113
  v_mul_f32 v80, v80, v113
  v_mul_f32 v81, v81, v113
  v_mul_f32 v82, v82, v113
  v_mul_f32 v83, v83, v113
  v_cvt_pk_bf16_f32 v124, v76, v77
  v_cvt_pk_bf16_f32 v125, v78, v79
  v_cvt_pk_bf16_f32 v126, v80, v81
  v_cvt_pk_bf16_f32 v127, v82, v83
  v_or_b32 v124, 1, v124
  v_or_b32 v125, 1, v125
  v_or_b32 v126, 1, v126
  v_or_b32 v127, 1, v127
  buffer_store_dwordx4 v[124:127], v3, s[48:51], s60 offen sc1
  s_add_u32 s60, s60, 32768
  v_mul_f32 v88, v88, v114
  v_mul_f32 v89, v89, v114
  v_mul_f32 v90, v90, v114
  v_mul_f32 v91, v91, v114
  v_mul_f32 v92, v92, v114
  v_mul_f32 v93, v93, v114
  v_mul_f32 v94, v94, v114
  v_mul_f32 v95, v95, v114
  v_cvt_pk_bf16_f32 v128, v88, v89
  v_cvt_pk_bf16_f32 v129, v90, v91
  v_cvt_pk_bf16_f32 v130, v92, v93
  v_cvt_pk_bf16_f32 v131, v94, v95
  v_or_b32 v128, 1, v128
  v_or_b32 v129, 1, v129
  v_or_b32 v130, 1, v130
  v_or_b32 v131, 1, v131
  buffer_store_dwordx4 v[128:131], v3, s[48:51], s60 offen sc1
  s_add_u32 s60, s60, 32768
  v_mul_f32 v100, v100, v115
  v_mul_f32 v101, v101, v115
  v_mul_f32 v102, v102, v115
  v_mul_f32 v103, v103, v115
  v_mul_f32 v104, v104, v115
  v_mul_f32 v105, v105, v115
  v_mul_f32 v106, v106, v115
  v_mul_f32 v107, v107, v115
  v_cvt_pk_bf16_f32 v132, v100, v101
  v_cvt_pk_bf16_f32 v133, v102, v103
  v_cvt_pk_bf16_f32 v134, v104, v105
  v_cvt_pk_bf16_f32 v135, v106, v107
  v_or_b32 v132, 1, v132
  v_or_b32 v133, 1, v133
  v_or_b32 v134, 1, v134
  v_or_b32 v135, 1, v135
  buffer_store_dwordx4 v[132:135], v3, s[48:51], s60 offen sc1
  s_add_u32 s60, s60, 32768
  s_setprio 0
  s_mov_b32 s43, 4000
  v_lshrrev_b32 v5, 1, v2
  v_lshlrev_b32 v5, 7, v5
  v_and_b32 v4, 1, v2
  v_lshl_add_u32 v5, v4, 4, v5
K3_ul:
  s_cmp_lg_u32 s42, 0
  s_cbranch_scc1 K3_ul_done
  buffer_load_dwordx4 v[28:31], v5, s[24:27], 0 offen offset:32 sc1
  s_waitcnt vmcnt(0)
  v_xor_b32 v28, v28, v226
  v_xor_b32 v29, v29, v226
  v_xor_b32 v30, v30, v226
  v_xor_b32 v31, v31, v226
  v_or3_b32 v28, v28, v29, v30
  v_or_b32 v28, v28, v31
  v_cmp_ne_u32 vcc, 0, v28
  s_sub_u32 s43, s43, 1
  s_cbranch_scc1 K3_ul_go
  s_cmp_eq_u64 vcc, 0
  s_cbranch_scc1 K3_ul_go
  s_sleep 4
  s_branch K3_ul
K3_ul_go:
  s_add_u32 m0, s7, 4384
  s_nop 0
  buffer_load_dwordx4 v3, s[44:47], s71 offen offset:0 sc1 lds
  buffer_load_dwordx4 v3, s[44:47], s71 offen offset:1024 sc1 lds
  buffer_load_dwordx4 v3, s[44:47], s71 offen offset:2048 sc1 lds
  buffer_load_dwordx4 v3, s[44:47], s71 offen offset:3072 sc1 lds
  s_mov_b32 s42, 1
  s_waitcnt vmcnt(0) lgkmcnt(0)
  s_mov_b64 exec, 1
  ds_add_u32 v9, v11 offset:8
  s_mov_b64 exec, -1
K3_ul_done:
  s_and_b32 s60, s10, 3
  s_lshl_b32 s60, s60, 2
  s_and_b32 s61, s11, 3
  s_add_u32 s60, s60, s61
  s_lshl_b32 s60, s60, 18
  s_lshr_b32 s61, s11, 2
  s_lshl_b32 s61, s61, 2
  s_add_u32 s61, s61, s4
  s_lshl_b32 s61, s61, 13
  s_add_u32 s63, s60, s61
  v_lshlrev_b32 v8, 7, v2
  s_add_u32 m0, s70, 98304
  s_nop 0
  buffer_load_dwordx4 v232, s[20:23], s69 offen offset:0 lds
  buffer_load_dwordx4 v233, s[20:23], s69 offen offset:1024 lds
  buffer_load_dwordx4 v234, s[20:23], s69 offen offset:2048 lds
  buffer_load_dwordx4 v235, s[20:23], s69 offen offset:3072 lds
  s_add_u32 s69, s69, 262144
  s_mov_b32 s61, 131072
K3_wcd:
  s_sleep 1
  ds_read_b32 v16, v9 offset:56
  s_waitcnt lgkmcnt(0)
  v_readfirstlane_b32 s60, v16
  s_sub_u32 s61, s61, 1
  s_cbranch_scc1 K3_wcd_ok
  s_cmp_lt_u32 s60, 1
  s_cbranch_scc1 K3_wcd
K3_wcd_ok:
  s_mov_b32 m0, s7
  s_nop 0
  buffer_load_dwordx4 v232, s[20:23], s69 offen offset:0 lds
  buffer_load_dwordx4 v233, s[20:23], s69 offen offset:1024 lds
  buffer_load_dwordx4 v234, s[20:23], s69 offen offset:2048 lds
  buffer_load_dwordx4 v235, s[20:23], s69 offen offset:3072 lds
  s_add_u32 s69, s69, 262144
  s_waitcnt vmcnt(8)
  buffer_load_dword v60, v8, s[48:51], s63 offen
  s_waitcnt vmcnt(0)
  s_mov_b64 exec, 1
  ds_add_u32 v10, v11 offset:48
  s_mov_b64 exec, -1
  s_cmp_eq_u32 s40, 1
  s_cbranch_scc1 K3_fin
  s_mov_b32 s40, 2
  s_mov_b32 s43, 4000
K3_post:
  buffer_load_dwordx4 v[16:19], v225, s[44:47], s73 offen sc1
  buffer_load_dwordx4 v[20:23], v225, s[44:47], s65 offen sc1
  buffer_load_dwordx4 v[24:27], v225, s[44:47], s66 offen sc1
  buffer_load_dwordx4 v[28:31], v225, s[44:47], s67 offen sc1
  s_waitcnt vmcnt(0)
  v_bitop3_b32 v48, v16, v17, 1 bitop3:0x80
  v_bitop3_b32 v48, v48, v18, v19 bitop3:0x80
  v_bitop3_b32 v48, v48, v20, v21 bitop3:0x80
  v_bitop3_b32 v48, v48, v22, v23 bitop3:0x80
  v_bitop3_b32 v48, v48, v24, v25 bitop3:0x80
  v_bitop3_b32 v48, v48, v26, v27 bitop3:0x80
  v_bitop3_b32 v48, v48, v28, v29 bitop3:0x80
  v_bitop3_b32 v48, v48, v30, v31 bitop3:0x80
  v_cmp_eq_u32 vcc, 0, v48
  s_nop 0
  s_cmp_eq_u64 vcc, 0
  s_cbranch_scc1 K3_yok
  s_add_u32 s75, s75, 1
  s_cmp_eq_u32 s40, 0
  s_cbranch_scc1 K3_zp_s2
  s_sub_u32 s43, s43, 1
  s_cbranch_scc1 K3_yok
  s_sleep 8
  s_branch K3_post
K3_yok:
  v_lshlrev_b32 v48, 16, v16
  v_lshlrev_b32 v49, 16, v20
  v_lshlrev_b32 v50, 16, v24
  v_lshlrev_b32 v51, 16, v28
  v_lshlrev_b32 v52, 16, v208
  v_and_b32 v53, 0xffff0000, v208
  v_lshlrev_b32 v54, 16, v209
  v_and_b32 v55, 0xffff0000, v209
  v_mul_f32 v48, v48, v52
  v_mul_f32 v49, v49, v53
  v_mul_f32 v50, v50, v54
  v_mul_f32 v51, v51, v55
  v_cvt_pk_bf16_f32 v64, v48, v49
  v_cvt_pk_bf16_f32 v65, v50, v51
  buffer_store_dwordx2 v[64:65], v224, s[32:35], s72 offen nt
  s_add_u32 s72, s72, 262144
  v_and_b32 v56, 0xffff0000, v16
  v_and_b32 v57, 0xffff0000, v20
  v_and_b32 v58, 0xffff0000, v24
  v_and_b32 v59, 0xffff0000, v28
  v_lshlrev_b32 v60, 16, v210
  v_and_b32 v61, 0xffff0000, v210
  v_lshlrev_b32 v62, 16, v211
  v_and_b32 v63, 0xffff0000, v211
  v_mul_f32 v56, v56, v60
  v_mul_f32 v57, v57, v61
  v_mul_f32 v58, v58, v62
  v_mul_f32 v59, v59, v63
  v_cvt_pk_bf16_f32 v66, v56, v57
  v_cvt_pk_bf16_f32 v67, v58, v59
  buffer_store_dwordx2 v[66:67], v224, s[32:35], s72 offen nt
  s_add_u32 s72, s72, 262144
  v_lshlrev_b32 v48, 16, v17
  v_lshlrev_b32 v49, 16, v21
  v_lshlrev_b32 v50, 16, v25
  v_lshlrev_b32 v51, 16, v29
  v_lshlrev_b32 v52, 16, v212
  v_and_b32 v53, 0xffff0000, v212
  v_lshlrev_b32 v54, 16, v213
  v_and_b32 v55, 0xffff0000, v213
  v_mul_f32 v48, v48, v52
  v_mul_f32 v49, v49, v53
  v_mul_f32 v50, v50, v54
  v_mul_f32 v51, v51, v55
  v_cvt_pk_bf16_f32 v68, v48, v49
  v_cvt_pk_bf16_f32 v69, v50, v51
  buffer_store_dwordx2 v[68:69], v224, s[32:35], s72 offen nt
  s_add_u32 s72, s72, 262144
  v_and_b32 v56, 0xffff0000, v17
  v_and_b32 v57, 0xffff0000, v21
  v_and_b32 v58, 0xffff0000, v25
  v_and_b32 v59, 0xffff0000, v29
  v_lshlrev_b32 v60, 16, v214
  v_and_b32 v61, 0xffff0000, v214
  v_lshlrev_b32 v62, 16, v215
  v_and_b32 v63, 0xffff0000, v215
  v_mul_f32 v56, v56, v60
  v_mul_f32 v57, v57, v61
  v_mul_f32 v58, v58, v62
  v_mul_f32 v59, v59, v63
  v_cvt_pk_bf16_f32 v70, v56, v57
  v_cvt_pk_bf16_f32 v71, v58, v59
  buffer_store_dwordx2 v[70:71], v224, s[32:35], s72 offen nt
  s_add_u32 s72, s72, 262144
  v_lshlrev_b32 v48, 16, v18
  v_lshlrev_b32 v49, 16, v22
  v_lshlrev_b32 v50, 16, v26
  v_lshlrev_b32 v51, 16, v30
  v_lshlrev_b32 v52, 16, v216
  v_and_b32 v53, 0xffff0000, v216
  v_lshlrev_b32 v54, 16, v217
  v_and_b32 v55, 0xffff0000, v217
  v_mul_f32 v48, v48, v52
  v_mul_f32 v49, v49, v53
  v_mul_f32 v50, v50, v54
  v_mul_f32 v51, v51, v55
  v_cvt_pk_bf16_f32 v72, v48, v49
  v_cvt_pk_bf16_f32 v73, v50, v51
  buffer_store_dwordx2 v[72:73], v224, s[32:35], s72 offen nt
  s_add_u32 s72, s72, 262144
  v_and_b32 v56, 0xffff0000, v18
  v_and_b32 v57, 0xffff0000, v22
  v_and_b32 v58, 0xffff0000, v26
  v_and_b32 v59, 0xffff0000, v30
  v_lshlrev_b32 v60, 16, v218
  v_and_b32 v61, 0xffff0000, v218
  v_lshlrev_b32 v62, 16, v219
  v_and_b32 v63, 0xffff0000, v219
  v_mul_f32 v56, v56, v60
  v_mul_f32 v57, v57, v61
  v_mul_f32 v58, v58, v62
  v_mul_f32 v59, v59, v63
  v_cvt_pk_bf16_f32 v74, v56, v57
  v_cvt_pk_bf16_f32 v75, v58, v59
  buffer_store_dwordx2 v[74:75], v224, s[32:35], s72 offen nt
  s_add_u32 s72, s72, 262144
  v_lshlrev_b32 v48, 16, v19
  v_lshlrev_b32 v49, 16, v23
  v_lshlrev_b32 v50, 16, v27
  v_lshlrev_b32 v51, 16, v31
  v_lshlrev_b32 v52, 16, v220
  v_and_b32 v53, 0xffff0000, v220
  v_lshlrev_b32 v54, 16, v221
  v_and_b32 v55, 0xffff0000, v221
  v_mul_f32 v48, v48, v52
  v_mul_f32 v49, v49, v53
  v_mul_f32 v50, v50, v54
  v_mul_f32 v51, v51, v55
  v_cvt_pk_bf16_f32 v76, v48, v49
  v_cvt_pk_bf16_f32 v77, v50, v51
  buffer_store_dwordx2 v[76:77], v224, s[32:35], s72 offen nt
  s_add_u32 s72, s72, 262144
  v_and_b32 v56, 0xffff0000, v19
  v_and_b32 v57, 0xffff0000, v23
  v_and_b32 v58, 0xffff0000, v27
  v_and_b32 v59, 0xffff0000, v31
  v_lshlrev_b32 v60, 16, v222
  v_and_b32 v61, 0xffff0000, v222
  v_lshlrev_b32 v62, 16, v223
  v_and_b32 v63, 0xffff0000, v223
  v_mul_f32 v56, v56, v60
  v_mul_f32 v57, v57, v61
  v_mul_f32 v58, v58, v62
  v_mul_f32 v59, v59, v63
  v_cvt_pk_bf16_f32 v78, v56, v57
  v_cvt_pk_bf16_f32 v79, v58, v59
  buffer_store_dwordx2 v[78:79], v224, s[32:35], s72 offen nt
  s_add_u32 s72, s72, 262144
  s_mov_b32 s41, s40
  s_mov_b32 s40, 1
  s_cmp_eq_u32 s41, 0
  s_cbranch_scc1 K3_zp
K3_fin:
K3_end:
  s_endpgm
.section .rodata,"a"
.p2align 6
.amdhsa_kernel concat_heads__ssm_conv_h3__linear_attn_block__prompt_kernel
  .amdhsa_next_free_vgpr 252
  .amdhsa_next_free_sgpr 102
  .amdhsa_accum_offset 252
  .amdhsa_group_segment_fixed_size 0
  .amdhsa_kernarg_size 96
  .amdhsa_user_sgpr_count 2
  .amdhsa_user_sgpr_kernarg_segment_ptr 1
  .amdhsa_system_sgpr_workgroup_id_x 1
.end_amdhsa_kernel
```

```asm
; @launch grid=(256,1,1) block=(512,1,1) lds=163840
.amdgcn_target "amdgcn-amd-amdhsa--gfx950"
.text
.globl concat_heads__ssm_conv_h3__linear_attn_block__prompt_kernel
.p2align 8
.type concat_heads__ssm_conv_h3__linear_attn_block__prompt_kernel,@function
concat_heads__ssm_conv_h3__linear_attn_block__prompt_kernel:
  s_cmp_ge_u32 s2, 256
  s_cbranch_scc1 K3_end
  s_load_dwordx8 s[84:91], s[0:1], 32
  s_load_dwordx8 s[92:99], s[0:1], 64
  s_load_dwordx8 s[76:83], s[0:1], 0
  v_lshrrev_b32 v1, 6, v0
  v_and_b32 v2, 63, v0
  s_and_b32 s10, s2, 7
  v_readfirstlane_b32 s3, v1
  s_lshr_b32 s11, s2, 3
  s_and_b32 s12, s10, 1
  s_lshl_b32 s12, s12, 3
  s_and_b32 s13, s11, 7
  s_add_u32 s12, s12, s13
  s_lshr_b32 s13, s10, 1
  s_lshl_b32 s13, s13, 2
  s_lshr_b32 s14, s11, 3
  s_add_u32 s13, s13, s14
  s_mov_b32 s75, 0
  s_and_b32 s4, s3, 3
  s_and_b32 s36, s3, 1
  s_bfe_u32 s37, s3, 0x10001
  s_lshl_b32 s5, s13, 1
  s_add_u32 s5, s5, s37
  s_xor_b32 s15, s5, 2
  s_lshl_b32 s6, s10, 7
  s_lshl_b32 s7, s11, 2
  s_add_u32 s6, s6, s7
  s_add_u32 s6, s6, s4
  s_mul_i32 s7, s4, 8704
  v_lshlrev_b32 v3, 4, v2
  v_lshrrev_b32 v14, 4, v2
  v_and_b32 v15, 15, v2
  s_waitcnt lgkmcnt(0)
  s_cmp_ge_u32 s3, 4
  s_cbranch_scc1 K3_L
  s_cmp_lg_u32 s3, 0
  s_cbranch_scc1 K3_pfw
  s_mov_b32 s40, s88
  s_mov_b32 s41, s89
  s_mov_b32 s42, 4194304
  s_mov_b32 s43, 0x20000
  v_lshrrev_b32 v192, 3, v2
  v_lshlrev_b32 v192, 11, v192
  v_and_b32 v16, 7, v2
  v_lshl_add_u32 v192, v16, 7, v192
  s_lshl_b32 s45, s2, 14
  s_add_u32 s44, s45, 1024
  s_branch K3_pfd
K3_pfw:
  s_mov_b32 s40, s90
  s_mov_b32 s41, s91
  s_mov_b32 s42, 6291456
  s_mov_b32 s43, 0x20000
  v_lshlrev_b32 v192, 7, v2
  s_mul_i32 s45, s2, 12288
  s_sub_u32 s44, s3, 1
  s_lshl_b32 s44, s44, 12
  s_add_u32 s45, s45, s44
  s_add_u32 s44, s45, 3145728
  s_cmp_eq_u32 s3, 3
  s_cselect_b32 s45, 8388608, s45
  s_cselect_b32 s44, 8388608, s44
K3_pfd:
  buffer_load_dword v195, v192, s[40:43], s45 offen
  s_mov_b32 s56, s96
  s_mov_b32 s57, s97
  s_mov_b32 s58, 256
  s_mov_b32 s59, 0x20000
  s_add_u32 s60, s98, 13631488
  s_addc_u32 s61, s99, 0
  s_mov_b32 s62, 4096
  s_mov_b32 s63, 0x20000
  s_memrealtime s[16:17]
  v_mov_b32 v199, 0
  s_waitcnt lgkmcnt(0)
  s_or_b32 s16, s16, 1
  v_mov_b32 v198, s16
  s_cmp_lg_u32 s3, 3
  s_cbranch_scc1 K3_noseed
  s_cmp_lg_u32 s11, 0
  s_cbranch_scc1 K3_noseed
  v_mov_b32 v196, s16
  v_mov_b32 v197, 0
  s_mov_b64 exec, 1
  buffer_atomic_cmpswap v[196:197], v199, s[56:59], 0 offen sc1
  s_mov_b64 exec, -1
K3_noseed:
  s_lshl_b32 s46, s11, 7
  s_lshl_b32 s47, s10, 2
  s_add_u32 s47, s47, s46
  s_cmp_ge_u32 s3, 2
  s_cselect_b32 s48, s80, s78
  s_cselect_b32 s49, s81, s79
  s_mov_b32 s50, 4194304
  s_mov_b32 s51, 0x20000
  v_lshrrev_b32 v193, 2, v2
  v_lshlrev_b32 v193, 11, v193
  v_and_b32 v16, 3, v2
  v_lshl_add_u32 v193, v16, 7, v193
  s_lshr_b32 s45, s2, 2
  s_lshl_b32 s45, s45, 16
  s_lshl_b32 s46, s36, 15
  s_add_u32 s45, s45, s46
  s_and_b32 s46, s2, 3
  s_lshl_b32 s46, s46, 9
  s_add_u32 s45, s45, s46
  s_mov_b32 s45, 16777216
  v_mov_b32 v200, v15
  s_cmp_lg_u32 s3, 0
  s_cbranch_scc1 K3_e3_1
  s_mov_b32 s64, s84
  s_mov_b32 s65, s85
  s_mov_b32 s66, 4194304
  s_mov_b32 s67, 0x20000
  s_lshl_b32 s68, s10, 19
  s_lshl_b32 s69, s11, 14
  s_add_u32 s68, s68, s69
  s_add_u32 s69, s68, 8192
  v_lshlrev_b32 v194, 7, v2
  s_branch K3_e3_done
K3_e3_1:
  s_cmp_lg_u32 s3, 1
  s_cbranch_scc1 K3_e3_2
  s_mov_b32 s64, s76
  s_mov_b32 s65, s77
  s_mov_b32 s66, 4194304
  s_mov_b32 s67, 0x20000
  s_lshl_b32 s68, s11, 17
  s_lshl_b32 s69, s10, 8
  s_add_u32 s68, s68, s69
  s_add_u32 s69, s68, 65536
  v_lshrrev_b32 v194, 1, v2
  v_lshlrev_b32 v194, 11, v194
  v_and_b32 v15, 1, v2
  v_lshl_add_u32 v194, v15, 7, v194
  s_branch K3_e3_done
K3_e3_2:
  s_cmp_lg_u32 s3, 2
  s_cbranch_scc1 K3_e3_3
  s_mov_b32 s64, s92
  s_mov_b32 s65, s93
  s_mov_b32 s66, 2097152
  s_mov_b32 s67, 0x20000
  s_lshl_b32 s68, s11, 16
  s_lshr_b32 s69, s10, 2
  s_lshl_b32 s69, s69, 10
  s_add_u32 s68, s68, s69
  s_add_u32 s69, s68, 16384
  v_lshrrev_b32 v194, 3, v2
  v_lshlrev_b32 v194, 11, v194
  v_and_b32 v15, 7, v2
  v_lshl_add_u32 v194, v15, 7, v194
  s_branch K3_e3_done
K3_e3_3:
  s_mov_b32 s64, s92
  s_mov_b32 s65, s93
  s_mov_b32 s66, 2097152
  s_mov_b32 s67, 0x20000
  s_lshl_b32 s68, s11, 16
  s_lshr_b32 s69, s10, 2
  s_lshl_b32 s69, s69, 10
  s_add_u32 s68, s68, s69
  s_add_u32 s68, s68, 32768
  s_add_u32 s69, s68, 16384
  v_lshrrev_b32 v194, 3, v2
  v_lshlrev_b32 v194, 11, v194
  v_and_b32 v15, 7, v2
  v_lshl_add_u32 v194, v15, 7, v194
K3_e3_done:
  v_mov_b32 v15, v200
  s_and_b32 s55, s11, 3
  s_add_u32 s55, s55, 0
  s_and_b32 s52, s11, 3
  s_add_u32 s52, s52, 4
  s_sub_u32 s52, s52, s55
  s_sub_u32 s52, s52, 1
  s_mov_b32 s54, 0
  s_lshr_b32 s70, s11, 2
  s_and_b32 s70, s70, 3
  s_add_u32 s70, s70, 1000
  s_cmp_lt_u32 s3, 2
  s_cselect_b32 s70, 1000, s70
  s_cmp_eq_u32 s3, 3
  s_cselect_b32 s71, 8, 1000
  s_mov_b32 s53, 0
  s_lshl_b32 s38, s36, 6
  v_add_u32 v16, s38, v15
  v_lshrrev_b32 v17, 1, v15
  v_lshlrev_b32 v16, 7, v16
  v_xor_b32 v17, v14, v17
  v_lshl_add_u32 v4, v17, 4, v16
  v_xor_b32 v5, 64, v4
  v_add_u32 v6, 81920, v4
  v_add_u32 v7, 81920, v5
  v_bfe_u32 v17, v2, 2, 2
  v_and_b32 v18, 3, v2
  v_lshlrev_b32 v17, 6, v17
  v_lshl_add_u32 v17, v18, 3, v17
  v_and_b32 v18, 1, v14
  v_lshl_add_u32 v17, v18, 10, v17
  v_lshl_add_u32 v17, v18, 5, v17
  v_lshrrev_b32 v18, 1, v14
  v_mul_u32_u24 v18, 6144, v18
  v_add_u32 v17, v17, v18
  s_lshl_b32 s38, s37, 8
  s_add_u32 s38, s38, 16384
  v_add_u32 v8, s38, v17
  v_xor_b32 v9, 32, v8
  v_add_u32 v10, 81920, v8
  v_add_u32 v11, 81920, v9
  v_mov_b32 v96, 0
  v_mov_b32 v97, 0
  v_mov_b32 v98, 0
  v_mov_b32 v99, 0
  v_mov_b32 v100, 0
  v_mov_b32 v101, 0
  v_mov_b32 v102, 0
  v_mov_b32 v103, 0
  v_mov_b32 v104, 0
  v_mov_b32 v105, 0
  v_mov_b32 v106, 0
  v_mov_b32 v107, 0
  v_mov_b32 v108, 0
  v_mov_b32 v109, 0
  v_mov_b32 v110, 0
  v_mov_b32 v111, 0
  v_mov_b32 v112, 0
  v_mov_b32 v113, 0
  v_mov_b32 v114, 0
  v_mov_b32 v115, 0
  v_mov_b32 v116, 0
  v_mov_b32 v117, 0
  v_mov_b32 v118, 0
  v_mov_b32 v119, 0
  v_mov_b32 v120, 0
  v_mov_b32 v121, 0
  v_mov_b32 v122, 0
  v_mov_b32 v123, 0
  v_mov_b32 v124, 0
  v_mov_b32 v125, 0
  v_mov_b32 v126, 0
  v_mov_b32 v127, 0
  v_mov_b32 v128, 0
  v_mov_b32 v129, 0
  v_mov_b32 v130, 0
  v_mov_b32 v131, 0
  v_mov_b32 v132, 0
  v_mov_b32 v133, 0
  v_mov_b32 v134, 0
  v_mov_b32 v135, 0
  v_mov_b32 v136, 0
  v_mov_b32 v137, 0
  v_mov_b32 v138, 0
  v_mov_b32 v139, 0
  v_mov_b32 v140, 0
  v_mov_b32 v141, 0
  v_mov_b32 v142, 0
  v_mov_b32 v143, 0
  v_mov_b32 v144, 0
  v_mov_b32 v145, 0
  v_mov_b32 v146, 0
  v_mov_b32 v147, 0
  v_mov_b32 v148, 0
  v_mov_b32 v149, 0
  v_mov_b32 v150, 0
  v_mov_b32 v151, 0
  v_mov_b32 v152, 0
  v_mov_b32 v153, 0
  v_mov_b32 v154, 0
  v_mov_b32 v155, 0
  v_mov_b32 v156, 0
  v_mov_b32 v157, 0
  v_mov_b32 v158, 0
  v_mov_b32 v159, 0
  v_mov_b32 v160, 0
  v_mov_b32 v161, 0
  v_mov_b32 v162, 0
  v_mov_b32 v163, 0
  v_mov_b32 v164, 0
  v_mov_b32 v165, 0
  v_mov_b32 v166, 0
  v_mov_b32 v167, 0
  v_mov_b32 v168, 0
  v_mov_b32 v169, 0
  v_mov_b32 v170, 0
  v_mov_b32 v171, 0
  v_mov_b32 v172, 0
  v_mov_b32 v173, 0
  v_mov_b32 v174, 0
  v_mov_b32 v175, 0
  v_mov_b32 v176, 0
  v_mov_b32 v177, 0
  v_mov_b32 v178, 0
  v_mov_b32 v179, 0
  v_mov_b32 v180, 0
  v_mov_b32 v181, 0
  v_mov_b32 v182, 0
  v_mov_b32 v183, 0
  v_mov_b32 v184, 0
  v_mov_b32 v185, 0
  v_mov_b32 v186, 0
  v_mov_b32 v187, 0
  v_mov_b32 v188, 0
  v_mov_b32 v189, 0
  v_mov_b32 v190, 0
  v_mov_b32 v191, 0
  s_waitcnt lgkmcnt(0)
  s_add_u32 s28, s98, 8388608
  s_addc_u32 s29, s99, 0
  s_mov_b32 s30, 2097152
  s_mov_b32 s31, 0x20000
  s_add_u32 s32, s98, 12582912
  s_addc_u32 s33, s99, 0
  s_mov_b32 s34, 65536
  s_mov_b32 s35, 0x20000
  s_barrier
  ds_read_b128 v[16:19], v4 offset:0
  ds_read_b64_tr_b16 v[32:33], v8 offset:0
  ds_read_b64_tr_b16 v[34:35], v8 offset:512
  ds_read_b128 v[20:23], v4 offset:2048
  ds_read_b128 v[24:27], v4 offset:4096
  ds_read_b128 v[28:31], v4 offset:6144
  ds_read_b64_tr_b16 v[36:37], v9 offset:0
  ds_read_b64_tr_b16 v[38:39], v9 offset:512
  ds_read_b64_tr_b16 v[40:41], v8 offset:2048
  ds_read_b64_tr_b16 v[42:43], v8 offset:2560
  ds_read_b64_tr_b16 v[44:45], v9 offset:2048
  ds_read_b64_tr_b16 v[46:47], v9 offset:2560
  ds_read_b64_tr_b16 v[48:49], v8 offset:4096
  ds_read_b64_tr_b16 v[50:51], v8 offset:4608
  ds_read_b64_tr_b16 v[52:53], v9 offset:4096
  ds_read_b64_tr_b16 v[54:55], v9 offset:4608
  s_waitcnt lgkmcnt(0)
  s_mov_b32 s39, 4
K3_loop:
  v_mfma_f32_16x16x32_bf16 v[96:99], v[32:35], v[16:19], v[96:99]
  ds_read_b128 v[56:59], v5 offset:0
  v_mfma_f32_16x16x32_bf16 v[104:107], v[32:35], v[20:23], v[104:107]
  ds_read_b64_tr_b16 v[72:73], v8 offset:12288
  v_mfma_f32_16x16x32_bf16 v[112:115], v[32:35], v[24:27], v[112:115]
  ds_read_b64_tr_b16 v[74:75], v8 offset:12800
  v_mfma_f32_16x16x32_bf16 v[120:123], v[32:35], v[28:31], v[120:123]
  ds_read_b128 v[60:63], v5 offset:2048
  v_mfma_f32_16x16x32_bf16 v[100:103], v[36:39], v[16:19], v[100:103]
  ds_read_b128 v[64:67], v5 offset:4096
  v_mfma_f32_16x16x32_bf16 v[108:111], v[36:39], v[20:23], v[108:111]
  ds_read_b128 v[68:71], v5 offset:6144
  v_mfma_f32_16x16x32_bf16 v[116:119], v[36:39], v[24:27], v[116:119]
  ds_read_b64_tr_b16 v[76:77], v9 offset:12288
  v_mfma_f32_16x16x32_bf16 v[124:127], v[36:39], v[28:31], v[124:127]
  ds_read_b64_tr_b16 v[78:79], v9 offset:12800
  v_mfma_f32_16x16x32_bf16 v[128:131], v[16:19], v[40:43], v[128:131]
  ds_read_b64_tr_b16 v[80:81], v8 offset:14336
  v_mfma_f32_16x16x32_bf16 v[136:139], v[20:23], v[40:43], v[136:139]
  ds_read_b64_tr_b16 v[82:83], v8 offset:14848
  v_mfma_f32_16x16x32_bf16 v[144:147], v[24:27], v[40:43], v[144:147]
  ds_read_b64_tr_b16 v[84:85], v9 offset:14336
  v_mfma_f32_16x16x32_bf16 v[152:155], v[28:31], v[40:43], v[152:155]
  ds_read_b64_tr_b16 v[86:87], v9 offset:14848
  v_mfma_f32_16x16x32_bf16 v[132:135], v[16:19], v[44:47], v[132:135]
  ds_read_b64_tr_b16 v[88:89], v8 offset:16384
  v_mfma_f32_16x16x32_bf16 v[140:143], v[20:23], v[44:47], v[140:143]
  ds_read_b64_tr_b16 v[90:91], v8 offset:16896
  v_mfma_f32_16x16x32_bf16 v[148:151], v[24:27], v[44:47], v[148:151]
  ds_read_b64_tr_b16 v[92:93], v9 offset:16384
  v_mfma_f32_16x16x32_bf16 v[156:159], v[28:31], v[44:47], v[156:159]
  ds_read_b64_tr_b16 v[94:95], v9 offset:16896
  v_mfma_f32_16x16x32_bf16 v[160:163], v[16:19], v[48:51], v[160:163]
  v_mfma_f32_16x16x32_bf16 v[168:171], v[20:23], v[48:51], v[168:171]
  v_mfma_f32_16x16x32_bf16 v[176:179], v[24:27], v[48:51], v[176:179]
  v_mfma_f32_16x16x32_bf16 v[184:187], v[28:31], v[48:51], v[184:187]
  v_mfma_f32_16x16x32_bf16 v[164:167], v[16:19], v[52:55], v[164:167]
  v_mfma_f32_16x16x32_bf16 v[172:175], v[20:23], v[52:55], v[172:175]
  v_mfma_f32_16x16x32_bf16 v[180:183], v[24:27], v[52:55], v[180:183]
  v_mfma_f32_16x16x32_bf16 v[188:191], v[28:31], v[52:55], v[188:191]
  s_waitcnt lgkmcnt(0)
  s_barrier
  s_sub_u32 s55, s55, 1
  s_cbranch_scc1 K3_event0
K3_noev0:
  s_sub_u32 s70, s70, 1
  s_cbranch_scc1 K3_evB0
K3_noevB0:
  s_sub_u32 s71, s71, 1
  s_cbranch_scc1 K3_evC0
K3_noevC0:
  v_mfma_f32_16x16x32_bf16 v[96:99], v[72:75], v[56:59], v[96:99]
  ds_read_b128 v[16:19], v4 offset:40960
  v_mfma_f32_16x16x32_bf16 v[104:107], v[72:75], v[60:63], v[104:107]
  ds_read_b64_tr_b16 v[32:33], v8 offset:40960
  v_mfma_f32_16x16x32_bf16 v[112:115], v[72:75], v[64:67], v[112:115]
  ds_read_b64_tr_b16 v[34:35], v8 offset:41472
  v_mfma_f32_16x16x32_bf16 v[120:123], v[72:75], v[68:71], v[120:123]
  ds_read_b128 v[20:23], v4 offset:43008
  v_mfma_f32_16x16x32_bf16 v[100:103], v[76:79], v[56:59], v[100:103]
  ds_read_b128 v[24:27], v4 offset:45056
  v_mfma_f32_16x16x32_bf16 v[108:111], v[76:79], v[60:63], v[108:111]
  ds_read_b128 v[28:31], v4 offset:47104
  v_mfma_f32_16x16x32_bf16 v[116:119], v[76:79], v[64:67], v[116:119]
  ds_read_b64_tr_b16 v[36:37], v9 offset:40960
  v_mfma_f32_16x16x32_bf16 v[124:127], v[76:79], v[68:71], v[124:127]
  ds_read_b64_tr_b16 v[38:39], v9 offset:41472
  v_mfma_f32_16x16x32_bf16 v[128:131], v[56:59], v[80:83], v[128:131]
  ds_read_b64_tr_b16 v[40:41], v8 offset:43008
  v_mfma_f32_16x16x32_bf16 v[136:139], v[60:63], v[80:83], v[136:139]
  ds_read_b64_tr_b16 v[42:43], v8 offset:43520
  v_mfma_f32_16x16x32_bf16 v[144:147], v[64:67], v[80:83], v[144:147]
  ds_read_b64_tr_b16 v[44:45], v9 offset:43008
  v_mfma_f32_16x16x32_bf16 v[152:155], v[68:71], v[80:83], v[152:155]
  ds_read_b64_tr_b16 v[46:47], v9 offset:43520
  v_mfma_f32_16x16x32_bf16 v[132:135], v[56:59], v[84:87], v[132:135]
  ds_read_b64_tr_b16 v[48:49], v8 offset:45056
  v_mfma_f32_16x16x32_bf16 v[140:143], v[60:63], v[84:87], v[140:143]
  ds_read_b64_tr_b16 v[50:51], v8 offset:45568
  v_mfma_f32_16x16x32_bf16 v[148:151], v[64:67], v[84:87], v[148:151]
  ds_read_b64_tr_b16 v[52:53], v9 offset:45056
  v_mfma_f32_16x16x32_bf16 v[156:159], v[68:71], v[84:87], v[156:159]
  ds_read_b64_tr_b16 v[54:55], v9 offset:45568
  v_mfma_f32_16x16x32_bf16 v[160:163], v[56:59], v[88:91], v[160:163]
  v_mfma_f32_16x16x32_bf16 v[168:171], v[60:63], v[88:91], v[168:171]
  v_mfma_f32_16x16x32_bf16 v[176:179], v[64:67], v[88:91], v[176:179]
  v_mfma_f32_16x16x32_bf16 v[184:187], v[68:71], v[88:91], v[184:187]
  v_mfma_f32_16x16x32_bf16 v[164:167], v[56:59], v[92:95], v[164:167]
  v_mfma_f32_16x16x32_bf16 v[172:175], v[60:63], v[92:95], v[172:175]
  v_mfma_f32_16x16x32_bf16 v[180:183], v[64:67], v[92:95], v[180:183]
  v_mfma_f32_16x16x32_bf16 v[188:191], v[68:71], v[92:95], v[188:191]
  s_waitcnt lgkmcnt(13)
  v_mfma_f32_16x16x32_bf16 v[96:99], v[32:35], v[16:19], v[96:99]
  ds_read_b128 v[56:59], v5 offset:40960
  s_waitcnt lgkmcnt(13)
  v_mfma_f32_16x16x32_bf16 v[104:107], v[32:35], v[20:23], v[104:107]
  ds_read_b64_tr_b16 v[72:73], v8 offset:53248
  s_waitcnt lgkmcnt(13)
  v_mfma_f32_16x16x32_bf16 v[112:115], v[32:35], v[24:27], v[112:115]
  ds_read_b64_tr_b16 v[74:75], v8 offset:53760
  s_waitcnt lgkmcnt(13)
  v_mfma_f32_16x16x32_bf16 v[120:123], v[32:35], v[28:31], v[120:123]
  ds_read_b128 v[60:63], v5 offset:43008
  s_waitcnt lgkmcnt(12)
  v_mfma_f32_16x16x32_bf16 v[100:103], v[36:39], v[16:19], v[100:103]
  ds_read_b128 v[64:67], v5 offset:45056
  v_mfma_f32_16x16x32_bf16 v[108:111], v[36:39], v[20:23], v[108:111]
  ds_read_b128 v[68:71], v5 offset:47104
  v_mfma_f32_16x16x32_bf16 v[116:119], v[36:39], v[24:27], v[116:119]
  ds_read_b64_tr_b16 v[76:77], v9 offset:53248
  v_mfma_f32_16x16x32_bf16 v[124:127], v[36:39], v[28:31], v[124:127]
  ds_read_b64_tr_b16 v[78:79], v9 offset:53760
  s_waitcnt lgkmcnt(14)
  v_mfma_f32_16x16x32_bf16 v[128:131], v[16:19], v[40:43], v[128:131]
  ds_read_b64_tr_b16 v[80:81], v8 offset:55296
  v_mfma_f32_16x16x32_bf16 v[136:139], v[20:23], v[40:43], v[136:139]
  ds_read_b64_tr_b16 v[82:83], v8 offset:55808
  v_mfma_f32_16x16x32_bf16 v[144:147], v[24:27], v[40:43], v[144:147]
  ds_read_b64_tr_b16 v[84:85], v9 offset:55296
  v_mfma_f32_16x16x32_bf16 v[152:155], v[28:31], v[40:43], v[152:155]
  ds_read_b64_tr_b16 v[86:87], v9 offset:55808
  s_waitcnt lgkmcnt(15)
  v_mfma_f32_16x16x32_bf16 v[132:135], v[16:19], v[44:47], v[132:135]
  ds_read_b64_tr_b16 v[88:89], v8 offset:57344
  v_mfma_f32_16x16x32_bf16 v[140:143], v[20:23], v[44:47], v[140:143]
  ds_read_b64_tr_b16 v[90:91], v8 offset:57856
  v_mfma_f32_16x16x32_bf16 v[148:151], v[24:27], v[44:47], v[148:151]
  ds_read_b64_tr_b16 v[92:93], v9 offset:57344
  v_mfma_f32_16x16x32_bf16 v[156:159], v[28:31], v[44:47], v[156:159]
  ds_read_b64_tr_b16 v[94:95], v9 offset:57856
  s_waitcnt lgkmcnt(15)
  v_mfma_f32_16x16x32_bf16 v[160:163], v[16:19], v[48:51], v[160:163]
  v_mfma_f32_16x16x32_bf16 v[168:171], v[20:23], v[48:51], v[168:171]
  v_mfma_f32_16x16x32_bf16 v[176:179], v[24:27], v[48:51], v[176:179]
  v_mfma_f32_16x16x32_bf16 v[184:187], v[28:31], v[48:51], v[184:187]
  v_mfma_f32_16x16x32_bf16 v[164:167], v[16:19], v[52:55], v[164:167]
  v_mfma_f32_16x16x32_bf16 v[172:175], v[20:23], v[52:55], v[172:175]
  v_mfma_f32_16x16x32_bf16 v[180:183], v[24:27], v[52:55], v[180:183]
  v_mfma_f32_16x16x32_bf16 v[188:191], v[28:31], v[52:55], v[188:191]
  s_waitcnt lgkmcnt(0)
  s_barrier
  s_sub_u32 s55, s55, 1
  s_cbranch_scc1 K3_event1
K3_noev1:
  s_sub_u32 s70, s70, 1
  s_cbranch_scc1 K3_evB1
K3_noevB1:
  s_sub_u32 s71, s71, 1
  s_cbranch_scc1 K3_evC1
K3_noevC1:
  v_mfma_f32_16x16x32_bf16 v[96:99], v[72:75], v[56:59], v[96:99]
  ds_read_b128 v[16:19], v6 offset:0
  v_mfma_f32_16x16x32_bf16 v[104:107], v[72:75], v[60:63], v[104:107]
  ds_read_b64_tr_b16 v[32:33], v10 offset:0
  v_mfma_f32_16x16x32_bf16 v[112:115], v[72:75], v[64:67], v[112:115]
  ds_read_b64_tr_b16 v[34:35], v10 offset:512
  v_mfma_f32_16x16x32_bf16 v[120:123], v[72:75], v[68:71], v[120:123]
  ds_read_b128 v[20:23], v6 offset:2048
  v_mfma_f32_16x16x32_bf16 v[100:103], v[76:79], v[56:59], v[100:103]
  ds_read_b128 v[24:27], v6 offset:4096
  v_mfma_f32_16x16x32_bf16 v[108:111], v[76:79], v[60:63], v[108:111]
  ds_read_b128 v[28:31], v6 offset:6144
  v_mfma_f32_16x16x32_bf16 v[116:119], v[76:79], v[64:67], v[116:119]
  ds_read_b64_tr_b16 v[36:37], v11 offset:0
  v_mfma_f32_16x16x32_bf16 v[124:127], v[76:79], v[68:71], v[124:127]
  ds_read_b64_tr_b16 v[38:39], v11 offset:512
  v_mfma_f32_16x16x32_bf16 v[128:131], v[56:59], v[80:83], v[128:131]
  ds_read_b64_tr_b16 v[40:41], v10 offset:2048
  v_mfma_f32_16x16x32_bf16 v[136:139], v[60:63], v[80:83], v[136:139]
  ds_read_b64_tr_b16 v[42:43], v10 offset:2560
  v_mfma_f32_16x16x32_bf16 v[144:147], v[64:67], v[80:83], v[144:147]
  ds_read_b64_tr_b16 v[44:45], v11 offset:2048
  v_mfma_f32_16x16x32_bf16 v[152:155], v[68:71], v[80:83], v[152:155]
  ds_read_b64_tr_b16 v[46:47], v11 offset:2560
  v_mfma_f32_16x16x32_bf16 v[132:135], v[56:59], v[84:87], v[132:135]
  ds_read_b64_tr_b16 v[48:49], v10 offset:4096
  v_mfma_f32_16x16x32_bf16 v[140:143], v[60:63], v[84:87], v[140:143]
  ds_read_b64_tr_b16 v[50:51], v10 offset:4608
  v_mfma_f32_16x16x32_bf16 v[148:151], v[64:67], v[84:87], v[148:151]
  ds_read_b64_tr_b16 v[52:53], v11 offset:4096
  v_mfma_f32_16x16x32_bf16 v[156:159], v[68:71], v[84:87], v[156:159]
  ds_read_b64_tr_b16 v[54:55], v11 offset:4608
  v_mfma_f32_16x16x32_bf16 v[160:163], v[56:59], v[88:91], v[160:163]
  v_mfma_f32_16x16x32_bf16 v[168:171], v[60:63], v[88:91], v[168:171]
  v_mfma_f32_16x16x32_bf16 v[176:179], v[64:67], v[88:91], v[176:179]
  v_mfma_f32_16x16x32_bf16 v[184:187], v[68:71], v[88:91], v[184:187]
  v_mfma_f32_16x16x32_bf16 v[164:167], v[56:59], v[92:95], v[164:167]
  v_mfma_f32_16x16x32_bf16 v[172:175], v[60:63], v[92:95], v[172:175]
  v_mfma_f32_16x16x32_bf16 v[180:183], v[64:67], v[92:95], v[180:183]
  v_mfma_f32_16x16x32_bf16 v[188:191], v[68:71], v[92:95], v[188:191]
  s_waitcnt lgkmcnt(13)
  v_mfma_f32_16x16x32_bf16 v[96:99], v[32:35], v[16:19], v[96:99]
  ds_read_b128 v[56:59], v7 offset:0
  s_waitcnt lgkmcnt(13)
  v_mfma_f32_16x16x32_bf16 v[104:107], v[32:35], v[20:23], v[104:107]
  ds_read_b64_tr_b16 v[72:73], v10 offset:12288
  s_waitcnt lgkmcnt(13)
  v_mfma_f32_16x16x32_bf16 v[112:115], v[32:35], v[24:27], v[112:115]
  ds_read_b64_tr_b16 v[74:75], v10 offset:12800
  s_waitcnt lgkmcnt(13)
  v_mfma_f32_16x16x32_bf16 v[120:123], v[32:35], v[28:31], v[120:123]
  ds_read_b128 v[60:63], v7 offset:2048
  s_waitcnt lgkmcnt(12)
  v_mfma_f32_16x16x32_bf16 v[100:103], v[36:39], v[16:19], v[100:103]
  ds_read_b128 v[64:67], v7 offset:4096
  v_mfma_f32_16x16x32_bf16 v[108:111], v[36:39], v[20:23], v[108:111]
  ds_read_b128 v[68:71], v7 offset:6144
  v_mfma_f32_16x16x32_bf16 v[116:119], v[36:39], v[24:27], v[116:119]
  ds_read_b64_tr_b16 v[76:77], v11 offset:12288
  v_mfma_f32_16x16x32_bf16 v[124:127], v[36:39], v[28:31], v[124:127]
  ds_read_b64_tr_b16 v[78:79], v11 offset:12800
  s_waitcnt lgkmcnt(14)
  v_mfma_f32_16x16x32_bf16 v[128:131], v[16:19], v[40:43], v[128:131]
  ds_read_b64_tr_b16 v[80:81], v10 offset:14336
  v_mfma_f32_16x16x32_bf16 v[136:139], v[20:23], v[40:43], v[136:139]
  ds_read_b64_tr_b16 v[82:83], v10 offset:14848
  v_mfma_f32_16x16x32_bf16 v[144:147], v[24:27], v[40:43], v[144:147]
  ds_read_b64_tr_b16 v[84:85], v11 offset:14336
  v_mfma_f32_16x16x32_bf16 v[152:155], v[28:31], v[40:43], v[152:155]
  ds_read_b64_tr_b16 v[86:87], v11 offset:14848
  s_waitcnt lgkmcnt(15)
  v_mfma_f32_16x16x32_bf16 v[132:135], v[16:19], v[44:47], v[132:135]
  ds_read_b64_tr_b16 v[88:89], v10 offset:16384
  v_mfma_f32_16x16x32_bf16 v[140:143], v[20:23], v[44:47], v[140:143]
  ds_read_b64_tr_b16 v[90:91], v10 offset:16896
  v_mfma_f32_16x16x32_bf16 v[148:151], v[24:27], v[44:47], v[148:151]
  ds_read_b64_tr_b16 v[92:93], v11 offset:16384
  v_mfma_f32_16x16x32_bf16 v[156:159], v[28:31], v[44:47], v[156:159]
  ds_read_b64_tr_b16 v[94:95], v11 offset:16896
  s_waitcnt lgkmcnt(15)
  v_mfma_f32_16x16x32_bf16 v[160:163], v[16:19], v[48:51], v[160:163]
  v_mfma_f32_16x16x32_bf16 v[168:171], v[20:23], v[48:51], v[168:171]
  v_mfma_f32_16x16x32_bf16 v[176:179], v[24:27], v[48:51], v[176:179]
  v_mfma_f32_16x16x32_bf16 v[184:187], v[28:31], v[48:51], v[184:187]
  v_mfma_f32_16x16x32_bf16 v[164:167], v[16:19], v[52:55], v[164:167]
  v_mfma_f32_16x16x32_bf16 v[172:175], v[20:23], v[52:55], v[172:175]
  v_mfma_f32_16x16x32_bf16 v[180:183], v[24:27], v[52:55], v[180:183]
  v_mfma_f32_16x16x32_bf16 v[188:191], v[28:31], v[52:55], v[188:191]
  s_waitcnt lgkmcnt(0)
  s_barrier
  s_sub_u32 s55, s55, 1
  s_cbranch_scc1 K3_event2
K3_noev2:
  s_sub_u32 s70, s70, 1
  s_cbranch_scc1 K3_evB2
K3_noevB2:
  s_sub_u32 s71, s71, 1
  s_cbranch_scc1 K3_evC2
K3_noevC2:
  v_mfma_f32_16x16x32_bf16 v[96:99], v[72:75], v[56:59], v[96:99]
  ds_read_b128 v[16:19], v6 offset:40960
  v_mfma_f32_16x16x32_bf16 v[104:107], v[72:75], v[60:63], v[104:107]
  ds_read_b64_tr_b16 v[32:33], v10 offset:40960
  v_mfma_f32_16x16x32_bf16 v[112:115], v[72:75], v[64:67], v[112:115]
  ds_read_b64_tr_b16 v[34:35], v10 offset:41472
  v_mfma_f32_16x16x32_bf16 v[120:123], v[72:75], v[68:71], v[120:123]
  ds_read_b128 v[20:23], v6 offset:43008
  v_mfma_f32_16x16x32_bf16 v[100:103], v[76:79], v[56:59], v[100:103]
  ds_read_b128 v[24:27], v6 offset:45056
  v_mfma_f32_16x16x32_bf16 v[108:111], v[76:79], v[60:63], v[108:111]
  ds_read_b128 v[28:31], v6 offset:47104
  v_mfma_f32_16x16x32_bf16 v[116:119], v[76:79], v[64:67], v[116:119]
  ds_read_b64_tr_b16 v[36:37], v11 offset:40960
  v_mfma_f32_16x16x32_bf16 v[124:127], v[76:79], v[68:71], v[124:127]
  ds_read_b64_tr_b16 v[38:39], v11 offset:41472
  v_mfma_f32_16x16x32_bf16 v[128:131], v[56:59], v[80:83], v[128:131]
  ds_read_b64_tr_b16 v[40:41], v10 offset:43008
  v_mfma_f32_16x16x32_bf16 v[136:139], v[60:63], v[80:83], v[136:139]
  ds_read_b64_tr_b16 v[42:43], v10 offset:43520
  v_mfma_f32_16x16x32_bf16 v[144:147], v[64:67], v[80:83], v[144:147]
  ds_read_b64_tr_b16 v[44:45], v11 offset:43008
  v_mfma_f32_16x16x32_bf16 v[152:155], v[68:71], v[80:83], v[152:155]
  ds_read_b64_tr_b16 v[46:47], v11 offset:43520
  v_mfma_f32_16x16x32_bf16 v[132:135], v[56:59], v[84:87], v[132:135]
  ds_read_b64_tr_b16 v[48:49], v10 offset:45056
  v_mfma_f32_16x16x32_bf16 v[140:143], v[60:63], v[84:87], v[140:143]
  ds_read_b64_tr_b16 v[50:51], v10 offset:45568
  v_mfma_f32_16x16x32_bf16 v[148:151], v[64:67], v[84:87], v[148:151]
  ds_read_b64_tr_b16 v[52:53], v11 offset:45056
  v_mfma_f32_16x16x32_bf16 v[156:159], v[68:71], v[84:87], v[156:159]
  ds_read_b64_tr_b16 v[54:55], v11 offset:45568
  v_mfma_f32_16x16x32_bf16 v[160:163], v[56:59], v[88:91], v[160:163]
  v_mfma_f32_16x16x32_bf16 v[168:171], v[60:63], v[88:91], v[168:171]
  v_mfma_f32_16x16x32_bf16 v[176:179], v[64:67], v[88:91], v[176:179]
  v_mfma_f32_16x16x32_bf16 v[184:187], v[68:71], v[88:91], v[184:187]
  v_mfma_f32_16x16x32_bf16 v[164:167], v[56:59], v[92:95], v[164:167]
  v_mfma_f32_16x16x32_bf16 v[172:175], v[60:63], v[92:95], v[172:175]
  v_mfma_f32_16x16x32_bf16 v[180:183], v[64:67], v[92:95], v[180:183]
  v_mfma_f32_16x16x32_bf16 v[188:191], v[68:71], v[92:95], v[188:191]
  s_waitcnt lgkmcnt(13)
  v_mfma_f32_16x16x32_bf16 v[96:99], v[32:35], v[16:19], v[96:99]
  ds_read_b128 v[56:59], v7 offset:40960
  s_waitcnt lgkmcnt(13)
  v_mfma_f32_16x16x32_bf16 v[104:107], v[32:35], v[20:23], v[104:107]
  ds_read_b64_tr_b16 v[72:73], v10 offset:53248
  s_waitcnt lgkmcnt(13)
  v_mfma_f32_16x16x32_bf16 v[112:115], v[32:35], v[24:27], v[112:115]
  ds_read_b64_tr_b16 v[74:75], v10 offset:53760
  s_waitcnt lgkmcnt(13)
  v_mfma_f32_16x16x32_bf16 v[120:123], v[32:35], v[28:31], v[120:123]
  ds_read_b128 v[60:63], v7 offset:43008
  s_waitcnt lgkmcnt(12)
  v_mfma_f32_16x16x32_bf16 v[100:103], v[36:39], v[16:19], v[100:103]
  ds_read_b128 v[64:67], v7 offset:45056
  v_mfma_f32_16x16x32_bf16 v[108:111], v[36:39], v[20:23], v[108:111]
  ds_read_b128 v[68:71], v7 offset:47104
  v_mfma_f32_16x16x32_bf16 v[116:119], v[36:39], v[24:27], v[116:119]
  ds_read_b64_tr_b16 v[76:77], v11 offset:53248
  v_mfma_f32_16x16x32_bf16 v[124:127], v[36:39], v[28:31], v[124:127]
  ds_read_b64_tr_b16 v[78:79], v11 offset:53760
  s_waitcnt lgkmcnt(14)
  v_mfma_f32_16x16x32_bf16 v[128:131], v[16:19], v[40:43], v[128:131]
  ds_read_b64_tr_b16 v[80:81], v10 offset:55296
  v_mfma_f32_16x16x32_bf16 v[136:139], v[20:23], v[40:43], v[136:139]
  ds_read_b64_tr_b16 v[82:83], v10 offset:55808
  v_mfma_f32_16x16x32_bf16 v[144:147], v[24:27], v[40:43], v[144:147]
  ds_read_b64_tr_b16 v[84:85], v11 offset:55296
  v_mfma_f32_16x16x32_bf16 v[152:155], v[28:31], v[40:43], v[152:155]
  ds_read_b64_tr_b16 v[86:87], v11 offset:55808
  s_waitcnt lgkmcnt(15)
  v_mfma_f32_16x16x32_bf16 v[132:135], v[16:19], v[44:47], v[132:135]
  ds_read_b64_tr_b16 v[88:89], v10 offset:57344
  v_mfma_f32_16x16x32_bf16 v[140:143], v[20:23], v[44:47], v[140:143]
  ds_read_b64_tr_b16 v[90:91], v10 offset:57856
  v_mfma_f32_16x16x32_bf16 v[148:151], v[24:27], v[44:47], v[148:151]
  ds_read_b64_tr_b16 v[92:93], v11 offset:57344
  v_mfma_f32_16x16x32_bf16 v[156:159], v[28:31], v[44:47], v[156:159]
  ds_read_b64_tr_b16 v[94:95], v11 offset:57856
  s_waitcnt lgkmcnt(15)
  v_mfma_f32_16x16x32_bf16 v[160:163], v[16:19], v[48:51], v[160:163]
  v_mfma_f32_16x16x32_bf16 v[168:171], v[20:23], v[48:51], v[168:171]
  v_mfma_f32_16x16x32_bf16 v[176:179], v[24:27], v[48:51], v[176:179]
  v_mfma_f32_16x16x32_bf16 v[184:187], v[28:31], v[48:51], v[184:187]
  v_mfma_f32_16x16x32_bf16 v[164:167], v[16:19], v[52:55], v[164:167]
  v_mfma_f32_16x16x32_bf16 v[172:175], v[20:23], v[52:55], v[172:175]
  v_mfma_f32_16x16x32_bf16 v[180:183], v[24:27], v[52:55], v[180:183]
  v_mfma_f32_16x16x32_bf16 v[188:191], v[28:31], v[52:55], v[188:191]
  s_waitcnt lgkmcnt(0)
  s_barrier
  s_sub_u32 s55, s55, 1
  s_cbranch_scc1 K3_event3
K3_noev3:
  s_sub_u32 s70, s70, 1
  s_cbranch_scc1 K3_evB3
K3_noevB3:
  s_sub_u32 s71, s71, 1
  s_cbranch_scc1 K3_evC3
K3_noevC3:
  v_mfma_f32_16x16x32_bf16 v[96:99], v[72:75], v[56:59], v[96:99]
  ds_read_b128 v[16:19], v4 offset:0
  v_mfma_f32_16x16x32_bf16 v[104:107], v[72:75], v[60:63], v[104:107]
  ds_read_b64_tr_b16 v[32:33], v8 offset:0
  v_mfma_f32_16x16x32_bf16 v[112:115], v[72:75], v[64:67], v[112:115]
  ds_read_b64_tr_b16 v[34:35], v8 offset:512
  v_mfma_f32_16x16x32_bf16 v[120:123], v[72:75], v[68:71], v[120:123]
  ds_read_b128 v[20:23], v4 offset:2048
  v_mfma_f32_16x16x32_bf16 v[100:103], v[76:79], v[56:59], v[100:103]
  ds_read_b128 v[24:27], v4 offset:4096
  v_mfma_f32_16x16x32_bf16 v[108:111], v[76:79], v[60:63], v[108:111]
  ds_read_b128 v[28:31], v4 offset:6144
  v_mfma_f32_16x16x32_bf16 v[116:119], v[76:79], v[64:67], v[116:119]
  ds_read_b64_tr_b16 v[36:37], v9 offset:0
  v_mfma_f32_16x16x32_bf16 v[124:127], v[76:79], v[68:71], v[124:127]
  ds_read_b64_tr_b16 v[38:39], v9 offset:512
  v_mfma_f32_16x16x32_bf16 v[128:131], v[56:59], v[80:83], v[128:131]
  ds_read_b64_tr_b16 v[40:41], v8 offset:2048
  v_mfma_f32_16x16x32_bf16 v[136:139], v[60:63], v[80:83], v[136:139]
  ds_read_b64_tr_b16 v[42:43], v8 offset:2560
  v_mfma_f32_16x16x32_bf16 v[144:147], v[64:67], v[80:83], v[144:147]
  ds_read_b64_tr_b16 v[44:45], v9 offset:2048
  v_mfma_f32_16x16x32_bf16 v[152:155], v[68:71], v[80:83], v[152:155]
  ds_read_b64_tr_b16 v[46:47], v9 offset:2560
  v_mfma_f32_16x16x32_bf16 v[132:135], v[56:59], v[84:87], v[132:135]
  ds_read_b64_tr_b16 v[48:49], v8 offset:4096
  v_mfma_f32_16x16x32_bf16 v[140:143], v[60:63], v[84:87], v[140:143]
  ds_read_b64_tr_b16 v[50:51], v8 offset:4608
  v_mfma_f32_16x16x32_bf16 v[148:151], v[64:67], v[84:87], v[148:151]
  ds_read_b64_tr_b16 v[52:53], v9 offset:4096
  v_mfma_f32_16x16x32_bf16 v[156:159], v[68:71], v[84:87], v[156:159]
  ds_read_b64_tr_b16 v[54:55], v9 offset:4608
  v_mfma_f32_16x16x32_bf16 v[160:163], v[56:59], v[88:91], v[160:163]
  v_mfma_f32_16x16x32_bf16 v[168:171], v[60:63], v[88:91], v[168:171]
  v_mfma_f32_16x16x32_bf16 v[176:179], v[64:67], v[88:91], v[176:179]
  v_mfma_f32_16x16x32_bf16 v[184:187], v[68:71], v[88:91], v[184:187]
  v_mfma_f32_16x16x32_bf16 v[164:167], v[56:59], v[92:95], v[164:167]
  v_mfma_f32_16x16x32_bf16 v[172:175], v[60:63], v[92:95], v[172:175]
  v_mfma_f32_16x16x32_bf16 v[180:183], v[64:67], v[92:95], v[180:183]
  v_mfma_f32_16x16x32_bf16 v[188:191], v[68:71], v[92:95], v[188:191]
  s_sub_u32 s39, s39, 1
  s_cmp_lg_u32 s39, 0
  s_waitcnt lgkmcnt(0)
  s_cbranch_scc1 K3_loop
  s_mov_b32 s44, 1069066811
  s_mov_b32 s45, 1069066811
  s_mov_b32 s46, 897988541
  s_mov_b32 s47, 897988541
  v_mov_b32 v10, 39168
  v_mov_b32 v11, 1
  v_cvt_pk_bf16_f32 v16, v160, v161
  v_cvt_pk_bf16_f32 v17, v162, v163
  v_cvt_pk_bf16_f32 v18, v168, v169
  v_cvt_pk_bf16_f32 v19, v170, v171
  v_cvt_pk_bf16_f32 v20, v176, v177
  v_cvt_pk_bf16_f32 v21, v178, v179
  v_cvt_pk_bf16_f32 v22, v184, v185
  v_cvt_pk_bf16_f32 v23, v186, v187
  v_cvt_pk_bf16_f32 v24, v164, v165
  v_cvt_pk_bf16_f32 v25, v166, v167
  v_cvt_pk_bf16_f32 v26, v172, v173
  v_cvt_pk_bf16_f32 v27, v174, v175
  v_cvt_pk_bf16_f32 v28, v180, v181
  v_cvt_pk_bf16_f32 v29, v182, v183
  v_cvt_pk_bf16_f32 v30, v188, v189
  v_cvt_pk_bf16_f32 v31, v190, v191
  v_mov_b32 v48, 0x3f803f80
  v_mov_b32 v49, 0x3f803f80
  v_mov_b32 v50, 0x3f803f80
  v_mov_b32 v51, 0x3f803f80
  v_cvt_pk_bf16_f32 v52, v128, v129
  v_cvt_pk_bf16_f32 v53, v130, v131
  v_cvt_pk_bf16_f32 v54, v136, v137
  v_cvt_pk_bf16_f32 v55, v138, v139
  v_lshlrev_b32 v56, 16, v52
  v_and_b32 v57, 0xffff0000, v52
  v_lshlrev_b32 v58, 16, v53
  v_and_b32 v59, 0xffff0000, v53
  v_lshlrev_b32 v60, 16, v54
  v_and_b32 v61, 0xffff0000, v54
  v_lshlrev_b32 v62, 16, v55
  v_and_b32 v63, 0xffff0000, v55
  v_min_f32 v64, 0, v56
  v_min_f32 v65, 0, v57
  v_min_f32 v66, 0, v58
  v_min_f32 v67, 0, v59
  v_min_f32 v68, 0, v60
  v_min_f32 v69, 0, v61
  v_min_f32 v70, 0, v62
  v_min_f32 v71, 0, v63
  v_pk_mul_f32 v[72:73], v[64:65], s[44:45]
  v_pk_mul_f32 v[74:75], v[66:67], s[44:45]
  v_pk_mul_f32 v[76:77], v[68:69], s[44:45]
  v_pk_mul_f32 v[78:79], v[70:71], s[44:45]
  v_exp_f32 v72, v72
  v_exp_f32 v73, v73
  v_exp_f32 v74, v74
  v_exp_f32 v75, v75
  v_exp_f32 v76, v76
  v_exp_f32 v77, v77
  v_exp_f32 v78, v78
  v_exp_f32 v79, v79
  v_pk_add_f32 v[56:57], v[56:57], v[64:65] neg_lo:[0,1] neg_hi:[0,1]
  v_pk_add_f32 v[58:59], v[58:59], v[66:67] neg_lo:[0,1] neg_hi:[0,1]
  v_pk_add_f32 v[60:61], v[60:61], v[68:69] neg_lo:[0,1] neg_hi:[0,1]
  v_pk_add_f32 v[62:63], v[62:63], v[70:71] neg_lo:[0,1] neg_hi:[0,1]
  v_pk_add_f32 v[56:57], v[56:57], v[72:73]
  v_pk_add_f32 v[58:59], v[58:59], v[74:75]
  v_pk_add_f32 v[60:61], v[60:61], v[76:77]
  v_pk_add_f32 v[62:63], v[62:63], v[78:79]
  v_pk_add_f32 v[56:57], v[56:57], s[46:47]
  v_pk_add_f32 v[58:59], v[58:59], s[46:47]
  v_pk_add_f32 v[60:61], v[60:61], s[46:47]
  v_pk_add_f32 v[62:63], v[62:63], s[46:47]
  v_cvt_pk_bf16_f32 v32, v56, v57
  v_cvt_pk_bf16_f32 v33, v58, v59
  v_cvt_pk_bf16_f32 v34, v60, v61
  v_cvt_pk_bf16_f32 v35, v62, v63
  s_nop 1
  v_mfma_f32_16x16x32_bf16 v[160:163], v[32:35], v[16:19], 0
  v_mfma_f32_16x16x32_bf16 v[168:171], v[32:35], v[24:27], 0
  v_mfma_f32_16x16x32_bf16 v[176:179], v[32:35], v[48:51], 0
  v_cvt_pk_bf16_f32 v52, v132, v133
  v_cvt_pk_bf16_f32 v53, v134, v135
  v_cvt_pk_bf16_f32 v54, v140, v141
  v_cvt_pk_bf16_f32 v55, v142, v143
  v_lshlrev_b32 v56, 16, v52
  v_and_b32 v57, 0xffff0000, v52
  v_lshlrev_b32 v58, 16, v53
  v_and_b32 v59, 0xffff0000, v53
  v_lshlrev_b32 v60, 16, v54
  v_and_b32 v61, 0xffff0000, v54
  v_lshlrev_b32 v62, 16, v55
  v_and_b32 v63, 0xffff0000, v55
  v_min_f32 v64, 0, v56
  v_min_f32 v65, 0, v57
  v_min_f32 v66, 0, v58
  v_min_f32 v67, 0, v59
  v_min_f32 v68, 0, v60
  v_min_f32 v69, 0, v61
  v_min_f32 v70, 0, v62
  v_min_f32 v71, 0, v63
  v_pk_mul_f32 v[72:73], v[64:65], s[44:45]
  v_pk_mul_f32 v[74:75], v[66:67], s[44:45]
  v_pk_mul_f32 v[76:77], v[68:69], s[44:45]
  v_pk_mul_f32 v[78:79], v[70:71], s[44:45]
  v_exp_f32 v72, v72
  v_exp_f32 v73, v73
  v_exp_f32 v74, v74
  v_exp_f32 v75, v75
  v_exp_f32 v76, v76
  v_exp_f32 v77, v77
  v_exp_f32 v78, v78
  v_exp_f32 v79, v79
  v_pk_add_f32 v[56:57], v[56:57], v[64:65] neg_lo:[0,1] neg_hi:[0,1]
  v_pk_add_f32 v[58:59], v[58:59], v[66:67] neg_lo:[0,1] neg_hi:[0,1]
  v_pk_add_f32 v[60:61], v[60:61], v[68:69] neg_lo:[0,1] neg_hi:[0,1]
  v_pk_add_f32 v[62:63], v[62:63], v[70:71] neg_lo:[0,1] neg_hi:[0,1]
  v_pk_add_f32 v[56:57], v[56:57], v[72:73]
  v_pk_add_f32 v[58:59], v[58:59], v[74:75]
  v_pk_add_f32 v[60:61], v[60:61], v[76:77]
  v_pk_add_f32 v[62:63], v[62:63], v[78:79]
  v_pk_add_f32 v[56:57], v[56:57], s[46:47]
  v_pk_add_f32 v[58:59], v[58:59], s[46:47]
  v_pk_add_f32 v[60:61], v[60:61], s[46:47]
  v_pk_add_f32 v[62:63], v[62:63], s[46:47]
  v_cvt_pk_bf16_f32 v40, v56, v57
  v_cvt_pk_bf16_f32 v41, v58, v59
  v_cvt_pk_bf16_f32 v42, v60, v61
  v_cvt_pk_bf16_f32 v43, v62, v63
  s_nop 1
  v_mfma_f32_16x16x32_bf16 v[164:167], v[40:43], v[16:19], 0
  v_mfma_f32_16x16x32_bf16 v[172:175], v[40:43], v[24:27], 0
  v_mfma_f32_16x16x32_bf16 v[180:183], v[40:43], v[48:51], 0
  v_cvt_pk_bf16_f32 v52, v144, v145
  v_cvt_pk_bf16_f32 v53, v146, v147
  v_cvt_pk_bf16_f32 v54, v152, v153
  v_cvt_pk_bf16_f32 v55, v154, v155
  v_lshlrev_b32 v56, 16, v52
  v_and_b32 v57, 0xffff0000, v52
  v_lshlrev_b32 v58, 16, v53
  v_and_b32 v59, 0xffff0000, v53
  v_lshlrev_b32 v60, 16, v54
  v_and_b32 v61, 0xffff0000, v54
  v_lshlrev_b32 v62, 16, v55
  v_and_b32 v63, 0xffff0000, v55
  v_min_f32 v64, 0, v56
  v_min_f32 v65, 0, v57
  v_min_f32 v66, 0, v58
  v_min_f32 v67, 0, v59
  v_min_f32 v68, 0, v60
  v_min_f32 v69, 0, v61
  v_min_f32 v70, 0, v62
  v_min_f32 v71, 0, v63
  v_pk_mul_f32 v[72:73], v[64:65], s[44:45]
  v_pk_mul_f32 v[74:75], v[66:67], s[44:45]
  v_pk_mul_f32 v[76:77], v[68:69], s[44:45]
  v_pk_mul_f32 v[78:79], v[70:71], s[44:45]
  v_exp_f32 v72, v72
  v_exp_f32 v73, v73
  v_exp_f32 v74, v74
  v_exp_f32 v75, v75
  v_exp_f32 v76, v76
  v_exp_f32 v77, v77
  v_exp_f32 v78, v78
  v_exp_f32 v79, v79
  v_pk_add_f32 v[56:57], v[56:57], v[64:65] neg_lo:[0,1] neg_hi:[0,1]
  v_pk_add_f32 v[58:59], v[58:59], v[66:67] neg_lo:[0,1] neg_hi:[0,1]
  v_pk_add_f32 v[60:61], v[60:61], v[68:69] neg_lo:[0,1] neg_hi:[0,1]
  v_pk_add_f32 v[62:63], v[62:63], v[70:71] neg_lo:[0,1] neg_hi:[0,1]
  v_pk_add_f32 v[56:57], v[56:57], v[72:73]
  v_pk_add_f32 v[58:59], v[58:59], v[74:75]
  v_pk_add_f32 v[60:61], v[60:61], v[76:77]
  v_pk_add_f32 v[62:63], v[62:63], v[78:79]
  v_pk_add_f32 v[56:57], v[56:57], s[46:47]
  v_pk_add_f32 v[58:59], v[58:59], s[46:47]
  v_pk_add_f32 v[60:61], v[60:61], s[46:47]
  v_pk_add_f32 v[62:63], v[62:63], s[46:47]
  v_cvt_pk_bf16_f32 v36, v56, v57
  v_cvt_pk_bf16_f32 v37, v58, v59
  v_cvt_pk_bf16_f32 v38, v60, v61
  v_cvt_pk_bf16_f32 v39, v62, v63
  s_nop 1
  v_mfma_f32_16x16x32_bf16 v[160:163], v[36:39], v[20:23], v[160:163]
  v_mfma_f32_16x16x32_bf16 v[168:171], v[36:39], v[28:31], v[168:171]
  v_mfma_f32_16x16x32_bf16 v[176:179], v[36:39], v[48:51], v[176:179]
  v_cvt_pk_bf16_f32 v52, v148, v149
  v_cvt_pk_bf16_f32 v53, v150, v151
  v_cvt_pk_bf16_f32 v54, v156, v157
  v_cvt_pk_bf16_f32 v55, v158, v159
  v_lshlrev_b32 v56, 16, v52
  v_and_b32 v57, 0xffff0000, v52
  v_lshlrev_b32 v58, 16, v53
  v_and_b32 v59, 0xffff0000, v53
  v_lshlrev_b32 v60, 16, v54
  v_and_b32 v61, 0xffff0000, v54
  v_lshlrev_b32 v62, 16, v55
  v_and_b32 v63, 0xffff0000, v55
  v_min_f32 v64, 0, v56
  v_min_f32 v65, 0, v57
  v_min_f32 v66, 0, v58
  v_min_f32 v67, 0, v59
  v_min_f32 v68, 0, v60
  v_min_f32 v69, 0, v61
  v_min_f32 v70, 0, v62
  v_min_f32 v71, 0, v63
  v_pk_mul_f32 v[72:73], v[64:65], s[44:45]
  v_pk_mul_f32 v[74:75], v[66:67], s[44:45]
  v_pk_mul_f32 v[76:77], v[68:69], s[44:45]
  v_pk_mul_f32 v[78:79], v[70:71], s[44:45]
  v_exp_f32 v72, v72
  v_exp_f32 v73, v73
  v_exp_f32 v74, v74
  v_exp_f32 v75, v75
  v_exp_f32 v76, v76
  v_exp_f32 v77, v77
  v_exp_f32 v78, v78
  v_exp_f32 v79, v79
  v_pk_add_f32 v[56:57], v[56:57], v[64:65] neg_lo:[0,1] neg_hi:[0,1]
  v_pk_add_f32 v[58:59], v[58:59], v[66:67] neg_lo:[0,1] neg_hi:[0,1]
  v_pk_add_f32 v[60:61], v[60:61], v[68:69] neg_lo:[0,1] neg_hi:[0,1]
  v_pk_add_f32 v[62:63], v[62:63], v[70:71] neg_lo:[0,1] neg_hi:[0,1]
  v_pk_add_f32 v[56:57], v[56:57], v[72:73]
  v_pk_add_f32 v[58:59], v[58:59], v[74:75]
  v_pk_add_f32 v[60:61], v[60:61], v[76:77]
  v_pk_add_f32 v[62:63], v[62:63], v[78:79]
  v_pk_add_f32 v[56:57], v[56:57], s[46:47]
  v_pk_add_f32 v[58:59], v[58:59], s[46:47]
  v_pk_add_f32 v[60:61], v[60:61], s[46:47]
  v_pk_add_f32 v[62:63], v[62:63], s[46:47]
  v_cvt_pk_bf16_f32 v44, v56, v57
  v_cvt_pk_bf16_f32 v45, v58, v59
  v_cvt_pk_bf16_f32 v46, v60, v61
  v_cvt_pk_bf16_f32 v47, v62, v63
  s_nop 1
  v_mfma_f32_16x16x32_bf16 v[164:167], v[44:47], v[20:23], v[164:167]
  v_mfma_f32_16x16x32_bf16 v[172:175], v[44:47], v[28:31], v[172:175]
  v_mfma_f32_16x16x32_bf16 v[180:183], v[44:47], v[48:51], v[180:183]
  s_lshl_b32 s43, s37, 12
  s_add_u32 s43, s43, 155648
  v_add_u32 v4, s43, v3
  s_lshl_b32 s43, s37, 7
  s_add_u32 s43, s43, 39424
  v_lshlrev_b32 v5, 5, v14
  v_add_u32 v5, s43, v5
  s_lshl_b32 s43, s37, 2
  v_add_u32 v6, s43, v10
  s_cmp_eq_u32 s36, 0
  s_cbranch_scc1 K3_wr0
  ds_write_b128 v4, v[160:163] offset:0
  ds_write_b128 v4, v[164:167] offset:1024
  ds_write_b128 v4, v[168:171] offset:2048
  ds_write_b128 v4, v[172:175] offset:3072
  ds_write_b128 v5, v[176:179] offset:0
  ds_write_b128 v5, v[180:183] offset:16
  s_waitcnt lgkmcnt(0)
  s_mov_b64 exec, 1
  ds_add_u32 v6, v11 offset:0
  s_mov_b64 exec, -1
  s_branch K3_q
K3_wr0:
  s_lshl_b32 s48, s5, 4
  s_add_u32 s48, s48, s12
  s_lshl_b32 s49, s48, 12
  s_lshl_b32 s50, s48, 7
  v_lshlrev_b32 v7, 4, v14
  s_mov_b32 s43, 131072
K3_wx:
  ds_read_b32 v8, v6 offset:0
  s_waitcnt lgkmcnt(0)
  v_readfirstlane_b32 s42, v8
  s_sub_u32 s43, s43, 1
  s_cbranch_scc1 K3_wx_ok
  s_cmp_lt_u32 s42, 1
  s_cbranch_scc1 K3_wx
K3_wx_ok:
  ds_read_b128 v[16:19], v4 offset:0
  ds_read_b128 v[20:23], v4 offset:1024
  ds_read_b128 v[24:27], v4 offset:2048
  ds_read_b128 v[28:31], v4 offset:3072
  ds_read_b128 v[32:35], v5 offset:0
  ds_read_b128 v[36:39], v5 offset:16
  s_waitcnt lgkmcnt(5)
  v_pk_add_f32 v[160:161], v[160:161], v[16:17]
  v_pk_add_f32 v[162:163], v[162:163], v[18:19]
  v_or_b32 v160, 1, v160
  v_or_b32 v161, 1, v161
  v_or_b32 v162, 1, v162
  v_or_b32 v163, 1, v163
  buffer_store_dwordx4 v[160:163], v3, s[28:31], s49 offen offset:0 sc1
  s_waitcnt lgkmcnt(4)
  v_pk_add_f32 v[164:165], v[164:165], v[20:21]
  v_pk_add_f32 v[166:167], v[166:167], v[22:23]
  v_or_b32 v164, 1, v164
  v_or_b32 v165, 1, v165
  v_or_b32 v166, 1, v166
  v_or_b32 v167, 1, v167
  buffer_store_dwordx4 v[164:167], v3, s[28:31], s49 offen offset:1024 sc1
  s_waitcnt lgkmcnt(3)
  v_pk_add_f32 v[168:169], v[168:169], v[24:25]
  v_pk_add_f32 v[170:171], v[170:171], v[26:27]
  v_or_b32 v168, 1, v168
  v_or_b32 v169, 1, v169
  v_or_b32 v170, 1, v170
  v_or_b32 v171, 1, v171
  buffer_store_dwordx4 v[168:171], v3, s[28:31], s49 offen offset:2048 sc1
  s_waitcnt lgkmcnt(2)
  v_pk_add_f32 v[172:173], v[172:173], v[28:29]
  v_pk_add_f32 v[174:175], v[174:175], v[30:31]
  v_or_b32 v172, 1, v172
  v_or_b32 v173, 1, v173
  v_or_b32 v174, 1, v174
  v_or_b32 v175, 1, v175
  buffer_store_dwordx4 v[172:175], v3, s[28:31], s49 offen offset:3072 sc1
  s_waitcnt lgkmcnt(1)
  v_pk_add_f32 v[176:177], v[176:177], v[32:33]
  v_pk_add_f32 v[178:179], v[178:179], v[34:35]
  v_or_b32 v176, 1, v176
  v_or_b32 v177, 1, v177
  v_or_b32 v178, 1, v178
  v_or_b32 v179, 1, v179
  s_waitcnt lgkmcnt(0)
  v_pk_add_f32 v[180:181], v[180:181], v[36:37]
  v_pk_add_f32 v[182:183], v[182:183], v[38:39]
  v_or_b32 v180, 1, v180
  v_or_b32 v181, 1, v181
  v_or_b32 v182, 1, v182
  v_or_b32 v183, 1, v183
  s_mov_b32 exec_lo, 0x00010001
  s_mov_b32 exec_hi, 0x00010001
  buffer_store_dwordx4 v[176:179], v7, s[32:35], s50 offen offset:0 sc1
  buffer_store_dwordx4 v[180:183], v7, s[32:35], s50 offen offset:64 sc1
  s_mov_b64 exec, -1
  s_mov_b64 exec, 1
  ds_add_u32 v10, v11 offset:84
  s_mov_b64 exec, -1
K3_q:
  s_lshl_b32 s43, s3, 12
  s_add_u32 s43, s43, 139264
  v_add_u32 v4, s43, v3
  v_cvt_pk_bf16_f32 v52, v96, v97
  v_cvt_pk_bf16_f32 v53, v98, v99
  v_cvt_pk_bf16_f32 v54, v100, v101
  v_cvt_pk_bf16_f32 v55, v102, v103
  v_lshlrev_b32 v56, 16, v52
  v_and_b32 v57, 0xffff0000, v52
  v_lshlrev_b32 v58, 16, v53
  v_and_b32 v59, 0xffff0000, v53
  v_lshlrev_b32 v60, 16, v54
  v_and_b32 v61, 0xffff0000, v54
  v_lshlrev_b32 v62, 16, v55
  v_and_b32 v63, 0xffff0000, v55
  v_min_f32 v64, 0, v56
  v_min_f32 v65, 0, v57
  v_min_f32 v66, 0, v58
  v_min_f32 v67, 0, v59
  v_min_f32 v68, 0, v60
  v_min_f32 v69, 0, v61
  v_min_f32 v70, 0, v62
  v_min_f32 v71, 0, v63
  v_pk_mul_f32 v[72:73], v[64:65], s[44:45]
  v_pk_mul_f32 v[74:75], v[66:67], s[44:45]
  v_pk_mul_f32 v[76:77], v[68:69], s[44:45]
  v_pk_mul_f32 v[78:79], v[70:71], s[44:45]
  v_exp_f32 v72, v72
  v_exp_f32 v73, v73
  v_exp_f32 v74, v74
  v_exp_f32 v75, v75
  v_exp_f32 v76, v76
  v_exp_f32 v77, v77
  v_exp_f32 v78, v78
  v_exp_f32 v79, v79
  v_pk_add_f32 v[56:57], v[56:57], v[64:65] neg_lo:[0,1] neg_hi:[0,1]
  v_pk_add_f32 v[58:59], v[58:59], v[66:67] neg_lo:[0,1] neg_hi:[0,1]
  v_pk_add_f32 v[60:61], v[60:61], v[68:69] neg_lo:[0,1] neg_hi:[0,1]
  v_pk_add_f32 v[62:63], v[62:63], v[70:71] neg_lo:[0,1] neg_hi:[0,1]
  v_pk_add_f32 v[56:57], v[56:57], v[72:73]
  v_pk_add_f32 v[58:59], v[58:59], v[74:75]
  v_pk_add_f32 v[60:61], v[60:61], v[76:77]
  v_pk_add_f32 v[62:63], v[62:63], v[78:79]
  v_pk_add_f32 v[56:57], v[56:57], s[46:47]
  v_pk_add_f32 v[58:59], v[58:59], s[46:47]
  v_pk_add_f32 v[60:61], v[60:61], s[46:47]
  v_pk_add_f32 v[62:63], v[62:63], s[46:47]
  v_cvt_pk_bf16_f32 v80, v56, v57
  v_cvt_pk_bf16_f32 v81, v58, v59
  v_cvt_pk_bf16_f32 v82, v60, v61
  v_cvt_pk_bf16_f32 v83, v62, v63
  ds_write_b128 v4, v[80:83] offset:0
  v_cvt_pk_bf16_f32 v52, v104, v105
  v_cvt_pk_bf16_f32 v53, v106, v107
  v_cvt_pk_bf16_f32 v54, v108, v109
  v_cvt_pk_bf16_f32 v55, v110, v111
  v_lshlrev_b32 v56, 16, v52
  v_and_b32 v57, 0xffff0000, v52
  v_lshlrev_b32 v58, 16, v53
  v_and_b32 v59, 0xffff0000, v53
  v_lshlrev_b32 v60, 16, v54
  v_and_b32 v61, 0xffff0000, v54
  v_lshlrev_b32 v62, 16, v55
  v_and_b32 v63, 0xffff0000, v55
  v_min_f32 v64, 0, v56
  v_min_f32 v65, 0, v57
  v_min_f32 v66, 0, v58
  v_min_f32 v67, 0, v59
  v_min_f32 v68, 0, v60
  v_min_f32 v69, 0, v61
  v_min_f32 v70, 0, v62
  v_min_f32 v71, 0, v63
  v_pk_mul_f32 v[72:73], v[64:65], s[44:45]
  v_pk_mul_f32 v[74:75], v[66:67], s[44:45]
  v_pk_mul_f32 v[76:77], v[68:69], s[44:45]
  v_pk_mul_f32 v[78:79], v[70:71], s[44:45]
  v_exp_f32 v72, v72
  v_exp_f32 v73, v73
  v_exp_f32 v74, v74
  v_exp_f32 v75, v75
  v_exp_f32 v76, v76
  v_exp_f32 v77, v77
  v_exp_f32 v78, v78
  v_exp_f32 v79, v79
  v_pk_add_f32 v[56:57], v[56:57], v[64:65] neg_lo:[0,1] neg_hi:[0,1]
  v_pk_add_f32 v[58:59], v[58:59], v[66:67] neg_lo:[0,1] neg_hi:[0,1]
  v_pk_add_f32 v[60:61], v[60:61], v[68:69] neg_lo:[0,1] neg_hi:[0,1]
  v_pk_add_f32 v[62:63], v[62:63], v[70:71] neg_lo:[0,1] neg_hi:[0,1]
  v_pk_add_f32 v[56:57], v[56:57], v[72:73]
  v_pk_add_f32 v[58:59], v[58:59], v[74:75]
  v_pk_add_f32 v[60:61], v[60:61], v[76:77]
  v_pk_add_f32 v[62:63], v[62:63], v[78:79]
  v_pk_add_f32 v[56:57], v[56:57], s[46:47]
  v_pk_add_f32 v[58:59], v[58:59], s[46:47]
  v_pk_add_f32 v[60:61], v[60:61], s[46:47]
  v_pk_add_f32 v[62:63], v[62:63], s[46:47]
  v_cvt_pk_bf16_f32 v84, v56, v57
  v_cvt_pk_bf16_f32 v85, v58, v59
  v_cvt_pk_bf16_f32 v86, v60, v61
  v_cvt_pk_bf16_f32 v87, v62, v63
  ds_write_b128 v4, v[84:87] offset:1024
  v_cvt_pk_bf16_f32 v52, v112, v113
  v_cvt_pk_bf16_f32 v53, v114, v115
  v_cvt_pk_bf16_f32 v54, v116, v117
  v_cvt_pk_bf16_f32 v55, v118, v119
  v_lshlrev_b32 v56, 16, v52
  v_and_b32 v57, 0xffff0000, v52
  v_lshlrev_b32 v58, 16, v53
  v_and_b32 v59, 0xffff0000, v53
  v_lshlrev_b32 v60, 16, v54
  v_and_b32 v61, 0xffff0000, v54
  v_lshlrev_b32 v62, 16, v55
  v_and_b32 v63, 0xffff0000, v55
  v_min_f32 v64, 0, v56
  v_min_f32 v65, 0, v57
  v_min_f32 v66, 0, v58
  v_min_f32 v67, 0, v59
  v_min_f32 v68, 0, v60
  v_min_f32 v69, 0, v61
  v_min_f32 v70, 0, v62
  v_min_f32 v71, 0, v63
  v_pk_mul_f32 v[72:73], v[64:65], s[44:45]
  v_pk_mul_f32 v[74:75], v[66:67], s[44:45]
  v_pk_mul_f32 v[76:77], v[68:69], s[44:45]
  v_pk_mul_f32 v[78:79], v[70:71], s[44:45]
  v_exp_f32 v72, v72
  v_exp_f32 v73, v73
  v_exp_f32 v74, v74
  v_exp_f32 v75, v75
  v_exp_f32 v76, v76
  v_exp_f32 v77, v77
  v_exp_f32 v78, v78
  v_exp_f32 v79, v79
  v_pk_add_f32 v[56:57], v[56:57], v[64:65] neg_lo:[0,1] neg_hi:[0,1]
  v_pk_add_f32 v[58:59], v[58:59], v[66:67] neg_lo:[0,1] neg_hi:[0,1]
  v_pk_add_f32 v[60:61], v[60:61], v[68:69] neg_lo:[0,1] neg_hi:[0,1]
  v_pk_add_f32 v[62:63], v[62:63], v[70:71] neg_lo:[0,1] neg_hi:[0,1]
  v_pk_add_f32 v[56:57], v[56:57], v[72:73]
  v_pk_add_f32 v[58:59], v[58:59], v[74:75]
  v_pk_add_f32 v[60:61], v[60:61], v[76:77]
  v_pk_add_f32 v[62:63], v[62:63], v[78:79]
  v_pk_add_f32 v[56:57], v[56:57], s[46:47]
  v_pk_add_f32 v[58:59], v[58:59], s[46:47]
  v_pk_add_f32 v[60:61], v[60:61], s[46:47]
  v_pk_add_f32 v[62:63], v[62:63], s[46:47]
  v_cvt_pk_bf16_f32 v88, v56, v57
  v_cvt_pk_bf16_f32 v89, v58, v59
  v_cvt_pk_bf16_f32 v90, v60, v61
  v_cvt_pk_bf16_f32 v91, v62, v63
  ds_write_b128 v4, v[88:91] offset:2048
  v_cvt_pk_bf16_f32 v52, v120, v121
  v_cvt_pk_bf16_f32 v53, v122, v123
  v_cvt_pk_bf16_f32 v54, v124, v125
  v_cvt_pk_bf16_f32 v55, v126, v127
  v_lshlrev_b32 v56, 16, v52
  v_and_b32 v57, 0xffff0000, v52
  v_lshlrev_b32 v58, 16, v53
  v_and_b32 v59, 0xffff0000, v53
  v_lshlrev_b32 v60, 16, v54
  v_and_b32 v61, 0xffff0000, v54
  v_lshlrev_b32 v62, 16, v55
  v_and_b32 v63, 0xffff0000, v55
  v_min_f32 v64, 0, v56
  v_min_f32 v65, 0, v57
  v_min_f32 v66, 0, v58
  v_min_f32 v67, 0, v59
  v_min_f32 v68, 0, v60
  v_min_f32 v69, 0, v61
  v_min_f32 v70, 0, v62
  v_min_f32 v71, 0, v63
  v_pk_mul_f32 v[72:73], v[64:65], s[44:45]
  v_pk_mul_f32 v[74:75], v[66:67], s[44:45]
  v_pk_mul_f32 v[76:77], v[68:69], s[44:45]
  v_pk_mul_f32 v[78:79], v[70:71], s[44:45]
  v_exp_f32 v72, v72
  v_exp_f32 v73, v73
  v_exp_f32 v74, v74
  v_exp_f32 v75, v75
  v_exp_f32 v76, v76
  v_exp_f32 v77, v77
  v_exp_f32 v78, v78
  v_exp_f32 v79, v79
  v_pk_add_f32 v[56:57], v[56:57], v[64:65] neg_lo:[0,1] neg_hi:[0,1]
  v_pk_add_f32 v[58:59], v[58:59], v[66:67] neg_lo:[0,1] neg_hi:[0,1]
  v_pk_add_f32 v[60:61], v[60:61], v[68:69] neg_lo:[0,1] neg_hi:[0,1]
  v_pk_add_f32 v[62:63], v[62:63], v[70:71] neg_lo:[0,1] neg_hi:[0,1]
  v_pk_add_f32 v[56:57], v[56:57], v[72:73]
  v_pk_add_f32 v[58:59], v[58:59], v[74:75]
  v_pk_add_f32 v[60:61], v[60:61], v[76:77]
  v_pk_add_f32 v[62:63], v[62:63], v[78:79]
  v_pk_add_f32 v[56:57], v[56:57], s[46:47]
  v_pk_add_f32 v[58:59], v[58:59], s[46:47]
  v_pk_add_f32 v[60:61], v[60:61], s[46:47]
  v_pk_add_f32 v[62:63], v[62:63], s[46:47]
  v_cvt_pk_bf16_f32 v92, v56, v57
  v_cvt_pk_bf16_f32 v93, v58, v59
  v_cvt_pk_bf16_f32 v94, v60, v61
  v_cvt_pk_bf16_f32 v95, v62, v63
  ds_write_b128 v4, v[92:95] offset:3072
  s_lshl_b32 s43, s3, 2
  v_add_u32 v9, s43, v10
  v_and_b32 v6, 3, v2
  v_bfe_u32 v7, v2, 2, 2
  v_add_u32 v12, v6, v7
  v_lshlrev_b32 v12, 3, v12
  v_lshl_add_u32 v12, v14, 6, v12
  s_add_u32 s43, s7, 8
  v_add_u32 v12, s43, v12
  v_lshlrev_b32 v13, 5, v6
  v_lshlrev_b32 v7, 3, v7
  v_sub_u32 v13, v13, v7
  v_lshlrev_b32 v7, 6, v14
  v_sub_u32 v13, v13, v7
  s_add_u32 s43, s7, 4376
  v_add_u32 v13, s43, v13
  s_add_u32 s43, s7, 4384
  v_add_u32 v8, s43, v3
  s_waitcnt lgkmcnt(0)
  s_mov_b64 exec, 1
  ds_add_u32 v9, v11 offset:24
  s_mov_b64 exec, -1
  s_mov_b32 s43, 131072
K3_whu:
  ds_read_b32 v16, v9 offset:8
  s_waitcnt lgkmcnt(0)
  v_readfirstlane_b32 s42, v16
  s_sub_u32 s43, s43, 1
  s_cbranch_scc1 K3_whu_ok
  s_cmp_lt_u32 s42, 1
  s_cbranch_scc1 K3_whu
K3_whu_ok:
  ds_read_b64_tr_b16 v[96:97], v13 offset:32
  ds_read_b64_tr_b16 v[98:99], v13 offset:0
  ds_read_b64_tr_b16 v[32:33], v12 offset:0
  ds_read_b64_tr_b16 v[34:35], v12 offset:32
  ds_read_b64_tr_b16 v[100:101], v13 offset:160
  ds_read_b64_tr_b16 v[102:103], v13 offset:128
  ds_read_b64_tr_b16 v[104:105], v13 offset:288
  ds_read_b64_tr_b16 v[106:107], v13 offset:256
  ds_read_b64_tr_b16 v[36:37], v12 offset:256
  ds_read_b64_tr_b16 v[38:39], v12 offset:288
  s_waitcnt lgkmcnt(6)
  v_mfma_f32_16x16x32_bf16 v[16:19], v[96:99], v[32:35], 0
  ds_read_b64_tr_b16 v[108:109], v13 offset:416
  ds_read_b64_tr_b16 v[110:111], v13 offset:384
  s_waitcnt lgkmcnt(6)
  v_mfma_f32_16x16x32_bf16 v[20:23], v[100:103], v[32:35], 0
  ds_read_b64_tr_b16 v[112:113], v13 offset:544
  ds_read_b64_tr_b16 v[114:115], v13 offset:512
  ds_read_b64_tr_b16 v[40:41], v12 offset:512
  ds_read_b64_tr_b16 v[42:43], v12 offset:544
  s_waitcnt lgkmcnt(8)
  v_mfma_f32_16x16x32_bf16 v[24:27], v[104:107], v[32:35], 0
  ds_read_b64_tr_b16 v[116:117], v13 offset:672
  ds_read_b64_tr_b16 v[118:119], v13 offset:640
  v_add_f32_dpp v224, v19, v18 wave_shr:1 row_mask:0xf bank_mask:0xf bound_ctrl:0
  s_nop 1
  v_add_f32_dpp v226, v224, v17 wave_shr:1 row_mask:0xf bank_mask:0xf bound_ctrl:0
  s_waitcnt lgkmcnt(8)
  v_mfma_f32_16x16x32_bf16 v[24:27], v[96:99], v[36:39], v[24:27]
  v_add_f32_dpp v228, v226, v16 wave_shr:1 row_mask:0xf bank_mask:0xf bound_ctrl:0
  s_waitcnt lgkmcnt(6)
  v_mfma_f32_16x16x32_bf16 v[28:31], v[108:111], v[32:35], 0
  ds_read_b64_tr_b16 v[120:121], v13 offset:800
  ds_read_b64_tr_b16 v[122:123], v13 offset:768
  ds_read_b64_tr_b16 v[44:45], v12 offset:768
  ds_read_b64_tr_b16 v[46:47], v12 offset:800
  v_add_f32_dpp v225, v19, v22 wave_ror:1 row_mask:0xf bank_mask:0xf
  v_add_f32_dpp v227, v224, v21 wave_ror:1 row_mask:0xf bank_mask:0xf
  v_add_f32_dpp v229, v226, v20 wave_ror:1 row_mask:0xf bank_mask:0xf
  v_add_f32_dpp v225, v23, v22 wave_shr:1 row_mask:0xf bank_mask:0xf
  v_mfma_f32_16x16x32_bf16 v[28:31], v[100:103], v[36:39], v[28:31]
  s_nop 0
  v_add_f32_dpp v227, v225, v21 wave_shr:1 row_mask:0xf bank_mask:0xf
  s_nop 1
  v_add_f32_dpp v229, v227, v20 wave_shr:1 row_mask:0xf bank_mask:0xf
  v_cvt_pk_bf16_f32 v232, v228, v229
  v_or_b32 v232, 1, v232
  s_waitcnt lgkmcnt(8)
  v_mfma_f32_16x16x32_bf16 v[16:19], v[112:115], v[32:35], 0
  ds_read_b64_tr_b16 v[124:125], v13 offset:928
  ds_read_b64_tr_b16 v[126:127], v13 offset:896
  v_add_f32_dpp v224, v23, v26 wave_ror:1 row_mask:0xf bank_mask:0xf
  v_add_f32_dpp v226, v225, v25 wave_ror:1 row_mask:0xf bank_mask:0xf
  v_mfma_f32_16x16x32_bf16 v[16:19], v[104:107], v[36:39], v[16:19]
  v_add_f32_dpp v228, v227, v24 wave_ror:1 row_mask:0xf bank_mask:0xf
  v_add_f32_dpp v224, v27, v26 wave_shr:1 row_mask:0xf bank_mask:0xf
  s_waitcnt lgkmcnt(8)
  v_mfma_f32_16x16x32_bf16 v[16:19], v[96:99], v[40:43], v[16:19]
  v_add_f32_dpp v226, v224, v25 wave_shr:1 row_mask:0xf bank_mask:0xf
  s_nop 1
  v_add_f32_dpp v228, v226, v24 wave_shr:1 row_mask:0xf bank_mask:0xf
  s_waitcnt lgkmcnt(6)
  v_mfma_f32_16x16x32_bf16 v[20:23], v[116:119], v[32:35], 0
  ds_read_b64_tr_b16 v[128:129], v13 offset:1056
  ds_read_b64_tr_b16 v[130:131], v13 offset:1024
  ds_read_b64_tr_b16 v[48:49], v12 offset:1024
  ds_read_b64_tr_b16 v[50:51], v12 offset:1056
  v_add_f32_dpp v225, v27, v30 wave_ror:1 row_mask:0xf bank_mask:0xf
  v_add_f32_dpp v227, v224, v29 wave_ror:1 row_mask:0xf bank_mask:0xf
  v_add_f32_dpp v229, v226, v28 wave_ror:1 row_mask:0xf bank_mask:0xf
  v_mfma_f32_16x16x32_bf16 v[20:23], v[108:111], v[36:39], v[20:23]
  v_add_f32_dpp v225, v31, v30 wave_shr:1 row_mask:0xf bank_mask:0xf
  s_nop 1
  v_add_f32_dpp v227, v225, v29 wave_shr:1 row_mask:0xf bank_mask:0xf
  s_nop 1
  v_add_f32_dpp v229, v227, v28 wave_shr:1 row_mask:0xf bank_mask:0xf
  v_mfma_f32_16x16x32_bf16 v[20:23], v[100:103], v[40:43], v[20:23]
  v_cvt_pk_bf16_f32 v233, v228, v229
  v_or_b32 v233, 1, v233
  s_waitcnt lgkmcnt(8)
  v_mfma_f32_16x16x32_bf16 v[24:27], v[120:123], v[32:35], 0
  ds_read_b64_tr_b16 v[132:133], v13 offset:1184
  ds_read_b64_tr_b16 v[134:135], v13 offset:1152
  v_add_f32_dpp v224, v31, v18 wave_ror:1 row_mask:0xf bank_mask:0xf
  v_add_f32_dpp v226, v225, v17 wave_ror:1 row_mask:0xf bank_mask:0xf
  v_mfma_f32_16x16x32_bf16 v[24:27], v[112:115], v[36:39], v[24:27]
  v_add_f32_dpp v228, v227, v16 wave_ror:1 row_mask:0xf bank_mask:0xf
  v_add_f32_dpp v224, v19, v18 wave_shr:1 row_mask:0xf bank_mask:0xf
  v_mfma_f32_16x16x32_bf16 v[24:27], v[104:107], v[40:43], v[24:27]
  s_nop 0
  v_add_f32_dpp v226, v224, v17 wave_shr:1 row_mask:0xf bank_mask:0xf
  s_waitcnt lgkmcnt(8)
  v_mfma_f32_16x16x32_bf16 v[24:27], v[96:99], v[44:47], v[24:27]
  v_add_f32_dpp v228, v226, v16 wave_shr:1 row_mask:0xf bank_mask:0xf
  s_waitcnt lgkmcnt(6)
  v_mfma_f32_16x16x32_bf16 v[28:31], v[124:127], v[32:35], 0
  ds_read_b64_tr_b16 v[136:137], v13 offset:1312
  ds_read_b64_tr_b16 v[138:139], v13 offset:1280
  ds_read_b64_tr_b16 v[52:53], v12 offset:1280
  ds_read_b64_tr_b16 v[54:55], v12 offset:1312
  v_add_f32_dpp v225, v19, v22 wave_ror:1 row_mask:0xf bank_mask:0xf
  v_add_f32_dpp v227, v224, v21 wave_ror:1 row_mask:0xf bank_mask:0xf
  v_mfma_f32_16x16x32_bf16 v[28:31], v[116:119], v[36:39], v[28:31]
  v_add_f32_dpp v229, v226, v20 wave_ror:1 row_mask:0xf bank_mask:0xf
  v_add_f32_dpp v225, v23, v22 wave_shr:1 row_mask:0xf bank_mask:0xf
  v_mfma_f32_16x16x32_bf16 v[28:31], v[108:111], v[40:43], v[28:31]
  s_nop 0
  v_add_f32_dpp v227, v225, v21 wave_shr:1 row_mask:0xf bank_mask:0xf
  s_nop 1
  v_add_f32_dpp v229, v227, v20 wave_shr:1 row_mask:0xf bank_mask:0xf
  v_mfma_f32_16x16x32_bf16 v[28:31], v[100:103], v[44:47], v[28:31]
  v_cvt_pk_bf16_f32 v234, v228, v229
  v_or_b32 v234, 1, v234
  s_waitcnt lgkmcnt(8)
  v_mfma_f32_16x16x32_bf16 v[16:19], v[128:131], v[32:35], 0
  ds_read_b64_tr_b16 v[140:141], v13 offset:1440
  ds_read_b64_tr_b16 v[142:143], v13 offset:1408
  v_add_f32_dpp v224, v23, v26 wave_ror:1 row_mask:0xf bank_mask:0xf
  v_add_f32_dpp v226, v225, v25 wave_ror:1 row_mask:0xf bank_mask:0xf
  v_mfma_f32_16x16x32_bf16 v[16:19], v[120:123], v[36:39], v[16:19]
  v_add_f32_dpp v228, v227, v24 wave_ror:1 row_mask:0xf bank_mask:0xf
  v_mfma_f32_16x16x32_bf16 v[16:19], v[112:115], v[40:43], v[16:19]
  v_add_f32_dpp v224, v27, v26 wave_shr:1 row_mask:0xf bank_mask:0xf
  v_mfma_f32_16x16x32_bf16 v[16:19], v[104:107], v[44:47], v[16:19]
  s_nop 0
  v_add_f32_dpp v226, v224, v25 wave_shr:1 row_mask:0xf bank_mask:0xf
  s_waitcnt lgkmcnt(8)
  v_mfma_f32_16x16x32_bf16 v[16:19], v[96:99], v[48:51], v[16:19]
  v_add_f32_dpp v228, v226, v24 wave_shr:1 row_mask:0xf bank_mask:0xf
  s_waitcnt lgkmcnt(6)
  v_mfma_f32_16x16x32_bf16 v[20:23], v[132:135], v[32:35], 0
  ds_read_b64_tr_b16 v[144:145], v13 offset:1568
  ds_read_b64_tr_b16 v[146:147], v13 offset:1536
  ds_read_b64_tr_b16 v[56:57], v12 offset:1536
  ds_read_b64_tr_b16 v[58:59], v12 offset:1568
  v_add_f32_dpp v225, v27, v30 wave_ror:1 row_mask:0xf bank_mask:0xf
  v_add_f32_dpp v227, v224, v29 wave_ror:1 row_mask:0xf bank_mask:0xf
  v_mfma_f32_16x16x32_bf16 v[20:23], v[124:127], v[36:39], v[20:23]
  v_add_f32_dpp v229, v226, v28 wave_ror:1 row_mask:0xf bank_mask:0xf
  v_add_f32_dpp v225, v31, v30 wave_shr:1 row_mask:0xf bank_mask:0xf
  v_mfma_f32_16x16x32_bf16 v[20:23], v[116:119], v[40:43], v[20:23]
  s_nop 0
  v_add_f32_dpp v227, v225, v29 wave_shr:1 row_mask:0xf bank_mask:0xf
  s_nop 1
  v_add_f32_dpp v229, v227, v28 wave_shr:1 row_mask:0xf bank_mask:0xf
  v_mfma_f32_16x16x32_bf16 v[20:23], v[108:111], v[44:47], v[20:23]
  v_cvt_pk_bf16_f32 v235, v228, v229
  v_mfma_f32_16x16x32_bf16 v[20:23], v[100:103], v[48:51], v[20:23]
  v_or_b32 v235, 1, v235
  s_waitcnt lgkmcnt(8)
  v_mfma_f32_16x16x32_bf16 v[24:27], v[136:139], v[32:35], 0
  ds_read_b64_tr_b16 v[148:149], v13 offset:1696
  ds_read_b64_tr_b16 v[150:151], v13 offset:1664
  v_add_f32_dpp v224, v31, v18 wave_ror:1 row_mask:0xf bank_mask:0xf
  v_mfma_f32_16x16x32_bf16 v[24:27], v[128:131], v[36:39], v[24:27]
  v_add_f32_dpp v226, v225, v17 wave_ror:1 row_mask:0xf bank_mask:0xf
  v_mfma_f32_16x16x32_bf16 v[24:27], v[120:123], v[40:43], v[24:27]
  v_add_f32_dpp v228, v227, v16 wave_ror:1 row_mask:0xf bank_mask:0xf
  v_mfma_f32_16x16x32_bf16 v[24:27], v[112:115], v[44:47], v[24:27]
  v_add_f32_dpp v224, v19, v18 wave_shr:1 row_mask:0xf bank_mask:0xf
  v_mfma_f32_16x16x32_bf16 v[24:27], v[104:107], v[48:51], v[24:27]
  s_nop 0
  v_add_f32_dpp v226, v224, v17 wave_shr:1 row_mask:0xf bank_mask:0xf
  s_waitcnt lgkmcnt(8)
  v_mfma_f32_16x16x32_bf16 v[24:27], v[96:99], v[52:55], v[24:27]
  v_add_f32_dpp v228, v226, v16 wave_shr:1 row_mask:0xf bank_mask:0xf
  s_waitcnt lgkmcnt(6)
  v_mfma_f32_16x16x32_bf16 v[28:31], v[140:143], v[32:35], 0
  ds_read_b64_tr_b16 v[152:153], v13 offset:1824
  ds_read_b64_tr_b16 v[154:155], v13 offset:1792
  ds_read_b64_tr_b16 v[60:61], v12 offset:1792
  ds_read_b64_tr_b16 v[62:63], v12 offset:1824
  v_add_f32_dpp v225, v19, v22 wave_ror:1 row_mask:0xf bank_mask:0xf
  v_add_f32_dpp v227, v224, v21 wave_ror:1 row_mask:0xf bank_mask:0xf
  v_mfma_f32_16x16x32_bf16 v[28:31], v[132:135], v[36:39], v[28:31]
  v_add_f32_dpp v229, v226, v20 wave_ror:1 row_mask:0xf bank_mask:0xf
  v_add_f32_dpp v225, v23, v22 wave_shr:1 row_mask:0xf bank_mask:0xf
  v_mfma_f32_16x16x32_bf16 v[28:31], v[124:127], v[40:43], v[28:31]
  s_nop 0
  v_add_f32_dpp v227, v225, v21 wave_shr:1 row_mask:0xf bank_mask:0xf
  v_mfma_f32_16x16x32_bf16 v[28:31], v[116:119], v[44:47], v[28:31]
  s_nop 0
  v_add_f32_dpp v229, v227, v20 wave_shr:1 row_mask:0xf bank_mask:0xf
  v_mfma_f32_16x16x32_bf16 v[28:31], v[108:111], v[48:51], v[28:31]
  v_cvt_pk_bf16_f32 v236, v228, v229
  v_mfma_f32_16x16x32_bf16 v[28:31], v[100:103], v[52:55], v[28:31]
  v_or_b32 v236, 1, v236
  s_waitcnt lgkmcnt(8)
  v_mfma_f32_16x16x32_bf16 v[16:19], v[144:147], v[32:35], 0
  ds_read_b64_tr_b16 v[156:157], v13 offset:1952
  ds_read_b64_tr_b16 v[158:159], v13 offset:1920
  v_add_f32_dpp v224, v23, v26 wave_ror:1 row_mask:0xf bank_mask:0xf
  v_mfma_f32_16x16x32_bf16 v[16:19], v[136:139], v[36:39], v[16:19]
  v_add_f32_dpp v226, v225, v25 wave_ror:1 row_mask:0xf bank_mask:0xf
  v_mfma_f32_16x16x32_bf16 v[16:19], v[128:131], v[40:43], v[16:19]
  v_add_f32_dpp v228, v227, v24 wave_ror:1 row_mask:0xf bank_mask:0xf
  v_mfma_f32_16x16x32_bf16 v[16:19], v[120:123], v[44:47], v[16:19]
  v_add_f32_dpp v224, v27, v26 wave_shr:1 row_mask:0xf bank_mask:0xf
  v_mfma_f32_16x16x32_bf16 v[16:19], v[112:115], v[48:51], v[16:19]
  s_nop 0
  v_add_f32_dpp v226, v224, v25 wave_shr:1 row_mask:0xf bank_mask:0xf
  v_mfma_f32_16x16x32_bf16 v[16:19], v[104:107], v[52:55], v[16:19]
  s_nop 0
  v_add_f32_dpp v228, v226, v24 wave_shr:1 row_mask:0xf bank_mask:0xf
  s_waitcnt lgkmcnt(8)
  v_mfma_f32_16x16x32_bf16 v[16:19], v[96:99], v[56:59], v[16:19]
  s_waitcnt lgkmcnt(6)
  v_mfma_f32_16x16x32_bf16 v[20:23], v[148:151], v[32:35], 0
  ds_read_b64_tr_b16 v[160:161], v13 offset:2080
  ds_read_b64_tr_b16 v[162:163], v13 offset:2048
  ds_read_b64_tr_b16 v[64:65], v12 offset:2048
  ds_read_b64_tr_b16 v[66:67], v12 offset:2080
  v_add_f32_dpp v225, v27, v30 wave_ror:1 row_mask:0xf bank_mask:0xf
  v_add_f32_dpp v227, v224, v29 wave_ror:1 row_mask:0xf bank_mask:0xf
  v_mfma_f32_16x16x32_bf16 v[20:23], v[140:143], v[36:39], v[20:23]
  v_add_f32_dpp v229, v226, v28 wave_ror:1 row_mask:0xf bank_mask:0xf
  v_mfma_f32_16x16x32_bf16 v[20:23], v[132:135], v[40:43], v[20:23]
  v_add_f32_dpp v225, v31, v30 wave_shr:1 row_mask:0xf bank_mask:0xf
  v_mfma_f32_16x16x32_bf16 v[20:23], v[124:127], v[44:47], v[20:23]
  s_nop 0
  v_add_f32_dpp v227, v225, v29 wave_shr:1 row_mask:0xf bank_mask:0xf
  v_mfma_f32_16x16x32_bf16 v[20:23], v[116:119], v[48:51], v[20:23]
  s_nop 0
  v_add_f32_dpp v229, v227, v28 wave_shr:1 row_mask:0xf bank_mask:0xf
  v_mfma_f32_16x16x32_bf16 v[20:23], v[108:111], v[52:55], v[20:23]
  v_cvt_pk_bf16_f32 v237, v228, v229
  v_mfma_f32_16x16x32_bf16 v[20:23], v[100:103], v[56:59], v[20:23]
  v_or_b32 v237, 1, v237
  s_waitcnt lgkmcnt(8)
  v_mfma_f32_16x16x32_bf16 v[24:27], v[152:155], v[32:35], 0
  ds_read_b64_tr_b16 v[164:165], v13 offset:2208
  ds_read_b64_tr_b16 v[166:167], v13 offset:2176
  v_add_f32_dpp v224, v31, v18 wave_ror:1 row_mask:0xf bank_mask:0xf
  v_mfma_f32_16x16x32_bf16 v[24:27], v[144:147], v[36:39], v[24:27]
  v_add_f32_dpp v226, v225, v17 wave_ror:1 row_mask:0xf bank_mask:0xf
  v_mfma_f32_16x16x32_bf16 v[24:27], v[136:139], v[40:43], v[24:27]
  v_add_f32_dpp v228, v227, v16 wave_ror:1 row_mask:0xf bank_mask:0xf
  v_mfma_f32_16x16x32_bf16 v[24:27], v[128:131], v[44:47], v[24:27]
  v_add_f32_dpp v224, v19, v18 wave_shr:1 row_mask:0xf bank_mask:0xf
  v_mfma_f32_16x16x32_bf16 v[24:27], v[120:123], v[48:51], v[24:27]
  s_nop 0
  v_add_f32_dpp v226, v224, v17 wave_shr:1 row_mask:0xf bank_mask:0xf
  v_mfma_f32_16x16x32_bf16 v[24:27], v[112:115], v[52:55], v[24:27]
  s_nop 0
  v_add_f32_dpp v228, v226, v16 wave_shr:1 row_mask:0xf bank_mask:0xf
  v_mfma_f32_16x16x32_bf16 v[24:27], v[104:107], v[56:59], v[24:27]
  s_waitcnt lgkmcnt(8)
  v_mfma_f32_16x16x32_bf16 v[24:27], v[96:99], v[60:63], v[24:27]
  s_waitcnt lgkmcnt(6)
  v_mfma_f32_16x16x32_bf16 v[28:31], v[156:159], v[32:35], 0
  ds_read_b64_tr_b16 v[168:169], v13 offset:2336
  ds_read_b64_tr_b16 v[170:171], v13 offset:2304
  ds_read_b64_tr_b16 v[68:69], v12 offset:2304
  ds_read_b64_tr_b16 v[70:71], v12 offset:2336
  v_add_f32_dpp v225, v19, v22 wave_ror:1 row_mask:0xf bank_mask:0xf
  v_mfma_f32_16x16x32_bf16 v[28:31], v[148:151], v[36:39], v[28:31]
  v_add_f32_dpp v227, v224, v21 wave_ror:1 row_mask:0xf bank_mask:0xf
  v_mfma_f32_16x16x32_bf16 v[28:31], v[140:143], v[40:43], v[28:31]
  v_add_f32_dpp v229, v226, v20 wave_ror:1 row_mask:0xf bank_mask:0xf
  v_mfma_f32_16x16x32_bf16 v[28:31], v[132:135], v[44:47], v[28:31]
  v_add_f32_dpp v225, v23, v22 wave_shr:1 row_mask:0xf bank_mask:0xf
  v_mfma_f32_16x16x32_bf16 v[28:31], v[124:127], v[48:51], v[28:31]
  s_nop 0
  v_add_f32_dpp v227, v225, v21 wave_shr:1 row_mask:0xf bank_mask:0xf
  v_mfma_f32_16x16x32_bf16 v[28:31], v[116:119], v[52:55], v[28:31]
  s_nop 0
  v_add_f32_dpp v229, v227, v20 wave_shr:1 row_mask:0xf bank_mask:0xf
  v_mfma_f32_16x16x32_bf16 v[28:31], v[108:111], v[56:59], v[28:31]
  v_cvt_pk_bf16_f32 v238, v228, v229
  v_mfma_f32_16x16x32_bf16 v[28:31], v[100:103], v[60:63], v[28:31]
  v_or_b32 v238, 1, v238
  s_waitcnt lgkmcnt(8)
  v_mfma_f32_16x16x32_bf16 v[16:19], v[160:163], v[32:35], 0
  ds_read_b64_tr_b16 v[172:173], v13 offset:2464
  ds_read_b64_tr_b16 v[174:175], v13 offset:2432
  v_add_f32_dpp v224, v23, v26 wave_ror:1 row_mask:0xf bank_mask:0xf
  v_mfma_f32_16x16x32_bf16 v[16:19], v[152:155], v[36:39], v[16:19]
  v_add_f32_dpp v226, v225, v25 wave_ror:1 row_mask:0xf bank_mask:0xf
  v_mfma_f32_16x16x32_bf16 v[16:19], v[144:147], v[40:43], v[16:19]
  v_add_f32_dpp v228, v227, v24 wave_ror:1 row_mask:0xf bank_mask:0xf
  v_mfma_f32_16x16x32_bf16 v[16:19], v[136:139], v[44:47], v[16:19]
  v_add_f32_dpp v224, v27, v26 wave_shr:1 row_mask:0xf bank_mask:0xf
  v_mfma_f32_16x16x32_bf16 v[16:19], v[128:131], v[48:51], v[16:19]
  s_nop 0
  v_add_f32_dpp v226, v224, v25 wave_shr:1 row_mask:0xf bank_mask:0xf
  v_mfma_f32_16x16x32_bf16 v[16:19], v[120:123], v[52:55], v[16:19]
  s_nop 0
  v_add_f32_dpp v228, v226, v24 wave_shr:1 row_mask:0xf bank_mask:0xf
  v_mfma_f32_16x16x32_bf16 v[16:19], v[112:115], v[56:59], v[16:19]
  v_mfma_f32_16x16x32_bf16 v[16:19], v[104:107], v[60:63], v[16:19]
  s_waitcnt lgkmcnt(8)
  v_mfma_f32_16x16x32_bf16 v[16:19], v[96:99], v[64:67], v[16:19]
  s_waitcnt lgkmcnt(6)
  v_mfma_f32_16x16x32_bf16 v[20:23], v[164:167], v[32:35], 0
  ds_read_b64_tr_b16 v[176:177], v13 offset:2592
  ds_read_b64_tr_b16 v[178:179], v13 offset:2560
  ds_read_b64_tr_b16 v[72:73], v12 offset:2560
  ds_read_b64_tr_b16 v[74:75], v12 offset:2592
  v_add_f32_dpp v225, v27, v30 wave_ror:1 row_mask:0xf bank_mask:0xf
  v_mfma_f32_16x16x32_bf16 v[20:23], v[156:159], v[36:39], v[20:23]
  v_add_f32_dpp v227, v224, v29 wave_ror:1 row_mask:0xf bank_mask:0xf
  v_mfma_f32_16x16x32_bf16 v[20:23], v[148:151], v[40:43], v[20:23]
  v_add_f32_dpp v229, v226, v28 wave_ror:1 row_mask:0xf bank_mask:0xf
  v_mfma_f32_16x16x32_bf16 v[20:23], v[140:143], v[44:47], v[20:23]
  v_add_f32_dpp v225, v31, v30 wave_shr:1 row_mask:0xf bank_mask:0xf
  v_mfma_f32_16x16x32_bf16 v[20:23], v[132:135], v[48:51], v[20:23]
  s_nop 0
  v_add_f32_dpp v227, v225, v29 wave_shr:1 row_mask:0xf bank_mask:0xf
  v_mfma_f32_16x16x32_bf16 v[20:23], v[124:127], v[52:55], v[20:23]
  s_nop 0
  v_add_f32_dpp v229, v227, v28 wave_shr:1 row_mask:0xf bank_mask:0xf
  v_mfma_f32_16x16x32_bf16 v[20:23], v[116:119], v[56:59], v[20:23]
  v_cvt_pk_bf16_f32 v239, v228, v229
  v_mfma_f32_16x16x32_bf16 v[20:23], v[108:111], v[60:63], v[20:23]
  v_or_b32 v239, 1, v239
  v_mfma_f32_16x16x32_bf16 v[20:23], v[100:103], v[64:67], v[20:23]
  s_waitcnt lgkmcnt(8)
  v_mfma_f32_16x16x32_bf16 v[24:27], v[168:171], v[32:35], 0
  ds_read_b64_tr_b16 v[180:181], v13 offset:2720
  ds_read_b64_tr_b16 v[182:183], v13 offset:2688
  v_add_f32_dpp v224, v31, v18 wave_ror:1 row_mask:0xf bank_mask:0xf
  v_mfma_f32_16x16x32_bf16 v[24:27], v[160:163], v[36:39], v[24:27]
  v_add_f32_dpp v226, v225, v17 wave_ror:1 row_mask:0xf bank_mask:0xf
  v_mfma_f32_16x16x32_bf16 v[24:27], v[152:155], v[40:43], v[24:27]
  v_add_f32_dpp v228, v227, v16 wave_ror:1 row_mask:0xf bank_mask:0xf
  v_mfma_f32_16x16x32_bf16 v[24:27], v[144:147], v[44:47], v[24:27]
  v_add_f32_dpp v224, v19, v18 wave_shr:1 row_mask:0xf bank_mask:0xf
  v_mfma_f32_16x16x32_bf16 v[24:27], v[136:139], v[48:51], v[24:27]
  s_nop 0
  v_add_f32_dpp v226, v224, v17 wave_shr:1 row_mask:0xf bank_mask:0xf
  v_mfma_f32_16x16x32_bf16 v[24:27], v[128:131], v[52:55], v[24:27]
  s_nop 0
  v_add_f32_dpp v228, v226, v16 wave_shr:1 row_mask:0xf bank_mask:0xf
  v_mfma_f32_16x16x32_bf16 v[24:27], v[120:123], v[56:59], v[24:27]
  v_mfma_f32_16x16x32_bf16 v[24:27], v[112:115], v[60:63], v[24:27]
  v_mfma_f32_16x16x32_bf16 v[24:27], v[104:107], v[64:67], v[24:27]
  s_waitcnt lgkmcnt(8)
  v_mfma_f32_16x16x32_bf16 v[24:27], v[96:99], v[68:71], v[24:27]
  s_waitcnt lgkmcnt(6)
  v_mfma_f32_16x16x32_bf16 v[28:31], v[172:175], v[32:35], 0
  ds_read_b64_tr_b16 v[184:185], v13 offset:2848
  ds_read_b64_tr_b16 v[186:187], v13 offset:2816
  ds_read_b64_tr_b16 v[76:77], v12 offset:2816
  ds_read_b64_tr_b16 v[78:79], v12 offset:2848
  v_add_f32_dpp v225, v19, v22 wave_ror:1 row_mask:0xf bank_mask:0xf
  v_mfma_f32_16x16x32_bf16 v[28:31], v[164:167], v[36:39], v[28:31]
  v_add_f32_dpp v227, v224, v21 wave_ror:1 row_mask:0xf bank_mask:0xf
  v_mfma_f32_16x16x32_bf16 v[28:31], v[156:159], v[40:43], v[28:31]
  v_add_f32_dpp v229, v226, v20 wave_ror:1 row_mask:0xf bank_mask:0xf
  v_mfma_f32_16x16x32_bf16 v[28:31], v[148:151], v[44:47], v[28:31]
  v_add_f32_dpp v225, v23, v22 wave_shr:1 row_mask:0xf bank_mask:0xf
  v_mfma_f32_16x16x32_bf16 v[28:31], v[140:143], v[48:51], v[28:31]
  s_nop 0
  v_add_f32_dpp v227, v225, v21 wave_shr:1 row_mask:0xf bank_mask:0xf
  v_mfma_f32_16x16x32_bf16 v[28:31], v[132:135], v[52:55], v[28:31]
  s_nop 0
  v_add_f32_dpp v229, v227, v20 wave_shr:1 row_mask:0xf bank_mask:0xf
  v_mfma_f32_16x16x32_bf16 v[28:31], v[124:127], v[56:59], v[28:31]
  v_cvt_pk_bf16_f32 v240, v228, v229
  v_mfma_f32_16x16x32_bf16 v[28:31], v[116:119], v[60:63], v[28:31]
  v_or_b32 v240, 1, v240
  v_mfma_f32_16x16x32_bf16 v[28:31], v[108:111], v[64:67], v[28:31]
  v_mfma_f32_16x16x32_bf16 v[28:31], v[100:103], v[68:71], v[28:31]
  s_waitcnt lgkmcnt(8)
  v_mfma_f32_16x16x32_bf16 v[16:19], v[176:179], v[32:35], 0
  ds_read_b64_tr_b16 v[188:189], v13 offset:2976
  ds_read_b64_tr_b16 v[190:191], v13 offset:2944
  v_add_f32_dpp v224, v23, v26 wave_ror:1 row_mask:0xf bank_mask:0xf
  v_mfma_f32_16x16x32_bf16 v[16:19], v[168:171], v[36:39], v[16:19]
  v_add_f32_dpp v226, v225, v25 wave_ror:1 row_mask:0xf bank_mask:0xf
  v_mfma_f32_16x16x32_bf16 v[16:19], v[160:163], v[40:43], v[16:19]
  v_add_f32_dpp v228, v227, v24 wave_ror:1 row_mask:0xf bank_mask:0xf
  v_mfma_f32_16x16x32_bf16 v[16:19], v[152:155], v[44:47], v[16:19]
  v_add_f32_dpp v224, v27, v26 wave_shr:1 row_mask:0xf bank_mask:0xf
  v_mfma_f32_16x16x32_bf16 v[16:19], v[144:147], v[48:51], v[16:19]
  s_nop 0
  v_add_f32_dpp v226, v224, v25 wave_shr:1 row_mask:0xf bank_mask:0xf
  v_mfma_f32_16x16x32_bf16 v[16:19], v[136:139], v[52:55], v[16:19]
  s_nop 0
  v_add_f32_dpp v228, v226, v24 wave_shr:1 row_mask:0xf bank_mask:0xf
  v_mfma_f32_16x16x32_bf16 v[16:19], v[128:131], v[56:59], v[16:19]
  v_mfma_f32_16x16x32_bf16 v[16:19], v[120:123], v[60:63], v[16:19]
  v_mfma_f32_16x16x32_bf16 v[16:19], v[112:115], v[64:67], v[16:19]
  v_mfma_f32_16x16x32_bf16 v[16:19], v[104:107], v[68:71], v[16:19]
  s_waitcnt lgkmcnt(8)
  v_mfma_f32_16x16x32_bf16 v[16:19], v[96:99], v[72:75], v[16:19]
  s_waitcnt lgkmcnt(6)
  v_mfma_f32_16x16x32_bf16 v[20:23], v[180:183], v[32:35], 0
  ds_read_b64_tr_b16 v[192:193], v13 offset:3104
  ds_read_b64_tr_b16 v[194:195], v13 offset:3072
  ds_read_b64_tr_b16 v[80:81], v12 offset:3072
  ds_read_b64_tr_b16 v[82:83], v12 offset:3104
  v_add_f32_dpp v225, v27, v30 wave_ror:1 row_mask:0xf bank_mask:0xf
  v_mfma_f32_16x16x32_bf16 v[20:23], v[172:175], v[36:39], v[20:23]
  v_add_f32_dpp v227, v224, v29 wave_ror:1 row_mask:0xf bank_mask:0xf
  v_mfma_f32_16x16x32_bf16 v[20:23], v[164:167], v[40:43], v[20:23]
  v_add_f32_dpp v229, v226, v28 wave_ror:1 row_mask:0xf bank_mask:0xf
  v_mfma_f32_16x16x32_bf16 v[20:23], v[156:159], v[44:47], v[20:23]
  v_add_f32_dpp v225, v31, v30 wave_shr:1 row_mask:0xf bank_mask:0xf
  v_mfma_f32_16x16x32_bf16 v[20:23], v[148:151], v[48:51], v[20:23]
  s_nop 0
  v_add_f32_dpp v227, v225, v29 wave_shr:1 row_mask:0xf bank_mask:0xf
  v_mfma_f32_16x16x32_bf16 v[20:23], v[140:143], v[52:55], v[20:23]
  s_nop 0
  v_add_f32_dpp v229, v227, v28 wave_shr:1 row_mask:0xf bank_mask:0xf
  v_mfma_f32_16x16x32_bf16 v[20:23], v[132:135], v[56:59], v[20:23]
  v_cvt_pk_bf16_f32 v241, v228, v229
  v_mfma_f32_16x16x32_bf16 v[20:23], v[124:127], v[60:63], v[20:23]
  v_or_b32 v241, 1, v241
  v_mfma_f32_16x16x32_bf16 v[20:23], v[116:119], v[64:67], v[20:23]
  v_mfma_f32_16x16x32_bf16 v[20:23], v[108:111], v[68:71], v[20:23]
  v_mfma_f32_16x16x32_bf16 v[20:23], v[100:103], v[72:75], v[20:23]
  s_waitcnt lgkmcnt(8)
  v_mfma_f32_16x16x32_bf16 v[24:27], v[184:187], v[32:35], 0
  ds_read_b64_tr_b16 v[196:197], v13 offset:3232
  ds_read_b64_tr_b16 v[198:199], v13 offset:3200
  v_add_f32_dpp v224, v31, v18 wave_ror:1 row_mask:0xf bank_mask:0xf
  v_mfma_f32_16x16x32_bf16 v[24:27], v[176:179], v[36:39], v[24:27]
  v_add_f32_dpp v226, v225, v17 wave_ror:1 row_mask:0xf bank_mask:0xf
  v_mfma_f32_16x16x32_bf16 v[24:27], v[168:171], v[40:43], v[24:27]
  v_add_f32_dpp v228, v227, v16 wave_ror:1 row_mask:0xf bank_mask:0xf
  v_mfma_f32_16x16x32_bf16 v[24:27], v[160:163], v[44:47], v[24:27]
  v_add_f32_dpp v224, v19, v18 wave_shr:1 row_mask:0xf bank_mask:0xf
  v_mfma_f32_16x16x32_bf16 v[24:27], v[152:155], v[48:51], v[24:27]
  s_nop 0
  v_add_f32_dpp v226, v224, v17 wave_shr:1 row_mask:0xf bank_mask:0xf
  v_mfma_f32_16x16x32_bf16 v[24:27], v[144:147], v[52:55], v[24:27]
  s_nop 0
  v_add_f32_dpp v228, v226, v16 wave_shr:1 row_mask:0xf bank_mask:0xf
  v_mfma_f32_16x16x32_bf16 v[24:27], v[136:139], v[56:59], v[24:27]
  v_mfma_f32_16x16x32_bf16 v[24:27], v[128:131], v[60:63], v[24:27]
  v_mfma_f32_16x16x32_bf16 v[24:27], v[120:123], v[64:67], v[24:27]
  v_mfma_f32_16x16x32_bf16 v[24:27], v[112:115], v[68:71], v[24:27]
  v_mfma_f32_16x16x32_bf16 v[24:27], v[104:107], v[72:75], v[24:27]
  s_waitcnt lgkmcnt(8)
  v_mfma_f32_16x16x32_bf16 v[24:27], v[96:99], v[76:79], v[24:27]
  s_waitcnt lgkmcnt(6)
  v_mfma_f32_16x16x32_bf16 v[28:31], v[188:191], v[32:35], 0
  ds_read_b64_tr_b16 v[200:201], v13 offset:3360
  ds_read_b64_tr_b16 v[202:203], v13 offset:3328
  ds_read_b64_tr_b16 v[84:85], v12 offset:3328
  ds_read_b64_tr_b16 v[86:87], v12 offset:3360
  v_add_f32_dpp v225, v19, v22 wave_ror:1 row_mask:0xf bank_mask:0xf
  v_mfma_f32_16x16x32_bf16 v[28:31], v[180:183], v[36:39], v[28:31]
  v_add_f32_dpp v227, v224, v21 wave_ror:1 row_mask:0xf bank_mask:0xf
  v_mfma_f32_16x16x32_bf16 v[28:31], v[172:175], v[40:43], v[28:31]
  v_add_f32_dpp v229, v226, v20 wave_ror:1 row_mask:0xf bank_mask:0xf
  v_mfma_f32_16x16x32_bf16 v[28:31], v[164:167], v[44:47], v[28:31]
  v_add_f32_dpp v225, v23, v22 wave_shr:1 row_mask:0xf bank_mask:0xf
  v_mfma_f32_16x16x32_bf16 v[28:31], v[156:159], v[48:51], v[28:31]
  s_nop 0
  v_add_f32_dpp v227, v225, v21 wave_shr:1 row_mask:0xf bank_mask:0xf
  v_mfma_f32_16x16x32_bf16 v[28:31], v[148:151], v[52:55], v[28:31]
  s_nop 0
  v_add_f32_dpp v229, v227, v20 wave_shr:1 row_mask:0xf bank_mask:0xf
  v_mfma_f32_16x16x32_bf16 v[28:31], v[140:143], v[56:59], v[28:31]
  v_cvt_pk_bf16_f32 v242, v228, v229
  v_mfma_f32_16x16x32_bf16 v[28:31], v[132:135], v[60:63], v[28:31]
  v_or_b32 v242, 1, v242
  v_mfma_f32_16x16x32_bf16 v[28:31], v[124:127], v[64:67], v[28:31]
  v_mfma_f32_16x16x32_bf16 v[28:31], v[116:119], v[68:71], v[28:31]
  v_mfma_f32_16x16x32_bf16 v[28:31], v[108:111], v[72:75], v[28:31]
  v_mfma_f32_16x16x32_bf16 v[28:31], v[100:103], v[76:79], v[28:31]
  s_waitcnt lgkmcnt(8)
  v_mfma_f32_16x16x32_bf16 v[16:19], v[192:195], v[32:35], 0
  ds_read_b64_tr_b16 v[204:205], v13 offset:3488
  ds_read_b64_tr_b16 v[206:207], v13 offset:3456
  v_add_f32_dpp v224, v23, v26 wave_ror:1 row_mask:0xf bank_mask:0xf
  v_mfma_f32_16x16x32_bf16 v[16:19], v[184:187], v[36:39], v[16:19]
  v_add_f32_dpp v226, v225, v25 wave_ror:1 row_mask:0xf bank_mask:0xf
  v_mfma_f32_16x16x32_bf16 v[16:19], v[176:179], v[40:43], v[16:19]
  v_add_f32_dpp v228, v227, v24 wave_ror:1 row_mask:0xf bank_mask:0xf
  v_mfma_f32_16x16x32_bf16 v[16:19], v[168:171], v[44:47], v[16:19]
  v_add_f32_dpp v224, v27, v26 wave_shr:1 row_mask:0xf bank_mask:0xf
  v_mfma_f32_16x16x32_bf16 v[16:19], v[160:163], v[48:51], v[16:19]
  s_nop 0
  v_add_f32_dpp v226, v224, v25 wave_shr:1 row_mask:0xf bank_mask:0xf
  v_mfma_f32_16x16x32_bf16 v[16:19], v[152:155], v[52:55], v[16:19]
  s_nop 0
  v_add_f32_dpp v228, v226, v24 wave_shr:1 row_mask:0xf bank_mask:0xf
  v_mfma_f32_16x16x32_bf16 v[16:19], v[144:147], v[56:59], v[16:19]
  v_mfma_f32_16x16x32_bf16 v[16:19], v[136:139], v[60:63], v[16:19]
  v_mfma_f32_16x16x32_bf16 v[16:19], v[128:131], v[64:67], v[16:19]
  v_mfma_f32_16x16x32_bf16 v[16:19], v[120:123], v[68:71], v[16:19]
  v_mfma_f32_16x16x32_bf16 v[16:19], v[112:115], v[72:75], v[16:19]
  v_mfma_f32_16x16x32_bf16 v[16:19], v[104:107], v[76:79], v[16:19]
  s_waitcnt lgkmcnt(8)
  v_mfma_f32_16x16x32_bf16 v[16:19], v[96:99], v[80:83], v[16:19]
  s_waitcnt lgkmcnt(6)
  v_mfma_f32_16x16x32_bf16 v[20:23], v[196:199], v[32:35], 0
  ds_read_b64_tr_b16 v[208:209], v13 offset:3616
  ds_read_b64_tr_b16 v[210:211], v13 offset:3584
  ds_read_b64_tr_b16 v[88:89], v12 offset:3584
  ds_read_b64_tr_b16 v[90:91], v12 offset:3616
  v_add_f32_dpp v225, v27, v30 wave_ror:1 row_mask:0xf bank_mask:0xf
  v_mfma_f32_16x16x32_bf16 v[20:23], v[188:191], v[36:39], v[20:23]
  v_add_f32_dpp v227, v224, v29 wave_ror:1 row_mask:0xf bank_mask:0xf
  v_mfma_f32_16x16x32_bf16 v[20:23], v[180:183], v[40:43], v[20:23]
  v_add_f32_dpp v229, v226, v28 wave_ror:1 row_mask:0xf bank_mask:0xf
  v_mfma_f32_16x16x32_bf16 v[20:23], v[172:175], v[44:47], v[20:23]
  v_add_f32_dpp v225, v31, v30 wave_shr:1 row_mask:0xf bank_mask:0xf
  v_mfma_f32_16x16x32_bf16 v[20:23], v[164:167], v[48:51], v[20:23]
  s_nop 0
  v_add_f32_dpp v227, v225, v29 wave_shr:1 row_mask:0xf bank_mask:0xf
  v_mfma_f32_16x16x32_bf16 v[20:23], v[156:159], v[52:55], v[20:23]
  s_nop 0
  v_add_f32_dpp v229, v227, v28 wave_shr:1 row_mask:0xf bank_mask:0xf
  v_mfma_f32_16x16x32_bf16 v[20:23], v[148:151], v[56:59], v[20:23]
  v_cvt_pk_bf16_f32 v243, v228, v229
  v_mfma_f32_16x16x32_bf16 v[20:23], v[140:143], v[60:63], v[20:23]
  v_or_b32 v243, 1, v243
  v_mfma_f32_16x16x32_bf16 v[20:23], v[132:135], v[64:67], v[20:23]
  v_mfma_f32_16x16x32_bf16 v[20:23], v[124:127], v[68:71], v[20:23]
  v_mfma_f32_16x16x32_bf16 v[20:23], v[116:119], v[72:75], v[20:23]
  v_mfma_f32_16x16x32_bf16 v[20:23], v[108:111], v[76:79], v[20:23]
  v_mfma_f32_16x16x32_bf16 v[20:23], v[100:103], v[80:83], v[20:23]
  s_waitcnt lgkmcnt(8)
  v_mfma_f32_16x16x32_bf16 v[24:27], v[200:203], v[32:35], 0
  ds_read_b64_tr_b16 v[212:213], v13 offset:3744
  ds_read_b64_tr_b16 v[214:215], v13 offset:3712
  v_add_f32_dpp v224, v31, v18 wave_ror:1 row_mask:0xf bank_mask:0xf
  v_mfma_f32_16x16x32_bf16 v[24:27], v[192:195], v[36:39], v[24:27]
  v_add_f32_dpp v226, v225, v17 wave_ror:1 row_mask:0xf bank_mask:0xf
  v_mfma_f32_16x16x32_bf16 v[24:27], v[184:187], v[40:43], v[24:27]
  v_add_f32_dpp v228, v227, v16 wave_ror:1 row_mask:0xf bank_mask:0xf
  v_mfma_f32_16x16x32_bf16 v[24:27], v[176:179], v[44:47], v[24:27]
  v_add_f32_dpp v224, v19, v18 wave_shr:1 row_mask:0xf bank_mask:0xf
  v_mfma_f32_16x16x32_bf16 v[24:27], v[168:171], v[48:51], v[24:27]
  s_nop 0
  v_add_f32_dpp v226, v224, v17 wave_shr:1 row_mask:0xf bank_mask:0xf
  v_mfma_f32_16x16x32_bf16 v[24:27], v[160:163], v[52:55], v[24:27]
  s_nop 0
  v_add_f32_dpp v228, v226, v16 wave_shr:1 row_mask:0xf bank_mask:0xf
  v_mfma_f32_16x16x32_bf16 v[24:27], v[152:155], v[56:59], v[24:27]
  v_mfma_f32_16x16x32_bf16 v[24:27], v[144:147], v[60:63], v[24:27]
  v_mfma_f32_16x16x32_bf16 v[24:27], v[136:139], v[64:67], v[24:27]
  v_mfma_f32_16x16x32_bf16 v[24:27], v[128:131], v[68:71], v[24:27]
  v_mfma_f32_16x16x32_bf16 v[24:27], v[120:123], v[72:75], v[24:27]
  v_mfma_f32_16x16x32_bf16 v[24:27], v[112:115], v[76:79], v[24:27]
  v_mfma_f32_16x16x32_bf16 v[24:27], v[104:107], v[80:83], v[24:27]
  s_waitcnt lgkmcnt(8)
  v_mfma_f32_16x16x32_bf16 v[24:27], v[96:99], v[84:87], v[24:27]
  s_waitcnt lgkmcnt(6)
  v_mfma_f32_16x16x32_bf16 v[28:31], v[204:207], v[32:35], 0
  ds_read_b64_tr_b16 v[216:217], v13 offset:3872
  ds_read_b64_tr_b16 v[218:219], v13 offset:3840
  ds_read_b64_tr_b16 v[92:93], v12 offset:3840
  ds_read_b64_tr_b16 v[94:95], v12 offset:3872
  v_add_f32_dpp v225, v19, v22 wave_ror:1 row_mask:0xf bank_mask:0xf
  v_mfma_f32_16x16x32_bf16 v[28:31], v[196:199], v[36:39], v[28:31]
  v_add_f32_dpp v227, v224, v21 wave_ror:1 row_mask:0xf bank_mask:0xf
  v_mfma_f32_16x16x32_bf16 v[28:31], v[188:191], v[40:43], v[28:31]
  v_add_f32_dpp v229, v226, v20 wave_ror:1 row_mask:0xf bank_mask:0xf
  v_mfma_f32_16x16x32_bf16 v[28:31], v[180:183], v[44:47], v[28:31]
  v_add_f32_dpp v225, v23, v22 wave_shr:1 row_mask:0xf bank_mask:0xf
  v_mfma_f32_16x16x32_bf16 v[28:31], v[172:175], v[48:51], v[28:31]
  s_nop 0
  v_add_f32_dpp v227, v225, v21 wave_shr:1 row_mask:0xf bank_mask:0xf
  v_mfma_f32_16x16x32_bf16 v[28:31], v[164:167], v[52:55], v[28:31]
  s_nop 0
  v_add_f32_dpp v229, v227, v20 wave_shr:1 row_mask:0xf bank_mask:0xf
  v_mfma_f32_16x16x32_bf16 v[28:31], v[156:159], v[56:59], v[28:31]
  v_cvt_pk_bf16_f32 v244, v228, v229
  v_mfma_f32_16x16x32_bf16 v[28:31], v[148:151], v[60:63], v[28:31]
  v_or_b32 v244, 1, v244
  v_mfma_f32_16x16x32_bf16 v[28:31], v[140:143], v[64:67], v[28:31]
  v_mfma_f32_16x16x32_bf16 v[28:31], v[132:135], v[68:71], v[28:31]
  v_mfma_f32_16x16x32_bf16 v[28:31], v[124:127], v[72:75], v[28:31]
  v_mfma_f32_16x16x32_bf16 v[28:31], v[116:119], v[76:79], v[28:31]
  v_mfma_f32_16x16x32_bf16 v[28:31], v[108:111], v[80:83], v[28:31]
  v_mfma_f32_16x16x32_bf16 v[28:31], v[100:103], v[84:87], v[28:31]
  s_waitcnt lgkmcnt(8)
  v_mfma_f32_16x16x32_bf16 v[16:19], v[208:211], v[32:35], 0
  ds_read_b64_tr_b16 v[220:221], v13 offset:4000
  ds_read_b64_tr_b16 v[222:223], v13 offset:3968
  v_add_f32_dpp v224, v23, v26 wave_ror:1 row_mask:0xf bank_mask:0xf
  v_mfma_f32_16x16x32_bf16 v[16:19], v[200:203], v[36:39], v[16:19]
  v_add_f32_dpp v226, v225, v25 wave_ror:1 row_mask:0xf bank_mask:0xf
  v_mfma_f32_16x16x32_bf16 v[16:19], v[192:195], v[40:43], v[16:19]
  v_add_f32_dpp v228, v227, v24 wave_ror:1 row_mask:0xf bank_mask:0xf
  v_mfma_f32_16x16x32_bf16 v[16:19], v[184:187], v[44:47], v[16:19]
  v_add_f32_dpp v224, v27, v26 wave_shr:1 row_mask:0xf bank_mask:0xf
  v_mfma_f32_16x16x32_bf16 v[16:19], v[176:179], v[48:51], v[16:19]
  s_nop 0
  v_add_f32_dpp v226, v224, v25 wave_shr:1 row_mask:0xf bank_mask:0xf
  v_mfma_f32_16x16x32_bf16 v[16:19], v[168:171], v[52:55], v[16:19]
  s_nop 0
  v_add_f32_dpp v228, v226, v24 wave_shr:1 row_mask:0xf bank_mask:0xf
  v_mfma_f32_16x16x32_bf16 v[16:19], v[160:163], v[56:59], v[16:19]
  v_mfma_f32_16x16x32_bf16 v[16:19], v[152:155], v[60:63], v[16:19]
  v_mfma_f32_16x16x32_bf16 v[16:19], v[144:147], v[64:67], v[16:19]
  v_mfma_f32_16x16x32_bf16 v[16:19], v[136:139], v[68:71], v[16:19]
  v_mfma_f32_16x16x32_bf16 v[16:19], v[128:131], v[72:75], v[16:19]
  v_mfma_f32_16x16x32_bf16 v[16:19], v[120:123], v[76:79], v[16:19]
  v_mfma_f32_16x16x32_bf16 v[16:19], v[112:115], v[80:83], v[16:19]
  v_mfma_f32_16x16x32_bf16 v[16:19], v[104:107], v[84:87], v[16:19]
  s_waitcnt lgkmcnt(8)
  v_mfma_f32_16x16x32_bf16 v[16:19], v[96:99], v[88:91], v[16:19]
  s_waitcnt lgkmcnt(6)
  v_mfma_f32_16x16x32_bf16 v[20:23], v[212:215], v[32:35], 0
  v_add_f32_dpp v225, v27, v30 wave_ror:1 row_mask:0xf bank_mask:0xf
  v_mfma_f32_16x16x32_bf16 v[20:23], v[204:207], v[36:39], v[20:23]
  v_add_f32_dpp v227, v224, v29 wave_ror:1 row_mask:0xf bank_mask:0xf
  v_mfma_f32_16x16x32_bf16 v[20:23], v[196:199], v[40:43], v[20:23]
  v_add_f32_dpp v229, v226, v28 wave_ror:1 row_mask:0xf bank_mask:0xf
  v_mfma_f32_16x16x32_bf16 v[20:23], v[188:191], v[44:47], v[20:23]
  v_add_f32_dpp v225, v31, v30 wave_shr:1 row_mask:0xf bank_mask:0xf
  v_mfma_f32_16x16x32_bf16 v[20:23], v[180:183], v[48:51], v[20:23]
  s_nop 0
  v_add_f32_dpp v227, v225, v29 wave_shr:1 row_mask:0xf bank_mask:0xf
  v_mfma_f32_16x16x32_bf16 v[20:23], v[172:175], v[52:55], v[20:23]
  s_nop 0
  v_add_f32_dpp v229, v227, v28 wave_shr:1 row_mask:0xf bank_mask:0xf
  v_mfma_f32_16x16x32_bf16 v[20:23], v[164:167], v[56:59], v[20:23]
  v_cvt_pk_bf16_f32 v245, v228, v229
  v_mfma_f32_16x16x32_bf16 v[20:23], v[156:159], v[60:63], v[20:23]
  v_or_b32 v245, 1, v245
  v_mfma_f32_16x16x32_bf16 v[20:23], v[148:151], v[64:67], v[20:23]
  v_mfma_f32_16x16x32_bf16 v[20:23], v[140:143], v[68:71], v[20:23]
  v_mfma_f32_16x16x32_bf16 v[20:23], v[132:135], v[72:75], v[20:23]
  v_mfma_f32_16x16x32_bf16 v[20:23], v[124:127], v[76:79], v[20:23]
  v_mfma_f32_16x16x32_bf16 v[20:23], v[116:119], v[80:83], v[20:23]
  v_mfma_f32_16x16x32_bf16 v[20:23], v[108:111], v[84:87], v[20:23]
  v_mfma_f32_16x16x32_bf16 v[20:23], v[100:103], v[88:91], v[20:23]
  s_waitcnt lgkmcnt(4)
  v_mfma_f32_16x16x32_bf16 v[24:27], v[216:219], v[32:35], 0
  v_add_f32_dpp v224, v31, v18 wave_ror:1 row_mask:0xf bank_mask:0xf
  v_mfma_f32_16x16x32_bf16 v[24:27], v[208:211], v[36:39], v[24:27]
  v_add_f32_dpp v226, v225, v17 wave_ror:1 row_mask:0xf bank_mask:0xf
  v_mfma_f32_16x16x32_bf16 v[24:27], v[200:203], v[40:43], v[24:27]
  v_add_f32_dpp v228, v227, v16 wave_ror:1 row_mask:0xf bank_mask:0xf
  v_mfma_f32_16x16x32_bf16 v[24:27], v[192:195], v[44:47], v[24:27]
  v_add_f32_dpp v224, v19, v18 wave_shr:1 row_mask:0xf bank_mask:0xf
  v_mfma_f32_16x16x32_bf16 v[24:27], v[184:187], v[48:51], v[24:27]
  s_nop 0
  v_add_f32_dpp v226, v224, v17 wave_shr:1 row_mask:0xf bank_mask:0xf
  v_mfma_f32_16x16x32_bf16 v[24:27], v[176:179], v[52:55], v[24:27]
  s_nop 0
  v_add_f32_dpp v228, v226, v16 wave_shr:1 row_mask:0xf bank_mask:0xf
  v_mfma_f32_16x16x32_bf16 v[24:27], v[168:171], v[56:59], v[24:27]
  v_mfma_f32_16x16x32_bf16 v[24:27], v[160:163], v[60:63], v[24:27]
  v_mfma_f32_16x16x32_bf16 v[24:27], v[152:155], v[64:67], v[24:27]
  v_mfma_f32_16x16x32_bf16 v[24:27], v[144:147], v[68:71], v[24:27]
  v_mfma_f32_16x16x32_bf16 v[24:27], v[136:139], v[72:75], v[24:27]
  v_mfma_f32_16x16x32_bf16 v[24:27], v[128:131], v[76:79], v[24:27]
  v_mfma_f32_16x16x32_bf16 v[24:27], v[120:123], v[80:83], v[24:27]
  v_mfma_f32_16x16x32_bf16 v[24:27], v[112:115], v[84:87], v[24:27]
  v_mfma_f32_16x16x32_bf16 v[24:27], v[104:107], v[88:91], v[24:27]
  s_waitcnt lgkmcnt(2)
  v_mfma_f32_16x16x32_bf16 v[24:27], v[96:99], v[92:95], v[24:27]
  s_waitcnt lgkmcnt(0)
  v_mfma_f32_16x16x32_bf16 v[28:31], v[220:223], v[32:35], 0
  v_add_f32_dpp v225, v19, v22 wave_ror:1 row_mask:0xf bank_mask:0xf
  v_mfma_f32_16x16x32_bf16 v[28:31], v[212:215], v[36:39], v[28:31]
  v_add_f32_dpp v227, v224, v21 wave_ror:1 row_mask:0xf bank_mask:0xf
  v_mfma_f32_16x16x32_bf16 v[28:31], v[204:207], v[40:43], v[28:31]
  v_add_f32_dpp v229, v226, v20 wave_ror:1 row_mask:0xf bank_mask:0xf
  v_mfma_f32_16x16x32_bf16 v[28:31], v[196:199], v[44:47], v[28:31]
  v_add_f32_dpp v225, v23, v22 wave_shr:1 row_mask:0xf bank_mask:0xf
  v_mfma_f32_16x16x32_bf16 v[28:31], v[188:191], v[48:51], v[28:31]
  s_nop 0
  v_add_f32_dpp v227, v225, v21 wave_shr:1 row_mask:0xf bank_mask:0xf
  v_mfma_f32_16x16x32_bf16 v[28:31], v[180:183], v[52:55], v[28:31]
  s_nop 0
  v_add_f32_dpp v229, v227, v20 wave_shr:1 row_mask:0xf bank_mask:0xf
  v_mfma_f32_16x16x32_bf16 v[28:31], v[172:175], v[56:59], v[28:31]
  v_cvt_pk_bf16_f32 v246, v228, v229
  v_mfma_f32_16x16x32_bf16 v[28:31], v[164:167], v[60:63], v[28:31]
  v_or_b32 v246, 1, v246
  v_mfma_f32_16x16x32_bf16 v[28:31], v[156:159], v[64:67], v[28:31]
  v_mfma_f32_16x16x32_bf16 v[28:31], v[148:151], v[68:71], v[28:31]
  v_mfma_f32_16x16x32_bf16 v[28:31], v[140:143], v[72:75], v[28:31]
  v_mfma_f32_16x16x32_bf16 v[28:31], v[132:135], v[76:79], v[28:31]
  v_mfma_f32_16x16x32_bf16 v[28:31], v[124:127], v[80:83], v[28:31]
  v_mfma_f32_16x16x32_bf16 v[28:31], v[116:119], v[84:87], v[28:31]
  v_mfma_f32_16x16x32_bf16 v[28:31], v[108:111], v[88:91], v[28:31]
  v_mfma_f32_16x16x32_bf16 v[28:31], v[100:103], v[92:95], v[28:31]
  v_add_f32_dpp v224, v23, v26 wave_ror:1 row_mask:0xf bank_mask:0xf
  v_add_f32_dpp v226, v225, v25 wave_ror:1 row_mask:0xf bank_mask:0xf
  v_add_f32_dpp v228, v227, v24 wave_ror:1 row_mask:0xf bank_mask:0xf
  v_add_f32_dpp v224, v27, v26 wave_shr:1 row_mask:0xf bank_mask:0xf
  s_nop 1
  v_add_f32_dpp v226, v224, v25 wave_shr:1 row_mask:0xf bank_mask:0xf
  s_nop 1
  v_add_f32_dpp v228, v226, v24 wave_shr:1 row_mask:0xf bank_mask:0xf
  v_add_f32_dpp v225, v27, v30 wave_ror:1 row_mask:0xf bank_mask:0xf
  v_add_f32_dpp v227, v224, v29 wave_ror:1 row_mask:0xf bank_mask:0xf
  v_add_f32_dpp v229, v226, v28 wave_ror:1 row_mask:0xf bank_mask:0xf
  v_add_f32_dpp v225, v31, v30 wave_shr:1 row_mask:0xf bank_mask:0xf
  s_nop 1
  v_add_f32_dpp v227, v225, v29 wave_shr:1 row_mask:0xf bank_mask:0xf
  s_nop 1
  v_add_f32_dpp v229, v227, v28 wave_shr:1 row_mask:0xf bank_mask:0xf
  v_cvt_pk_bf16_f32 v247, v228, v229
  v_or_b32 v247, 1, v247
  s_add_u32 s28, s98, 16777216
  s_addc_u32 s29, s99, 0
  s_mov_b32 s30, 4194304
  s_mov_b32 s31, 0x20000
  s_lshl_b32 s40, s6, 12
  buffer_store_dwordx4 v[232:235], v3, s[28:31], s40 offen offset:0 sc1
  buffer_store_dwordx4 v[236:239], v3, s[28:31], s40 offen offset:1024 sc1
  buffer_store_dwordx4 v[240:243], v3, s[28:31], s40 offen offset:2048 sc1
  buffer_store_dwordx4 v[244:247], v3, s[28:31], s40 offen offset:3072 sc1
  s_and_b32 s40, s10, 3
  s_lshl_b32 s40, s40, 2
  s_and_b32 s41, s11, 3
  s_add_u32 s40, s40, s41
  s_lshl_b32 s41, s40, 3
  s_lshl_b32 s42, s3, 1
  s_add_u32 s41, s41, s42
  s_lshl_b32 s48, s41, 15
  s_mov_b32 s47, s48
  v_lshrrev_b32 v5, 5, v2
  v_and_b32 v6, 1, v14
  v_lshlrev_b32 v12, 15, v6
  v_lshl_add_u32 v12, v5, 8, v12
  v_lshl_add_u32 v12, v15, 4, v12
  s_add_u32 s28, s98, 0
  s_addc_u32 s29, s99, 0
  s_mov_b32 s30, 4194304
  s_mov_b32 s31, 0x20000
  s_mov_b32 s32, s94
  s_mov_b32 s33, s95
  s_mov_b32 s34, 8388608
  s_mov_b32 s35, 0x20000
  s_waitcnt lgkmcnt(0)
  s_mov_b64 exec, 1
  ds_add_u32 v9, v11 offset:56
  s_mov_b64 exec, -1
  s_mov_b32 s43, 131072
K3_wwo:
  ds_read_b32 v80, v10 offset:48
  s_waitcnt lgkmcnt(0)
  v_readfirstlane_b32 s42, v80
  s_sub_u32 s43, s43, 1
  s_cbranch_scc1 K3_wwo_ok
  s_cmp_lt_u32 s42, 4
  s_cbranch_scc1 K3_wwo
K3_wwo_ok:
  s_setprio 1
  buffer_load_dwordx4 v[96:99], v12, s[28:31], s48 offen offset:0
  buffer_load_dwordx4 v[100:103], v12, s[28:31], s48 offen offset:512
  buffer_load_dwordx4 v[104:107], v12, s[28:31], s48 offen offset:1024
  buffer_load_dwordx4 v[108:111], v12, s[28:31], s48 offen offset:1536
  buffer_load_dwordx4 v[112:115], v12, s[28:31], s48 offen offset:2048
  buffer_load_dwordx4 v[116:119], v12, s[28:31], s48 offen offset:2560
  buffer_load_dwordx4 v[120:123], v12, s[28:31], s48 offen offset:3072
  buffer_load_dwordx4 v[124:127], v12, s[28:31], s48 offen offset:3584
  s_add_u32 s48, s48, 4096
  buffer_load_dwordx4 v[128:131], v12, s[28:31], s48 offen offset:0
  buffer_load_dwordx4 v[132:135], v12, s[28:31], s48 offen offset:512
  buffer_load_dwordx4 v[136:139], v12, s[28:31], s48 offen offset:1024
  buffer_load_dwordx4 v[140:143], v12, s[28:31], s48 offen offset:1536
  buffer_load_dwordx4 v[144:147], v12, s[28:31], s48 offen offset:2048
  buffer_load_dwordx4 v[148:151], v12, s[28:31], s48 offen offset:2560
  buffer_load_dwordx4 v[152:155], v12, s[28:31], s48 offen offset:3072
  buffer_load_dwordx4 v[156:159], v12, s[28:31], s48 offen offset:3584
  s_add_u32 s48, s48, 4096
  buffer_load_dwordx4 v[160:163], v12, s[28:31], s48 offen offset:0
  buffer_load_dwordx4 v[164:167], v12, s[28:31], s48 offen offset:512
  buffer_load_dwordx4 v[168:171], v12, s[28:31], s48 offen offset:1024
  buffer_load_dwordx4 v[172:175], v12, s[28:31], s48 offen offset:1536
  buffer_load_dwordx4 v[176:179], v12, s[28:31], s48 offen offset:2048
  buffer_load_dwordx4 v[180:183], v12, s[28:31], s48 offen offset:2560
  buffer_load_dwordx4 v[184:187], v12, s[28:31], s48 offen offset:3072
  buffer_load_dwordx4 v[188:191], v12, s[28:31], s48 offen offset:3584
  s_add_u32 s48, s48, 4096
  v_bfe_u32 v4, v2, 2, 2
  v_and_b32 v7, 3, v2
  v_lshlrev_b32 v4, 6, v4
  v_lshl_add_u32 v4, v7, 3, v4
  v_lshl_add_u32 v4, v5, 9, v4
  v_xor_b32 v7, v6, v5
  v_lshl_add_u32 v13, v7, 5, v4
  v_add_u32 v4, 40960, v13
  v_add_u32 v8, 106496, v13
  ds_read_b64_tr_b16 v[48:49], v4 offset:0
  ds_read_b64_tr_b16 v[50:51], v4 offset:2048
  ds_read_b64_tr_b16 v[52:53], v4 offset:256
  ds_read_b64_tr_b16 v[54:55], v4 offset:2304
  ds_read_b64_tr_b16 v[56:57], v4 offset:1024
  ds_read_b64_tr_b16 v[58:59], v4 offset:3072
  ds_read_b64_tr_b16 v[60:61], v4 offset:1280
  ds_read_b64_tr_b16 v[62:63], v4 offset:3328
  s_waitcnt vmcnt(16)
  v_bitop3_b32 v81, v96, v97, v98 bitop3:0x80
  v_bitop3_b32 v81, v81, v99, v100 bitop3:0x80
  v_bitop3_b32 v81, v81, v101, v102 bitop3:0x80
  v_bitop3_b32 v81, v81, v103, v104 bitop3:0x80
  v_bitop3_b32 v81, v81, v105, v106 bitop3:0x80
  v_bitop3_b32 v81, v81, v107, v108 bitop3:0x80
  v_bitop3_b32 v81, v81, v109, v110 bitop3:0x80
  v_bitop3_b32 v81, v81, v111, v112 bitop3:0x80
  v_bitop3_b32 v81, v81, v113, v114 bitop3:0x80
  v_bitop3_b32 v81, v81, v115, v116 bitop3:0x80
  v_bitop3_b32 v81, v81, v117, v118 bitop3:0x80
  v_bitop3_b32 v81, v81, v119, v120 bitop3:0x80
  v_bitop3_b32 v81, v81, v121, v122 bitop3:0x80
  v_bitop3_b32 v81, v81, v123, v124 bitop3:0x80
  v_bitop3_b32 v81, v81, v125, v126 bitop3:0x80
  v_bitop3_b32 v81, v81, v127, 1 bitop3:0x80
  v_cmp_eq_u32 vcc, 0, v81
  s_nop 0
  s_cmp_lg_u64 vcc, 0
  s_cbranch_scc1 K3_retry0
K3_retry0_ret:
  s_waitcnt lgkmcnt(6)
  v_mfma_f32_32x32x16_bf16 v[16:31], v[48:51], v[96:99], 0
  ds_read_b64_tr_b16 v[64:65], v4 offset:4096
  ds_read_b64_tr_b16 v[66:67], v4 offset:6144
  s_waitcnt lgkmcnt(6)
  v_mfma_f32_32x32x16_bf16 v[32:47], v[52:55], v[96:99], 0
  ds_read_b64_tr_b16 v[68:69], v4 offset:4352
  ds_read_b64_tr_b16 v[70:71], v4 offset:6400
  s_waitcnt lgkmcnt(6)
  v_mfma_f32_32x32x16_bf16 v[16:31], v[56:59], v[100:103], v[16:31]
  ds_read_b64_tr_b16 v[72:73], v4 offset:5120
  ds_read_b64_tr_b16 v[74:75], v4 offset:7168
  s_waitcnt lgkmcnt(6)
  v_mfma_f32_32x32x16_bf16 v[32:47], v[60:63], v[100:103], v[32:47]
  ds_read_b64_tr_b16 v[76:77], v4 offset:5376
  ds_read_b64_tr_b16 v[78:79], v4 offset:7424
  buffer_load_dwordx4 v[192:195], v12, s[28:31], s48 offen offset:0
  buffer_load_dwordx4 v[196:199], v12, s[28:31], s48 offen offset:512
  buffer_load_dwordx4 v[200:203], v12, s[28:31], s48 offen offset:1024
  buffer_load_dwordx4 v[204:207], v12, s[28:31], s48 offen offset:1536
  s_waitcnt lgkmcnt(6)
  v_mfma_f32_32x32x16_bf16 v[16:31], v[64:67], v[104:107], v[16:31]
  ds_read_b64_tr_b16 v[48:49], v4 offset:8192
  ds_read_b64_tr_b16 v[50:51], v4 offset:10240
  s_waitcnt lgkmcnt(6)
  v_mfma_f32_32x32x16_bf16 v[32:47], v[68:71], v[104:107], v[32:47]
  ds_read_b64_tr_b16 v[52:53], v4 offset:8448
  ds_read_b64_tr_b16 v[54:55], v4 offset:10496
  s_waitcnt lgkmcnt(6)
  v_mfma_f32_32x32x16_bf16 v[16:31], v[72:75], v[108:111], v[16:31]
  ds_read_b64_tr_b16 v[56:57], v4 offset:9216
  ds_read_b64_tr_b16 v[58:59], v4 offset:11264
  s_waitcnt lgkmcnt(6)
  v_mfma_f32_32x32x16_bf16 v[32:47], v[76:79], v[108:111], v[32:47]
  ds_read_b64_tr_b16 v[60:61], v4 offset:9472
  ds_read_b64_tr_b16 v[62:63], v4 offset:11520
  buffer_load_dwordx4 v[208:211], v12, s[28:31], s48 offen offset:2048
  buffer_load_dwordx4 v[212:215], v12, s[28:31], s48 offen offset:2560
  buffer_load_dwordx4 v[216:219], v12, s[28:31], s48 offen offset:3072
  buffer_load_dwordx4 v[220:223], v12, s[28:31], s48 offen offset:3584
  s_add_u32 s48, s48, 4096
  s_waitcnt vmcnt(16)
  s_waitcnt lgkmcnt(6)
  v_mfma_f32_32x32x16_bf16 v[16:31], v[48:51], v[112:115], v[16:31]
  ds_read_b64_tr_b16 v[64:65], v4 offset:12288
  v_bitop3_b32 v81, v128, v129, v130 bitop3:0x80
  ds_read_b64_tr_b16 v[66:67], v4 offset:14336
  v_bitop3_b32 v81, v81, v131, v132 bitop3:0x80
  s_waitcnt lgkmcnt(6)
  v_mfma_f32_32x32x16_bf16 v[32:47], v[52:55], v[112:115], v[32:47]
  ds_read_b64_tr_b16 v[68:69], v4 offset:12544
  v_bitop3_b32 v81, v81, v133, v134 bitop3:0x80
  ds_read_b64_tr_b16 v[70:71], v4 offset:14592
  v_bitop3_b32 v81, v81, v135, v136 bitop3:0x80
  s_waitcnt lgkmcnt(6)
  v_mfma_f32_32x32x16_bf16 v[16:31], v[56:59], v[116:119], v[16:31]
  ds_read_b64_tr_b16 v[72:73], v4 offset:13312
  v_bitop3_b32 v81, v81, v137, v138 bitop3:0x80
  ds_read_b64_tr_b16 v[74:75], v4 offset:15360
  v_bitop3_b32 v81, v81, v139, v140 bitop3:0x80
  s_waitcnt lgkmcnt(6)
  v_mfma_f32_32x32x16_bf16 v[32:47], v[60:63], v[116:119], v[32:47]
  ds_read_b64_tr_b16 v[76:77], v4 offset:13568
  v_bitop3_b32 v81, v81, v141, v142 bitop3:0x80
  ds_read_b64_tr_b16 v[78:79], v4 offset:15616
  v_bitop3_b32 v81, v81, v143, v144 bitop3:0x80
  buffer_load_dwordx4 v[96:99], v12, s[28:31], s48 offen offset:0
  buffer_load_dwordx4 v[100:103], v12, s[28:31], s48 offen offset:512
  buffer_load_dwordx4 v[104:107], v12, s[28:31], s48 offen offset:1024
  buffer_load_dwordx4 v[108:111], v12, s[28:31], s48 offen offset:1536
  s_waitcnt lgkmcnt(6)
  v_mfma_f32_32x32x16_bf16 v[16:31], v[64:67], v[120:123], v[16:31]
  ds_read_b64_tr_b16 v[48:49], v4 offset:16384
  v_bitop3_b32 v81, v81, v145, v146 bitop3:0x80
  ds_read_b64_tr_b16 v[50:51], v4 offset:18432
  v_bitop3_b32 v81, v81, v147, v148 bitop3:0x80
  s_waitcnt lgkmcnt(6)
  v_mfma_f32_32x32x16_bf16 v[32:47], v[68:71], v[120:123], v[32:47]
  ds_read_b64_tr_b16 v[52:53], v4 offset:16640
  v_bitop3_b32 v81, v81, v149, v150 bitop3:0x80
  ds_read_b64_tr_b16 v[54:55], v4 offset:18688
  v_bitop3_b32 v81, v81, v151, v152 bitop3:0x80
  s_waitcnt lgkmcnt(6)
  v_mfma_f32_32x32x16_bf16 v[16:31], v[72:75], v[124:127], v[16:31]
  ds_read_b64_tr_b16 v[56:57], v4 offset:17408
  v_bitop3_b32 v81, v81, v153, v154 bitop3:0x80
  ds_read_b64_tr_b16 v[58:59], v4 offset:19456
  v_bitop3_b32 v81, v81, v155, v156 bitop3:0x80
  s_waitcnt lgkmcnt(6)
  v_mfma_f32_32x32x16_bf16 v[32:47], v[76:79], v[124:127], v[32:47]
  ds_read_b64_tr_b16 v[60:61], v4 offset:17664
  v_bitop3_b32 v81, v81, v157, v158 bitop3:0x80
  ds_read_b64_tr_b16 v[62:63], v4 offset:19712
  v_bitop3_b32 v81, v81, v159, 1 bitop3:0x80
  v_cmp_eq_u32 vcc, 0, v81
  s_nop 0
  s_cmp_lg_u64 vcc, 0
  s_cbranch_scc1 K3_retry1
K3_retry1_ret:
  buffer_load_dwordx4 v[112:115], v12, s[28:31], s48 offen offset:2048
  buffer_load_dwordx4 v[116:119], v12, s[28:31], s48 offen offset:2560
  buffer_load_dwordx4 v[120:123], v12, s[28:31], s48 offen offset:3072
  buffer_load_dwordx4 v[124:127], v12, s[28:31], s48 offen offset:3584
  s_add_u32 s48, s48, 4096
  s_waitcnt lgkmcnt(6)
  v_mfma_f32_32x32x16_bf16 v[16:31], v[48:51], v[128:131], v[16:31]
  ds_read_b64_tr_b16 v[64:65], v4 offset:20480
  ds_read_b64_tr_b16 v[66:67], v4 offset:22528
  s_waitcnt lgkmcnt(6)
  v_mfma_f32_32x32x16_bf16 v[32:47], v[52:55], v[128:131], v[32:47]
  ds_read_b64_tr_b16 v[68:69], v4 offset:20736
  ds_read_b64_tr_b16 v[70:71], v4 offset:22784
  s_waitcnt lgkmcnt(6)
  v_mfma_f32_32x32x16_bf16 v[16:31], v[56:59], v[132:135], v[16:31]
  ds_read_b64_tr_b16 v[72:73], v4 offset:21504
  ds_read_b64_tr_b16 v[74:75], v4 offset:23552
  s_waitcnt lgkmcnt(6)
  v_mfma_f32_32x32x16_bf16 v[32:47], v[60:63], v[132:135], v[32:47]
  ds_read_b64_tr_b16 v[76:77], v4 offset:21760
  ds_read_b64_tr_b16 v[78:79], v4 offset:23808
  buffer_load_dwordx4 v[128:131], v12, s[28:31], s48 offen offset:0
  buffer_load_dwordx4 v[132:135], v12, s[28:31], s48 offen offset:512
  s_waitcnt lgkmcnt(6)
  v_mfma_f32_32x32x16_bf16 v[16:31], v[64:67], v[136:139], v[16:31]
  ds_read_b64_tr_b16 v[48:49], v4 offset:24576
  ds_read_b64_tr_b16 v[50:51], v4 offset:26624
  s_waitcnt lgkmcnt(6)
  v_mfma_f32_32x32x16_bf16 v[32:47], v[68:71], v[136:139], v[32:47]
  ds_read_b64_tr_b16 v[52:53], v4 offset:24832
  ds_read_b64_tr_b16 v[54:55], v4 offset:26880
  s_waitcnt lgkmcnt(6)
  v_mfma_f32_32x32x16_bf16 v[16:31], v[72:75], v[140:143], v[16:31]
  ds_read_b64_tr_b16 v[56:57], v4 offset:25600
  ds_read_b64_tr_b16 v[58:59], v4 offset:27648
  s_waitcnt lgkmcnt(6)
  v_mfma_f32_32x32x16_bf16 v[32:47], v[76:79], v[140:143], v[32:47]
  ds_read_b64_tr_b16 v[60:61], v4 offset:25856
  ds_read_b64_tr_b16 v[62:63], v4 offset:27904
  buffer_load_dwordx4 v[136:139], v12, s[28:31], s48 offen offset:1024
  buffer_load_dwordx4 v[140:143], v12, s[28:31], s48 offen offset:1536
  s_waitcnt vmcnt(20)
  s_waitcnt lgkmcnt(6)
  v_mfma_f32_32x32x16_bf16 v[16:31], v[48:51], v[144:147], v[16:31]
  ds_read_b64_tr_b16 v[64:65], v4 offset:28672
  v_bitop3_b32 v81, v160, v161, v162 bitop3:0x80
  ds_read_b64_tr_b16 v[66:67], v4 offset:30720
  v_bitop3_b32 v81, v81, v163, v164 bitop3:0x80
  s_waitcnt lgkmcnt(6)
  v_mfma_f32_32x32x16_bf16 v[32:47], v[52:55], v[144:147], v[32:47]
  ds_read_b64_tr_b16 v[68:69], v4 offset:28928
  v_bitop3_b32 v81, v81, v165, v166 bitop3:0x80
  ds_read_b64_tr_b16 v[70:71], v4 offset:30976
  v_bitop3_b32 v81, v81, v167, v168 bitop3:0x80
  s_waitcnt lgkmcnt(6)
  v_mfma_f32_32x32x16_bf16 v[16:31], v[56:59], v[148:151], v[16:31]
  ds_read_b64_tr_b16 v[72:73], v4 offset:29696
  v_bitop3_b32 v81, v81, v169, v170 bitop3:0x80
  ds_read_b64_tr_b16 v[74:75], v4 offset:31744
  v_bitop3_b32 v81, v81, v171, v172 bitop3:0x80
  s_waitcnt lgkmcnt(6)
  v_mfma_f32_32x32x16_bf16 v[32:47], v[60:63], v[148:151], v[32:47]
  ds_read_b64_tr_b16 v[76:77], v4 offset:29952
  v_bitop3_b32 v81, v81, v173, v174 bitop3:0x80
  ds_read_b64_tr_b16 v[78:79], v4 offset:32000
  v_bitop3_b32 v81, v81, v175, v176 bitop3:0x80
  buffer_load_dwordx4 v[144:147], v12, s[28:31], s48 offen offset:2048
  buffer_load_dwordx4 v[148:151], v12, s[28:31], s48 offen offset:2560
  s_waitcnt lgkmcnt(6)
  v_mfma_f32_32x32x16_bf16 v[16:31], v[64:67], v[152:155], v[16:31]
  ds_read_b64_tr_b16 v[48:49], v4 offset:32768
  v_bitop3_b32 v81, v81, v177, v178 bitop3:0x80
  ds_read_b64_tr_b16 v[50:51], v4 offset:34816
  v_bitop3_b32 v81, v81, v179, v180 bitop3:0x80
  s_waitcnt lgkmcnt(6)
  v_mfma_f32_32x32x16_bf16 v[32:47], v[68:71], v[152:155], v[32:47]
  ds_read_b64_tr_b16 v[52:53], v4 offset:33024
  v_bitop3_b32 v81, v81, v181, v182 bitop3:0x80
  ds_read_b64_tr_b16 v[54:55], v4 offset:35072
  v_bitop3_b32 v81, v81, v183, v184 bitop3:0x80
  s_waitcnt lgkmcnt(6)
  v_mfma_f32_32x32x16_bf16 v[16:31], v[72:75], v[156:159], v[16:31]
  ds_read_b64_tr_b16 v[56:57], v4 offset:33792
  v_bitop3_b32 v81, v81, v185, v186 bitop3:0x80
  ds_read_b64_tr_b16 v[58:59], v4 offset:35840
  v_bitop3_b32 v81, v81, v187, v188 bitop3:0x80
  s_waitcnt lgkmcnt(6)
  v_mfma_f32_32x32x16_bf16 v[32:47], v[76:79], v[156:159], v[32:47]
  ds_read_b64_tr_b16 v[60:61], v4 offset:34048
  v_bitop3_b32 v81, v81, v189, v190 bitop3:0x80
  ds_read_b64_tr_b16 v[62:63], v4 offset:36096
  v_bitop3_b32 v81, v81, v191, 1 bitop3:0x80
  v_cmp_eq_u32 vcc, 0, v81
  s_nop 0
  s_cmp_lg_u64 vcc, 0
  s_cbranch_scc1 K3_retry2
K3_retry2_ret:
  buffer_load_dwordx4 v[152:155], v12, s[28:31], s48 offen offset:3072
  buffer_load_dwordx4 v[156:159], v12, s[28:31], s48 offen offset:3584
  s_add_u32 s48, s48, 4096
  s_waitcnt lgkmcnt(6)
  v_mfma_f32_32x32x16_bf16 v[16:31], v[48:51], v[160:163], v[16:31]
  ds_read_b64_tr_b16 v[64:65], v4 offset:36864
  ds_read_b64_tr_b16 v[66:67], v4 offset:38912
  s_waitcnt lgkmcnt(6)
  v_mfma_f32_32x32x16_bf16 v[32:47], v[52:55], v[160:163], v[32:47]
  ds_read_b64_tr_b16 v[68:69], v4 offset:37120
  ds_read_b64_tr_b16 v[70:71], v4 offset:39168
  s_waitcnt lgkmcnt(6)
  v_mfma_f32_32x32x16_bf16 v[16:31], v[56:59], v[164:167], v[16:31]
  ds_read_b64_tr_b16 v[72:73], v4 offset:37888
  ds_read_b64_tr_b16 v[74:75], v4 offset:39936
  s_waitcnt lgkmcnt(6)
  v_mfma_f32_32x32x16_bf16 v[32:47], v[60:63], v[164:167], v[32:47]
  ds_read_b64_tr_b16 v[76:77], v4 offset:38144
  ds_read_b64_tr_b16 v[78:79], v4 offset:40192
  buffer_load_dwordx4 v[160:163], v12, s[28:31], s48 offen offset:0
  buffer_load_dwordx4 v[164:167], v12, s[28:31], s48 offen offset:512
  s_waitcnt lgkmcnt(6)
  v_mfma_f32_32x32x16_bf16 v[16:31], v[64:67], v[168:171], v[16:31]
  ds_read_b64_tr_b16 v[48:49], v4 offset:40960
  ds_read_b64_tr_b16 v[50:51], v4 offset:43008
  s_waitcnt lgkmcnt(6)
  v_mfma_f32_32x32x16_bf16 v[32:47], v[68:71], v[168:171], v[32:47]
  ds_read_b64_tr_b16 v[52:53], v4 offset:41216
  ds_read_b64_tr_b16 v[54:55], v4 offset:43264
  s_waitcnt lgkmcnt(6)
  v_mfma_f32_32x32x16_bf16 v[16:31], v[72:75], v[172:175], v[16:31]
  ds_read_b64_tr_b16 v[56:57], v4 offset:41984
  ds_read_b64_tr_b16 v[58:59], v4 offset:44032
  s_waitcnt lgkmcnt(6)
  v_mfma_f32_32x32x16_bf16 v[32:47], v[76:79], v[172:175], v[32:47]
  ds_read_b64_tr_b16 v[60:61], v4 offset:42240
  ds_read_b64_tr_b16 v[62:63], v4 offset:44288
  buffer_load_dwordx4 v[168:171], v12, s[28:31], s48 offen offset:1024
  buffer_load_dwordx4 v[172:175], v12, s[28:31], s48 offen offset:1536
  s_waitcnt vmcnt(20)
  s_waitcnt lgkmcnt(6)
  v_mfma_f32_32x32x16_bf16 v[16:31], v[48:51], v[176:179], v[16:31]
  ds_read_b64_tr_b16 v[64:65], v4 offset:45056
  v_bitop3_b32 v81, v192, v193, v194 bitop3:0x80
  ds_read_b64_tr_b16 v[66:67], v4 offset:47104
  v_bitop3_b32 v81, v81, v195, v196 bitop3:0x80
  s_waitcnt lgkmcnt(6)
  v_mfma_f32_32x32x16_bf16 v[32:47], v[52:55], v[176:179], v[32:47]
  ds_read_b64_tr_b16 v[68:69], v4 offset:45312
  v_bitop3_b32 v81, v81, v197, v198 bitop3:0x80
  ds_read_b64_tr_b16 v[70:71], v4 offset:47360
  v_bitop3_b32 v81, v81, v199, v200 bitop3:0x80
  s_waitcnt lgkmcnt(6)
  v_mfma_f32_32x32x16_bf16 v[16:31], v[56:59], v[180:183], v[16:31]
  ds_read_b64_tr_b16 v[72:73], v4 offset:46080
  v_bitop3_b32 v81, v81, v201, v202 bitop3:0x80
  ds_read_b64_tr_b16 v[74:75], v4 offset:48128
  v_bitop3_b32 v81, v81, v203, v204 bitop3:0x80
  s_waitcnt lgkmcnt(6)
  v_mfma_f32_32x32x16_bf16 v[32:47], v[60:63], v[180:183], v[32:47]
  ds_read_b64_tr_b16 v[76:77], v4 offset:46336
  v_bitop3_b32 v81, v81, v205, v206 bitop3:0x80
  ds_read_b64_tr_b16 v[78:79], v4 offset:48384
  v_bitop3_b32 v81, v81, v207, v208 bitop3:0x80
  buffer_load_dwordx4 v[176:179], v12, s[28:31], s48 offen offset:2048
  buffer_load_dwordx4 v[180:183], v12, s[28:31], s48 offen offset:2560
  s_waitcnt lgkmcnt(6)
  v_mfma_f32_32x32x16_bf16 v[16:31], v[64:67], v[184:187], v[16:31]
  ds_read_b64_tr_b16 v[48:49], v4 offset:49152
  v_bitop3_b32 v81, v81, v209, v210 bitop3:0x80
  ds_read_b64_tr_b16 v[50:51], v4 offset:51200
  v_bitop3_b32 v81, v81, v211, v212 bitop3:0x80
  s_waitcnt lgkmcnt(6)
  v_mfma_f32_32x32x16_bf16 v[32:47], v[68:71], v[184:187], v[32:47]
  ds_read_b64_tr_b16 v[52:53], v4 offset:49408
  v_bitop3_b32 v81, v81, v213, v214 bitop3:0x80
  ds_read_b64_tr_b16 v[54:55], v4 offset:51456
  v_bitop3_b32 v81, v81, v215, v216 bitop3:0x80
  s_waitcnt lgkmcnt(6)
  v_mfma_f32_32x32x16_bf16 v[16:31], v[72:75], v[188:191], v[16:31]
  ds_read_b64_tr_b16 v[56:57], v4 offset:50176
  v_bitop3_b32 v81, v81, v217, v218 bitop3:0x80
  ds_read_b64_tr_b16 v[58:59], v4 offset:52224
  v_bitop3_b32 v81, v81, v219, v220 bitop3:0x80
  s_waitcnt lgkmcnt(6)
  v_mfma_f32_32x32x16_bf16 v[32:47], v[76:79], v[188:191], v[32:47]
  ds_read_b64_tr_b16 v[60:61], v4 offset:50432
  v_bitop3_b32 v81, v81, v221, v222 bitop3:0x80
  ds_read_b64_tr_b16 v[62:63], v4 offset:52480
  v_bitop3_b32 v81, v81, v223, 1 bitop3:0x80
  v_cmp_eq_u32 vcc, 0, v81
  s_nop 0
  s_cmp_lg_u64 vcc, 0
  s_cbranch_scc1 K3_retry3
K3_retry3_ret:
  buffer_load_dwordx4 v[184:187], v12, s[28:31], s48 offen offset:3072
  buffer_load_dwordx4 v[188:191], v12, s[28:31], s48 offen offset:3584
  s_add_u32 s48, s48, 4096
  s_waitcnt lgkmcnt(6)
  v_mfma_f32_32x32x16_bf16 v[16:31], v[48:51], v[192:195], v[16:31]
  ds_read_b64_tr_b16 v[64:65], v4 offset:53248
  ds_read_b64_tr_b16 v[66:67], v4 offset:55296
  s_waitcnt lgkmcnt(6)
  v_mfma_f32_32x32x16_bf16 v[32:47], v[52:55], v[192:195], v[32:47]
  ds_read_b64_tr_b16 v[68:69], v4 offset:53504
  ds_read_b64_tr_b16 v[70:71], v4 offset:55552
  s_waitcnt lgkmcnt(6)
  v_mfma_f32_32x32x16_bf16 v[16:31], v[56:59], v[196:199], v[16:31]
  ds_read_b64_tr_b16 v[72:73], v4 offset:54272
  ds_read_b64_tr_b16 v[74:75], v4 offset:56320
  s_waitcnt lgkmcnt(6)
  v_mfma_f32_32x32x16_bf16 v[32:47], v[60:63], v[196:199], v[32:47]
  ds_read_b64_tr_b16 v[76:77], v4 offset:54528
  ds_read_b64_tr_b16 v[78:79], v4 offset:56576
  buffer_load_dwordx4 v[192:195], v12, s[28:31], s48 offen offset:0
  buffer_load_dwordx4 v[196:199], v12, s[28:31], s48 offen offset:512
  s_waitcnt lgkmcnt(6)
  v_mfma_f32_32x32x16_bf16 v[16:31], v[64:67], v[200:203], v[16:31]
  ds_read_b64_tr_b16 v[48:49], v4 offset:57344
  ds_read_b64_tr_b16 v[50:51], v4 offset:59392
  s_waitcnt lgkmcnt(6)
  v_mfma_f32_32x32x16_bf16 v[32:47], v[68:71], v[200:203], v[32:47]
  ds_read_b64_tr_b16 v[52:53], v4 offset:57600
  ds_read_b64_tr_b16 v[54:55], v4 offset:59648
  s_waitcnt lgkmcnt(6)
  v_mfma_f32_32x32x16_bf16 v[16:31], v[72:75], v[204:207], v[16:31]
  ds_read_b64_tr_b16 v[56:57], v4 offset:58368
  ds_read_b64_tr_b16 v[58:59], v4 offset:60416
  s_waitcnt lgkmcnt(6)
  v_mfma_f32_32x32x16_bf16 v[32:47], v[76:79], v[204:207], v[32:47]
  ds_read_b64_tr_b16 v[60:61], v4 offset:58624
  ds_read_b64_tr_b16 v[62:63], v4 offset:60672
  buffer_load_dwordx4 v[200:203], v12, s[28:31], s48 offen offset:1024
  buffer_load_dwordx4 v[204:207], v12, s[28:31], s48 offen offset:1536
  s_waitcnt vmcnt(20)
  s_waitcnt lgkmcnt(6)
  v_mfma_f32_32x32x16_bf16 v[16:31], v[48:51], v[208:211], v[16:31]
  ds_read_b64_tr_b16 v[64:65], v4 offset:61440
  v_bitop3_b32 v81, v96, v97, v98 bitop3:0x80
  ds_read_b64_tr_b16 v[66:67], v4 offset:63488
  v_bitop3_b32 v81, v81, v99, v100 bitop3:0x80
  s_waitcnt lgkmcnt(6)
  v_mfma_f32_32x32x16_bf16 v[32:47], v[52:55], v[208:211], v[32:47]
  ds_read_b64_tr_b16 v[68:69], v4 offset:61696
  v_bitop3_b32 v81, v81, v101, v102 bitop3:0x80
  ds_read_b64_tr_b16 v[70:71], v4 offset:63744
  v_bitop3_b32 v81, v81, v103, v104 bitop3:0x80
  s_waitcnt lgkmcnt(6)
  v_mfma_f32_32x32x16_bf16 v[16:31], v[56:59], v[212:215], v[16:31]
  ds_read_b64_tr_b16 v[72:73], v4 offset:62464
  v_bitop3_b32 v81, v81, v105, v106 bitop3:0x80
  ds_read_b64_tr_b16 v[74:75], v4 offset:64512
  v_bitop3_b32 v81, v81, v107, v108 bitop3:0x80
  s_waitcnt lgkmcnt(6)
  v_mfma_f32_32x32x16_bf16 v[32:47], v[60:63], v[212:215], v[32:47]
  ds_read_b64_tr_b16 v[76:77], v4 offset:62720
  v_bitop3_b32 v81, v81, v109, v110 bitop3:0x80
  ds_read_b64_tr_b16 v[78:79], v4 offset:64768
  v_bitop3_b32 v81, v81, v111, v112 bitop3:0x80
  buffer_load_dwordx4 v[208:211], v12, s[28:31], s48 offen offset:2048
  buffer_load_dwordx4 v[212:215], v12, s[28:31], s48 offen offset:2560
  s_waitcnt lgkmcnt(6)
  v_mfma_f32_32x32x16_bf16 v[16:31], v[64:67], v[216:219], v[16:31]
  ds_read_b64_tr_b16 v[48:49], v8 offset:0
  v_bitop3_b32 v81, v81, v113, v114 bitop3:0x80
  ds_read_b64_tr_b16 v[50:51], v8 offset:2048
  v_bitop3_b32 v81, v81, v115, v116 bitop3:0x80
  s_waitcnt lgkmcnt(6)
  v_mfma_f32_32x32x16_bf16 v[32:47], v[68:71], v[216:219], v[32:47]
  ds_read_b64_tr_b16 v[52:53], v8 offset:256
  v_bitop3_b32 v81, v81, v117, v118 bitop3:0x80
  ds_read_b64_tr_b16 v[54:55], v8 offset:2304
  v_bitop3_b32 v81, v81, v119, v120 bitop3:0x80
  s_waitcnt lgkmcnt(6)
  v_mfma_f32_32x32x16_bf16 v[16:31], v[72:75], v[220:223], v[16:31]
  ds_read_b64_tr_b16 v[56:57], v8 offset:1024
  v_bitop3_b32 v81, v81, v121, v122 bitop3:0x80
  ds_read_b64_tr_b16 v[58:59], v8 offset:3072
  v_bitop3_b32 v81, v81, v123, v124 bitop3:0x80
  s_waitcnt lgkmcnt(6)
  v_mfma_f32_32x32x16_bf16 v[32:47], v[76:79], v[220:223], v[32:47]
  ds_read_b64_tr_b16 v[60:61], v8 offset:1280
  v_bitop3_b32 v81, v81, v125, v126 bitop3:0x80
  ds_read_b64_tr_b16 v[62:63], v8 offset:3328
  v_bitop3_b32 v81, v81, v127, 1 bitop3:0x80
  v_cmp_eq_u32 vcc, 0, v81
  s_nop 0
  s_cmp_lg_u64 vcc, 0
  s_cbranch_scc1 K3_retry4
K3_retry4_ret:
  buffer_load_dwordx4 v[216:219], v12, s[28:31], s48 offen offset:3072
  buffer_load_dwordx4 v[220:223], v12, s[28:31], s48 offen offset:3584
  s_add_u32 s48, s48, 4096
  s_waitcnt lgkmcnt(6)
  v_mfma_f32_32x32x16_bf16 v[16:31], v[48:51], v[96:99], v[16:31]
  ds_read_b64_tr_b16 v[64:65], v8 offset:4096
  ds_read_b64_tr_b16 v[66:67], v8 offset:6144
  s_waitcnt lgkmcnt(6)
  v_mfma_f32_32x32x16_bf16 v[32:47], v[52:55], v[96:99], v[32:47]
  ds_read_b64_tr_b16 v[68:69], v8 offset:4352
  ds_read_b64_tr_b16 v[70:71], v8 offset:6400
  s_waitcnt lgkmcnt(6)
  v_mfma_f32_32x32x16_bf16 v[16:31], v[56:59], v[100:103], v[16:31]
  ds_read_b64_tr_b16 v[72:73], v8 offset:5120
  ds_read_b64_tr_b16 v[74:75], v8 offset:7168
  s_waitcnt lgkmcnt(6)
  v_mfma_f32_32x32x16_bf16 v[32:47], v[60:63], v[100:103], v[32:47]
  ds_read_b64_tr_b16 v[76:77], v8 offset:5376
  ds_read_b64_tr_b16 v[78:79], v8 offset:7424
  s_waitcnt lgkmcnt(6)
  v_mfma_f32_32x32x16_bf16 v[16:31], v[64:67], v[104:107], v[16:31]
  ds_read_b64_tr_b16 v[48:49], v8 offset:8192
  ds_read_b64_tr_b16 v[50:51], v8 offset:10240
  s_waitcnt lgkmcnt(6)
  v_mfma_f32_32x32x16_bf16 v[32:47], v[68:71], v[104:107], v[32:47]
  ds_read_b64_tr_b16 v[52:53], v8 offset:8448
  ds_read_b64_tr_b16 v[54:55], v8 offset:10496
  s_waitcnt lgkmcnt(6)
  v_mfma_f32_32x32x16_bf16 v[16:31], v[72:75], v[108:111], v[16:31]
  ds_read_b64_tr_b16 v[56:57], v8 offset:9216
  ds_read_b64_tr_b16 v[58:59], v8 offset:11264
  s_waitcnt lgkmcnt(6)
  v_mfma_f32_32x32x16_bf16 v[32:47], v[76:79], v[108:111], v[32:47]
  ds_read_b64_tr_b16 v[60:61], v8 offset:9472
  ds_read_b64_tr_b16 v[62:63], v8 offset:11520
  s_waitcnt vmcnt(16)
  s_waitcnt lgkmcnt(6)
  v_mfma_f32_32x32x16_bf16 v[16:31], v[48:51], v[112:115], v[16:31]
  ds_read_b64_tr_b16 v[64:65], v8 offset:12288
  v_bitop3_b32 v81, v128, v129, v130 bitop3:0x80
  ds_read_b64_tr_b16 v[66:67], v8 offset:14336
  v_bitop3_b32 v81, v81, v131, v132 bitop3:0x80
  s_waitcnt lgkmcnt(6)
  v_mfma_f32_32x32x16_bf16 v[32:47], v[52:55], v[112:115], v[32:47]
  ds_read_b64_tr_b16 v[68:69], v8 offset:12544
  v_bitop3_b32 v81, v81, v133, v134 bitop3:0x80
  ds_read_b64_tr_b16 v[70:71], v8 offset:14592
  v_bitop3_b32 v81, v81, v135, v136 bitop3:0x80
  s_waitcnt lgkmcnt(6)
  v_mfma_f32_32x32x16_bf16 v[16:31], v[56:59], v[116:119], v[16:31]
  ds_read_b64_tr_b16 v[72:73], v8 offset:13312
  v_bitop3_b32 v81, v81, v137, v138 bitop3:0x80
  ds_read_b64_tr_b16 v[74:75], v8 offset:15360
  v_bitop3_b32 v81, v81, v139, v140 bitop3:0x80
  s_waitcnt lgkmcnt(6)
  v_mfma_f32_32x32x16_bf16 v[32:47], v[60:63], v[116:119], v[32:47]
  ds_read_b64_tr_b16 v[76:77], v8 offset:13568
  v_bitop3_b32 v81, v81, v141, v142 bitop3:0x80
  ds_read_b64_tr_b16 v[78:79], v8 offset:15616
  v_bitop3_b32 v81, v81, v143, v144 bitop3:0x80
  s_waitcnt lgkmcnt(6)
  v_mfma_f32_32x32x16_bf16 v[16:31], v[64:67], v[120:123], v[16:31]
  ds_read_b64_tr_b16 v[48:49], v8 offset:16384
  v_bitop3_b32 v81, v81, v145, v146 bitop3:0x80
  ds_read_b64_tr_b16 v[50:51], v8 offset:18432
  v_bitop3_b32 v81, v81, v147, v148 bitop3:0x80
  s_waitcnt lgkmcnt(6)
  v_mfma_f32_32x32x16_bf16 v[32:47], v[68:71], v[120:123], v[32:47]
  ds_read_b64_tr_b16 v[52:53], v8 offset:16640
  v_bitop3_b32 v81, v81, v149, v150 bitop3:0x80
  ds_read_b64_tr_b16 v[54:55], v8 offset:18688
  v_bitop3_b32 v81, v81, v151, v152 bitop3:0x80
  s_waitcnt lgkmcnt(6)
  v_mfma_f32_32x32x16_bf16 v[16:31], v[72:75], v[124:127], v[16:31]
  ds_read_b64_tr_b16 v[56:57], v8 offset:17408
  v_bitop3_b32 v81, v81, v153, v154 bitop3:0x80
  ds_read_b64_tr_b16 v[58:59], v8 offset:19456
  v_bitop3_b32 v81, v81, v155, v156 bitop3:0x80
  s_waitcnt lgkmcnt(6)
  v_mfma_f32_32x32x16_bf16 v[32:47], v[76:79], v[124:127], v[32:47]
  ds_read_b64_tr_b16 v[60:61], v8 offset:17664
  v_bitop3_b32 v81, v81, v157, v158 bitop3:0x80
  ds_read_b64_tr_b16 v[62:63], v8 offset:19712
  v_bitop3_b32 v81, v81, v159, 1 bitop3:0x80
  v_cmp_eq_u32 vcc, 0, v81
  s_nop 0
  s_cmp_lg_u64 vcc, 0
  s_cbranch_scc1 K3_retry5
K3_retry5_ret:
  s_waitcnt lgkmcnt(6)
  v_mfma_f32_32x32x16_bf16 v[16:31], v[48:51], v[128:131], v[16:31]
  ds_read_b64_tr_b16 v[64:65], v8 offset:20480
  ds_read_b64_tr_b16 v[66:67], v8 offset:22528
  s_waitcnt lgkmcnt(6)
  v_mfma_f32_32x32x16_bf16 v[32:47], v[52:55], v[128:131], v[32:47]
  ds_read_b64_tr_b16 v[68:69], v8 offset:20736
  ds_read_b64_tr_b16 v[70:71], v8 offset:22784
  s_waitcnt lgkmcnt(6)
  v_mfma_f32_32x32x16_bf16 v[16:31], v[56:59], v[132:135], v[16:31]
  ds_read_b64_tr_b16 v[72:73], v8 offset:21504
  ds_read_b64_tr_b16 v[74:75], v8 offset:23552
  s_waitcnt lgkmcnt(6)
  v_mfma_f32_32x32x16_bf16 v[32:47], v[60:63], v[132:135], v[32:47]
  ds_read_b64_tr_b16 v[76:77], v8 offset:21760
  ds_read_b64_tr_b16 v[78:79], v8 offset:23808
  s_waitcnt lgkmcnt(6)
  v_mfma_f32_32x32x16_bf16 v[16:31], v[64:67], v[136:139], v[16:31]
  ds_read_b64_tr_b16 v[48:49], v8 offset:24576
  ds_read_b64_tr_b16 v[50:51], v8 offset:26624
  s_waitcnt lgkmcnt(6)
  v_mfma_f32_32x32x16_bf16 v[32:47], v[68:71], v[136:139], v[32:47]
  ds_read_b64_tr_b16 v[52:53], v8 offset:24832
  ds_read_b64_tr_b16 v[54:55], v8 offset:26880
  s_waitcnt lgkmcnt(6)
  v_mfma_f32_32x32x16_bf16 v[16:31], v[72:75], v[140:143], v[16:31]
  ds_read_b64_tr_b16 v[56:57], v8 offset:25600
  ds_read_b64_tr_b16 v[58:59], v8 offset:27648
  s_waitcnt lgkmcnt(6)
  v_mfma_f32_32x32x16_bf16 v[32:47], v[76:79], v[140:143], v[32:47]
  ds_read_b64_tr_b16 v[60:61], v8 offset:25856
  ds_read_b64_tr_b16 v[62:63], v8 offset:27904
  s_waitcnt vmcnt(8)
  s_waitcnt lgkmcnt(6)
  v_mfma_f32_32x32x16_bf16 v[16:31], v[48:51], v[144:147], v[16:31]
  ds_read_b64_tr_b16 v[64:65], v8 offset:28672
  v_bitop3_b32 v81, v160, v161, v162 bitop3:0x80
  ds_read_b64_tr_b16 v[66:67], v8 offset:30720
  v_bitop3_b32 v81, v81, v163, v164 bitop3:0x80
  s_waitcnt lgkmcnt(6)
  v_mfma_f32_32x32x16_bf16 v[32:47], v[52:55], v[144:147], v[32:47]
  ds_read_b64_tr_b16 v[68:69], v8 offset:28928
  v_bitop3_b32 v81, v81, v165, v166 bitop3:0x80
  ds_read_b64_tr_b16 v[70:71], v8 offset:30976
  v_bitop3_b32 v81, v81, v167, v168 bitop3:0x80
  s_waitcnt lgkmcnt(6)
  v_mfma_f32_32x32x16_bf16 v[16:31], v[56:59], v[148:151], v[16:31]
  ds_read_b64_tr_b16 v[72:73], v8 offset:29696
  v_bitop3_b32 v81, v81, v169, v170 bitop3:0x80
  ds_read_b64_tr_b16 v[74:75], v8 offset:31744
  v_bitop3_b32 v81, v81, v171, v172 bitop3:0x80
  s_waitcnt lgkmcnt(6)
  v_mfma_f32_32x32x16_bf16 v[32:47], v[60:63], v[148:151], v[32:47]
  ds_read_b64_tr_b16 v[76:77], v8 offset:29952
  v_bitop3_b32 v81, v81, v173, v174 bitop3:0x80
  ds_read_b64_tr_b16 v[78:79], v8 offset:32000
  v_bitop3_b32 v81, v81, v175, v176 bitop3:0x80
  s_waitcnt lgkmcnt(6)
  v_mfma_f32_32x32x16_bf16 v[16:31], v[64:67], v[152:155], v[16:31]
  ds_read_b64_tr_b16 v[48:49], v8 offset:32768
  v_bitop3_b32 v81, v81, v177, v178 bitop3:0x80
  ds_read_b64_tr_b16 v[50:51], v8 offset:34816
  v_bitop3_b32 v81, v81, v179, v180 bitop3:0x80
  s_waitcnt lgkmcnt(6)
  v_mfma_f32_32x32x16_bf16 v[32:47], v[68:71], v[152:155], v[32:47]
  ds_read_b64_tr_b16 v[52:53], v8 offset:33024
  v_bitop3_b32 v81, v81, v181, v182 bitop3:0x80
  ds_read_b64_tr_b16 v[54:55], v8 offset:35072
  v_bitop3_b32 v81, v81, v183, v184 bitop3:0x80
  s_waitcnt lgkmcnt(6)
  v_mfma_f32_32x32x16_bf16 v[16:31], v[72:75], v[156:159], v[16:31]
  ds_read_b64_tr_b16 v[56:57], v8 offset:33792
  v_bitop3_b32 v81, v81, v185, v186 bitop3:0x80
  ds_read_b64_tr_b16 v[58:59], v8 offset:35840
  v_bitop3_b32 v81, v81, v187, v188 bitop3:0x80
  s_waitcnt lgkmcnt(6)
  v_mfma_f32_32x32x16_bf16 v[32:47], v[76:79], v[156:159], v[32:47]
  ds_read_b64_tr_b16 v[60:61], v8 offset:34048
  v_bitop3_b32 v81, v81, v189, v190 bitop3:0x80
  ds_read_b64_tr_b16 v[62:63], v8 offset:36096
  v_bitop3_b32 v81, v81, v191, 1 bitop3:0x80
  v_cmp_eq_u32 vcc, 0, v81
  s_nop 0
  s_cmp_lg_u64 vcc, 0
  s_cbranch_scc1 K3_retry6
K3_retry6_ret:
  s_waitcnt lgkmcnt(6)
  v_mfma_f32_32x32x16_bf16 v[16:31], v[48:51], v[160:163], v[16:31]
  ds_read_b64_tr_b16 v[64:65], v8 offset:36864
  ds_read_b64_tr_b16 v[66:67], v8 offset:38912
  s_waitcnt lgkmcnt(6)
  v_mfma_f32_32x32x16_bf16 v[32:47], v[52:55], v[160:163], v[32:47]
  ds_read_b64_tr_b16 v[68:69], v8 offset:37120
  ds_read_b64_tr_b16 v[70:71], v8 offset:39168
  s_waitcnt lgkmcnt(6)
  v_mfma_f32_32x32x16_bf16 v[16:31], v[56:59], v[164:167], v[16:31]
  ds_read_b64_tr_b16 v[72:73], v8 offset:37888
  ds_read_b64_tr_b16 v[74:75], v8 offset:39936
  s_waitcnt lgkmcnt(6)
  v_mfma_f32_32x32x16_bf16 v[32:47], v[60:63], v[164:167], v[32:47]
  ds_read_b64_tr_b16 v[76:77], v8 offset:38144
  ds_read_b64_tr_b16 v[78:79], v8 offset:40192
  s_waitcnt lgkmcnt(6)
  v_mfma_f32_32x32x16_bf16 v[16:31], v[64:67], v[168:171], v[16:31]
  ds_read_b64_tr_b16 v[48:49], v8 offset:40960
  ds_read_b64_tr_b16 v[50:51], v8 offset:43008
  s_waitcnt lgkmcnt(6)
  v_mfma_f32_32x32x16_bf16 v[32:47], v[68:71], v[168:171], v[32:47]
  ds_read_b64_tr_b16 v[52:53], v8 offset:41216
  ds_read_b64_tr_b16 v[54:55], v8 offset:43264
  s_waitcnt lgkmcnt(6)
  v_mfma_f32_32x32x16_bf16 v[16:31], v[72:75], v[172:175], v[16:31]
  ds_read_b64_tr_b16 v[56:57], v8 offset:41984
  ds_read_b64_tr_b16 v[58:59], v8 offset:44032
  s_waitcnt lgkmcnt(6)
  v_mfma_f32_32x32x16_bf16 v[32:47], v[76:79], v[172:175], v[32:47]
  ds_read_b64_tr_b16 v[60:61], v8 offset:42240
  ds_read_b64_tr_b16 v[62:63], v8 offset:44288
  s_waitcnt vmcnt(0)
  s_waitcnt lgkmcnt(6)
  v_mfma_f32_32x32x16_bf16 v[16:31], v[48:51], v[176:179], v[16:31]
  ds_read_b64_tr_b16 v[64:65], v8 offset:45056
  v_bitop3_b32 v81, v192, v193, v194 bitop3:0x80
  ds_read_b64_tr_b16 v[66:67], v8 offset:47104
  v_bitop3_b32 v81, v81, v195, v196 bitop3:0x80
  s_waitcnt lgkmcnt(6)
  v_mfma_f32_32x32x16_bf16 v[32:47], v[52:55], v[176:179], v[32:47]
  ds_read_b64_tr_b16 v[68:69], v8 offset:45312
  v_bitop3_b32 v81, v81, v197, v198 bitop3:0x80
  ds_read_b64_tr_b16 v[70:71], v8 offset:47360
  v_bitop3_b32 v81, v81, v199, v200 bitop3:0x80
  s_waitcnt lgkmcnt(6)
  v_mfma_f32_32x32x16_bf16 v[16:31], v[56:59], v[180:183], v[16:31]
  ds_read_b64_tr_b16 v[72:73], v8 offset:46080
  v_bitop3_b32 v81, v81, v201, v202 bitop3:0x80
  ds_read_b64_tr_b16 v[74:75], v8 offset:48128
  v_bitop3_b32 v81, v81, v203, v204 bitop3:0x80
  s_waitcnt lgkmcnt(6)
  v_mfma_f32_32x32x16_bf16 v[32:47], v[60:63], v[180:183], v[32:47]
  ds_read_b64_tr_b16 v[76:77], v8 offset:46336
  v_bitop3_b32 v81, v81, v205, v206 bitop3:0x80
  ds_read_b64_tr_b16 v[78:79], v8 offset:48384
  v_bitop3_b32 v81, v81, v207, v208 bitop3:0x80
  s_waitcnt lgkmcnt(6)
  v_mfma_f32_32x32x16_bf16 v[16:31], v[64:67], v[184:187], v[16:31]
  ds_read_b64_tr_b16 v[48:49], v13 offset:0
  v_bitop3_b32 v81, v81, v209, v210 bitop3:0x80
  ds_read_b64_tr_b16 v[50:51], v13 offset:2048
  v_bitop3_b32 v81, v81, v211, v212 bitop3:0x80
  s_waitcnt lgkmcnt(6)
  v_mfma_f32_32x32x16_bf16 v[32:47], v[68:71], v[184:187], v[32:47]
  ds_read_b64_tr_b16 v[52:53], v13 offset:256
  v_bitop3_b32 v81, v81, v213, v214 bitop3:0x80
  ds_read_b64_tr_b16 v[54:55], v13 offset:2304
  v_bitop3_b32 v81, v81, v215, v216 bitop3:0x80
  s_waitcnt lgkmcnt(6)
  v_mfma_f32_32x32x16_bf16 v[16:31], v[72:75], v[188:191], v[16:31]
  ds_read_b64_tr_b16 v[56:57], v13 offset:1024
  v_bitop3_b32 v81, v81, v217, v218 bitop3:0x80
  ds_read_b64_tr_b16 v[58:59], v13 offset:3072
  v_bitop3_b32 v81, v81, v219, v220 bitop3:0x80
  s_waitcnt lgkmcnt(6)
  v_mfma_f32_32x32x16_bf16 v[32:47], v[76:79], v[188:191], v[32:47]
  ds_read_b64_tr_b16 v[60:61], v13 offset:1280
  v_bitop3_b32 v81, v81, v221, v222 bitop3:0x80
  ds_read_b64_tr_b16 v[62:63], v13 offset:3328
  v_bitop3_b32 v81, v81, v223, 1 bitop3:0x80
  v_cmp_eq_u32 vcc, 0, v81
  s_nop 0
  s_cmp_lg_u64 vcc, 0
  s_cbranch_scc1 K3_retry7
K3_retry7_ret:
  s_waitcnt lgkmcnt(6)
  v_mfma_f32_32x32x16_bf16 v[16:31], v[48:51], v[192:195], v[16:31]
  ds_read_b64_tr_b16 v[64:65], v13 offset:8704
  ds_read_b64_tr_b16 v[66:67], v13 offset:10752
  s_waitcnt lgkmcnt(6)
  v_mfma_f32_32x32x16_bf16 v[32:47], v[52:55], v[192:195], v[32:47]
  ds_read_b64_tr_b16 v[68:69], v13 offset:8960
  ds_read_b64_tr_b16 v[70:71], v13 offset:11008
  s_waitcnt lgkmcnt(6)
  v_mfma_f32_32x32x16_bf16 v[16:31], v[56:59], v[196:199], v[16:31]
  ds_read_b64_tr_b16 v[72:73], v13 offset:9728
  ds_read_b64_tr_b16 v[74:75], v13 offset:11776
  s_waitcnt lgkmcnt(6)
  v_mfma_f32_32x32x16_bf16 v[32:47], v[60:63], v[196:199], v[32:47]
  ds_read_b64_tr_b16 v[76:77], v13 offset:9984
  ds_read_b64_tr_b16 v[78:79], v13 offset:12032
  s_waitcnt lgkmcnt(6)
  v_mfma_f32_32x32x16_bf16 v[16:31], v[64:67], v[200:203], v[16:31]
  ds_read_b64_tr_b16 v[48:49], v13 offset:17408
  ds_read_b64_tr_b16 v[50:51], v13 offset:19456
  s_waitcnt lgkmcnt(6)
  v_mfma_f32_32x32x16_bf16 v[32:47], v[68:71], v[200:203], v[32:47]
  ds_read_b64_tr_b16 v[52:53], v13 offset:17664
  ds_read_b64_tr_b16 v[54:55], v13 offset:19712
  s_waitcnt lgkmcnt(6)
  v_mfma_f32_32x32x16_bf16 v[16:31], v[72:75], v[204:207], v[16:31]
  ds_read_b64_tr_b16 v[56:57], v13 offset:18432
  ds_read_b64_tr_b16 v[58:59], v13 offset:20480
  s_waitcnt lgkmcnt(6)
  v_mfma_f32_32x32x16_bf16 v[32:47], v[76:79], v[204:207], v[32:47]
  ds_read_b64_tr_b16 v[60:61], v13 offset:18688
  ds_read_b64_tr_b16 v[62:63], v13 offset:20736
  s_waitcnt lgkmcnt(6)
  v_mfma_f32_32x32x16_bf16 v[16:31], v[48:51], v[208:211], v[16:31]
  ds_read_b64_tr_b16 v[64:65], v13 offset:26112
  ds_read_b64_tr_b16 v[66:67], v13 offset:28160
  s_waitcnt lgkmcnt(6)
  v_mfma_f32_32x32x16_bf16 v[32:47], v[52:55], v[208:211], v[32:47]
  ds_read_b64_tr_b16 v[68:69], v13 offset:26368
  ds_read_b64_tr_b16 v[70:71], v13 offset:28416
  s_waitcnt lgkmcnt(6)
  v_mfma_f32_32x32x16_bf16 v[16:31], v[56:59], v[212:215], v[16:31]
  ds_read_b64_tr_b16 v[72:73], v13 offset:27136
  ds_read_b64_tr_b16 v[74:75], v13 offset:29184
  s_waitcnt lgkmcnt(6)
  v_mfma_f32_32x32x16_bf16 v[32:47], v[60:63], v[212:215], v[32:47]
  ds_read_b64_tr_b16 v[76:77], v13 offset:27392
  ds_read_b64_tr_b16 v[78:79], v13 offset:29440
  s_waitcnt lgkmcnt(6)
  v_mfma_f32_32x32x16_bf16 v[16:31], v[64:67], v[216:219], v[16:31]
  s_waitcnt lgkmcnt(4)
  v_mfma_f32_32x32x16_bf16 v[32:47], v[68:71], v[216:219], v[32:47]
  s_waitcnt lgkmcnt(2)
  v_mfma_f32_32x32x16_bf16 v[16:31], v[72:75], v[220:223], v[16:31]
  s_waitcnt lgkmcnt(0)
  v_mfma_f32_32x32x16_bf16 v[32:47], v[76:79], v[220:223], v[32:47]
  v_and_b32 v4, 31, v2
  v_lshlrev_b32 v4, 12, v4
  v_lshl_add_u32 v4, v5, 4, v4
  s_lshr_b32 s36, s10, 2
  s_lshl_b32 s36, s36, 3
  s_lshr_b32 s37, s11, 2
  s_add_u32 s36, s36, s37
  s_lshl_b32 s38, s41, 16
  s_lshl_b32 s39, s36, 7
  s_add_u32 s38, s38, s39
  s_add_u32 s38, s38, 2048
  v_cvt_pk_bf16_f32 v80, v16, v17
  v_cvt_pk_bf16_f32 v81, v18, v19
  v_cvt_pk_bf16_f32 v82, v20, v21
  v_cvt_pk_bf16_f32 v83, v22, v23
  s_nop 0
  v_permlane32_swap_b32 v80, v82
  v_permlane32_swap_b32 v81, v83
  buffer_store_dwordx4 v[80:83], v4, s[32:35], s38 offen offset:0
  v_cvt_pk_bf16_f32 v84, v24, v25
  v_cvt_pk_bf16_f32 v85, v26, v27
  v_cvt_pk_bf16_f32 v86, v28, v29
  v_cvt_pk_bf16_f32 v87, v30, v31
  s_nop 0
  v_permlane32_swap_b32 v84, v86
  v_permlane32_swap_b32 v85, v87
  buffer_store_dwordx4 v[84:87], v4, s[32:35], s38 offen offset:32
  v_cvt_pk_bf16_f32 v88, v32, v33
  v_cvt_pk_bf16_f32 v89, v34, v35
  v_cvt_pk_bf16_f32 v90, v36, v37
  v_cvt_pk_bf16_f32 v91, v38, v39
  s_nop 0
  v_permlane32_swap_b32 v88, v90
  v_permlane32_swap_b32 v89, v91
  buffer_store_dwordx4 v[88:91], v4, s[32:35], s38 offen offset:64
  v_cvt_pk_bf16_f32 v92, v40, v41
  v_cvt_pk_bf16_f32 v93, v42, v43
  v_cvt_pk_bf16_f32 v94, v44, v45
  v_cvt_pk_bf16_f32 v95, v46, v47
  s_nop 0
  v_permlane32_swap_b32 v92, v94
  v_permlane32_swap_b32 v93, v95
  buffer_store_dwordx4 v[92:95], v4, s[32:35], s38 offen offset:96
  s_endpgm
K3_retry0:
  s_mov_b32 s46, 4000
  s_add_u32 s44, s47, 0
K3_retry0_l:
  s_add_u32 s75, s75, 1
  s_sleep 4
  buffer_load_dwordx4 v[96:99], v12, s[28:31], s44 offen offset:0 sc1
  buffer_load_dwordx4 v[100:103], v12, s[28:31], s44 offen offset:512 sc1
  buffer_load_dwordx4 v[104:107], v12, s[28:31], s44 offen offset:1024 sc1
  buffer_load_dwordx4 v[108:111], v12, s[28:31], s44 offen offset:1536 sc1
  buffer_load_dwordx4 v[112:115], v12, s[28:31], s44 offen offset:2048 sc1
  buffer_load_dwordx4 v[116:119], v12, s[28:31], s44 offen offset:2560 sc1
  buffer_load_dwordx4 v[120:123], v12, s[28:31], s44 offen offset:3072 sc1
  buffer_load_dwordx4 v[124:127], v12, s[28:31], s44 offen offset:3584 sc1
  s_waitcnt vmcnt(0)
  v_bitop3_b32 v81, v96, v97, v98 bitop3:0x80
  v_bitop3_b32 v81, v81, v99, v100 bitop3:0x80
  v_bitop3_b32 v81, v81, v101, v102 bitop3:0x80
  v_bitop3_b32 v81, v81, v103, v104 bitop3:0x80
  v_bitop3_b32 v81, v81, v105, v106 bitop3:0x80
  v_bitop3_b32 v81, v81, v107, v108 bitop3:0x80
  v_bitop3_b32 v81, v81, v109, v110 bitop3:0x80
  v_bitop3_b32 v81, v81, v111, v112 bitop3:0x80
  v_bitop3_b32 v81, v81, v113, v114 bitop3:0x80
  v_bitop3_b32 v81, v81, v115, v116 bitop3:0x80
  v_bitop3_b32 v81, v81, v117, v118 bitop3:0x80
  v_bitop3_b32 v81, v81, v119, v120 bitop3:0x80
  v_bitop3_b32 v81, v81, v121, v122 bitop3:0x80
  v_bitop3_b32 v81, v81, v123, v124 bitop3:0x80
  v_bitop3_b32 v81, v81, v125, v126 bitop3:0x80
  v_bitop3_b32 v81, v81, v127, 1 bitop3:0x80
  v_cmp_eq_u32 vcc, 0, v81
  s_sub_u32 s46, s46, 1
  s_cbranch_scc1 K3_retry0_ret
  s_cmp_lg_u64 vcc, 0
  s_cbranch_scc1 K3_retry0_l
  s_branch K3_retry0_ret
K3_retry1:
  s_mov_b32 s46, 4000
  s_add_u32 s44, s47, 4096
K3_retry1_l:
  s_add_u32 s75, s75, 1
  s_sleep 4
  buffer_load_dwordx4 v[128:131], v12, s[28:31], s44 offen offset:0 sc1
  buffer_load_dwordx4 v[132:135], v12, s[28:31], s44 offen offset:512 sc1
  buffer_load_dwordx4 v[136:139], v12, s[28:31], s44 offen offset:1024 sc1
  buffer_load_dwordx4 v[140:143], v12, s[28:31], s44 offen offset:1536 sc1
  buffer_load_dwordx4 v[144:147], v12, s[28:31], s44 offen offset:2048 sc1
  buffer_load_dwordx4 v[148:151], v12, s[28:31], s44 offen offset:2560 sc1
  buffer_load_dwordx4 v[152:155], v12, s[28:31], s44 offen offset:3072 sc1
  buffer_load_dwordx4 v[156:159], v12, s[28:31], s44 offen offset:3584 sc1
  s_waitcnt vmcnt(0)
  v_bitop3_b32 v81, v128, v129, v130 bitop3:0x80
  v_bitop3_b32 v81, v81, v131, v132 bitop3:0x80
  v_bitop3_b32 v81, v81, v133, v134 bitop3:0x80
  v_bitop3_b32 v81, v81, v135, v136 bitop3:0x80
  v_bitop3_b32 v81, v81, v137, v138 bitop3:0x80
  v_bitop3_b32 v81, v81, v139, v140 bitop3:0x80
  v_bitop3_b32 v81, v81, v141, v142 bitop3:0x80
  v_bitop3_b32 v81, v81, v143, v144 bitop3:0x80
  v_bitop3_b32 v81, v81, v145, v146 bitop3:0x80
  v_bitop3_b32 v81, v81, v147, v148 bitop3:0x80
  v_bitop3_b32 v81, v81, v149, v150 bitop3:0x80
  v_bitop3_b32 v81, v81, v151, v152 bitop3:0x80
  v_bitop3_b32 v81, v81, v153, v154 bitop3:0x80
  v_bitop3_b32 v81, v81, v155, v156 bitop3:0x80
  v_bitop3_b32 v81, v81, v157, v158 bitop3:0x80
  v_bitop3_b32 v81, v81, v159, 1 bitop3:0x80
  v_cmp_eq_u32 vcc, 0, v81
  s_sub_u32 s46, s46, 1
  s_cbranch_scc1 K3_retry1_ret
  s_cmp_lg_u64 vcc, 0
  s_cbranch_scc1 K3_retry1_l
  s_branch K3_retry1_ret
K3_retry2:
  s_mov_b32 s46, 4000
  s_add_u32 s44, s47, 8192
K3_retry2_l:
  s_add_u32 s75, s75, 1
  s_sleep 4
  buffer_load_dwordx4 v[160:163], v12, s[28:31], s44 offen offset:0 sc1
  buffer_load_dwordx4 v[164:167], v12, s[28:31], s44 offen offset:512 sc1
  buffer_load_dwordx4 v[168:171], v12, s[28:31], s44 offen offset:1024 sc1
  buffer_load_dwordx4 v[172:175], v12, s[28:31], s44 offen offset:1536 sc1
  buffer_load_dwordx4 v[176:179], v12, s[28:31], s44 offen offset:2048 sc1
  buffer_load_dwordx4 v[180:183], v12, s[28:31], s44 offen offset:2560 sc1
  buffer_load_dwordx4 v[184:187], v12, s[28:31], s44 offen offset:3072 sc1
  buffer_load_dwordx4 v[188:191], v12, s[28:31], s44 offen offset:3584 sc1
  s_waitcnt vmcnt(0)
  v_bitop3_b32 v81, v160, v161, v162 bitop3:0x80
  v_bitop3_b32 v81, v81, v163, v164 bitop3:0x80
  v_bitop3_b32 v81, v81, v165, v166 bitop3:0x80
  v_bitop3_b32 v81, v81, v167, v168 bitop3:0x80
  v_bitop3_b32 v81, v81, v169, v170 bitop3:0x80
  v_bitop3_b32 v81, v81, v171, v172 bitop3:0x80
  v_bitop3_b32 v81, v81, v173, v174 bitop3:0x80
  v_bitop3_b32 v81, v81, v175, v176 bitop3:0x80
  v_bitop3_b32 v81, v81, v177, v178 bitop3:0x80
  v_bitop3_b32 v81, v81, v179, v180 bitop3:0x80
  v_bitop3_b32 v81, v81, v181, v182 bitop3:0x80
  v_bitop3_b32 v81, v81, v183, v184 bitop3:0x80
  v_bitop3_b32 v81, v81, v185, v186 bitop3:0x80
  v_bitop3_b32 v81, v81, v187, v188 bitop3:0x80
  v_bitop3_b32 v81, v81, v189, v190 bitop3:0x80
  v_bitop3_b32 v81, v81, v191, 1 bitop3:0x80
  v_cmp_eq_u32 vcc, 0, v81
  s_sub_u32 s46, s46, 1
  s_cbranch_scc1 K3_retry2_ret
  s_cmp_lg_u64 vcc, 0
  s_cbranch_scc1 K3_retry2_l
  s_branch K3_retry2_ret
K3_retry3:
  s_mov_b32 s46, 4000
  s_add_u32 s44, s47, 12288
K3_retry3_l:
  s_add_u32 s75, s75, 1
  s_sleep 4
  buffer_load_dwordx4 v[192:195], v12, s[28:31], s44 offen offset:0 sc1
  buffer_load_dwordx4 v[196:199], v12, s[28:31], s44 offen offset:512 sc1
  buffer_load_dwordx4 v[200:203], v12, s[28:31], s44 offen offset:1024 sc1
  buffer_load_dwordx4 v[204:207], v12, s[28:31], s44 offen offset:1536 sc1
  buffer_load_dwordx4 v[208:211], v12, s[28:31], s44 offen offset:2048 sc1
  buffer_load_dwordx4 v[212:215], v12, s[28:31], s44 offen offset:2560 sc1
  buffer_load_dwordx4 v[216:219], v12, s[28:31], s44 offen offset:3072 sc1
  buffer_load_dwordx4 v[220:223], v12, s[28:31], s44 offen offset:3584 sc1
  s_waitcnt vmcnt(0)
  v_bitop3_b32 v81, v192, v193, v194 bitop3:0x80
  v_bitop3_b32 v81, v81, v195, v196 bitop3:0x80
  v_bitop3_b32 v81, v81, v197, v198 bitop3:0x80
  v_bitop3_b32 v81, v81, v199, v200 bitop3:0x80
  v_bitop3_b32 v81, v81, v201, v202 bitop3:0x80
  v_bitop3_b32 v81, v81, v203, v204 bitop3:0x80
  v_bitop3_b32 v81, v81, v205, v206 bitop3:0x80
  v_bitop3_b32 v81, v81, v207, v208 bitop3:0x80
  v_bitop3_b32 v81, v81, v209, v210 bitop3:0x80
  v_bitop3_b32 v81, v81, v211, v212 bitop3:0x80
  v_bitop3_b32 v81, v81, v213, v214 bitop3:0x80
  v_bitop3_b32 v81, v81, v215, v216 bitop3:0x80
  v_bitop3_b32 v81, v81, v217, v218 bitop3:0x80
  v_bitop3_b32 v81, v81, v219, v220 bitop3:0x80
  v_bitop3_b32 v81, v81, v221, v222 bitop3:0x80
  v_bitop3_b32 v81, v81, v223, 1 bitop3:0x80
  v_cmp_eq_u32 vcc, 0, v81
  s_sub_u32 s46, s46, 1
  s_cbranch_scc1 K3_retry3_ret
  s_cmp_lg_u64 vcc, 0
  s_cbranch_scc1 K3_retry3_l
  s_branch K3_retry3_ret
K3_retry4:
  s_mov_b32 s46, 4000
  s_add_u32 s44, s47, 16384
K3_retry4_l:
  s_add_u32 s75, s75, 1
  s_sleep 4
  buffer_load_dwordx4 v[96:99], v12, s[28:31], s44 offen offset:0 sc1
  buffer_load_dwordx4 v[100:103], v12, s[28:31], s44 offen offset:512 sc1
  buffer_load_dwordx4 v[104:107], v12, s[28:31], s44 offen offset:1024 sc1
  buffer_load_dwordx4 v[108:111], v12, s[28:31], s44 offen offset:1536 sc1
  buffer_load_dwordx4 v[112:115], v12, s[28:31], s44 offen offset:2048 sc1
  buffer_load_dwordx4 v[116:119], v12, s[28:31], s44 offen offset:2560 sc1
  buffer_load_dwordx4 v[120:123], v12, s[28:31], s44 offen offset:3072 sc1
  buffer_load_dwordx4 v[124:127], v12, s[28:31], s44 offen offset:3584 sc1
  s_waitcnt vmcnt(0)
  v_bitop3_b32 v81, v96, v97, v98 bitop3:0x80
  v_bitop3_b32 v81, v81, v99, v100 bitop3:0x80
  v_bitop3_b32 v81, v81, v101, v102 bitop3:0x80
  v_bitop3_b32 v81, v81, v103, v104 bitop3:0x80
  v_bitop3_b32 v81, v81, v105, v106 bitop3:0x80
  v_bitop3_b32 v81, v81, v107, v108 bitop3:0x80
  v_bitop3_b32 v81, v81, v109, v110 bitop3:0x80
  v_bitop3_b32 v81, v81, v111, v112 bitop3:0x80
  v_bitop3_b32 v81, v81, v113, v114 bitop3:0x80
  v_bitop3_b32 v81, v81, v115, v116 bitop3:0x80
  v_bitop3_b32 v81, v81, v117, v118 bitop3:0x80
  v_bitop3_b32 v81, v81, v119, v120 bitop3:0x80
  v_bitop3_b32 v81, v81, v121, v122 bitop3:0x80
  v_bitop3_b32 v81, v81, v123, v124 bitop3:0x80
  v_bitop3_b32 v81, v81, v125, v126 bitop3:0x80
  v_bitop3_b32 v81, v81, v127, 1 bitop3:0x80
  v_cmp_eq_u32 vcc, 0, v81
  s_sub_u32 s46, s46, 1
  s_cbranch_scc1 K3_retry4_ret
  s_cmp_lg_u64 vcc, 0
  s_cbranch_scc1 K3_retry4_l
  s_branch K3_retry4_ret
K3_retry5:
  s_mov_b32 s46, 4000
  s_add_u32 s44, s47, 20480
K3_retry5_l:
  s_add_u32 s75, s75, 1
  s_sleep 4
  buffer_load_dwordx4 v[128:131], v12, s[28:31], s44 offen offset:0 sc1
  buffer_load_dwordx4 v[132:135], v12, s[28:31], s44 offen offset:512 sc1
  buffer_load_dwordx4 v[136:139], v12, s[28:31], s44 offen offset:1024 sc1
  buffer_load_dwordx4 v[140:143], v12, s[28:31], s44 offen offset:1536 sc1
  buffer_load_dwordx4 v[144:147], v12, s[28:31], s44 offen offset:2048 sc1
  buffer_load_dwordx4 v[148:151], v12, s[28:31], s44 offen offset:2560 sc1
  buffer_load_dwordx4 v[152:155], v12, s[28:31], s44 offen offset:3072 sc1
  buffer_load_dwordx4 v[156:159], v12, s[28:31], s44 offen offset:3584 sc1
  s_waitcnt vmcnt(0)
  v_bitop3_b32 v81, v128, v129, v130 bitop3:0x80
  v_bitop3_b32 v81, v81, v131, v132 bitop3:0x80
  v_bitop3_b32 v81, v81, v133, v134 bitop3:0x80
  v_bitop3_b32 v81, v81, v135, v136 bitop3:0x80
  v_bitop3_b32 v81, v81, v137, v138 bitop3:0x80
  v_bitop3_b32 v81, v81, v139, v140 bitop3:0x80
  v_bitop3_b32 v81, v81, v141, v142 bitop3:0x80
  v_bitop3_b32 v81, v81, v143, v144 bitop3:0x80
  v_bitop3_b32 v81, v81, v145, v146 bitop3:0x80
  v_bitop3_b32 v81, v81, v147, v148 bitop3:0x80
  v_bitop3_b32 v81, v81, v149, v150 bitop3:0x80
  v_bitop3_b32 v81, v81, v151, v152 bitop3:0x80
  v_bitop3_b32 v81, v81, v153, v154 bitop3:0x80
  v_bitop3_b32 v81, v81, v155, v156 bitop3:0x80
  v_bitop3_b32 v81, v81, v157, v158 bitop3:0x80
  v_bitop3_b32 v81, v81, v159, 1 bitop3:0x80
  v_cmp_eq_u32 vcc, 0, v81
  s_sub_u32 s46, s46, 1
  s_cbranch_scc1 K3_retry5_ret
  s_cmp_lg_u64 vcc, 0
  s_cbranch_scc1 K3_retry5_l
  s_branch K3_retry5_ret
K3_retry6:
  s_mov_b32 s46, 4000
  s_add_u32 s44, s47, 24576
K3_retry6_l:
  s_add_u32 s75, s75, 1
  s_sleep 4
  buffer_load_dwordx4 v[160:163], v12, s[28:31], s44 offen offset:0 sc1
  buffer_load_dwordx4 v[164:167], v12, s[28:31], s44 offen offset:512 sc1
  buffer_load_dwordx4 v[168:171], v12, s[28:31], s44 offen offset:1024 sc1
  buffer_load_dwordx4 v[172:175], v12, s[28:31], s44 offen offset:1536 sc1
  buffer_load_dwordx4 v[176:179], v12, s[28:31], s44 offen offset:2048 sc1
  buffer_load_dwordx4 v[180:183], v12, s[28:31], s44 offen offset:2560 sc1
  buffer_load_dwordx4 v[184:187], v12, s[28:31], s44 offen offset:3072 sc1
  buffer_load_dwordx4 v[188:191], v12, s[28:31], s44 offen offset:3584 sc1
  s_waitcnt vmcnt(0)
  v_bitop3_b32 v81, v160, v161, v162 bitop3:0x80
  v_bitop3_b32 v81, v81, v163, v164 bitop3:0x80
  v_bitop3_b32 v81, v81, v165, v166 bitop3:0x80
  v_bitop3_b32 v81, v81, v167, v168 bitop3:0x80
  v_bitop3_b32 v81, v81, v169, v170 bitop3:0x80
  v_bitop3_b32 v81, v81, v171, v172 bitop3:0x80
  v_bitop3_b32 v81, v81, v173, v174 bitop3:0x80
  v_bitop3_b32 v81, v81, v175, v176 bitop3:0x80
  v_bitop3_b32 v81, v81, v177, v178 bitop3:0x80
  v_bitop3_b32 v81, v81, v179, v180 bitop3:0x80
  v_bitop3_b32 v81, v81, v181, v182 bitop3:0x80
  v_bitop3_b32 v81, v81, v183, v184 bitop3:0x80
  v_bitop3_b32 v81, v81, v185, v186 bitop3:0x80
  v_bitop3_b32 v81, v81, v187, v188 bitop3:0x80
  v_bitop3_b32 v81, v81, v189, v190 bitop3:0x80
  v_bitop3_b32 v81, v81, v191, 1 bitop3:0x80
  v_cmp_eq_u32 vcc, 0, v81
  s_sub_u32 s46, s46, 1
  s_cbranch_scc1 K3_retry6_ret
  s_cmp_lg_u64 vcc, 0
  s_cbranch_scc1 K3_retry6_l
  s_branch K3_retry6_ret
K3_retry7:
  s_mov_b32 s46, 4000
  s_add_u32 s44, s47, 28672
K3_retry7_l:
  s_add_u32 s75, s75, 1
  s_sleep 4
  buffer_load_dwordx4 v[192:195], v12, s[28:31], s44 offen offset:0 sc1
  buffer_load_dwordx4 v[196:199], v12, s[28:31], s44 offen offset:512 sc1
  buffer_load_dwordx4 v[200:203], v12, s[28:31], s44 offen offset:1024 sc1
  buffer_load_dwordx4 v[204:207], v12, s[28:31], s44 offen offset:1536 sc1
  buffer_load_dwordx4 v[208:211], v12, s[28:31], s44 offen offset:2048 sc1
  buffer_load_dwordx4 v[212:215], v12, s[28:31], s44 offen offset:2560 sc1
  buffer_load_dwordx4 v[216:219], v12, s[28:31], s44 offen offset:3072 sc1
  buffer_load_dwordx4 v[220:223], v12, s[28:31], s44 offen offset:3584 sc1
  s_waitcnt vmcnt(0)
  v_bitop3_b32 v81, v192, v193, v194 bitop3:0x80
  v_bitop3_b32 v81, v81, v195, v196 bitop3:0x80
  v_bitop3_b32 v81, v81, v197, v198 bitop3:0x80
  v_bitop3_b32 v81, v81, v199, v200 bitop3:0x80
  v_bitop3_b32 v81, v81, v201, v202 bitop3:0x80
  v_bitop3_b32 v81, v81, v203, v204 bitop3:0x80
  v_bitop3_b32 v81, v81, v205, v206 bitop3:0x80
  v_bitop3_b32 v81, v81, v207, v208 bitop3:0x80
  v_bitop3_b32 v81, v81, v209, v210 bitop3:0x80
  v_bitop3_b32 v81, v81, v211, v212 bitop3:0x80
  v_bitop3_b32 v81, v81, v213, v214 bitop3:0x80
  v_bitop3_b32 v81, v81, v215, v216 bitop3:0x80
  v_bitop3_b32 v81, v81, v217, v218 bitop3:0x80
  v_bitop3_b32 v81, v81, v219, v220 bitop3:0x80
  v_bitop3_b32 v81, v81, v221, v222 bitop3:0x80
  v_bitop3_b32 v81, v81, v223, 1 bitop3:0x80
  v_cmp_eq_u32 vcc, 0, v81
  s_sub_u32 s46, s46, 1
  s_cbranch_scc1 K3_retry7_ret
  s_cmp_lg_u64 vcc, 0
  s_cbranch_scc1 K3_retry7_l
  s_branch K3_retry7_ret
K3_event0:
  s_add_u32 s54, s54, 1
  s_cmp_lg_u32 s54, 1
  s_cbranch_scc1 K3_ev2_0
  buffer_load_dword v195, v192, s[40:43], s44 offen
  s_mov_b32 s55, s52
  s_branch K3_noev0
K3_ev2_0:
  buffer_load_dword v195, v193, s[48:51], s45 offen
  s_mov_b32 s55, 1000
  s_branch K3_noev0
K3_evB0:
  buffer_load_dword v195, v194, s[64:67], s68 offen
  buffer_load_dword v195, v194, s[64:67], s69 offen
  s_branch K3_noevB0
K3_evC0:
  s_add_u32 s53, s53, 1
  s_cmp_lg_u32 s53, 1
  s_cbranch_scc1 K3_ev4_0
  buffer_load_dword v196, v199, s[56:59], 0 offen sc1
  s_mov_b32 s71, 3
  s_branch K3_noevC0
K3_ev4_0:
  s_cmp_lg_u32 s53, 2
  s_cbranch_scc1 K3_ev6_0
  s_waitcnt vmcnt(0)
  v_readfirstlane_b32 s46, v196
  s_mov_b64 exec, 1
  s_cmp_lg_u32 s46, 0
  s_cbranch_scc1 K3_ev5_0
  v_mov_b32 v196, v198
  v_mov_b32 v197, 0
  buffer_atomic_cmpswap v[196:197], v199, s[56:59], 0 offen sc0 sc1
  s_waitcnt vmcnt(0)
  v_cmp_eq_u32 vcc, 0, v196
  s_nop 1
  v_cndmask_b32 v196, v196, v198, vcc
K3_ev5_0:
  buffer_store_dword v196, v199, s[60:63], s47 offen sc1
  s_mov_b64 exec, -1
  s_mov_b32 s71, 0
  s_branch K3_noevC0
K3_ev6_0:
  s_mov_b64 exec, 1
  buffer_store_dword v196, v199, s[60:63], s47 offen offset:32 sc1
  s_mov_b64 exec, -1
  s_mov_b32 s71, 1000
  s_branch K3_noevC0
K3_event1:
  s_add_u32 s54, s54, 1
  s_cmp_lg_u32 s54, 1
  s_cbranch_scc1 K3_ev2_1
  buffer_load_dword v195, v192, s[40:43], s44 offen
  s_mov_b32 s55, s52
  s_branch K3_noev1
K3_ev2_1:
  buffer_load_dword v195, v193, s[48:51], s45 offen
  s_mov_b32 s55, 1000
  s_branch K3_noev1
K3_evB1:
  buffer_load_dword v195, v194, s[64:67], s68 offen
  buffer_load_dword v195, v194, s[64:67], s69 offen
  s_branch K3_noevB1
K3_evC1:
  s_add_u32 s53, s53, 1
  s_cmp_lg_u32 s53, 1
  s_cbranch_scc1 K3_ev4_1
  buffer_load_dword v196, v199, s[56:59], 0 offen sc1
  s_mov_b32 s71, 3
  s_branch K3_noevC1
K3_ev4_1:
  s_cmp_lg_u32 s53, 2
  s_cbranch_scc1 K3_ev6_1
  s_waitcnt vmcnt(0)
  v_readfirstlane_b32 s46, v196
  s_mov_b64 exec, 1
  s_cmp_lg_u32 s46, 0
  s_cbranch_scc1 K3_ev5_1
  v_mov_b32 v196, v198
  v_mov_b32 v197, 0
  buffer_atomic_cmpswap v[196:197], v199, s[56:59], 0 offen sc0 sc1
  s_waitcnt vmcnt(0)
  v_cmp_eq_u32 vcc, 0, v196
  s_nop 1
  v_cndmask_b32 v196, v196, v198, vcc
K3_ev5_1:
  buffer_store_dword v196, v199, s[60:63], s47 offen sc1
  s_mov_b64 exec, -1
  s_mov_b32 s71, 0
  s_branch K3_noevC1
K3_ev6_1:
  s_mov_b64 exec, 1
  buffer_store_dword v196, v199, s[60:63], s47 offen offset:32 sc1
  s_mov_b64 exec, -1
  s_mov_b32 s71, 1000
  s_branch K3_noevC1
K3_event2:
  s_add_u32 s54, s54, 1
  s_cmp_lg_u32 s54, 1
  s_cbranch_scc1 K3_ev2_2
  buffer_load_dword v195, v192, s[40:43], s44 offen
  s_mov_b32 s55, s52
  s_branch K3_noev2
K3_ev2_2:
  buffer_load_dword v195, v193, s[48:51], s45 offen
  s_mov_b32 s55, 1000
  s_branch K3_noev2
K3_evB2:
  buffer_load_dword v195, v194, s[64:67], s68 offen
  buffer_load_dword v195, v194, s[64:67], s69 offen
  s_branch K3_noevB2
K3_evC2:
  s_add_u32 s53, s53, 1
  s_cmp_lg_u32 s53, 1
  s_cbranch_scc1 K3_ev4_2
  buffer_load_dword v196, v199, s[56:59], 0 offen sc1
  s_mov_b32 s71, 3
  s_branch K3_noevC2
K3_ev4_2:
  s_cmp_lg_u32 s53, 2
  s_cbranch_scc1 K3_ev6_2
  s_waitcnt vmcnt(0)
  v_readfirstlane_b32 s46, v196
  s_mov_b64 exec, 1
  s_cmp_lg_u32 s46, 0
  s_cbranch_scc1 K3_ev5_2
  v_mov_b32 v196, v198
  v_mov_b32 v197, 0
  buffer_atomic_cmpswap v[196:197], v199, s[56:59], 0 offen sc0 sc1
  s_waitcnt vmcnt(0)
  v_cmp_eq_u32 vcc, 0, v196
  s_nop 1
  v_cndmask_b32 v196, v196, v198, vcc
K3_ev5_2:
  buffer_store_dword v196, v199, s[60:63], s47 offen sc1
  s_mov_b64 exec, -1
  s_mov_b32 s71, 0
  s_branch K3_noevC2
K3_ev6_2:
  s_mov_b64 exec, 1
  buffer_store_dword v196, v199, s[60:63], s47 offen offset:32 sc1
  s_mov_b64 exec, -1
  s_mov_b32 s71, 1000
  s_branch K3_noevC2
K3_event3:
  s_add_u32 s54, s54, 1
  s_cmp_lg_u32 s54, 1
  s_cbranch_scc1 K3_ev2_3
  buffer_load_dword v195, v192, s[40:43], s44 offen
  s_mov_b32 s55, s52
  s_branch K3_noev3
K3_ev2_3:
  buffer_load_dword v195, v193, s[48:51], s45 offen
  s_mov_b32 s55, 1000
  s_branch K3_noev3
K3_evB3:
  buffer_load_dword v195, v194, s[64:67], s68 offen
  buffer_load_dword v195, v194, s[64:67], s69 offen
  s_branch K3_noevB3
K3_evC3:
  s_add_u32 s53, s53, 1
  s_cmp_lg_u32 s53, 1
  s_cbranch_scc1 K3_ev4_3
  buffer_load_dword v196, v199, s[56:59], 0 offen sc1
  s_mov_b32 s71, 3
  s_branch K3_noevC3
K3_ev4_3:
  s_cmp_lg_u32 s53, 2
  s_cbranch_scc1 K3_ev6_3
  s_waitcnt vmcnt(0)
  v_readfirstlane_b32 s46, v196
  s_mov_b64 exec, 1
  s_cmp_lg_u32 s46, 0
  s_cbranch_scc1 K3_ev5_3
  v_mov_b32 v196, v198
  v_mov_b32 v197, 0
  buffer_atomic_cmpswap v[196:197], v199, s[56:59], 0 offen sc0 sc1
  s_waitcnt vmcnt(0)
  v_cmp_eq_u32 vcc, 0, v196
  s_nop 1
  v_cndmask_b32 v196, v196, v198, vcc
K3_ev5_3:
  buffer_store_dword v196, v199, s[60:63], s47 offen sc1
  s_mov_b64 exec, -1
  s_mov_b32 s71, 0
  s_branch K3_noevC3
K3_ev6_3:
  s_mov_b64 exec, 1
  buffer_store_dword v196, v199, s[60:63], s47 offen offset:32 sc1
  s_mov_b64 exec, -1
  s_mov_b32 s71, 1000
  s_branch K3_noevC3
K3_L:
  v_lshrrev_b32 v4, 3, v2
  v_and_b32 v5, 7, v2
  v_add_u32 v6, 0, v14
  v_xor_b32 v6, v6, v5
  v_lshlrev_b32 v6, 4, v6
  v_lshl_add_u32 v6, v4, 11, v6
  v_add_u32 v240, 0, v6
  v_add_u32 v6, 4, v14
  v_xor_b32 v6, v6, v5
  v_lshlrev_b32 v6, 4, v6
  v_lshl_add_u32 v6, v4, 11, v6
  v_add_u32 v241, 15360, v6
  v_add_u32 v6, 0, v14
  v_xor_b32 v6, v6, v5
  v_lshlrev_b32 v6, 4, v6
  v_lshl_add_u32 v6, v4, 11, v6
  v_add_u32 v242, 30720, v6
  v_add_u32 v6, 4, v14
  v_xor_b32 v6, v6, v5
  v_lshlrev_b32 v6, 4, v6
  v_lshl_add_u32 v6, v4, 11, v6
  v_add_u32 v243, 46080, v6
  v_lshrrev_b32 v6, 5, v2
  v_bfe_u32 v7, v2, 2, 2
  v_lshl_add_u32 v6, v6, 2, v7
  v_mul_u32_u24 v6, 6144, v6
  v_bfe_u32 v7, v2, 4, 1
  v_lshl_add_u32 v6, v7, 6, v6
  v_and_b32 v7, 3, v2
  v_lshl_add_u32 v6, v7, 4, v6
  v_xor_b32 v7, 32, v6
  s_and_b32 s40, s13, 1
  s_lshl_b32 s40, s40, 7
  s_xor_b32 s41, s40, 128
  v_add_u32 v244, 0, v6
  v_add_u32 v244, s41, v244
  v_add_u32 v245, 48128, v7
  v_add_u32 v245, s41, v245
  v_add_u32 v246, 0, v6
  v_add_u32 v246, s40, v246
  v_add_u32 v247, 48128, v7
  v_add_u32 v247, s40, v247
  v_add_u32 v248, 4096, v6
  v_add_u32 v248, s40, v248
  v_add_u32 v249, 52224, v7
  v_add_u32 v249, s40, v249
  s_lshl_b32 s38, s12, 7
  s_lshl_b32 s40, s4, 5
  s_add_u32 s38, s38, s40
  s_lshl_b32 s38, s38, 11
  s_mul_i32 s39, s4, 98304
  s_lshr_b32 s40, s13, 1
  s_lshl_b32 s40, s40, 8
  s_add_u32 s39, s39, s40
  s_lshl_b32 s41, s4, 12
  s_mul_i32 s42, s4, 6144
  s_add_u32 s42, s42, 16384
  s_mov_b32 s16, s88
  s_mov_b32 s17, s89
  s_mov_b32 s18, 4194304
  s_mov_b32 s19, 0x20000
  s_mov_b32 s20, s90
  s_mov_b32 s21, s91
  s_mov_b32 s22, 6291456
  s_mov_b32 s23, 0x20000
  s_add_u32 m0, s41, 0
  s_nop 0
  buffer_load_dwordx4 v240, s[16:19], s38 offen offset:0 lds
  buffer_load_dwordx4 v241, s[16:19], s38 offen offset:1024 lds
  buffer_load_dwordx4 v242, s[16:19], s38 offen offset:2048 lds
  buffer_load_dwordx4 v243, s[16:19], s38 offen offset:3072 lds
  s_add_u32 m0, s42, 0
  s_nop 0
  buffer_load_dwordx4 v244, s[20:23], s39 offen offset:0 lds
  buffer_load_dwordx4 v245, s[20:23], s39 offen offset:1024 lds
  buffer_load_dwordx4 v246, s[20:23], s39 offen offset:2048 lds
  buffer_load_dwordx4 v247, s[20:23], s39 offen offset:3072 lds
  s_add_u32 m0, s42, 4096
  s_nop 0
  buffer_load_dwordx4 v248, s[20:23], s39 offen offset:0 lds
  buffer_load_dwordx4 v249, s[20:23], s39 offen offset:1024 lds
  s_add_u32 s38, s38, 128
  s_add_u32 s39, s39, 393216
  s_add_u32 m0, s41, 40960
  s_nop 0
  buffer_load_dwordx4 v240, s[16:19], s38 offen offset:0 lds
  buffer_load_dwordx4 v241, s[16:19], s38 offen offset:1024 lds
  buffer_load_dwordx4 v242, s[16:19], s38 offen offset:2048 lds
  buffer_load_dwordx4 v243, s[16:19], s38 offen offset:3072 lds
  s_add_u32 m0, s42, 40960
  s_nop 0
  buffer_load_dwordx4 v244, s[20:23], s39 offen offset:0 lds
  buffer_load_dwordx4 v245, s[20:23], s39 offen offset:1024 lds
  buffer_load_dwordx4 v246, s[20:23], s39 offen offset:2048 lds
  buffer_load_dwordx4 v247, s[20:23], s39 offen offset:3072 lds
  s_add_u32 m0, s42, 45056
  s_nop 0
  buffer_load_dwordx4 v248, s[20:23], s39 offen offset:0 lds
  buffer_load_dwordx4 v249, s[20:23], s39 offen offset:1024 lds
  s_add_u32 s38, s38, 128
  s_add_u32 s39, s39, 393216
  s_add_u32 m0, s41, 81920
  s_nop 0
  buffer_load_dwordx4 v240, s[16:19], s38 offen offset:0 lds
  buffer_load_dwordx4 v241, s[16:19], s38 offen offset:1024 lds
  buffer_load_dwordx4 v242, s[16:19], s38 offen offset:2048 lds
  buffer_load_dwordx4 v243, s[16:19], s38 offen offset:3072 lds
  s_add_u32 m0, s42, 81920
  s_nop 0
  buffer_load_dwordx4 v244, s[20:23], s39 offen offset:0 lds
  buffer_load_dwordx4 v245, s[20:23], s39 offen offset:1024 lds
  buffer_load_dwordx4 v246, s[20:23], s39 offen offset:2048 lds
  buffer_load_dwordx4 v247, s[20:23], s39 offen offset:3072 lds
  s_add_u32 m0, s42, 86016
  s_nop 0
  buffer_load_dwordx4 v248, s[20:23], s39 offen offset:0 lds
  buffer_load_dwordx4 v249, s[20:23], s39 offen offset:1024 lds
  s_add_u32 s38, s38, 128
  s_add_u32 s39, s39, 393216
  s_mov_b32 s24, s78
  s_mov_b32 s25, s79
  s_mov_b32 s26, 4194304
  s_mov_b32 s27, 0x20000
  s_mov_b32 s28, s80
  s_mov_b32 s29, s81
  s_mov_b32 s30, 4194304
  s_mov_b32 s31, 0x20000
  s_mov_b32 s32, s82
  s_mov_b32 s33, s83
  s_mov_b32 s34, 8192
  s_mov_b32 s35, 0x20000
  s_add_u32 s44, s98, 16777216
  s_addc_u32 s45, s99, 0
  s_mov_b32 s46, 4194304
  s_mov_b32 s47, 0x20000
  s_add_u32 s48, s98, 0
  s_addc_u32 s49, s99, 0
  s_mov_b32 s50, 4194304
  s_mov_b32 s51, 0x20000
  s_add_u32 s52, s98, 8388608
  s_addc_u32 s53, s99, 0
  s_mov_b32 s54, 2097152
  s_mov_b32 s55, 0x20000
  s_add_u32 s56, s98, 12582912
  s_addc_u32 s57, s99, 0
  s_mov_b32 s58, 65536
  s_mov_b32 s59, 0x20000
  s_lshl_b32 s60, s2, 2
  s_add_u32 s60, s60, s4
  s_and_b32 s61, s60, 15
  s_lshr_b32 s60, s60, 4
  s_lshl_b32 s62, s60, 16
  s_lshl_b32 s63, s61, 7
  s_add_u32 s62, s62, s63
  v_lshlrev_b32 v21, 14, v14
  v_lshl_add_u32 v21, v15, 3, v21
  v_add_u32 v21, s62, v21
  s_lshl_b32 s63, s61, 9
  v_lshlrev_b32 v22, 5, v15
  s_lshl_b32 s62, s61, 18
  s_lshl_b32 s64, s60, 6
  s_add_u32 s62, s62, s64
  v_lshlrev_b32 v19, 14, v15
  v_lshl_add_u32 v19, v14, 4, v19
  s_lshl_b32 s64, s12, 3
  s_lshl_b32 s65, s4, 1
  s_add_u32 s64, s64, s65
  s_lshl_b32 s64, s64, 15
  s_lshr_b32 s65, s15, 1
  s_lshl_b32 s65, s65, 11
  s_add_u32 s64, s64, s65
  s_add_u32 s65, s64, 32768
  s_lshl_b32 s66, s5, 4
  s_add_u32 s66, s66, s12
  s_lshl_b32 s67, s66, 7
  s_lshl_b32 s66, s66, 12
  s_lshl_b32 s68, s36, 11
  s_add_u32 s66, s66, s68
  v_mov_b32 v160, 0
  v_mov_b32 v161, 0
  v_mov_b32 v162, 0
  v_mov_b32 v163, 0
  v_and_b32 v18, 7, v2
  v_lshlrev_b32 v18, 4, v18
  v_lshrrev_b32 v6, 5, v2
  v_bfe_u32 v7, v2, 2, 2
  v_lshl_add_u32 v7, v6, 2, v7
  v_lshlrev_b32 v7, 11, v7
  v_bfe_u32 v8, v2, 4, 1
  v_lshl_add_u32 v7, v8, 6, v7
  v_and_b32 v8, 3, v2
  v_lshlrev_b32 v6, 1, v6
  v_xor_b32 v8, v8, v6
  v_lshl_add_u32 v7, v8, 4, v7
  v_add_u32 v232, 0, v7
  v_add_u32 v233, 15360, v7
  v_add_u32 v234, 30720, v7
  v_add_u32 v235, 46080, v7
  s_lshl_b32 s69, s4, 16
  s_lshr_b32 s70, s10, 2
  s_lshl_b32 s70, s70, 3
  s_lshr_b32 s71, s11, 2
  s_add_u32 s70, s70, s71
  s_lshl_b32 s70, s70, 7
  s_add_u32 s69, s69, s70
  s_lshl_b32 s70, s4, 12
  s_add_u32 s70, s70, 40960
  s_lshl_b32 s71, s6, 12
  v_mov_b32 v10, 39168
  v_mov_b32 v11, 1
  s_lshl_b32 s43, s4, 2
  v_add_u32 v9, s43, v10
  s_waitcnt vmcnt(20)
  s_barrier
  s_add_u32 m0, s41, 122880
  s_nop 0
  buffer_load_dwordx4 v240, s[16:19], s38 offen offset:0 lds
  buffer_load_dwordx4 v241, s[16:19], s38 offen offset:1024 lds
  buffer_load_dwordx4 v242, s[16:19], s38 offen offset:2048 lds
  buffer_load_dwordx4 v243, s[16:19], s38 offen offset:3072 lds
  s_add_u32 m0, s42, 122880
  s_nop 0
  buffer_load_dwordx4 v244, s[20:23], s39 offen offset:0 lds
  buffer_load_dwordx4 v245, s[20:23], s39 offen offset:1024 lds
  buffer_load_dwordx4 v246, s[20:23], s39 offen offset:2048 lds
  buffer_load_dwordx4 v247, s[20:23], s39 offen offset:3072 lds
  s_add_u32 m0, s42, 126976
  s_nop 0
  buffer_load_dwordx4 v248, s[20:23], s39 offen offset:0 lds
  buffer_load_dwordx4 v249, s[20:23], s39 offen offset:1024 lds
  s_add_u32 s38, s38, 128
  s_add_u32 s39, s39, 393216
  buffer_store_dwordx4 v[160:163], v3, s[48:51], s64 offen sc1
  s_waitcnt vmcnt(21)
  s_barrier
  s_add_u32 m0, s41, 0
  s_nop 0
  buffer_load_dwordx4 v240, s[16:19], s38 offen offset:0 lds
  buffer_load_dwordx4 v241, s[16:19], s38 offen offset:1024 lds
  buffer_load_dwordx4 v242, s[16:19], s38 offen offset:2048 lds
  buffer_load_dwordx4 v243, s[16:19], s38 offen offset:3072 lds
  s_add_u32 m0, s42, 0
  s_nop 0
  buffer_load_dwordx4 v244, s[20:23], s39 offen offset:0 lds
  buffer_load_dwordx4 v245, s[20:23], s39 offen offset:1024 lds
  buffer_load_dwordx4 v246, s[20:23], s39 offen offset:2048 lds
  buffer_load_dwordx4 v247, s[20:23], s39 offen offset:3072 lds
  s_add_u32 m0, s42, 4096
  s_nop 0
  buffer_load_dwordx4 v248, s[20:23], s39 offen offset:0 lds
  buffer_load_dwordx4 v249, s[20:23], s39 offen offset:1024 lds
  s_add_u32 s38, s38, 128
  s_add_u32 s39, s39, 393216
  buffer_store_dwordx4 v[160:163], v3, s[48:51], s64 offen offset:1024 sc1
  s_waitcnt vmcnt(22)
  s_barrier
  s_add_u32 m0, s41, 40960
  s_nop 0
  buffer_load_dwordx4 v240, s[16:19], s38 offen offset:0 lds
  buffer_load_dwordx4 v241, s[16:19], s38 offen offset:1024 lds
  buffer_load_dwordx4 v242, s[16:19], s38 offen offset:2048 lds
  buffer_load_dwordx4 v243, s[16:19], s38 offen offset:3072 lds
  s_add_u32 m0, s42, 40960
  s_nop 0
  buffer_load_dwordx4 v244, s[20:23], s39 offen offset:0 lds
  buffer_load_dwordx4 v245, s[20:23], s39 offen offset:1024 lds
  buffer_load_dwordx4 v246, s[20:23], s39 offen offset:2048 lds
  buffer_load_dwordx4 v247, s[20:23], s39 offen offset:3072 lds
  s_add_u32 m0, s42, 45056
  s_nop 0
  buffer_load_dwordx4 v248, s[20:23], s39 offen offset:0 lds
  buffer_load_dwordx4 v249, s[20:23], s39 offen offset:1024 lds
  s_add_u32 s38, s38, 128
  s_add_u32 s39, s39, 393216
  buffer_store_dwordx4 v[160:163], v3, s[48:51], s65 offen sc1
  s_waitcnt vmcnt(23)
  s_barrier
  s_add_u32 m0, s41, 81920
  s_nop 0
  buffer_load_dwordx4 v240, s[16:19], s38 offen offset:0 lds
  buffer_load_dwordx4 v241, s[16:19], s38 offen offset:1024 lds
  buffer_load_dwordx4 v242, s[16:19], s38 offen offset:2048 lds
  buffer_load_dwordx4 v243, s[16:19], s38 offen offset:3072 lds
  s_add_u32 m0, s42, 81920
  s_nop 0
  buffer_load_dwordx4 v244, s[20:23], s39 offen offset:0 lds
  buffer_load_dwordx4 v245, s[20:23], s39 offen offset:1024 lds
  buffer_load_dwordx4 v246, s[20:23], s39 offen offset:2048 lds
  buffer_load_dwordx4 v247, s[20:23], s39 offen offset:3072 lds
  s_add_u32 m0, s42, 86016
  s_nop 0
  buffer_load_dwordx4 v248, s[20:23], s39 offen offset:0 lds
  buffer_load_dwordx4 v249, s[20:23], s39 offen offset:1024 lds
  s_add_u32 s38, s38, 128
  s_add_u32 s39, s39, 393216
  buffer_store_dwordx4 v[160:163], v3, s[48:51], s65 offen offset:1024 sc1
  s_waitcnt vmcnt(23)
  s_barrier
  s_add_u32 m0, s41, 122880
  s_nop 0
  buffer_load_dwordx4 v240, s[16:19], s38 offen offset:0 lds
  buffer_load_dwordx4 v241, s[16:19], s38 offen offset:1024 lds
  buffer_load_dwordx4 v242, s[16:19], s38 offen offset:2048 lds
  buffer_load_dwordx4 v243, s[16:19], s38 offen offset:3072 lds
  s_add_u32 m0, s42, 122880
  s_nop 0
  buffer_load_dwordx4 v244, s[20:23], s39 offen offset:0 lds
  buffer_load_dwordx4 v245, s[20:23], s39 offen offset:1024 lds
  buffer_load_dwordx4 v246, s[20:23], s39 offen offset:2048 lds
  buffer_load_dwordx4 v247, s[20:23], s39 offen offset:3072 lds
  s_add_u32 m0, s42, 126976
  s_nop 0
  buffer_load_dwordx4 v248, s[20:23], s39 offen offset:0 lds
  buffer_load_dwordx4 v249, s[20:23], s39 offen offset:1024 lds
  s_add_u32 s38, s38, 128
  s_add_u32 s39, s39, 393216
  buffer_store_dwordx4 v[160:163], v3, s[52:55], s66 offen sc1
  buffer_load_dwordx4 v[24:27], v22, s[32:35], s63 offen offset:0
  buffer_load_dwordx4 v[28:31], v22, s[32:35], s63 offen offset:16
  v_add_u32 v23, 4294961152, v21
  buffer_load_dwordx2 v[32:33], v23, s[24:27], 0 offen nt
  v_add_u32 v23, 4294963200, v21
  buffer_load_dwordx2 v[34:35], v23, s[24:27], 0 offen nt
  v_add_u32 v23, 4294965248, v21
  buffer_load_dwordx2 v[36:37], v23, s[24:27], 0 offen nt
  v_add_u32 v23, 0, v21
  buffer_load_dwordx2 v[38:39], v23, s[24:27], 0 offen nt
  v_add_u32 v23, 2048, v21
  buffer_load_dwordx2 v[40:41], v23, s[24:27], 0 offen nt
  v_add_u32 v23, 4096, v21
  buffer_load_dwordx2 v[42:43], v23, s[24:27], 0 offen nt
  v_add_u32 v23, 6144, v21
  buffer_load_dwordx2 v[44:45], v23, s[24:27], 0 offen nt
  v_add_u32 v23, 8192, v21
  buffer_load_dwordx2 v[46:47], v23, s[24:27], 0 offen nt
  v_add_u32 v23, 10240, v21
  buffer_load_dwordx2 v[48:49], v23, s[24:27], 0 offen nt
  s_waitcnt vmcnt(34)
  s_barrier
  s_add_u32 m0, s41, 0
  s_nop 0
  buffer_load_dwordx4 v240, s[16:19], s38 offen offset:0 lds
  buffer_load_dwordx4 v241, s[16:19], s38 offen offset:1024 lds
  buffer_load_dwordx4 v242, s[16:19], s38 offen offset:2048 lds
  buffer_load_dwordx4 v243, s[16:19], s38 offen offset:3072 lds
  s_add_u32 m0, s42, 0
  s_nop 0
  buffer_load_dwordx4 v244, s[20:23], s39 offen offset:0 lds
  buffer_load_dwordx4 v245, s[20:23], s39 offen offset:1024 lds
  buffer_load_dwordx4 v246, s[20:23], s39 offen offset:2048 lds
  buffer_load_dwordx4 v247, s[20:23], s39 offen offset:3072 lds
  s_add_u32 m0, s42, 4096
  s_nop 0
  buffer_load_dwordx4 v248, s[20:23], s39 offen offset:0 lds
  buffer_load_dwordx4 v249, s[20:23], s39 offen offset:1024 lds
  s_add_u32 s38, s38, 128
  s_add_u32 s39, s39, 393216
  buffer_store_dwordx4 v[160:163], v3, s[52:55], s66 offen offset:1024 sc1
  v_add_u32 v23, 12288, v21
  buffer_load_dwordx2 v[50:51], v23, s[24:27], 0 offen nt
  v_add_u32 v23, 14336, v21
  buffer_load_dwordx2 v[52:53], v23, s[24:27], 0 offen nt
  v_add_u32 v23, 0, v21
  buffer_load_dwordx2 v[54:55], v23, s[28:31], 0 offen nt
  v_add_u32 v23, 2048, v21
  buffer_load_dwordx2 v[56:57], v23, s[28:31], 0 offen nt
  v_add_u32 v23, 4096, v21
  buffer_load_dwordx2 v[58:59], v23, s[28:31], 0 offen nt
  v_add_u32 v23, 6144, v21
  buffer_load_dwordx2 v[60:61], v23, s[28:31], 0 offen nt
  v_add_u32 v23, 8192, v21
  buffer_load_dwordx2 v[62:63], v23, s[28:31], 0 offen nt
  v_add_u32 v23, 10240, v21
  buffer_load_dwordx2 v[64:65], v23, s[28:31], 0 offen nt
  v_add_u32 v23, 12288, v21
  buffer_load_dwordx2 v[66:67], v23, s[28:31], 0 offen nt
  v_add_u32 v23, 14336, v21
  buffer_load_dwordx2 v[68:69], v23, s[28:31], 0 offen nt
  s_waitcnt vmcnt(44)
  s_barrier
  s_add_u32 m0, s41, 40960
  s_nop 0
  buffer_load_dwordx4 v240, s[16:19], s38 offen offset:0 lds
  buffer_load_dwordx4 v241, s[16:19], s38 offen offset:1024 lds
  buffer_load_dwordx4 v242, s[16:19], s38 offen offset:2048 lds
  buffer_load_dwordx4 v243, s[16:19], s38 offen offset:3072 lds
  s_add_u32 m0, s42, 40960
  s_nop 0
  buffer_load_dwordx4 v244, s[20:23], s39 offen offset:0 lds
  buffer_load_dwordx4 v245, s[20:23], s39 offen offset:1024 lds
  buffer_load_dwordx4 v246, s[20:23], s39 offen offset:2048 lds
  buffer_load_dwordx4 v247, s[20:23], s39 offen offset:3072 lds
  s_add_u32 m0, s42, 45056
  s_nop 0
  buffer_load_dwordx4 v248, s[20:23], s39 offen offset:0 lds
  buffer_load_dwordx4 v249, s[20:23], s39 offen offset:1024 lds
  s_add_u32 s38, s38, 128
  s_add_u32 s39, s39, 393216
  buffer_store_dwordx4 v[160:163], v18, s[56:59], s67 offen sc1
  s_waitcnt vmcnt(11)
  v_lshlrev_b32 v72, 16, v24
  v_and_b32 v76, 0xffff0000, v24
  v_lshlrev_b32 v80, 16, v25
  v_and_b32 v84, 0xffff0000, v25
  v_lshlrev_b32 v73, 16, v26
  v_and_b32 v77, 0xffff0000, v26
  v_lshlrev_b32 v81, 16, v27
  v_and_b32 v85, 0xffff0000, v27
  v_lshlrev_b32 v74, 16, v28
  v_and_b32 v78, 0xffff0000, v28
  v_lshlrev_b32 v82, 16, v29
  v_and_b32 v86, 0xffff0000, v29
  v_lshlrev_b32 v75, 16, v30
  v_and_b32 v79, 0xffff0000, v30
  v_lshlrev_b32 v83, 16, v31
  v_and_b32 v87, 0xffff0000, v31
  v_lshlrev_b32 v88, 16, v32
  v_and_b32 v89, 0xffff0000, v32
  v_lshlrev_b32 v90, 16, v34
  v_and_b32 v91, 0xffff0000, v34
  v_lshlrev_b32 v92, 16, v36
  v_and_b32 v93, 0xffff0000, v36
  v_lshlrev_b32 v94, 16, v38
  v_and_b32 v95, 0xffff0000, v38
  v_lshlrev_b32 v96, 16, v40
  v_and_b32 v97, 0xffff0000, v40
  v_lshlrev_b32 v98, 16, v42
  v_and_b32 v99, 0xffff0000, v42
  v_lshlrev_b32 v100, 16, v44
  v_and_b32 v101, 0xffff0000, v44
  v_lshlrev_b32 v102, 16, v46
  v_and_b32 v103, 0xffff0000, v46
  v_lshlrev_b32 v104, 16, v48
  v_and_b32 v105, 0xffff0000, v48
  v_lshlrev_b32 v106, 16, v50
  v_and_b32 v107, 0xffff0000, v50
  v_lshlrev_b32 v108, 16, v52
  v_and_b32 v109, 0xffff0000, v52
  v_lshlrev_b32 v110, 16, v54
  v_and_b32 v111, 0xffff0000, v54
  v_lshlrev_b32 v112, 16, v56
  v_and_b32 v113, 0xffff0000, v56
  v_lshlrev_b32 v114, 16, v58
  v_and_b32 v115, 0xffff0000, v58
  v_lshlrev_b32 v116, 16, v60
  v_and_b32 v117, 0xffff0000, v60
  v_lshlrev_b32 v118, 16, v62
  v_and_b32 v119, 0xffff0000, v62
  v_lshlrev_b32 v120, 16, v64
  v_and_b32 v121, 0xffff0000, v64
  v_lshlrev_b32 v122, 16, v66
  v_and_b32 v123, 0xffff0000, v66
  v_lshlrev_b32 v124, 16, v68
  v_and_b32 v125, 0xffff0000, v68
  v_mul_f32 v126, v88, v84
  v_mul_f32 v127, v89, v85
  v_mul_f32 v128, v90, v84
  v_mul_f32 v129, v91, v85
  v_mul_f32 v130, v92, v84
  v_mul_f32 v131, v93, v85
  v_mul_f32 v132, v94, v84
  v_mul_f32 v133, v95, v85
  v_mul_f32 v134, v96, v84
  v_mul_f32 v135, v97, v85
  v_mul_f32 v136, v98, v84
  v_mul_f32 v137, v99, v85
  v_mul_f32 v138, v100, v84
  v_mul_f32 v139, v101, v85
  v_mul_f32 v140, v102, v84
  v_mul_f32 v141, v103, v85
  v_fmac_f32 v126, v90, v80
  v_fmac_f32 v127, v91, v81
  v_fmac_f32 v128, v92, v80
  s_barrier
  s_add_u32 m0, s41, 81920
  s_nop 0
  buffer_load_dwordx4 v240, s[16:19], s38 offen offset:0 lds
  buffer_load_dwordx4 v241, s[16:19], s38 offen offset:1024 lds
  buffer_load_dwordx4 v242, s[16:19], s38 offen offset:2048 lds
  buffer_load_dwordx4 v243, s[16:19], s38 offen offset:3072 lds
  s_add_u32 m0, s42, 81920
  s_nop 0
  buffer_load_dwordx4 v244, s[20:23], s39 offen offset:0 lds
  buffer_load_dwordx4 v245, s[20:23], s39 offen offset:1024 lds
  buffer_load_dwordx4 v246, s[20:23], s39 offen offset:2048 lds
  buffer_load_dwordx4 v247, s[20:23], s39 offen offset:3072 lds
  s_add_u32 m0, s42, 86016
  s_nop 0
  buffer_load_dwordx4 v248, s[20:23], s39 offen offset:0 lds
  buffer_load_dwordx4 v249, s[20:23], s39 offen offset:1024 lds
  s_add_u32 s38, s38, 128
  s_add_u32 s39, s39, 393216
  v_fmac_f32 v129, v93, v81
  v_fmac_f32 v130, v94, v80
  v_fmac_f32 v131, v95, v81
  v_fmac_f32 v132, v96, v80
  v_fmac_f32 v133, v97, v81
  v_fmac_f32 v134, v98, v80
  v_fmac_f32 v135, v99, v81
  v_fmac_f32 v136, v100, v80
  v_fmac_f32 v137, v101, v81
  v_fmac_f32 v138, v102, v80
  v_fmac_f32 v139, v103, v81
  v_fmac_f32 v140, v104, v80
  v_fmac_f32 v141, v105, v81
  v_fmac_f32 v126, v92, v76
  v_fmac_f32 v127, v93, v77
  v_fmac_f32 v128, v94, v76
  v_fmac_f32 v129, v95, v77
  v_fmac_f32 v130, v96, v76
  v_fmac_f32 v131, v97, v77
  v_fmac_f32 v132, v98, v76
  v_fmac_f32 v133, v99, v77
  v_fmac_f32 v134, v100, v76
  v_fmac_f32 v135, v101, v77
  v_fmac_f32 v136, v102, v76
  v_fmac_f32 v137, v103, v77
  v_fmac_f32 v138, v104, v76
  v_fmac_f32 v139, v105, v77
  v_fmac_f32 v140, v106, v76
  v_fmac_f32 v141, v107, v77
  v_fmac_f32 v126, v94, v72
  v_fmac_f32 v127, v95, v73
  v_fmac_f32 v128, v96, v72
  v_fmac_f32 v129, v97, v73
  v_fmac_f32 v130, v98, v72
  v_fmac_f32 v131, v99, v73
  v_fmac_f32 v132, v100, v72
  v_fmac_f32 v133, v101, v73
  v_fmac_f32 v134, v102, v72
  v_fmac_f32 v135, v103, v73
  v_fmac_f32 v136, v104, v72
  v_fmac_f32 v137, v105, v73
  v_fmac_f32 v138, v106, v72
  v_fmac_f32 v139, v107, v73
  v_fmac_f32 v140, v108, v72
  v_fmac_f32 v141, v109, v73
  v_mul_f32 v126, v126, v110
  v_mul_f32 v127, v127, v111
  v_mul_f32 v128, v128, v112
  v_mul_f32 v129, v129, v113
  v_mul_f32 v130, v130, v114
  v_mul_f32 v131, v131, v115
  v_mul_f32 v132, v132, v116
  v_mul_f32 v133, v133, v117
  v_mul_f32 v134, v134, v118
  v_mul_f32 v135, v135, v119
  v_mul_f32 v136, v136, v120
  v_mul_f32 v137, v137, v121
  v_mul_f32 v138, v138, v122
  v_mul_f32 v139, v139, v123
  v_mul_f32 v140, v140, v124
  v_mul_f32 v141, v141, v125
  v_cvt_pk_bf16_f32 v144, v126, v128
  v_cvt_pk_bf16_f32 v145, v130, v132
  v_cvt_pk_bf16_f32 v146, v134, v136
  v_cvt_pk_bf16_f32 v147, v138, v140
  v_cvt_pk_bf16_f32 v148, v127, v129
  v_cvt_pk_bf16_f32 v149, v131, v133
  v_cvt_pk_bf16_f32 v150, v135, v137
  v_cvt_pk_bf16_f32 v151, v139, v141
  v_and_b32 v144, -2, v144
  v_and_b32 v145, -2, v145
  v_and_b32 v146, -2, v146
  v_and_b32 v147, -2, v147
  s_barrier
  s_add_u32 m0, s41, 122880
  s_nop 0
  buffer_load_dwordx4 v240, s[16:19], s38 offen offset:0 lds
  buffer_load_dwordx4 v241, s[16:19], s38 offen offset:1024 lds
  buffer_load_dwordx4 v242, s[16:19], s38 offen offset:2048 lds
  buffer_load_dwordx4 v243, s[16:19], s38 offen offset:3072 lds
  s_add_u32 m0, s42, 122880
  s_nop 0
  buffer_load_dwordx4 v244, s[20:23], s39 offen offset:0 lds
  buffer_load_dwordx4 v245, s[20:23], s39 offen offset:1024 lds
  buffer_load_dwordx4 v246, s[20:23], s39 offen offset:2048 lds
  buffer_load_dwordx4 v247, s[20:23], s39 offen offset:3072 lds
  s_add_u32 m0, s42, 126976
  s_nop 0
  buffer_load_dwordx4 v248, s[20:23], s39 offen offset:0 lds
  buffer_load_dwordx4 v249, s[20:23], s39 offen offset:1024 lds
  s_add_u32 s38, s38, 128
  s_add_u32 s39, s39, 393216
  v_and_b32 v148, -2, v148
  v_and_b32 v149, -2, v149
  v_and_b32 v150, -2, v150
  v_and_b32 v151, -2, v151
  buffer_store_dwordx4 v[144:147], v19, s[44:47], s62 offen sc1
  s_add_u32 s62, s62, 4096
  buffer_store_dwordx4 v[148:151], v19, s[44:47], s62 offen sc1
  s_add_u32 s62, s62, 4096
  v_lshlrev_b32 v88, 16, v33
  v_and_b32 v89, 0xffff0000, v33
  v_lshlrev_b32 v90, 16, v35
  v_and_b32 v91, 0xffff0000, v35
  v_lshlrev_b32 v92, 16, v37
  v_and_b32 v93, 0xffff0000, v37
  v_lshlrev_b32 v94, 16, v39
  v_and_b32 v95, 0xffff0000, v39
  v_lshlrev_b32 v96, 16, v41
  v_and_b32 v97, 0xffff0000, v41
  v_lshlrev_b32 v98, 16, v43
  v_and_b32 v99, 0xffff0000, v43
  v_lshlrev_b32 v100, 16, v45
  v_and_b32 v101, 0xffff0000, v45
  v_lshlrev_b32 v102, 16, v47
  v_and_b32 v103, 0xffff0000, v47
  v_lshlrev_b32 v104, 16, v49
  v_and_b32 v105, 0xffff0000, v49
  v_lshlrev_b32 v106, 16, v51
  v_and_b32 v107, 0xffff0000, v51
  v_lshlrev_b32 v108, 16, v53
  v_and_b32 v109, 0xffff0000, v53
  v_lshlrev_b32 v110, 16, v55
  v_and_b32 v111, 0xffff0000, v55
  v_lshlrev_b32 v112, 16, v57
  v_and_b32 v113, 0xffff0000, v57
  v_lshlrev_b32 v114, 16, v59
  v_and_b32 v115, 0xffff0000, v59
  v_lshlrev_b32 v116, 16, v61
  v_and_b32 v117, 0xffff0000, v61
  v_lshlrev_b32 v118, 16, v63
  v_and_b32 v119, 0xffff0000, v63
  v_lshlrev_b32 v120, 16, v65
  v_and_b32 v121, 0xffff0000, v65
  v_lshlrev_b32 v122, 16, v67
  v_and_b32 v123, 0xffff0000, v67
  v_lshlrev_b32 v124, 16, v69
  v_and_b32 v125, 0xffff0000, v69
  v_mul_f32 v126, v88, v86
  v_mul_f32 v127, v89, v87
  v_mul_f32 v128, v90, v86
  v_mul_f32 v129, v91, v87
  v_mul_f32 v130, v92, v86
  v_mul_f32 v131, v93, v87
  v_mul_f32 v132, v94, v86
  v_mul_f32 v133, v95, v87
  v_mul_f32 v134, v96, v86
  v_mul_f32 v135, v97, v87
  v_mul_f32 v136, v98, v86
  v_mul_f32 v137, v99, v87
  v_mul_f32 v138, v100, v86
  v_mul_f32 v139, v101, v87
  v_mul_f32 v140, v102, v86
  v_mul_f32 v141, v103, v87
  v_fmac_f32 v126, v90, v82
  v_fmac_f32 v127, v91, v83
  v_fmac_f32 v128, v92, v82
  v_fmac_f32 v129, v93, v83
  v_fmac_f32 v130, v94, v82
  v_fmac_f32 v131, v95, v83
  v_fmac_f32 v132, v96, v82
  v_fmac_f32 v133, v97, v83
  v_fmac_f32 v134, v98, v82
  v_fmac_f32 v135, v99, v83
  v_fmac_f32 v136, v100, v82
  s_waitcnt vmcnt(23)
  s_barrier
  s_add_u32 m0, s41, 0
  s_nop 0
  buffer_load_dwordx4 v240, s[16:19], s38 offen offset:0 lds
  buffer_load_dwordx4 v241, s[16:19], s38 offen offset:1024 lds
  buffer_load_dwordx4 v242, s[16:19], s38 offen offset:2048 lds
  buffer_load_dwordx4 v243, s[16:19], s38 offen offset:3072 lds
  s_add_u32 m0, s42, 0
  s_nop 0
  buffer_load_dwordx4 v244, s[20:23], s39 offen offset:0 lds
  buffer_load_dwordx4 v245, s[20:23], s39 offen offset:1024 lds
  buffer_load_dwordx4 v246, s[20:23], s39 offen offset:2048 lds
  buffer_load_dwordx4 v247, s[20:23], s39 offen offset:3072 lds
  s_add_u32 m0, s42, 4096
  s_nop 0
  buffer_load_dwordx4 v248, s[20:23], s39 offen offset:0 lds
  buffer_load_dwordx4 v249, s[20:23], s39 offen offset:1024 lds
  s_add_u32 s38, s38, 128
  s_add_u32 s39, s39, 393216
  v_fmac_f32 v137, v101, v83
  v_fmac_f32 v138, v102, v82
  v_fmac_f32 v139, v103, v83
  v_fmac_f32 v140, v104, v82
  v_fmac_f32 v141, v105, v83
  v_fmac_f32 v126, v92, v78
  v_fmac_f32 v127, v93, v79
  v_fmac_f32 v128, v94, v78
  v_fmac_f32 v129, v95, v79
  v_fmac_f32 v130, v96, v78
  v_fmac_f32 v131, v97, v79
  v_fmac_f32 v132, v98, v78
  v_fmac_f32 v133, v99, v79
  v_fmac_f32 v134, v100, v78
  v_fmac_f32 v135, v101, v79
  v_fmac_f32 v136, v102, v78
  v_fmac_f32 v137, v103, v79
  v_fmac_f32 v138, v104, v78
  v_fmac_f32 v139, v105, v79
  v_fmac_f32 v140, v106, v78
  v_fmac_f32 v141, v107, v79
  v_fmac_f32 v126, v94, v74
  v_fmac_f32 v127, v95, v75
  v_fmac_f32 v128, v96, v74
  v_fmac_f32 v129, v97, v75
  v_fmac_f32 v130, v98, v74
  v_fmac_f32 v131, v99, v75
  v_fmac_f32 v132, v100, v74
  v_fmac_f32 v133, v101, v75
  v_fmac_f32 v134, v102, v74
  v_fmac_f32 v135, v103, v75
  v_fmac_f32 v136, v104, v74
  v_fmac_f32 v137, v105, v75
  v_fmac_f32 v138, v106, v74
  v_fmac_f32 v139, v107, v75
  v_fmac_f32 v140, v108, v74
  v_fmac_f32 v141, v109, v75
  v_mul_f32 v126, v126, v110
  v_mul_f32 v127, v127, v111
  v_mul_f32 v128, v128, v112
  v_mul_f32 v129, v129, v113
  v_mul_f32 v130, v130, v114
  v_mul_f32 v131, v131, v115
  v_mul_f32 v132, v132, v116
  v_mul_f32 v133, v133, v117
  v_mul_f32 v134, v134, v118
  v_mul_f32 v135, v135, v119
  v_mul_f32 v136, v136, v120
  v_mul_f32 v137, v137, v121
  v_mul_f32 v138, v138, v122
  v_mul_f32 v139, v139, v123
  v_mul_f32 v140, v140, v124
  v_mul_f32 v141, v141, v125
  v_cvt_pk_bf16_f32 v152, v126, v128
  v_cvt_pk_bf16_f32 v153, v130, v132
  v_cvt_pk_bf16_f32 v154, v134, v136
  v_cvt_pk_bf16_f32 v155, v138, v140
  v_cvt_pk_bf16_f32 v156, v127, v129
  v_cvt_pk_bf16_f32 v157, v131, v133
  v_cvt_pk_bf16_f32 v158, v135, v137
  v_cvt_pk_bf16_f32 v159, v139, v141
  v_and_b32 v152, -2, v152
  v_and_b32 v153, -2, v153
  v_and_b32 v154, -2, v154
  v_and_b32 v155, -2, v155
  v_and_b32 v156, -2, v156
  v_and_b32 v157, -2, v157
  v_and_b32 v158, -2, v158
  v_and_b32 v159, -2, v159
  buffer_store_dwordx4 v[152:155], v19, s[44:47], s62 offen sc1
  s_add_u32 s62, s62, 4096
  buffer_store_dwordx4 v[156:159], v19, s[44:47], s62 offen sc1
  s_add_u32 s62, s62, 4096
  s_waitcnt vmcnt(24)
  s_barrier
  s_add_u32 m0, s41, 40960
  s_nop 0
  buffer_load_dwordx4 v240, s[16:19], s38 offen offset:0 lds
  buffer_load_dwordx4 v241, s[16:19], s38 offen offset:1024 lds
  buffer_load_dwordx4 v242, s[16:19], s38 offen offset:2048 lds
  buffer_load_dwordx4 v243, s[16:19], s38 offen offset:3072 lds
  s_add_u32 m0, s42, 40960
  s_nop 0
  buffer_load_dwordx4 v244, s[20:23], s39 offen offset:0 lds
  buffer_load_dwordx4 v245, s[20:23], s39 offen offset:1024 lds
  buffer_load_dwordx4 v246, s[20:23], s39 offen offset:2048 lds
  buffer_load_dwordx4 v247, s[20:23], s39 offen offset:3072 lds
  s_add_u32 m0, s42, 45056
  s_nop 0
  buffer_load_dwordx4 v248, s[20:23], s39 offen offset:0 lds
  buffer_load_dwordx4 v249, s[20:23], s39 offen offset:1024 lds
  s_add_u32 s38, s38, 128
  s_add_u32 s39, s39, 393216
  s_waitcnt vmcnt(24)
  s_barrier
  s_add_u32 m0, s41, 81920
  s_nop 0
  buffer_load_dwordx4 v240, s[16:19], s38 offen offset:0 lds
  buffer_load_dwordx4 v241, s[16:19], s38 offen offset:1024 lds
  buffer_load_dwordx4 v242, s[16:19], s38 offen offset:2048 lds
  buffer_load_dwordx4 v243, s[16:19], s38 offen offset:3072 lds
  s_add_u32 m0, s42, 81920
  s_nop 0
  buffer_load_dwordx4 v244, s[20:23], s39 offen offset:0 lds
  buffer_load_dwordx4 v245, s[20:23], s39 offen offset:1024 lds
  buffer_load_dwordx4 v246, s[20:23], s39 offen offset:2048 lds
  buffer_load_dwordx4 v247, s[20:23], s39 offen offset:3072 lds
  s_add_u32 m0, s42, 86016
  s_nop 0
  buffer_load_dwordx4 v248, s[20:23], s39 offen offset:0 lds
  buffer_load_dwordx4 v249, s[20:23], s39 offen offset:1024 lds
  s_add_u32 s38, s38, 128
  s_add_u32 s39, s39, 393216
  s_waitcnt vmcnt(22)
  s_barrier
  s_add_u32 m0, s41, 122880
  s_nop 0
  buffer_load_dwordx4 v240, s[16:19], s38 offen offset:0 lds
  buffer_load_dwordx4 v241, s[16:19], s38 offen offset:1024 lds
  buffer_load_dwordx4 v242, s[16:19], s38 offen offset:2048 lds
  buffer_load_dwordx4 v243, s[16:19], s38 offen offset:3072 lds
  s_add_u32 m0, s42, 122880
  s_nop 0
  buffer_load_dwordx4 v244, s[20:23], s39 offen offset:0 lds
  buffer_load_dwordx4 v245, s[20:23], s39 offen offset:1024 lds
  buffer_load_dwordx4 v246, s[20:23], s39 offen offset:2048 lds
  buffer_load_dwordx4 v247, s[20:23], s39 offen offset:3072 lds
  s_add_u32 m0, s42, 126976
  s_nop 0
  buffer_load_dwordx4 v248, s[20:23], s39 offen offset:0 lds
  buffer_load_dwordx4 v249, s[20:23], s39 offen offset:1024 lds
  s_add_u32 s38, s38, 128
  s_add_u32 s39, s39, 393216
  s_waitcnt vmcnt(20)
  s_barrier
  s_lshl_b32 s16, s10, 1
  s_lshr_b32 s17, s11, 4
  s_add_u32 s16, s16, s17
  s_and_b32 s17, s11, 15
  s_lshl_b32 s17, s17, 2
  s_add_u32 s17, s17, s4
  s_lshr_b32 s18, s17, 4
  s_and_b32 s17, s17, 15
  s_lshl_b32 s19, s18, 9
  s_lshl_b32 s64, s17, 2
  s_add_u32 s19, s19, s64
  s_lshl_b32 s64, s19, 11
  s_lshl_b32 s65, s16, 7
  s_add_u32 s64, s64, s65
  s_lshl_b32 s72, s19, 12
  s_add_u32 s72, s72, s65
  s_lshl_b32 s73, s16, 18
  s_lshl_b32 s65, s18, 10
  s_add_u32 s73, s73, s65
  s_lshl_b32 s65, s17, 6
  s_add_u32 s73, s73, s65
  s_add_u32 s65, s73, 4096
  s_add_u32 s66, s73, 8192
  s_add_u32 s67, s73, 12288
  v_lshlrev_b32 v224, 12, v14
  v_lshl_add_u32 v224, v15, 3, v224
  v_lshlrev_b32 v225, 14, v15
  v_lshl_add_u32 v225, v14, 4, v225
  s_mov_b32 s16, s84
  s_mov_b32 s17, s85
  s_mov_b32 s18, 4194304
  s_mov_b32 s19, 0x20000
  s_mov_b32 s20, s86
  s_mov_b32 s21, s87
  s_mov_b32 s22, 2048
  s_mov_b32 s23, 0x20000
  v_mov_b32 v4, 0
  v_lshlrev_b32 v5, 2, v2
  v_add_u32 v6, 39168, v5
  ds_write_b32 v6, v4
  v_add_u32 v6, s7, v5
  ds_write_b32 v6, v4 offset:4128
  v_and_b32 v6, 7, v2
  v_lshlrev_b32 v6, 2, v6
  v_add_u32 v6, s7, v6
  ds_write_b32 v6, v4
  s_add_u32 m0, s7, 32
  s_nop 0
  buffer_load_dwordx4 v3, s[16:19], s71 offen offset:0 nt lds
  buffer_load_dwordx4 v3, s[16:19], s71 offen offset:1024 nt lds
  buffer_load_dwordx4 v3, s[16:19], s71 offen offset:2048 nt lds
  buffer_load_dwordx4 v3, s[16:19], s71 offen offset:3072 nt lds
  s_lshl_b32 s43, s6, 1
  v_mov_b32 v4, 0
  buffer_load_ushort v164, v4, s[20:23], s43 offen
  s_mov_b32 s20, s92
  s_mov_b32 s21, s93
  s_mov_b32 s22, 2097152
  s_mov_b32 s23, 0x20000
  s_waitcnt vmcnt(15)
  s_waitcnt lgkmcnt(0)
  s_barrier
  s_add_u32 m0, s70, 0
  s_nop 0
  buffer_load_dwordx4 v232, s[20:23], s69 offen offset:0 lds
  buffer_load_dwordx4 v233, s[20:23], s69 offen offset:1024 lds
  buffer_load_dwordx4 v234, s[20:23], s69 offen offset:2048 lds
  buffer_load_dwordx4 v235, s[20:23], s69 offen offset:3072 lds
  s_add_u32 s69, s69, 262144
  s_add_u32 m0, s70, 16384
  s_nop 0
  buffer_load_dwordx4 v232, s[20:23], s69 offen offset:0 lds
  buffer_load_dwordx4 v233, s[20:23], s69 offen offset:1024 lds
  buffer_load_dwordx4 v234, s[20:23], s69 offen offset:2048 lds
  buffer_load_dwordx4 v235, s[20:23], s69 offen offset:3072 lds
  s_add_u32 s69, s69, 262144
  s_waitcnt vmcnt(13)
  s_barrier
  s_add_u32 m0, s70, 32768
  s_nop 0
  buffer_load_dwordx4 v232, s[20:23], s69 offen offset:0 lds
  buffer_load_dwordx4 v233, s[20:23], s69 offen offset:1024 lds
  buffer_load_dwordx4 v234, s[20:23], s69 offen offset:2048 lds
  buffer_load_dwordx4 v235, s[20:23], s69 offen offset:3072 lds
  s_add_u32 s69, s69, 262144
  s_add_u32 m0, s70, 49152
  s_nop 0
  buffer_load_dwordx4 v232, s[20:23], s69 offen offset:0 lds
  buffer_load_dwordx4 v233, s[20:23], s69 offen offset:1024 lds
  buffer_load_dwordx4 v234, s[20:23], s69 offen offset:2048 lds
  buffer_load_dwordx4 v235, s[20:23], s69 offen offset:3072 lds
  s_add_u32 s69, s69, 262144
  s_barrier
  s_mov_b32 s24, s96
  s_mov_b32 s25, s97
  s_mov_b32 s26, 256
  s_mov_b32 s27, 0x20000
  s_mov_b32 s32, s94
  s_mov_b32 s33, s95
  s_mov_b32 s34, 8388608
  s_mov_b32 s35, 0x20000
  s_mov_b32 s40, 0
  s_mov_b32 s42, 0
  v_lshrrev_b32 v5, 1, v2
  v_lshlrev_b32 v5, 7, v5
  v_and_b32 v4, 1, v2
  v_lshl_add_u32 v5, v4, 4, v5
  v_mov_b32 v4, 0
  buffer_load_dword v226, v4, s[24:27], 0 offen sc1
  s_add_u32 s24, s98, 13631488
  s_addc_u32 s25, s99, 0
  s_mov_b32 s26, 4096
  s_mov_b32 s27, 0x20000
  v_lshlrev_b32 v6, 7, v15
  v_lshl_add_u32 v6, v14, 4, v6
  s_lshl_b32 s60, s15, 11
  s_lshl_b32 s61, s15, 16
  s_lshl_b32 s62, s36, 11
  s_add_u32 s61, s61, s62
  s_mov_b32 s43, 4000
K3_fp:
  buffer_load_dwordx4 v[24:27], v5, s[24:27], 0 offen sc1
  buffer_load_dwordx4 v[28:31], v5, s[24:27], 0 offen offset:32 sc1
  s_waitcnt vmcnt(0)
  v_xor_b32 v24, v24, v226
  v_xor_b32 v25, v25, v226
  v_xor_b32 v26, v26, v226
  v_xor_b32 v27, v27, v226
  v_or3_b32 v24, v24, v25, v26
  v_or_b32 v24, v24, v27
  v_cmp_ne_u32 vcc, 0, v24
  s_sub_u32 s43, s43, 1
  s_cbranch_scc1 K3_fp_ok
  s_cmp_eq_u64 vcc, 0
  s_cbranch_scc1 K3_fp_ok
  s_add_u32 s75, s75, 1
  s_sleep 8
  s_branch K3_fp
K3_fp_ok:
  v_mov_b32 v4, s7
  ds_read_u16 v7, v4 offset:32
  v_lshlrev_b32 v164, 16, v164
  s_waitcnt lgkmcnt(0)
  v_lshlrev_b32 v7, 16, v7
  v_add_f32 v7, v7, v164
  v_cvt_pk_bf16_f32 v7, v7, v7
  ds_write_b16 v4, v7 offset:32
  v_xor_b32 v28, v28, v226
  v_xor_b32 v29, v29, v226
  v_xor_b32 v30, v30, v226
  v_xor_b32 v31, v31, v226
  v_or3_b32 v28, v28, v29, v30
  v_or_b32 v28, v28, v31
  v_cmp_ne_u32 vcc, 0, v28
  s_nop 0
  s_cmp_lg_u64 vcc, 0
  s_cbranch_scc1 K3_nou0
  s_add_u32 m0, s7, 4384
  s_nop 0
  buffer_load_dwordx4 v3, s[44:47], s71 offen offset:0 sc1 lds
  buffer_load_dwordx4 v3, s[44:47], s71 offen offset:1024 sc1 lds
  buffer_load_dwordx4 v3, s[44:47], s71 offen offset:2048 sc1 lds
  buffer_load_dwordx4 v3, s[44:47], s71 offen offset:3072 sc1 lds
  s_mov_b32 s42, 1
  s_waitcnt vmcnt(0) lgkmcnt(0)
  s_mov_b64 exec, 1
  ds_add_u32 v9, v11 offset:8
  s_mov_b64 exec, -1
K3_nou0:
  s_mov_b32 s63, 131072
K3_wkvs:
  s_sleep 1
  ds_read_b32 v16, v10 offset:84
  s_waitcnt lgkmcnt(0)
  v_readfirstlane_b32 s62, v16
  s_sub_u32 s63, s63, 1
  s_cbranch_scc1 K3_wkvs_ok
  s_cmp_lt_u32 s62, 2
  s_cbranch_scc1 K3_wkvs
K3_wkvs_ok:
  s_add_u32 m0, s70, 65536
  s_nop 0
  buffer_load_dwordx4 v232, s[20:23], s69 offen offset:0 lds
  buffer_load_dwordx4 v233, s[20:23], s69 offen offset:1024 lds
  buffer_load_dwordx4 v234, s[20:23], s69 offen offset:2048 lds
  buffer_load_dwordx4 v235, s[20:23], s69 offen offset:3072 lds
  s_add_u32 s69, s69, 262144
  s_add_u32 m0, s70, 81920
  s_nop 0
  buffer_load_dwordx4 v232, s[20:23], s69 offen offset:0 lds
  buffer_load_dwordx4 v233, s[20:23], s69 offen offset:1024 lds
  buffer_load_dwordx4 v234, s[20:23], s69 offen offset:2048 lds
  buffer_load_dwordx4 v235, s[20:23], s69 offen offset:3072 lds
  s_add_u32 s69, s69, 262144
  v_and_b32 v7, 31, v2
  v_lshlrev_b32 v7, 11, v7
  s_add_u32 s62, s69, 262144
  buffer_load_dword v165, v7, s[20:23], s62 offen
  s_lshl_b32 s43, s4, 12
  s_add_u32 s43, s43, 139264
  v_add_u32 v8, s43, v3
  s_mov_b32 s63, 131072
K3_wpq:
  s_sleep 1
  ds_read_b32 v16, v9 offset:24
  s_waitcnt lgkmcnt(0)
  v_readfirstlane_b32 s62, v16
  s_sub_u32 s63, s63, 1
  s_cbranch_scc1 K3_wpq_ok
  s_cmp_lt_u32 s62, 1
  s_cbranch_scc1 K3_wpq
K3_wpq_ok:
  ds_read_b128 v[192:195], v8 offset:0
  ds_read_b128 v[196:199], v8 offset:1024
  ds_read_b128 v[200:203], v8 offset:2048
  ds_read_b128 v[204:207], v8 offset:3072
  s_waitcnt lgkmcnt(0)
  s_add_u32 m0, s70, 98304
  s_nop 0
  buffer_load_dwordx4 v232, s[20:23], s69 offen offset:0 lds
  buffer_load_dwordx4 v233, s[20:23], s69 offen offset:1024 lds
  buffer_load_dwordx4 v234, s[20:23], s69 offen offset:2048 lds
  buffer_load_dwordx4 v235, s[20:23], s69 offen offset:3072 lds
  s_add_u32 s69, s69, 262144
  s_mov_b32 s43, 4000
K3_zp:
  buffer_load_dwordx4 v[32:35], v6, s[56:59], s60 offen offset:0 sc1
  buffer_load_dwordx4 v[36:39], v6, s[56:59], s60 offen offset:64 sc1
  s_cmp_lg_u32 s42, 0
  s_cbranch_scc1 K3_zp_nf
  buffer_load_dwordx4 v[28:31], v5, s[24:27], 0 offen offset:32 sc1
  s_waitcnt vmcnt(0)
  v_xor_b32 v28, v28, v226
  v_xor_b32 v29, v29, v226
  v_xor_b32 v30, v30, v226
  v_xor_b32 v31, v31, v226
  v_or3_b32 v28, v28, v29, v30
  v_or_b32 v28, v28, v31
  v_cmp_ne_u32 vcc, 0, v28
  s_nop 0
  s_cmp_lg_u64 vcc, 0
  s_cbranch_scc1 K3_zp_nf
  s_add_u32 m0, s7, 4384
  s_nop 0
  buffer_load_dwordx4 v3, s[44:47], s71 offen offset:0 sc1 lds
  buffer_load_dwordx4 v3, s[44:47], s71 offen offset:1024 sc1 lds
  buffer_load_dwordx4 v3, s[44:47], s71 offen offset:2048 sc1 lds
  buffer_load_dwordx4 v3, s[44:47], s71 offen offset:3072 sc1 lds
  s_mov_b32 s42, 1
  s_waitcnt vmcnt(0) lgkmcnt(0)
  s_mov_b64 exec, 1
  ds_add_u32 v9, v11 offset:8
  s_mov_b64 exec, -1
K3_zp_nf:
  ds_read_b32 v17, v9 offset:56
  s_waitcnt vmcnt(0) lgkmcnt(0)
  v_bitop3_b32 v16, v32, v33, 1 bitop3:0x80
  v_bitop3_b32 v16, v16, v34, v35 bitop3:0x80
  v_bitop3_b32 v16, v16, v36, v37 bitop3:0x80
  v_bitop3_b32 v16, v16, v38, v39 bitop3:0x80
  v_readfirstlane_b32 s41, v17
  v_cmp_eq_u32 vcc, 0, v16
  s_sub_u32 s43, s43, 1
  s_cbranch_scc1 K3_zp_ok
  s_cmp_eq_u64 vcc, 0
  s_cbranch_scc1 K3_zp_ok
  s_cmp_lg_u32 s40, 0
  s_cbranch_scc1 K3_zp_s2
K3_zp_s2:
  s_sleep 10
  s_branch K3_zp
K3_zp_ok:
  s_setprio 2
  s_mov_b32 s43, 4000
  s_mov_b32 s62, s61
  buffer_load_dwordx4 v[64:67], v3, s[52:55], s62 offen offset:0
  buffer_load_dwordx4 v[68:71], v3, s[52:55], s62 offen offset:1024
  s_add_u32 s62, s62, 4096
  buffer_load_dwordx4 v[72:75], v3, s[52:55], s62 offen offset:0
  buffer_load_dwordx4 v[76:79], v3, s[52:55], s62 offen offset:1024
  s_add_u32 s62, s62, 4096
  buffer_load_dwordx4 v[80:83], v3, s[52:55], s62 offen offset:0
  buffer_load_dwordx4 v[84:87], v3, s[52:55], s62 offen offset:1024
  s_add_u32 s62, s62, 4096
  buffer_load_dwordx4 v[88:91], v3, s[52:55], s62 offen offset:0
  buffer_load_dwordx4 v[92:95], v3, s[52:55], s62 offen offset:1024
  s_add_u32 s62, s62, 4096
  buffer_load_dwordx4 v[96:99], v3, s[52:55], s62 offen offset:0
  buffer_load_dwordx4 v[100:103], v3, s[52:55], s62 offen offset:1024
  s_add_u32 s62, s62, 4096
  buffer_load_dwordx4 v[104:107], v3, s[52:55], s62 offen offset:0
  buffer_load_dwordx4 v[108:111], v3, s[52:55], s62 offen offset:1024
  s_add_u32 s62, s62, 4096
  buffer_load_dwordx4 v[112:115], v3, s[52:55], s62 offen offset:0
  buffer_load_dwordx4 v[116:119], v3, s[52:55], s62 offen offset:1024
  s_add_u32 s62, s62, 4096
  buffer_load_dwordx4 v[120:123], v3, s[52:55], s62 offen offset:0
  buffer_load_dwordx4 v[124:127], v3, s[52:55], s62 offen offset:1024
  s_add_u32 s62, s62, 4096
  buffer_load_dwordx4 v[128:131], v3, s[52:55], s62 offen offset:0
  buffer_load_dwordx4 v[132:135], v3, s[52:55], s62 offen offset:1024
  s_add_u32 s62, s62, 4096
  buffer_load_dwordx4 v[136:139], v3, s[52:55], s62 offen offset:0
  buffer_load_dwordx4 v[140:143], v3, s[52:55], s62 offen offset:1024
  s_add_u32 s62, s62, 4096
  buffer_load_dwordx4 v[144:147], v3, s[52:55], s62 offen offset:0
  buffer_load_dwordx4 v[148:151], v3, s[52:55], s62 offen offset:1024
  s_add_u32 s62, s62, 4096
  buffer_load_dwordx4 v[152:155], v3, s[52:55], s62 offen offset:0
  buffer_load_dwordx4 v[156:159], v3, s[52:55], s62 offen offset:1024
  s_add_u32 s62, s62, 4096
  buffer_load_dwordx4 v[160:163], v3, s[52:55], s62 offen offset:0
  buffer_load_dwordx4 v[164:167], v3, s[52:55], s62 offen offset:1024
  s_add_u32 s62, s62, 4096
  buffer_load_dwordx4 v[168:171], v3, s[52:55], s62 offen offset:0
  buffer_load_dwordx4 v[172:175], v3, s[52:55], s62 offen offset:1024
  s_add_u32 s62, s62, 4096
  buffer_load_dwordx4 v[176:179], v3, s[52:55], s62 offen offset:0
  buffer_load_dwordx4 v[180:183], v3, s[52:55], s62 offen offset:1024
  s_add_u32 s62, s62, 4096
  buffer_load_dwordx4 v[184:187], v3, s[52:55], s62 offen offset:0
  buffer_load_dwordx4 v[188:191], v3, s[52:55], s62 offen offset:1024
  s_add_u32 s62, s62, 4096
  s_mov_b32 s16, s76
  s_mov_b32 s17, s77
  s_mov_b32 s18, 4194304
  s_mov_b32 s19, 0x20000
  v_lshlrev_b32 v4, 11, v14
  v_lshl_add_u32 v4, v15, 3, v4
  buffer_load_dwordx2 v[208:209], v4, s[16:19], s64 offen nt
  s_add_u32 s64, s64, 131072
  buffer_load_dwordx2 v[210:211], v4, s[16:19], s64 offen nt
  s_add_u32 s64, s64, 131072
  buffer_load_dwordx2 v[212:213], v4, s[16:19], s64 offen nt
  s_add_u32 s64, s64, 131072
  buffer_load_dwordx2 v[214:215], v4, s[16:19], s64 offen nt
  s_add_u32 s64, s64, 131072
  buffer_load_dwordx2 v[216:217], v4, s[16:19], s64 offen nt
  s_add_u32 s64, s64, 131072
  buffer_load_dwordx2 v[218:219], v4, s[16:19], s64 offen nt
  s_add_u32 s64, s64, 131072
  buffer_load_dwordx2 v[220:221], v4, s[16:19], s64 offen nt
  s_add_u32 s64, s64, 131072
  buffer_load_dwordx2 v[222:223], v4, s[16:19], s64 offen nt
  s_add_u32 s64, s64, 131072
K3_gl:
  v_add_f32_dpp v40, v32, v32 row_ror:8 row_mask:0xf bank_mask:0xf
  v_add_f32_dpp v41, v33, v33 row_ror:8 row_mask:0xf bank_mask:0xf
  v_add_f32_dpp v42, v34, v34 row_ror:8 row_mask:0xf bank_mask:0xf
  v_add_f32_dpp v43, v35, v35 row_ror:8 row_mask:0xf bank_mask:0xf
  v_add_f32_dpp v44, v36, v36 row_ror:8 row_mask:0xf bank_mask:0xf
  v_add_f32_dpp v45, v37, v37 row_ror:8 row_mask:0xf bank_mask:0xf
  v_add_f32_dpp v46, v38, v38 row_ror:8 row_mask:0xf bank_mask:0xf
  v_add_f32_dpp v47, v39, v39 row_ror:8 row_mask:0xf bank_mask:0xf
  v_add_f32_dpp v40, v40, v40 row_ror:4 row_mask:0xf bank_mask:0xf
  v_add_f32_dpp v41, v41, v41 row_ror:4 row_mask:0xf bank_mask:0xf
  v_add_f32_dpp v42, v42, v42 row_ror:4 row_mask:0xf bank_mask:0xf
  v_add_f32_dpp v43, v43, v43 row_ror:4 row_mask:0xf bank_mask:0xf
  v_add_f32_dpp v44, v44, v44 row_ror:4 row_mask:0xf bank_mask:0xf
  v_add_f32_dpp v45, v45, v45 row_ror:4 row_mask:0xf bank_mask:0xf
  v_add_f32_dpp v46, v46, v46 row_ror:4 row_mask:0xf bank_mask:0xf
  v_add_f32_dpp v47, v47, v47 row_ror:4 row_mask:0xf bank_mask:0xf
  v_add_f32_dpp v40, v40, v40 row_ror:2 row_mask:0xf bank_mask:0xf
  v_add_f32_dpp v41, v41, v41 row_ror:2 row_mask:0xf bank_mask:0xf
  v_add_f32_dpp v42, v42, v42 row_ror:2 row_mask:0xf bank_mask:0xf
  v_add_f32_dpp v43, v43, v43 row_ror:2 row_mask:0xf bank_mask:0xf
  v_add_f32_dpp v44, v44, v44 row_ror:2 row_mask:0xf bank_mask:0xf
  v_add_f32_dpp v45, v45, v45 row_ror:2 row_mask:0xf bank_mask:0xf
  v_add_f32_dpp v46, v46, v46 row_ror:2 row_mask:0xf bank_mask:0xf
  v_add_f32_dpp v47, v47, v47 row_ror:2 row_mask:0xf bank_mask:0xf
  v_add_f32_dpp v40, v40, v40 row_ror:1 row_mask:0xf bank_mask:0xf
  v_add_f32_dpp v41, v41, v41 row_ror:1 row_mask:0xf bank_mask:0xf
  v_add_f32_dpp v42, v42, v42 row_ror:1 row_mask:0xf bank_mask:0xf
  v_add_f32_dpp v43, v43, v43 row_ror:1 row_mask:0xf bank_mask:0xf
  v_add_f32_dpp v44, v44, v44 row_ror:1 row_mask:0xf bank_mask:0xf
  v_add_f32_dpp v45, v45, v45 row_ror:1 row_mask:0xf bank_mask:0xf
  v_add_f32_dpp v46, v46, v46 row_ror:1 row_mask:0xf bank_mask:0xf
  v_add_f32_dpp v47, v47, v47 row_ror:1 row_mask:0xf bank_mask:0xf
  v_cvt_pk_bf16_f32 v48, v40, v41
  v_cvt_pk_bf16_f32 v49, v42, v43
  v_cvt_pk_bf16_f32 v50, v44, v45
  v_cvt_pk_bf16_f32 v51, v46, v47
  v_mov_b32 v16, 1
  s_waitcnt vmcnt(38)
  v_bitop3_b32 v16, v16, v64, v65 bitop3:0x80
  v_bitop3_b32 v16, v16, v66, v67 bitop3:0x80
  v_bitop3_b32 v16, v16, v68, v69 bitop3:0x80
  v_bitop3_b32 v16, v16, v70, v71 bitop3:0x80
  s_waitcnt vmcnt(36)
  v_bitop3_b32 v16, v16, v72, v73 bitop3:0x80
  v_bitop3_b32 v16, v16, v74, v75 bitop3:0x80
  v_bitop3_b32 v16, v16, v76, v77 bitop3:0x80
  v_bitop3_b32 v16, v16, v78, v79 bitop3:0x80
  v_add_f32 v64, v64, v72
  v_add_f32 v65, v65, v73
  v_add_f32 v66, v66, v74
  v_add_f32 v67, v67, v75
  v_add_f32 v68, v68, v76
  v_add_f32 v69, v69, v77
  v_add_f32 v70, v70, v78
  v_add_f32 v71, v71, v79
  s_waitcnt vmcnt(34)
  v_bitop3_b32 v16, v16, v80, v81 bitop3:0x80
  v_bitop3_b32 v16, v16, v82, v83 bitop3:0x80
  v_bitop3_b32 v16, v16, v84, v85 bitop3:0x80
  v_bitop3_b32 v16, v16, v86, v87 bitop3:0x80
  v_add_f32 v64, v64, v80
  v_add_f32 v65, v65, v81
  v_add_f32 v66, v66, v82
  v_add_f32 v67, v67, v83
  v_add_f32 v68, v68, v84
  v_add_f32 v69, v69, v85
  v_add_f32 v70, v70, v86
  v_add_f32 v71, v71, v87
  s_waitcnt vmcnt(32)
  v_bitop3_b32 v16, v16, v88, v89 bitop3:0x80
  v_bitop3_b32 v16, v16, v90, v91 bitop3:0x80
  v_bitop3_b32 v16, v16, v92, v93 bitop3:0x80
  v_bitop3_b32 v16, v16, v94, v95 bitop3:0x80
  v_add_f32 v64, v64, v88
  v_add_f32 v65, v65, v89
  v_add_f32 v66, v66, v90
  v_add_f32 v67, v67, v91
  v_add_f32 v68, v68, v92
  v_add_f32 v69, v69, v93
  v_add_f32 v70, v70, v94
  v_add_f32 v71, v71, v95
  s_waitcnt vmcnt(30)
  v_bitop3_b32 v16, v16, v96, v97 bitop3:0x80
  v_bitop3_b32 v16, v16, v98, v99 bitop3:0x80
  v_bitop3_b32 v16, v16, v100, v101 bitop3:0x80
  v_bitop3_b32 v16, v16, v102, v103 bitop3:0x80
  v_add_f32 v64, v64, v96
  v_add_f32 v65, v65, v97
  v_add_f32 v66, v66, v98
  v_add_f32 v67, v67, v99
  v_add_f32 v68, v68, v100
  v_add_f32 v69, v69, v101
  v_add_f32 v70, v70, v102
  v_add_f32 v71, v71, v103
  s_waitcnt vmcnt(28)
  v_bitop3_b32 v16, v16, v104, v105 bitop3:0x80
  v_bitop3_b32 v16, v16, v106, v107 bitop3:0x80
  v_bitop3_b32 v16, v16, v108, v109 bitop3:0x80
  v_bitop3_b32 v16, v16, v110, v111 bitop3:0x80
  v_add_f32 v64, v64, v104
  v_add_f32 v65, v65, v105
  v_add_f32 v66, v66, v106
  v_add_f32 v67, v67, v107
  v_add_f32 v68, v68, v108
  v_add_f32 v69, v69, v109
  v_add_f32 v70, v70, v110
  v_add_f32 v71, v71, v111
  s_waitcnt vmcnt(26)
  v_bitop3_b32 v16, v16, v112, v113 bitop3:0x80
  v_bitop3_b32 v16, v16, v114, v115 bitop3:0x80
  v_bitop3_b32 v16, v16, v116, v117 bitop3:0x80
  v_bitop3_b32 v16, v16, v118, v119 bitop3:0x80
  v_add_f32 v64, v64, v112
  v_add_f32 v65, v65, v113
  v_add_f32 v66, v66, v114
  v_add_f32 v67, v67, v115
  v_add_f32 v68, v68, v116
  v_add_f32 v69, v69, v117
  v_add_f32 v70, v70, v118
  v_add_f32 v71, v71, v119
  s_waitcnt vmcnt(24)
  v_bitop3_b32 v16, v16, v120, v121 bitop3:0x80
  v_bitop3_b32 v16, v16, v122, v123 bitop3:0x80
  v_bitop3_b32 v16, v16, v124, v125 bitop3:0x80
  v_bitop3_b32 v16, v16, v126, v127 bitop3:0x80
  v_add_f32 v64, v64, v120
  v_add_f32 v65, v65, v121
  v_add_f32 v66, v66, v122
  v_add_f32 v67, v67, v123
  v_add_f32 v68, v68, v124
  v_add_f32 v69, v69, v125
  v_add_f32 v70, v70, v126
  v_add_f32 v71, v71, v127
  s_waitcnt vmcnt(22)
  v_bitop3_b32 v16, v16, v128, v129 bitop3:0x80
  v_bitop3_b32 v16, v16, v130, v131 bitop3:0x80
  v_bitop3_b32 v16, v16, v132, v133 bitop3:0x80
  v_bitop3_b32 v16, v16, v134, v135 bitop3:0x80
  v_add_f32 v64, v64, v128
  v_add_f32 v65, v65, v129
  v_add_f32 v66, v66, v130
  v_add_f32 v67, v67, v131
  v_add_f32 v68, v68, v132
  v_add_f32 v69, v69, v133
  v_add_f32 v70, v70, v134
  v_add_f32 v71, v71, v135
  s_waitcnt vmcnt(20)
  v_bitop3_b32 v16, v16, v136, v137 bitop3:0x80
  v_bitop3_b32 v16, v16, v138, v139 bitop3:0x80
  v_bitop3_b32 v16, v16, v140, v141 bitop3:0x80
  v_bitop3_b32 v16, v16, v142, v143 bitop3:0x80
  v_add_f32 v64, v64, v136
  v_add_f32 v65, v65, v137
  v_add_f32 v66, v66, v138
  v_add_f32 v67, v67, v139
  v_add_f32 v68, v68, v140
  v_add_f32 v69, v69, v141
  v_add_f32 v70, v70, v142
  v_add_f32 v71, v71, v143
  s_waitcnt vmcnt(18)
  v_bitop3_b32 v16, v16, v144, v145 bitop3:0x80
  v_bitop3_b32 v16, v16, v146, v147 bitop3:0x80
  v_bitop3_b32 v16, v16, v148, v149 bitop3:0x80
  v_bitop3_b32 v16, v16, v150, v151 bitop3:0x80
  v_add_f32 v64, v64, v144
  v_add_f32 v65, v65, v145
  v_add_f32 v66, v66, v146
  v_add_f32 v67, v67, v147
  v_add_f32 v68, v68, v148
  v_add_f32 v69, v69, v149
  v_add_f32 v70, v70, v150
  v_add_f32 v71, v71, v151
  s_waitcnt vmcnt(16)
  v_bitop3_b32 v16, v16, v152, v153 bitop3:0x80
  v_bitop3_b32 v16, v16, v154, v155 bitop3:0x80
  v_bitop3_b32 v16, v16, v156, v157 bitop3:0x80
  v_bitop3_b32 v16, v16, v158, v159 bitop3:0x80
  v_add_f32 v64, v64, v152
  v_add_f32 v65, v65, v153
  v_add_f32 v66, v66, v154
  v_add_f32 v67, v67, v155
  v_add_f32 v68, v68, v156
  v_add_f32 v69, v69, v157
  v_add_f32 v70, v70, v158
  v_add_f32 v71, v71, v159
  s_waitcnt vmcnt(14)
  v_bitop3_b32 v16, v16, v160, v161 bitop3:0x80
  v_bitop3_b32 v16, v16, v162, v163 bitop3:0x80
  v_bitop3_b32 v16, v16, v164, v165 bitop3:0x80
  v_bitop3_b32 v16, v16, v166, v167 bitop3:0x80
  v_add_f32 v64, v64, v160
  v_add_f32 v65, v65, v161
  v_add_f32 v66, v66, v162
  v_add_f32 v67, v67, v163
  v_add_f32 v68, v68, v164
  v_add_f32 v69, v69, v165
  v_add_f32 v70, v70, v166
  v_add_f32 v71, v71, v167
  s_waitcnt vmcnt(12)
  v_bitop3_b32 v16, v16, v168, v169 bitop3:0x80
  v_bitop3_b32 v16, v16, v170, v171 bitop3:0x80
  v_bitop3_b32 v16, v16, v172, v173 bitop3:0x80
  v_bitop3_b32 v16, v16, v174, v175 bitop3:0x80
  v_add_f32 v64, v64, v168
  v_add_f32 v65, v65, v169
  v_add_f32 v66, v66, v170
  v_add_f32 v67, v67, v171
  v_add_f32 v68, v68, v172
  v_add_f32 v69, v69, v173
  v_add_f32 v70, v70, v174
  v_add_f32 v71, v71, v175
  s_waitcnt vmcnt(10)
  v_bitop3_b32 v16, v16, v176, v177 bitop3:0x80
  v_bitop3_b32 v16, v16, v178, v179 bitop3:0x80
  v_bitop3_b32 v16, v16, v180, v181 bitop3:0x80
  v_bitop3_b32 v16, v16, v182, v183 bitop3:0x80
  v_add_f32 v64, v64, v176
  v_add_f32 v65, v65, v177
  v_add_f32 v66, v66, v178
  v_add_f32 v67, v67, v179
  v_add_f32 v68, v68, v180
  v_add_f32 v69, v69, v181
  v_add_f32 v70, v70, v182
  v_add_f32 v71, v71, v183
  s_waitcnt vmcnt(8)
  v_bitop3_b32 v16, v16, v184, v185 bitop3:0x80
  v_bitop3_b32 v16, v16, v186, v187 bitop3:0x80
  v_bitop3_b32 v16, v16, v188, v189 bitop3:0x80
  v_bitop3_b32 v16, v16, v190, v191 bitop3:0x80
  v_add_f32 v64, v64, v184
  v_add_f32 v65, v65, v185
  v_add_f32 v66, v66, v186
  v_add_f32 v67, v67, v187
  v_add_f32 v68, v68, v188
  v_add_f32 v69, v69, v189
  v_add_f32 v70, v70, v190
  v_add_f32 v71, v71, v191
  v_cmp_eq_u32 vcc, 0, v16
  s_sub_u32 s43, s43, 1
  s_cbranch_scc1 K3_gl_ok
  s_cmp_eq_u64 vcc, 0
  s_cbranch_scc1 K3_gl_ok
  s_add_u32 s75, s75, 1
  s_sleep 4
  s_mov_b32 s62, s61
  buffer_load_dwordx4 v[64:67], v3, s[52:55], s62 offen offset:0 sc1
  buffer_load_dwordx4 v[68:71], v3, s[52:55], s62 offen offset:1024 sc1
  s_add_u32 s62, s62, 4096
  buffer_load_dwordx4 v[72:75], v3, s[52:55], s62 offen offset:0 sc1
  buffer_load_dwordx4 v[76:79], v3, s[52:55], s62 offen offset:1024 sc1
  s_add_u32 s62, s62, 4096
  buffer_load_dwordx4 v[80:83], v3, s[52:55], s62 offen offset:0 sc1
  buffer_load_dwordx4 v[84:87], v3, s[52:55], s62 offen offset:1024 sc1
  s_add_u32 s62, s62, 4096
  buffer_load_dwordx4 v[88:91], v3, s[52:55], s62 offen offset:0 sc1
  buffer_load_dwordx4 v[92:95], v3, s[52:55], s62 offen offset:1024 sc1
  s_add_u32 s62, s62, 4096
  buffer_load_dwordx4 v[96:99], v3, s[52:55], s62 offen offset:0 sc1
  buffer_load_dwordx4 v[100:103], v3, s[52:55], s62 offen offset:1024 sc1
  s_add_u32 s62, s62, 4096
  buffer_load_dwordx4 v[104:107], v3, s[52:55], s62 offen offset:0 sc1
  buffer_load_dwordx4 v[108:111], v3, s[52:55], s62 offen offset:1024 sc1
  s_add_u32 s62, s62, 4096
  buffer_load_dwordx4 v[112:115], v3, s[52:55], s62 offen offset:0 sc1
  buffer_load_dwordx4 v[116:119], v3, s[52:55], s62 offen offset:1024 sc1
  s_add_u32 s62, s62, 4096
  buffer_load_dwordx4 v[120:123], v3, s[52:55], s62 offen offset:0 sc1
  buffer_load_dwordx4 v[124:127], v3, s[52:55], s62 offen offset:1024 sc1
  s_add_u32 s62, s62, 4096
  buffer_load_dwordx4 v[128:131], v3, s[52:55], s62 offen offset:0 sc1
  buffer_load_dwordx4 v[132:135], v3, s[52:55], s62 offen offset:1024 sc1
  s_add_u32 s62, s62, 4096
  buffer_load_dwordx4 v[136:139], v3, s[52:55], s62 offen offset:0 sc1
  buffer_load_dwordx4 v[140:143], v3, s[52:55], s62 offen offset:1024 sc1
  s_add_u32 s62, s62, 4096
  buffer_load_dwordx4 v[144:147], v3, s[52:55], s62 offen offset:0 sc1
  buffer_load_dwordx4 v[148:151], v3, s[52:55], s62 offen offset:1024 sc1
  s_add_u32 s62, s62, 4096
  buffer_load_dwordx4 v[152:155], v3, s[52:55], s62 offen offset:0 sc1
  buffer_load_dwordx4 v[156:159], v3, s[52:55], s62 offen offset:1024 sc1
  s_add_u32 s62, s62, 4096
  buffer_load_dwordx4 v[160:163], v3, s[52:55], s62 offen offset:0 sc1
  buffer_load_dwordx4 v[164:167], v3, s[52:55], s62 offen offset:1024 sc1
  s_add_u32 s62, s62, 4096
  buffer_load_dwordx4 v[168:171], v3, s[52:55], s62 offen offset:0 sc1
  buffer_load_dwordx4 v[172:175], v3, s[52:55], s62 offen offset:1024 sc1
  s_add_u32 s62, s62, 4096
  buffer_load_dwordx4 v[176:179], v3, s[52:55], s62 offen offset:0 sc1
  buffer_load_dwordx4 v[180:183], v3, s[52:55], s62 offen offset:1024 sc1
  s_add_u32 s62, s62, 4096
  buffer_load_dwordx4 v[184:187], v3, s[52:55], s62 offen offset:0 sc1
  buffer_load_dwordx4 v[188:191], v3, s[52:55], s62 offen offset:1024 sc1
  s_add_u32 s62, s62, 4096
  s_waitcnt vmcnt(0)
  s_branch K3_gl
K3_gl_ok:
  v_cvt_pk_bf16_f32 v40, v64, v65
  v_cvt_pk_bf16_f32 v41, v66, v67
  v_cvt_pk_bf16_f32 v42, v68, v69
  v_cvt_pk_bf16_f32 v43, v70, v71
  s_lshl_b32 s43, s4, 10
  s_add_u32 s43, s43, 34816
  v_add_u32 v5, s43, v3
  ds_write_b128 v5, v[40:43]
  s_lshl_b32 s43, s37, 2
  v_add_u32 v7, s43, v10
  s_lshl_b32 s43, s37, 11
  s_add_u32 s43, s43, 34816
  v_add_u32 v5, s43, v3
  s_waitcnt lgkmcnt(0)
  s_mov_b64 exec, 1
  ds_add_u32 v7, v11 offset:40
  s_mov_b64 exec, -1
  s_mov_b32 s61, 131072
K3_wkt:
  ds_read_b32 v52, v7 offset:40
  s_waitcnt lgkmcnt(0)
  v_readfirstlane_b32 s60, v52
  s_sub_u32 s61, s61, 1
  s_cbranch_scc1 K3_wkt_ok
  s_cmp_lt_u32 s60, 2
  s_cbranch_scc1 K3_wkt
K3_wkt_ok:
  ds_read_b128 v[40:43], v5
  ds_read_b128 v[44:47], v5 offset:1024
  s_waitcnt lgkmcnt(0)
  v_mfma_f32_16x16x32_bf16 v[72:75], v[48:51], v[192:195], 0
  v_mfma_f32_16x16x32_bf16 v[64:67], v[40:43], v[192:195], 0
  v_mfma_f32_16x16x32_bf16 v[68:71], v[44:47], v[192:195], 0
  v_mfma_f32_16x16x32_bf16 v[84:87], v[48:51], v[196:199], 0
  v_mfma_f32_16x16x32_bf16 v[76:79], v[40:43], v[196:199], 0
  v_mfma_f32_16x16x32_bf16 v[80:83], v[44:47], v[196:199], 0
  v_mfma_f32_16x16x32_bf16 v[96:99], v[48:51], v[200:203], 0
  v_mfma_f32_16x16x32_bf16 v[88:91], v[40:43], v[200:203], 0
  v_mfma_f32_16x16x32_bf16 v[92:95], v[44:47], v[200:203], 0
  v_mfma_f32_16x16x32_bf16 v[108:111], v[48:51], v[204:207], 0
  v_mfma_f32_16x16x32_bf16 v[100:103], v[40:43], v[204:207], 0
  v_mfma_f32_16x16x32_bf16 v[104:107], v[44:47], v[204:207], 0
  s_lshl_b32 s60, s12, 3
  s_lshl_b32 s61, s36, 2
  s_add_u32 s60, s60, s61
  s_lshl_b32 s60, s60, 5
  s_add_u32 s60, s60, s15
  s_lshl_b32 s60, s60, 10
  s_mov_b32 s61, 897988541
  v_add_f32 v112, s61, v72
  v_rcp_f32 v112, v112
  v_add_f32 v113, s61, v84
  v_rcp_f32 v113, v113
  v_add_f32 v114, s61, v96
  v_rcp_f32 v114, v114
  v_add_f32 v115, s61, v108
  v_rcp_f32 v115, v115
  v_mul_f32 v64, v64, v112
  v_mul_f32 v65, v65, v112
  v_mul_f32 v66, v66, v112
  v_mul_f32 v67, v67, v112
  v_mul_f32 v68, v68, v112
  v_mul_f32 v69, v69, v112
  v_mul_f32 v70, v70, v112
  v_mul_f32 v71, v71, v112
  v_cvt_pk_bf16_f32 v120, v64, v65
  v_cvt_pk_bf16_f32 v121, v66, v67
  v_cvt_pk_bf16_f32 v122, v68, v69
  v_cvt_pk_bf16_f32 v123, v70, v71
  v_or_b32 v120, 1, v120
  v_or_b32 v121, 1, v121
  v_or_b32 v122, 1, v122
  v_or_b32 v123, 1, v123
  buffer_store_dwordx4 v[120:123], v3, s[48:51], s60 offen sc1
  s_add_u32 s60, s60, 32768
  v_mul_f32 v76, v76, v113
  v_mul_f32 v77, v77, v113
  v_mul_f32 v78, v78, v113
  v_mul_f32 v79, v79, v113
  v_mul_f32 v80, v80, v113
  v_mul_f32 v81, v81, v113
  v_mul_f32 v82, v82, v113
  v_mul_f32 v83, v83, v113
  v_cvt_pk_bf16_f32 v124, v76, v77
  v_cvt_pk_bf16_f32 v125, v78, v79
  v_cvt_pk_bf16_f32 v126, v80, v81
  v_cvt_pk_bf16_f32 v127, v82, v83
  v_or_b32 v124, 1, v124
  v_or_b32 v125, 1, v125
  v_or_b32 v126, 1, v126
  v_or_b32 v127, 1, v127
  buffer_store_dwordx4 v[124:127], v3, s[48:51], s60 offen sc1
  s_add_u32 s60, s60, 32768
  v_mul_f32 v88, v88, v114
  v_mul_f32 v89, v89, v114
  v_mul_f32 v90, v90, v114
  v_mul_f32 v91, v91, v114
  v_mul_f32 v92, v92, v114
  v_mul_f32 v93, v93, v114
  v_mul_f32 v94, v94, v114
  v_mul_f32 v95, v95, v114
  v_cvt_pk_bf16_f32 v128, v88, v89
  v_cvt_pk_bf16_f32 v129, v90, v91
  v_cvt_pk_bf16_f32 v130, v92, v93
  v_cvt_pk_bf16_f32 v131, v94, v95
  v_or_b32 v128, 1, v128
  v_or_b32 v129, 1, v129
  v_or_b32 v130, 1, v130
  v_or_b32 v131, 1, v131
  buffer_store_dwordx4 v[128:131], v3, s[48:51], s60 offen sc1
  s_add_u32 s60, s60, 32768
  v_mul_f32 v100, v100, v115
  v_mul_f32 v101, v101, v115
  v_mul_f32 v102, v102, v115
  v_mul_f32 v103, v103, v115
  v_mul_f32 v104, v104, v115
  v_mul_f32 v105, v105, v115
  v_mul_f32 v106, v106, v115
  v_mul_f32 v107, v107, v115
  v_cvt_pk_bf16_f32 v132, v100, v101
  v_cvt_pk_bf16_f32 v133, v102, v103
  v_cvt_pk_bf16_f32 v134, v104, v105
  v_cvt_pk_bf16_f32 v135, v106, v107
  v_or_b32 v132, 1, v132
  v_or_b32 v133, 1, v133
  v_or_b32 v134, 1, v134
  v_or_b32 v135, 1, v135
  buffer_store_dwordx4 v[132:135], v3, s[48:51], s60 offen sc1
  s_add_u32 s60, s60, 32768
  s_setprio 0
  s_mov_b32 s43, 4000
  v_lshrrev_b32 v5, 1, v2
  v_lshlrev_b32 v5, 7, v5
  v_and_b32 v4, 1, v2
  v_lshl_add_u32 v5, v4, 4, v5
K3_ul:
  s_cmp_lg_u32 s42, 0
  s_cbranch_scc1 K3_ul_done
  buffer_load_dwordx4 v[28:31], v5, s[24:27], 0 offen offset:32 sc1
  s_waitcnt vmcnt(0)
  v_xor_b32 v28, v28, v226
  v_xor_b32 v29, v29, v226
  v_xor_b32 v30, v30, v226
  v_xor_b32 v31, v31, v226
  v_or3_b32 v28, v28, v29, v30
  v_or_b32 v28, v28, v31
  v_cmp_ne_u32 vcc, 0, v28
  s_sub_u32 s43, s43, 1
  s_cbranch_scc1 K3_ul_go
  s_cmp_eq_u64 vcc, 0
  s_cbranch_scc1 K3_ul_go
  s_sleep 4
  s_branch K3_ul
K3_ul_go:
  s_add_u32 m0, s7, 4384
  s_nop 0
  buffer_load_dwordx4 v3, s[44:47], s71 offen offset:0 sc1 lds
  buffer_load_dwordx4 v3, s[44:47], s71 offen offset:1024 sc1 lds
  buffer_load_dwordx4 v3, s[44:47], s71 offen offset:2048 sc1 lds
  buffer_load_dwordx4 v3, s[44:47], s71 offen offset:3072 sc1 lds
  s_mov_b32 s42, 1
  s_waitcnt vmcnt(0) lgkmcnt(0)
  s_mov_b64 exec, 1
  ds_add_u32 v9, v11 offset:8
  s_mov_b64 exec, -1
K3_ul_done:
  s_and_b32 s60, s10, 3
  s_lshl_b32 s60, s60, 2
  s_and_b32 s61, s11, 3
  s_add_u32 s60, s60, s61
  s_lshl_b32 s60, s60, 18
  s_lshr_b32 s61, s11, 2
  s_lshl_b32 s61, s61, 2
  s_add_u32 s61, s61, s4
  s_lshl_b32 s61, s61, 13
  s_add_u32 s63, s60, s61
  v_lshlrev_b32 v8, 7, v2
  s_mov_b32 s61, 131072
K3_wcd:
  s_sleep 1
  ds_read_b32 v16, v9 offset:56
  s_waitcnt lgkmcnt(0)
  v_readfirstlane_b32 s60, v16
  s_sub_u32 s61, s61, 1
  s_cbranch_scc1 K3_wcd_ok
  s_cmp_lt_u32 s60, 1
  s_cbranch_scc1 K3_wcd
K3_wcd_ok:
  s_mov_b32 m0, s7
  s_nop 0
  buffer_load_dwordx4 v232, s[20:23], s69 offen offset:0 lds
  buffer_load_dwordx4 v233, s[20:23], s69 offen offset:1024 lds
  buffer_load_dwordx4 v234, s[20:23], s69 offen offset:2048 lds
  buffer_load_dwordx4 v235, s[20:23], s69 offen offset:3072 lds
  s_add_u32 s69, s69, 262144
  s_waitcnt vmcnt(4)
  buffer_load_dword v60, v8, s[48:51], s63 offen
  s_waitcnt vmcnt(0)
  s_mov_b64 exec, 1
  ds_add_u32 v10, v11 offset:48
  s_mov_b64 exec, -1
  s_cmp_eq_u32 s40, 1
  s_cbranch_scc1 K3_fin
  s_mov_b32 s40, 2
  s_mov_b32 s43, 4000
K3_post:
  buffer_load_dwordx4 v[16:19], v225, s[44:47], s73 offen sc1
  buffer_load_dwordx4 v[20:23], v225, s[44:47], s65 offen sc1
  buffer_load_dwordx4 v[24:27], v225, s[44:47], s66 offen sc1
  buffer_load_dwordx4 v[28:31], v225, s[44:47], s67 offen sc1
  s_waitcnt vmcnt(0)
  v_bitop3_b32 v48, v16, v17, 1 bitop3:0x80
  v_bitop3_b32 v48, v48, v18, v19 bitop3:0x80
  v_bitop3_b32 v48, v48, v20, v21 bitop3:0x80
  v_bitop3_b32 v48, v48, v22, v23 bitop3:0x80
  v_bitop3_b32 v48, v48, v24, v25 bitop3:0x80
  v_bitop3_b32 v48, v48, v26, v27 bitop3:0x80
  v_bitop3_b32 v48, v48, v28, v29 bitop3:0x80
  v_bitop3_b32 v48, v48, v30, v31 bitop3:0x80
  v_cmp_eq_u32 vcc, 0, v48
  s_nop 0
  s_cmp_eq_u64 vcc, 0
  s_cbranch_scc1 K3_yok
  s_add_u32 s75, s75, 1
  s_cmp_eq_u32 s40, 0
  s_cbranch_scc1 K3_zp_s2
  s_sub_u32 s43, s43, 1
  s_cbranch_scc1 K3_yok
  s_sleep 8
  s_branch K3_post
K3_yok:
  v_lshlrev_b32 v48, 16, v16
  v_lshlrev_b32 v49, 16, v20
  v_lshlrev_b32 v50, 16, v24
  v_lshlrev_b32 v51, 16, v28
  v_lshlrev_b32 v52, 16, v208
  v_and_b32 v53, 0xffff0000, v208
  v_lshlrev_b32 v54, 16, v209
  v_and_b32 v55, 0xffff0000, v209
  v_mul_f32 v48, v48, v52
  v_mul_f32 v49, v49, v53
  v_mul_f32 v50, v50, v54
  v_mul_f32 v51, v51, v55
  v_cvt_pk_bf16_f32 v64, v48, v49
  v_cvt_pk_bf16_f32 v65, v50, v51
  buffer_store_dwordx2 v[64:65], v224, s[32:35], s72 offen
  s_add_u32 s72, s72, 262144
  v_and_b32 v56, 0xffff0000, v16
  v_and_b32 v57, 0xffff0000, v20
  v_and_b32 v58, 0xffff0000, v24
  v_and_b32 v59, 0xffff0000, v28
  v_lshlrev_b32 v60, 16, v210
  v_and_b32 v61, 0xffff0000, v210
  v_lshlrev_b32 v62, 16, v211
  v_and_b32 v63, 0xffff0000, v211
  v_mul_f32 v56, v56, v60
  v_mul_f32 v57, v57, v61
  v_mul_f32 v58, v58, v62
  v_mul_f32 v59, v59, v63
  v_cvt_pk_bf16_f32 v66, v56, v57
  v_cvt_pk_bf16_f32 v67, v58, v59
  buffer_store_dwordx2 v[66:67], v224, s[32:35], s72 offen
  s_add_u32 s72, s72, 262144
  v_lshlrev_b32 v48, 16, v17
  v_lshlrev_b32 v49, 16, v21
  v_lshlrev_b32 v50, 16, v25
  v_lshlrev_b32 v51, 16, v29
  v_lshlrev_b32 v52, 16, v212
  v_and_b32 v53, 0xffff0000, v212
  v_lshlrev_b32 v54, 16, v213
  v_and_b32 v55, 0xffff0000, v213
  v_mul_f32 v48, v48, v52
  v_mul_f32 v49, v49, v53
  v_mul_f32 v50, v50, v54
  v_mul_f32 v51, v51, v55
  v_cvt_pk_bf16_f32 v68, v48, v49
  v_cvt_pk_bf16_f32 v69, v50, v51
  buffer_store_dwordx2 v[68:69], v224, s[32:35], s72 offen
  s_add_u32 s72, s72, 262144
  v_and_b32 v56, 0xffff0000, v17
  v_and_b32 v57, 0xffff0000, v21
  v_and_b32 v58, 0xffff0000, v25
  v_and_b32 v59, 0xffff0000, v29
  v_lshlrev_b32 v60, 16, v214
  v_and_b32 v61, 0xffff0000, v214
  v_lshlrev_b32 v62, 16, v215
  v_and_b32 v63, 0xffff0000, v215
  v_mul_f32 v56, v56, v60
  v_mul_f32 v57, v57, v61
  v_mul_f32 v58, v58, v62
  v_mul_f32 v59, v59, v63
  v_cvt_pk_bf16_f32 v70, v56, v57
  v_cvt_pk_bf16_f32 v71, v58, v59
  buffer_store_dwordx2 v[70:71], v224, s[32:35], s72 offen
  s_add_u32 s72, s72, 262144
  v_lshlrev_b32 v48, 16, v18
  v_lshlrev_b32 v49, 16, v22
  v_lshlrev_b32 v50, 16, v26
  v_lshlrev_b32 v51, 16, v30
  v_lshlrev_b32 v52, 16, v216
  v_and_b32 v53, 0xffff0000, v216
  v_lshlrev_b32 v54, 16, v217
  v_and_b32 v55, 0xffff0000, v217
  v_mul_f32 v48, v48, v52
  v_mul_f32 v49, v49, v53
  v_mul_f32 v50, v50, v54
  v_mul_f32 v51, v51, v55
  v_cvt_pk_bf16_f32 v72, v48, v49
  v_cvt_pk_bf16_f32 v73, v50, v51
  buffer_store_dwordx2 v[72:73], v224, s[32:35], s72 offen
  s_add_u32 s72, s72, 262144
  v_and_b32 v56, 0xffff0000, v18
  v_and_b32 v57, 0xffff0000, v22
  v_and_b32 v58, 0xffff0000, v26
  v_and_b32 v59, 0xffff0000, v30
  v_lshlrev_b32 v60, 16, v218
  v_and_b32 v61, 0xffff0000, v218
  v_lshlrev_b32 v62, 16, v219
  v_and_b32 v63, 0xffff0000, v219
  v_mul_f32 v56, v56, v60
  v_mul_f32 v57, v57, v61
  v_mul_f32 v58, v58, v62
  v_mul_f32 v59, v59, v63
  v_cvt_pk_bf16_f32 v74, v56, v57
  v_cvt_pk_bf16_f32 v75, v58, v59
  buffer_store_dwordx2 v[74:75], v224, s[32:35], s72 offen
  s_add_u32 s72, s72, 262144
  v_lshlrev_b32 v48, 16, v19
  v_lshlrev_b32 v49, 16, v23
  v_lshlrev_b32 v50, 16, v27
  v_lshlrev_b32 v51, 16, v31
  v_lshlrev_b32 v52, 16, v220
  v_and_b32 v53, 0xffff0000, v220
  v_lshlrev_b32 v54, 16, v221
  v_and_b32 v55, 0xffff0000, v221
  v_mul_f32 v48, v48, v52
  v_mul_f32 v49, v49, v53
  v_mul_f32 v50, v50, v54
  v_mul_f32 v51, v51, v55
  v_cvt_pk_bf16_f32 v76, v48, v49
  v_cvt_pk_bf16_f32 v77, v50, v51
  buffer_store_dwordx2 v[76:77], v224, s[32:35], s72 offen
  s_add_u32 s72, s72, 262144
  v_and_b32 v56, 0xffff0000, v19
  v_and_b32 v57, 0xffff0000, v23
  v_and_b32 v58, 0xffff0000, v27
  v_and_b32 v59, 0xffff0000, v31
  v_lshlrev_b32 v60, 16, v222
  v_and_b32 v61, 0xffff0000, v222
  v_lshlrev_b32 v62, 16, v223
  v_and_b32 v63, 0xffff0000, v223
  v_mul_f32 v56, v56, v60
  v_mul_f32 v57, v57, v61
  v_mul_f32 v58, v58, v62
  v_mul_f32 v59, v59, v63
  v_cvt_pk_bf16_f32 v78, v56, v57
  v_cvt_pk_bf16_f32 v79, v58, v59
  buffer_store_dwordx2 v[78:79], v224, s[32:35], s72 offen
  s_add_u32 s72, s72, 262144
  s_mov_b32 s41, s40
  s_mov_b32 s40, 1
  s_cmp_eq_u32 s41, 0
  s_cbranch_scc1 K3_zp
K3_fin:
K3_end:
  s_endpgm
.section .rodata,"a"
.p2align 6
.amdhsa_kernel concat_heads__ssm_conv_h3__linear_attn_block__prompt_kernel
  .amdhsa_next_free_vgpr 252
  .amdhsa_next_free_sgpr 102
  .amdhsa_accum_offset 252
  .amdhsa_group_segment_fixed_size 0
  .amdhsa_kernarg_size 96
  .amdhsa_user_sgpr_count 2
  .amdhsa_user_sgpr_kernarg_segment_ptr 1
  .amdhsa_system_sgpr_workgroup_id_x 1
.end_amdhsa_kernel
```

```asm
; @launch grid=(256,1,1) block=(512,1,1) lds=163840
.amdgcn_target "amdgcn-amd-amdhsa--gfx950"
.text
.globl concat_heads__ssm_conv_h3__linear_attn_block__prompt_kernel
.p2align 8
.type concat_heads__ssm_conv_h3__linear_attn_block__prompt_kernel,@function
concat_heads__ssm_conv_h3__linear_attn_block__prompt_kernel:
  s_cmp_ge_u32 s2, 256
  s_cbranch_scc1 K3_end
  s_load_dwordx8 s[84:91], s[0:1], 32
  s_load_dwordx8 s[92:99], s[0:1], 64
  s_load_dwordx8 s[76:83], s[0:1], 0
  v_lshrrev_b32 v1, 6, v0
  v_and_b32 v2, 63, v0
  s_and_b32 s10, s2, 7
  v_readfirstlane_b32 s3, v1
  s_lshr_b32 s11, s2, 3
  s_and_b32 s12, s10, 1
  s_lshl_b32 s12, s12, 3
  s_and_b32 s13, s11, 7
  s_add_u32 s12, s12, s13
  s_lshr_b32 s13, s10, 1
  s_lshl_b32 s13, s13, 2
  s_lshr_b32 s14, s11, 3
  s_add_u32 s13, s13, s14
  s_mov_b32 s75, 0
  s_and_b32 s4, s3, 3
  s_and_b32 s36, s3, 1
  s_bfe_u32 s37, s3, 0x10001
  s_lshl_b32 s5, s13, 1
  s_add_u32 s5, s5, s37
  s_xor_b32 s15, s5, 2
  s_lshl_b32 s6, s10, 7
  s_lshl_b32 s7, s11, 2
  s_add_u32 s6, s6, s7
  s_add_u32 s6, s6, s4
  s_mul_i32 s7, s4, 8704
  v_lshlrev_b32 v3, 4, v2
  v_lshrrev_b32 v14, 4, v2
  v_and_b32 v15, 15, v2
  s_waitcnt lgkmcnt(0)
  s_cmp_ge_u32 s3, 4
  s_cbranch_scc1 K3_L
  s_cmp_lg_u32 s3, 0
  s_cbranch_scc1 K3_pfw
  s_mov_b32 s40, s88
  s_mov_b32 s41, s89
  s_mov_b32 s42, 4194304
  s_mov_b32 s43, 0x20000
  v_lshrrev_b32 v192, 3, v2
  v_lshlrev_b32 v192, 11, v192
  v_and_b32 v16, 7, v2
  v_lshl_add_u32 v192, v16, 7, v192
  s_lshl_b32 s45, s2, 14
  s_add_u32 s44, s45, 1024
  s_branch K3_pfd
K3_pfw:
  s_mov_b32 s40, s90
  s_mov_b32 s41, s91
  s_mov_b32 s42, 6291456
  s_mov_b32 s43, 0x20000
  v_lshlrev_b32 v192, 7, v2
  s_mul_i32 s45, s2, 12288
  s_sub_u32 s44, s3, 1
  s_lshl_b32 s44, s44, 12
  s_add_u32 s45, s45, s44
  s_add_u32 s44, s45, 3145728
  s_cmp_eq_u32 s3, 3
  s_cselect_b32 s45, 8388608, s45
  s_cselect_b32 s44, 8388608, s44
K3_pfd:
  buffer_load_dword v195, v192, s[40:43], s45 offen
  s_mov_b32 s56, s96
  s_mov_b32 s57, s97
  s_mov_b32 s58, 256
  s_mov_b32 s59, 0x20000
  s_add_u32 s60, s98, 13631488
  s_addc_u32 s61, s99, 0
  s_mov_b32 s62, 4096
  s_mov_b32 s63, 0x20000
  s_memrealtime s[16:17]
  v_mov_b32 v199, 0
  s_waitcnt lgkmcnt(0)
  s_or_b32 s16, s16, 1
  v_mov_b32 v198, s16
  s_cmp_lg_u32 s3, 3
  s_cbranch_scc1 K3_noseed
  s_cmp_lg_u32 s11, 0
  s_cbranch_scc1 K3_noseed
  v_mov_b32 v196, s16
  v_mov_b32 v197, 0
  s_mov_b64 exec, 1
  buffer_atomic_cmpswap v[196:197], v199, s[56:59], 0 offen sc1
  s_mov_b64 exec, -1
K3_noseed:
  s_lshl_b32 s46, s11, 7
  s_lshl_b32 s47, s10, 2
  s_add_u32 s47, s47, s46
  s_cmp_ge_u32 s3, 2
  s_cselect_b32 s48, s80, s78
  s_cselect_b32 s49, s81, s79
  s_mov_b32 s50, 4194304
  s_mov_b32 s51, 0x20000
  v_lshrrev_b32 v193, 2, v2
  v_lshlrev_b32 v193, 11, v193
  v_and_b32 v16, 3, v2
  v_lshl_add_u32 v193, v16, 7, v193
  s_lshr_b32 s45, s2, 2
  s_lshl_b32 s45, s45, 16
  s_lshl_b32 s46, s36, 15
  s_add_u32 s45, s45, s46
  s_and_b32 s46, s2, 3
  s_lshl_b32 s46, s46, 9
  s_add_u32 s45, s45, s46
  s_mov_b32 s45, 16777216
  v_mov_b32 v200, v15
  s_cmp_lg_u32 s3, 0
  s_cbranch_scc1 K3_e3_1
  s_mov_b32 s64, s84
  s_mov_b32 s65, s85
  s_mov_b32 s66, 4194304
  s_mov_b32 s67, 0x20000
  s_lshl_b32 s68, s10, 19
  s_lshl_b32 s69, s11, 14
  s_add_u32 s68, s68, s69
  s_add_u32 s69, s68, 8192
  v_lshlrev_b32 v194, 7, v2
  s_branch K3_e3_done
K3_e3_1:
  s_cmp_lg_u32 s3, 1
  s_cbranch_scc1 K3_e3_2
  s_mov_b32 s64, s76
  s_mov_b32 s65, s77
  s_mov_b32 s66, 4194304
  s_mov_b32 s67, 0x20000
  s_lshl_b32 s68, s11, 17
  s_lshl_b32 s69, s10, 8
  s_add_u32 s68, s68, s69
  s_add_u32 s69, s68, 65536
  v_lshrrev_b32 v194, 1, v2
  v_lshlrev_b32 v194, 11, v194
  v_and_b32 v15, 1, v2
  v_lshl_add_u32 v194, v15, 7, v194
  s_branch K3_e3_done
K3_e3_2:
  s_cmp_lg_u32 s3, 2
  s_cbranch_scc1 K3_e3_3
  s_mov_b32 s64, s92
  s_mov_b32 s65, s93
  s_mov_b32 s66, 2097152
  s_mov_b32 s67, 0x20000
  s_lshl_b32 s68, s11, 16
  s_lshr_b32 s69, s10, 2
  s_lshl_b32 s69, s69, 10
  s_add_u32 s68, s68, s69
  s_add_u32 s69, s68, 16384
  v_lshrrev_b32 v194, 3, v2
  v_lshlrev_b32 v194, 11, v194
  v_and_b32 v15, 7, v2
  v_lshl_add_u32 v194, v15, 7, v194
  s_branch K3_e3_done
K3_e3_3:
  s_mov_b32 s64, s92
  s_mov_b32 s65, s93
  s_mov_b32 s66, 2097152
  s_mov_b32 s67, 0x20000
  s_lshl_b32 s68, s11, 16
  s_lshr_b32 s69, s10, 2
  s_lshl_b32 s69, s69, 10
  s_add_u32 s68, s68, s69
  s_add_u32 s68, s68, 32768
  s_add_u32 s69, s68, 16384
  v_lshrrev_b32 v194, 3, v2
  v_lshlrev_b32 v194, 11, v194
  v_and_b32 v15, 7, v2
  v_lshl_add_u32 v194, v15, 7, v194
K3_e3_done:
  v_mov_b32 v15, v200
  s_and_b32 s55, s11, 3
  s_add_u32 s55, s55, 0
  s_and_b32 s52, s11, 3
  s_add_u32 s52, s52, 4
  s_sub_u32 s52, s52, s55
  s_sub_u32 s52, s52, 1
  s_mov_b32 s54, 0
  s_lshr_b32 s70, s11, 2
  s_and_b32 s70, s70, 3
  s_add_u32 s70, s70, 1000
  s_cmp_lt_u32 s3, 2
  s_cselect_b32 s70, 1000, s70
  s_cmp_eq_u32 s3, 3
  s_cselect_b32 s71, 7, 1000
  s_mov_b32 s53, 0
  s_lshl_b32 s38, s36, 6
  v_add_u32 v16, s38, v15
  v_lshrrev_b32 v17, 1, v15
  v_lshlrev_b32 v16, 7, v16
  v_xor_b32 v17, v14, v17
  v_lshl_add_u32 v4, v17, 4, v16
  v_xor_b32 v5, 64, v4
  v_add_u32 v6, 81920, v4
  v_add_u32 v7, 81920, v5
  v_bfe_u32 v17, v2, 2, 2
  v_and_b32 v18, 3, v2
  v_lshlrev_b32 v17, 6, v17
  v_lshl_add_u32 v17, v18, 3, v17
  v_and_b32 v18, 1, v14
  v_lshl_add_u32 v17, v18, 10, v17
  v_lshl_add_u32 v17, v18, 5, v17
  v_lshrrev_b32 v18, 1, v14
  v_mul_u32_u24 v18, 6144, v18
  v_add_u32 v17, v17, v18
  s_lshl_b32 s38, s37, 8
  s_add_u32 s38, s38, 16384
  v_add_u32 v8, s38, v17
  v_xor_b32 v9, 32, v8
  v_add_u32 v10, 81920, v8
  v_add_u32 v11, 81920, v9
  v_mov_b32 v96, 0
  v_mov_b32 v97, 0
  v_mov_b32 v98, 0
  v_mov_b32 v99, 0
  v_mov_b32 v100, 0
  v_mov_b32 v101, 0
  v_mov_b32 v102, 0
  v_mov_b32 v103, 0
  v_mov_b32 v104, 0
  v_mov_b32 v105, 0
  v_mov_b32 v106, 0
  v_mov_b32 v107, 0
  v_mov_b32 v108, 0
  v_mov_b32 v109, 0
  v_mov_b32 v110, 0
  v_mov_b32 v111, 0
  v_mov_b32 v112, 0
  v_mov_b32 v113, 0
  v_mov_b32 v114, 0
  v_mov_b32 v115, 0
  v_mov_b32 v116, 0
  v_mov_b32 v117, 0
  v_mov_b32 v118, 0
  v_mov_b32 v119, 0
  v_mov_b32 v120, 0
  v_mov_b32 v121, 0
  v_mov_b32 v122, 0
  v_mov_b32 v123, 0
  v_mov_b32 v124, 0
  v_mov_b32 v125, 0
  v_mov_b32 v126, 0
  v_mov_b32 v127, 0
  v_mov_b32 v128, 0
  v_mov_b32 v129, 0
  v_mov_b32 v130, 0
  v_mov_b32 v131, 0
  v_mov_b32 v132, 0
  v_mov_b32 v133, 0
  v_mov_b32 v134, 0
  v_mov_b32 v135, 0
  v_mov_b32 v136, 0
  v_mov_b32 v137, 0
  v_mov_b32 v138, 0
  v_mov_b32 v139, 0
  v_mov_b32 v140, 0
  v_mov_b32 v141, 0
  v_mov_b32 v142, 0
  v_mov_b32 v143, 0
  v_mov_b32 v144, 0
  v_mov_b32 v145, 0
  v_mov_b32 v146, 0
  v_mov_b32 v147, 0
  v_mov_b32 v148, 0
  v_mov_b32 v149, 0
  v_mov_b32 v150, 0
  v_mov_b32 v151, 0
  v_mov_b32 v152, 0
  v_mov_b32 v153, 0
  v_mov_b32 v154, 0
  v_mov_b32 v155, 0
  v_mov_b32 v156, 0
  v_mov_b32 v157, 0
  v_mov_b32 v158, 0
  v_mov_b32 v159, 0
  v_mov_b32 v160, 0
  v_mov_b32 v161, 0
  v_mov_b32 v162, 0
  v_mov_b32 v163, 0
  v_mov_b32 v164, 0
  v_mov_b32 v165, 0
  v_mov_b32 v166, 0
  v_mov_b32 v167, 0
  v_mov_b32 v168, 0
  v_mov_b32 v169, 0
  v_mov_b32 v170, 0
  v_mov_b32 v171, 0
  v_mov_b32 v172, 0
  v_mov_b32 v173, 0
  v_mov_b32 v174, 0
  v_mov_b32 v175, 0
  v_mov_b32 v176, 0
  v_mov_b32 v177, 0
  v_mov_b32 v178, 0
  v_mov_b32 v179, 0
  v_mov_b32 v180, 0
  v_mov_b32 v181, 0
  v_mov_b32 v182, 0
  v_mov_b32 v183, 0
  v_mov_b32 v184, 0
  v_mov_b32 v185, 0
  v_mov_b32 v186, 0
  v_mov_b32 v187, 0
  v_mov_b32 v188, 0
  v_mov_b32 v189, 0
  v_mov_b32 v190, 0
  v_mov_b32 v191, 0
  s_waitcnt lgkmcnt(0)
  s_add_u32 s28, s98, 8388608
  s_addc_u32 s29, s99, 0
  s_mov_b32 s30, 2097152
  s_mov_b32 s31, 0x20000
  s_add_u32 s32, s98, 12582912
  s_addc_u32 s33, s99, 0
  s_mov_b32 s34, 65536
  s_mov_b32 s35, 0x20000
  s_barrier
  ds_read_b128 v[16:19], v4 offset:0
  ds_read_b64_tr_b16 v[32:33], v8 offset:0
  ds_read_b64_tr_b16 v[34:35], v8 offset:512
  ds_read_b128 v[20:23], v4 offset:2048
  ds_read_b128 v[24:27], v4 offset:4096
  ds_read_b128 v[28:31], v4 offset:6144
  ds_read_b64_tr_b16 v[36:37], v9 offset:0
  ds_read_b64_tr_b16 v[38:39], v9 offset:512
  ds_read_b64_tr_b16 v[40:41], v8 offset:2048
  ds_read_b64_tr_b16 v[42:43], v8 offset:2560
  ds_read_b64_tr_b16 v[44:45], v9 offset:2048
  ds_read_b64_tr_b16 v[46:47], v9 offset:2560
  ds_read_b64_tr_b16 v[48:49], v8 offset:4096
  ds_read_b64_tr_b16 v[50:51], v8 offset:4608
  ds_read_b64_tr_b16 v[52:53], v9 offset:4096
  ds_read_b64_tr_b16 v[54:55], v9 offset:4608
  s_waitcnt lgkmcnt(0)
  s_mov_b32 s39, 4
K3_loop:
  v_mfma_f32_16x16x32_bf16 v[96:99], v[32:35], v[16:19], v[96:99]
  ds_read_b128 v[56:59], v5 offset:0
  v_mfma_f32_16x16x32_bf16 v[104:107], v[32:35], v[20:23], v[104:107]
  ds_read_b64_tr_b16 v[72:73], v8 offset:12288
  v_mfma_f32_16x16x32_bf16 v[112:115], v[32:35], v[24:27], v[112:115]
  ds_read_b64_tr_b16 v[74:75], v8 offset:12800
  v_mfma_f32_16x16x32_bf16 v[120:123], v[32:35], v[28:31], v[120:123]
  ds_read_b128 v[60:63], v5 offset:2048
  v_mfma_f32_16x16x32_bf16 v[100:103], v[36:39], v[16:19], v[100:103]
  ds_read_b128 v[64:67], v5 offset:4096
  v_mfma_f32_16x16x32_bf16 v[108:111], v[36:39], v[20:23], v[108:111]
  ds_read_b128 v[68:71], v5 offset:6144
  v_mfma_f32_16x16x32_bf16 v[116:119], v[36:39], v[24:27], v[116:119]
  ds_read_b64_tr_b16 v[76:77], v9 offset:12288
  v_mfma_f32_16x16x32_bf16 v[124:127], v[36:39], v[28:31], v[124:127]
  ds_read_b64_tr_b16 v[78:79], v9 offset:12800
  v_mfma_f32_16x16x32_bf16 v[128:131], v[16:19], v[40:43], v[128:131]
  ds_read_b64_tr_b16 v[80:81], v8 offset:14336
  v_mfma_f32_16x16x32_bf16 v[136:139], v[20:23], v[40:43], v[136:139]
  ds_read_b64_tr_b16 v[82:83], v8 offset:14848
  v_mfma_f32_16x16x32_bf16 v[144:147], v[24:27], v[40:43], v[144:147]
  ds_read_b64_tr_b16 v[84:85], v9 offset:14336
  v_mfma_f32_16x16x32_bf16 v[152:155], v[28:31], v[40:43], v[152:155]
  ds_read_b64_tr_b16 v[86:87], v9 offset:14848
  v_mfma_f32_16x16x32_bf16 v[132:135], v[16:19], v[44:47], v[132:135]
  ds_read_b64_tr_b16 v[88:89], v8 offset:16384
  v_mfma_f32_16x16x32_bf16 v[140:143], v[20:23], v[44:47], v[140:143]
  ds_read_b64_tr_b16 v[90:91], v8 offset:16896
  v_mfma_f32_16x16x32_bf16 v[148:151], v[24:27], v[44:47], v[148:151]
  ds_read_b64_tr_b16 v[92:93], v9 offset:16384
  v_mfma_f32_16x16x32_bf16 v[156:159], v[28:31], v[44:47], v[156:159]
  ds_read_b64_tr_b16 v[94:95], v9 offset:16896
  v_mfma_f32_16x16x32_bf16 v[160:163], v[16:19], v[48:51], v[160:163]
  v_mfma_f32_16x16x32_bf16 v[168:171], v[20:23], v[48:51], v[168:171]
  v_mfma_f32_16x16x32_bf16 v[176:179], v[24:27], v[48:51], v[176:179]
  v_mfma_f32_16x16x32_bf16 v[184:187], v[28:31], v[48:51], v[184:187]
  v_mfma_f32_16x16x32_bf16 v[164:167], v[16:19], v[52:55], v[164:167]
  v_mfma_f32_16x16x32_bf16 v[172:175], v[20:23], v[52:55], v[172:175]
  v_mfma_f32_16x16x32_bf16 v[180:183], v[24:27], v[52:55], v[180:183]
  v_mfma_f32_16x16x32_bf16 v[188:191], v[28:31], v[52:55], v[188:191]
  s_waitcnt lgkmcnt(0)
  s_barrier
  s_sub_u32 s55, s55, 1
  s_cbranch_scc1 K3_event0
K3_noev0:
  s_sub_u32 s70, s70, 1
  s_cbranch_scc1 K3_evB0
K3_noevB0:
  s_sub_u32 s71, s71, 1
  s_cbranch_scc1 K3_evC0
K3_noevC0:
  v_mfma_f32_16x16x32_bf16 v[96:99], v[72:75], v[56:59], v[96:99]
  ds_read_b128 v[16:19], v4 offset:40960
  v_mfma_f32_16x16x32_bf16 v[104:107], v[72:75], v[60:63], v[104:107]
  ds_read_b64_tr_b16 v[32:33], v8 offset:40960
  v_mfma_f32_16x16x32_bf16 v[112:115], v[72:75], v[64:67], v[112:115]
  ds_read_b64_tr_b16 v[34:35], v8 offset:41472
  v_mfma_f32_16x16x32_bf16 v[120:123], v[72:75], v[68:71], v[120:123]
  ds_read_b128 v[20:23], v4 offset:43008
  v_mfma_f32_16x16x32_bf16 v[100:103], v[76:79], v[56:59], v[100:103]
  ds_read_b128 v[24:27], v4 offset:45056
  v_mfma_f32_16x16x32_bf16 v[108:111], v[76:79], v[60:63], v[108:111]
  ds_read_b128 v[28:31], v4 offset:47104
  v_mfma_f32_16x16x32_bf16 v[116:119], v[76:79], v[64:67], v[116:119]
  ds_read_b64_tr_b16 v[36:37], v9 offset:40960
  v_mfma_f32_16x16x32_bf16 v[124:127], v[76:79], v[68:71], v[124:127]
  ds_read_b64_tr_b16 v[38:39], v9 offset:41472
  v_mfma_f32_16x16x32_bf16 v[128:131], v[56:59], v[80:83], v[128:131]
  ds_read_b64_tr_b16 v[40:41], v8 offset:43008
  v_mfma_f32_16x16x32_bf16 v[136:139], v[60:63], v[80:83], v[136:139]
  ds_read_b64_tr_b16 v[42:43], v8 offset:43520
  v_mfma_f32_16x16x32_bf16 v[144:147], v[64:67], v[80:83], v[144:147]
  ds_read_b64_tr_b16 v[44:45], v9 offset:43008
  v_mfma_f32_16x16x32_bf16 v[152:155], v[68:71], v[80:83], v[152:155]
  ds_read_b64_tr_b16 v[46:47], v9 offset:43520
  v_mfma_f32_16x16x32_bf16 v[132:135], v[56:59], v[84:87], v[132:135]
  ds_read_b64_tr_b16 v[48:49], v8 offset:45056
  v_mfma_f32_16x16x32_bf16 v[140:143], v[60:63], v[84:87], v[140:143]
  ds_read_b64_tr_b16 v[50:51], v8 offset:45568
  v_mfma_f32_16x16x32_bf16 v[148:151], v[64:67], v[84:87], v[148:151]
  ds_read_b64_tr_b16 v[52:53], v9 offset:45056
  v_mfma_f32_16x16x32_bf16 v[156:159], v[68:71], v[84:87], v[156:159]
  ds_read_b64_tr_b16 v[54:55], v9 offset:45568
  v_mfma_f32_16x16x32_bf16 v[160:163], v[56:59], v[88:91], v[160:163]
  v_mfma_f32_16x16x32_bf16 v[168:171], v[60:63], v[88:91], v[168:171]
  v_mfma_f32_16x16x32_bf16 v[176:179], v[64:67], v[88:91], v[176:179]
  v_mfma_f32_16x16x32_bf16 v[184:187], v[68:71], v[88:91], v[184:187]
  v_mfma_f32_16x16x32_bf16 v[164:167], v[56:59], v[92:95], v[164:167]
  v_mfma_f32_16x16x32_bf16 v[172:175], v[60:63], v[92:95], v[172:175]
  v_mfma_f32_16x16x32_bf16 v[180:183], v[64:67], v[92:95], v[180:183]
  v_mfma_f32_16x16x32_bf16 v[188:191], v[68:71], v[92:95], v[188:191]
  s_waitcnt lgkmcnt(13)
  v_mfma_f32_16x16x32_bf16 v[96:99], v[32:35], v[16:19], v[96:99]
  ds_read_b128 v[56:59], v5 offset:40960
  s_waitcnt lgkmcnt(13)
  v_mfma_f32_16x16x32_bf16 v[104:107], v[32:35], v[20:23], v[104:107]
  ds_read_b64_tr_b16 v[72:73], v8 offset:53248
  s_waitcnt lgkmcnt(13)
  v_mfma_f32_16x16x32_bf16 v[112:115], v[32:35], v[24:27], v[112:115]
  ds_read_b64_tr_b16 v[74:75], v8 offset:53760
  s_waitcnt lgkmcnt(13)
  v_mfma_f32_16x16x32_bf16 v[120:123], v[32:35], v[28:31], v[120:123]
  ds_read_b128 v[60:63], v5 offset:43008
  s_waitcnt lgkmcnt(12)
  v_mfma_f32_16x16x32_bf16 v[100:103], v[36:39], v[16:19], v[100:103]
  ds_read_b128 v[64:67], v5 offset:45056
  v_mfma_f32_16x16x32_bf16 v[108:111], v[36:39], v[20:23], v[108:111]
  ds_read_b128 v[68:71], v5 offset:47104
  v_mfma_f32_16x16x32_bf16 v[116:119], v[36:39], v[24:27], v[116:119]
  ds_read_b64_tr_b16 v[76:77], v9 offset:53248
  v_mfma_f32_16x16x32_bf16 v[124:127], v[36:39], v[28:31], v[124:127]
  ds_read_b64_tr_b16 v[78:79], v9 offset:53760
  s_waitcnt lgkmcnt(14)
  v_mfma_f32_16x16x32_bf16 v[128:131], v[16:19], v[40:43], v[128:131]
  ds_read_b64_tr_b16 v[80:81], v8 offset:55296
  v_mfma_f32_16x16x32_bf16 v[136:139], v[20:23], v[40:43], v[136:139]
  ds_read_b64_tr_b16 v[82:83], v8 offset:55808
  v_mfma_f32_16x16x32_bf16 v[144:147], v[24:27], v[40:43], v[144:147]
  ds_read_b64_tr_b16 v[84:85], v9 offset:55296
  v_mfma_f32_16x16x32_bf16 v[152:155], v[28:31], v[40:43], v[152:155]
  ds_read_b64_tr_b16 v[86:87], v9 offset:55808
  s_waitcnt lgkmcnt(15)
  v_mfma_f32_16x16x32_bf16 v[132:135], v[16:19], v[44:47], v[132:135]
  ds_read_b64_tr_b16 v[88:89], v8 offset:57344
  v_mfma_f32_16x16x32_bf16 v[140:143], v[20:23], v[44:47], v[140:143]
  ds_read_b64_tr_b16 v[90:91], v8 offset:57856
  v_mfma_f32_16x16x32_bf16 v[148:151], v[24:27], v[44:47], v[148:151]
  ds_read_b64_tr_b16 v[92:93], v9 offset:57344
  v_mfma_f32_16x16x32_bf16 v[156:159], v[28:31], v[44:47], v[156:159]
  ds_read_b64_tr_b16 v[94:95], v9 offset:57856
  s_waitcnt lgkmcnt(15)
  v_mfma_f32_16x16x32_bf16 v[160:163], v[16:19], v[48:51], v[160:163]
  v_mfma_f32_16x16x32_bf16 v[168:171], v[20:23], v[48:51], v[168:171]
  v_mfma_f32_16x16x32_bf16 v[176:179], v[24:27], v[48:51], v[176:179]
  v_mfma_f32_16x16x32_bf16 v[184:187], v[28:31], v[48:51], v[184:187]
  v_mfma_f32_16x16x32_bf16 v[164:167], v[16:19], v[52:55], v[164:167]
  v_mfma_f32_16x16x32_bf16 v[172:175], v[20:23], v[52:55], v[172:175]
  v_mfma_f32_16x16x32_bf16 v[180:183], v[24:27], v[52:55], v[180:183]
  v_mfma_f32_16x16x32_bf16 v[188:191], v[28:31], v[52:55], v[188:191]
  s_waitcnt lgkmcnt(0)
  s_barrier
  s_sub_u32 s55, s55, 1
  s_cbranch_scc1 K3_event1
K3_noev1:
  s_sub_u32 s70, s70, 1
  s_cbranch_scc1 K3_evB1
K3_noevB1:
  s_sub_u32 s71, s71, 1
  s_cbranch_scc1 K3_evC1
K3_noevC1:
  v_mfma_f32_16x16x32_bf16 v[96:99], v[72:75], v[56:59], v[96:99]
  ds_read_b128 v[16:19], v6 offset:0
  v_mfma_f32_16x16x32_bf16 v[104:107], v[72:75], v[60:63], v[104:107]
  ds_read_b64_tr_b16 v[32:33], v10 offset:0
  v_mfma_f32_16x16x32_bf16 v[112:115], v[72:75], v[64:67], v[112:115]
  ds_read_b64_tr_b16 v[34:35], v10 offset:512
  v_mfma_f32_16x16x32_bf16 v[120:123], v[72:75], v[68:71], v[120:123]
  ds_read_b128 v[20:23], v6 offset:2048
  v_mfma_f32_16x16x32_bf16 v[100:103], v[76:79], v[56:59], v[100:103]
  ds_read_b128 v[24:27], v6 offset:4096
  v_mfma_f32_16x16x32_bf16 v[108:111], v[76:79], v[60:63], v[108:111]
  ds_read_b128 v[28:31], v6 offset:6144
  v_mfma_f32_16x16x32_bf16 v[116:119], v[76:79], v[64:67], v[116:119]
  ds_read_b64_tr_b16 v[36:37], v11 offset:0
  v_mfma_f32_16x16x32_bf16 v[124:127], v[76:79], v[68:71], v[124:127]
  ds_read_b64_tr_b16 v[38:39], v11 offset:512
  v_mfma_f32_16x16x32_bf16 v[128:131], v[56:59], v[80:83], v[128:131]
  ds_read_b64_tr_b16 v[40:41], v10 offset:2048
  v_mfma_f32_16x16x32_bf16 v[136:139], v[60:63], v[80:83], v[136:139]
  ds_read_b64_tr_b16 v[42:43], v10 offset:2560
  v_mfma_f32_16x16x32_bf16 v[144:147], v[64:67], v[80:83], v[144:147]
  ds_read_b64_tr_b16 v[44:45], v11 offset:2048
  v_mfma_f32_16x16x32_bf16 v[152:155], v[68:71], v[80:83], v[152:155]
  ds_read_b64_tr_b16 v[46:47], v11 offset:2560
  v_mfma_f32_16x16x32_bf16 v[132:135], v[56:59], v[84:87], v[132:135]
  ds_read_b64_tr_b16 v[48:49], v10 offset:4096
  v_mfma_f32_16x16x32_bf16 v[140:143], v[60:63], v[84:87], v[140:143]
  ds_read_b64_tr_b16 v[50:51], v10 offset:4608
  v_mfma_f32_16x16x32_bf16 v[148:151], v[64:67], v[84:87], v[148:151]
  ds_read_b64_tr_b16 v[52:53], v11 offset:4096
  v_mfma_f32_16x16x32_bf16 v[156:159], v[68:71], v[84:87], v[156:159]
  ds_read_b64_tr_b16 v[54:55], v11 offset:4608
  v_mfma_f32_16x16x32_bf16 v[160:163], v[56:59], v[88:91], v[160:163]
  v_mfma_f32_16x16x32_bf16 v[168:171], v[60:63], v[88:91], v[168:171]
  v_mfma_f32_16x16x32_bf16 v[176:179], v[64:67], v[88:91], v[176:179]
  v_mfma_f32_16x16x32_bf16 v[184:187], v[68:71], v[88:91], v[184:187]
  v_mfma_f32_16x16x32_bf16 v[164:167], v[56:59], v[92:95], v[164:167]
  v_mfma_f32_16x16x32_bf16 v[172:175], v[60:63], v[92:95], v[172:175]
  v_mfma_f32_16x16x32_bf16 v[180:183], v[64:67], v[92:95], v[180:183]
  v_mfma_f32_16x16x32_bf16 v[188:191], v[68:71], v[92:95], v[188:191]
  s_waitcnt lgkmcnt(13)
  v_mfma_f32_16x16x32_bf16 v[96:99], v[32:35], v[16:19], v[96:99]
  ds_read_b128 v[56:59], v7 offset:0
  s_waitcnt lgkmcnt(13)
  v_mfma_f32_16x16x32_bf16 v[104:107], v[32:35], v[20:23], v[104:107]
  ds_read_b64_tr_b16 v[72:73], v10 offset:12288
  s_waitcnt lgkmcnt(13)
  v_mfma_f32_16x16x32_bf16 v[112:115], v[32:35], v[24:27], v[112:115]
  ds_read_b64_tr_b16 v[74:75], v10 offset:12800
  s_waitcnt lgkmcnt(13)
  v_mfma_f32_16x16x32_bf16 v[120:123], v[32:35], v[28:31], v[120:123]
  ds_read_b128 v[60:63], v7 offset:2048
  s_waitcnt lgkmcnt(12)
  v_mfma_f32_16x16x32_bf16 v[100:103], v[36:39], v[16:19], v[100:103]
  ds_read_b128 v[64:67], v7 offset:4096
  v_mfma_f32_16x16x32_bf16 v[108:111], v[36:39], v[20:23], v[108:111]
  ds_read_b128 v[68:71], v7 offset:6144
  v_mfma_f32_16x16x32_bf16 v[116:119], v[36:39], v[24:27], v[116:119]
  ds_read_b64_tr_b16 v[76:77], v11 offset:12288
  v_mfma_f32_16x16x32_bf16 v[124:127], v[36:39], v[28:31], v[124:127]
  ds_read_b64_tr_b16 v[78:79], v11 offset:12800
  s_waitcnt lgkmcnt(14)
  v_mfma_f32_16x16x32_bf16 v[128:131], v[16:19], v[40:43], v[128:131]
  ds_read_b64_tr_b16 v[80:81], v10 offset:14336
  v_mfma_f32_16x16x32_bf16 v[136:139], v[20:23], v[40:43], v[136:139]
  ds_read_b64_tr_b16 v[82:83], v10 offset:14848
  v_mfma_f32_16x16x32_bf16 v[144:147], v[24:27], v[40:43], v[144:147]
  ds_read_b64_tr_b16 v[84:85], v11 offset:14336
  v_mfma_f32_16x16x32_bf16 v[152:155], v[28:31], v[40:43], v[152:155]
  ds_read_b64_tr_b16 v[86:87], v11 offset:14848
  s_waitcnt lgkmcnt(15)
  v_mfma_f32_16x16x32_bf16 v[132:135], v[16:19], v[44:47], v[132:135]
  ds_read_b64_tr_b16 v[88:89], v10 offset:16384
  v_mfma_f32_16x16x32_bf16 v[140:143], v[20:23], v[44:47], v[140:143]
  ds_read_b64_tr_b16 v[90:91], v10 offset:16896
  v_mfma_f32_16x16x32_bf16 v[148:151], v[24:27], v[44:47], v[148:151]
  ds_read_b64_tr_b16 v[92:93], v11 offset:16384
  v_mfma_f32_16x16x32_bf16 v[156:159], v[28:31], v[44:47], v[156:159]
  ds_read_b64_tr_b16 v[94:95], v11 offset:16896
  s_waitcnt lgkmcnt(15)
  v_mfma_f32_16x16x32_bf16 v[160:163], v[16:19], v[48:51], v[160:163]
  v_mfma_f32_16x16x32_bf16 v[168:171], v[20:23], v[48:51], v[168:171]
  v_mfma_f32_16x16x32_bf16 v[176:179], v[24:27], v[48:51], v[176:179]
  v_mfma_f32_16x16x32_bf16 v[184:187], v[28:31], v[48:51], v[184:187]
  v_mfma_f32_16x16x32_bf16 v[164:167], v[16:19], v[52:55], v[164:167]
  v_mfma_f32_16x16x32_bf16 v[172:175], v[20:23], v[52:55], v[172:175]
  v_mfma_f32_16x16x32_bf16 v[180:183], v[24:27], v[52:55], v[180:183]
  v_mfma_f32_16x16x32_bf16 v[188:191], v[28:31], v[52:55], v[188:191]
  s_waitcnt lgkmcnt(0)
  s_barrier
  s_sub_u32 s55, s55, 1
  s_cbranch_scc1 K3_event2
K3_noev2:
  s_sub_u32 s70, s70, 1
  s_cbranch_scc1 K3_evB2
K3_noevB2:
  s_sub_u32 s71, s71, 1
  s_cbranch_scc1 K3_evC2
K3_noevC2:
  v_mfma_f32_16x16x32_bf16 v[96:99], v[72:75], v[56:59], v[96:99]
  ds_read_b128 v[16:19], v6 offset:40960
  v_mfma_f32_16x16x32_bf16 v[104:107], v[72:75], v[60:63], v[104:107]
  ds_read_b64_tr_b16 v[32:33], v10 offset:40960
  v_mfma_f32_16x16x32_bf16 v[112:115], v[72:75], v[64:67], v[112:115]
  ds_read_b64_tr_b16 v[34:35], v10 offset:41472
  v_mfma_f32_16x16x32_bf16 v[120:123], v[72:75], v[68:71], v[120:123]
  ds_read_b128 v[20:23], v6 offset:43008
  v_mfma_f32_16x16x32_bf16 v[100:103], v[76:79], v[56:59], v[100:103]
  ds_read_b128 v[24:27], v6 offset:45056
  v_mfma_f32_16x16x32_bf16 v[108:111], v[76:79], v[60:63], v[108:111]
  ds_read_b128 v[28:31], v6 offset:47104
  v_mfma_f32_16x16x32_bf16 v[116:119], v[76:79], v[64:67], v[116:119]
  ds_read_b64_tr_b16 v[36:37], v11 offset:40960
  v_mfma_f32_16x16x32_bf16 v[124:127], v[76:79], v[68:71], v[124:127]
  ds_read_b64_tr_b16 v[38:39], v11 offset:41472
  v_mfma_f32_16x16x32_bf16 v[128:131], v[56:59], v[80:83], v[128:131]
  ds_read_b64_tr_b16 v[40:41], v10 offset:43008
  v_mfma_f32_16x16x32_bf16 v[136:139], v[60:63], v[80:83], v[136:139]
  ds_read_b64_tr_b16 v[42:43], v10 offset:43520
  v_mfma_f32_16x16x32_bf16 v[144:147], v[64:67], v[80:83], v[144:147]
  ds_read_b64_tr_b16 v[44:45], v11 offset:43008
  v_mfma_f32_16x16x32_bf16 v[152:155], v[68:71], v[80:83], v[152:155]
  ds_read_b64_tr_b16 v[46:47], v11 offset:43520
  v_mfma_f32_16x16x32_bf16 v[132:135], v[56:59], v[84:87], v[132:135]
  ds_read_b64_tr_b16 v[48:49], v10 offset:45056
  v_mfma_f32_16x16x32_bf16 v[140:143], v[60:63], v[84:87], v[140:143]
  ds_read_b64_tr_b16 v[50:51], v10 offset:45568
  v_mfma_f32_16x16x32_bf16 v[148:151], v[64:67], v[84:87], v[148:151]
  ds_read_b64_tr_b16 v[52:53], v11 offset:45056
  v_mfma_f32_16x16x32_bf16 v[156:159], v[68:71], v[84:87], v[156:159]
  ds_read_b64_tr_b16 v[54:55], v11 offset:45568
  v_mfma_f32_16x16x32_bf16 v[160:163], v[56:59], v[88:91], v[160:163]
  v_mfma_f32_16x16x32_bf16 v[168:171], v[60:63], v[88:91], v[168:171]
  v_mfma_f32_16x16x32_bf16 v[176:179], v[64:67], v[88:91], v[176:179]
  v_mfma_f32_16x16x32_bf16 v[184:187], v[68:71], v[88:91], v[184:187]
  v_mfma_f32_16x16x32_bf16 v[164:167], v[56:59], v[92:95], v[164:167]
  v_mfma_f32_16x16x32_bf16 v[172:175], v[60:63], v[92:95], v[172:175]
  v_mfma_f32_16x16x32_bf16 v[180:183], v[64:67], v[92:95], v[180:183]
  v_mfma_f32_16x16x32_bf16 v[188:191], v[68:71], v[92:95], v[188:191]
  s_waitcnt lgkmcnt(13)
  v_mfma_f32_16x16x32_bf16 v[96:99], v[32:35], v[16:19], v[96:99]
  ds_read_b128 v[56:59], v7 offset:40960
  s_waitcnt lgkmcnt(13)
  v_mfma_f32_16x16x32_bf16 v[104:107], v[32:35], v[20:23], v[104:107]
  ds_read_b64_tr_b16 v[72:73], v10 offset:53248
  s_waitcnt lgkmcnt(13)
  v_mfma_f32_16x16x32_bf16 v[112:115], v[32:35], v[24:27], v[112:115]
  ds_read_b64_tr_b16 v[74:75], v10 offset:53760
  s_waitcnt lgkmcnt(13)
  v_mfma_f32_16x16x32_bf16 v[120:123], v[32:35], v[28:31], v[120:123]
  ds_read_b128 v[60:63], v7 offset:43008
  s_waitcnt lgkmcnt(12)
  v_mfma_f32_16x16x32_bf16 v[100:103], v[36:39], v[16:19], v[100:103]
  ds_read_b128 v[64:67], v7 offset:45056
  v_mfma_f32_16x16x32_bf16 v[108:111], v[36:39], v[20:23], v[108:111]
  ds_read_b128 v[68:71], v7 offset:47104
  v_mfma_f32_16x16x32_bf16 v[116:119], v[36:39], v[24:27], v[116:119]
  ds_read_b64_tr_b16 v[76:77], v11 offset:53248
  v_mfma_f32_16x16x32_bf16 v[124:127], v[36:39], v[28:31], v[124:127]
  ds_read_b64_tr_b16 v[78:79], v11 offset:53760
  s_waitcnt lgkmcnt(14)
  v_mfma_f32_16x16x32_bf16 v[128:131], v[16:19], v[40:43], v[128:131]
  ds_read_b64_tr_b16 v[80:81], v10 offset:55296
  v_mfma_f32_16x16x32_bf16 v[136:139], v[20:23], v[40:43], v[136:139]
  ds_read_b64_tr_b16 v[82:83], v10 offset:55808
  v_mfma_f32_16x16x32_bf16 v[144:147], v[24:27], v[40:43], v[144:147]
  ds_read_b64_tr_b16 v[84:85], v11 offset:55296
  v_mfma_f32_16x16x32_bf16 v[152:155], v[28:31], v[40:43], v[152:155]
  ds_read_b64_tr_b16 v[86:87], v11 offset:55808
  s_waitcnt lgkmcnt(15)
  v_mfma_f32_16x16x32_bf16 v[132:135], v[16:19], v[44:47], v[132:135]
  ds_read_b64_tr_b16 v[88:89], v10 offset:57344
  v_mfma_f32_16x16x32_bf16 v[140:143], v[20:23], v[44:47], v[140:143]
  ds_read_b64_tr_b16 v[90:91], v10 offset:57856
  v_mfma_f32_16x16x32_bf16 v[148:151], v[24:27], v[44:47], v[148:151]
  ds_read_b64_tr_b16 v[92:93], v11 offset:57344
  v_mfma_f32_16x16x32_bf16 v[156:159], v[28:31], v[44:47], v[156:159]
  ds_read_b64_tr_b16 v[94:95], v11 offset:57856
  s_waitcnt lgkmcnt(15)
  v_mfma_f32_16x16x32_bf16 v[160:163], v[16:19], v[48:51], v[160:163]
  v_mfma_f32_16x16x32_bf16 v[168:171], v[20:23], v[48:51], v[168:171]
  v_mfma_f32_16x16x32_bf16 v[176:179], v[24:27], v[48:51], v[176:179]
  v_mfma_f32_16x16x32_bf16 v[184:187], v[28:31], v[48:51], v[184:187]
  v_mfma_f32_16x16x32_bf16 v[164:167], v[16:19], v[52:55], v[164:167]
  v_mfma_f32_16x16x32_bf16 v[172:175], v[20:23], v[52:55], v[172:175]
  v_mfma_f32_16x16x32_bf16 v[180:183], v[24:27], v[52:55], v[180:183]
  v_mfma_f32_16x16x32_bf16 v[188:191], v[28:31], v[52:55], v[188:191]
  s_waitcnt lgkmcnt(0)
  s_barrier
  s_sub_u32 s55, s55, 1
  s_cbranch_scc1 K3_event3
K3_noev3:
  s_sub_u32 s70, s70, 1
  s_cbranch_scc1 K3_evB3
K3_noevB3:
  s_sub_u32 s71, s71, 1
  s_cbranch_scc1 K3_evC3
K3_noevC3:
  v_mfma_f32_16x16x32_bf16 v[96:99], v[72:75], v[56:59], v[96:99]
  ds_read_b128 v[16:19], v4 offset:0
  v_mfma_f32_16x16x32_bf16 v[104:107], v[72:75], v[60:63], v[104:107]
  ds_read_b64_tr_b16 v[32:33], v8 offset:0
  v_mfma_f32_16x16x32_bf16 v[112:115], v[72:75], v[64:67], v[112:115]
  ds_read_b64_tr_b16 v[34:35], v8 offset:512
  v_mfma_f32_16x16x32_bf16 v[120:123], v[72:75], v[68:71], v[120:123]
  ds_read_b128 v[20:23], v4 offset:2048
  v_mfma_f32_16x16x32_bf16 v[100:103], v[76:79], v[56:59], v[100:103]
  ds_read_b128 v[24:27], v4 offset:4096
  v_mfma_f32_16x16x32_bf16 v[108:111], v[76:79], v[60:63], v[108:111]
  ds_read_b128 v[28:31], v4 offset:6144
  v_mfma_f32_16x16x32_bf16 v[116:119], v[76:79], v[64:67], v[116:119]
  ds_read_b64_tr_b16 v[36:37], v9 offset:0
  v_mfma_f32_16x16x32_bf16 v[124:127], v[76:79], v[68:71], v[124:127]
  ds_read_b64_tr_b16 v[38:39], v9 offset:512
  v_mfma_f32_16x16x32_bf16 v[128:131], v[56:59], v[80:83], v[128:131]
  ds_read_b64_tr_b16 v[40:41], v8 offset:2048
  v_mfma_f32_16x16x32_bf16 v[136:139], v[60:63], v[80:83], v[136:139]
  ds_read_b64_tr_b16 v[42:43], v8 offset:2560
  v_mfma_f32_16x16x32_bf16 v[144:147], v[64:67], v[80:83], v[144:147]
  ds_read_b64_tr_b16 v[44:45], v9 offset:2048
  v_mfma_f32_16x16x32_bf16 v[152:155], v[68:71], v[80:83], v[152:155]
  ds_read_b64_tr_b16 v[46:47], v9 offset:2560
  v_mfma_f32_16x16x32_bf16 v[132:135], v[56:59], v[84:87], v[132:135]
  ds_read_b64_tr_b16 v[48:49], v8 offset:4096
  v_mfma_f32_16x16x32_bf16 v[140:143], v[60:63], v[84:87], v[140:143]
  ds_read_b64_tr_b16 v[50:51], v8 offset:4608
  v_mfma_f32_16x16x32_bf16 v[148:151], v[64:67], v[84:87], v[148:151]
  ds_read_b64_tr_b16 v[52:53], v9 offset:4096
  v_mfma_f32_16x16x32_bf16 v[156:159], v[68:71], v[84:87], v[156:159]
  ds_read_b64_tr_b16 v[54:55], v9 offset:4608
  v_mfma_f32_16x16x32_bf16 v[160:163], v[56:59], v[88:91], v[160:163]
  v_mfma_f32_16x16x32_bf16 v[168:171], v[60:63], v[88:91], v[168:171]
  v_mfma_f32_16x16x32_bf16 v[176:179], v[64:67], v[88:91], v[176:179]
  v_mfma_f32_16x16x32_bf16 v[184:187], v[68:71], v[88:91], v[184:187]
  v_mfma_f32_16x16x32_bf16 v[164:167], v[56:59], v[92:95], v[164:167]
  v_mfma_f32_16x16x32_bf16 v[172:175], v[60:63], v[92:95], v[172:175]
  v_mfma_f32_16x16x32_bf16 v[180:183], v[64:67], v[92:95], v[180:183]
  v_mfma_f32_16x16x32_bf16 v[188:191], v[68:71], v[92:95], v[188:191]
  s_sub_u32 s39, s39, 1
  s_cmp_lg_u32 s39, 0
  s_waitcnt lgkmcnt(0)
  s_cbranch_scc1 K3_loop
  s_mov_b32 s44, 1069066811
  s_mov_b32 s45, 1069066811
  s_mov_b32 s46, 897988541
  s_mov_b32 s47, 897988541
  v_mov_b32 v10, 38912
  v_mov_b32 v11, 1
  v_cvt_pk_bf16_f32 v16, v160, v161
  v_cvt_pk_bf16_f32 v17, v162, v163
  v_cvt_pk_bf16_f32 v18, v168, v169
  v_cvt_pk_bf16_f32 v19, v170, v171
  v_cvt_pk_bf16_f32 v20, v176, v177
  v_cvt_pk_bf16_f32 v21, v178, v179
  v_cvt_pk_bf16_f32 v22, v184, v185
  v_cvt_pk_bf16_f32 v23, v186, v187
  v_cvt_pk_bf16_f32 v24, v164, v165
  v_cvt_pk_bf16_f32 v25, v166, v167
  v_cvt_pk_bf16_f32 v26, v172, v173
  v_cvt_pk_bf16_f32 v27, v174, v175
  v_cvt_pk_bf16_f32 v28, v180, v181
  v_cvt_pk_bf16_f32 v29, v182, v183
  v_cvt_pk_bf16_f32 v30, v188, v189
  v_cvt_pk_bf16_f32 v31, v190, v191
  v_mov_b32 v48, 0x3f803f80
  v_mov_b32 v49, 0x3f803f80
  v_mov_b32 v50, 0x3f803f80
  v_mov_b32 v51, 0x3f803f80
  v_cvt_pk_bf16_f32 v52, v128, v129
  v_cvt_pk_bf16_f32 v53, v130, v131
  v_cvt_pk_bf16_f32 v54, v136, v137
  v_cvt_pk_bf16_f32 v55, v138, v139
  v_lshlrev_b32 v56, 16, v52
  v_and_b32 v57, 0xffff0000, v52
  v_lshlrev_b32 v58, 16, v53
  v_and_b32 v59, 0xffff0000, v53
  v_lshlrev_b32 v60, 16, v54
  v_and_b32 v61, 0xffff0000, v54
  v_lshlrev_b32 v62, 16, v55
  v_and_b32 v63, 0xffff0000, v55
  v_min_f32 v64, 0, v56
  v_min_f32 v65, 0, v57
  v_min_f32 v66, 0, v58
  v_min_f32 v67, 0, v59
  v_min_f32 v68, 0, v60
  v_min_f32 v69, 0, v61
  v_min_f32 v70, 0, v62
  v_min_f32 v71, 0, v63
  v_pk_mul_f32 v[72:73], v[64:65], s[44:45]
  v_pk_mul_f32 v[74:75], v[66:67], s[44:45]
  v_pk_mul_f32 v[76:77], v[68:69], s[44:45]
  v_pk_mul_f32 v[78:79], v[70:71], s[44:45]
  v_exp_f32 v72, v72
  v_exp_f32 v73, v73
  v_exp_f32 v74, v74
  v_exp_f32 v75, v75
  v_exp_f32 v76, v76
  v_exp_f32 v77, v77
  v_exp_f32 v78, v78
  v_exp_f32 v79, v79
  v_pk_add_f32 v[56:57], v[56:57], v[64:65] neg_lo:[0,1] neg_hi:[0,1]
  v_pk_add_f32 v[58:59], v[58:59], v[66:67] neg_lo:[0,1] neg_hi:[0,1]
  v_pk_add_f32 v[60:61], v[60:61], v[68:69] neg_lo:[0,1] neg_hi:[0,1]
  v_pk_add_f32 v[62:63], v[62:63], v[70:71] neg_lo:[0,1] neg_hi:[0,1]
  v_pk_add_f32 v[56:57], v[56:57], v[72:73]
  v_pk_add_f32 v[58:59], v[58:59], v[74:75]
  v_pk_add_f32 v[60:61], v[60:61], v[76:77]
  v_pk_add_f32 v[62:63], v[62:63], v[78:79]
  v_pk_add_f32 v[56:57], v[56:57], s[46:47]
  v_pk_add_f32 v[58:59], v[58:59], s[46:47]
  v_pk_add_f32 v[60:61], v[60:61], s[46:47]
  v_pk_add_f32 v[62:63], v[62:63], s[46:47]
  v_cvt_pk_bf16_f32 v32, v56, v57
  v_cvt_pk_bf16_f32 v33, v58, v59
  v_cvt_pk_bf16_f32 v34, v60, v61
  v_cvt_pk_bf16_f32 v35, v62, v63
  s_nop 1
  v_mfma_f32_16x16x32_bf16 v[160:163], v[32:35], v[16:19], 0
  v_mfma_f32_16x16x32_bf16 v[168:171], v[32:35], v[24:27], 0
  v_mfma_f32_16x16x32_bf16 v[176:179], v[32:35], v[48:51], 0
  v_cvt_pk_bf16_f32 v52, v132, v133
  v_cvt_pk_bf16_f32 v53, v134, v135
  v_cvt_pk_bf16_f32 v54, v140, v141
  v_cvt_pk_bf16_f32 v55, v142, v143
  v_lshlrev_b32 v56, 16, v52
  v_and_b32 v57, 0xffff0000, v52
  v_lshlrev_b32 v58, 16, v53
  v_and_b32 v59, 0xffff0000, v53
  v_lshlrev_b32 v60, 16, v54
  v_and_b32 v61, 0xffff0000, v54
  v_lshlrev_b32 v62, 16, v55
  v_and_b32 v63, 0xffff0000, v55
  v_min_f32 v64, 0, v56
  v_min_f32 v65, 0, v57
  v_min_f32 v66, 0, v58
  v_min_f32 v67, 0, v59
  v_min_f32 v68, 0, v60
  v_min_f32 v69, 0, v61
  v_min_f32 v70, 0, v62
  v_min_f32 v71, 0, v63
  v_pk_mul_f32 v[72:73], v[64:65], s[44:45]
  v_pk_mul_f32 v[74:75], v[66:67], s[44:45]
  v_pk_mul_f32 v[76:77], v[68:69], s[44:45]
  v_pk_mul_f32 v[78:79], v[70:71], s[44:45]
  v_exp_f32 v72, v72
  v_exp_f32 v73, v73
  v_exp_f32 v74, v74
  v_exp_f32 v75, v75
  v_exp_f32 v76, v76
  v_exp_f32 v77, v77
  v_exp_f32 v78, v78
  v_exp_f32 v79, v79
  v_pk_add_f32 v[56:57], v[56:57], v[64:65] neg_lo:[0,1] neg_hi:[0,1]
  v_pk_add_f32 v[58:59], v[58:59], v[66:67] neg_lo:[0,1] neg_hi:[0,1]
  v_pk_add_f32 v[60:61], v[60:61], v[68:69] neg_lo:[0,1] neg_hi:[0,1]
  v_pk_add_f32 v[62:63], v[62:63], v[70:71] neg_lo:[0,1] neg_hi:[0,1]
  v_pk_add_f32 v[56:57], v[56:57], v[72:73]
  v_pk_add_f32 v[58:59], v[58:59], v[74:75]
  v_pk_add_f32 v[60:61], v[60:61], v[76:77]
  v_pk_add_f32 v[62:63], v[62:63], v[78:79]
  v_pk_add_f32 v[56:57], v[56:57], s[46:47]
  v_pk_add_f32 v[58:59], v[58:59], s[46:47]
  v_pk_add_f32 v[60:61], v[60:61], s[46:47]
  v_pk_add_f32 v[62:63], v[62:63], s[46:47]
  v_cvt_pk_bf16_f32 v40, v56, v57
  v_cvt_pk_bf16_f32 v41, v58, v59
  v_cvt_pk_bf16_f32 v42, v60, v61
  v_cvt_pk_bf16_f32 v43, v62, v63
  s_nop 1
  v_mfma_f32_16x16x32_bf16 v[164:167], v[40:43], v[16:19], 0
  v_mfma_f32_16x16x32_bf16 v[172:175], v[40:43], v[24:27], 0
  v_mfma_f32_16x16x32_bf16 v[180:183], v[40:43], v[48:51], 0
  v_cvt_pk_bf16_f32 v52, v144, v145
  v_cvt_pk_bf16_f32 v53, v146, v147
  v_cvt_pk_bf16_f32 v54, v152, v153
  v_cvt_pk_bf16_f32 v55, v154, v155
  v_lshlrev_b32 v56, 16, v52
  v_and_b32 v57, 0xffff0000, v52
  v_lshlrev_b32 v58, 16, v53
  v_and_b32 v59, 0xffff0000, v53
  v_lshlrev_b32 v60, 16, v54
  v_and_b32 v61, 0xffff0000, v54
  v_lshlrev_b32 v62, 16, v55
  v_and_b32 v63, 0xffff0000, v55
  v_min_f32 v64, 0, v56
  v_min_f32 v65, 0, v57
  v_min_f32 v66, 0, v58
  v_min_f32 v67, 0, v59
  v_min_f32 v68, 0, v60
  v_min_f32 v69, 0, v61
  v_min_f32 v70, 0, v62
  v_min_f32 v71, 0, v63
  v_pk_mul_f32 v[72:73], v[64:65], s[44:45]
  v_pk_mul_f32 v[74:75], v[66:67], s[44:45]
  v_pk_mul_f32 v[76:77], v[68:69], s[44:45]
  v_pk_mul_f32 v[78:79], v[70:71], s[44:45]
  v_exp_f32 v72, v72
  v_exp_f32 v73, v73
  v_exp_f32 v74, v74
  v_exp_f32 v75, v75
  v_exp_f32 v76, v76
  v_exp_f32 v77, v77
  v_exp_f32 v78, v78
  v_exp_f32 v79, v79
  v_pk_add_f32 v[56:57], v[56:57], v[64:65] neg_lo:[0,1] neg_hi:[0,1]
  v_pk_add_f32 v[58:59], v[58:59], v[66:67] neg_lo:[0,1] neg_hi:[0,1]
  v_pk_add_f32 v[60:61], v[60:61], v[68:69] neg_lo:[0,1] neg_hi:[0,1]
  v_pk_add_f32 v[62:63], v[62:63], v[70:71] neg_lo:[0,1] neg_hi:[0,1]
  v_pk_add_f32 v[56:57], v[56:57], v[72:73]
  v_pk_add_f32 v[58:59], v[58:59], v[74:75]
  v_pk_add_f32 v[60:61], v[60:61], v[76:77]
  v_pk_add_f32 v[62:63], v[62:63], v[78:79]
  v_pk_add_f32 v[56:57], v[56:57], s[46:47]
  v_pk_add_f32 v[58:59], v[58:59], s[46:47]
  v_pk_add_f32 v[60:61], v[60:61], s[46:47]
  v_pk_add_f32 v[62:63], v[62:63], s[46:47]
  v_cvt_pk_bf16_f32 v36, v56, v57
  v_cvt_pk_bf16_f32 v37, v58, v59
  v_cvt_pk_bf16_f32 v38, v60, v61
  v_cvt_pk_bf16_f32 v39, v62, v63
  s_nop 1
  v_mfma_f32_16x16x32_bf16 v[160:163], v[36:39], v[20:23], v[160:163]
  v_mfma_f32_16x16x32_bf16 v[168:171], v[36:39], v[28:31], v[168:171]
  v_mfma_f32_16x16x32_bf16 v[176:179], v[36:39], v[48:51], v[176:179]
  v_cvt_pk_bf16_f32 v52, v148, v149
  v_cvt_pk_bf16_f32 v53, v150, v151
  v_cvt_pk_bf16_f32 v54, v156, v157
  v_cvt_pk_bf16_f32 v55, v158, v159
  v_lshlrev_b32 v56, 16, v52
  v_and_b32 v57, 0xffff0000, v52
  v_lshlrev_b32 v58, 16, v53
  v_and_b32 v59, 0xffff0000, v53
  v_lshlrev_b32 v60, 16, v54
  v_and_b32 v61, 0xffff0000, v54
  v_lshlrev_b32 v62, 16, v55
  v_and_b32 v63, 0xffff0000, v55
  v_min_f32 v64, 0, v56
  v_min_f32 v65, 0, v57
  v_min_f32 v66, 0, v58
  v_min_f32 v67, 0, v59
  v_min_f32 v68, 0, v60
  v_min_f32 v69, 0, v61
  v_min_f32 v70, 0, v62
  v_min_f32 v71, 0, v63
  v_pk_mul_f32 v[72:73], v[64:65], s[44:45]
  v_pk_mul_f32 v[74:75], v[66:67], s[44:45]
  v_pk_mul_f32 v[76:77], v[68:69], s[44:45]
  v_pk_mul_f32 v[78:79], v[70:71], s[44:45]
  v_exp_f32 v72, v72
  v_exp_f32 v73, v73
  v_exp_f32 v74, v74
  v_exp_f32 v75, v75
  v_exp_f32 v76, v76
  v_exp_f32 v77, v77
  v_exp_f32 v78, v78
  v_exp_f32 v79, v79
  v_pk_add_f32 v[56:57], v[56:57], v[64:65] neg_lo:[0,1] neg_hi:[0,1]
  v_pk_add_f32 v[58:59], v[58:59], v[66:67] neg_lo:[0,1] neg_hi:[0,1]
  v_pk_add_f32 v[60:61], v[60:61], v[68:69] neg_lo:[0,1] neg_hi:[0,1]
  v_pk_add_f32 v[62:63], v[62:63], v[70:71] neg_lo:[0,1] neg_hi:[0,1]
  v_pk_add_f32 v[56:57], v[56:57], v[72:73]
  v_pk_add_f32 v[58:59], v[58:59], v[74:75]
  v_pk_add_f32 v[60:61], v[60:61], v[76:77]
  v_pk_add_f32 v[62:63], v[62:63], v[78:79]
  v_pk_add_f32 v[56:57], v[56:57], s[46:47]
  v_pk_add_f32 v[58:59], v[58:59], s[46:47]
  v_pk_add_f32 v[60:61], v[60:61], s[46:47]
  v_pk_add_f32 v[62:63], v[62:63], s[46:47]
  v_cvt_pk_bf16_f32 v44, v56, v57
  v_cvt_pk_bf16_f32 v45, v58, v59
  v_cvt_pk_bf16_f32 v46, v60, v61
  v_cvt_pk_bf16_f32 v47, v62, v63
  s_nop 1
  v_mfma_f32_16x16x32_bf16 v[164:167], v[44:47], v[20:23], v[164:167]
  v_mfma_f32_16x16x32_bf16 v[172:175], v[44:47], v[28:31], v[172:175]
  v_mfma_f32_16x16x32_bf16 v[180:183], v[44:47], v[48:51], v[180:183]
  s_lshl_b32 s43, s37, 12
  s_add_u32 s43, s43, 155648
  v_add_u32 v4, s43, v3
  s_lshl_b32 s43, s37, 7
  s_add_u32 s43, s43, 39168
  v_lshlrev_b32 v5, 5, v14
  v_add_u32 v5, s43, v5
  s_lshl_b32 s43, s37, 2
  v_add_u32 v6, s43, v10
  s_cmp_eq_u32 s36, 0
  s_cbranch_scc1 K3_wr0
  ds_write_b128 v4, v[160:163] offset:0
  ds_write_b128 v4, v[164:167] offset:1024
  ds_write_b128 v4, v[168:171] offset:2048
  ds_write_b128 v4, v[172:175] offset:3072
  ds_write_b128 v5, v[176:179] offset:0
  ds_write_b128 v5, v[180:183] offset:16
  s_waitcnt lgkmcnt(0)
  s_mov_b64 exec, 1
  ds_add_u32 v6, v11 offset:0
  s_mov_b64 exec, -1
  s_branch K3_q
K3_wr0:
  s_lshl_b32 s48, s5, 4
  s_add_u32 s48, s48, s12
  s_lshl_b32 s49, s48, 12
  s_lshl_b32 s50, s48, 7
  v_lshlrev_b32 v7, 4, v14
  s_mov_b32 s43, 131072
K3_wx:
  ds_read_b32 v8, v6 offset:0
  s_waitcnt lgkmcnt(0)
  v_readfirstlane_b32 s42, v8
  s_sub_u32 s43, s43, 1
  s_cbranch_scc1 K3_wx_ok
  s_cmp_lt_u32 s42, 1
  s_cbranch_scc1 K3_wx
K3_wx_ok:
  ds_read_b128 v[16:19], v4 offset:0
  ds_read_b128 v[20:23], v4 offset:1024
  ds_read_b128 v[24:27], v4 offset:2048
  ds_read_b128 v[28:31], v4 offset:3072
  ds_read_b128 v[32:35], v5 offset:0
  ds_read_b128 v[36:39], v5 offset:16
  s_waitcnt lgkmcnt(5)
  v_pk_add_f32 v[160:161], v[160:161], v[16:17]
  v_pk_add_f32 v[162:163], v[162:163], v[18:19]
  v_cvt_pk_bf16_f32 v40, v160, v161
  v_cvt_pk_bf16_f32 v41, v162, v163
  v_or_b32 v40, 1, v40
  v_or_b32 v41, 1, v41
  s_waitcnt lgkmcnt(4)
  v_pk_add_f32 v[164:165], v[164:165], v[20:21]
  v_pk_add_f32 v[166:167], v[166:167], v[22:23]
  v_cvt_pk_bf16_f32 v42, v164, v165
  v_cvt_pk_bf16_f32 v43, v166, v167
  v_or_b32 v42, 1, v42
  v_or_b32 v43, 1, v43
  buffer_store_dwordx4 v[40:43], v3, s[28:31], s49 offen offset:0 sc1
  s_waitcnt lgkmcnt(3)
  v_pk_add_f32 v[168:169], v[168:169], v[24:25]
  v_pk_add_f32 v[170:171], v[170:171], v[26:27]
  v_cvt_pk_bf16_f32 v44, v168, v169
  v_cvt_pk_bf16_f32 v45, v170, v171
  v_or_b32 v44, 1, v44
  v_or_b32 v45, 1, v45
  s_waitcnt lgkmcnt(2)
  v_pk_add_f32 v[172:173], v[172:173], v[28:29]
  v_pk_add_f32 v[174:175], v[174:175], v[30:31]
  v_cvt_pk_bf16_f32 v46, v172, v173
  v_cvt_pk_bf16_f32 v47, v174, v175
  v_or_b32 v46, 1, v46
  v_or_b32 v47, 1, v47
  buffer_store_dwordx4 v[44:47], v3, s[28:31], s49 offen offset:1024 sc1
  s_waitcnt lgkmcnt(1)
  v_pk_add_f32 v[176:177], v[176:177], v[32:33]
  v_pk_add_f32 v[178:179], v[178:179], v[34:35]
  v_or_b32 v176, 1, v176
  v_or_b32 v177, 1, v177
  v_or_b32 v178, 1, v178
  v_or_b32 v179, 1, v179
  s_waitcnt lgkmcnt(0)
  v_pk_add_f32 v[180:181], v[180:181], v[36:37]
  v_pk_add_f32 v[182:183], v[182:183], v[38:39]
  v_or_b32 v180, 1, v180
  v_or_b32 v181, 1, v181
  v_or_b32 v182, 1, v182
  v_or_b32 v183, 1, v183
  s_mov_b32 exec_lo, 0x00010001
  s_mov_b32 exec_hi, 0x00010001
  buffer_store_dwordx4 v[176:179], v7, s[32:35], s50 offen offset:0 sc1
  buffer_store_dwordx4 v[180:183], v7, s[32:35], s50 offen offset:64 sc1
  s_mov_b64 exec, -1
  s_mov_b64 exec, 1
  ds_add_u32 v10, v11 offset:84
  s_mov_b64 exec, -1
K3_q:
  s_lshl_b32 s43, s3, 12
  s_add_u32 s43, s43, 139264
  v_add_u32 v4, s43, v3
  v_cvt_pk_bf16_f32 v52, v96, v97
  v_cvt_pk_bf16_f32 v53, v98, v99
  v_cvt_pk_bf16_f32 v54, v100, v101
  v_cvt_pk_bf16_f32 v55, v102, v103
  v_lshlrev_b32 v56, 16, v52
  v_and_b32 v57, 0xffff0000, v52
  v_lshlrev_b32 v58, 16, v53
  v_and_b32 v59, 0xffff0000, v53
  v_lshlrev_b32 v60, 16, v54
  v_and_b32 v61, 0xffff0000, v54
  v_lshlrev_b32 v62, 16, v55
  v_and_b32 v63, 0xffff0000, v55
  v_min_f32 v64, 0, v56
  v_min_f32 v65, 0, v57
  v_min_f32 v66, 0, v58
  v_min_f32 v67, 0, v59
  v_min_f32 v68, 0, v60
  v_min_f32 v69, 0, v61
  v_min_f32 v70, 0, v62
  v_min_f32 v71, 0, v63
  v_pk_mul_f32 v[72:73], v[64:65], s[44:45]
  v_pk_mul_f32 v[74:75], v[66:67], s[44:45]
  v_pk_mul_f32 v[76:77], v[68:69], s[44:45]
  v_pk_mul_f32 v[78:79], v[70:71], s[44:45]
  v_exp_f32 v72, v72
  v_exp_f32 v73, v73
  v_exp_f32 v74, v74
  v_exp_f32 v75, v75
  v_exp_f32 v76, v76
  v_exp_f32 v77, v77
  v_exp_f32 v78, v78
  v_exp_f32 v79, v79
  v_pk_add_f32 v[56:57], v[56:57], v[64:65] neg_lo:[0,1] neg_hi:[0,1]
  v_pk_add_f32 v[58:59], v[58:59], v[66:67] neg_lo:[0,1] neg_hi:[0,1]
  v_pk_add_f32 v[60:61], v[60:61], v[68:69] neg_lo:[0,1] neg_hi:[0,1]
  v_pk_add_f32 v[62:63], v[62:63], v[70:71] neg_lo:[0,1] neg_hi:[0,1]
  v_pk_add_f32 v[56:57], v[56:57], v[72:73]
  v_pk_add_f32 v[58:59], v[58:59], v[74:75]
  v_pk_add_f32 v[60:61], v[60:61], v[76:77]
  v_pk_add_f32 v[62:63], v[62:63], v[78:79]
  v_pk_add_f32 v[56:57], v[56:57], s[46:47]
  v_pk_add_f32 v[58:59], v[58:59], s[46:47]
  v_pk_add_f32 v[60:61], v[60:61], s[46:47]
  v_pk_add_f32 v[62:63], v[62:63], s[46:47]
  v_cvt_pk_bf16_f32 v80, v56, v57
  v_cvt_pk_bf16_f32 v81, v58, v59
  v_cvt_pk_bf16_f32 v82, v60, v61
  v_cvt_pk_bf16_f32 v83, v62, v63
  ds_write_b128 v4, v[80:83] offset:0
  v_cvt_pk_bf16_f32 v52, v104, v105
  v_cvt_pk_bf16_f32 v53, v106, v107
  v_cvt_pk_bf16_f32 v54, v108, v109
  v_cvt_pk_bf16_f32 v55, v110, v111
  v_lshlrev_b32 v56, 16, v52
  v_and_b32 v57, 0xffff0000, v52
  v_lshlrev_b32 v58, 16, v53
  v_and_b32 v59, 0xffff0000, v53
  v_lshlrev_b32 v60, 16, v54
  v_and_b32 v61, 0xffff0000, v54
  v_lshlrev_b32 v62, 16, v55
  v_and_b32 v63, 0xffff0000, v55
  v_min_f32 v64, 0, v56
  v_min_f32 v65, 0, v57
  v_min_f32 v66, 0, v58
  v_min_f32 v67, 0, v59
  v_min_f32 v68, 0, v60
  v_min_f32 v69, 0, v61
  v_min_f32 v70, 0, v62
  v_min_f32 v71, 0, v63
  v_pk_mul_f32 v[72:73], v[64:65], s[44:45]
  v_pk_mul_f32 v[74:75], v[66:67], s[44:45]
  v_pk_mul_f32 v[76:77], v[68:69], s[44:45]
  v_pk_mul_f32 v[78:79], v[70:71], s[44:45]
  v_exp_f32 v72, v72
  v_exp_f32 v73, v73
  v_exp_f32 v74, v74
  v_exp_f32 v75, v75
  v_exp_f32 v76, v76
  v_exp_f32 v77, v77
  v_exp_f32 v78, v78
  v_exp_f32 v79, v79
  v_pk_add_f32 v[56:57], v[56:57], v[64:65] neg_lo:[0,1] neg_hi:[0,1]
  v_pk_add_f32 v[58:59], v[58:59], v[66:67] neg_lo:[0,1] neg_hi:[0,1]
  v_pk_add_f32 v[60:61], v[60:61], v[68:69] neg_lo:[0,1] neg_hi:[0,1]
  v_pk_add_f32 v[62:63], v[62:63], v[70:71] neg_lo:[0,1] neg_hi:[0,1]
  v_pk_add_f32 v[56:57], v[56:57], v[72:73]
  v_pk_add_f32 v[58:59], v[58:59], v[74:75]
  v_pk_add_f32 v[60:61], v[60:61], v[76:77]
  v_pk_add_f32 v[62:63], v[62:63], v[78:79]
  v_pk_add_f32 v[56:57], v[56:57], s[46:47]
  v_pk_add_f32 v[58:59], v[58:59], s[46:47]
  v_pk_add_f32 v[60:61], v[60:61], s[46:47]
  v_pk_add_f32 v[62:63], v[62:63], s[46:47]
  v_cvt_pk_bf16_f32 v84, v56, v57
  v_cvt_pk_bf16_f32 v85, v58, v59
  v_cvt_pk_bf16_f32 v86, v60, v61
  v_cvt_pk_bf16_f32 v87, v62, v63
  ds_write_b128 v4, v[84:87] offset:1024
  v_cvt_pk_bf16_f32 v52, v112, v113
  v_cvt_pk_bf16_f32 v53, v114, v115
  v_cvt_pk_bf16_f32 v54, v116, v117
  v_cvt_pk_bf16_f32 v55, v118, v119
  v_lshlrev_b32 v56, 16, v52
  v_and_b32 v57, 0xffff0000, v52
  v_lshlrev_b32 v58, 16, v53
  v_and_b32 v59, 0xffff0000, v53
  v_lshlrev_b32 v60, 16, v54
  v_and_b32 v61, 0xffff0000, v54
  v_lshlrev_b32 v62, 16, v55
  v_and_b32 v63, 0xffff0000, v55
  v_min_f32 v64, 0, v56
  v_min_f32 v65, 0, v57
  v_min_f32 v66, 0, v58
  v_min_f32 v67, 0, v59
  v_min_f32 v68, 0, v60
  v_min_f32 v69, 0, v61
  v_min_f32 v70, 0, v62
  v_min_f32 v71, 0, v63
  v_pk_mul_f32 v[72:73], v[64:65], s[44:45]
  v_pk_mul_f32 v[74:75], v[66:67], s[44:45]
  v_pk_mul_f32 v[76:77], v[68:69], s[44:45]
  v_pk_mul_f32 v[78:79], v[70:71], s[44:45]
  v_exp_f32 v72, v72
  v_exp_f32 v73, v73
  v_exp_f32 v74, v74
  v_exp_f32 v75, v75
  v_exp_f32 v76, v76
  v_exp_f32 v77, v77
  v_exp_f32 v78, v78
  v_exp_f32 v79, v79
  v_pk_add_f32 v[56:57], v[56:57], v[64:65] neg_lo:[0,1] neg_hi:[0,1]
  v_pk_add_f32 v[58:59], v[58:59], v[66:67] neg_lo:[0,1] neg_hi:[0,1]
  v_pk_add_f32 v[60:61], v[60:61], v[68:69] neg_lo:[0,1] neg_hi:[0,1]
  v_pk_add_f32 v[62:63], v[62:63], v[70:71] neg_lo:[0,1] neg_hi:[0,1]
  v_pk_add_f32 v[56:57], v[56:57], v[72:73]
  v_pk_add_f32 v[58:59], v[58:59], v[74:75]
  v_pk_add_f32 v[60:61], v[60:61], v[76:77]
  v_pk_add_f32 v[62:63], v[62:63], v[78:79]
  v_pk_add_f32 v[56:57], v[56:57], s[46:47]
  v_pk_add_f32 v[58:59], v[58:59], s[46:47]
  v_pk_add_f32 v[60:61], v[60:61], s[46:47]
  v_pk_add_f32 v[62:63], v[62:63], s[46:47]
  v_cvt_pk_bf16_f32 v88, v56, v57
  v_cvt_pk_bf16_f32 v89, v58, v59
  v_cvt_pk_bf16_f32 v90, v60, v61
  v_cvt_pk_bf16_f32 v91, v62, v63
  ds_write_b128 v4, v[88:91] offset:2048
  v_cvt_pk_bf16_f32 v52, v120, v121
  v_cvt_pk_bf16_f32 v53, v122, v123
  v_cvt_pk_bf16_f32 v54, v124, v125
  v_cvt_pk_bf16_f32 v55, v126, v127
  v_lshlrev_b32 v56, 16, v52
  v_and_b32 v57, 0xffff0000, v52
  v_lshlrev_b32 v58, 16, v53
  v_and_b32 v59, 0xffff0000, v53
  v_lshlrev_b32 v60, 16, v54
  v_and_b32 v61, 0xffff0000, v54
  v_lshlrev_b32 v62, 16, v55
  v_and_b32 v63, 0xffff0000, v55
  v_min_f32 v64, 0, v56
  v_min_f32 v65, 0, v57
  v_min_f32 v66, 0, v58
  v_min_f32 v67, 0, v59
  v_min_f32 v68, 0, v60
  v_min_f32 v69, 0, v61
  v_min_f32 v70, 0, v62
  v_min_f32 v71, 0, v63
  v_pk_mul_f32 v[72:73], v[64:65], s[44:45]
  v_pk_mul_f32 v[74:75], v[66:67], s[44:45]
  v_pk_mul_f32 v[76:77], v[68:69], s[44:45]
  v_pk_mul_f32 v[78:79], v[70:71], s[44:45]
  v_exp_f32 v72, v72
  v_exp_f32 v73, v73
  v_exp_f32 v74, v74
  v_exp_f32 v75, v75
  v_exp_f32 v76, v76
  v_exp_f32 v77, v77
  v_exp_f32 v78, v78
  v_exp_f32 v79, v79
  v_pk_add_f32 v[56:57], v[56:57], v[64:65] neg_lo:[0,1] neg_hi:[0,1]
  v_pk_add_f32 v[58:59], v[58:59], v[66:67] neg_lo:[0,1] neg_hi:[0,1]
  v_pk_add_f32 v[60:61], v[60:61], v[68:69] neg_lo:[0,1] neg_hi:[0,1]
  v_pk_add_f32 v[62:63], v[62:63], v[70:71] neg_lo:[0,1] neg_hi:[0,1]
  v_pk_add_f32 v[56:57], v[56:57], v[72:73]
  v_pk_add_f32 v[58:59], v[58:59], v[74:75]
  v_pk_add_f32 v[60:61], v[60:61], v[76:77]
  v_pk_add_f32 v[62:63], v[62:63], v[78:79]
  v_pk_add_f32 v[56:57], v[56:57], s[46:47]
  v_pk_add_f32 v[58:59], v[58:59], s[46:47]
  v_pk_add_f32 v[60:61], v[60:61], s[46:47]
  v_pk_add_f32 v[62:63], v[62:63], s[46:47]
  v_cvt_pk_bf16_f32 v92, v56, v57
  v_cvt_pk_bf16_f32 v93, v58, v59
  v_cvt_pk_bf16_f32 v94, v60, v61
  v_cvt_pk_bf16_f32 v95, v62, v63
  ds_write_b128 v4, v[92:95] offset:3072
  s_lshl_b32 s43, s3, 2
  v_add_u32 v9, s43, v10
  v_and_b32 v6, 3, v2
  v_bfe_u32 v7, v2, 2, 2
  v_add_u32 v12, v6, v7
  v_lshlrev_b32 v12, 3, v12
  v_lshl_add_u32 v12, v14, 6, v12
  s_add_u32 s43, s7, 8
  v_add_u32 v12, s43, v12
  v_lshlrev_b32 v13, 5, v6
  v_lshlrev_b32 v7, 3, v7
  v_sub_u32 v13, v13, v7
  v_lshlrev_b32 v7, 6, v14
  v_sub_u32 v13, v13, v7
  s_add_u32 s43, s7, 4376
  v_add_u32 v13, s43, v13
  s_add_u32 s43, s7, 4384
  v_add_u32 v8, s43, v3
  s_waitcnt lgkmcnt(0)
  s_mov_b64 exec, 1
  ds_add_u32 v9, v11 offset:24
  s_mov_b64 exec, -1
  s_mov_b32 s43, 131072
K3_whu:
  ds_read_b32 v16, v9 offset:8
  s_waitcnt lgkmcnt(0)
  v_readfirstlane_b32 s42, v16
  s_sub_u32 s43, s43, 1
  s_cbranch_scc1 K3_whu_ok
  s_cmp_lt_u32 s42, 1
  s_cbranch_scc1 K3_whu
K3_whu_ok:
  ds_read_b64_tr_b16 v[96:97], v13 offset:32
  ds_read_b64_tr_b16 v[98:99], v13 offset:0
  ds_read_b64_tr_b16 v[32:33], v12 offset:0
  ds_read_b64_tr_b16 v[34:35], v12 offset:32
  ds_read_b64_tr_b16 v[100:101], v13 offset:160
  ds_read_b64_tr_b16 v[102:103], v13 offset:128
  ds_read_b64_tr_b16 v[104:105], v13 offset:288
  ds_read_b64_tr_b16 v[106:107], v13 offset:256
  ds_read_b64_tr_b16 v[36:37], v12 offset:256
  ds_read_b64_tr_b16 v[38:39], v12 offset:288
  s_waitcnt lgkmcnt(6)
  v_mfma_f32_16x16x32_bf16 v[16:19], v[96:99], v[32:35], 0
  ds_read_b64_tr_b16 v[108:109], v13 offset:416
  ds_read_b64_tr_b16 v[110:111], v13 offset:384
  s_waitcnt lgkmcnt(6)
  v_mfma_f32_16x16x32_bf16 v[20:23], v[100:103], v[32:35], 0
  ds_read_b64_tr_b16 v[112:113], v13 offset:544
  ds_read_b64_tr_b16 v[114:115], v13 offset:512
  ds_read_b64_tr_b16 v[40:41], v12 offset:512
  ds_read_b64_tr_b16 v[42:43], v12 offset:544
  s_waitcnt lgkmcnt(8)
  v_mfma_f32_16x16x32_bf16 v[24:27], v[104:107], v[32:35], 0
  ds_read_b64_tr_b16 v[116:117], v13 offset:672
  ds_read_b64_tr_b16 v[118:119], v13 offset:640
  v_add_f32_dpp v224, v19, v18 wave_shr:1 row_mask:0xf bank_mask:0xf bound_ctrl:0
  s_nop 1
  v_add_f32_dpp v226, v224, v17 wave_shr:1 row_mask:0xf bank_mask:0xf bound_ctrl:0
  s_waitcnt lgkmcnt(8)
  v_mfma_f32_16x16x32_bf16 v[24:27], v[96:99], v[36:39], v[24:27]
  v_add_f32_dpp v228, v226, v16 wave_shr:1 row_mask:0xf bank_mask:0xf bound_ctrl:0
  s_waitcnt lgkmcnt(6)
  v_mfma_f32_16x16x32_bf16 v[28:31], v[108:111], v[32:35], 0
  ds_read_b64_tr_b16 v[120:121], v13 offset:800
  ds_read_b64_tr_b16 v[122:123], v13 offset:768
  ds_read_b64_tr_b16 v[44:45], v12 offset:768
  ds_read_b64_tr_b16 v[46:47], v12 offset:800
  v_add_f32_dpp v225, v19, v22 wave_ror:1 row_mask:0xf bank_mask:0xf
  v_add_f32_dpp v227, v224, v21 wave_ror:1 row_mask:0xf bank_mask:0xf
  v_add_f32_dpp v229, v226, v20 wave_ror:1 row_mask:0xf bank_mask:0xf
  v_add_f32_dpp v225, v23, v22 wave_shr:1 row_mask:0xf bank_mask:0xf
  v_mfma_f32_16x16x32_bf16 v[28:31], v[100:103], v[36:39], v[28:31]
  s_nop 0
  v_add_f32_dpp v227, v225, v21 wave_shr:1 row_mask:0xf bank_mask:0xf
  s_nop 1
  v_add_f32_dpp v229, v227, v20 wave_shr:1 row_mask:0xf bank_mask:0xf
  v_cvt_pk_bf16_f32 v232, v228, v229
  v_or_b32 v232, 1, v232
  s_waitcnt lgkmcnt(8)
  v_mfma_f32_16x16x32_bf16 v[16:19], v[112:115], v[32:35], 0
  ds_read_b64_tr_b16 v[124:125], v13 offset:928
  ds_read_b64_tr_b16 v[126:127], v13 offset:896
  v_add_f32_dpp v224, v23, v26 wave_ror:1 row_mask:0xf bank_mask:0xf
  v_add_f32_dpp v226, v225, v25 wave_ror:1 row_mask:0xf bank_mask:0xf
  v_mfma_f32_16x16x32_bf16 v[16:19], v[104:107], v[36:39], v[16:19]
  v_add_f32_dpp v228, v227, v24 wave_ror:1 row_mask:0xf bank_mask:0xf
  v_add_f32_dpp v224, v27, v26 wave_shr:1 row_mask:0xf bank_mask:0xf
  s_waitcnt lgkmcnt(8)
  v_mfma_f32_16x16x32_bf16 v[16:19], v[96:99], v[40:43], v[16:19]
  v_add_f32_dpp v226, v224, v25 wave_shr:1 row_mask:0xf bank_mask:0xf
  s_nop 1
  v_add_f32_dpp v228, v226, v24 wave_shr:1 row_mask:0xf bank_mask:0xf
  s_waitcnt lgkmcnt(6)
  v_mfma_f32_16x16x32_bf16 v[20:23], v[116:119], v[32:35], 0
  ds_read_b64_tr_b16 v[128:129], v13 offset:1056
  ds_read_b64_tr_b16 v[130:131], v13 offset:1024
  ds_read_b64_tr_b16 v[48:49], v12 offset:1024
  ds_read_b64_tr_b16 v[50:51], v12 offset:1056
  v_add_f32_dpp v225, v27, v30 wave_ror:1 row_mask:0xf bank_mask:0xf
  v_add_f32_dpp v227, v224, v29 wave_ror:1 row_mask:0xf bank_mask:0xf
  v_add_f32_dpp v229, v226, v28 wave_ror:1 row_mask:0xf bank_mask:0xf
  v_mfma_f32_16x16x32_bf16 v[20:23], v[108:111], v[36:39], v[20:23]
  v_add_f32_dpp v225, v31, v30 wave_shr:1 row_mask:0xf bank_mask:0xf
  s_nop 1
  v_add_f32_dpp v227, v225, v29 wave_shr:1 row_mask:0xf bank_mask:0xf
  s_nop 1
  v_add_f32_dpp v229, v227, v28 wave_shr:1 row_mask:0xf bank_mask:0xf
  v_mfma_f32_16x16x32_bf16 v[20:23], v[100:103], v[40:43], v[20:23]
  v_cvt_pk_bf16_f32 v233, v228, v229
  v_or_b32 v233, 1, v233
  s_waitcnt lgkmcnt(8)
  v_mfma_f32_16x16x32_bf16 v[24:27], v[120:123], v[32:35], 0
  ds_read_b64_tr_b16 v[132:133], v13 offset:1184
  ds_read_b64_tr_b16 v[134:135], v13 offset:1152
  v_add_f32_dpp v224, v31, v18 wave_ror:1 row_mask:0xf bank_mask:0xf
  v_add_f32_dpp v226, v225, v17 wave_ror:1 row_mask:0xf bank_mask:0xf
  v_mfma_f32_16x16x32_bf16 v[24:27], v[112:115], v[36:39], v[24:27]
  v_add_f32_dpp v228, v227, v16 wave_ror:1 row_mask:0xf bank_mask:0xf
  v_add_f32_dpp v224, v19, v18 wave_shr:1 row_mask:0xf bank_mask:0xf
  v_mfma_f32_16x16x32_bf16 v[24:27], v[104:107], v[40:43], v[24:27]
  s_nop 0
  v_add_f32_dpp v226, v224, v17 wave_shr:1 row_mask:0xf bank_mask:0xf
  s_waitcnt lgkmcnt(8)
  v_mfma_f32_16x16x32_bf16 v[24:27], v[96:99], v[44:47], v[24:27]
  v_add_f32_dpp v228, v226, v16 wave_shr:1 row_mask:0xf bank_mask:0xf
  s_waitcnt lgkmcnt(6)
  v_mfma_f32_16x16x32_bf16 v[28:31], v[124:127], v[32:35], 0
  ds_read_b64_tr_b16 v[136:137], v13 offset:1312
  ds_read_b64_tr_b16 v[138:139], v13 offset:1280
  ds_read_b64_tr_b16 v[52:53], v12 offset:1280
  ds_read_b64_tr_b16 v[54:55], v12 offset:1312
  v_add_f32_dpp v225, v19, v22 wave_ror:1 row_mask:0xf bank_mask:0xf
  v_add_f32_dpp v227, v224, v21 wave_ror:1 row_mask:0xf bank_mask:0xf
  v_mfma_f32_16x16x32_bf16 v[28:31], v[116:119], v[36:39], v[28:31]
  v_add_f32_dpp v229, v226, v20 wave_ror:1 row_mask:0xf bank_mask:0xf
  v_add_f32_dpp v225, v23, v22 wave_shr:1 row_mask:0xf bank_mask:0xf
  v_mfma_f32_16x16x32_bf16 v[28:31], v[108:111], v[40:43], v[28:31]
  s_nop 0
  v_add_f32_dpp v227, v225, v21 wave_shr:1 row_mask:0xf bank_mask:0xf
  s_nop 1
  v_add_f32_dpp v229, v227, v20 wave_shr:1 row_mask:0xf bank_mask:0xf
  v_mfma_f32_16x16x32_bf16 v[28:31], v[100:103], v[44:47], v[28:31]
  v_cvt_pk_bf16_f32 v234, v228, v229
  v_or_b32 v234, 1, v234
  s_waitcnt lgkmcnt(8)
  v_mfma_f32_16x16x32_bf16 v[16:19], v[128:131], v[32:35], 0
  ds_read_b64_tr_b16 v[140:141], v13 offset:1440
  ds_read_b64_tr_b16 v[142:143], v13 offset:1408
  v_add_f32_dpp v224, v23, v26 wave_ror:1 row_mask:0xf bank_mask:0xf
  v_add_f32_dpp v226, v225, v25 wave_ror:1 row_mask:0xf bank_mask:0xf
  v_mfma_f32_16x16x32_bf16 v[16:19], v[120:123], v[36:39], v[16:19]
  v_add_f32_dpp v228, v227, v24 wave_ror:1 row_mask:0xf bank_mask:0xf
  v_mfma_f32_16x16x32_bf16 v[16:19], v[112:115], v[40:43], v[16:19]
  v_add_f32_dpp v224, v27, v26 wave_shr:1 row_mask:0xf bank_mask:0xf
  v_mfma_f32_16x16x32_bf16 v[16:19], v[104:107], v[44:47], v[16:19]
  s_nop 0
  v_add_f32_dpp v226, v224, v25 wave_shr:1 row_mask:0xf bank_mask:0xf
  s_waitcnt lgkmcnt(8)
  v_mfma_f32_16x16x32_bf16 v[16:19], v[96:99], v[48:51], v[16:19]
  v_add_f32_dpp v228, v226, v24 wave_shr:1 row_mask:0xf bank_mask:0xf
  s_waitcnt lgkmcnt(6)
  v_mfma_f32_16x16x32_bf16 v[20:23], v[132:135], v[32:35], 0
  ds_read_b64_tr_b16 v[144:145], v13 offset:1568
  ds_read_b64_tr_b16 v[146:147], v13 offset:1536
  ds_read_b64_tr_b16 v[56:57], v12 offset:1536
  ds_read_b64_tr_b16 v[58:59], v12 offset:1568
  v_add_f32_dpp v225, v27, v30 wave_ror:1 row_mask:0xf bank_mask:0xf
  v_add_f32_dpp v227, v224, v29 wave_ror:1 row_mask:0xf bank_mask:0xf
  v_mfma_f32_16x16x32_bf16 v[20:23], v[124:127], v[36:39], v[20:23]
  v_add_f32_dpp v229, v226, v28 wave_ror:1 row_mask:0xf bank_mask:0xf
  v_add_f32_dpp v225, v31, v30 wave_shr:1 row_mask:0xf bank_mask:0xf
  v_mfma_f32_16x16x32_bf16 v[20:23], v[116:119], v[40:43], v[20:23]
  s_nop 0
  v_add_f32_dpp v227, v225, v29 wave_shr:1 row_mask:0xf bank_mask:0xf
  s_nop 1
  v_add_f32_dpp v229, v227, v28 wave_shr:1 row_mask:0xf bank_mask:0xf
  v_mfma_f32_16x16x32_bf16 v[20:23], v[108:111], v[44:47], v[20:23]
  v_cvt_pk_bf16_f32 v235, v228, v229
  v_mfma_f32_16x16x32_bf16 v[20:23], v[100:103], v[48:51], v[20:23]
  v_or_b32 v235, 1, v235
  s_waitcnt lgkmcnt(8)
  v_mfma_f32_16x16x32_bf16 v[24:27], v[136:139], v[32:35], 0
  ds_read_b64_tr_b16 v[148:149], v13 offset:1696
  ds_read_b64_tr_b16 v[150:151], v13 offset:1664
  v_add_f32_dpp v224, v31, v18 wave_ror:1 row_mask:0xf bank_mask:0xf
  v_mfma_f32_16x16x32_bf16 v[24:27], v[128:131], v[36:39], v[24:27]
  v_add_f32_dpp v226, v225, v17 wave_ror:1 row_mask:0xf bank_mask:0xf
  v_mfma_f32_16x16x32_bf16 v[24:27], v[120:123], v[40:43], v[24:27]
  v_add_f32_dpp v228, v227, v16 wave_ror:1 row_mask:0xf bank_mask:0xf
  v_mfma_f32_16x16x32_bf16 v[24:27], v[112:115], v[44:47], v[24:27]
  v_add_f32_dpp v224, v19, v18 wave_shr:1 row_mask:0xf bank_mask:0xf
  v_mfma_f32_16x16x32_bf16 v[24:27], v[104:107], v[48:51], v[24:27]
  s_nop 0
  v_add_f32_dpp v226, v224, v17 wave_shr:1 row_mask:0xf bank_mask:0xf
  s_waitcnt lgkmcnt(8)
  v_mfma_f32_16x16x32_bf16 v[24:27], v[96:99], v[52:55], v[24:27]
  v_add_f32_dpp v228, v226, v16 wave_shr:1 row_mask:0xf bank_mask:0xf
  s_waitcnt lgkmcnt(6)
  v_mfma_f32_16x16x32_bf16 v[28:31], v[140:143], v[32:35], 0
  ds_read_b64_tr_b16 v[152:153], v13 offset:1824
  ds_read_b64_tr_b16 v[154:155], v13 offset:1792
  ds_read_b64_tr_b16 v[60:61], v12 offset:1792
  ds_read_b64_tr_b16 v[62:63], v12 offset:1824
  v_add_f32_dpp v225, v19, v22 wave_ror:1 row_mask:0xf bank_mask:0xf
  v_add_f32_dpp v227, v224, v21 wave_ror:1 row_mask:0xf bank_mask:0xf
  v_mfma_f32_16x16x32_bf16 v[28:31], v[132:135], v[36:39], v[28:31]
  v_add_f32_dpp v229, v226, v20 wave_ror:1 row_mask:0xf bank_mask:0xf
  v_add_f32_dpp v225, v23, v22 wave_shr:1 row_mask:0xf bank_mask:0xf
  v_mfma_f32_16x16x32_bf16 v[28:31], v[124:127], v[40:43], v[28:31]
  s_nop 0
  v_add_f32_dpp v227, v225, v21 wave_shr:1 row_mask:0xf bank_mask:0xf
  v_mfma_f32_16x16x32_bf16 v[28:31], v[116:119], v[44:47], v[28:31]
  s_nop 0
  v_add_f32_dpp v229, v227, v20 wave_shr:1 row_mask:0xf bank_mask:0xf
  v_mfma_f32_16x16x32_bf16 v[28:31], v[108:111], v[48:51], v[28:31]
  v_cvt_pk_bf16_f32 v236, v228, v229
  v_mfma_f32_16x16x32_bf16 v[28:31], v[100:103], v[52:55], v[28:31]
  v_or_b32 v236, 1, v236
  s_waitcnt lgkmcnt(8)
  v_mfma_f32_16x16x32_bf16 v[16:19], v[144:147], v[32:35], 0
  ds_read_b64_tr_b16 v[156:157], v13 offset:1952
  ds_read_b64_tr_b16 v[158:159], v13 offset:1920
  v_add_f32_dpp v224, v23, v26 wave_ror:1 row_mask:0xf bank_mask:0xf
  v_mfma_f32_16x16x32_bf16 v[16:19], v[136:139], v[36:39], v[16:19]
  v_add_f32_dpp v226, v225, v25 wave_ror:1 row_mask:0xf bank_mask:0xf
  v_mfma_f32_16x16x32_bf16 v[16:19], v[128:131], v[40:43], v[16:19]
  v_add_f32_dpp v228, v227, v24 wave_ror:1 row_mask:0xf bank_mask:0xf
  v_mfma_f32_16x16x32_bf16 v[16:19], v[120:123], v[44:47], v[16:19]
  v_add_f32_dpp v224, v27, v26 wave_shr:1 row_mask:0xf bank_mask:0xf
  v_mfma_f32_16x16x32_bf16 v[16:19], v[112:115], v[48:51], v[16:19]
  s_nop 0
  v_add_f32_dpp v226, v224, v25 wave_shr:1 row_mask:0xf bank_mask:0xf
  v_mfma_f32_16x16x32_bf16 v[16:19], v[104:107], v[52:55], v[16:19]
  s_nop 0
  v_add_f32_dpp v228, v226, v24 wave_shr:1 row_mask:0xf bank_mask:0xf
  s_waitcnt lgkmcnt(8)
  v_mfma_f32_16x16x32_bf16 v[16:19], v[96:99], v[56:59], v[16:19]
  s_waitcnt lgkmcnt(6)
  v_mfma_f32_16x16x32_bf16 v[20:23], v[148:151], v[32:35], 0
  ds_read_b64_tr_b16 v[160:161], v13 offset:2080
  ds_read_b64_tr_b16 v[162:163], v13 offset:2048
  ds_read_b64_tr_b16 v[64:65], v12 offset:2048
  ds_read_b64_tr_b16 v[66:67], v12 offset:2080
  v_add_f32_dpp v225, v27, v30 wave_ror:1 row_mask:0xf bank_mask:0xf
  v_add_f32_dpp v227, v224, v29 wave_ror:1 row_mask:0xf bank_mask:0xf
  v_mfma_f32_16x16x32_bf16 v[20:23], v[140:143], v[36:39], v[20:23]
  v_add_f32_dpp v229, v226, v28 wave_ror:1 row_mask:0xf bank_mask:0xf
  v_mfma_f32_16x16x32_bf16 v[20:23], v[132:135], v[40:43], v[20:23]
  v_add_f32_dpp v225, v31, v30 wave_shr:1 row_mask:0xf bank_mask:0xf
  v_mfma_f32_16x16x32_bf16 v[20:23], v[124:127], v[44:47], v[20:23]
  s_nop 0
  v_add_f32_dpp v227, v225, v29 wave_shr:1 row_mask:0xf bank_mask:0xf
  v_mfma_f32_16x16x32_bf16 v[20:23], v[116:119], v[48:51], v[20:23]
  s_nop 0
  v_add_f32_dpp v229, v227, v28 wave_shr:1 row_mask:0xf bank_mask:0xf
  v_mfma_f32_16x16x32_bf16 v[20:23], v[108:111], v[52:55], v[20:23]
  v_cvt_pk_bf16_f32 v237, v228, v229
  v_mfma_f32_16x16x32_bf16 v[20:23], v[100:103], v[56:59], v[20:23]
  v_or_b32 v237, 1, v237
  s_waitcnt lgkmcnt(8)
  v_mfma_f32_16x16x32_bf16 v[24:27], v[152:155], v[32:35], 0
  ds_read_b64_tr_b16 v[164:165], v13 offset:2208
  ds_read_b64_tr_b16 v[166:167], v13 offset:2176
  v_add_f32_dpp v224, v31, v18 wave_ror:1 row_mask:0xf bank_mask:0xf
  v_mfma_f32_16x16x32_bf16 v[24:27], v[144:147], v[36:39], v[24:27]
  v_add_f32_dpp v226, v225, v17 wave_ror:1 row_mask:0xf bank_mask:0xf
  v_mfma_f32_16x16x32_bf16 v[24:27], v[136:139], v[40:43], v[24:27]
  v_add_f32_dpp v228, v227, v16 wave_ror:1 row_mask:0xf bank_mask:0xf
  v_mfma_f32_16x16x32_bf16 v[24:27], v[128:131], v[44:47], v[24:27]
  v_add_f32_dpp v224, v19, v18 wave_shr:1 row_mask:0xf bank_mask:0xf
  v_mfma_f32_16x16x32_bf16 v[24:27], v[120:123], v[48:51], v[24:27]
  s_nop 0
  v_add_f32_dpp v226, v224, v17 wave_shr:1 row_mask:0xf bank_mask:0xf
  v_mfma_f32_16x16x32_bf16 v[24:27], v[112:115], v[52:55], v[24:27]
  s_nop 0
  v_add_f32_dpp v228, v226, v16 wave_shr:1 row_mask:0xf bank_mask:0xf
  v_mfma_f32_16x16x32_bf16 v[24:27], v[104:107], v[56:59], v[24:27]
  s_waitcnt lgkmcnt(8)
  v_mfma_f32_16x16x32_bf16 v[24:27], v[96:99], v[60:63], v[24:27]
  s_waitcnt lgkmcnt(6)
  v_mfma_f32_16x16x32_bf16 v[28:31], v[156:159], v[32:35], 0
  ds_read_b64_tr_b16 v[168:169], v13 offset:2336
  ds_read_b64_tr_b16 v[170:171], v13 offset:2304
  ds_read_b64_tr_b16 v[68:69], v12 offset:2304
  ds_read_b64_tr_b16 v[70:71], v12 offset:2336
  v_add_f32_dpp v225, v19, v22 wave_ror:1 row_mask:0xf bank_mask:0xf
  v_mfma_f32_16x16x32_bf16 v[28:31], v[148:151], v[36:39], v[28:31]
  v_add_f32_dpp v227, v224, v21 wave_ror:1 row_mask:0xf bank_mask:0xf
  v_mfma_f32_16x16x32_bf16 v[28:31], v[140:143], v[40:43], v[28:31]
  v_add_f32_dpp v229, v226, v20 wave_ror:1 row_mask:0xf bank_mask:0xf
  v_mfma_f32_16x16x32_bf16 v[28:31], v[132:135], v[44:47], v[28:31]
  v_add_f32_dpp v225, v23, v22 wave_shr:1 row_mask:0xf bank_mask:0xf
  v_mfma_f32_16x16x32_bf16 v[28:31], v[124:127], v[48:51], v[28:31]
  s_nop 0
  v_add_f32_dpp v227, v225, v21 wave_shr:1 row_mask:0xf bank_mask:0xf
  v_mfma_f32_16x16x32_bf16 v[28:31], v[116:119], v[52:55], v[28:31]
  s_nop 0
  v_add_f32_dpp v229, v227, v20 wave_shr:1 row_mask:0xf bank_mask:0xf
  v_mfma_f32_16x16x32_bf16 v[28:31], v[108:111], v[56:59], v[28:31]
  v_cvt_pk_bf16_f32 v238, v228, v229
  v_mfma_f32_16x16x32_bf16 v[28:31], v[100:103], v[60:63], v[28:31]
  v_or_b32 v238, 1, v238
  s_waitcnt lgkmcnt(8)
  v_mfma_f32_16x16x32_bf16 v[16:19], v[160:163], v[32:35], 0
  ds_read_b64_tr_b16 v[172:173], v13 offset:2464
  ds_read_b64_tr_b16 v[174:175], v13 offset:2432
  v_add_f32_dpp v224, v23, v26 wave_ror:1 row_mask:0xf bank_mask:0xf
  v_mfma_f32_16x16x32_bf16 v[16:19], v[152:155], v[36:39], v[16:19]
  v_add_f32_dpp v226, v225, v25 wave_ror:1 row_mask:0xf bank_mask:0xf
  v_mfma_f32_16x16x32_bf16 v[16:19], v[144:147], v[40:43], v[16:19]
  v_add_f32_dpp v228, v227, v24 wave_ror:1 row_mask:0xf bank_mask:0xf
  v_mfma_f32_16x16x32_bf16 v[16:19], v[136:139], v[44:47], v[16:19]
  v_add_f32_dpp v224, v27, v26 wave_shr:1 row_mask:0xf bank_mask:0xf
  v_mfma_f32_16x16x32_bf16 v[16:19], v[128:131], v[48:51], v[16:19]
  s_nop 0
  v_add_f32_dpp v226, v224, v25 wave_shr:1 row_mask:0xf bank_mask:0xf
  v_mfma_f32_16x16x32_bf16 v[16:19], v[120:123], v[52:55], v[16:19]
  s_nop 0
  v_add_f32_dpp v228, v226, v24 wave_shr:1 row_mask:0xf bank_mask:0xf
  v_mfma_f32_16x16x32_bf16 v[16:19], v[112:115], v[56:59], v[16:19]
  v_mfma_f32_16x16x32_bf16 v[16:19], v[104:107], v[60:63], v[16:19]
  s_waitcnt lgkmcnt(8)
  v_mfma_f32_16x16x32_bf16 v[16:19], v[96:99], v[64:67], v[16:19]
  s_waitcnt lgkmcnt(6)
  v_mfma_f32_16x16x32_bf16 v[20:23], v[164:167], v[32:35], 0
  ds_read_b64_tr_b16 v[176:177], v13 offset:2592
  ds_read_b64_tr_b16 v[178:179], v13 offset:2560
  ds_read_b64_tr_b16 v[72:73], v12 offset:2560
  ds_read_b64_tr_b16 v[74:75], v12 offset:2592
  v_add_f32_dpp v225, v27, v30 wave_ror:1 row_mask:0xf bank_mask:0xf
  v_mfma_f32_16x16x32_bf16 v[20:23], v[156:159], v[36:39], v[20:23]
  v_add_f32_dpp v227, v224, v29 wave_ror:1 row_mask:0xf bank_mask:0xf
  v_mfma_f32_16x16x32_bf16 v[20:23], v[148:151], v[40:43], v[20:23]
  v_add_f32_dpp v229, v226, v28 wave_ror:1 row_mask:0xf bank_mask:0xf
  v_mfma_f32_16x16x32_bf16 v[20:23], v[140:143], v[44:47], v[20:23]
  v_add_f32_dpp v225, v31, v30 wave_shr:1 row_mask:0xf bank_mask:0xf
  v_mfma_f32_16x16x32_bf16 v[20:23], v[132:135], v[48:51], v[20:23]
  s_nop 0
  v_add_f32_dpp v227, v225, v29 wave_shr:1 row_mask:0xf bank_mask:0xf
  v_mfma_f32_16x16x32_bf16 v[20:23], v[124:127], v[52:55], v[20:23]
  s_nop 0
  v_add_f32_dpp v229, v227, v28 wave_shr:1 row_mask:0xf bank_mask:0xf
  v_mfma_f32_16x16x32_bf16 v[20:23], v[116:119], v[56:59], v[20:23]
  v_cvt_pk_bf16_f32 v239, v228, v229
  v_mfma_f32_16x16x32_bf16 v[20:23], v[108:111], v[60:63], v[20:23]
  v_or_b32 v239, 1, v239
  v_mfma_f32_16x16x32_bf16 v[20:23], v[100:103], v[64:67], v[20:23]
  s_waitcnt lgkmcnt(8)
  v_mfma_f32_16x16x32_bf16 v[24:27], v[168:171], v[32:35], 0
  ds_read_b64_tr_b16 v[180:181], v13 offset:2720
  ds_read_b64_tr_b16 v[182:183], v13 offset:2688
  v_add_f32_dpp v224, v31, v18 wave_ror:1 row_mask:0xf bank_mask:0xf
  v_mfma_f32_16x16x32_bf16 v[24:27], v[160:163], v[36:39], v[24:27]
  v_add_f32_dpp v226, v225, v17 wave_ror:1 row_mask:0xf bank_mask:0xf
  v_mfma_f32_16x16x32_bf16 v[24:27], v[152:155], v[40:43], v[24:27]
  v_add_f32_dpp v228, v227, v16 wave_ror:1 row_mask:0xf bank_mask:0xf
  v_mfma_f32_16x16x32_bf16 v[24:27], v[144:147], v[44:47], v[24:27]
  v_add_f32_dpp v224, v19, v18 wave_shr:1 row_mask:0xf bank_mask:0xf
  v_mfma_f32_16x16x32_bf16 v[24:27], v[136:139], v[48:51], v[24:27]
  s_nop 0
  v_add_f32_dpp v226, v224, v17 wave_shr:1 row_mask:0xf bank_mask:0xf
  v_mfma_f32_16x16x32_bf16 v[24:27], v[128:131], v[52:55], v[24:27]
  s_nop 0
  v_add_f32_dpp v228, v226, v16 wave_shr:1 row_mask:0xf bank_mask:0xf
  v_mfma_f32_16x16x32_bf16 v[24:27], v[120:123], v[56:59], v[24:27]
  v_mfma_f32_16x16x32_bf16 v[24:27], v[112:115], v[60:63], v[24:27]
  v_mfma_f32_16x16x32_bf16 v[24:27], v[104:107], v[64:67], v[24:27]
  s_waitcnt lgkmcnt(8)
  v_mfma_f32_16x16x32_bf16 v[24:27], v[96:99], v[68:71], v[24:27]
  s_waitcnt lgkmcnt(6)
  v_mfma_f32_16x16x32_bf16 v[28:31], v[172:175], v[32:35], 0
  ds_read_b64_tr_b16 v[184:185], v13 offset:2848
  ds_read_b64_tr_b16 v[186:187], v13 offset:2816
  ds_read_b64_tr_b16 v[76:77], v12 offset:2816
  ds_read_b64_tr_b16 v[78:79], v12 offset:2848
  v_add_f32_dpp v225, v19, v22 wave_ror:1 row_mask:0xf bank_mask:0xf
  v_mfma_f32_16x16x32_bf16 v[28:31], v[164:167], v[36:39], v[28:31]
  v_add_f32_dpp v227, v224, v21 wave_ror:1 row_mask:0xf bank_mask:0xf
  v_mfma_f32_16x16x32_bf16 v[28:31], v[156:159], v[40:43], v[28:31]
  v_add_f32_dpp v229, v226, v20 wave_ror:1 row_mask:0xf bank_mask:0xf
  v_mfma_f32_16x16x32_bf16 v[28:31], v[148:151], v[44:47], v[28:31]
  v_add_f32_dpp v225, v23, v22 wave_shr:1 row_mask:0xf bank_mask:0xf
  v_mfma_f32_16x16x32_bf16 v[28:31], v[140:143], v[48:51], v[28:31]
  s_nop 0
  v_add_f32_dpp v227, v225, v21 wave_shr:1 row_mask:0xf bank_mask:0xf
  v_mfma_f32_16x16x32_bf16 v[28:31], v[132:135], v[52:55], v[28:31]
  s_nop 0
  v_add_f32_dpp v229, v227, v20 wave_shr:1 row_mask:0xf bank_mask:0xf
  v_mfma_f32_16x16x32_bf16 v[28:31], v[124:127], v[56:59], v[28:31]
  v_cvt_pk_bf16_f32 v240, v228, v229
  v_mfma_f32_16x16x32_bf16 v[28:31], v[116:119], v[60:63], v[28:31]
  v_or_b32 v240, 1, v240
  v_mfma_f32_16x16x32_bf16 v[28:31], v[108:111], v[64:67], v[28:31]
  v_mfma_f32_16x16x32_bf16 v[28:31], v[100:103], v[68:71], v[28:31]
  s_waitcnt lgkmcnt(8)
  v_mfma_f32_16x16x32_bf16 v[16:19], v[176:179], v[32:35], 0
  ds_read_b64_tr_b16 v[188:189], v13 offset:2976
  ds_read_b64_tr_b16 v[190:191], v13 offset:2944
  v_add_f32_dpp v224, v23, v26 wave_ror:1 row_mask:0xf bank_mask:0xf
  v_mfma_f32_16x16x32_bf16 v[16:19], v[168:171], v[36:39], v[16:19]
  v_add_f32_dpp v226, v225, v25 wave_ror:1 row_mask:0xf bank_mask:0xf
  v_mfma_f32_16x16x32_bf16 v[16:19], v[160:163], v[40:43], v[16:19]
  v_add_f32_dpp v228, v227, v24 wave_ror:1 row_mask:0xf bank_mask:0xf
  v_mfma_f32_16x16x32_bf16 v[16:19], v[152:155], v[44:47], v[16:19]
  v_add_f32_dpp v224, v27, v26 wave_shr:1 row_mask:0xf bank_mask:0xf
  v_mfma_f32_16x16x32_bf16 v[16:19], v[144:147], v[48:51], v[16:19]
  s_nop 0
  v_add_f32_dpp v226, v224, v25 wave_shr:1 row_mask:0xf bank_mask:0xf
  v_mfma_f32_16x16x32_bf16 v[16:19], v[136:139], v[52:55], v[16:19]
  s_nop 0
  v_add_f32_dpp v228, v226, v24 wave_shr:1 row_mask:0xf bank_mask:0xf
  v_mfma_f32_16x16x32_bf16 v[16:19], v[128:131], v[56:59], v[16:19]
  v_mfma_f32_16x16x32_bf16 v[16:19], v[120:123], v[60:63], v[16:19]
  v_mfma_f32_16x16x32_bf16 v[16:19], v[112:115], v[64:67], v[16:19]
  v_mfma_f32_16x16x32_bf16 v[16:19], v[104:107], v[68:71], v[16:19]
  s_waitcnt lgkmcnt(8)
  v_mfma_f32_16x16x32_bf16 v[16:19], v[96:99], v[72:75], v[16:19]
  s_waitcnt lgkmcnt(6)
  v_mfma_f32_16x16x32_bf16 v[20:23], v[180:183], v[32:35], 0
  ds_read_b64_tr_b16 v[192:193], v13 offset:3104
  ds_read_b64_tr_b16 v[194:195], v13 offset:3072
  ds_read_b64_tr_b16 v[80:81], v12 offset:3072
  ds_read_b64_tr_b16 v[82:83], v12 offset:3104
  v_add_f32_dpp v225, v27, v30 wave_ror:1 row_mask:0xf bank_mask:0xf
  v_mfma_f32_16x16x32_bf16 v[20:23], v[172:175], v[36:39], v[20:23]
  v_add_f32_dpp v227, v224, v29 wave_ror:1 row_mask:0xf bank_mask:0xf
  v_mfma_f32_16x16x32_bf16 v[20:23], v[164:167], v[40:43], v[20:23]
  v_add_f32_dpp v229, v226, v28 wave_ror:1 row_mask:0xf bank_mask:0xf
  v_mfma_f32_16x16x32_bf16 v[20:23], v[156:159], v[44:47], v[20:23]
  v_add_f32_dpp v225, v31, v30 wave_shr:1 row_mask:0xf bank_mask:0xf
  v_mfma_f32_16x16x32_bf16 v[20:23], v[148:151], v[48:51], v[20:23]
  s_nop 0
  v_add_f32_dpp v227, v225, v29 wave_shr:1 row_mask:0xf bank_mask:0xf
  v_mfma_f32_16x16x32_bf16 v[20:23], v[140:143], v[52:55], v[20:23]
  s_nop 0
  v_add_f32_dpp v229, v227, v28 wave_shr:1 row_mask:0xf bank_mask:0xf
  v_mfma_f32_16x16x32_bf16 v[20:23], v[132:135], v[56:59], v[20:23]
  v_cvt_pk_bf16_f32 v241, v228, v229
  v_mfma_f32_16x16x32_bf16 v[20:23], v[124:127], v[60:63], v[20:23]
  v_or_b32 v241, 1, v241
  v_mfma_f32_16x16x32_bf16 v[20:23], v[116:119], v[64:67], v[20:23]
  v_mfma_f32_16x16x32_bf16 v[20:23], v[108:111], v[68:71], v[20:23]
  v_mfma_f32_16x16x32_bf16 v[20:23], v[100:103], v[72:75], v[20:23]
  s_waitcnt lgkmcnt(8)
  v_mfma_f32_16x16x32_bf16 v[24:27], v[184:187], v[32:35], 0
  ds_read_b64_tr_b16 v[196:197], v13 offset:3232
  ds_read_b64_tr_b16 v[198:199], v13 offset:3200
  v_add_f32_dpp v224, v31, v18 wave_ror:1 row_mask:0xf bank_mask:0xf
  v_mfma_f32_16x16x32_bf16 v[24:27], v[176:179], v[36:39], v[24:27]
  v_add_f32_dpp v226, v225, v17 wave_ror:1 row_mask:0xf bank_mask:0xf
  v_mfma_f32_16x16x32_bf16 v[24:27], v[168:171], v[40:43], v[24:27]
  v_add_f32_dpp v228, v227, v16 wave_ror:1 row_mask:0xf bank_mask:0xf
  v_mfma_f32_16x16x32_bf16 v[24:27], v[160:163], v[44:47], v[24:27]
  v_add_f32_dpp v224, v19, v18 wave_shr:1 row_mask:0xf bank_mask:0xf
  v_mfma_f32_16x16x32_bf16 v[24:27], v[152:155], v[48:51], v[24:27]
  s_nop 0
  v_add_f32_dpp v226, v224, v17 wave_shr:1 row_mask:0xf bank_mask:0xf
  v_mfma_f32_16x16x32_bf16 v[24:27], v[144:147], v[52:55], v[24:27]
  s_nop 0
  v_add_f32_dpp v228, v226, v16 wave_shr:1 row_mask:0xf bank_mask:0xf
  v_mfma_f32_16x16x32_bf16 v[24:27], v[136:139], v[56:59], v[24:27]
  v_mfma_f32_16x16x32_bf16 v[24:27], v[128:131], v[60:63], v[24:27]
  v_mfma_f32_16x16x32_bf16 v[24:27], v[120:123], v[64:67], v[24:27]
  v_mfma_f32_16x16x32_bf16 v[24:27], v[112:115], v[68:71], v[24:27]
  v_mfma_f32_16x16x32_bf16 v[24:27], v[104:107], v[72:75], v[24:27]
  s_waitcnt lgkmcnt(8)
  v_mfma_f32_16x16x32_bf16 v[24:27], v[96:99], v[76:79], v[24:27]
  s_waitcnt lgkmcnt(6)
  v_mfma_f32_16x16x32_bf16 v[28:31], v[188:191], v[32:35], 0
  ds_read_b64_tr_b16 v[200:201], v13 offset:3360
  ds_read_b64_tr_b16 v[202:203], v13 offset:3328
  ds_read_b64_tr_b16 v[84:85], v12 offset:3328
  ds_read_b64_tr_b16 v[86:87], v12 offset:3360
  v_add_f32_dpp v225, v19, v22 wave_ror:1 row_mask:0xf bank_mask:0xf
  v_mfma_f32_16x16x32_bf16 v[28:31], v[180:183], v[36:39], v[28:31]
  v_add_f32_dpp v227, v224, v21 wave_ror:1 row_mask:0xf bank_mask:0xf
  v_mfma_f32_16x16x32_bf16 v[28:31], v[172:175], v[40:43], v[28:31]
  v_add_f32_dpp v229, v226, v20 wave_ror:1 row_mask:0xf bank_mask:0xf
  v_mfma_f32_16x16x32_bf16 v[28:31], v[164:167], v[44:47], v[28:31]
  v_add_f32_dpp v225, v23, v22 wave_shr:1 row_mask:0xf bank_mask:0xf
  v_mfma_f32_16x16x32_bf16 v[28:31], v[156:159], v[48:51], v[28:31]
  s_nop 0
  v_add_f32_dpp v227, v225, v21 wave_shr:1 row_mask:0xf bank_mask:0xf
  v_mfma_f32_16x16x32_bf16 v[28:31], v[148:151], v[52:55], v[28:31]
  s_nop 0
  v_add_f32_dpp v229, v227, v20 wave_shr:1 row_mask:0xf bank_mask:0xf
  v_mfma_f32_16x16x32_bf16 v[28:31], v[140:143], v[56:59], v[28:31]
  v_cvt_pk_bf16_f32 v242, v228, v229
  v_mfma_f32_16x16x32_bf16 v[28:31], v[132:135], v[60:63], v[28:31]
  v_or_b32 v242, 1, v242
  v_mfma_f32_16x16x32_bf16 v[28:31], v[124:127], v[64:67], v[28:31]
  v_mfma_f32_16x16x32_bf16 v[28:31], v[116:119], v[68:71], v[28:31]
  v_mfma_f32_16x16x32_bf16 v[28:31], v[108:111], v[72:75], v[28:31]
  v_mfma_f32_16x16x32_bf16 v[28:31], v[100:103], v[76:79], v[28:31]
  s_waitcnt lgkmcnt(8)
  v_mfma_f32_16x16x32_bf16 v[16:19], v[192:195], v[32:35], 0
  ds_read_b64_tr_b16 v[204:205], v13 offset:3488
  ds_read_b64_tr_b16 v[206:207], v13 offset:3456
  v_add_f32_dpp v224, v23, v26 wave_ror:1 row_mask:0xf bank_mask:0xf
  v_mfma_f32_16x16x32_bf16 v[16:19], v[184:187], v[36:39], v[16:19]
  v_add_f32_dpp v226, v225, v25 wave_ror:1 row_mask:0xf bank_mask:0xf
  v_mfma_f32_16x16x32_bf16 v[16:19], v[176:179], v[40:43], v[16:19]
  v_add_f32_dpp v228, v227, v24 wave_ror:1 row_mask:0xf bank_mask:0xf
  v_mfma_f32_16x16x32_bf16 v[16:19], v[168:171], v[44:47], v[16:19]
  v_add_f32_dpp v224, v27, v26 wave_shr:1 row_mask:0xf bank_mask:0xf
  v_mfma_f32_16x16x32_bf16 v[16:19], v[160:163], v[48:51], v[16:19]
  s_nop 0
  v_add_f32_dpp v226, v224, v25 wave_shr:1 row_mask:0xf bank_mask:0xf
  v_mfma_f32_16x16x32_bf16 v[16:19], v[152:155], v[52:55], v[16:19]
  s_nop 0
  v_add_f32_dpp v228, v226, v24 wave_shr:1 row_mask:0xf bank_mask:0xf
  v_mfma_f32_16x16x32_bf16 v[16:19], v[144:147], v[56:59], v[16:19]
  v_mfma_f32_16x16x32_bf16 v[16:19], v[136:139], v[60:63], v[16:19]
  v_mfma_f32_16x16x32_bf16 v[16:19], v[128:131], v[64:67], v[16:19]
  v_mfma_f32_16x16x32_bf16 v[16:19], v[120:123], v[68:71], v[16:19]
  v_mfma_f32_16x16x32_bf16 v[16:19], v[112:115], v[72:75], v[16:19]
  v_mfma_f32_16x16x32_bf16 v[16:19], v[104:107], v[76:79], v[16:19]
  s_waitcnt lgkmcnt(8)
  v_mfma_f32_16x16x32_bf16 v[16:19], v[96:99], v[80:83], v[16:19]
  s_waitcnt lgkmcnt(6)
  v_mfma_f32_16x16x32_bf16 v[20:23], v[196:199], v[32:35], 0
  ds_read_b64_tr_b16 v[208:209], v13 offset:3616
  ds_read_b64_tr_b16 v[210:211], v13 offset:3584
  ds_read_b64_tr_b16 v[88:89], v12 offset:3584
  ds_read_b64_tr_b16 v[90:91], v12 offset:3616
  v_add_f32_dpp v225, v27, v30 wave_ror:1 row_mask:0xf bank_mask:0xf
  v_mfma_f32_16x16x32_bf16 v[20:23], v[188:191], v[36:39], v[20:23]
  v_add_f32_dpp v227, v224, v29 wave_ror:1 row_mask:0xf bank_mask:0xf
  v_mfma_f32_16x16x32_bf16 v[20:23], v[180:183], v[40:43], v[20:23]
  v_add_f32_dpp v229, v226, v28 wave_ror:1 row_mask:0xf bank_mask:0xf
  v_mfma_f32_16x16x32_bf16 v[20:23], v[172:175], v[44:47], v[20:23]
  v_add_f32_dpp v225, v31, v30 wave_shr:1 row_mask:0xf bank_mask:0xf
  v_mfma_f32_16x16x32_bf16 v[20:23], v[164:167], v[48:51], v[20:23]
  s_nop 0
  v_add_f32_dpp v227, v225, v29 wave_shr:1 row_mask:0xf bank_mask:0xf
  v_mfma_f32_16x16x32_bf16 v[20:23], v[156:159], v[52:55], v[20:23]
  s_nop 0
  v_add_f32_dpp v229, v227, v28 wave_shr:1 row_mask:0xf bank_mask:0xf
  v_mfma_f32_16x16x32_bf16 v[20:23], v[148:151], v[56:59], v[20:23]
  v_cvt_pk_bf16_f32 v243, v228, v229
  v_mfma_f32_16x16x32_bf16 v[20:23], v[140:143], v[60:63], v[20:23]
  v_or_b32 v243, 1, v243
  v_mfma_f32_16x16x32_bf16 v[20:23], v[132:135], v[64:67], v[20:23]
  v_mfma_f32_16x16x32_bf16 v[20:23], v[124:127], v[68:71], v[20:23]
  v_mfma_f32_16x16x32_bf16 v[20:23], v[116:119], v[72:75], v[20:23]
  v_mfma_f32_16x16x32_bf16 v[20:23], v[108:111], v[76:79], v[20:23]
  v_mfma_f32_16x16x32_bf16 v[20:23], v[100:103], v[80:83], v[20:23]
  s_waitcnt lgkmcnt(8)
  v_mfma_f32_16x16x32_bf16 v[24:27], v[200:203], v[32:35], 0
  ds_read_b64_tr_b16 v[212:213], v13 offset:3744
  ds_read_b64_tr_b16 v[214:215], v13 offset:3712
  v_add_f32_dpp v224, v31, v18 wave_ror:1 row_mask:0xf bank_mask:0xf
  v_mfma_f32_16x16x32_bf16 v[24:27], v[192:195], v[36:39], v[24:27]
  v_add_f32_dpp v226, v225, v17 wave_ror:1 row_mask:0xf bank_mask:0xf
  v_mfma_f32_16x16x32_bf16 v[24:27], v[184:187], v[40:43], v[24:27]
  v_add_f32_dpp v228, v227, v16 wave_ror:1 row_mask:0xf bank_mask:0xf
  v_mfma_f32_16x16x32_bf16 v[24:27], v[176:179], v[44:47], v[24:27]
  v_add_f32_dpp v224, v19, v18 wave_shr:1 row_mask:0xf bank_mask:0xf
  v_mfma_f32_16x16x32_bf16 v[24:27], v[168:171], v[48:51], v[24:27]
  s_nop 0
  v_add_f32_dpp v226, v224, v17 wave_shr:1 row_mask:0xf bank_mask:0xf
  v_mfma_f32_16x16x32_bf16 v[24:27], v[160:163], v[52:55], v[24:27]
  s_nop 0
  v_add_f32_dpp v228, v226, v16 wave_shr:1 row_mask:0xf bank_mask:0xf
  v_mfma_f32_16x16x32_bf16 v[24:27], v[152:155], v[56:59], v[24:27]
  v_mfma_f32_16x16x32_bf16 v[24:27], v[144:147], v[60:63], v[24:27]
  v_mfma_f32_16x16x32_bf16 v[24:27], v[136:139], v[64:67], v[24:27]
  v_mfma_f32_16x16x32_bf16 v[24:27], v[128:131], v[68:71], v[24:27]
  v_mfma_f32_16x16x32_bf16 v[24:27], v[120:123], v[72:75], v[24:27]
  v_mfma_f32_16x16x32_bf16 v[24:27], v[112:115], v[76:79], v[24:27]
  v_mfma_f32_16x16x32_bf16 v[24:27], v[104:107], v[80:83], v[24:27]
  s_waitcnt lgkmcnt(8)
  v_mfma_f32_16x16x32_bf16 v[24:27], v[96:99], v[84:87], v[24:27]
  s_waitcnt lgkmcnt(6)
  v_mfma_f32_16x16x32_bf16 v[28:31], v[204:207], v[32:35], 0
  ds_read_b64_tr_b16 v[216:217], v13 offset:3872
  ds_read_b64_tr_b16 v[218:219], v13 offset:3840
  ds_read_b64_tr_b16 v[92:93], v12 offset:3840
  ds_read_b64_tr_b16 v[94:95], v12 offset:3872
  v_add_f32_dpp v225, v19, v22 wave_ror:1 row_mask:0xf bank_mask:0xf
  v_mfma_f32_16x16x32_bf16 v[28:31], v[196:199], v[36:39], v[28:31]
  v_add_f32_dpp v227, v224, v21 wave_ror:1 row_mask:0xf bank_mask:0xf
  v_mfma_f32_16x16x32_bf16 v[28:31], v[188:191], v[40:43], v[28:31]
  v_add_f32_dpp v229, v226, v20 wave_ror:1 row_mask:0xf bank_mask:0xf
  v_mfma_f32_16x16x32_bf16 v[28:31], v[180:183], v[44:47], v[28:31]
  v_add_f32_dpp v225, v23, v22 wave_shr:1 row_mask:0xf bank_mask:0xf
  v_mfma_f32_16x16x32_bf16 v[28:31], v[172:175], v[48:51], v[28:31]
  s_nop 0
  v_add_f32_dpp v227, v225, v21 wave_shr:1 row_mask:0xf bank_mask:0xf
  v_mfma_f32_16x16x32_bf16 v[28:31], v[164:167], v[52:55], v[28:31]
  s_nop 0
  v_add_f32_dpp v229, v227, v20 wave_shr:1 row_mask:0xf bank_mask:0xf
  v_mfma_f32_16x16x32_bf16 v[28:31], v[156:159], v[56:59], v[28:31]
  v_cvt_pk_bf16_f32 v244, v228, v229
  v_mfma_f32_16x16x32_bf16 v[28:31], v[148:151], v[60:63], v[28:31]
  v_or_b32 v244, 1, v244
  v_mfma_f32_16x16x32_bf16 v[28:31], v[140:143], v[64:67], v[28:31]
  v_mfma_f32_16x16x32_bf16 v[28:31], v[132:135], v[68:71], v[28:31]
  v_mfma_f32_16x16x32_bf16 v[28:31], v[124:127], v[72:75], v[28:31]
  v_mfma_f32_16x16x32_bf16 v[28:31], v[116:119], v[76:79], v[28:31]
  v_mfma_f32_16x16x32_bf16 v[28:31], v[108:111], v[80:83], v[28:31]
  v_mfma_f32_16x16x32_bf16 v[28:31], v[100:103], v[84:87], v[28:31]
  s_waitcnt lgkmcnt(8)
  v_mfma_f32_16x16x32_bf16 v[16:19], v[208:211], v[32:35], 0
  ds_read_b64_tr_b16 v[220:221], v13 offset:4000
  ds_read_b64_tr_b16 v[222:223], v13 offset:3968
  v_add_f32_dpp v224, v23, v26 wave_ror:1 row_mask:0xf bank_mask:0xf
  v_mfma_f32_16x16x32_bf16 v[16:19], v[200:203], v[36:39], v[16:19]
  v_add_f32_dpp v226, v225, v25 wave_ror:1 row_mask:0xf bank_mask:0xf
  v_mfma_f32_16x16x32_bf16 v[16:19], v[192:195], v[40:43], v[16:19]
  v_add_f32_dpp v228, v227, v24 wave_ror:1 row_mask:0xf bank_mask:0xf
  v_mfma_f32_16x16x32_bf16 v[16:19], v[184:187], v[44:47], v[16:19]
  v_add_f32_dpp v224, v27, v26 wave_shr:1 row_mask:0xf bank_mask:0xf
  v_mfma_f32_16x16x32_bf16 v[16:19], v[176:179], v[48:51], v[16:19]
  s_nop 0
  v_add_f32_dpp v226, v224, v25 wave_shr:1 row_mask:0xf bank_mask:0xf
  v_mfma_f32_16x16x32_bf16 v[16:19], v[168:171], v[52:55], v[16:19]
  s_nop 0
  v_add_f32_dpp v228, v226, v24 wave_shr:1 row_mask:0xf bank_mask:0xf
  v_mfma_f32_16x16x32_bf16 v[16:19], v[160:163], v[56:59], v[16:19]
  v_mfma_f32_16x16x32_bf16 v[16:19], v[152:155], v[60:63], v[16:19]
  v_mfma_f32_16x16x32_bf16 v[16:19], v[144:147], v[64:67], v[16:19]
  v_mfma_f32_16x16x32_bf16 v[16:19], v[136:139], v[68:71], v[16:19]
  v_mfma_f32_16x16x32_bf16 v[16:19], v[128:131], v[72:75], v[16:19]
  v_mfma_f32_16x16x32_bf16 v[16:19], v[120:123], v[76:79], v[16:19]
  v_mfma_f32_16x16x32_bf16 v[16:19], v[112:115], v[80:83], v[16:19]
  v_mfma_f32_16x16x32_bf16 v[16:19], v[104:107], v[84:87], v[16:19]
  s_waitcnt lgkmcnt(8)
  v_mfma_f32_16x16x32_bf16 v[16:19], v[96:99], v[88:91], v[16:19]
  s_waitcnt lgkmcnt(6)
  v_mfma_f32_16x16x32_bf16 v[20:23], v[212:215], v[32:35], 0
  v_add_f32_dpp v225, v27, v30 wave_ror:1 row_mask:0xf bank_mask:0xf
  v_mfma_f32_16x16x32_bf16 v[20:23], v[204:207], v[36:39], v[20:23]
  v_add_f32_dpp v227, v224, v29 wave_ror:1 row_mask:0xf bank_mask:0xf
  v_mfma_f32_16x16x32_bf16 v[20:23], v[196:199], v[40:43], v[20:23]
  v_add_f32_dpp v229, v226, v28 wave_ror:1 row_mask:0xf bank_mask:0xf
  v_mfma_f32_16x16x32_bf16 v[20:23], v[188:191], v[44:47], v[20:23]
  v_add_f32_dpp v225, v31, v30 wave_shr:1 row_mask:0xf bank_mask:0xf
  v_mfma_f32_16x16x32_bf16 v[20:23], v[180:183], v[48:51], v[20:23]
  s_nop 0
  v_add_f32_dpp v227, v225, v29 wave_shr:1 row_mask:0xf bank_mask:0xf
  v_mfma_f32_16x16x32_bf16 v[20:23], v[172:175], v[52:55], v[20:23]
  s_nop 0
  v_add_f32_dpp v229, v227, v28 wave_shr:1 row_mask:0xf bank_mask:0xf
  v_mfma_f32_16x16x32_bf16 v[20:23], v[164:167], v[56:59], v[20:23]
  v_cvt_pk_bf16_f32 v245, v228, v229
  v_mfma_f32_16x16x32_bf16 v[20:23], v[156:159], v[60:63], v[20:23]
  v_or_b32 v245, 1, v245
  v_mfma_f32_16x16x32_bf16 v[20:23], v[148:151], v[64:67], v[20:23]
  v_mfma_f32_16x16x32_bf16 v[20:23], v[140:143], v[68:71], v[20:23]
  v_mfma_f32_16x16x32_bf16 v[20:23], v[132:135], v[72:75], v[20:23]
  v_mfma_f32_16x16x32_bf16 v[20:23], v[124:127], v[76:79], v[20:23]
  v_mfma_f32_16x16x32_bf16 v[20:23], v[116:119], v[80:83], v[20:23]
  v_mfma_f32_16x16x32_bf16 v[20:23], v[108:111], v[84:87], v[20:23]
  v_mfma_f32_16x16x32_bf16 v[20:23], v[100:103], v[88:91], v[20:23]
  s_waitcnt lgkmcnt(4)
  v_mfma_f32_16x16x32_bf16 v[24:27], v[216:219], v[32:35], 0
  v_add_f32_dpp v224, v31, v18 wave_ror:1 row_mask:0xf bank_mask:0xf
  v_mfma_f32_16x16x32_bf16 v[24:27], v[208:211], v[36:39], v[24:27]
  v_add_f32_dpp v226, v225, v17 wave_ror:1 row_mask:0xf bank_mask:0xf
  v_mfma_f32_16x16x32_bf16 v[24:27], v[200:203], v[40:43], v[24:27]
  v_add_f32_dpp v228, v227, v16 wave_ror:1 row_mask:0xf bank_mask:0xf
  v_mfma_f32_16x16x32_bf16 v[24:27], v[192:195], v[44:47], v[24:27]
  v_add_f32_dpp v224, v19, v18 wave_shr:1 row_mask:0xf bank_mask:0xf
  v_mfma_f32_16x16x32_bf16 v[24:27], v[184:187], v[48:51], v[24:27]
  s_nop 0
  v_add_f32_dpp v226, v224, v17 wave_shr:1 row_mask:0xf bank_mask:0xf
  v_mfma_f32_16x16x32_bf16 v[24:27], v[176:179], v[52:55], v[24:27]
  s_nop 0
  v_add_f32_dpp v228, v226, v16 wave_shr:1 row_mask:0xf bank_mask:0xf
  v_mfma_f32_16x16x32_bf16 v[24:27], v[168:171], v[56:59], v[24:27]
  v_mfma_f32_16x16x32_bf16 v[24:27], v[160:163], v[60:63], v[24:27]
  v_mfma_f32_16x16x32_bf16 v[24:27], v[152:155], v[64:67], v[24:27]
  v_mfma_f32_16x16x32_bf16 v[24:27], v[144:147], v[68:71], v[24:27]
  v_mfma_f32_16x16x32_bf16 v[24:27], v[136:139], v[72:75], v[24:27]
  v_mfma_f32_16x16x32_bf16 v[24:27], v[128:131], v[76:79], v[24:27]
  v_mfma_f32_16x16x32_bf16 v[24:27], v[120:123], v[80:83], v[24:27]
  v_mfma_f32_16x16x32_bf16 v[24:27], v[112:115], v[84:87], v[24:27]
  v_mfma_f32_16x16x32_bf16 v[24:27], v[104:107], v[88:91], v[24:27]
  s_waitcnt lgkmcnt(2)
  v_mfma_f32_16x16x32_bf16 v[24:27], v[96:99], v[92:95], v[24:27]
  s_waitcnt lgkmcnt(0)
  v_mfma_f32_16x16x32_bf16 v[28:31], v[220:223], v[32:35], 0
  v_add_f32_dpp v225, v19, v22 wave_ror:1 row_mask:0xf bank_mask:0xf
  v_mfma_f32_16x16x32_bf16 v[28:31], v[212:215], v[36:39], v[28:31]
  v_add_f32_dpp v227, v224, v21 wave_ror:1 row_mask:0xf bank_mask:0xf
  v_mfma_f32_16x16x32_bf16 v[28:31], v[204:207], v[40:43], v[28:31]
  v_add_f32_dpp v229, v226, v20 wave_ror:1 row_mask:0xf bank_mask:0xf
  v_mfma_f32_16x16x32_bf16 v[28:31], v[196:199], v[44:47], v[28:31]
  v_add_f32_dpp v225, v23, v22 wave_shr:1 row_mask:0xf bank_mask:0xf
  v_mfma_f32_16x16x32_bf16 v[28:31], v[188:191], v[48:51], v[28:31]
  s_nop 0
  v_add_f32_dpp v227, v225, v21 wave_shr:1 row_mask:0xf bank_mask:0xf
  v_mfma_f32_16x16x32_bf16 v[28:31], v[180:183], v[52:55], v[28:31]
  s_nop 0
  v_add_f32_dpp v229, v227, v20 wave_shr:1 row_mask:0xf bank_mask:0xf
  v_mfma_f32_16x16x32_bf16 v[28:31], v[172:175], v[56:59], v[28:31]
  v_cvt_pk_bf16_f32 v246, v228, v229
  v_mfma_f32_16x16x32_bf16 v[28:31], v[164:167], v[60:63], v[28:31]
  v_or_b32 v246, 1, v246
  v_mfma_f32_16x16x32_bf16 v[28:31], v[156:159], v[64:67], v[28:31]
  v_mfma_f32_16x16x32_bf16 v[28:31], v[148:151], v[68:71], v[28:31]
  v_mfma_f32_16x16x32_bf16 v[28:31], v[140:143], v[72:75], v[28:31]
  v_mfma_f32_16x16x32_bf16 v[28:31], v[132:135], v[76:79], v[28:31]
  v_mfma_f32_16x16x32_bf16 v[28:31], v[124:127], v[80:83], v[28:31]
  v_mfma_f32_16x16x32_bf16 v[28:31], v[116:119], v[84:87], v[28:31]
  v_mfma_f32_16x16x32_bf16 v[28:31], v[108:111], v[88:91], v[28:31]
  v_mfma_f32_16x16x32_bf16 v[28:31], v[100:103], v[92:95], v[28:31]
  v_add_f32_dpp v224, v23, v26 wave_ror:1 row_mask:0xf bank_mask:0xf
  v_add_f32_dpp v226, v225, v25 wave_ror:1 row_mask:0xf bank_mask:0xf
  v_add_f32_dpp v228, v227, v24 wave_ror:1 row_mask:0xf bank_mask:0xf
  v_add_f32_dpp v224, v27, v26 wave_shr:1 row_mask:0xf bank_mask:0xf
  s_nop 1
  v_add_f32_dpp v226, v224, v25 wave_shr:1 row_mask:0xf bank_mask:0xf
  s_nop 1
  v_add_f32_dpp v228, v226, v24 wave_shr:1 row_mask:0xf bank_mask:0xf
  v_add_f32_dpp v225, v27, v30 wave_ror:1 row_mask:0xf bank_mask:0xf
  v_add_f32_dpp v227, v224, v29 wave_ror:1 row_mask:0xf bank_mask:0xf
  v_add_f32_dpp v229, v226, v28 wave_ror:1 row_mask:0xf bank_mask:0xf
  v_add_f32_dpp v225, v31, v30 wave_shr:1 row_mask:0xf bank_mask:0xf
  s_nop 1
  v_add_f32_dpp v227, v225, v29 wave_shr:1 row_mask:0xf bank_mask:0xf
  s_nop 1
  v_add_f32_dpp v229, v227, v28 wave_shr:1 row_mask:0xf bank_mask:0xf
  v_cvt_pk_bf16_f32 v247, v228, v229
  v_or_b32 v247, 1, v247
  s_add_u32 s28, s98, 16777216
  s_addc_u32 s29, s99, 0
  s_mov_b32 s30, 4194304
  s_mov_b32 s31, 0x20000
  s_lshl_b32 s40, s6, 12
  buffer_store_dwordx4 v[232:235], v3, s[28:31], s40 offen offset:0 sc1
  buffer_store_dwordx4 v[236:239], v3, s[28:31], s40 offen offset:1024 sc1
  buffer_store_dwordx4 v[240:243], v3, s[28:31], s40 offen offset:2048 sc1
  buffer_store_dwordx4 v[244:247], v3, s[28:31], s40 offen offset:3072 sc1
  s_and_b32 s40, s10, 3
  s_lshl_b32 s40, s40, 2
  s_and_b32 s41, s11, 3
  s_add_u32 s40, s40, s41
  s_lshl_b32 s41, s40, 3
  s_lshl_b32 s42, s3, 1
  s_add_u32 s41, s41, s42
  s_lshl_b32 s48, s41, 15
  s_mov_b32 s47, s48
  v_lshrrev_b32 v5, 5, v2
  v_and_b32 v6, 1, v14
  v_lshlrev_b32 v12, 15, v6
  v_lshl_add_u32 v12, v5, 8, v12
  v_lshl_add_u32 v12, v15, 4, v12
  s_add_u32 s28, s98, 0
  s_addc_u32 s29, s99, 0
  s_mov_b32 s30, 4194304
  s_mov_b32 s31, 0x20000
  s_mov_b32 s32, s94
  s_mov_b32 s33, s95
  s_mov_b32 s34, 8388608
  s_mov_b32 s35, 0x20000
  s_waitcnt lgkmcnt(0)
  s_mov_b64 exec, 1
  ds_add_u32 v9, v11 offset:56
  s_mov_b64 exec, -1
  s_mov_b32 s43, 131072
K3_wwo:
  ds_read_b32 v80, v10 offset:48
  s_waitcnt lgkmcnt(0)
  v_readfirstlane_b32 s42, v80
  s_sub_u32 s43, s43, 1
  s_cbranch_scc1 K3_wwo_ok
  s_cmp_lt_u32 s42, 4
  s_cbranch_scc1 K3_wwo
K3_wwo_ok:
  s_setprio 1
  buffer_load_dwordx4 v[96:99], v12, s[28:31], s48 offen offset:0
  buffer_load_dwordx4 v[100:103], v12, s[28:31], s48 offen offset:512
  buffer_load_dwordx4 v[104:107], v12, s[28:31], s48 offen offset:1024
  buffer_load_dwordx4 v[108:111], v12, s[28:31], s48 offen offset:1536
  buffer_load_dwordx4 v[112:115], v12, s[28:31], s48 offen offset:2048
  buffer_load_dwordx4 v[116:119], v12, s[28:31], s48 offen offset:2560
  buffer_load_dwordx4 v[120:123], v12, s[28:31], s48 offen offset:3072
  buffer_load_dwordx4 v[124:127], v12, s[28:31], s48 offen offset:3584
  s_add_u32 s48, s48, 4096
  buffer_load_dwordx4 v[128:131], v12, s[28:31], s48 offen offset:0
  buffer_load_dwordx4 v[132:135], v12, s[28:31], s48 offen offset:512
  buffer_load_dwordx4 v[136:139], v12, s[28:31], s48 offen offset:1024
  buffer_load_dwordx4 v[140:143], v12, s[28:31], s48 offen offset:1536
  buffer_load_dwordx4 v[144:147], v12, s[28:31], s48 offen offset:2048
  buffer_load_dwordx4 v[148:151], v12, s[28:31], s48 offen offset:2560
  buffer_load_dwordx4 v[152:155], v12, s[28:31], s48 offen offset:3072
  buffer_load_dwordx4 v[156:159], v12, s[28:31], s48 offen offset:3584
  s_add_u32 s48, s48, 4096
  buffer_load_dwordx4 v[160:163], v12, s[28:31], s48 offen offset:0
  buffer_load_dwordx4 v[164:167], v12, s[28:31], s48 offen offset:512
  buffer_load_dwordx4 v[168:171], v12, s[28:31], s48 offen offset:1024
  buffer_load_dwordx4 v[172:175], v12, s[28:31], s48 offen offset:1536
  buffer_load_dwordx4 v[176:179], v12, s[28:31], s48 offen offset:2048
  buffer_load_dwordx4 v[180:183], v12, s[28:31], s48 offen offset:2560
  buffer_load_dwordx4 v[184:187], v12, s[28:31], s48 offen offset:3072
  buffer_load_dwordx4 v[188:191], v12, s[28:31], s48 offen offset:3584
  s_add_u32 s48, s48, 4096
  v_bfe_u32 v4, v2, 2, 2
  v_and_b32 v7, 3, v2
  v_lshlrev_b32 v4, 6, v4
  v_lshl_add_u32 v4, v7, 3, v4
  v_lshl_add_u32 v4, v5, 9, v4
  v_xor_b32 v7, v6, v5
  v_lshl_add_u32 v13, v7, 5, v4
  v_add_u32 v4, 40960, v13
  v_add_u32 v8, 106496, v13
  ds_read_b64_tr_b16 v[48:49], v4 offset:0
  ds_read_b64_tr_b16 v[50:51], v4 offset:2048
  ds_read_b64_tr_b16 v[52:53], v4 offset:256
  ds_read_b64_tr_b16 v[54:55], v4 offset:2304
  ds_read_b64_tr_b16 v[56:57], v4 offset:1024
  ds_read_b64_tr_b16 v[58:59], v4 offset:3072
  ds_read_b64_tr_b16 v[60:61], v4 offset:1280
  ds_read_b64_tr_b16 v[62:63], v4 offset:3328
  s_waitcnt vmcnt(16)
  v_bitop3_b32 v81, v96, v97, v98 bitop3:0x80
  v_bitop3_b32 v81, v81, v99, v100 bitop3:0x80
  v_bitop3_b32 v81, v81, v101, v102 bitop3:0x80
  v_bitop3_b32 v81, v81, v103, v104 bitop3:0x80
  v_bitop3_b32 v81, v81, v105, v106 bitop3:0x80
  v_bitop3_b32 v81, v81, v107, v108 bitop3:0x80
  v_bitop3_b32 v81, v81, v109, v110 bitop3:0x80
  v_bitop3_b32 v81, v81, v111, v112 bitop3:0x80
  v_bitop3_b32 v81, v81, v113, v114 bitop3:0x80
  v_bitop3_b32 v81, v81, v115, v116 bitop3:0x80
  v_bitop3_b32 v81, v81, v117, v118 bitop3:0x80
  v_bitop3_b32 v81, v81, v119, v120 bitop3:0x80
  v_bitop3_b32 v81, v81, v121, v122 bitop3:0x80
  v_bitop3_b32 v81, v81, v123, v124 bitop3:0x80
  v_bitop3_b32 v81, v81, v125, v126 bitop3:0x80
  v_bitop3_b32 v81, v81, v127, 1 bitop3:0x80
  v_cmp_eq_u32 vcc, 0, v81
  s_nop 0
  s_cmp_lg_u64 vcc, 0
  s_cbranch_scc1 K3_retry0
K3_retry0_ret:
  s_waitcnt lgkmcnt(6)
  v_mfma_f32_32x32x16_bf16 v[16:31], v[48:51], v[96:99], 0
  ds_read_b64_tr_b16 v[64:65], v4 offset:4096
  ds_read_b64_tr_b16 v[66:67], v4 offset:6144
  s_waitcnt lgkmcnt(6)
  v_mfma_f32_32x32x16_bf16 v[32:47], v[52:55], v[96:99], 0
  ds_read_b64_tr_b16 v[68:69], v4 offset:4352
  ds_read_b64_tr_b16 v[70:71], v4 offset:6400
  s_waitcnt lgkmcnt(6)
  v_mfma_f32_32x32x16_bf16 v[16:31], v[56:59], v[100:103], v[16:31]
  ds_read_b64_tr_b16 v[72:73], v4 offset:5120
  ds_read_b64_tr_b16 v[74:75], v4 offset:7168
  s_waitcnt lgkmcnt(6)
  v_mfma_f32_32x32x16_bf16 v[32:47], v[60:63], v[100:103], v[32:47]
  ds_read_b64_tr_b16 v[76:77], v4 offset:5376
  ds_read_b64_tr_b16 v[78:79], v4 offset:7424
  buffer_load_dwordx4 v[192:195], v12, s[28:31], s48 offen offset:0
  buffer_load_dwordx4 v[196:199], v12, s[28:31], s48 offen offset:512
  buffer_load_dwordx4 v[200:203], v12, s[28:31], s48 offen offset:1024
  buffer_load_dwordx4 v[204:207], v12, s[28:31], s48 offen offset:1536
  s_waitcnt lgkmcnt(6)
  v_mfma_f32_32x32x16_bf16 v[16:31], v[64:67], v[104:107], v[16:31]
  ds_read_b64_tr_b16 v[48:49], v4 offset:8192
  ds_read_b64_tr_b16 v[50:51], v4 offset:10240
  s_waitcnt lgkmcnt(6)
  v_mfma_f32_32x32x16_bf16 v[32:47], v[68:71], v[104:107], v[32:47]
  ds_read_b64_tr_b16 v[52:53], v4 offset:8448
  ds_read_b64_tr_b16 v[54:55], v4 offset:10496
  s_waitcnt lgkmcnt(6)
  v_mfma_f32_32x32x16_bf16 v[16:31], v[72:75], v[108:111], v[16:31]
  ds_read_b64_tr_b16 v[56:57], v4 offset:9216
  ds_read_b64_tr_b16 v[58:59], v4 offset:11264
  s_waitcnt lgkmcnt(6)
  v_mfma_f32_32x32x16_bf16 v[32:47], v[76:79], v[108:111], v[32:47]
  ds_read_b64_tr_b16 v[60:61], v4 offset:9472
  ds_read_b64_tr_b16 v[62:63], v4 offset:11520
  buffer_load_dwordx4 v[208:211], v12, s[28:31], s48 offen offset:2048
  buffer_load_dwordx4 v[212:215], v12, s[28:31], s48 offen offset:2560
  buffer_load_dwordx4 v[216:219], v12, s[28:31], s48 offen offset:3072
  buffer_load_dwordx4 v[220:223], v12, s[28:31], s48 offen offset:3584
  s_add_u32 s48, s48, 4096
  s_waitcnt vmcnt(16)
  s_waitcnt lgkmcnt(6)
  v_mfma_f32_32x32x16_bf16 v[16:31], v[48:51], v[112:115], v[16:31]
  ds_read_b64_tr_b16 v[64:65], v4 offset:12288
  v_bitop3_b32 v81, v128, v129, v130 bitop3:0x80
  ds_read_b64_tr_b16 v[66:67], v4 offset:14336
  v_bitop3_b32 v81, v81, v131, v132 bitop3:0x80
  s_waitcnt lgkmcnt(6)
  v_mfma_f32_32x32x16_bf16 v[32:47], v[52:55], v[112:115], v[32:47]
  ds_read_b64_tr_b16 v[68:69], v4 offset:12544
  v_bitop3_b32 v81, v81, v133, v134 bitop3:0x80
  ds_read_b64_tr_b16 v[70:71], v4 offset:14592
  v_bitop3_b32 v81, v81, v135, v136 bitop3:0x80
  s_waitcnt lgkmcnt(6)
  v_mfma_f32_32x32x16_bf16 v[16:31], v[56:59], v[116:119], v[16:31]
  ds_read_b64_tr_b16 v[72:73], v4 offset:13312
  v_bitop3_b32 v81, v81, v137, v138 bitop3:0x80
  ds_read_b64_tr_b16 v[74:75], v4 offset:15360
  v_bitop3_b32 v81, v81, v139, v140 bitop3:0x80
  s_waitcnt lgkmcnt(6)
  v_mfma_f32_32x32x16_bf16 v[32:47], v[60:63], v[116:119], v[32:47]
  ds_read_b64_tr_b16 v[76:77], v4 offset:13568
  v_bitop3_b32 v81, v81, v141, v142 bitop3:0x80
  ds_read_b64_tr_b16 v[78:79], v4 offset:15616
  v_bitop3_b32 v81, v81, v143, v144 bitop3:0x80
  buffer_load_dwordx4 v[96:99], v12, s[28:31], s48 offen offset:0
  buffer_load_dwordx4 v[100:103], v12, s[28:31], s48 offen offset:512
  buffer_load_dwordx4 v[104:107], v12, s[28:31], s48 offen offset:1024
  buffer_load_dwordx4 v[108:111], v12, s[28:31], s48 offen offset:1536
  s_waitcnt lgkmcnt(6)
  v_mfma_f32_32x32x16_bf16 v[16:31], v[64:67], v[120:123], v[16:31]
  ds_read_b64_tr_b16 v[48:49], v4 offset:16384
  v_bitop3_b32 v81, v81, v145, v146 bitop3:0x80
  ds_read_b64_tr_b16 v[50:51], v4 offset:18432
  v_bitop3_b32 v81, v81, v147, v148 bitop3:0x80
  s_waitcnt lgkmcnt(6)
  v_mfma_f32_32x32x16_bf16 v[32:47], v[68:71], v[120:123], v[32:47]
  ds_read_b64_tr_b16 v[52:53], v4 offset:16640
  v_bitop3_b32 v81, v81, v149, v150 bitop3:0x80
  ds_read_b64_tr_b16 v[54:55], v4 offset:18688
  v_bitop3_b32 v81, v81, v151, v152 bitop3:0x80
  s_waitcnt lgkmcnt(6)
  v_mfma_f32_32x32x16_bf16 v[16:31], v[72:75], v[124:127], v[16:31]
  ds_read_b64_tr_b16 v[56:57], v4 offset:17408
  v_bitop3_b32 v81, v81, v153, v154 bitop3:0x80
  ds_read_b64_tr_b16 v[58:59], v4 offset:19456
  v_bitop3_b32 v81, v81, v155, v156 bitop3:0x80
  s_waitcnt lgkmcnt(6)
  v_mfma_f32_32x32x16_bf16 v[32:47], v[76:79], v[124:127], v[32:47]
  ds_read_b64_tr_b16 v[60:61], v4 offset:17664
  v_bitop3_b32 v81, v81, v157, v158 bitop3:0x80
  ds_read_b64_tr_b16 v[62:63], v4 offset:19712
  v_bitop3_b32 v81, v81, v159, 1 bitop3:0x80
  v_cmp_eq_u32 vcc, 0, v81
  s_nop 0
  s_cmp_lg_u64 vcc, 0
  s_cbranch_scc1 K3_retry1
K3_retry1_ret:
  buffer_load_dwordx4 v[112:115], v12, s[28:31], s48 offen offset:2048
  buffer_load_dwordx4 v[116:119], v12, s[28:31], s48 offen offset:2560
  buffer_load_dwordx4 v[120:123], v12, s[28:31], s48 offen offset:3072
  buffer_load_dwordx4 v[124:127], v12, s[28:31], s48 offen offset:3584
  s_add_u32 s48, s48, 4096
  s_waitcnt lgkmcnt(6)
  v_mfma_f32_32x32x16_bf16 v[16:31], v[48:51], v[128:131], v[16:31]
  ds_read_b64_tr_b16 v[64:65], v4 offset:20480
  ds_read_b64_tr_b16 v[66:67], v4 offset:22528
  s_waitcnt lgkmcnt(6)
  v_mfma_f32_32x32x16_bf16 v[32:47], v[52:55], v[128:131], v[32:47]
  ds_read_b64_tr_b16 v[68:69], v4 offset:20736
  ds_read_b64_tr_b16 v[70:71], v4 offset:22784
  s_waitcnt lgkmcnt(6)
  v_mfma_f32_32x32x16_bf16 v[16:31], v[56:59], v[132:135], v[16:31]
  ds_read_b64_tr_b16 v[72:73], v4 offset:21504
  ds_read_b64_tr_b16 v[74:75], v4 offset:23552
  s_waitcnt lgkmcnt(6)
  v_mfma_f32_32x32x16_bf16 v[32:47], v[60:63], v[132:135], v[32:47]
  ds_read_b64_tr_b16 v[76:77], v4 offset:21760
  ds_read_b64_tr_b16 v[78:79], v4 offset:23808
  buffer_load_dwordx4 v[128:131], v12, s[28:31], s48 offen offset:0
  buffer_load_dwordx4 v[132:135], v12, s[28:31], s48 offen offset:512
  s_waitcnt lgkmcnt(6)
  v_mfma_f32_32x32x16_bf16 v[16:31], v[64:67], v[136:139], v[16:31]
  ds_read_b64_tr_b16 v[48:49], v4 offset:24576
  ds_read_b64_tr_b16 v[50:51], v4 offset:26624
  s_waitcnt lgkmcnt(6)
  v_mfma_f32_32x32x16_bf16 v[32:47], v[68:71], v[136:139], v[32:47]
  ds_read_b64_tr_b16 v[52:53], v4 offset:24832
  ds_read_b64_tr_b16 v[54:55], v4 offset:26880
  s_waitcnt lgkmcnt(6)
  v_mfma_f32_32x32x16_bf16 v[16:31], v[72:75], v[140:143], v[16:31]
  ds_read_b64_tr_b16 v[56:57], v4 offset:25600
  ds_read_b64_tr_b16 v[58:59], v4 offset:27648
  s_waitcnt lgkmcnt(6)
  v_mfma_f32_32x32x16_bf16 v[32:47], v[76:79], v[140:143], v[32:47]
  ds_read_b64_tr_b16 v[60:61], v4 offset:25856
  ds_read_b64_tr_b16 v[62:63], v4 offset:27904
  buffer_load_dwordx4 v[136:139], v12, s[28:31], s48 offen offset:1024
  buffer_load_dwordx4 v[140:143], v12, s[28:31], s48 offen offset:1536
  s_waitcnt vmcnt(20)
  s_waitcnt lgkmcnt(6)
  v_mfma_f32_32x32x16_bf16 v[16:31], v[48:51], v[144:147], v[16:31]
  ds_read_b64_tr_b16 v[64:65], v4 offset:28672
  v_bitop3_b32 v81, v160, v161, v162 bitop3:0x80
  ds_read_b64_tr_b16 v[66:67], v4 offset:30720
  v_bitop3_b32 v81, v81, v163, v164 bitop3:0x80
  s_waitcnt lgkmcnt(6)
  v_mfma_f32_32x32x16_bf16 v[32:47], v[52:55], v[144:147], v[32:47]
  ds_read_b64_tr_b16 v[68:69], v4 offset:28928
  v_bitop3_b32 v81, v81, v165, v166 bitop3:0x80
  ds_read_b64_tr_b16 v[70:71], v4 offset:30976
  v_bitop3_b32 v81, v81, v167, v168 bitop3:0x80
  s_waitcnt lgkmcnt(6)
  v_mfma_f32_32x32x16_bf16 v[16:31], v[56:59], v[148:151], v[16:31]
  ds_read_b64_tr_b16 v[72:73], v4 offset:29696
  v_bitop3_b32 v81, v81, v169, v170 bitop3:0x80
  ds_read_b64_tr_b16 v[74:75], v4 offset:31744
  v_bitop3_b32 v81, v81, v171, v172 bitop3:0x80
  s_waitcnt lgkmcnt(6)
  v_mfma_f32_32x32x16_bf16 v[32:47], v[60:63], v[148:151], v[32:47]
  ds_read_b64_tr_b16 v[76:77], v4 offset:29952
  v_bitop3_b32 v81, v81, v173, v174 bitop3:0x80
  ds_read_b64_tr_b16 v[78:79], v4 offset:32000
  v_bitop3_b32 v81, v81, v175, v176 bitop3:0x80
  buffer_load_dwordx4 v[144:147], v12, s[28:31], s48 offen offset:2048
  buffer_load_dwordx4 v[148:151], v12, s[28:31], s48 offen offset:2560
  s_waitcnt lgkmcnt(6)
  v_mfma_f32_32x32x16_bf16 v[16:31], v[64:67], v[152:155], v[16:31]
  ds_read_b64_tr_b16 v[48:49], v4 offset:32768
  v_bitop3_b32 v81, v81, v177, v178 bitop3:0x80
  ds_read_b64_tr_b16 v[50:51], v4 offset:34816
  v_bitop3_b32 v81, v81, v179, v180 bitop3:0x80
  s_waitcnt lgkmcnt(6)
  v_mfma_f32_32x32x16_bf16 v[32:47], v[68:71], v[152:155], v[32:47]
  ds_read_b64_tr_b16 v[52:53], v4 offset:33024
  v_bitop3_b32 v81, v81, v181, v182 bitop3:0x80
  ds_read_b64_tr_b16 v[54:55], v4 offset:35072
  v_bitop3_b32 v81, v81, v183, v184 bitop3:0x80
  s_waitcnt lgkmcnt(6)
  v_mfma_f32_32x32x16_bf16 v[16:31], v[72:75], v[156:159], v[16:31]
  ds_read_b64_tr_b16 v[56:57], v4 offset:33792
  v_bitop3_b32 v81, v81, v185, v186 bitop3:0x80
  ds_read_b64_tr_b16 v[58:59], v4 offset:35840
  v_bitop3_b32 v81, v81, v187, v188 bitop3:0x80
  s_waitcnt lgkmcnt(6)
  v_mfma_f32_32x32x16_bf16 v[32:47], v[76:79], v[156:159], v[32:47]
  ds_read_b64_tr_b16 v[60:61], v4 offset:34048
  v_bitop3_b32 v81, v81, v189, v190 bitop3:0x80
  ds_read_b64_tr_b16 v[62:63], v4 offset:36096
  v_bitop3_b32 v81, v81, v191, 1 bitop3:0x80
  v_cmp_eq_u32 vcc, 0, v81
  s_nop 0
  s_cmp_lg_u64 vcc, 0
  s_cbranch_scc1 K3_retry2
K3_retry2_ret:
  buffer_load_dwordx4 v[152:155], v12, s[28:31], s48 offen offset:3072
  buffer_load_dwordx4 v[156:159], v12, s[28:31], s48 offen offset:3584
  s_add_u32 s48, s48, 4096
  s_waitcnt lgkmcnt(6)
  v_mfma_f32_32x32x16_bf16 v[16:31], v[48:51], v[160:163], v[16:31]
  ds_read_b64_tr_b16 v[64:65], v4 offset:36864
  ds_read_b64_tr_b16 v[66:67], v4 offset:38912
  s_waitcnt lgkmcnt(6)
  v_mfma_f32_32x32x16_bf16 v[32:47], v[52:55], v[160:163], v[32:47]
  ds_read_b64_tr_b16 v[68:69], v4 offset:37120
  ds_read_b64_tr_b16 v[70:71], v4 offset:39168
  s_waitcnt lgkmcnt(6)
  v_mfma_f32_32x32x16_bf16 v[16:31], v[56:59], v[164:167], v[16:31]
  ds_read_b64_tr_b16 v[72:73], v4 offset:37888
  ds_read_b64_tr_b16 v[74:75], v4 offset:39936
  s_waitcnt lgkmcnt(6)
  v_mfma_f32_32x32x16_bf16 v[32:47], v[60:63], v[164:167], v[32:47]
  ds_read_b64_tr_b16 v[76:77], v4 offset:38144
  ds_read_b64_tr_b16 v[78:79], v4 offset:40192
  buffer_load_dwordx4 v[160:163], v12, s[28:31], s48 offen offset:0
  buffer_load_dwordx4 v[164:167], v12, s[28:31], s48 offen offset:512
  s_waitcnt lgkmcnt(6)
  v_mfma_f32_32x32x16_bf16 v[16:31], v[64:67], v[168:171], v[16:31]
  ds_read_b64_tr_b16 v[48:49], v4 offset:40960
  ds_read_b64_tr_b16 v[50:51], v4 offset:43008
  s_waitcnt lgkmcnt(6)
  v_mfma_f32_32x32x16_bf16 v[32:47], v[68:71], v[168:171], v[32:47]
  ds_read_b64_tr_b16 v[52:53], v4 offset:41216
  ds_read_b64_tr_b16 v[54:55], v4 offset:43264
  s_waitcnt lgkmcnt(6)
  v_mfma_f32_32x32x16_bf16 v[16:31], v[72:75], v[172:175], v[16:31]
  ds_read_b64_tr_b16 v[56:57], v4 offset:41984
  ds_read_b64_tr_b16 v[58:59], v4 offset:44032
  s_waitcnt lgkmcnt(6)
  v_mfma_f32_32x32x16_bf16 v[32:47], v[76:79], v[172:175], v[32:47]
  ds_read_b64_tr_b16 v[60:61], v4 offset:42240
  ds_read_b64_tr_b16 v[62:63], v4 offset:44288
  buffer_load_dwordx4 v[168:171], v12, s[28:31], s48 offen offset:1024
  buffer_load_dwordx4 v[172:175], v12, s[28:31], s48 offen offset:1536
  s_waitcnt vmcnt(20)
  s_waitcnt lgkmcnt(6)
  v_mfma_f32_32x32x16_bf16 v[16:31], v[48:51], v[176:179], v[16:31]
  ds_read_b64_tr_b16 v[64:65], v4 offset:45056
  v_bitop3_b32 v81, v192, v193, v194 bitop3:0x80
  ds_read_b64_tr_b16 v[66:67], v4 offset:47104
  v_bitop3_b32 v81, v81, v195, v196 bitop3:0x80
  s_waitcnt lgkmcnt(6)
  v_mfma_f32_32x32x16_bf16 v[32:47], v[52:55], v[176:179], v[32:47]
  ds_read_b64_tr_b16 v[68:69], v4 offset:45312
  v_bitop3_b32 v81, v81, v197, v198 bitop3:0x80
  ds_read_b64_tr_b16 v[70:71], v4 offset:47360
  v_bitop3_b32 v81, v81, v199, v200 bitop3:0x80
  s_waitcnt lgkmcnt(6)
  v_mfma_f32_32x32x16_bf16 v[16:31], v[56:59], v[180:183], v[16:31]
  ds_read_b64_tr_b16 v[72:73], v4 offset:46080
  v_bitop3_b32 v81, v81, v201, v202 bitop3:0x80
  ds_read_b64_tr_b16 v[74:75], v4 offset:48128
  v_bitop3_b32 v81, v81, v203, v204 bitop3:0x80
  s_waitcnt lgkmcnt(6)
  v_mfma_f32_32x32x16_bf16 v[32:47], v[60:63], v[180:183], v[32:47]
  ds_read_b64_tr_b16 v[76:77], v4 offset:46336
  v_bitop3_b32 v81, v81, v205, v206 bitop3:0x80
  ds_read_b64_tr_b16 v[78:79], v4 offset:48384
  v_bitop3_b32 v81, v81, v207, v208 bitop3:0x80
  buffer_load_dwordx4 v[176:179], v12, s[28:31], s48 offen offset:2048
  buffer_load_dwordx4 v[180:183], v12, s[28:31], s48 offen offset:2560
  s_waitcnt lgkmcnt(6)
  v_mfma_f32_32x32x16_bf16 v[16:31], v[64:67], v[184:187], v[16:31]
  ds_read_b64_tr_b16 v[48:49], v4 offset:49152
  v_bitop3_b32 v81, v81, v209, v210 bitop3:0x80
  ds_read_b64_tr_b16 v[50:51], v4 offset:51200
  v_bitop3_b32 v81, v81, v211, v212 bitop3:0x80
  s_waitcnt lgkmcnt(6)
  v_mfma_f32_32x32x16_bf16 v[32:47], v[68:71], v[184:187], v[32:47]
  ds_read_b64_tr_b16 v[52:53], v4 offset:49408
  v_bitop3_b32 v81, v81, v213, v214 bitop3:0x80
  ds_read_b64_tr_b16 v[54:55], v4 offset:51456
  v_bitop3_b32 v81, v81, v215, v216 bitop3:0x80
  s_waitcnt lgkmcnt(6)
  v_mfma_f32_32x32x16_bf16 v[16:31], v[72:75], v[188:191], v[16:31]
  ds_read_b64_tr_b16 v[56:57], v4 offset:50176
  v_bitop3_b32 v81, v81, v217, v218 bitop3:0x80
  ds_read_b64_tr_b16 v[58:59], v4 offset:52224
  v_bitop3_b32 v81, v81, v219, v220 bitop3:0x80
  s_waitcnt lgkmcnt(6)
  v_mfma_f32_32x32x16_bf16 v[32:47], v[76:79], v[188:191], v[32:47]
  ds_read_b64_tr_b16 v[60:61], v4 offset:50432
  v_bitop3_b32 v81, v81, v221, v222 bitop3:0x80
  ds_read_b64_tr_b16 v[62:63], v4 offset:52480
  v_bitop3_b32 v81, v81, v223, 1 bitop3:0x80
  v_cmp_eq_u32 vcc, 0, v81
  s_nop 0
  s_cmp_lg_u64 vcc, 0
  s_cbranch_scc1 K3_retry3
K3_retry3_ret:
  buffer_load_dwordx4 v[184:187], v12, s[28:31], s48 offen offset:3072
  buffer_load_dwordx4 v[188:191], v12, s[28:31], s48 offen offset:3584
  s_add_u32 s48, s48, 4096
  s_waitcnt lgkmcnt(6)
  v_mfma_f32_32x32x16_bf16 v[16:31], v[48:51], v[192:195], v[16:31]
  ds_read_b64_tr_b16 v[64:65], v4 offset:53248
  ds_read_b64_tr_b16 v[66:67], v4 offset:55296
  s_waitcnt lgkmcnt(6)
  v_mfma_f32_32x32x16_bf16 v[32:47], v[52:55], v[192:195], v[32:47]
  ds_read_b64_tr_b16 v[68:69], v4 offset:53504
  ds_read_b64_tr_b16 v[70:71], v4 offset:55552
  s_waitcnt lgkmcnt(6)
  v_mfma_f32_32x32x16_bf16 v[16:31], v[56:59], v[196:199], v[16:31]
  ds_read_b64_tr_b16 v[72:73], v4 offset:54272
  ds_read_b64_tr_b16 v[74:75], v4 offset:56320
  s_waitcnt lgkmcnt(6)
  v_mfma_f32_32x32x16_bf16 v[32:47], v[60:63], v[196:199], v[32:47]
  ds_read_b64_tr_b16 v[76:77], v4 offset:54528
  ds_read_b64_tr_b16 v[78:79], v4 offset:56576
  buffer_load_dwordx4 v[192:195], v12, s[28:31], s48 offen offset:0
  buffer_load_dwordx4 v[196:199], v12, s[28:31], s48 offen offset:512
  s_waitcnt lgkmcnt(6)
  v_mfma_f32_32x32x16_bf16 v[16:31], v[64:67], v[200:203], v[16:31]
  ds_read_b64_tr_b16 v[48:49], v4 offset:57344
  ds_read_b64_tr_b16 v[50:51], v4 offset:59392
  s_waitcnt lgkmcnt(6)
  v_mfma_f32_32x32x16_bf16 v[32:47], v[68:71], v[200:203], v[32:47]
  ds_read_b64_tr_b16 v[52:53], v4 offset:57600
  ds_read_b64_tr_b16 v[54:55], v4 offset:59648
  s_waitcnt lgkmcnt(6)
  v_mfma_f32_32x32x16_bf16 v[16:31], v[72:75], v[204:207], v[16:31]
  ds_read_b64_tr_b16 v[56:57], v4 offset:58368
  ds_read_b64_tr_b16 v[58:59], v4 offset:60416
  s_waitcnt lgkmcnt(6)
  v_mfma_f32_32x32x16_bf16 v[32:47], v[76:79], v[204:207], v[32:47]
  ds_read_b64_tr_b16 v[60:61], v4 offset:58624
  ds_read_b64_tr_b16 v[62:63], v4 offset:60672
  buffer_load_dwordx4 v[200:203], v12, s[28:31], s48 offen offset:1024
  buffer_load_dwordx4 v[204:207], v12, s[28:31], s48 offen offset:1536
  s_waitcnt vmcnt(20)
  s_waitcnt lgkmcnt(6)
  v_mfma_f32_32x32x16_bf16 v[16:31], v[48:51], v[208:211], v[16:31]
  ds_read_b64_tr_b16 v[64:65], v4 offset:61440
  v_bitop3_b32 v81, v96, v97, v98 bitop3:0x80
  ds_read_b64_tr_b16 v[66:67], v4 offset:63488
  v_bitop3_b32 v81, v81, v99, v100 bitop3:0x80
  s_waitcnt lgkmcnt(6)
  v_mfma_f32_32x32x16_bf16 v[32:47], v[52:55], v[208:211], v[32:47]
  ds_read_b64_tr_b16 v[68:69], v4 offset:61696
  v_bitop3_b32 v81, v81, v101, v102 bitop3:0x80
  ds_read_b64_tr_b16 v[70:71], v4 offset:63744
  v_bitop3_b32 v81, v81, v103, v104 bitop3:0x80
  s_waitcnt lgkmcnt(6)
  v_mfma_f32_32x32x16_bf16 v[16:31], v[56:59], v[212:215], v[16:31]
  ds_read_b64_tr_b16 v[72:73], v4 offset:62464
  v_bitop3_b32 v81, v81, v105, v106 bitop3:0x80
  ds_read_b64_tr_b16 v[74:75], v4 offset:64512
  v_bitop3_b32 v81, v81, v107, v108 bitop3:0x80
  s_waitcnt lgkmcnt(6)
  v_mfma_f32_32x32x16_bf16 v[32:47], v[60:63], v[212:215], v[32:47]
  ds_read_b64_tr_b16 v[76:77], v4 offset:62720
  v_bitop3_b32 v81, v81, v109, v110 bitop3:0x80
  ds_read_b64_tr_b16 v[78:79], v4 offset:64768
  v_bitop3_b32 v81, v81, v111, v112 bitop3:0x80
  buffer_load_dwordx4 v[208:211], v12, s[28:31], s48 offen offset:2048
  buffer_load_dwordx4 v[212:215], v12, s[28:31], s48 offen offset:2560
  s_waitcnt lgkmcnt(6)
  v_mfma_f32_32x32x16_bf16 v[16:31], v[64:67], v[216:219], v[16:31]
  ds_read_b64_tr_b16 v[48:49], v8 offset:0
  v_bitop3_b32 v81, v81, v113, v114 bitop3:0x80
  ds_read_b64_tr_b16 v[50:51], v8 offset:2048
  v_bitop3_b32 v81, v81, v115, v116 bitop3:0x80
  s_waitcnt lgkmcnt(6)
  v_mfma_f32_32x32x16_bf16 v[32:47], v[68:71], v[216:219], v[32:47]
  ds_read_b64_tr_b16 v[52:53], v8 offset:256
  v_bitop3_b32 v81, v81, v117, v118 bitop3:0x80
  ds_read_b64_tr_b16 v[54:55], v8 offset:2304
  v_bitop3_b32 v81, v81, v119, v120 bitop3:0x80
  s_waitcnt lgkmcnt(6)
  v_mfma_f32_32x32x16_bf16 v[16:31], v[72:75], v[220:223], v[16:31]
  ds_read_b64_tr_b16 v[56:57], v8 offset:1024
  v_bitop3_b32 v81, v81, v121, v122 bitop3:0x80
  ds_read_b64_tr_b16 v[58:59], v8 offset:3072
  v_bitop3_b32 v81, v81, v123, v124 bitop3:0x80
  s_waitcnt lgkmcnt(6)
  v_mfma_f32_32x32x16_bf16 v[32:47], v[76:79], v[220:223], v[32:47]
  ds_read_b64_tr_b16 v[60:61], v8 offset:1280
  v_bitop3_b32 v81, v81, v125, v126 bitop3:0x80
  ds_read_b64_tr_b16 v[62:63], v8 offset:3328
  v_bitop3_b32 v81, v81, v127, 1 bitop3:0x80
  v_cmp_eq_u32 vcc, 0, v81
  s_nop 0
  s_cmp_lg_u64 vcc, 0
  s_cbranch_scc1 K3_retry4
K3_retry4_ret:
  buffer_load_dwordx4 v[216:219], v12, s[28:31], s48 offen offset:3072
  buffer_load_dwordx4 v[220:223], v12, s[28:31], s48 offen offset:3584
  s_add_u32 s48, s48, 4096
  s_mov_b64 exec, 1
  ds_add_u32 v9, v11 offset:112
  s_mov_b64 exec, -1
  s_waitcnt lgkmcnt(7)
  v_mfma_f32_32x32x16_bf16 v[16:31], v[48:51], v[96:99], v[16:31]
  ds_read_b64_tr_b16 v[64:65], v8 offset:4096
  ds_read_b64_tr_b16 v[66:67], v8 offset:6144
  s_waitcnt lgkmcnt(7)
  v_mfma_f32_32x32x16_bf16 v[32:47], v[52:55], v[96:99], v[32:47]
  ds_read_b64_tr_b16 v[68:69], v8 offset:4352
  ds_read_b64_tr_b16 v[70:71], v8 offset:6400
  s_waitcnt lgkmcnt(7)
  v_mfma_f32_32x32x16_bf16 v[16:31], v[56:59], v[100:103], v[16:31]
  ds_read_b64_tr_b16 v[72:73], v8 offset:5120
  ds_read_b64_tr_b16 v[74:75], v8 offset:7168
  s_waitcnt lgkmcnt(7)
  v_mfma_f32_32x32x16_bf16 v[32:47], v[60:63], v[100:103], v[32:47]
  ds_read_b64_tr_b16 v[76:77], v8 offset:5376
  ds_read_b64_tr_b16 v[78:79], v8 offset:7424
  s_waitcnt lgkmcnt(6)
  v_mfma_f32_32x32x16_bf16 v[16:31], v[64:67], v[104:107], v[16:31]
  ds_read_b64_tr_b16 v[48:49], v8 offset:8192
  ds_read_b64_tr_b16 v[50:51], v8 offset:10240
  s_waitcnt lgkmcnt(6)
  v_mfma_f32_32x32x16_bf16 v[32:47], v[68:71], v[104:107], v[32:47]
  ds_read_b64_tr_b16 v[52:53], v8 offset:8448
  ds_read_b64_tr_b16 v[54:55], v8 offset:10496
  s_waitcnt lgkmcnt(6)
  v_mfma_f32_32x32x16_bf16 v[16:31], v[72:75], v[108:111], v[16:31]
  ds_read_b64_tr_b16 v[56:57], v8 offset:9216
  ds_read_b64_tr_b16 v[58:59], v8 offset:11264
  s_waitcnt lgkmcnt(6)
  v_mfma_f32_32x32x16_bf16 v[32:47], v[76:79], v[108:111], v[32:47]
  ds_read_b64_tr_b16 v[60:61], v8 offset:9472
  ds_read_b64_tr_b16 v[62:63], v8 offset:11520
  s_waitcnt vmcnt(16)
  s_waitcnt lgkmcnt(6)
  v_mfma_f32_32x32x16_bf16 v[16:31], v[48:51], v[112:115], v[16:31]
  ds_read_b64_tr_b16 v[64:65], v8 offset:12288
  v_bitop3_b32 v81, v128, v129, v130 bitop3:0x80
  ds_read_b64_tr_b16 v[66:67], v8 offset:14336
  v_bitop3_b32 v81, v81, v131, v132 bitop3:0x80
  s_waitcnt lgkmcnt(6)
  v_mfma_f32_32x32x16_bf16 v[32:47], v[52:55], v[112:115], v[32:47]
  ds_read_b64_tr_b16 v[68:69], v8 offset:12544
  v_bitop3_b32 v81, v81, v133, v134 bitop3:0x80
  ds_read_b64_tr_b16 v[70:71], v8 offset:14592
  v_bitop3_b32 v81, v81, v135, v136 bitop3:0x80
  s_waitcnt lgkmcnt(6)
  v_mfma_f32_32x32x16_bf16 v[16:31], v[56:59], v[116:119], v[16:31]
  ds_read_b64_tr_b16 v[72:73], v8 offset:13312
  v_bitop3_b32 v81, v81, v137, v138 bitop3:0x80
  ds_read_b64_tr_b16 v[74:75], v8 offset:15360
  v_bitop3_b32 v81, v81, v139, v140 bitop3:0x80
  s_waitcnt lgkmcnt(6)
  v_mfma_f32_32x32x16_bf16 v[32:47], v[60:63], v[116:119], v[32:47]
  ds_read_b64_tr_b16 v[76:77], v8 offset:13568
  v_bitop3_b32 v81, v81, v141, v142 bitop3:0x80
  ds_read_b64_tr_b16 v[78:79], v8 offset:15616
  v_bitop3_b32 v81, v81, v143, v144 bitop3:0x80
  s_waitcnt lgkmcnt(6)
  v_mfma_f32_32x32x16_bf16 v[16:31], v[64:67], v[120:123], v[16:31]
  ds_read_b64_tr_b16 v[48:49], v8 offset:16384
  v_bitop3_b32 v81, v81, v145, v146 bitop3:0x80
  ds_read_b64_tr_b16 v[50:51], v8 offset:18432
  v_bitop3_b32 v81, v81, v147, v148 bitop3:0x80
  s_waitcnt lgkmcnt(6)
  v_mfma_f32_32x32x16_bf16 v[32:47], v[68:71], v[120:123], v[32:47]
  ds_read_b64_tr_b16 v[52:53], v8 offset:16640
  v_bitop3_b32 v81, v81, v149, v150 bitop3:0x80
  ds_read_b64_tr_b16 v[54:55], v8 offset:18688
  v_bitop3_b32 v81, v81, v151, v152 bitop3:0x80
  s_waitcnt lgkmcnt(6)
  v_mfma_f32_32x32x16_bf16 v[16:31], v[72:75], v[124:127], v[16:31]
  ds_read_b64_tr_b16 v[56:57], v8 offset:17408
  v_bitop3_b32 v81, v81, v153, v154 bitop3:0x80
  ds_read_b64_tr_b16 v[58:59], v8 offset:19456
  v_bitop3_b32 v81, v81, v155, v156 bitop3:0x80
  s_waitcnt lgkmcnt(6)
  v_mfma_f32_32x32x16_bf16 v[32:47], v[76:79], v[124:127], v[32:47]
  ds_read_b64_tr_b16 v[60:61], v8 offset:17664
  v_bitop3_b32 v81, v81, v157, v158 bitop3:0x80
  ds_read_b64_tr_b16 v[62:63], v8 offset:19712
  v_bitop3_b32 v81, v81, v159, 1 bitop3:0x80
  v_cmp_eq_u32 vcc, 0, v81
  s_nop 0
  s_cmp_lg_u64 vcc, 0
  s_cbranch_scc1 K3_retry5
K3_retry5_ret:
  s_waitcnt lgkmcnt(6)
  v_mfma_f32_32x32x16_bf16 v[16:31], v[48:51], v[128:131], v[16:31]
  ds_read_b64_tr_b16 v[64:65], v8 offset:20480
  ds_read_b64_tr_b16 v[66:67], v8 offset:22528
  s_waitcnt lgkmcnt(6)
  v_mfma_f32_32x32x16_bf16 v[32:47], v[52:55], v[128:131], v[32:47]
  ds_read_b64_tr_b16 v[68:69], v8 offset:20736
  ds_read_b64_tr_b16 v[70:71], v8 offset:22784
  s_waitcnt lgkmcnt(6)
  v_mfma_f32_32x32x16_bf16 v[16:31], v[56:59], v[132:135], v[16:31]
  ds_read_b64_tr_b16 v[72:73], v8 offset:21504
  ds_read_b64_tr_b16 v[74:75], v8 offset:23552
  s_waitcnt lgkmcnt(6)
  v_mfma_f32_32x32x16_bf16 v[32:47], v[60:63], v[132:135], v[32:47]
  ds_read_b64_tr_b16 v[76:77], v8 offset:21760
  ds_read_b64_tr_b16 v[78:79], v8 offset:23808
  s_waitcnt lgkmcnt(6)
  v_mfma_f32_32x32x16_bf16 v[16:31], v[64:67], v[136:139], v[16:31]
  ds_read_b64_tr_b16 v[48:49], v8 offset:24576
  ds_read_b64_tr_b16 v[50:51], v8 offset:26624
  s_waitcnt lgkmcnt(6)
  v_mfma_f32_32x32x16_bf16 v[32:47], v[68:71], v[136:139], v[32:47]
  ds_read_b64_tr_b16 v[52:53], v8 offset:24832
  ds_read_b64_tr_b16 v[54:55], v8 offset:26880
  s_waitcnt lgkmcnt(6)
  v_mfma_f32_32x32x16_bf16 v[16:31], v[72:75], v[140:143], v[16:31]
  ds_read_b64_tr_b16 v[56:57], v8 offset:25600
  ds_read_b64_tr_b16 v[58:59], v8 offset:27648
  s_waitcnt lgkmcnt(6)
  v_mfma_f32_32x32x16_bf16 v[32:47], v[76:79], v[140:143], v[32:47]
  ds_read_b64_tr_b16 v[60:61], v8 offset:25856
  ds_read_b64_tr_b16 v[62:63], v8 offset:27904
  s_waitcnt vmcnt(8)
  s_waitcnt lgkmcnt(6)
  v_mfma_f32_32x32x16_bf16 v[16:31], v[48:51], v[144:147], v[16:31]
  ds_read_b64_tr_b16 v[64:65], v8 offset:28672
  v_bitop3_b32 v81, v160, v161, v162 bitop3:0x80
  ds_read_b64_tr_b16 v[66:67], v8 offset:30720
  v_bitop3_b32 v81, v81, v163, v164 bitop3:0x80
  s_waitcnt lgkmcnt(6)
  v_mfma_f32_32x32x16_bf16 v[32:47], v[52:55], v[144:147], v[32:47]
  ds_read_b64_tr_b16 v[68:69], v8 offset:28928
  v_bitop3_b32 v81, v81, v165, v166 bitop3:0x80
  ds_read_b64_tr_b16 v[70:71], v8 offset:30976
  v_bitop3_b32 v81, v81, v167, v168 bitop3:0x80
  s_waitcnt lgkmcnt(6)
  v_mfma_f32_32x32x16_bf16 v[16:31], v[56:59], v[148:151], v[16:31]
  ds_read_b64_tr_b16 v[72:73], v8 offset:29696
  v_bitop3_b32 v81, v81, v169, v170 bitop3:0x80
  ds_read_b64_tr_b16 v[74:75], v8 offset:31744
  v_bitop3_b32 v81, v81, v171, v172 bitop3:0x80
  s_waitcnt lgkmcnt(6)
  v_mfma_f32_32x32x16_bf16 v[32:47], v[60:63], v[148:151], v[32:47]
  ds_read_b64_tr_b16 v[76:77], v8 offset:29952
  v_bitop3_b32 v81, v81, v173, v174 bitop3:0x80
  ds_read_b64_tr_b16 v[78:79], v8 offset:32000
  v_bitop3_b32 v81, v81, v175, v176 bitop3:0x80
  s_waitcnt lgkmcnt(6)
  v_mfma_f32_32x32x16_bf16 v[16:31], v[64:67], v[152:155], v[16:31]
  ds_read_b64_tr_b16 v[48:49], v8 offset:32768
  v_bitop3_b32 v81, v81, v177, v178 bitop3:0x80
  ds_read_b64_tr_b16 v[50:51], v8 offset:34816
  v_bitop3_b32 v81, v81, v179, v180 bitop3:0x80
  s_waitcnt lgkmcnt(6)
  v_mfma_f32_32x32x16_bf16 v[32:47], v[68:71], v[152:155], v[32:47]
  ds_read_b64_tr_b16 v[52:53], v8 offset:33024
  v_bitop3_b32 v81, v81, v181, v182 bitop3:0x80
  ds_read_b64_tr_b16 v[54:55], v8 offset:35072
  v_bitop3_b32 v81, v81, v183, v184 bitop3:0x80
  s_waitcnt lgkmcnt(6)
  v_mfma_f32_32x32x16_bf16 v[16:31], v[72:75], v[156:159], v[16:31]
  ds_read_b64_tr_b16 v[56:57], v8 offset:33792
  v_bitop3_b32 v81, v81, v185, v186 bitop3:0x80
  ds_read_b64_tr_b16 v[58:59], v8 offset:35840
  v_bitop3_b32 v81, v81, v187, v188 bitop3:0x80
  s_waitcnt lgkmcnt(6)
  v_mfma_f32_32x32x16_bf16 v[32:47], v[76:79], v[156:159], v[32:47]
  ds_read_b64_tr_b16 v[60:61], v8 offset:34048
  v_bitop3_b32 v81, v81, v189, v190 bitop3:0x80
  ds_read_b64_tr_b16 v[62:63], v8 offset:36096
  v_bitop3_b32 v81, v81, v191, 1 bitop3:0x80
  v_cmp_eq_u32 vcc, 0, v81
  s_nop 0
  s_cmp_lg_u64 vcc, 0
  s_cbranch_scc1 K3_retry6
K3_retry6_ret:
  s_waitcnt lgkmcnt(6)
  v_mfma_f32_32x32x16_bf16 v[16:31], v[48:51], v[160:163], v[16:31]
  ds_read_b64_tr_b16 v[64:65], v8 offset:36864
  ds_read_b64_tr_b16 v[66:67], v8 offset:38912
  s_waitcnt lgkmcnt(6)
  v_mfma_f32_32x32x16_bf16 v[32:47], v[52:55], v[160:163], v[32:47]
  ds_read_b64_tr_b16 v[68:69], v8 offset:37120
  ds_read_b64_tr_b16 v[70:71], v8 offset:39168
  s_waitcnt lgkmcnt(6)
  v_mfma_f32_32x32x16_bf16 v[16:31], v[56:59], v[164:167], v[16:31]
  ds_read_b64_tr_b16 v[72:73], v8 offset:37888
  ds_read_b64_tr_b16 v[74:75], v8 offset:39936
  s_waitcnt lgkmcnt(6)
  v_mfma_f32_32x32x16_bf16 v[32:47], v[60:63], v[164:167], v[32:47]
  ds_read_b64_tr_b16 v[76:77], v8 offset:38144
  ds_read_b64_tr_b16 v[78:79], v8 offset:40192
  s_waitcnt lgkmcnt(6)
  v_mfma_f32_32x32x16_bf16 v[16:31], v[64:67], v[168:171], v[16:31]
  ds_read_b64_tr_b16 v[48:49], v8 offset:40960
  ds_read_b64_tr_b16 v[50:51], v8 offset:43008
  s_waitcnt lgkmcnt(6)
  v_mfma_f32_32x32x16_bf16 v[32:47], v[68:71], v[168:171], v[32:47]
  ds_read_b64_tr_b16 v[52:53], v8 offset:41216
  ds_read_b64_tr_b16 v[54:55], v8 offset:43264
  s_waitcnt lgkmcnt(6)
  v_mfma_f32_32x32x16_bf16 v[16:31], v[72:75], v[172:175], v[16:31]
  ds_read_b64_tr_b16 v[56:57], v8 offset:41984
  ds_read_b64_tr_b16 v[58:59], v8 offset:44032
  s_waitcnt lgkmcnt(6)
  v_mfma_f32_32x32x16_bf16 v[32:47], v[76:79], v[172:175], v[32:47]
  ds_read_b64_tr_b16 v[60:61], v8 offset:42240
  ds_read_b64_tr_b16 v[62:63], v8 offset:44288
  s_waitcnt vmcnt(0)
  s_waitcnt lgkmcnt(6)
  v_mfma_f32_32x32x16_bf16 v[16:31], v[48:51], v[176:179], v[16:31]
  ds_read_b64_tr_b16 v[64:65], v8 offset:45056
  v_bitop3_b32 v81, v192, v193, v194 bitop3:0x80
  ds_read_b64_tr_b16 v[66:67], v8 offset:47104
  v_bitop3_b32 v81, v81, v195, v196 bitop3:0x80
  s_waitcnt lgkmcnt(6)
  v_mfma_f32_32x32x16_bf16 v[32:47], v[52:55], v[176:179], v[32:47]
  ds_read_b64_tr_b16 v[68:69], v8 offset:45312
  v_bitop3_b32 v81, v81, v197, v198 bitop3:0x80
  ds_read_b64_tr_b16 v[70:71], v8 offset:47360
  v_bitop3_b32 v81, v81, v199, v200 bitop3:0x80
  s_waitcnt lgkmcnt(6)
  v_mfma_f32_32x32x16_bf16 v[16:31], v[56:59], v[180:183], v[16:31]
  ds_read_b64_tr_b16 v[72:73], v8 offset:46080
  v_bitop3_b32 v81, v81, v201, v202 bitop3:0x80
  ds_read_b64_tr_b16 v[74:75], v8 offset:48128
  v_bitop3_b32 v81, v81, v203, v204 bitop3:0x80
  s_waitcnt lgkmcnt(6)
  v_mfma_f32_32x32x16_bf16 v[32:47], v[60:63], v[180:183], v[32:47]
  ds_read_b64_tr_b16 v[76:77], v8 offset:46336
  v_bitop3_b32 v81, v81, v205, v206 bitop3:0x80
  ds_read_b64_tr_b16 v[78:79], v8 offset:48384
  v_bitop3_b32 v81, v81, v207, v208 bitop3:0x80
  s_waitcnt lgkmcnt(0)
  s_mov_b32 s43, 131072
K3_wwt:
  ds_read_b32 v80, v10 offset:52
  s_waitcnt lgkmcnt(0)
  v_readfirstlane_b32 s42, v80
  s_sub_u32 s43, s43, 1
  s_cbranch_scc1 K3_wwt_ok
  s_cmp_lt_u32 s42, 4
  s_cbranch_scc1 K3_wwt
K3_wwt_ok:
  v_mfma_f32_32x32x16_bf16 v[16:31], v[64:67], v[184:187], v[16:31]
  ds_read_b64_tr_b16 v[48:49], v13 offset:0
  v_bitop3_b32 v81, v81, v209, v210 bitop3:0x80
  ds_read_b64_tr_b16 v[50:51], v13 offset:2048
  v_bitop3_b32 v81, v81, v211, v212 bitop3:0x80
  v_mfma_f32_32x32x16_bf16 v[32:47], v[68:71], v[184:187], v[32:47]
  ds_read_b64_tr_b16 v[52:53], v13 offset:256
  v_bitop3_b32 v81, v81, v213, v214 bitop3:0x80
  ds_read_b64_tr_b16 v[54:55], v13 offset:2304
  v_bitop3_b32 v81, v81, v215, v216 bitop3:0x80
  v_mfma_f32_32x32x16_bf16 v[16:31], v[72:75], v[188:191], v[16:31]
  ds_read_b64_tr_b16 v[56:57], v13 offset:1024
  v_bitop3_b32 v81, v81, v217, v218 bitop3:0x80
  ds_read_b64_tr_b16 v[58:59], v13 offset:3072
  v_bitop3_b32 v81, v81, v219, v220 bitop3:0x80
  v_mfma_f32_32x32x16_bf16 v[32:47], v[76:79], v[188:191], v[32:47]
  ds_read_b64_tr_b16 v[60:61], v13 offset:1280
  v_bitop3_b32 v81, v81, v221, v222 bitop3:0x80
  ds_read_b64_tr_b16 v[62:63], v13 offset:3328
  v_bitop3_b32 v81, v81, v223, 1 bitop3:0x80
  v_cmp_eq_u32 vcc, 0, v81
  s_nop 0
  s_cmp_lg_u64 vcc, 0
  s_cbranch_scc1 K3_retry7
K3_retry7_ret:
  s_waitcnt lgkmcnt(6)
  v_mfma_f32_32x32x16_bf16 v[16:31], v[48:51], v[192:195], v[16:31]
  ds_read_b64_tr_b16 v[64:65], v13 offset:8704
  ds_read_b64_tr_b16 v[66:67], v13 offset:10752
  s_waitcnt lgkmcnt(6)
  v_mfma_f32_32x32x16_bf16 v[32:47], v[52:55], v[192:195], v[32:47]
  ds_read_b64_tr_b16 v[68:69], v13 offset:8960
  ds_read_b64_tr_b16 v[70:71], v13 offset:11008
  s_waitcnt lgkmcnt(6)
  v_mfma_f32_32x32x16_bf16 v[16:31], v[56:59], v[196:199], v[16:31]
  ds_read_b64_tr_b16 v[72:73], v13 offset:9728
  ds_read_b64_tr_b16 v[74:75], v13 offset:11776
  s_waitcnt lgkmcnt(6)
  v_mfma_f32_32x32x16_bf16 v[32:47], v[60:63], v[196:199], v[32:47]
  ds_read_b64_tr_b16 v[76:77], v13 offset:9984
  ds_read_b64_tr_b16 v[78:79], v13 offset:12032
  s_waitcnt lgkmcnt(6)
  v_mfma_f32_32x32x16_bf16 v[16:31], v[64:67], v[200:203], v[16:31]
  ds_read_b64_tr_b16 v[48:49], v13 offset:17408
  ds_read_b64_tr_b16 v[50:51], v13 offset:19456
  s_waitcnt lgkmcnt(6)
  v_mfma_f32_32x32x16_bf16 v[32:47], v[68:71], v[200:203], v[32:47]
  ds_read_b64_tr_b16 v[52:53], v13 offset:17664
  ds_read_b64_tr_b16 v[54:55], v13 offset:19712
  s_waitcnt lgkmcnt(6)
  v_mfma_f32_32x32x16_bf16 v[16:31], v[72:75], v[204:207], v[16:31]
  ds_read_b64_tr_b16 v[56:57], v13 offset:18432
  ds_read_b64_tr_b16 v[58:59], v13 offset:20480
  s_waitcnt lgkmcnt(6)
  v_mfma_f32_32x32x16_bf16 v[32:47], v[76:79], v[204:207], v[32:47]
  ds_read_b64_tr_b16 v[60:61], v13 offset:18688
  ds_read_b64_tr_b16 v[62:63], v13 offset:20736
  s_waitcnt lgkmcnt(6)
  v_mfma_f32_32x32x16_bf16 v[16:31], v[48:51], v[208:211], v[16:31]
  ds_read_b64_tr_b16 v[64:65], v13 offset:26112
  ds_read_b64_tr_b16 v[66:67], v13 offset:28160
  s_waitcnt lgkmcnt(6)
  v_mfma_f32_32x32x16_bf16 v[32:47], v[52:55], v[208:211], v[32:47]
  ds_read_b64_tr_b16 v[68:69], v13 offset:26368
  ds_read_b64_tr_b16 v[70:71], v13 offset:28416
  s_waitcnt lgkmcnt(6)
  v_mfma_f32_32x32x16_bf16 v[16:31], v[56:59], v[212:215], v[16:31]
  ds_read_b64_tr_b16 v[72:73], v13 offset:27136
  ds_read_b64_tr_b16 v[74:75], v13 offset:29184
  s_waitcnt lgkmcnt(6)
  v_mfma_f32_32x32x16_bf16 v[32:47], v[60:63], v[212:215], v[32:47]
  ds_read_b64_tr_b16 v[76:77], v13 offset:27392
  ds_read_b64_tr_b16 v[78:79], v13 offset:29440
  s_waitcnt lgkmcnt(6)
  v_mfma_f32_32x32x16_bf16 v[16:31], v[64:67], v[216:219], v[16:31]
  s_waitcnt lgkmcnt(4)
  v_mfma_f32_32x32x16_bf16 v[32:47], v[68:71], v[216:219], v[32:47]
  s_waitcnt lgkmcnt(2)
  v_mfma_f32_32x32x16_bf16 v[16:31], v[72:75], v[220:223], v[16:31]
  s_waitcnt lgkmcnt(0)
  v_mfma_f32_32x32x16_bf16 v[32:47], v[76:79], v[220:223], v[32:47]
  v_and_b32 v4, 31, v2
  v_lshlrev_b32 v4, 12, v4
  v_lshl_add_u32 v4, v5, 4, v4
  s_lshr_b32 s36, s10, 2
  s_lshl_b32 s36, s36, 3
  s_lshr_b32 s37, s11, 2
  s_add_u32 s36, s36, s37
  s_lshl_b32 s38, s41, 16
  s_lshl_b32 s39, s36, 7
  s_add_u32 s38, s38, s39
  s_add_u32 s38, s38, 2048
  v_cvt_pk_bf16_f32 v80, v16, v17
  v_cvt_pk_bf16_f32 v81, v18, v19
  v_cvt_pk_bf16_f32 v82, v20, v21
  v_cvt_pk_bf16_f32 v83, v22, v23
  s_nop 0
  v_permlane32_swap_b32 v80, v82
  v_permlane32_swap_b32 v81, v83
  buffer_store_dwordx4 v[80:83], v4, s[32:35], s38 offen offset:0
  v_cvt_pk_bf16_f32 v84, v24, v25
  v_cvt_pk_bf16_f32 v85, v26, v27
  v_cvt_pk_bf16_f32 v86, v28, v29
  v_cvt_pk_bf16_f32 v87, v30, v31
  s_nop 0
  v_permlane32_swap_b32 v84, v86
  v_permlane32_swap_b32 v85, v87
  buffer_store_dwordx4 v[84:87], v4, s[32:35], s38 offen offset:32
  v_cvt_pk_bf16_f32 v88, v32, v33
  v_cvt_pk_bf16_f32 v89, v34, v35
  v_cvt_pk_bf16_f32 v90, v36, v37
  v_cvt_pk_bf16_f32 v91, v38, v39
  s_nop 0
  v_permlane32_swap_b32 v88, v90
  v_permlane32_swap_b32 v89, v91
  buffer_store_dwordx4 v[88:91], v4, s[32:35], s38 offen offset:64
  v_cvt_pk_bf16_f32 v92, v40, v41
  v_cvt_pk_bf16_f32 v93, v42, v43
  v_cvt_pk_bf16_f32 v94, v44, v45
  v_cvt_pk_bf16_f32 v95, v46, v47
  s_nop 0
  v_permlane32_swap_b32 v92, v94
  v_permlane32_swap_b32 v93, v95
  buffer_store_dwordx4 v[92:95], v4, s[32:35], s38 offen offset:96
  s_endpgm
K3_retry0:
  s_mov_b32 s46, 4000
  s_add_u32 s44, s47, 0
K3_retry0_l:
  s_add_u32 s75, s75, 1
  s_sleep 4
  buffer_load_dwordx4 v[96:99], v12, s[28:31], s44 offen offset:0 sc1
  buffer_load_dwordx4 v[100:103], v12, s[28:31], s44 offen offset:512 sc1
  buffer_load_dwordx4 v[104:107], v12, s[28:31], s44 offen offset:1024 sc1
  buffer_load_dwordx4 v[108:111], v12, s[28:31], s44 offen offset:1536 sc1
  buffer_load_dwordx4 v[112:115], v12, s[28:31], s44 offen offset:2048 sc1
  buffer_load_dwordx4 v[116:119], v12, s[28:31], s44 offen offset:2560 sc1
  buffer_load_dwordx4 v[120:123], v12, s[28:31], s44 offen offset:3072 sc1
  buffer_load_dwordx4 v[124:127], v12, s[28:31], s44 offen offset:3584 sc1
  s_waitcnt vmcnt(0)
  v_bitop3_b32 v81, v96, v97, v98 bitop3:0x80
  v_bitop3_b32 v81, v81, v99, v100 bitop3:0x80
  v_bitop3_b32 v81, v81, v101, v102 bitop3:0x80
  v_bitop3_b32 v81, v81, v103, v104 bitop3:0x80
  v_bitop3_b32 v81, v81, v105, v106 bitop3:0x80
  v_bitop3_b32 v81, v81, v107, v108 bitop3:0x80
  v_bitop3_b32 v81, v81, v109, v110 bitop3:0x80
  v_bitop3_b32 v81, v81, v111, v112 bitop3:0x80
  v_bitop3_b32 v81, v81, v113, v114 bitop3:0x80
  v_bitop3_b32 v81, v81, v115, v116 bitop3:0x80
  v_bitop3_b32 v81, v81, v117, v118 bitop3:0x80
  v_bitop3_b32 v81, v81, v119, v120 bitop3:0x80
  v_bitop3_b32 v81, v81, v121, v122 bitop3:0x80
  v_bitop3_b32 v81, v81, v123, v124 bitop3:0x80
  v_bitop3_b32 v81, v81, v125, v126 bitop3:0x80
  v_bitop3_b32 v81, v81, v127, 1 bitop3:0x80
  v_cmp_eq_u32 vcc, 0, v81
  s_sub_u32 s46, s46, 1
  s_cbranch_scc1 K3_retry0_ret
  s_cmp_lg_u64 vcc, 0
  s_cbranch_scc1 K3_retry0_l
  s_branch K3_retry0_ret
K3_retry1:
  s_mov_b32 s46, 4000
  s_add_u32 s44, s47, 4096
K3_retry1_l:
  s_add_u32 s75, s75, 1
  s_sleep 4
  buffer_load_dwordx4 v[128:131], v12, s[28:31], s44 offen offset:0 sc1
  buffer_load_dwordx4 v[132:135], v12, s[28:31], s44 offen offset:512 sc1
  buffer_load_dwordx4 v[136:139], v12, s[28:31], s44 offen offset:1024 sc1
  buffer_load_dwordx4 v[140:143], v12, s[28:31], s44 offen offset:1536 sc1
  buffer_load_dwordx4 v[144:147], v12, s[28:31], s44 offen offset:2048 sc1
  buffer_load_dwordx4 v[148:151], v12, s[28:31], s44 offen offset:2560 sc1
  buffer_load_dwordx4 v[152:155], v12, s[28:31], s44 offen offset:3072 sc1
  buffer_load_dwordx4 v[156:159], v12, s[28:31], s44 offen offset:3584 sc1
  s_waitcnt vmcnt(0)
  v_bitop3_b32 v81, v128, v129, v130 bitop3:0x80
  v_bitop3_b32 v81, v81, v131, v132 bitop3:0x80
  v_bitop3_b32 v81, v81, v133, v134 bitop3:0x80
  v_bitop3_b32 v81, v81, v135, v136 bitop3:0x80
  v_bitop3_b32 v81, v81, v137, v138 bitop3:0x80
  v_bitop3_b32 v81, v81, v139, v140 bitop3:0x80
  v_bitop3_b32 v81, v81, v141, v142 bitop3:0x80
  v_bitop3_b32 v81, v81, v143, v144 bitop3:0x80
  v_bitop3_b32 v81, v81, v145, v146 bitop3:0x80
  v_bitop3_b32 v81, v81, v147, v148 bitop3:0x80
  v_bitop3_b32 v81, v81, v149, v150 bitop3:0x80
  v_bitop3_b32 v81, v81, v151, v152 bitop3:0x80
  v_bitop3_b32 v81, v81, v153, v154 bitop3:0x80
  v_bitop3_b32 v81, v81, v155, v156 bitop3:0x80
  v_bitop3_b32 v81, v81, v157, v158 bitop3:0x80
  v_bitop3_b32 v81, v81, v159, 1 bitop3:0x80
  v_cmp_eq_u32 vcc, 0, v81
  s_sub_u32 s46, s46, 1
  s_cbranch_scc1 K3_retry1_ret
  s_cmp_lg_u64 vcc, 0
  s_cbranch_scc1 K3_retry1_l
  s_branch K3_retry1_ret
K3_retry2:
  s_mov_b32 s46, 4000
  s_add_u32 s44, s47, 8192
K3_retry2_l:
  s_add_u32 s75, s75, 1
  s_sleep 4
  buffer_load_dwordx4 v[160:163], v12, s[28:31], s44 offen offset:0 sc1
  buffer_load_dwordx4 v[164:167], v12, s[28:31], s44 offen offset:512 sc1
  buffer_load_dwordx4 v[168:171], v12, s[28:31], s44 offen offset:1024 sc1
  buffer_load_dwordx4 v[172:175], v12, s[28:31], s44 offen offset:1536 sc1
  buffer_load_dwordx4 v[176:179], v12, s[28:31], s44 offen offset:2048 sc1
  buffer_load_dwordx4 v[180:183], v12, s[28:31], s44 offen offset:2560 sc1
  buffer_load_dwordx4 v[184:187], v12, s[28:31], s44 offen offset:3072 sc1
  buffer_load_dwordx4 v[188:191], v12, s[28:31], s44 offen offset:3584 sc1
  s_waitcnt vmcnt(0)
  v_bitop3_b32 v81, v160, v161, v162 bitop3:0x80
  v_bitop3_b32 v81, v81, v163, v164 bitop3:0x80
  v_bitop3_b32 v81, v81, v165, v166 bitop3:0x80
  v_bitop3_b32 v81, v81, v167, v168 bitop3:0x80
  v_bitop3_b32 v81, v81, v169, v170 bitop3:0x80
  v_bitop3_b32 v81, v81, v171, v172 bitop3:0x80
  v_bitop3_b32 v81, v81, v173, v174 bitop3:0x80
  v_bitop3_b32 v81, v81, v175, v176 bitop3:0x80
  v_bitop3_b32 v81, v81, v177, v178 bitop3:0x80
  v_bitop3_b32 v81, v81, v179, v180 bitop3:0x80
  v_bitop3_b32 v81, v81, v181, v182 bitop3:0x80
  v_bitop3_b32 v81, v81, v183, v184 bitop3:0x80
  v_bitop3_b32 v81, v81, v185, v186 bitop3:0x80
  v_bitop3_b32 v81, v81, v187, v188 bitop3:0x80
  v_bitop3_b32 v81, v81, v189, v190 bitop3:0x80
  v_bitop3_b32 v81, v81, v191, 1 bitop3:0x80
  v_cmp_eq_u32 vcc, 0, v81
  s_sub_u32 s46, s46, 1
  s_cbranch_scc1 K3_retry2_ret
  s_cmp_lg_u64 vcc, 0
  s_cbranch_scc1 K3_retry2_l
  s_branch K3_retry2_ret
K3_retry3:
  s_mov_b32 s46, 4000
  s_add_u32 s44, s47, 12288
K3_retry3_l:
  s_add_u32 s75, s75, 1
  s_sleep 4
  buffer_load_dwordx4 v[192:195], v12, s[28:31], s44 offen offset:0 sc1
  buffer_load_dwordx4 v[196:199], v12, s[28:31], s44 offen offset:512 sc1
  buffer_load_dwordx4 v[200:203], v12, s[28:31], s44 offen offset:1024 sc1
  buffer_load_dwordx4 v[204:207], v12, s[28:31], s44 offen offset:1536 sc1
  buffer_load_dwordx4 v[208:211], v12, s[28:31], s44 offen offset:2048 sc1
  buffer_load_dwordx4 v[212:215], v12, s[28:31], s44 offen offset:2560 sc1
  buffer_load_dwordx4 v[216:219], v12, s[28:31], s44 offen offset:3072 sc1
  buffer_load_dwordx4 v[220:223], v12, s[28:31], s44 offen offset:3584 sc1
  s_waitcnt vmcnt(0)
  v_bitop3_b32 v81, v192, v193, v194 bitop3:0x80
  v_bitop3_b32 v81, v81, v195, v196 bitop3:0x80
  v_bitop3_b32 v81, v81, v197, v198 bitop3:0x80
  v_bitop3_b32 v81, v81, v199, v200 bitop3:0x80
  v_bitop3_b32 v81, v81, v201, v202 bitop3:0x80
  v_bitop3_b32 v81, v81, v203, v204 bitop3:0x80
  v_bitop3_b32 v81, v81, v205, v206 bitop3:0x80
  v_bitop3_b32 v81, v81, v207, v208 bitop3:0x80
  v_bitop3_b32 v81, v81, v209, v210 bitop3:0x80
  v_bitop3_b32 v81, v81, v211, v212 bitop3:0x80
  v_bitop3_b32 v81, v81, v213, v214 bitop3:0x80
  v_bitop3_b32 v81, v81, v215, v216 bitop3:0x80
  v_bitop3_b32 v81, v81, v217, v218 bitop3:0x80
  v_bitop3_b32 v81, v81, v219, v220 bitop3:0x80
  v_bitop3_b32 v81, v81, v221, v222 bitop3:0x80
  v_bitop3_b32 v81, v81, v223, 1 bitop3:0x80
  v_cmp_eq_u32 vcc, 0, v81
  s_sub_u32 s46, s46, 1
  s_cbranch_scc1 K3_retry3_ret
  s_cmp_lg_u64 vcc, 0
  s_cbranch_scc1 K3_retry3_l
  s_branch K3_retry3_ret
K3_retry4:
  s_mov_b32 s46, 4000
  s_add_u32 s44, s47, 16384
K3_retry4_l:
  s_add_u32 s75, s75, 1
  s_sleep 4
  buffer_load_dwordx4 v[96:99], v12, s[28:31], s44 offen offset:0 sc1
  buffer_load_dwordx4 v[100:103], v12, s[28:31], s44 offen offset:512 sc1
  buffer_load_dwordx4 v[104:107], v12, s[28:31], s44 offen offset:1024 sc1
  buffer_load_dwordx4 v[108:111], v12, s[28:31], s44 offen offset:1536 sc1
  buffer_load_dwordx4 v[112:115], v12, s[28:31], s44 offen offset:2048 sc1
  buffer_load_dwordx4 v[116:119], v12, s[28:31], s44 offen offset:2560 sc1
  buffer_load_dwordx4 v[120:123], v12, s[28:31], s44 offen offset:3072 sc1
  buffer_load_dwordx4 v[124:127], v12, s[28:31], s44 offen offset:3584 sc1
  s_waitcnt vmcnt(0)
  v_bitop3_b32 v81, v96, v97, v98 bitop3:0x80
  v_bitop3_b32 v81, v81, v99, v100 bitop3:0x80
  v_bitop3_b32 v81, v81, v101, v102 bitop3:0x80
  v_bitop3_b32 v81, v81, v103, v104 bitop3:0x80
  v_bitop3_b32 v81, v81, v105, v106 bitop3:0x80
  v_bitop3_b32 v81, v81, v107, v108 bitop3:0x80
  v_bitop3_b32 v81, v81, v109, v110 bitop3:0x80
  v_bitop3_b32 v81, v81, v111, v112 bitop3:0x80
  v_bitop3_b32 v81, v81, v113, v114 bitop3:0x80
  v_bitop3_b32 v81, v81, v115, v116 bitop3:0x80
  v_bitop3_b32 v81, v81, v117, v118 bitop3:0x80
  v_bitop3_b32 v81, v81, v119, v120 bitop3:0x80
  v_bitop3_b32 v81, v81, v121, v122 bitop3:0x80
  v_bitop3_b32 v81, v81, v123, v124 bitop3:0x80
  v_bitop3_b32 v81, v81, v125, v126 bitop3:0x80
  v_bitop3_b32 v81, v81, v127, 1 bitop3:0x80
  v_cmp_eq_u32 vcc, 0, v81
  s_sub_u32 s46, s46, 1
  s_cbranch_scc1 K3_retry4_ret
  s_cmp_lg_u64 vcc, 0
  s_cbranch_scc1 K3_retry4_l
  s_branch K3_retry4_ret
K3_retry5:
  s_mov_b32 s46, 4000
  s_add_u32 s44, s47, 20480
K3_retry5_l:
  s_add_u32 s75, s75, 1
  s_sleep 4
  buffer_load_dwordx4 v[128:131], v12, s[28:31], s44 offen offset:0 sc1
  buffer_load_dwordx4 v[132:135], v12, s[28:31], s44 offen offset:512 sc1
  buffer_load_dwordx4 v[136:139], v12, s[28:31], s44 offen offset:1024 sc1
  buffer_load_dwordx4 v[140:143], v12, s[28:31], s44 offen offset:1536 sc1
  buffer_load_dwordx4 v[144:147], v12, s[28:31], s44 offen offset:2048 sc1
  buffer_load_dwordx4 v[148:151], v12, s[28:31], s44 offen offset:2560 sc1
  buffer_load_dwordx4 v[152:155], v12, s[28:31], s44 offen offset:3072 sc1
  buffer_load_dwordx4 v[156:159], v12, s[28:31], s44 offen offset:3584 sc1
  s_waitcnt vmcnt(0)
  v_bitop3_b32 v81, v128, v129, v130 bitop3:0x80
  v_bitop3_b32 v81, v81, v131, v132 bitop3:0x80
  v_bitop3_b32 v81, v81, v133, v134 bitop3:0x80
  v_bitop3_b32 v81, v81, v135, v136 bitop3:0x80
  v_bitop3_b32 v81, v81, v137, v138 bitop3:0x80
  v_bitop3_b32 v81, v81, v139, v140 bitop3:0x80
  v_bitop3_b32 v81, v81, v141, v142 bitop3:0x80
  v_bitop3_b32 v81, v81, v143, v144 bitop3:0x80
  v_bitop3_b32 v81, v81, v145, v146 bitop3:0x80
  v_bitop3_b32 v81, v81, v147, v148 bitop3:0x80
  v_bitop3_b32 v81, v81, v149, v150 bitop3:0x80
  v_bitop3_b32 v81, v81, v151, v152 bitop3:0x80
  v_bitop3_b32 v81, v81, v153, v154 bitop3:0x80
  v_bitop3_b32 v81, v81, v155, v156 bitop3:0x80
  v_bitop3_b32 v81, v81, v157, v158 bitop3:0x80
  v_bitop3_b32 v81, v81, v159, 1 bitop3:0x80
  v_cmp_eq_u32 vcc, 0, v81
  s_sub_u32 s46, s46, 1
  s_cbranch_scc1 K3_retry5_ret
  s_cmp_lg_u64 vcc, 0
  s_cbranch_scc1 K3_retry5_l
  s_branch K3_retry5_ret
K3_retry6:
  s_mov_b32 s46, 4000
  s_add_u32 s44, s47, 24576
K3_retry6_l:
  s_add_u32 s75, s75, 1
  s_sleep 4
  buffer_load_dwordx4 v[160:163], v12, s[28:31], s44 offen offset:0 sc1
  buffer_load_dwordx4 v[164:167], v12, s[28:31], s44 offen offset:512 sc1
  buffer_load_dwordx4 v[168:171], v12, s[28:31], s44 offen offset:1024 sc1
  buffer_load_dwordx4 v[172:175], v12, s[28:31], s44 offen offset:1536 sc1
  buffer_load_dwordx4 v[176:179], v12, s[28:31], s44 offen offset:2048 sc1
  buffer_load_dwordx4 v[180:183], v12, s[28:31], s44 offen offset:2560 sc1
  buffer_load_dwordx4 v[184:187], v12, s[28:31], s44 offen offset:3072 sc1
  buffer_load_dwordx4 v[188:191], v12, s[28:31], s44 offen offset:3584 sc1
  s_waitcnt vmcnt(0)
  v_bitop3_b32 v81, v160, v161, v162 bitop3:0x80
  v_bitop3_b32 v81, v81, v163, v164 bitop3:0x80
  v_bitop3_b32 v81, v81, v165, v166 bitop3:0x80
  v_bitop3_b32 v81, v81, v167, v168 bitop3:0x80
  v_bitop3_b32 v81, v81, v169, v170 bitop3:0x80
  v_bitop3_b32 v81, v81, v171, v172 bitop3:0x80
  v_bitop3_b32 v81, v81, v173, v174 bitop3:0x80
  v_bitop3_b32 v81, v81, v175, v176 bitop3:0x80
  v_bitop3_b32 v81, v81, v177, v178 bitop3:0x80
  v_bitop3_b32 v81, v81, v179, v180 bitop3:0x80
  v_bitop3_b32 v81, v81, v181, v182 bitop3:0x80
  v_bitop3_b32 v81, v81, v183, v184 bitop3:0x80
  v_bitop3_b32 v81, v81, v185, v186 bitop3:0x80
  v_bitop3_b32 v81, v81, v187, v188 bitop3:0x80
  v_bitop3_b32 v81, v81, v189, v190 bitop3:0x80
  v_bitop3_b32 v81, v81, v191, 1 bitop3:0x80
  v_cmp_eq_u32 vcc, 0, v81
  s_sub_u32 s46, s46, 1
  s_cbranch_scc1 K3_retry6_ret
  s_cmp_lg_u64 vcc, 0
  s_cbranch_scc1 K3_retry6_l
  s_branch K3_retry6_ret
K3_retry7:
  s_mov_b32 s46, 4000
  s_add_u32 s44, s47, 28672
K3_retry7_l:
  s_add_u32 s75, s75, 1
  s_sleep 4
  buffer_load_dwordx4 v[192:195], v12, s[28:31], s44 offen offset:0 sc1
  buffer_load_dwordx4 v[196:199], v12, s[28:31], s44 offen offset:512 sc1
  buffer_load_dwordx4 v[200:203], v12, s[28:31], s44 offen offset:1024 sc1
  buffer_load_dwordx4 v[204:207], v12, s[28:31], s44 offen offset:1536 sc1
  buffer_load_dwordx4 v[208:211], v12, s[28:31], s44 offen offset:2048 sc1
  buffer_load_dwordx4 v[212:215], v12, s[28:31], s44 offen offset:2560 sc1
  buffer_load_dwordx4 v[216:219], v12, s[28:31], s44 offen offset:3072 sc1
  buffer_load_dwordx4 v[220:223], v12, s[28:31], s44 offen offset:3584 sc1
  s_waitcnt vmcnt(0)
  v_bitop3_b32 v81, v192, v193, v194 bitop3:0x80
  v_bitop3_b32 v81, v81, v195, v196 bitop3:0x80
  v_bitop3_b32 v81, v81, v197, v198 bitop3:0x80
  v_bitop3_b32 v81, v81, v199, v200 bitop3:0x80
  v_bitop3_b32 v81, v81, v201, v202 bitop3:0x80
  v_bitop3_b32 v81, v81, v203, v204 bitop3:0x80
  v_bitop3_b32 v81, v81, v205, v206 bitop3:0x80
  v_bitop3_b32 v81, v81, v207, v208 bitop3:0x80
  v_bitop3_b32 v81, v81, v209, v210 bitop3:0x80
  v_bitop3_b32 v81, v81, v211, v212 bitop3:0x80
  v_bitop3_b32 v81, v81, v213, v214 bitop3:0x80
  v_bitop3_b32 v81, v81, v215, v216 bitop3:0x80
  v_bitop3_b32 v81, v81, v217, v218 bitop3:0x80
  v_bitop3_b32 v81, v81, v219, v220 bitop3:0x80
  v_bitop3_b32 v81, v81, v221, v222 bitop3:0x80
  v_bitop3_b32 v81, v81, v223, 1 bitop3:0x80
  v_cmp_eq_u32 vcc, 0, v81
  s_sub_u32 s46, s46, 1
  s_cbranch_scc1 K3_retry7_ret
  s_cmp_lg_u64 vcc, 0
  s_cbranch_scc1 K3_retry7_l
  s_branch K3_retry7_ret
K3_event0:
  s_add_u32 s54, s54, 1
  s_cmp_lg_u32 s54, 1
  s_cbranch_scc1 K3_ev2_0
  buffer_load_dword v195, v192, s[40:43], s44 offen
  s_mov_b32 s55, s52
  s_branch K3_noev0
K3_ev2_0:
  buffer_load_dword v195, v193, s[48:51], s45 offen
  s_mov_b32 s55, 1000
  s_branch K3_noev0
K3_evB0:
  buffer_load_dword v195, v194, s[64:67], s68 offen
  buffer_load_dword v195, v194, s[64:67], s69 offen
  s_branch K3_noevB0
K3_evC0:
  s_add_u32 s53, s53, 1
  s_cmp_lg_u32 s53, 1
  s_cbranch_scc1 K3_ev4_0
  buffer_load_dword v196, v199, s[56:59], 0 offen sc1
  s_mov_b32 s71, 3
  s_branch K3_noevC0
K3_ev4_0:
  s_cmp_lg_u32 s53, 2
  s_cbranch_scc1 K3_ev6_0
  s_waitcnt vmcnt(0)
  v_readfirstlane_b32 s46, v196
  s_mov_b64 exec, 1
  s_cmp_lg_u32 s46, 0
  s_cbranch_scc1 K3_ev5_0
  v_mov_b32 v196, v198
  v_mov_b32 v197, 0
  buffer_atomic_cmpswap v[196:197], v199, s[56:59], 0 offen sc0 sc1
  s_waitcnt vmcnt(0)
  v_cmp_eq_u32 vcc, 0, v196
  s_nop 1
  v_cndmask_b32 v196, v196, v198, vcc
K3_ev5_0:
  buffer_store_dword v196, v199, s[60:63], s47 offen sc1
  s_mov_b64 exec, -1
  s_mov_b32 s71, 0
  s_branch K3_noevC0
K3_ev6_0:
  s_mov_b64 exec, 1
  buffer_store_dword v196, v199, s[60:63], s47 offen offset:32 sc1
  s_mov_b64 exec, -1
  s_mov_b32 s71, 1000
  s_branch K3_noevC0
K3_event1:
  s_add_u32 s54, s54, 1
  s_cmp_lg_u32 s54, 1
  s_cbranch_scc1 K3_ev2_1
  buffer_load_dword v195, v192, s[40:43], s44 offen
  s_mov_b32 s55, s52
  s_branch K3_noev1
K3_ev2_1:
  buffer_load_dword v195, v193, s[48:51], s45 offen
  s_mov_b32 s55, 1000
  s_branch K3_noev1
K3_evB1:
  buffer_load_dword v195, v194, s[64:67], s68 offen
  buffer_load_dword v195, v194, s[64:67], s69 offen
  s_branch K3_noevB1
K3_evC1:
  s_add_u32 s53, s53, 1
  s_cmp_lg_u32 s53, 1
  s_cbranch_scc1 K3_ev4_1
  buffer_load_dword v196, v199, s[56:59], 0 offen sc1
  s_mov_b32 s71, 3
  s_branch K3_noevC1
K3_ev4_1:
  s_cmp_lg_u32 s53, 2
  s_cbranch_scc1 K3_ev6_1
  s_waitcnt vmcnt(0)
  v_readfirstlane_b32 s46, v196
  s_mov_b64 exec, 1
  s_cmp_lg_u32 s46, 0
  s_cbranch_scc1 K3_ev5_1
  v_mov_b32 v196, v198
  v_mov_b32 v197, 0
  buffer_atomic_cmpswap v[196:197], v199, s[56:59], 0 offen sc0 sc1
  s_waitcnt vmcnt(0)
  v_cmp_eq_u32 vcc, 0, v196
  s_nop 1
  v_cndmask_b32 v196, v196, v198, vcc
K3_ev5_1:
  buffer_store_dword v196, v199, s[60:63], s47 offen sc1
  s_mov_b64 exec, -1
  s_mov_b32 s71, 0
  s_branch K3_noevC1
K3_ev6_1:
  s_mov_b64 exec, 1
  buffer_store_dword v196, v199, s[60:63], s47 offen offset:32 sc1
  s_mov_b64 exec, -1
  s_mov_b32 s71, 1000
  s_branch K3_noevC1
K3_event2:
  s_add_u32 s54, s54, 1
  s_cmp_lg_u32 s54, 1
  s_cbranch_scc1 K3_ev2_2
  buffer_load_dword v195, v192, s[40:43], s44 offen
  s_mov_b32 s55, s52
  s_branch K3_noev2
K3_ev2_2:
  buffer_load_dword v195, v193, s[48:51], s45 offen
  s_mov_b32 s55, 1000
  s_branch K3_noev2
K3_evB2:
  buffer_load_dword v195, v194, s[64:67], s68 offen
  buffer_load_dword v195, v194, s[64:67], s69 offen
  s_branch K3_noevB2
K3_evC2:
  s_add_u32 s53, s53, 1
  s_cmp_lg_u32 s53, 1
  s_cbranch_scc1 K3_ev4_2
  buffer_load_dword v196, v199, s[56:59], 0 offen sc1
  s_mov_b32 s71, 3
  s_branch K3_noevC2
K3_ev4_2:
  s_cmp_lg_u32 s53, 2
  s_cbranch_scc1 K3_ev6_2
  s_waitcnt vmcnt(0)
  v_readfirstlane_b32 s46, v196
  s_mov_b64 exec, 1
  s_cmp_lg_u32 s46, 0
  s_cbranch_scc1 K3_ev5_2
  v_mov_b32 v196, v198
  v_mov_b32 v197, 0
  buffer_atomic_cmpswap v[196:197], v199, s[56:59], 0 offen sc0 sc1
  s_waitcnt vmcnt(0)
  v_cmp_eq_u32 vcc, 0, v196
  s_nop 1
  v_cndmask_b32 v196, v196, v198, vcc
K3_ev5_2:
  buffer_store_dword v196, v199, s[60:63], s47 offen sc1
  s_mov_b64 exec, -1
  s_mov_b32 s71, 0
  s_branch K3_noevC2
K3_ev6_2:
  s_mov_b64 exec, 1
  buffer_store_dword v196, v199, s[60:63], s47 offen offset:32 sc1
  s_mov_b64 exec, -1
  s_mov_b32 s71, 1000
  s_branch K3_noevC2
K3_event3:
  s_add_u32 s54, s54, 1
  s_cmp_lg_u32 s54, 1
  s_cbranch_scc1 K3_ev2_3
  buffer_load_dword v195, v192, s[40:43], s44 offen
  s_mov_b32 s55, s52
  s_branch K3_noev3
K3_ev2_3:
  buffer_load_dword v195, v193, s[48:51], s45 offen
  s_mov_b32 s55, 1000
  s_branch K3_noev3
K3_evB3:
  buffer_load_dword v195, v194, s[64:67], s68 offen
  buffer_load_dword v195, v194, s[64:67], s69 offen
  s_branch K3_noevB3
K3_evC3:
  s_add_u32 s53, s53, 1
  s_cmp_lg_u32 s53, 1
  s_cbranch_scc1 K3_ev4_3
  buffer_load_dword v196, v199, s[56:59], 0 offen sc1
  s_mov_b32 s71, 3
  s_branch K3_noevC3
K3_ev4_3:
  s_cmp_lg_u32 s53, 2
  s_cbranch_scc1 K3_ev6_3
  s_waitcnt vmcnt(0)
  v_readfirstlane_b32 s46, v196
  s_mov_b64 exec, 1
  s_cmp_lg_u32 s46, 0
  s_cbranch_scc1 K3_ev5_3
  v_mov_b32 v196, v198
  v_mov_b32 v197, 0
  buffer_atomic_cmpswap v[196:197], v199, s[56:59], 0 offen sc0 sc1
  s_waitcnt vmcnt(0)
  v_cmp_eq_u32 vcc, 0, v196
  s_nop 1
  v_cndmask_b32 v196, v196, v198, vcc
K3_ev5_3:
  buffer_store_dword v196, v199, s[60:63], s47 offen sc1
  s_mov_b64 exec, -1
  s_mov_b32 s71, 0
  s_branch K3_noevC3
K3_ev6_3:
  s_mov_b64 exec, 1
  buffer_store_dword v196, v199, s[60:63], s47 offen offset:32 sc1
  s_mov_b64 exec, -1
  s_mov_b32 s71, 1000
  s_branch K3_noevC3
K3_L:
  v_lshrrev_b32 v4, 3, v2
  v_and_b32 v5, 7, v2
  v_add_u32 v6, 0, v14
  v_xor_b32 v6, v6, v5
  v_lshlrev_b32 v6, 4, v6
  v_lshl_add_u32 v6, v4, 11, v6
  v_add_u32 v240, 0, v6
  v_add_u32 v6, 4, v14
  v_xor_b32 v6, v6, v5
  v_lshlrev_b32 v6, 4, v6
  v_lshl_add_u32 v6, v4, 11, v6
  v_add_u32 v241, 15360, v6
  v_add_u32 v6, 0, v14
  v_xor_b32 v6, v6, v5
  v_lshlrev_b32 v6, 4, v6
  v_lshl_add_u32 v6, v4, 11, v6
  v_add_u32 v242, 30720, v6
  v_add_u32 v6, 4, v14
  v_xor_b32 v6, v6, v5
  v_lshlrev_b32 v6, 4, v6
  v_lshl_add_u32 v6, v4, 11, v6
  v_add_u32 v243, 46080, v6
  v_lshrrev_b32 v6, 5, v2
  v_bfe_u32 v7, v2, 2, 2
  v_lshl_add_u32 v6, v6, 2, v7
  v_mul_u32_u24 v6, 6144, v6
  v_bfe_u32 v7, v2, 4, 1
  v_lshl_add_u32 v6, v7, 6, v6
  v_and_b32 v7, 3, v2
  v_lshl_add_u32 v6, v7, 4, v6
  v_xor_b32 v7, 32, v6
  s_and_b32 s40, s13, 1
  s_lshl_b32 s40, s40, 7
  s_xor_b32 s41, s40, 128
  v_add_u32 v244, 0, v6
  v_add_u32 v244, s41, v244
  v_add_u32 v245, 48128, v7
  v_add_u32 v245, s41, v245
  v_add_u32 v246, 0, v6
  v_add_u32 v246, s40, v246
  v_add_u32 v247, 48128, v7
  v_add_u32 v247, s40, v247
  v_add_u32 v248, 4096, v6
  v_add_u32 v248, s40, v248
  v_add_u32 v249, 52224, v7
  v_add_u32 v249, s40, v249
  s_lshl_b32 s38, s12, 7
  s_lshl_b32 s40, s4, 5
  s_add_u32 s38, s38, s40
  s_lshl_b32 s38, s38, 11
  s_mul_i32 s39, s4, 98304
  s_lshr_b32 s40, s13, 1
  s_lshl_b32 s40, s40, 8
  s_add_u32 s39, s39, s40
  s_lshl_b32 s41, s4, 12
  s_mul_i32 s42, s4, 6144
  s_add_u32 s42, s42, 16384
  s_mov_b32 s16, s88
  s_mov_b32 s17, s89
  s_mov_b32 s18, 4194304
  s_mov_b32 s19, 0x20000
  s_mov_b32 s20, s90
  s_mov_b32 s21, s91
  s_mov_b32 s22, 6291456
  s_mov_b32 s23, 0x20000
  s_add_u32 m0, s41, 0
  s_nop 0
  buffer_load_dwordx4 v240, s[16:19], s38 offen offset:0 lds
  buffer_load_dwordx4 v241, s[16:19], s38 offen offset:1024 lds
  buffer_load_dwordx4 v242, s[16:19], s38 offen offset:2048 lds
  buffer_load_dwordx4 v243, s[16:19], s38 offen offset:3072 lds
  s_add_u32 m0, s42, 0
  s_nop 0
  buffer_load_dwordx4 v244, s[20:23], s39 offen offset:0 lds
  buffer_load_dwordx4 v245, s[20:23], s39 offen offset:1024 lds
  buffer_load_dwordx4 v246, s[20:23], s39 offen offset:2048 lds
  buffer_load_dwordx4 v247, s[20:23], s39 offen offset:3072 lds
  s_add_u32 m0, s42, 4096
  s_nop 0
  buffer_load_dwordx4 v248, s[20:23], s39 offen offset:0 lds
  buffer_load_dwordx4 v249, s[20:23], s39 offen offset:1024 lds
  s_add_u32 s38, s38, 128
  s_add_u32 s39, s39, 393216
  s_add_u32 m0, s41, 40960
  s_nop 0
  buffer_load_dwordx4 v240, s[16:19], s38 offen offset:0 lds
  buffer_load_dwordx4 v241, s[16:19], s38 offen offset:1024 lds
  buffer_load_dwordx4 v242, s[16:19], s38 offen offset:2048 lds
  buffer_load_dwordx4 v243, s[16:19], s38 offen offset:3072 lds
  s_add_u32 m0, s42, 40960
  s_nop 0
  buffer_load_dwordx4 v244, s[20:23], s39 offen offset:0 lds
  buffer_load_dwordx4 v245, s[20:23], s39 offen offset:1024 lds
  buffer_load_dwordx4 v246, s[20:23], s39 offen offset:2048 lds
  buffer_load_dwordx4 v247, s[20:23], s39 offen offset:3072 lds
  s_add_u32 m0, s42, 45056
  s_nop 0
  buffer_load_dwordx4 v248, s[20:23], s39 offen offset:0 lds
  buffer_load_dwordx4 v249, s[20:23], s39 offen offset:1024 lds
  s_add_u32 s38, s38, 128
  s_add_u32 s39, s39, 393216
  s_add_u32 m0, s41, 81920
  s_nop 0
  buffer_load_dwordx4 v240, s[16:19], s38 offen offset:0 lds
  buffer_load_dwordx4 v241, s[16:19], s38 offen offset:1024 lds
  buffer_load_dwordx4 v242, s[16:19], s38 offen offset:2048 lds
  buffer_load_dwordx4 v243, s[16:19], s38 offen offset:3072 lds
  s_add_u32 m0, s42, 81920
  s_nop 0
  buffer_load_dwordx4 v244, s[20:23], s39 offen offset:0 lds
  buffer_load_dwordx4 v245, s[20:23], s39 offen offset:1024 lds
  buffer_load_dwordx4 v246, s[20:23], s39 offen offset:2048 lds
  buffer_load_dwordx4 v247, s[20:23], s39 offen offset:3072 lds
  s_add_u32 m0, s42, 86016
  s_nop 0
  buffer_load_dwordx4 v248, s[20:23], s39 offen offset:0 lds
  buffer_load_dwordx4 v249, s[20:23], s39 offen offset:1024 lds
  s_add_u32 s38, s38, 128
  s_add_u32 s39, s39, 393216
  s_mov_b32 s24, s78
  s_mov_b32 s25, s79
  s_mov_b32 s26, 4194304
  s_mov_b32 s27, 0x20000
  s_mov_b32 s28, s80
  s_mov_b32 s29, s81
  s_mov_b32 s30, 4194304
  s_mov_b32 s31, 0x20000
  s_mov_b32 s32, s82
  s_mov_b32 s33, s83
  s_mov_b32 s34, 8192
  s_mov_b32 s35, 0x20000
  s_add_u32 s44, s98, 16777216
  s_addc_u32 s45, s99, 0
  s_mov_b32 s46, 4194304
  s_mov_b32 s47, 0x20000
  s_add_u32 s48, s98, 0
  s_addc_u32 s49, s99, 0
  s_mov_b32 s50, 4194304
  s_mov_b32 s51, 0x20000
  s_add_u32 s52, s98, 8388608
  s_addc_u32 s53, s99, 0
  s_mov_b32 s54, 2097152
  s_mov_b32 s55, 0x20000
  s_add_u32 s56, s98, 12582912
  s_addc_u32 s57, s99, 0
  s_mov_b32 s58, 65536
  s_mov_b32 s59, 0x20000
  s_lshl_b32 s60, s2, 2
  s_add_u32 s60, s60, s4
  s_and_b32 s61, s60, 15
  s_lshr_b32 s60, s60, 4
  s_lshl_b32 s62, s60, 16
  s_lshl_b32 s63, s61, 7
  s_add_u32 s62, s62, s63
  v_lshlrev_b32 v21, 14, v14
  v_lshl_add_u32 v21, v15, 3, v21
  v_add_u32 v21, s62, v21
  s_lshl_b32 s63, s61, 9
  v_lshlrev_b32 v22, 5, v15
  s_lshl_b32 s62, s61, 18
  s_lshl_b32 s64, s60, 6
  s_add_u32 s62, s62, s64
  v_lshlrev_b32 v19, 14, v15
  v_lshl_add_u32 v19, v14, 4, v19
  s_lshl_b32 s64, s12, 3
  s_lshl_b32 s65, s4, 1
  s_add_u32 s64, s64, s65
  s_lshl_b32 s64, s64, 15
  s_lshr_b32 s65, s15, 1
  s_lshl_b32 s65, s65, 11
  s_add_u32 s64, s64, s65
  s_add_u32 s65, s64, 32768
  s_lshl_b32 s66, s5, 4
  s_add_u32 s66, s66, s12
  s_lshl_b32 s67, s66, 7
  s_lshl_b32 s66, s66, 12
  s_lshl_b32 s68, s36, 10
  s_add_u32 s66, s66, s68
  v_mov_b32 v160, 0
  v_mov_b32 v161, 0
  v_mov_b32 v162, 0
  v_mov_b32 v163, 0
  v_and_b32 v18, 7, v2
  v_lshlrev_b32 v18, 4, v18
  v_lshrrev_b32 v6, 5, v2
  v_bfe_u32 v7, v2, 2, 2
  v_lshl_add_u32 v7, v6, 2, v7
  v_lshlrev_b32 v7, 11, v7
  v_bfe_u32 v8, v2, 4, 1
  v_lshl_add_u32 v7, v8, 6, v7
  v_and_b32 v8, 3, v2
  v_lshlrev_b32 v6, 1, v6
  v_xor_b32 v8, v8, v6
  v_lshl_add_u32 v7, v8, 4, v7
  v_add_u32 v232, 0, v7
  v_add_u32 v233, 15360, v7
  v_add_u32 v234, 30720, v7
  v_add_u32 v235, 46080, v7
  s_lshl_b32 s69, s4, 16
  s_lshr_b32 s70, s10, 2
  s_lshl_b32 s70, s70, 3
  s_lshr_b32 s71, s11, 2
  s_add_u32 s70, s70, s71
  s_lshl_b32 s70, s70, 7
  s_add_u32 s69, s69, s70
  s_lshl_b32 s70, s4, 12
  s_add_u32 s70, s70, 40960
  s_lshl_b32 s71, s6, 12
  v_mov_b32 v10, 38912
  v_mov_b32 v11, 1
  s_lshl_b32 s43, s4, 2
  v_add_u32 v9, s43, v10
  s_waitcnt vmcnt(20)
  s_barrier
  s_add_u32 m0, s41, 122880
  s_nop 0
  buffer_load_dwordx4 v240, s[16:19], s38 offen offset:0 lds
  buffer_load_dwordx4 v241, s[16:19], s38 offen offset:1024 lds
  buffer_load_dwordx4 v242, s[16:19], s38 offen offset:2048 lds
  buffer_load_dwordx4 v243, s[16:19], s38 offen offset:3072 lds
  s_add_u32 m0, s42, 122880
  s_nop 0
  buffer_load_dwordx4 v244, s[20:23], s39 offen offset:0 lds
  buffer_load_dwordx4 v245, s[20:23], s39 offen offset:1024 lds
  buffer_load_dwordx4 v246, s[20:23], s39 offen offset:2048 lds
  buffer_load_dwordx4 v247, s[20:23], s39 offen offset:3072 lds
  s_add_u32 m0, s42, 126976
  s_nop 0
  buffer_load_dwordx4 v248, s[20:23], s39 offen offset:0 lds
  buffer_load_dwordx4 v249, s[20:23], s39 offen offset:1024 lds
  s_add_u32 s38, s38, 128
  s_add_u32 s39, s39, 393216
  buffer_store_dwordx4 v[160:163], v3, s[48:51], s64 offen sc1
  s_waitcnt vmcnt(21)
  s_barrier
  s_add_u32 m0, s41, 0
  s_nop 0
  buffer_load_dwordx4 v240, s[16:19], s38 offen offset:0 lds
  buffer_load_dwordx4 v241, s[16:19], s38 offen offset:1024 lds
  buffer_load_dwordx4 v242, s[16:19], s38 offen offset:2048 lds
  buffer_load_dwordx4 v243, s[16:19], s38 offen offset:3072 lds
  s_add_u32 m0, s42, 0
  s_nop 0
  buffer_load_dwordx4 v244, s[20:23], s39 offen offset:0 lds
  buffer_load_dwordx4 v245, s[20:23], s39 offen offset:1024 lds
  buffer_load_dwordx4 v246, s[20:23], s39 offen offset:2048 lds
  buffer_load_dwordx4 v247, s[20:23], s39 offen offset:3072 lds
  s_add_u32 m0, s42, 4096
  s_nop 0
  buffer_load_dwordx4 v248, s[20:23], s39 offen offset:0 lds
  buffer_load_dwordx4 v249, s[20:23], s39 offen offset:1024 lds
  s_add_u32 s38, s38, 128
  s_add_u32 s39, s39, 393216
  buffer_store_dwordx4 v[160:163], v3, s[48:51], s64 offen offset:1024 sc1
  s_waitcnt vmcnt(22)
  s_barrier
  s_add_u32 m0, s41, 40960
  s_nop 0
  buffer_load_dwordx4 v240, s[16:19], s38 offen offset:0 lds
  buffer_load_dwordx4 v241, s[16:19], s38 offen offset:1024 lds
  buffer_load_dwordx4 v242, s[16:19], s38 offen offset:2048 lds
  buffer_load_dwordx4 v243, s[16:19], s38 offen offset:3072 lds
  s_add_u32 m0, s42, 40960
  s_nop 0
  buffer_load_dwordx4 v244, s[20:23], s39 offen offset:0 lds
  buffer_load_dwordx4 v245, s[20:23], s39 offen offset:1024 lds
  buffer_load_dwordx4 v246, s[20:23], s39 offen offset:2048 lds
  buffer_load_dwordx4 v247, s[20:23], s39 offen offset:3072 lds
  s_add_u32 m0, s42, 45056
  s_nop 0
  buffer_load_dwordx4 v248, s[20:23], s39 offen offset:0 lds
  buffer_load_dwordx4 v249, s[20:23], s39 offen offset:1024 lds
  s_add_u32 s38, s38, 128
  s_add_u32 s39, s39, 393216
  buffer_store_dwordx4 v[160:163], v3, s[48:51], s65 offen sc1
  s_waitcnt vmcnt(23)
  s_barrier
  s_add_u32 m0, s41, 81920
  s_nop 0
  buffer_load_dwordx4 v240, s[16:19], s38 offen offset:0 lds
  buffer_load_dwordx4 v241, s[16:19], s38 offen offset:1024 lds
  buffer_load_dwordx4 v242, s[16:19], s38 offen offset:2048 lds
  buffer_load_dwordx4 v243, s[16:19], s38 offen offset:3072 lds
  s_add_u32 m0, s42, 81920
  s_nop 0
  buffer_load_dwordx4 v244, s[20:23], s39 offen offset:0 lds
  buffer_load_dwordx4 v245, s[20:23], s39 offen offset:1024 lds
  buffer_load_dwordx4 v246, s[20:23], s39 offen offset:2048 lds
  buffer_load_dwordx4 v247, s[20:23], s39 offen offset:3072 lds
  s_add_u32 m0, s42, 86016
  s_nop 0
  buffer_load_dwordx4 v248, s[20:23], s39 offen offset:0 lds
  buffer_load_dwordx4 v249, s[20:23], s39 offen offset:1024 lds
  s_add_u32 s38, s38, 128
  s_add_u32 s39, s39, 393216
  buffer_store_dwordx4 v[160:163], v3, s[48:51], s65 offen offset:1024 sc1
  s_waitcnt vmcnt(23)
  s_barrier
  s_add_u32 m0, s41, 122880
  s_nop 0
  buffer_load_dwordx4 v240, s[16:19], s38 offen offset:0 lds
  buffer_load_dwordx4 v241, s[16:19], s38 offen offset:1024 lds
  buffer_load_dwordx4 v242, s[16:19], s38 offen offset:2048 lds
  buffer_load_dwordx4 v243, s[16:19], s38 offen offset:3072 lds
  s_add_u32 m0, s42, 122880
  s_nop 0
  buffer_load_dwordx4 v244, s[20:23], s39 offen offset:0 lds
  buffer_load_dwordx4 v245, s[20:23], s39 offen offset:1024 lds
  buffer_load_dwordx4 v246, s[20:23], s39 offen offset:2048 lds
  buffer_load_dwordx4 v247, s[20:23], s39 offen offset:3072 lds
  s_add_u32 m0, s42, 126976
  s_nop 0
  buffer_load_dwordx4 v248, s[20:23], s39 offen offset:0 lds
  buffer_load_dwordx4 v249, s[20:23], s39 offen offset:1024 lds
  s_add_u32 s38, s38, 128
  s_add_u32 s39, s39, 393216
  buffer_store_dwordx4 v[160:163], v3, s[52:55], s66 offen sc1
  buffer_load_dwordx4 v[24:27], v22, s[32:35], s63 offen offset:0
  buffer_load_dwordx4 v[28:31], v22, s[32:35], s63 offen offset:16
  v_add_u32 v23, 4294961152, v21
  buffer_load_dwordx2 v[32:33], v23, s[24:27], 0 offen nt
  v_add_u32 v23, 4294963200, v21
  buffer_load_dwordx2 v[34:35], v23, s[24:27], 0 offen nt
  v_add_u32 v23, 4294965248, v21
  buffer_load_dwordx2 v[36:37], v23, s[24:27], 0 offen nt
  v_add_u32 v23, 0, v21
  buffer_load_dwordx2 v[38:39], v23, s[24:27], 0 offen nt
  v_add_u32 v23, 2048, v21
  buffer_load_dwordx2 v[40:41], v23, s[24:27], 0 offen nt
  v_add_u32 v23, 4096, v21
  buffer_load_dwordx2 v[42:43], v23, s[24:27], 0 offen nt
  v_add_u32 v23, 6144, v21
  buffer_load_dwordx2 v[44:45], v23, s[24:27], 0 offen nt
  v_add_u32 v23, 8192, v21
  buffer_load_dwordx2 v[46:47], v23, s[24:27], 0 offen nt
  v_add_u32 v23, 10240, v21
  buffer_load_dwordx2 v[48:49], v23, s[24:27], 0 offen nt
  s_waitcnt vmcnt(34)
  s_barrier
  s_add_u32 m0, s41, 0
  s_nop 0
  buffer_load_dwordx4 v240, s[16:19], s38 offen offset:0 lds
  buffer_load_dwordx4 v241, s[16:19], s38 offen offset:1024 lds
  buffer_load_dwordx4 v242, s[16:19], s38 offen offset:2048 lds
  buffer_load_dwordx4 v243, s[16:19], s38 offen offset:3072 lds
  s_add_u32 m0, s42, 0
  s_nop 0
  buffer_load_dwordx4 v244, s[20:23], s39 offen offset:0 lds
  buffer_load_dwordx4 v245, s[20:23], s39 offen offset:1024 lds
  buffer_load_dwordx4 v246, s[20:23], s39 offen offset:2048 lds
  buffer_load_dwordx4 v247, s[20:23], s39 offen offset:3072 lds
  s_add_u32 m0, s42, 4096
  s_nop 0
  buffer_load_dwordx4 v248, s[20:23], s39 offen offset:0 lds
  buffer_load_dwordx4 v249, s[20:23], s39 offen offset:1024 lds
  s_add_u32 s38, s38, 128
  s_add_u32 s39, s39, 393216
  buffer_store_dwordx4 v[160:163], v18, s[56:59], s67 offen sc1
  v_add_u32 v23, 12288, v21
  buffer_load_dwordx2 v[50:51], v23, s[24:27], 0 offen nt
  v_add_u32 v23, 14336, v21
  buffer_load_dwordx2 v[52:53], v23, s[24:27], 0 offen nt
  v_add_u32 v23, 0, v21
  buffer_load_dwordx2 v[54:55], v23, s[28:31], 0 offen nt
  v_add_u32 v23, 2048, v21
  buffer_load_dwordx2 v[56:57], v23, s[28:31], 0 offen nt
  v_add_u32 v23, 4096, v21
  buffer_load_dwordx2 v[58:59], v23, s[28:31], 0 offen nt
  v_add_u32 v23, 6144, v21
  buffer_load_dwordx2 v[60:61], v23, s[28:31], 0 offen nt
  v_add_u32 v23, 8192, v21
  buffer_load_dwordx2 v[62:63], v23, s[28:31], 0 offen nt
  v_add_u32 v23, 10240, v21
  buffer_load_dwordx2 v[64:65], v23, s[28:31], 0 offen nt
  v_add_u32 v23, 12288, v21
  buffer_load_dwordx2 v[66:67], v23, s[28:31], 0 offen nt
  v_add_u32 v23, 14336, v21
  buffer_load_dwordx2 v[68:69], v23, s[28:31], 0 offen nt
  s_waitcnt vmcnt(44)
  s_barrier
  s_add_u32 m0, s41, 40960
  s_nop 0
  buffer_load_dwordx4 v240, s[16:19], s38 offen offset:0 lds
  buffer_load_dwordx4 v241, s[16:19], s38 offen offset:1024 lds
  buffer_load_dwordx4 v242, s[16:19], s38 offen offset:2048 lds
  buffer_load_dwordx4 v243, s[16:19], s38 offen offset:3072 lds
  s_add_u32 m0, s42, 40960
  s_nop 0
  buffer_load_dwordx4 v244, s[20:23], s39 offen offset:0 lds
  buffer_load_dwordx4 v245, s[20:23], s39 offen offset:1024 lds
  buffer_load_dwordx4 v246, s[20:23], s39 offen offset:2048 lds
  buffer_load_dwordx4 v247, s[20:23], s39 offen offset:3072 lds
  s_add_u32 m0, s42, 45056
  s_nop 0
  buffer_load_dwordx4 v248, s[20:23], s39 offen offset:0 lds
  buffer_load_dwordx4 v249, s[20:23], s39 offen offset:1024 lds
  s_add_u32 s38, s38, 128
  s_add_u32 s39, s39, 393216
  s_waitcnt vmcnt(10)
  v_lshlrev_b32 v72, 16, v24
  v_and_b32 v76, 0xffff0000, v24
  v_lshlrev_b32 v80, 16, v25
  v_and_b32 v84, 0xffff0000, v25
  v_lshlrev_b32 v73, 16, v26
  v_and_b32 v77, 0xffff0000, v26
  v_lshlrev_b32 v81, 16, v27
  v_and_b32 v85, 0xffff0000, v27
  v_lshlrev_b32 v74, 16, v28
  v_and_b32 v78, 0xffff0000, v28
  v_lshlrev_b32 v82, 16, v29
  v_and_b32 v86, 0xffff0000, v29
  v_lshlrev_b32 v75, 16, v30
  v_and_b32 v79, 0xffff0000, v30
  v_lshlrev_b32 v83, 16, v31
  v_and_b32 v87, 0xffff0000, v31
  v_lshlrev_b32 v88, 16, v32
  v_and_b32 v89, 0xffff0000, v32
  v_lshlrev_b32 v90, 16, v34
  v_and_b32 v91, 0xffff0000, v34
  v_lshlrev_b32 v92, 16, v36
  v_and_b32 v93, 0xffff0000, v36
  v_lshlrev_b32 v94, 16, v38
  v_and_b32 v95, 0xffff0000, v38
  v_lshlrev_b32 v96, 16, v40
  v_and_b32 v97, 0xffff0000, v40
  v_lshlrev_b32 v98, 16, v42
  v_and_b32 v99, 0xffff0000, v42
  v_lshlrev_b32 v100, 16, v44
  v_and_b32 v101, 0xffff0000, v44
  v_lshlrev_b32 v102, 16, v46
  v_and_b32 v103, 0xffff0000, v46
  v_lshlrev_b32 v104, 16, v48
  v_and_b32 v105, 0xffff0000, v48
  v_lshlrev_b32 v106, 16, v50
  v_and_b32 v107, 0xffff0000, v50
  v_lshlrev_b32 v108, 16, v52
  v_and_b32 v109, 0xffff0000, v52
  v_lshlrev_b32 v110, 16, v54
  v_and_b32 v111, 0xffff0000, v54
  v_lshlrev_b32 v112, 16, v56
  v_and_b32 v113, 0xffff0000, v56
  v_lshlrev_b32 v114, 16, v58
  v_and_b32 v115, 0xffff0000, v58
  v_lshlrev_b32 v116, 16, v60
  v_and_b32 v117, 0xffff0000, v60
  v_lshlrev_b32 v118, 16, v62
  v_and_b32 v119, 0xffff0000, v62
  v_lshlrev_b32 v120, 16, v64
  v_and_b32 v121, 0xffff0000, v64
  v_lshlrev_b32 v122, 16, v66
  v_and_b32 v123, 0xffff0000, v66
  v_lshlrev_b32 v124, 16, v68
  v_and_b32 v125, 0xffff0000, v68
  v_mul_f32 v126, v88, v84
  v_mul_f32 v127, v89, v85
  v_mul_f32 v128, v90, v84
  v_mul_f32 v129, v91, v85
  v_mul_f32 v130, v92, v84
  v_mul_f32 v131, v93, v85
  v_mul_f32 v132, v94, v84
  v_mul_f32 v133, v95, v85
  v_mul_f32 v134, v96, v84
  v_mul_f32 v135, v97, v85
  v_mul_f32 v136, v98, v84
  v_mul_f32 v137, v99, v85
  v_mul_f32 v138, v100, v84
  v_mul_f32 v139, v101, v85
  v_mul_f32 v140, v102, v84
  v_mul_f32 v141, v103, v85
  v_fmac_f32 v126, v90, v80
  v_fmac_f32 v127, v91, v81
  v_fmac_f32 v128, v92, v80
  v_fmac_f32 v129, v93, v81
  v_fmac_f32 v130, v94, v80
  v_fmac_f32 v131, v95, v81
  v_fmac_f32 v132, v96, v80
  v_fmac_f32 v133, v97, v81
  v_fmac_f32 v134, v98, v80
  v_fmac_f32 v135, v99, v81
  v_fmac_f32 v136, v100, v80
  v_fmac_f32 v137, v101, v81
  v_fmac_f32 v138, v102, v80
  v_fmac_f32 v139, v103, v81
  v_fmac_f32 v140, v104, v80
  v_fmac_f32 v141, v105, v81
  v_fmac_f32 v126, v92, v76
  v_fmac_f32 v127, v93, v77
  v_fmac_f32 v128, v94, v76
  v_fmac_f32 v129, v95, v77
  v_fmac_f32 v130, v96, v76
  v_fmac_f32 v131, v97, v77
  v_fmac_f32 v132, v98, v76
  v_fmac_f32 v133, v99, v77
  v_fmac_f32 v134, v100, v76
  v_fmac_f32 v135, v101, v77
  v_fmac_f32 v136, v102, v76
  v_fmac_f32 v137, v103, v77
  s_barrier
  s_add_u32 m0, s41, 81920
  s_nop 0
  buffer_load_dwordx4 v240, s[16:19], s38 offen offset:0 lds
  buffer_load_dwordx4 v241, s[16:19], s38 offen offset:1024 lds
  buffer_load_dwordx4 v242, s[16:19], s38 offen offset:2048 lds
  buffer_load_dwordx4 v243, s[16:19], s38 offen offset:3072 lds
  s_add_u32 m0, s42, 81920
  s_nop 0
  buffer_load_dwordx4 v244, s[20:23], s39 offen offset:0 lds
  buffer_load_dwordx4 v245, s[20:23], s39 offen offset:1024 lds
  buffer_load_dwordx4 v246, s[20:23], s39 offen offset:2048 lds
  buffer_load_dwordx4 v247, s[20:23], s39 offen offset:3072 lds
  s_add_u32 m0, s42, 86016
  s_nop 0
  buffer_load_dwordx4 v248, s[20:23], s39 offen offset:0 lds
  buffer_load_dwordx4 v249, s[20:23], s39 offen offset:1024 lds
  s_add_u32 s38, s38, 128
  s_add_u32 s39, s39, 393216
  v_fmac_f32 v138, v104, v76
  v_fmac_f32 v139, v105, v77
  v_fmac_f32 v140, v106, v76
  v_fmac_f32 v141, v107, v77
  v_fmac_f32 v126, v94, v72
  v_fmac_f32 v127, v95, v73
  v_fmac_f32 v128, v96, v72
  v_fmac_f32 v129, v97, v73
  v_fmac_f32 v130, v98, v72
  v_fmac_f32 v131, v99, v73
  v_fmac_f32 v132, v100, v72
  v_fmac_f32 v133, v101, v73
  v_fmac_f32 v134, v102, v72
  v_fmac_f32 v135, v103, v73
  v_fmac_f32 v136, v104, v72
  v_fmac_f32 v137, v105, v73
  v_fmac_f32 v138, v106, v72
  v_fmac_f32 v139, v107, v73
  v_fmac_f32 v140, v108, v72
  v_fmac_f32 v141, v109, v73
  v_mul_f32 v126, v126, v110
  v_mul_f32 v127, v127, v111
  v_mul_f32 v128, v128, v112
  v_mul_f32 v129, v129, v113
  v_mul_f32 v130, v130, v114
  v_mul_f32 v131, v131, v115
  v_mul_f32 v132, v132, v116
  v_mul_f32 v133, v133, v117
  v_mul_f32 v134, v134, v118
  v_mul_f32 v135, v135, v119
  v_mul_f32 v136, v136, v120
  v_mul_f32 v137, v137, v121
  v_mul_f32 v138, v138, v122
  v_mul_f32 v139, v139, v123
  v_mul_f32 v140, v140, v124
  v_mul_f32 v141, v141, v125
  v_cvt_pk_bf16_f32 v144, v126, v128
  v_cvt_pk_bf16_f32 v145, v130, v132
  v_cvt_pk_bf16_f32 v146, v134, v136
  v_cvt_pk_bf16_f32 v147, v138, v140
  v_cvt_pk_bf16_f32 v148, v127, v129
  v_cvt_pk_bf16_f32 v149, v131, v133
  v_cvt_pk_bf16_f32 v150, v135, v137
  v_cvt_pk_bf16_f32 v151, v139, v141
  v_and_b32 v144, -2, v144
  v_and_b32 v145, -2, v145
  v_and_b32 v146, -2, v146
  v_and_b32 v147, -2, v147
  v_and_b32 v148, -2, v148
  v_and_b32 v149, -2, v149
  v_and_b32 v150, -2, v150
  v_and_b32 v151, -2, v151
  buffer_store_dwordx4 v[144:147], v19, s[44:47], s62 offen sc1
  s_add_u32 s62, s62, 4096
  buffer_store_dwordx4 v[148:151], v19, s[44:47], s62 offen sc1
  s_add_u32 s62, s62, 4096
  v_lshlrev_b32 v88, 16, v33
  v_and_b32 v89, 0xffff0000, v33
  v_lshlrev_b32 v90, 16, v35
  v_and_b32 v91, 0xffff0000, v35
  v_lshlrev_b32 v92, 16, v37
  v_and_b32 v93, 0xffff0000, v37
  v_lshlrev_b32 v94, 16, v39
  v_and_b32 v95, 0xffff0000, v39
  v_lshlrev_b32 v96, 16, v41
  v_and_b32 v97, 0xffff0000, v41
  v_lshlrev_b32 v98, 16, v43
  v_and_b32 v99, 0xffff0000, v43
  v_lshlrev_b32 v100, 16, v45
  v_and_b32 v101, 0xffff0000, v45
  v_lshlrev_b32 v102, 16, v47
  v_and_b32 v103, 0xffff0000, v47
  v_lshlrev_b32 v104, 16, v49
  v_and_b32 v105, 0xffff0000, v49
  v_lshlrev_b32 v106, 16, v51
  v_and_b32 v107, 0xffff0000, v51
  v_lshlrev_b32 v108, 16, v53
  v_and_b32 v109, 0xffff0000, v53
  v_lshlrev_b32 v110, 16, v55
  v_and_b32 v111, 0xffff0000, v55
  v_lshlrev_b32 v112, 16, v57
  v_and_b32 v113, 0xffff0000, v57
  v_lshlrev_b32 v114, 16, v59
  v_and_b32 v115, 0xffff0000, v59
  v_lshlrev_b32 v116, 16, v61
  v_and_b32 v117, 0xffff0000, v61
  v_lshlrev_b32 v118, 16, v63
  v_and_b32 v119, 0xffff0000, v63
  v_lshlrev_b32 v120, 16, v65
  v_and_b32 v121, 0xffff0000, v65
  v_lshlrev_b32 v122, 16, v67
  v_and_b32 v123, 0xffff0000, v67
  v_lshlrev_b32 v124, 16, v69
  v_and_b32 v125, 0xffff0000, v69
  v_mul_f32 v126, v88, v86
  v_mul_f32 v127, v89, v87
  v_mul_f32 v128, v90, v86
  v_mul_f32 v129, v91, v87
  s_barrier
  s_add_u32 m0, s41, 122880
  s_nop 0
  buffer_load_dwordx4 v240, s[16:19], s38 offen offset:0 lds
  buffer_load_dwordx4 v241, s[16:19], s38 offen offset:1024 lds
  buffer_load_dwordx4 v242, s[16:19], s38 offen offset:2048 lds
  buffer_load_dwordx4 v243, s[16:19], s38 offen offset:3072 lds
  s_add_u32 m0, s42, 122880
  s_nop 0
  buffer_load_dwordx4 v244, s[20:23], s39 offen offset:0 lds
  buffer_load_dwordx4 v245, s[20:23], s39 offen offset:1024 lds
  buffer_load_dwordx4 v246, s[20:23], s39 offen offset:2048 lds
  buffer_load_dwordx4 v247, s[20:23], s39 offen offset:3072 lds
  s_add_u32 m0, s42, 126976
  s_nop 0
  buffer_load_dwordx4 v248, s[20:23], s39 offen offset:0 lds
  buffer_load_dwordx4 v249, s[20:23], s39 offen offset:1024 lds
  s_add_u32 s38, s38, 128
  s_add_u32 s39, s39, 393216
  v_mul_f32 v130, v92, v86
  v_mul_f32 v131, v93, v87
  v_mul_f32 v132, v94, v86
  v_mul_f32 v133, v95, v87
  v_mul_f32 v134, v96, v86
  v_mul_f32 v135, v97, v87
  v_mul_f32 v136, v98, v86
  v_mul_f32 v137, v99, v87
  v_mul_f32 v138, v100, v86
  v_mul_f32 v139, v101, v87
  v_mul_f32 v140, v102, v86
  v_mul_f32 v141, v103, v87
  v_fmac_f32 v126, v90, v82
  v_fmac_f32 v127, v91, v83
  v_fmac_f32 v128, v92, v82
  v_fmac_f32 v129, v93, v83
  v_fmac_f32 v130, v94, v82
  v_fmac_f32 v131, v95, v83
  v_fmac_f32 v132, v96, v82
  v_fmac_f32 v133, v97, v83
  v_fmac_f32 v134, v98, v82
  v_fmac_f32 v135, v99, v83
  v_fmac_f32 v136, v100, v82
  v_fmac_f32 v137, v101, v83
  v_fmac_f32 v138, v102, v82
  v_fmac_f32 v139, v103, v83
  v_fmac_f32 v140, v104, v82
  v_fmac_f32 v141, v105, v83
  v_fmac_f32 v126, v92, v78
  v_fmac_f32 v127, v93, v79
  v_fmac_f32 v128, v94, v78
  v_fmac_f32 v129, v95, v79
  v_fmac_f32 v130, v96, v78
  v_fmac_f32 v131, v97, v79
  v_fmac_f32 v132, v98, v78
  v_fmac_f32 v133, v99, v79
  v_fmac_f32 v134, v100, v78
  v_fmac_f32 v135, v101, v79
  v_fmac_f32 v136, v102, v78
  v_fmac_f32 v137, v103, v79
  v_fmac_f32 v138, v104, v78
  v_fmac_f32 v139, v105, v79
  v_fmac_f32 v140, v106, v78
  v_fmac_f32 v141, v107, v79
  v_fmac_f32 v126, v94, v74
  v_fmac_f32 v127, v95, v75
  v_fmac_f32 v128, v96, v74
  v_fmac_f32 v129, v97, v75
  v_fmac_f32 v130, v98, v74
  v_fmac_f32 v131, v99, v75
  v_fmac_f32 v132, v100, v74
  v_fmac_f32 v133, v101, v75
  v_fmac_f32 v134, v102, v74
  v_fmac_f32 v135, v103, v75
  v_fmac_f32 v136, v104, v74
  v_fmac_f32 v137, v105, v75
  v_fmac_f32 v138, v106, v74
  v_fmac_f32 v139, v107, v75
  v_fmac_f32 v140, v108, v74
  v_fmac_f32 v141, v109, v75
  v_mul_f32 v126, v126, v110
  v_mul_f32 v127, v127, v111
  v_mul_f32 v128, v128, v112
  v_mul_f32 v129, v129, v113
  v_mul_f32 v130, v130, v114
  v_mul_f32 v131, v131, v115
  v_mul_f32 v132, v132, v116
  v_mul_f32 v133, v133, v117
  v_mul_f32 v134, v134, v118
  v_mul_f32 v135, v135, v119
  v_mul_f32 v136, v136, v120
  v_mul_f32 v137, v137, v121
  v_mul_f32 v138, v138, v122
  v_mul_f32 v139, v139, v123
  v_mul_f32 v140, v140, v124
  v_mul_f32 v141, v141, v125
  v_cvt_pk_bf16_f32 v152, v126, v128
  v_cvt_pk_bf16_f32 v153, v130, v132
  v_cvt_pk_bf16_f32 v154, v134, v136
  v_cvt_pk_bf16_f32 v155, v138, v140
  v_cvt_pk_bf16_f32 v156, v127, v129
  v_cvt_pk_bf16_f32 v157, v131, v133
  v_cvt_pk_bf16_f32 v158, v135, v137
  v_cvt_pk_bf16_f32 v159, v139, v141
  v_and_b32 v152, -2, v152
  v_and_b32 v153, -2, v153
  v_and_b32 v154, -2, v154
  v_and_b32 v155, -2, v155
  v_and_b32 v156, -2, v156
  v_and_b32 v157, -2, v157
  v_and_b32 v158, -2, v158
  v_and_b32 v159, -2, v159
  buffer_store_dwordx4 v[152:155], v19, s[44:47], s62 offen sc1
  s_add_u32 s62, s62, 4096
  buffer_store_dwordx4 v[156:159], v19, s[44:47], s62 offen sc1
  s_add_u32 s62, s62, 4096
  s_waitcnt vmcnt(24)
  s_barrier
  s_add_u32 m0, s41, 0
  s_nop 0
  buffer_load_dwordx4 v240, s[16:19], s38 offen offset:0 lds
  buffer_load_dwordx4 v241, s[16:19], s38 offen offset:1024 lds
  buffer_load_dwordx4 v242, s[16:19], s38 offen offset:2048 lds
  buffer_load_dwordx4 v243, s[16:19], s38 offen offset:3072 lds
  s_add_u32 m0, s42, 0
  s_nop 0
  buffer_load_dwordx4 v244, s[20:23], s39 offen offset:0 lds
  buffer_load_dwordx4 v245, s[20:23], s39 offen offset:1024 lds
  buffer_load_dwordx4 v246, s[20:23], s39 offen offset:2048 lds
  buffer_load_dwordx4 v247, s[20:23], s39 offen offset:3072 lds
  s_add_u32 m0, s42, 4096
  s_nop 0
  buffer_load_dwordx4 v248, s[20:23], s39 offen offset:0 lds
  buffer_load_dwordx4 v249, s[20:23], s39 offen offset:1024 lds
  s_add_u32 s38, s38, 128
  s_add_u32 s39, s39, 393216
  s_waitcnt vmcnt(24)
  s_barrier
  s_add_u32 m0, s41, 40960
  s_nop 0
  buffer_load_dwordx4 v240, s[16:19], s38 offen offset:0 lds
  buffer_load_dwordx4 v241, s[16:19], s38 offen offset:1024 lds
  buffer_load_dwordx4 v242, s[16:19], s38 offen offset:2048 lds
  buffer_load_dwordx4 v243, s[16:19], s38 offen offset:3072 lds
  s_add_u32 m0, s42, 40960
  s_nop 0
  buffer_load_dwordx4 v244, s[20:23], s39 offen offset:0 lds
  buffer_load_dwordx4 v245, s[20:23], s39 offen offset:1024 lds
  buffer_load_dwordx4 v246, s[20:23], s39 offen offset:2048 lds
  buffer_load_dwordx4 v247, s[20:23], s39 offen offset:3072 lds
  s_add_u32 m0, s42, 45056
  s_nop 0
  buffer_load_dwordx4 v248, s[20:23], s39 offen offset:0 lds
  buffer_load_dwordx4 v249, s[20:23], s39 offen offset:1024 lds
  s_add_u32 s38, s38, 128
  s_add_u32 s39, s39, 393216
  s_waitcnt vmcnt(22)
  s_barrier
  s_add_u32 m0, s41, 81920
  s_nop 0
  buffer_load_dwordx4 v240, s[16:19], s38 offen offset:0 lds
  buffer_load_dwordx4 v241, s[16:19], s38 offen offset:1024 lds
  buffer_load_dwordx4 v242, s[16:19], s38 offen offset:2048 lds
  buffer_load_dwordx4 v243, s[16:19], s38 offen offset:3072 lds
  s_add_u32 m0, s42, 81920
  s_nop 0
  buffer_load_dwordx4 v244, s[20:23], s39 offen offset:0 lds
  buffer_load_dwordx4 v245, s[20:23], s39 offen offset:1024 lds
  buffer_load_dwordx4 v246, s[20:23], s39 offen offset:2048 lds
  buffer_load_dwordx4 v247, s[20:23], s39 offen offset:3072 lds
  s_add_u32 m0, s42, 86016
  s_nop 0
  buffer_load_dwordx4 v248, s[20:23], s39 offen offset:0 lds
  buffer_load_dwordx4 v249, s[20:23], s39 offen offset:1024 lds
  s_add_u32 s38, s38, 128
  s_add_u32 s39, s39, 393216
  s_waitcnt vmcnt(20)
  s_barrier
  s_add_u32 m0, s41, 122880
  s_nop 0
  buffer_load_dwordx4 v240, s[16:19], s38 offen offset:0 lds
  buffer_load_dwordx4 v241, s[16:19], s38 offen offset:1024 lds
  buffer_load_dwordx4 v242, s[16:19], s38 offen offset:2048 lds
  buffer_load_dwordx4 v243, s[16:19], s38 offen offset:3072 lds
  s_add_u32 m0, s42, 122880
  s_nop 0
  buffer_load_dwordx4 v244, s[20:23], s39 offen offset:0 lds
  buffer_load_dwordx4 v245, s[20:23], s39 offen offset:1024 lds
  buffer_load_dwordx4 v246, s[20:23], s39 offen offset:2048 lds
  buffer_load_dwordx4 v247, s[20:23], s39 offen offset:3072 lds
  s_add_u32 m0, s42, 126976
  s_nop 0
  buffer_load_dwordx4 v248, s[20:23], s39 offen offset:0 lds
  buffer_load_dwordx4 v249, s[20:23], s39 offen offset:1024 lds
  s_add_u32 s38, s38, 128
  s_add_u32 s39, s39, 393216
  s_waitcnt vmcnt(20)
  s_barrier
  s_lshl_b32 s16, s10, 1
  s_lshr_b32 s17, s11, 4
  s_add_u32 s16, s16, s17
  s_and_b32 s17, s11, 15
  s_lshl_b32 s17, s17, 2
  s_add_u32 s17, s17, s4
  s_lshr_b32 s18, s17, 4
  s_and_b32 s17, s17, 15
  s_lshl_b32 s19, s18, 9
  s_lshl_b32 s64, s17, 2
  s_add_u32 s19, s19, s64
  s_lshl_b32 s64, s19, 11
  s_lshl_b32 s65, s16, 7
  s_add_u32 s64, s64, s65
  s_lshl_b32 s72, s19, 12
  s_add_u32 s72, s72, s65
  s_lshl_b32 s73, s16, 18
  s_lshl_b32 s65, s18, 10
  s_add_u32 s73, s73, s65
  s_lshl_b32 s65, s17, 6
  s_add_u32 s73, s73, s65
  s_add_u32 s65, s73, 4096
  s_add_u32 s66, s73, 8192
  s_add_u32 s67, s73, 12288
  v_lshlrev_b32 v224, 12, v14
  v_lshl_add_u32 v224, v15, 3, v224
  v_lshlrev_b32 v225, 14, v15
  v_lshl_add_u32 v225, v14, 4, v225
  s_mov_b32 s16, s84
  s_mov_b32 s17, s85
  s_mov_b32 s18, 4194304
  s_mov_b32 s19, 0x20000
  s_mov_b32 s20, s86
  s_mov_b32 s21, s87
  s_mov_b32 s22, 2048
  s_mov_b32 s23, 0x20000
  v_mov_b32 v4, 0
  v_lshlrev_b32 v5, 2, v2
  v_add_u32 v6, 38912, v5
  ds_write_b32 v6, v4
  v_add_u32 v6, s7, v5
  ds_write_b32 v6, v4 offset:4128
  v_and_b32 v6, 7, v2
  v_lshlrev_b32 v6, 2, v6
  v_add_u32 v6, s7, v6
  ds_write_b32 v6, v4
  s_add_u32 m0, s7, 32
  s_nop 0
  buffer_load_dwordx4 v3, s[16:19], s71 offen offset:0 nt lds
  buffer_load_dwordx4 v3, s[16:19], s71 offen offset:1024 nt lds
  buffer_load_dwordx4 v3, s[16:19], s71 offen offset:2048 nt lds
  buffer_load_dwordx4 v3, s[16:19], s71 offen offset:3072 nt lds
  s_lshl_b32 s43, s6, 1
  v_mov_b32 v4, 0
  buffer_load_ushort v164, v4, s[20:23], s43 offen
  s_mov_b32 s20, s92
  s_mov_b32 s21, s93
  s_mov_b32 s22, 2097152
  s_mov_b32 s23, 0x20000
  s_waitcnt vmcnt(15)
  s_waitcnt lgkmcnt(0)
  s_barrier
  s_add_u32 m0, s70, 0
  s_nop 0
  buffer_load_dwordx4 v232, s[20:23], s69 offen offset:0 lds
  buffer_load_dwordx4 v233, s[20:23], s69 offen offset:1024 lds
  buffer_load_dwordx4 v234, s[20:23], s69 offen offset:2048 lds
  buffer_load_dwordx4 v235, s[20:23], s69 offen offset:3072 lds
  s_add_u32 s69, s69, 262144
  s_add_u32 m0, s70, 16384
  s_nop 0
  buffer_load_dwordx4 v232, s[20:23], s69 offen offset:0 lds
  buffer_load_dwordx4 v233, s[20:23], s69 offen offset:1024 lds
  buffer_load_dwordx4 v234, s[20:23], s69 offen offset:2048 lds
  buffer_load_dwordx4 v235, s[20:23], s69 offen offset:3072 lds
  s_add_u32 s69, s69, 262144
  s_waitcnt vmcnt(13)
  s_barrier
  s_add_u32 m0, s70, 32768
  s_nop 0
  buffer_load_dwordx4 v232, s[20:23], s69 offen offset:0 lds
  buffer_load_dwordx4 v233, s[20:23], s69 offen offset:1024 lds
  buffer_load_dwordx4 v234, s[20:23], s69 offen offset:2048 lds
  buffer_load_dwordx4 v235, s[20:23], s69 offen offset:3072 lds
  s_add_u32 s69, s69, 262144
  s_add_u32 m0, s70, 49152
  s_nop 0
  buffer_load_dwordx4 v232, s[20:23], s69 offen offset:0 lds
  buffer_load_dwordx4 v233, s[20:23], s69 offen offset:1024 lds
  buffer_load_dwordx4 v234, s[20:23], s69 offen offset:2048 lds
  buffer_load_dwordx4 v235, s[20:23], s69 offen offset:3072 lds
  s_add_u32 s69, s69, 262144
  s_barrier
  s_mov_b32 s24, s96
  s_mov_b32 s25, s97
  s_mov_b32 s26, 256
  s_mov_b32 s27, 0x20000
  s_mov_b32 s32, s94
  s_mov_b32 s33, s95
  s_mov_b32 s34, 8388608
  s_mov_b32 s35, 0x20000
  s_mov_b32 s40, 0
  s_mov_b32 s42, 0
  v_lshrrev_b32 v5, 1, v2
  v_lshlrev_b32 v5, 7, v5
  v_and_b32 v4, 1, v2
  v_lshl_add_u32 v5, v4, 4, v5
  v_mov_b32 v4, 0
  buffer_load_dword v226, v4, s[24:27], 0 offen sc1
  s_add_u32 s24, s98, 13631488
  s_addc_u32 s25, s99, 0
  s_mov_b32 s26, 4096
  s_mov_b32 s27, 0x20000
  v_lshlrev_b32 v6, 7, v15
  v_lshl_add_u32 v6, v14, 4, v6
  s_lshl_b32 s60, s15, 11
  s_lshl_b32 s61, s15, 16
  s_lshl_b32 s62, s36, 10
  s_add_u32 s61, s61, s62
  s_mov_b32 s43, 4000
K3_fp:
  buffer_load_dwordx4 v[24:27], v5, s[24:27], 0 offen sc1
  buffer_load_dwordx4 v[28:31], v5, s[24:27], 0 offen offset:32 sc1
  s_waitcnt vmcnt(0)
  v_xor_b32 v24, v24, v226
  v_xor_b32 v25, v25, v226
  v_xor_b32 v26, v26, v226
  v_xor_b32 v27, v27, v226
  v_or3_b32 v24, v24, v25, v26
  v_or_b32 v24, v24, v27
  v_cmp_ne_u32 vcc, 0, v24
  s_sub_u32 s43, s43, 1
  s_cbranch_scc1 K3_fp_ok
  s_cmp_eq_u64 vcc, 0
  s_cbranch_scc1 K3_fp_ok
  s_add_u32 s75, s75, 1
  s_sleep 8
  s_branch K3_fp
K3_fp_ok:
  v_mov_b32 v4, s7
  ds_read_u16 v7, v4 offset:32
  v_lshlrev_b32 v164, 16, v164
  s_waitcnt lgkmcnt(0)
  v_lshlrev_b32 v7, 16, v7
  v_add_f32 v7, v7, v164
  v_cvt_pk_bf16_f32 v7, v7, v7
  ds_write_b16 v4, v7 offset:32
  v_xor_b32 v28, v28, v226
  v_xor_b32 v29, v29, v226
  v_xor_b32 v30, v30, v226
  v_xor_b32 v31, v31, v226
  v_or3_b32 v28, v28, v29, v30
  v_or_b32 v28, v28, v31
  v_cmp_ne_u32 vcc, 0, v28
  s_nop 0
  s_cmp_lg_u64 vcc, 0
  s_cbranch_scc1 K3_nou0
  s_add_u32 m0, s7, 4384
  s_nop 0
  buffer_load_dwordx4 v3, s[44:47], s71 offen offset:0 sc1 lds
  buffer_load_dwordx4 v3, s[44:47], s71 offen offset:1024 sc1 lds
  buffer_load_dwordx4 v3, s[44:47], s71 offen offset:2048 sc1 lds
  buffer_load_dwordx4 v3, s[44:47], s71 offen offset:3072 sc1 lds
  s_mov_b32 s42, 1
  s_waitcnt vmcnt(0) lgkmcnt(0)
  s_mov_b64 exec, 1
  ds_add_u32 v9, v11 offset:8
  s_mov_b64 exec, -1
K3_nou0:
  s_mov_b32 s63, 131072
K3_wkvs:
  s_sleep 1
  ds_read_b32 v16, v10 offset:84
  s_waitcnt lgkmcnt(0)
  v_readfirstlane_b32 s62, v16
  s_sub_u32 s63, s63, 1
  s_cbranch_scc1 K3_wkvs_ok
  s_cmp_lt_u32 s62, 2
  s_cbranch_scc1 K3_wkvs
K3_wkvs_ok:
  s_add_u32 m0, s70, 65536
  s_nop 0
  buffer_load_dwordx4 v232, s[20:23], s69 offen offset:0 lds
  buffer_load_dwordx4 v233, s[20:23], s69 offen offset:1024 lds
  buffer_load_dwordx4 v234, s[20:23], s69 offen offset:2048 lds
  buffer_load_dwordx4 v235, s[20:23], s69 offen offset:3072 lds
  s_add_u32 s69, s69, 262144
  s_add_u32 m0, s70, 81920
  s_nop 0
  buffer_load_dwordx4 v232, s[20:23], s69 offen offset:0 lds
  buffer_load_dwordx4 v233, s[20:23], s69 offen offset:1024 lds
  buffer_load_dwordx4 v234, s[20:23], s69 offen offset:2048 lds
  buffer_load_dwordx4 v235, s[20:23], s69 offen offset:3072 lds
  s_add_u32 s69, s69, 262144
  v_and_b32 v7, 31, v2
  v_lshlrev_b32 v7, 11, v7
  s_add_u32 s62, s69, 262144
  buffer_load_dword v165, v7, s[20:23], s62 offen
  s_lshl_b32 s43, s4, 12
  s_add_u32 s43, s43, 139264
  v_add_u32 v8, s43, v3
  s_mov_b32 s63, 131072
K3_wpq:
  s_sleep 1
  ds_read_b32 v16, v9 offset:24
  s_waitcnt lgkmcnt(0)
  v_readfirstlane_b32 s62, v16
  s_sub_u32 s63, s63, 1
  s_cbranch_scc1 K3_wpq_ok
  s_cmp_lt_u32 s62, 1
  s_cbranch_scc1 K3_wpq
K3_wpq_ok:
  ds_read_b128 v[192:195], v8 offset:0
  ds_read_b128 v[196:199], v8 offset:1024
  ds_read_b128 v[200:203], v8 offset:2048
  ds_read_b128 v[204:207], v8 offset:3072
  s_waitcnt lgkmcnt(0)
  s_add_u32 m0, s70, 98304
  s_nop 0
  buffer_load_dwordx4 v232, s[20:23], s69 offen offset:0 lds
  buffer_load_dwordx4 v233, s[20:23], s69 offen offset:1024 lds
  buffer_load_dwordx4 v234, s[20:23], s69 offen offset:2048 lds
  buffer_load_dwordx4 v235, s[20:23], s69 offen offset:3072 lds
  s_add_u32 s69, s69, 262144
  s_mov_b32 s43, 4000
K3_zp:
  buffer_load_dwordx4 v[32:35], v6, s[56:59], s60 offen offset:0 sc1
  buffer_load_dwordx4 v[36:39], v6, s[56:59], s60 offen offset:64 sc1
  s_cmp_lg_u32 s42, 0
  s_cbranch_scc1 K3_zp_nf
  buffer_load_dwordx4 v[28:31], v5, s[24:27], 0 offen offset:32 sc1
  s_waitcnt vmcnt(0)
  v_xor_b32 v28, v28, v226
  v_xor_b32 v29, v29, v226
  v_xor_b32 v30, v30, v226
  v_xor_b32 v31, v31, v226
  v_or3_b32 v28, v28, v29, v30
  v_or_b32 v28, v28, v31
  v_cmp_ne_u32 vcc, 0, v28
  s_nop 0
  s_cmp_lg_u64 vcc, 0
  s_cbranch_scc1 K3_zp_nf
  s_add_u32 m0, s7, 4384
  s_nop 0
  buffer_load_dwordx4 v3, s[44:47], s71 offen offset:0 sc1 lds
  buffer_load_dwordx4 v3, s[44:47], s71 offen offset:1024 sc1 lds
  buffer_load_dwordx4 v3, s[44:47], s71 offen offset:2048 sc1 lds
  buffer_load_dwordx4 v3, s[44:47], s71 offen offset:3072 sc1 lds
  s_mov_b32 s42, 1
  s_waitcnt vmcnt(0) lgkmcnt(0)
  s_mov_b64 exec, 1
  ds_add_u32 v9, v11 offset:8
  s_mov_b64 exec, -1
K3_zp_nf:
  ds_read_b32 v17, v9 offset:56
  s_waitcnt vmcnt(0) lgkmcnt(0)
  v_bitop3_b32 v16, v32, v33, 1 bitop3:0x80
  v_bitop3_b32 v16, v16, v34, v35 bitop3:0x80
  v_bitop3_b32 v16, v16, v36, v37 bitop3:0x80
  v_bitop3_b32 v16, v16, v38, v39 bitop3:0x80
  v_readfirstlane_b32 s41, v17
  v_cmp_eq_u32 vcc, 0, v16
  s_sub_u32 s43, s43, 1
  s_cbranch_scc1 K3_zp_ok
  s_cmp_eq_u64 vcc, 0
  s_cbranch_scc1 K3_zp_ok
  s_cmp_lg_u32 s40, 0
  s_cbranch_scc1 K3_zp_s2
K3_zp_s2:
  s_sleep 10
  s_branch K3_zp
K3_zp_ok:
  s_setprio 2
  s_mov_b32 s43, 4000
  s_mov_b32 s62, s61
  buffer_load_dwordx4 v[96:99], v3, s[52:55], s62 offen offset:0
  s_add_u32 s62, s62, 4096
  buffer_load_dwordx4 v[100:103], v3, s[52:55], s62 offen offset:0
  s_add_u32 s62, s62, 4096
  buffer_load_dwordx4 v[104:107], v3, s[52:55], s62 offen offset:0
  s_add_u32 s62, s62, 4096
  buffer_load_dwordx4 v[108:111], v3, s[52:55], s62 offen offset:0
  s_add_u32 s62, s62, 4096
  buffer_load_dwordx4 v[112:115], v3, s[52:55], s62 offen offset:0
  s_add_u32 s62, s62, 4096
  buffer_load_dwordx4 v[116:119], v3, s[52:55], s62 offen offset:0
  s_add_u32 s62, s62, 4096
  buffer_load_dwordx4 v[120:123], v3, s[52:55], s62 offen offset:0
  s_add_u32 s62, s62, 4096
  buffer_load_dwordx4 v[124:127], v3, s[52:55], s62 offen offset:0
  s_add_u32 s62, s62, 4096
  buffer_load_dwordx4 v[128:131], v3, s[52:55], s62 offen offset:0
  s_add_u32 s62, s62, 4096
  buffer_load_dwordx4 v[132:135], v3, s[52:55], s62 offen offset:0
  s_add_u32 s62, s62, 4096
  buffer_load_dwordx4 v[136:139], v3, s[52:55], s62 offen offset:0
  s_add_u32 s62, s62, 4096
  buffer_load_dwordx4 v[140:143], v3, s[52:55], s62 offen offset:0
  s_add_u32 s62, s62, 4096
  buffer_load_dwordx4 v[144:147], v3, s[52:55], s62 offen offset:0
  s_add_u32 s62, s62, 4096
  buffer_load_dwordx4 v[148:151], v3, s[52:55], s62 offen offset:0
  s_add_u32 s62, s62, 4096
  buffer_load_dwordx4 v[152:155], v3, s[52:55], s62 offen offset:0
  s_add_u32 s62, s62, 4096
  buffer_load_dwordx4 v[156:159], v3, s[52:55], s62 offen offset:0
  s_add_u32 s62, s62, 4096
  s_mov_b32 s16, s76
  s_mov_b32 s17, s77
  s_mov_b32 s18, 4194304
  s_mov_b32 s19, 0x20000
  v_lshlrev_b32 v4, 11, v14
  v_lshl_add_u32 v4, v15, 3, v4
  buffer_load_dwordx2 v[208:209], v4, s[16:19], s64 offen nt
  s_add_u32 s64, s64, 131072
  buffer_load_dwordx2 v[210:211], v4, s[16:19], s64 offen nt
  s_add_u32 s64, s64, 131072
  buffer_load_dwordx2 v[212:213], v4, s[16:19], s64 offen nt
  s_add_u32 s64, s64, 131072
  buffer_load_dwordx2 v[214:215], v4, s[16:19], s64 offen nt
  s_add_u32 s64, s64, 131072
  buffer_load_dwordx2 v[216:217], v4, s[16:19], s64 offen nt
  s_add_u32 s64, s64, 131072
  buffer_load_dwordx2 v[218:219], v4, s[16:19], s64 offen nt
  s_add_u32 s64, s64, 131072
  buffer_load_dwordx2 v[220:221], v4, s[16:19], s64 offen nt
  s_add_u32 s64, s64, 131072
  buffer_load_dwordx2 v[222:223], v4, s[16:19], s64 offen nt
  s_add_u32 s64, s64, 131072
K3_gl:
  v_add_f32_dpp v40, v32, v32 row_ror:8 row_mask:0xf bank_mask:0xf
  v_add_f32_dpp v41, v33, v33 row_ror:8 row_mask:0xf bank_mask:0xf
  v_add_f32_dpp v42, v34, v34 row_ror:8 row_mask:0xf bank_mask:0xf
  v_add_f32_dpp v43, v35, v35 row_ror:8 row_mask:0xf bank_mask:0xf
  v_add_f32_dpp v44, v36, v36 row_ror:8 row_mask:0xf bank_mask:0xf
  v_add_f32_dpp v45, v37, v37 row_ror:8 row_mask:0xf bank_mask:0xf
  v_add_f32_dpp v46, v38, v38 row_ror:8 row_mask:0xf bank_mask:0xf
  v_add_f32_dpp v47, v39, v39 row_ror:8 row_mask:0xf bank_mask:0xf
  v_add_f32_dpp v40, v40, v40 row_ror:4 row_mask:0xf bank_mask:0xf
  v_add_f32_dpp v41, v41, v41 row_ror:4 row_mask:0xf bank_mask:0xf
  v_add_f32_dpp v42, v42, v42 row_ror:4 row_mask:0xf bank_mask:0xf
  v_add_f32_dpp v43, v43, v43 row_ror:4 row_mask:0xf bank_mask:0xf
  v_add_f32_dpp v44, v44, v44 row_ror:4 row_mask:0xf bank_mask:0xf
  v_add_f32_dpp v45, v45, v45 row_ror:4 row_mask:0xf bank_mask:0xf
  v_add_f32_dpp v46, v46, v46 row_ror:4 row_mask:0xf bank_mask:0xf
  v_add_f32_dpp v47, v47, v47 row_ror:4 row_mask:0xf bank_mask:0xf
  v_add_f32_dpp v40, v40, v40 row_ror:2 row_mask:0xf bank_mask:0xf
  v_add_f32_dpp v41, v41, v41 row_ror:2 row_mask:0xf bank_mask:0xf
  v_add_f32_dpp v42, v42, v42 row_ror:2 row_mask:0xf bank_mask:0xf
  v_add_f32_dpp v43, v43, v43 row_ror:2 row_mask:0xf bank_mask:0xf
  v_add_f32_dpp v44, v44, v44 row_ror:2 row_mask:0xf bank_mask:0xf
  v_add_f32_dpp v45, v45, v45 row_ror:2 row_mask:0xf bank_mask:0xf
  v_add_f32_dpp v46, v46, v46 row_ror:2 row_mask:0xf bank_mask:0xf
  v_add_f32_dpp v47, v47, v47 row_ror:2 row_mask:0xf bank_mask:0xf
  v_add_f32_dpp v40, v40, v40 row_ror:1 row_mask:0xf bank_mask:0xf
  v_add_f32_dpp v41, v41, v41 row_ror:1 row_mask:0xf bank_mask:0xf
  v_add_f32_dpp v42, v42, v42 row_ror:1 row_mask:0xf bank_mask:0xf
  v_add_f32_dpp v43, v43, v43 row_ror:1 row_mask:0xf bank_mask:0xf
  v_add_f32_dpp v44, v44, v44 row_ror:1 row_mask:0xf bank_mask:0xf
  v_add_f32_dpp v45, v45, v45 row_ror:1 row_mask:0xf bank_mask:0xf
  v_add_f32_dpp v46, v46, v46 row_ror:1 row_mask:0xf bank_mask:0xf
  v_add_f32_dpp v47, v47, v47 row_ror:1 row_mask:0xf bank_mask:0xf
  v_cvt_pk_bf16_f32 v48, v40, v41
  v_cvt_pk_bf16_f32 v49, v42, v43
  v_cvt_pk_bf16_f32 v50, v44, v45
  v_cvt_pk_bf16_f32 v51, v46, v47
  v_mov_b32 v16, 1
  s_waitcnt vmcnt(23)
  v_bitop3_b32 v16, v16, v96, v97 bitop3:0x80
  v_bitop3_b32 v16, v16, v98, v99 bitop3:0x80
  v_lshlrev_b32 v64, 16, v96
  v_and_b32 v65, 0xffff0000, v96
  v_lshlrev_b32 v66, 16, v97
  v_and_b32 v67, 0xffff0000, v97
  v_lshlrev_b32 v68, 16, v98
  v_and_b32 v69, 0xffff0000, v98
  v_lshlrev_b32 v70, 16, v99
  v_and_b32 v71, 0xffff0000, v99
  s_waitcnt vmcnt(22)
  v_bitop3_b32 v16, v16, v100, v101 bitop3:0x80
  v_bitop3_b32 v16, v16, v102, v103 bitop3:0x80
  v_lshlrev_b32 v72, 16, v100
  v_and_b32 v73, 0xffff0000, v100
  v_lshlrev_b32 v74, 16, v101
  v_and_b32 v75, 0xffff0000, v101
  v_lshlrev_b32 v76, 16, v102
  v_and_b32 v77, 0xffff0000, v102
  v_lshlrev_b32 v78, 16, v103
  v_and_b32 v79, 0xffff0000, v103
  v_add_f32 v64, v64, v72
  v_add_f32 v65, v65, v73
  v_add_f32 v66, v66, v74
  v_add_f32 v67, v67, v75
  v_add_f32 v68, v68, v76
  v_add_f32 v69, v69, v77
  v_add_f32 v70, v70, v78
  v_add_f32 v71, v71, v79
  s_waitcnt vmcnt(21)
  v_bitop3_b32 v16, v16, v104, v105 bitop3:0x80
  v_bitop3_b32 v16, v16, v106, v107 bitop3:0x80
  v_lshlrev_b32 v72, 16, v104
  v_and_b32 v73, 0xffff0000, v104
  v_lshlrev_b32 v74, 16, v105
  v_and_b32 v75, 0xffff0000, v105
  v_lshlrev_b32 v76, 16, v106
  v_and_b32 v77, 0xffff0000, v106
  v_lshlrev_b32 v78, 16, v107
  v_and_b32 v79, 0xffff0000, v107
  v_add_f32 v64, v64, v72
  v_add_f32 v65, v65, v73
  v_add_f32 v66, v66, v74
  v_add_f32 v67, v67, v75
  v_add_f32 v68, v68, v76
  v_add_f32 v69, v69, v77
  v_add_f32 v70, v70, v78
  v_add_f32 v71, v71, v79
  s_waitcnt vmcnt(20)
  v_bitop3_b32 v16, v16, v108, v109 bitop3:0x80
  v_bitop3_b32 v16, v16, v110, v111 bitop3:0x80
  v_lshlrev_b32 v72, 16, v108
  v_and_b32 v73, 0xffff0000, v108
  v_lshlrev_b32 v74, 16, v109
  v_and_b32 v75, 0xffff0000, v109
  v_lshlrev_b32 v76, 16, v110
  v_and_b32 v77, 0xffff0000, v110
  v_lshlrev_b32 v78, 16, v111
  v_and_b32 v79, 0xffff0000, v111
  v_add_f32 v64, v64, v72
  v_add_f32 v65, v65, v73
  v_add_f32 v66, v66, v74
  v_add_f32 v67, v67, v75
  v_add_f32 v68, v68, v76
  v_add_f32 v69, v69, v77
  v_add_f32 v70, v70, v78
  v_add_f32 v71, v71, v79
  s_waitcnt vmcnt(19)
  v_bitop3_b32 v16, v16, v112, v113 bitop3:0x80
  v_bitop3_b32 v16, v16, v114, v115 bitop3:0x80
  v_lshlrev_b32 v72, 16, v112
  v_and_b32 v73, 0xffff0000, v112
  v_lshlrev_b32 v74, 16, v113
  v_and_b32 v75, 0xffff0000, v113
  v_lshlrev_b32 v76, 16, v114
  v_and_b32 v77, 0xffff0000, v114
  v_lshlrev_b32 v78, 16, v115
  v_and_b32 v79, 0xffff0000, v115
  v_add_f32 v64, v64, v72
  v_add_f32 v65, v65, v73
  v_add_f32 v66, v66, v74
  v_add_f32 v67, v67, v75
  v_add_f32 v68, v68, v76
  v_add_f32 v69, v69, v77
  v_add_f32 v70, v70, v78
  v_add_f32 v71, v71, v79
  s_waitcnt vmcnt(18)
  v_bitop3_b32 v16, v16, v116, v117 bitop3:0x80
  v_bitop3_b32 v16, v16, v118, v119 bitop3:0x80
  v_lshlrev_b32 v72, 16, v116
  v_and_b32 v73, 0xffff0000, v116
  v_lshlrev_b32 v74, 16, v117
  v_and_b32 v75, 0xffff0000, v117
  v_lshlrev_b32 v76, 16, v118
  v_and_b32 v77, 0xffff0000, v118
  v_lshlrev_b32 v78, 16, v119
  v_and_b32 v79, 0xffff0000, v119
  v_add_f32 v64, v64, v72
  v_add_f32 v65, v65, v73
  v_add_f32 v66, v66, v74
  v_add_f32 v67, v67, v75
  v_add_f32 v68, v68, v76
  v_add_f32 v69, v69, v77
  v_add_f32 v70, v70, v78
  v_add_f32 v71, v71, v79
  s_waitcnt vmcnt(17)
  v_bitop3_b32 v16, v16, v120, v121 bitop3:0x80
  v_bitop3_b32 v16, v16, v122, v123 bitop3:0x80
  v_lshlrev_b32 v72, 16, v120
  v_and_b32 v73, 0xffff0000, v120
  v_lshlrev_b32 v74, 16, v121
  v_and_b32 v75, 0xffff0000, v121
  v_lshlrev_b32 v76, 16, v122
  v_and_b32 v77, 0xffff0000, v122
  v_lshlrev_b32 v78, 16, v123
  v_and_b32 v79, 0xffff0000, v123
  v_add_f32 v64, v64, v72
  v_add_f32 v65, v65, v73
  v_add_f32 v66, v66, v74
  v_add_f32 v67, v67, v75
  v_add_f32 v68, v68, v76
  v_add_f32 v69, v69, v77
  v_add_f32 v70, v70, v78
  v_add_f32 v71, v71, v79
  s_waitcnt vmcnt(16)
  v_bitop3_b32 v16, v16, v124, v125 bitop3:0x80
  v_bitop3_b32 v16, v16, v126, v127 bitop3:0x80
  v_lshlrev_b32 v72, 16, v124
  v_and_b32 v73, 0xffff0000, v124
  v_lshlrev_b32 v74, 16, v125
  v_and_b32 v75, 0xffff0000, v125
  v_lshlrev_b32 v76, 16, v126
  v_and_b32 v77, 0xffff0000, v126
  v_lshlrev_b32 v78, 16, v127
  v_and_b32 v79, 0xffff0000, v127
  v_add_f32 v64, v64, v72
  v_add_f32 v65, v65, v73
  v_add_f32 v66, v66, v74
  v_add_f32 v67, v67, v75
  v_add_f32 v68, v68, v76
  v_add_f32 v69, v69, v77
  v_add_f32 v70, v70, v78
  v_add_f32 v71, v71, v79
  s_waitcnt vmcnt(15)
  v_bitop3_b32 v16, v16, v128, v129 bitop3:0x80
  v_bitop3_b32 v16, v16, v130, v131 bitop3:0x80
  v_lshlrev_b32 v72, 16, v128
  v_and_b32 v73, 0xffff0000, v128
  v_lshlrev_b32 v74, 16, v129
  v_and_b32 v75, 0xffff0000, v129
  v_lshlrev_b32 v76, 16, v130
  v_and_b32 v77, 0xffff0000, v130
  v_lshlrev_b32 v78, 16, v131
  v_and_b32 v79, 0xffff0000, v131
  v_add_f32 v64, v64, v72
  v_add_f32 v65, v65, v73
  v_add_f32 v66, v66, v74
  v_add_f32 v67, v67, v75
  v_add_f32 v68, v68, v76
  v_add_f32 v69, v69, v77
  v_add_f32 v70, v70, v78
  v_add_f32 v71, v71, v79
  s_waitcnt vmcnt(14)
  v_bitop3_b32 v16, v16, v132, v133 bitop3:0x80
  v_bitop3_b32 v16, v16, v134, v135 bitop3:0x80
  v_lshlrev_b32 v72, 16, v132
  v_and_b32 v73, 0xffff0000, v132
  v_lshlrev_b32 v74, 16, v133
  v_and_b32 v75, 0xffff0000, v133
  v_lshlrev_b32 v76, 16, v134
  v_and_b32 v77, 0xffff0000, v134
  v_lshlrev_b32 v78, 16, v135
  v_and_b32 v79, 0xffff0000, v135
  v_add_f32 v64, v64, v72
  v_add_f32 v65, v65, v73
  v_add_f32 v66, v66, v74
  v_add_f32 v67, v67, v75
  v_add_f32 v68, v68, v76
  v_add_f32 v69, v69, v77
  v_add_f32 v70, v70, v78
  v_add_f32 v71, v71, v79
  s_waitcnt vmcnt(13)
  v_bitop3_b32 v16, v16, v136, v137 bitop3:0x80
  v_bitop3_b32 v16, v16, v138, v139 bitop3:0x80
  v_lshlrev_b32 v72, 16, v136
  v_and_b32 v73, 0xffff0000, v136
  v_lshlrev_b32 v74, 16, v137
  v_and_b32 v75, 0xffff0000, v137
  v_lshlrev_b32 v76, 16, v138
  v_and_b32 v77, 0xffff0000, v138
  v_lshlrev_b32 v78, 16, v139
  v_and_b32 v79, 0xffff0000, v139
  v_add_f32 v64, v64, v72
  v_add_f32 v65, v65, v73
  v_add_f32 v66, v66, v74
  v_add_f32 v67, v67, v75
  v_add_f32 v68, v68, v76
  v_add_f32 v69, v69, v77
  v_add_f32 v70, v70, v78
  v_add_f32 v71, v71, v79
  s_waitcnt vmcnt(12)
  v_bitop3_b32 v16, v16, v140, v141 bitop3:0x80
  v_bitop3_b32 v16, v16, v142, v143 bitop3:0x80
  v_lshlrev_b32 v72, 16, v140
  v_and_b32 v73, 0xffff0000, v140
  v_lshlrev_b32 v74, 16, v141
  v_and_b32 v75, 0xffff0000, v141
  v_lshlrev_b32 v76, 16, v142
  v_and_b32 v77, 0xffff0000, v142
  v_lshlrev_b32 v78, 16, v143
  v_and_b32 v79, 0xffff0000, v143
  v_add_f32 v64, v64, v72
  v_add_f32 v65, v65, v73
  v_add_f32 v66, v66, v74
  v_add_f32 v67, v67, v75
  v_add_f32 v68, v68, v76
  v_add_f32 v69, v69, v77
  v_add_f32 v70, v70, v78
  v_add_f32 v71, v71, v79
  s_waitcnt vmcnt(11)
  v_bitop3_b32 v16, v16, v144, v145 bitop3:0x80
  v_bitop3_b32 v16, v16, v146, v147 bitop3:0x80
  v_lshlrev_b32 v72, 16, v144
  v_and_b32 v73, 0xffff0000, v144
  v_lshlrev_b32 v74, 16, v145
  v_and_b32 v75, 0xffff0000, v145
  v_lshlrev_b32 v76, 16, v146
  v_and_b32 v77, 0xffff0000, v146
  v_lshlrev_b32 v78, 16, v147
  v_and_b32 v79, 0xffff0000, v147
  v_add_f32 v64, v64, v72
  v_add_f32 v65, v65, v73
  v_add_f32 v66, v66, v74
  v_add_f32 v67, v67, v75
  v_add_f32 v68, v68, v76
  v_add_f32 v69, v69, v77
  v_add_f32 v70, v70, v78
  v_add_f32 v71, v71, v79
  s_waitcnt vmcnt(10)
  v_bitop3_b32 v16, v16, v148, v149 bitop3:0x80
  v_bitop3_b32 v16, v16, v150, v151 bitop3:0x80
  v_lshlrev_b32 v72, 16, v148
  v_and_b32 v73, 0xffff0000, v148
  v_lshlrev_b32 v74, 16, v149
  v_and_b32 v75, 0xffff0000, v149
  v_lshlrev_b32 v76, 16, v150
  v_and_b32 v77, 0xffff0000, v150
  v_lshlrev_b32 v78, 16, v151
  v_and_b32 v79, 0xffff0000, v151
  v_add_f32 v64, v64, v72
  v_add_f32 v65, v65, v73
  v_add_f32 v66, v66, v74
  v_add_f32 v67, v67, v75
  v_add_f32 v68, v68, v76
  v_add_f32 v69, v69, v77
  v_add_f32 v70, v70, v78
  v_add_f32 v71, v71, v79
  s_waitcnt vmcnt(9)
  v_bitop3_b32 v16, v16, v152, v153 bitop3:0x80
  v_bitop3_b32 v16, v16, v154, v155 bitop3:0x80
  v_lshlrev_b32 v72, 16, v152
  v_and_b32 v73, 0xffff0000, v152
  v_lshlrev_b32 v74, 16, v153
  v_and_b32 v75, 0xffff0000, v153
  v_lshlrev_b32 v76, 16, v154
  v_and_b32 v77, 0xffff0000, v154
  v_lshlrev_b32 v78, 16, v155
  v_and_b32 v79, 0xffff0000, v155
  v_add_f32 v64, v64, v72
  v_add_f32 v65, v65, v73
  v_add_f32 v66, v66, v74
  v_add_f32 v67, v67, v75
  v_add_f32 v68, v68, v76
  v_add_f32 v69, v69, v77
  v_add_f32 v70, v70, v78
  v_add_f32 v71, v71, v79
  s_waitcnt vmcnt(8)
  v_bitop3_b32 v16, v16, v156, v157 bitop3:0x80
  v_bitop3_b32 v16, v16, v158, v159 bitop3:0x80
  v_lshlrev_b32 v72, 16, v156
  v_and_b32 v73, 0xffff0000, v156
  v_lshlrev_b32 v74, 16, v157
  v_and_b32 v75, 0xffff0000, v157
  v_lshlrev_b32 v76, 16, v158
  v_and_b32 v77, 0xffff0000, v158
  v_lshlrev_b32 v78, 16, v159
  v_and_b32 v79, 0xffff0000, v159
  v_add_f32 v64, v64, v72
  v_add_f32 v65, v65, v73
  v_add_f32 v66, v66, v74
  v_add_f32 v67, v67, v75
  v_add_f32 v68, v68, v76
  v_add_f32 v69, v69, v77
  v_add_f32 v70, v70, v78
  v_add_f32 v71, v71, v79
  v_cmp_eq_u32 vcc, 0, v16
  s_sub_u32 s43, s43, 1
  s_cbranch_scc1 K3_gl_ok
  s_cmp_eq_u64 vcc, 0
  s_cbranch_scc1 K3_gl_ok
  s_add_u32 s75, s75, 1
  s_sleep 4
  s_mov_b32 s62, s61
  buffer_load_dwordx4 v[96:99], v3, s[52:55], s62 offen offset:0 sc1
  s_add_u32 s62, s62, 4096
  buffer_load_dwordx4 v[100:103], v3, s[52:55], s62 offen offset:0 sc1
  s_add_u32 s62, s62, 4096
  buffer_load_dwordx4 v[104:107], v3, s[52:55], s62 offen offset:0 sc1
  s_add_u32 s62, s62, 4096
  buffer_load_dwordx4 v[108:111], v3, s[52:55], s62 offen offset:0 sc1
  s_add_u32 s62, s62, 4096
  buffer_load_dwordx4 v[112:115], v3, s[52:55], s62 offen offset:0 sc1
  s_add_u32 s62, s62, 4096
  buffer_load_dwordx4 v[116:119], v3, s[52:55], s62 offen offset:0 sc1
  s_add_u32 s62, s62, 4096
  buffer_load_dwordx4 v[120:123], v3, s[52:55], s62 offen offset:0 sc1
  s_add_u32 s62, s62, 4096
  buffer_load_dwordx4 v[124:127], v3, s[52:55], s62 offen offset:0 sc1
  s_add_u32 s62, s62, 4096
  buffer_load_dwordx4 v[128:131], v3, s[52:55], s62 offen offset:0 sc1
  s_add_u32 s62, s62, 4096
  buffer_load_dwordx4 v[132:135], v3, s[52:55], s62 offen offset:0 sc1
  s_add_u32 s62, s62, 4096
  buffer_load_dwordx4 v[136:139], v3, s[52:55], s62 offen offset:0 sc1
  s_add_u32 s62, s62, 4096
  buffer_load_dwordx4 v[140:143], v3, s[52:55], s62 offen offset:0 sc1
  s_add_u32 s62, s62, 4096
  buffer_load_dwordx4 v[144:147], v3, s[52:55], s62 offen offset:0 sc1
  s_add_u32 s62, s62, 4096
  buffer_load_dwordx4 v[148:151], v3, s[52:55], s62 offen offset:0 sc1
  s_add_u32 s62, s62, 4096
  buffer_load_dwordx4 v[152:155], v3, s[52:55], s62 offen offset:0 sc1
  s_add_u32 s62, s62, 4096
  buffer_load_dwordx4 v[156:159], v3, s[52:55], s62 offen offset:0 sc1
  s_add_u32 s62, s62, 4096
  s_waitcnt vmcnt(0)
  s_branch K3_gl
K3_gl_ok:
  v_cvt_pk_bf16_f32 v40, v64, v65
  v_cvt_pk_bf16_f32 v41, v66, v67
  v_cvt_pk_bf16_f32 v42, v68, v69
  v_cvt_pk_bf16_f32 v43, v70, v71
  s_lshl_b32 s43, s4, 10
  s_add_u32 s43, s43, 34816
  v_add_u32 v5, s43, v3
  ds_write_b128 v5, v[40:43]
  s_lshl_b32 s43, s37, 2
  v_add_u32 v7, s43, v10
  s_lshl_b32 s43, s37, 11
  s_add_u32 s43, s43, 34816
  v_add_u32 v5, s43, v3
  s_waitcnt lgkmcnt(0)
  s_mov_b64 exec, 1
  ds_add_u32 v7, v11 offset:40
  s_mov_b64 exec, -1
  s_mov_b32 s61, 131072
K3_wkt:
  ds_read_b32 v52, v7 offset:40
  s_waitcnt lgkmcnt(0)
  v_readfirstlane_b32 s60, v52
  s_sub_u32 s61, s61, 1
  s_cbranch_scc1 K3_wkt_ok
  s_cmp_lt_u32 s60, 2
  s_cbranch_scc1 K3_wkt
K3_wkt_ok:
  ds_read_b128 v[40:43], v5
  ds_read_b128 v[44:47], v5 offset:1024
  s_waitcnt lgkmcnt(0)
  v_mfma_f32_16x16x32_bf16 v[72:75], v[48:51], v[192:195], 0
  v_mfma_f32_16x16x32_bf16 v[64:67], v[40:43], v[192:195], 0
  v_mfma_f32_16x16x32_bf16 v[68:71], v[44:47], v[192:195], 0
  v_mfma_f32_16x16x32_bf16 v[84:87], v[48:51], v[196:199], 0
  v_mfma_f32_16x16x32_bf16 v[76:79], v[40:43], v[196:199], 0
  v_mfma_f32_16x16x32_bf16 v[80:83], v[44:47], v[196:199], 0
  v_mfma_f32_16x16x32_bf16 v[96:99], v[48:51], v[200:203], 0
  v_mfma_f32_16x16x32_bf16 v[88:91], v[40:43], v[200:203], 0
  v_mfma_f32_16x16x32_bf16 v[92:95], v[44:47], v[200:203], 0
  v_mfma_f32_16x16x32_bf16 v[108:111], v[48:51], v[204:207], 0
  v_mfma_f32_16x16x32_bf16 v[100:103], v[40:43], v[204:207], 0
  v_mfma_f32_16x16x32_bf16 v[104:107], v[44:47], v[204:207], 0
  s_lshl_b32 s60, s12, 3
  s_lshl_b32 s61, s36, 2
  s_add_u32 s60, s60, s61
  s_lshl_b32 s60, s60, 5
  s_add_u32 s60, s60, s15
  s_lshl_b32 s60, s60, 10
  s_mov_b32 s61, 897988541
  v_add_f32 v112, s61, v72
  v_rcp_f32 v112, v112
  v_add_f32 v113, s61, v84
  v_rcp_f32 v113, v113
  v_add_f32 v114, s61, v96
  v_rcp_f32 v114, v114
  v_add_f32 v115, s61, v108
  v_rcp_f32 v115, v115
  v_mul_f32 v64, v64, v112
  v_mul_f32 v65, v65, v112
  v_mul_f32 v66, v66, v112
  v_mul_f32 v67, v67, v112
  v_mul_f32 v68, v68, v112
  v_mul_f32 v69, v69, v112
  v_mul_f32 v70, v70, v112
  v_mul_f32 v71, v71, v112
  v_cvt_pk_bf16_f32 v120, v64, v65
  v_cvt_pk_bf16_f32 v121, v66, v67
  v_cvt_pk_bf16_f32 v122, v68, v69
  v_cvt_pk_bf16_f32 v123, v70, v71
  v_or_b32 v120, 1, v120
  v_or_b32 v121, 1, v121
  v_or_b32 v122, 1, v122
  v_or_b32 v123, 1, v123
  buffer_store_dwordx4 v[120:123], v3, s[48:51], s60 offen sc1
  s_add_u32 s60, s60, 32768
  v_mul_f32 v76, v76, v113
  v_mul_f32 v77, v77, v113
  v_mul_f32 v78, v78, v113
  v_mul_f32 v79, v79, v113
  v_mul_f32 v80, v80, v113
  v_mul_f32 v81, v81, v113
  v_mul_f32 v82, v82, v113
  v_mul_f32 v83, v83, v113
  v_cvt_pk_bf16_f32 v124, v76, v77
  v_cvt_pk_bf16_f32 v125, v78, v79
  v_cvt_pk_bf16_f32 v126, v80, v81
  v_cvt_pk_bf16_f32 v127, v82, v83
  v_or_b32 v124, 1, v124
  v_or_b32 v125, 1, v125
  v_or_b32 v126, 1, v126
  v_or_b32 v127, 1, v127
  buffer_store_dwordx4 v[124:127], v3, s[48:51], s60 offen sc1
  s_add_u32 s60, s60, 32768
  v_mul_f32 v88, v88, v114
  v_mul_f32 v89, v89, v114
  v_mul_f32 v90, v90, v114
  v_mul_f32 v91, v91, v114
  v_mul_f32 v92, v92, v114
  v_mul_f32 v93, v93, v114
  v_mul_f32 v94, v94, v114
  v_mul_f32 v95, v95, v114
  v_cvt_pk_bf16_f32 v128, v88, v89
  v_cvt_pk_bf16_f32 v129, v90, v91
  v_cvt_pk_bf16_f32 v130, v92, v93
  v_cvt_pk_bf16_f32 v131, v94, v95
  v_or_b32 v128, 1, v128
  v_or_b32 v129, 1, v129
  v_or_b32 v130, 1, v130
  v_or_b32 v131, 1, v131
  buffer_store_dwordx4 v[128:131], v3, s[48:51], s60 offen sc1
  s_add_u32 s60, s60, 32768
  v_mul_f32 v100, v100, v115
  v_mul_f32 v101, v101, v115
  v_mul_f32 v102, v102, v115
  v_mul_f32 v103, v103, v115
  v_mul_f32 v104, v104, v115
  v_mul_f32 v105, v105, v115
  v_mul_f32 v106, v106, v115
  v_mul_f32 v107, v107, v115
  v_cvt_pk_bf16_f32 v132, v100, v101
  v_cvt_pk_bf16_f32 v133, v102, v103
  v_cvt_pk_bf16_f32 v134, v104, v105
  v_cvt_pk_bf16_f32 v135, v106, v107
  v_or_b32 v132, 1, v132
  v_or_b32 v133, 1, v133
  v_or_b32 v134, 1, v134
  v_or_b32 v135, 1, v135
  buffer_store_dwordx4 v[132:135], v3, s[48:51], s60 offen sc1
  s_add_u32 s60, s60, 32768
  s_setprio 0
  s_mov_b32 s43, 4000
  v_lshrrev_b32 v5, 1, v2
  v_lshlrev_b32 v5, 7, v5
  v_and_b32 v4, 1, v2
  v_lshl_add_u32 v5, v4, 4, v5
K3_ul:
  s_cmp_lg_u32 s42, 0
  s_cbranch_scc1 K3_ul_done
  buffer_load_dwordx4 v[28:31], v5, s[24:27], 0 offen offset:32 sc1
  s_waitcnt vmcnt(0)
  v_xor_b32 v28, v28, v226
  v_xor_b32 v29, v29, v226
  v_xor_b32 v30, v30, v226
  v_xor_b32 v31, v31, v226
  v_or3_b32 v28, v28, v29, v30
  v_or_b32 v28, v28, v31
  v_cmp_ne_u32 vcc, 0, v28
  s_sub_u32 s43, s43, 1
  s_cbranch_scc1 K3_ul_go
  s_cmp_eq_u64 vcc, 0
  s_cbranch_scc1 K3_ul_go
  s_sleep 4
  s_branch K3_ul
K3_ul_go:
  s_add_u32 m0, s7, 4384
  s_nop 0
  buffer_load_dwordx4 v3, s[44:47], s71 offen offset:0 sc1 lds
  buffer_load_dwordx4 v3, s[44:47], s71 offen offset:1024 sc1 lds
  buffer_load_dwordx4 v3, s[44:47], s71 offen offset:2048 sc1 lds
  buffer_load_dwordx4 v3, s[44:47], s71 offen offset:3072 sc1 lds
  s_mov_b32 s42, 1
  s_waitcnt vmcnt(0) lgkmcnt(0)
  s_mov_b64 exec, 1
  ds_add_u32 v9, v11 offset:8
  s_mov_b64 exec, -1
K3_ul_done:
  s_and_b32 s60, s10, 3
  s_lshl_b32 s60, s60, 2
  s_and_b32 s61, s11, 3
  s_add_u32 s60, s60, s61
  s_lshl_b32 s60, s60, 18
  s_lshr_b32 s61, s11, 2
  s_lshl_b32 s61, s61, 2
  s_add_u32 s61, s61, s4
  s_lshl_b32 s61, s61, 13
  s_add_u32 s63, s60, s61
  v_lshlrev_b32 v8, 7, v2
  s_waitcnt vmcnt(0)
  buffer_load_dword v60, v8, s[48:51], s63 offen
  s_waitcnt vmcnt(0)
  s_mov_b64 exec, 1
  ds_add_u32 v10, v11 offset:48
  s_mov_b64 exec, -1
  s_mov_b32 s61, 131072
K3_wcd:
  s_sleep 1
  ds_read_b32 v16, v9 offset:56
  s_waitcnt lgkmcnt(0)
  v_readfirstlane_b32 s60, v16
  s_sub_u32 s61, s61, 1
  s_cbranch_scc1 K3_wcd_ok
  s_cmp_lt_u32 s60, 1
  s_cbranch_scc1 K3_wcd
K3_wcd_ok:
  s_mov_b32 m0, s7
  s_nop 0
  buffer_load_dwordx4 v232, s[20:23], s69 offen offset:0 lds
  buffer_load_dwordx4 v233, s[20:23], s69 offen offset:1024 lds
  buffer_load_dwordx4 v234, s[20:23], s69 offen offset:2048 lds
  buffer_load_dwordx4 v235, s[20:23], s69 offen offset:3072 lds
  s_add_u32 s69, s69, 262144
  s_waitcnt vmcnt(0)
  s_mov_b64 exec, 1
  ds_add_u32 v10, v11 offset:52
  s_mov_b64 exec, -1
  s_cmp_eq_u32 s40, 1
  s_cbranch_scc1 K3_fin
  s_mov_b32 s61, 131072
K3_wg2:
  s_sleep 2
  ds_read_b32 v16, v9 offset:112
  s_waitcnt lgkmcnt(0)
  v_readfirstlane_b32 s60, v16
  s_sub_u32 s61, s61, 1
  s_cbranch_scc1 K3_wg2_ok
  s_cmp_lt_u32 s60, 1
  s_cbranch_scc1 K3_wg2
K3_wg2_ok:
  s_mov_b32 s40, 2
  s_mov_b32 s43, 4000
K3_post:
  buffer_load_dwordx4 v[16:19], v225, s[44:47], s73 offen sc1
  buffer_load_dwordx4 v[20:23], v225, s[44:47], s65 offen sc1
  buffer_load_dwordx4 v[24:27], v225, s[44:47], s66 offen sc1
  buffer_load_dwordx4 v[28:31], v225, s[44:47], s67 offen sc1
  s_waitcnt vmcnt(0)
  v_bitop3_b32 v48, v16, v17, 1 bitop3:0x80
  v_bitop3_b32 v48, v48, v18, v19 bitop3:0x80
  v_bitop3_b32 v48, v48, v20, v21 bitop3:0x80
  v_bitop3_b32 v48, v48, v22, v23 bitop3:0x80
  v_bitop3_b32 v48, v48, v24, v25 bitop3:0x80
  v_bitop3_b32 v48, v48, v26, v27 bitop3:0x80
  v_bitop3_b32 v48, v48, v28, v29 bitop3:0x80
  v_bitop3_b32 v48, v48, v30, v31 bitop3:0x80
  v_cmp_eq_u32 vcc, 0, v48
  s_nop 0
  s_cmp_eq_u64 vcc, 0
  s_cbranch_scc1 K3_yok
  s_add_u32 s75, s75, 1
  s_cmp_eq_u32 s40, 0
  s_cbranch_scc1 K3_zp_s2
  s_sub_u32 s43, s43, 1
  s_cbranch_scc1 K3_yok
  s_sleep 8
  s_branch K3_post
K3_yok:
  v_lshlrev_b32 v48, 16, v16
  v_lshlrev_b32 v49, 16, v20
  v_lshlrev_b32 v50, 16, v24
  v_lshlrev_b32 v51, 16, v28
  v_lshlrev_b32 v52, 16, v208
  v_and_b32 v53, 0xffff0000, v208
  v_lshlrev_b32 v54, 16, v209
  v_and_b32 v55, 0xffff0000, v209
  v_mul_f32 v48, v48, v52
  v_mul_f32 v49, v49, v53
  v_mul_f32 v50, v50, v54
  v_mul_f32 v51, v51, v55
  v_cvt_pk_bf16_f32 v64, v48, v49
  v_cvt_pk_bf16_f32 v65, v50, v51
  buffer_store_dwordx2 v[64:65], v224, s[32:35], s72 offen
  s_add_u32 s72, s72, 262144
  v_and_b32 v56, 0xffff0000, v16
  v_and_b32 v57, 0xffff0000, v20
  v_and_b32 v58, 0xffff0000, v24
  v_and_b32 v59, 0xffff0000, v28
  v_lshlrev_b32 v60, 16, v210
  v_and_b32 v61, 0xffff0000, v210
  v_lshlrev_b32 v62, 16, v211
  v_and_b32 v63, 0xffff0000, v211
  v_mul_f32 v56, v56, v60
  v_mul_f32 v57, v57, v61
  v_mul_f32 v58, v58, v62
  v_mul_f32 v59, v59, v63
  v_cvt_pk_bf16_f32 v66, v56, v57
  v_cvt_pk_bf16_f32 v67, v58, v59
  buffer_store_dwordx2 v[66:67], v224, s[32:35], s72 offen
  s_add_u32 s72, s72, 262144
  v_lshlrev_b32 v48, 16, v17
  v_lshlrev_b32 v49, 16, v21
  v_lshlrev_b32 v50, 16, v25
  v_lshlrev_b32 v51, 16, v29
  v_lshlrev_b32 v52, 16, v212
  v_and_b32 v53, 0xffff0000, v212
  v_lshlrev_b32 v54, 16, v213
  v_and_b32 v55, 0xffff0000, v213
  v_mul_f32 v48, v48, v52
  v_mul_f32 v49, v49, v53
  v_mul_f32 v50, v50, v54
  v_mul_f32 v51, v51, v55
  v_cvt_pk_bf16_f32 v68, v48, v49
  v_cvt_pk_bf16_f32 v69, v50, v51
  buffer_store_dwordx2 v[68:69], v224, s[32:35], s72 offen
  s_add_u32 s72, s72, 262144
  v_and_b32 v56, 0xffff0000, v17
  v_and_b32 v57, 0xffff0000, v21
  v_and_b32 v58, 0xffff0000, v25
  v_and_b32 v59, 0xffff0000, v29
  v_lshlrev_b32 v60, 16, v214
  v_and_b32 v61, 0xffff0000, v214
  v_lshlrev_b32 v62, 16, v215
  v_and_b32 v63, 0xffff0000, v215
  v_mul_f32 v56, v56, v60
  v_mul_f32 v57, v57, v61
  v_mul_f32 v58, v58, v62
  v_mul_f32 v59, v59, v63
  v_cvt_pk_bf16_f32 v70, v56, v57
  v_cvt_pk_bf16_f32 v71, v58, v59
  buffer_store_dwordx2 v[70:71], v224, s[32:35], s72 offen
  s_add_u32 s72, s72, 262144
  v_lshlrev_b32 v48, 16, v18
  v_lshlrev_b32 v49, 16, v22
  v_lshlrev_b32 v50, 16, v26
  v_lshlrev_b32 v51, 16, v30
  v_lshlrev_b32 v52, 16, v216
  v_and_b32 v53, 0xffff0000, v216
  v_lshlrev_b32 v54, 16, v217
  v_and_b32 v55, 0xffff0000, v217
  v_mul_f32 v48, v48, v52
  v_mul_f32 v49, v49, v53
  v_mul_f32 v50, v50, v54
  v_mul_f32 v51, v51, v55
  v_cvt_pk_bf16_f32 v72, v48, v49
  v_cvt_pk_bf16_f32 v73, v50, v51
  buffer_store_dwordx2 v[72:73], v224, s[32:35], s72 offen
  s_add_u32 s72, s72, 262144
  v_and_b32 v56, 0xffff0000, v18
  v_and_b32 v57, 0xffff0000, v22
  v_and_b32 v58, 0xffff0000, v26
  v_and_b32 v59, 0xffff0000, v30
  v_lshlrev_b32 v60, 16, v218
  v_and_b32 v61, 0xffff0000, v218
  v_lshlrev_b32 v62, 16, v219
  v_and_b32 v63, 0xffff0000, v219
  v_mul_f32 v56, v56, v60
  v_mul_f32 v57, v57, v61
  v_mul_f32 v58, v58, v62
  v_mul_f32 v59, v59, v63
  v_cvt_pk_bf16_f32 v74, v56, v57
  v_cvt_pk_bf16_f32 v75, v58, v59
  buffer_store_dwordx2 v[74:75], v224, s[32:35], s72 offen
  s_add_u32 s72, s72, 262144
  v_lshlrev_b32 v48, 16, v19
  v_lshlrev_b32 v49, 16, v23
  v_lshlrev_b32 v50, 16, v27
  v_lshlrev_b32 v51, 16, v31
  v_lshlrev_b32 v52, 16, v220
  v_and_b32 v53, 0xffff0000, v220
  v_lshlrev_b32 v54, 16, v221
  v_and_b32 v55, 0xffff0000, v221
  v_mul_f32 v48, v48, v52
  v_mul_f32 v49, v49, v53
  v_mul_f32 v50, v50, v54
  v_mul_f32 v51, v51, v55
  v_cvt_pk_bf16_f32 v76, v48, v49
  v_cvt_pk_bf16_f32 v77, v50, v51
  buffer_store_dwordx2 v[76:77], v224, s[32:35], s72 offen
  s_add_u32 s72, s72, 262144
  v_and_b32 v56, 0xffff0000, v19
  v_and_b32 v57, 0xffff0000, v23
  v_and_b32 v58, 0xffff0000, v27
  v_and_b32 v59, 0xffff0000, v31
  v_lshlrev_b32 v60, 16, v222
  v_and_b32 v61, 0xffff0000, v222
  v_lshlrev_b32 v62, 16, v223
  v_and_b32 v63, 0xffff0000, v223
  v_mul_f32 v56, v56, v60
  v_mul_f32 v57, v57, v61
  v_mul_f32 v58, v58, v62
  v_mul_f32 v59, v59, v63
  v_cvt_pk_bf16_f32 v78, v56, v57
  v_cvt_pk_bf16_f32 v79, v58, v59
  buffer_store_dwordx2 v[78:79], v224, s[32:35], s72 offen
  s_add_u32 s72, s72, 262144
  s_mov_b32 s41, s40
  s_mov_b32 s40, 1
  s_cmp_eq_u32 s41, 0
  s_cbranch_scc1 K3_zp
K3_fin:
K3_end:
  s_endpgm
.section .rodata,"a"
.p2align 6
.amdhsa_kernel concat_heads__ssm_conv_h3__linear_attn_block__prompt_kernel
  .amdhsa_next_free_vgpr 252
  .amdhsa_next_free_sgpr 102
  .amdhsa_accum_offset 252
  .amdhsa_group_segment_fixed_size 0
  .amdhsa_kernarg_size 96
  .amdhsa_user_sgpr_count 2
  .amdhsa_user_sgpr_kernarg_segment_ptr 1
  .amdhsa_system_sgpr_workgroup_id_x 1
.end_amdhsa_kernel
```

```asm
; @launch grid=(256,1,1) block=(512,1,1) lds=163840
.amdgcn_target "amdgcn-amd-amdhsa--gfx950"
.text
.globl concat_heads__ssm_conv_h3__linear_attn_block__prompt_kernel
.p2align 8
.type concat_heads__ssm_conv_h3__linear_attn_block__prompt_kernel,@function
concat_heads__ssm_conv_h3__linear_attn_block__prompt_kernel:
K3_code_begin:
  s_cmp_ge_u32 s2, 256
  s_cbranch_scc1 K3_end
  s_load_dwordx8 s[84:91], s[0:1], 32
  s_load_dwordx8 s[92:99], s[0:1], 64
  s_load_dwordx8 s[76:83], s[0:1], 0
  v_lshrrev_b32 v1, 6, v0
  v_and_b32 v2, 63, v0
  s_and_b32 s10, s2, 7
  v_readfirstlane_b32 s3, v1
  s_lshr_b32 s11, s2, 3
  s_and_b32 s12, s10, 1
  s_lshl_b32 s12, s12, 3
  s_and_b32 s13, s11, 7
  s_add_u32 s12, s12, s13
  s_lshr_b32 s13, s10, 1
  s_lshl_b32 s13, s13, 2
  s_lshr_b32 s14, s11, 3
  s_add_u32 s13, s13, s14
  s_mov_b32 s75, 0
  s_and_b32 s4, s3, 3
  s_and_b32 s36, s3, 1
  s_bfe_u32 s37, s3, 0x10001
  s_lshl_b32 s5, s13, 1
  s_add_u32 s5, s5, s37
  s_xor_b32 s15, s5, 2
  s_lshl_b32 s6, s10, 7
  s_lshl_b32 s7, s11, 2
  s_add_u32 s6, s6, s7
  s_add_u32 s6, s6, s4
  s_mul_i32 s7, s4, 8704
  v_lshlrev_b32 v3, 4, v2
  v_lshrrev_b32 v14, 4, v2
  v_and_b32 v15, 15, v2
  s_cmp_ge_u32 s3, 4
  s_cbranch_scc1 K3_L
  s_waitcnt lgkmcnt(0)
  s_cmp_lg_u32 s3, 0
  s_cbranch_scc1 K3_pfw
  s_mov_b32 s40, s88
  s_mov_b32 s41, s89
  s_mov_b32 s42, 4194304
  s_mov_b32 s43, 0x20000
  v_lshrrev_b32 v192, 3, v2
  v_lshlrev_b32 v192, 11, v192
  v_and_b32 v16, 7, v2
  v_lshl_add_u32 v192, v16, 7, v192
  s_lshl_b32 s45, s2, 14
  s_add_u32 s44, s45, 1024
  s_branch K3_pfd
K3_pfw:
  s_mov_b32 s40, s90
  s_mov_b32 s41, s91
  s_mov_b32 s42, 6291456
  s_mov_b32 s43, 0x20000
  v_lshlrev_b32 v192, 7, v2
  s_mul_i32 s45, s2, 12288
  s_sub_u32 s44, s3, 1
  s_lshl_b32 s44, s44, 12
  s_add_u32 s45, s45, s44
  s_add_u32 s44, s45, 3145728
  s_cmp_eq_u32 s3, 3
  s_cselect_b32 s45, 8388608, s45
  s_cselect_b32 s44, 8388608, s44
K3_pfd:
  buffer_load_dword v195, v192, s[40:43], s45 offen
  s_mov_b32 s56, s96
  s_mov_b32 s57, s97
  s_mov_b32 s58, 256
  s_mov_b32 s59, 0x20000
  s_add_u32 s60, s98, 13631488
  s_addc_u32 s61, s99, 0
  s_mov_b32 s62, 4096
  s_mov_b32 s63, 0x20000
  s_memrealtime s[16:17]
  v_mov_b32 v199, 0
  s_waitcnt lgkmcnt(0)
  s_or_b32 s16, s16, 1
  v_mov_b32 v198, s16
  s_cmp_lg_u32 s3, 3
  s_cbranch_scc1 K3_noseed
  s_cmp_lg_u32 s11, 0
  s_cbranch_scc1 K3_noseed
  v_mov_b32 v196, s16
  v_mov_b32 v197, 0
  s_mov_b64 exec, 1
  buffer_atomic_cmpswap v[196:197], v199, s[56:59], 0 offen sc1
  s_mov_b64 exec, -1
K3_noseed:
  s_lshl_b32 s46, s11, 7
  s_lshl_b32 s47, s10, 2
  s_add_u32 s47, s47, s46
  s_cmp_ge_u32 s3, 2
  s_cselect_b32 s48, s80, s78
  s_cselect_b32 s49, s81, s79
  s_mov_b32 s50, 4194304
  s_mov_b32 s51, 0x20000
  v_lshrrev_b32 v193, 2, v2
  v_lshlrev_b32 v193, 11, v193
  v_and_b32 v16, 3, v2
  v_lshl_add_u32 v193, v16, 7, v193
  s_lshr_b32 s45, s2, 2
  s_lshl_b32 s45, s45, 16
  s_lshl_b32 s46, s36, 15
  s_add_u32 s45, s45, s46
  s_and_b32 s46, s2, 3
  s_lshl_b32 s46, s46, 9
  s_add_u32 s45, s45, s46
  s_mov_b32 s45, 16777216
  v_mov_b32 v200, v15
  s_cmp_lg_u32 s3, 0
  s_cbranch_scc1 K3_e3_1
  s_mov_b32 s64, s84
  s_mov_b32 s65, s85
  s_mov_b32 s66, 4194304
  s_mov_b32 s67, 0x20000
  s_lshl_b32 s68, s10, 19
  s_lshl_b32 s69, s11, 14
  s_add_u32 s68, s68, s69
  s_add_u32 s69, s68, 8192
  v_lshlrev_b32 v194, 7, v2
  s_branch K3_e3_done
K3_e3_1:
  s_cmp_lg_u32 s3, 1
  s_cbranch_scc1 K3_e3_2
  s_mov_b32 s64, s76
  s_mov_b32 s65, s77
  s_mov_b32 s66, 4194304
  s_mov_b32 s67, 0x20000
  s_lshl_b32 s68, s11, 17
  s_lshl_b32 s69, s10, 8
  s_add_u32 s68, s68, s69
  s_add_u32 s69, s68, 65536
  v_lshrrev_b32 v194, 1, v2
  v_lshlrev_b32 v194, 11, v194
  v_and_b32 v15, 1, v2
  v_lshl_add_u32 v194, v15, 7, v194
  s_branch K3_e3_done
K3_e3_2:
  s_cmp_lg_u32 s3, 2
  s_cbranch_scc1 K3_e3_3
  s_mov_b32 s64, s92
  s_mov_b32 s65, s93
  s_mov_b32 s66, 2097152
  s_mov_b32 s67, 0x20000
  s_lshl_b32 s68, s11, 16
  s_lshr_b32 s69, s10, 2
  s_lshl_b32 s69, s69, 10
  s_add_u32 s68, s68, s69
  s_add_u32 s69, s68, 16384
  v_lshrrev_b32 v194, 3, v2
  v_lshlrev_b32 v194, 11, v194
  v_and_b32 v15, 7, v2
  v_lshl_add_u32 v194, v15, 7, v194
  s_branch K3_e3_done
K3_e3_3:
  s_mov_b32 s64, s92
  s_mov_b32 s65, s93
  s_mov_b32 s66, 2097152
  s_mov_b32 s67, 0x20000
  s_lshl_b32 s68, s11, 16
  s_lshr_b32 s69, s10, 2
  s_lshl_b32 s69, s69, 10
  s_add_u32 s68, s68, s69
  s_add_u32 s68, s68, 32768
  s_add_u32 s69, s68, 16384
  v_lshrrev_b32 v194, 3, v2
  v_lshlrev_b32 v194, 11, v194
  v_and_b32 v15, 7, v2
  v_lshl_add_u32 v194, v15, 7, v194
K3_e3_done:
  v_mov_b32 v15, v200
  s_and_b32 s55, s11, 3
  s_add_u32 s55, s55, 0
  s_and_b32 s52, s11, 3
  s_add_u32 s52, s52, 4
  s_sub_u32 s52, s52, s55
  s_sub_u32 s52, s52, 1
  s_mov_b32 s54, 0
  s_lshr_b32 s70, s11, 2
  s_and_b32 s70, s70, 3
  s_add_u32 s70, s70, 1000
  s_cmp_lt_u32 s3, 2
  s_cselect_b32 s70, 1000, s70
  s_cmp_eq_u32 s3, 3
  s_cselect_b32 s71, 7, 1000
  s_mov_b32 s53, 0
  s_lshl_b32 s38, s36, 6
  v_add_u32 v16, s38, v15
  v_lshrrev_b32 v17, 1, v15
  v_lshlrev_b32 v16, 7, v16
  v_xor_b32 v17, v14, v17
  v_lshl_add_u32 v4, v17, 4, v16
  v_xor_b32 v5, 64, v4
  v_add_u32 v6, 81920, v4
  v_add_u32 v7, 81920, v5
  v_bfe_u32 v17, v2, 2, 2
  v_and_b32 v18, 3, v2
  v_lshlrev_b32 v17, 6, v17
  v_lshl_add_u32 v17, v18, 3, v17
  v_and_b32 v18, 1, v14
  v_lshl_add_u32 v17, v18, 10, v17
  v_lshl_add_u32 v17, v18, 5, v17
  v_lshrrev_b32 v18, 1, v14
  v_mul_u32_u24 v18, 6144, v18
  v_add_u32 v17, v17, v18
  s_lshl_b32 s38, s37, 8
  s_add_u32 s38, s38, 16384
  v_add_u32 v8, s38, v17
  v_xor_b32 v9, 32, v8
  v_add_u32 v10, 81920, v8
  v_add_u32 v11, 81920, v9
  v_mov_b32 v96, 0
  v_mov_b32 v97, 0
  v_mov_b32 v98, 0
  v_mov_b32 v99, 0
  v_mov_b32 v100, 0
  v_mov_b32 v101, 0
  v_mov_b32 v102, 0
  v_mov_b32 v103, 0
  v_mov_b32 v104, 0
  v_mov_b32 v105, 0
  v_mov_b32 v106, 0
  v_mov_b32 v107, 0
  v_mov_b32 v108, 0
  v_mov_b32 v109, 0
  v_mov_b32 v110, 0
  v_mov_b32 v111, 0
  v_mov_b32 v112, 0
  v_mov_b32 v113, 0
  v_mov_b32 v114, 0
  v_mov_b32 v115, 0
  v_mov_b32 v116, 0
  v_mov_b32 v117, 0
  v_mov_b32 v118, 0
  v_mov_b32 v119, 0
  v_mov_b32 v120, 0
  v_mov_b32 v121, 0
  v_mov_b32 v122, 0
  v_mov_b32 v123, 0
  v_mov_b32 v124, 0
  v_mov_b32 v125, 0
  v_mov_b32 v126, 0
  v_mov_b32 v127, 0
  v_mov_b32 v128, 0
  v_mov_b32 v129, 0
  v_mov_b32 v130, 0
  v_mov_b32 v131, 0
  v_mov_b32 v132, 0
  v_mov_b32 v133, 0
  v_mov_b32 v134, 0
  v_mov_b32 v135, 0
  v_mov_b32 v136, 0
  v_mov_b32 v137, 0
  v_mov_b32 v138, 0
  v_mov_b32 v139, 0
  v_mov_b32 v140, 0
  v_mov_b32 v141, 0
  v_mov_b32 v142, 0
  v_mov_b32 v143, 0
  v_mov_b32 v144, 0
  v_mov_b32 v145, 0
  v_mov_b32 v146, 0
  v_mov_b32 v147, 0
  v_mov_b32 v148, 0
  v_mov_b32 v149, 0
  v_mov_b32 v150, 0
  v_mov_b32 v151, 0
  v_mov_b32 v152, 0
  v_mov_b32 v153, 0
  v_mov_b32 v154, 0
  v_mov_b32 v155, 0
  v_mov_b32 v156, 0
  v_mov_b32 v157, 0
  v_mov_b32 v158, 0
  v_mov_b32 v159, 0
  v_mov_b32 v160, 0
  v_mov_b32 v161, 0
  v_mov_b32 v162, 0
  v_mov_b32 v163, 0
  v_mov_b32 v164, 0
  v_mov_b32 v165, 0
  v_mov_b32 v166, 0
  v_mov_b32 v167, 0
  v_mov_b32 v168, 0
  v_mov_b32 v169, 0
  v_mov_b32 v170, 0
  v_mov_b32 v171, 0
  v_mov_b32 v172, 0
  v_mov_b32 v173, 0
  v_mov_b32 v174, 0
  v_mov_b32 v175, 0
  v_mov_b32 v176, 0
  v_mov_b32 v177, 0
  v_mov_b32 v178, 0
  v_mov_b32 v179, 0
  v_mov_b32 v180, 0
  v_mov_b32 v181, 0
  v_mov_b32 v182, 0
  v_mov_b32 v183, 0
  v_mov_b32 v184, 0
  v_mov_b32 v185, 0
  v_mov_b32 v186, 0
  v_mov_b32 v187, 0
  v_mov_b32 v188, 0
  v_mov_b32 v189, 0
  v_mov_b32 v190, 0
  v_mov_b32 v191, 0
  s_waitcnt lgkmcnt(0)
  s_add_u32 s28, s98, 8388608
  s_addc_u32 s29, s99, 0
  s_mov_b32 s30, 2097152
  s_mov_b32 s31, 0x20000
  s_add_u32 s32, s98, 12582912
  s_addc_u32 s33, s99, 0
  s_mov_b32 s34, 65536
  s_mov_b32 s35, 0x20000
  s_barrier
  ds_read_b128 v[16:19], v4 offset:0
  ds_read_b64_tr_b16 v[32:33], v8 offset:0
  ds_read_b64_tr_b16 v[34:35], v8 offset:512
  ds_read_b128 v[20:23], v4 offset:2048
  ds_read_b128 v[24:27], v4 offset:4096
  ds_read_b128 v[28:31], v4 offset:6144
  ds_read_b64_tr_b16 v[36:37], v9 offset:0
  ds_read_b64_tr_b16 v[38:39], v9 offset:512
  ds_read_b64_tr_b16 v[40:41], v8 offset:2048
  ds_read_b64_tr_b16 v[42:43], v8 offset:2560
  ds_read_b64_tr_b16 v[44:45], v9 offset:2048
  ds_read_b64_tr_b16 v[46:47], v9 offset:2560
  ds_read_b64_tr_b16 v[48:49], v8 offset:4096
  ds_read_b64_tr_b16 v[50:51], v8 offset:4608
  ds_read_b64_tr_b16 v[52:53], v9 offset:4096
  ds_read_b64_tr_b16 v[54:55], v9 offset:4608
  s_waitcnt lgkmcnt(0)
  s_mov_b32 s39, 4
K3_loop:
  v_mfma_f32_16x16x32_bf16 v[96:99], v[32:35], v[16:19], v[96:99]
  ds_read_b128 v[56:59], v5 offset:0
  v_mfma_f32_16x16x32_bf16 v[104:107], v[32:35], v[20:23], v[104:107]
  ds_read_b64_tr_b16 v[72:73], v8 offset:12288
  v_mfma_f32_16x16x32_bf16 v[112:115], v[32:35], v[24:27], v[112:115]
  ds_read_b64_tr_b16 v[74:75], v8 offset:12800
  v_mfma_f32_16x16x32_bf16 v[120:123], v[32:35], v[28:31], v[120:123]
  ds_read_b128 v[60:63], v5 offset:2048
  v_mfma_f32_16x16x32_bf16 v[100:103], v[36:39], v[16:19], v[100:103]
  ds_read_b128 v[64:67], v5 offset:4096
  v_mfma_f32_16x16x32_bf16 v[108:111], v[36:39], v[20:23], v[108:111]
  ds_read_b128 v[68:71], v5 offset:6144
  v_mfma_f32_16x16x32_bf16 v[116:119], v[36:39], v[24:27], v[116:119]
  ds_read_b64_tr_b16 v[76:77], v9 offset:12288
  v_mfma_f32_16x16x32_bf16 v[124:127], v[36:39], v[28:31], v[124:127]
  ds_read_b64_tr_b16 v[78:79], v9 offset:12800
  v_mfma_f32_16x16x32_bf16 v[128:131], v[16:19], v[40:43], v[128:131]
  ds_read_b64_tr_b16 v[80:81], v8 offset:14336
  v_mfma_f32_16x16x32_bf16 v[136:139], v[20:23], v[40:43], v[136:139]
  ds_read_b64_tr_b16 v[82:83], v8 offset:14848
  v_mfma_f32_16x16x32_bf16 v[144:147], v[24:27], v[40:43], v[144:147]
  ds_read_b64_tr_b16 v[84:85], v9 offset:14336
  v_mfma_f32_16x16x32_bf16 v[152:155], v[28:31], v[40:43], v[152:155]
  ds_read_b64_tr_b16 v[86:87], v9 offset:14848
  v_mfma_f32_16x16x32_bf16 v[132:135], v[16:19], v[44:47], v[132:135]
  ds_read_b64_tr_b16 v[88:89], v8 offset:16384
  v_mfma_f32_16x16x32_bf16 v[140:143], v[20:23], v[44:47], v[140:143]
  ds_read_b64_tr_b16 v[90:91], v8 offset:16896
  v_mfma_f32_16x16x32_bf16 v[148:151], v[24:27], v[44:47], v[148:151]
  ds_read_b64_tr_b16 v[92:93], v9 offset:16384
  v_mfma_f32_16x16x32_bf16 v[156:159], v[28:31], v[44:47], v[156:159]
  ds_read_b64_tr_b16 v[94:95], v9 offset:16896
  v_mfma_f32_16x16x32_bf16 v[160:163], v[16:19], v[48:51], v[160:163]
  v_mfma_f32_16x16x32_bf16 v[168:171], v[20:23], v[48:51], v[168:171]
  v_mfma_f32_16x16x32_bf16 v[176:179], v[24:27], v[48:51], v[176:179]
  v_mfma_f32_16x16x32_bf16 v[184:187], v[28:31], v[48:51], v[184:187]
  v_mfma_f32_16x16x32_bf16 v[164:167], v[16:19], v[52:55], v[164:167]
  v_mfma_f32_16x16x32_bf16 v[172:175], v[20:23], v[52:55], v[172:175]
  v_mfma_f32_16x16x32_bf16 v[180:183], v[24:27], v[52:55], v[180:183]
  v_mfma_f32_16x16x32_bf16 v[188:191], v[28:31], v[52:55], v[188:191]
  s_waitcnt lgkmcnt(0)
  s_barrier
  s_sub_u32 s55, s55, 1
  s_cbranch_scc1 K3_event0
K3_noev0:
  s_sub_u32 s70, s70, 1
  s_cbranch_scc1 K3_evB0
K3_noevB0:
  s_sub_u32 s71, s71, 1
  s_cbranch_scc1 K3_evC0
K3_noevC0:
  v_mfma_f32_16x16x32_bf16 v[96:99], v[72:75], v[56:59], v[96:99]
  ds_read_b128 v[16:19], v4 offset:40960
  v_mfma_f32_16x16x32_bf16 v[104:107], v[72:75], v[60:63], v[104:107]
  ds_read_b64_tr_b16 v[32:33], v8 offset:40960
  v_mfma_f32_16x16x32_bf16 v[112:115], v[72:75], v[64:67], v[112:115]
  ds_read_b64_tr_b16 v[34:35], v8 offset:41472
  v_mfma_f32_16x16x32_bf16 v[120:123], v[72:75], v[68:71], v[120:123]
  ds_read_b128 v[20:23], v4 offset:43008
  v_mfma_f32_16x16x32_bf16 v[100:103], v[76:79], v[56:59], v[100:103]
  ds_read_b128 v[24:27], v4 offset:45056
  v_mfma_f32_16x16x32_bf16 v[108:111], v[76:79], v[60:63], v[108:111]
  ds_read_b128 v[28:31], v4 offset:47104
  v_mfma_f32_16x16x32_bf16 v[116:119], v[76:79], v[64:67], v[116:119]
  ds_read_b64_tr_b16 v[36:37], v9 offset:40960
  v_mfma_f32_16x16x32_bf16 v[124:127], v[76:79], v[68:71], v[124:127]
  ds_read_b64_tr_b16 v[38:39], v9 offset:41472
  v_mfma_f32_16x16x32_bf16 v[128:131], v[56:59], v[80:83], v[128:131]
  ds_read_b64_tr_b16 v[40:41], v8 offset:43008
  v_mfma_f32_16x16x32_bf16 v[136:139], v[60:63], v[80:83], v[136:139]
  ds_read_b64_tr_b16 v[42:43], v8 offset:43520
  v_mfma_f32_16x16x32_bf16 v[144:147], v[64:67], v[80:83], v[144:147]
  ds_read_b64_tr_b16 v[44:45], v9 offset:43008
  v_mfma_f32_16x16x32_bf16 v[152:155], v[68:71], v[80:83], v[152:155]
  ds_read_b64_tr_b16 v[46:47], v9 offset:43520
  v_mfma_f32_16x16x32_bf16 v[132:135], v[56:59], v[84:87], v[132:135]
  ds_read_b64_tr_b16 v[48:49], v8 offset:45056
  v_mfma_f32_16x16x32_bf16 v[140:143], v[60:63], v[84:87], v[140:143]
  ds_read_b64_tr_b16 v[50:51], v8 offset:45568
  v_mfma_f32_16x16x32_bf16 v[148:151], v[64:67], v[84:87], v[148:151]
  ds_read_b64_tr_b16 v[52:53], v9 offset:45056
  v_mfma_f32_16x16x32_bf16 v[156:159], v[68:71], v[84:87], v[156:159]
  ds_read_b64_tr_b16 v[54:55], v9 offset:45568
  v_mfma_f32_16x16x32_bf16 v[160:163], v[56:59], v[88:91], v[160:163]
  v_mfma_f32_16x16x32_bf16 v[168:171], v[60:63], v[88:91], v[168:171]
  v_mfma_f32_16x16x32_bf16 v[176:179], v[64:67], v[88:91], v[176:179]
  v_mfma_f32_16x16x32_bf16 v[184:187], v[68:71], v[88:91], v[184:187]
  v_mfma_f32_16x16x32_bf16 v[164:167], v[56:59], v[92:95], v[164:167]
  v_mfma_f32_16x16x32_bf16 v[172:175], v[60:63], v[92:95], v[172:175]
  v_mfma_f32_16x16x32_bf16 v[180:183], v[64:67], v[92:95], v[180:183]
  v_mfma_f32_16x16x32_bf16 v[188:191], v[68:71], v[92:95], v[188:191]
  s_waitcnt lgkmcnt(13)
  v_mfma_f32_16x16x32_bf16 v[96:99], v[32:35], v[16:19], v[96:99]
  ds_read_b128 v[56:59], v5 offset:40960
  s_waitcnt lgkmcnt(13)
  v_mfma_f32_16x16x32_bf16 v[104:107], v[32:35], v[20:23], v[104:107]
  ds_read_b64_tr_b16 v[72:73], v8 offset:53248
  s_waitcnt lgkmcnt(13)
  v_mfma_f32_16x16x32_bf16 v[112:115], v[32:35], v[24:27], v[112:115]
  ds_read_b64_tr_b16 v[74:75], v8 offset:53760
  s_waitcnt lgkmcnt(13)
  v_mfma_f32_16x16x32_bf16 v[120:123], v[32:35], v[28:31], v[120:123]
  ds_read_b128 v[60:63], v5 offset:43008
  s_waitcnt lgkmcnt(12)
  v_mfma_f32_16x16x32_bf16 v[100:103], v[36:39], v[16:19], v[100:103]
  ds_read_b128 v[64:67], v5 offset:45056
  v_mfma_f32_16x16x32_bf16 v[108:111], v[36:39], v[20:23], v[108:111]
  ds_read_b128 v[68:71], v5 offset:47104
  v_mfma_f32_16x16x32_bf16 v[116:119], v[36:39], v[24:27], v[116:119]
  ds_read_b64_tr_b16 v[76:77], v9 offset:53248
  v_mfma_f32_16x16x32_bf16 v[124:127], v[36:39], v[28:31], v[124:127]
  ds_read_b64_tr_b16 v[78:79], v9 offset:53760
  s_waitcnt lgkmcnt(14)
  v_mfma_f32_16x16x32_bf16 v[128:131], v[16:19], v[40:43], v[128:131]
  ds_read_b64_tr_b16 v[80:81], v8 offset:55296
  v_mfma_f32_16x16x32_bf16 v[136:139], v[20:23], v[40:43], v[136:139]
  ds_read_b64_tr_b16 v[82:83], v8 offset:55808
  v_mfma_f32_16x16x32_bf16 v[144:147], v[24:27], v[40:43], v[144:147]
  ds_read_b64_tr_b16 v[84:85], v9 offset:55296
  v_mfma_f32_16x16x32_bf16 v[152:155], v[28:31], v[40:43], v[152:155]
  ds_read_b64_tr_b16 v[86:87], v9 offset:55808
  s_waitcnt lgkmcnt(15)
  v_mfma_f32_16x16x32_bf16 v[132:135], v[16:19], v[44:47], v[132:135]
  ds_read_b64_tr_b16 v[88:89], v8 offset:57344
  v_mfma_f32_16x16x32_bf16 v[140:143], v[20:23], v[44:47], v[140:143]
  ds_read_b64_tr_b16 v[90:91], v8 offset:57856
  v_mfma_f32_16x16x32_bf16 v[148:151], v[24:27], v[44:47], v[148:151]
  ds_read_b64_tr_b16 v[92:93], v9 offset:57344
  v_mfma_f32_16x16x32_bf16 v[156:159], v[28:31], v[44:47], v[156:159]
  ds_read_b64_tr_b16 v[94:95], v9 offset:57856
  s_waitcnt lgkmcnt(15)
  v_mfma_f32_16x16x32_bf16 v[160:163], v[16:19], v[48:51], v[160:163]
  v_mfma_f32_16x16x32_bf16 v[168:171], v[20:23], v[48:51], v[168:171]
  v_mfma_f32_16x16x32_bf16 v[176:179], v[24:27], v[48:51], v[176:179]
  v_mfma_f32_16x16x32_bf16 v[184:187], v[28:31], v[48:51], v[184:187]
  v_mfma_f32_16x16x32_bf16 v[164:167], v[16:19], v[52:55], v[164:167]
  v_mfma_f32_16x16x32_bf16 v[172:175], v[20:23], v[52:55], v[172:175]
  v_mfma_f32_16x16x32_bf16 v[180:183], v[24:27], v[52:55], v[180:183]
  v_mfma_f32_16x16x32_bf16 v[188:191], v[28:31], v[52:55], v[188:191]
  s_waitcnt lgkmcnt(0)
  s_barrier
  s_sub_u32 s55, s55, 1
  s_cbranch_scc1 K3_event1
K3_noev1:
  s_sub_u32 s70, s70, 1
  s_cbranch_scc1 K3_evB1
K3_noevB1:
  s_sub_u32 s71, s71, 1
  s_cbranch_scc1 K3_evC1
K3_noevC1:
  v_mfma_f32_16x16x32_bf16 v[96:99], v[72:75], v[56:59], v[96:99]
  ds_read_b128 v[16:19], v6 offset:0
  v_mfma_f32_16x16x32_bf16 v[104:107], v[72:75], v[60:63], v[104:107]
  ds_read_b64_tr_b16 v[32:33], v10 offset:0
  v_mfma_f32_16x16x32_bf16 v[112:115], v[72:75], v[64:67], v[112:115]
  ds_read_b64_tr_b16 v[34:35], v10 offset:512
  v_mfma_f32_16x16x32_bf16 v[120:123], v[72:75], v[68:71], v[120:123]
  ds_read_b128 v[20:23], v6 offset:2048
  v_mfma_f32_16x16x32_bf16 v[100:103], v[76:79], v[56:59], v[100:103]
  ds_read_b128 v[24:27], v6 offset:4096
  v_mfma_f32_16x16x32_bf16 v[108:111], v[76:79], v[60:63], v[108:111]
  ds_read_b128 v[28:31], v6 offset:6144
  v_mfma_f32_16x16x32_bf16 v[116:119], v[76:79], v[64:67], v[116:119]
  ds_read_b64_tr_b16 v[36:37], v11 offset:0
  v_mfma_f32_16x16x32_bf16 v[124:127], v[76:79], v[68:71], v[124:127]
  ds_read_b64_tr_b16 v[38:39], v11 offset:512
  v_mfma_f32_16x16x32_bf16 v[128:131], v[56:59], v[80:83], v[128:131]
  ds_read_b64_tr_b16 v[40:41], v10 offset:2048
  v_mfma_f32_16x16x32_bf16 v[136:139], v[60:63], v[80:83], v[136:139]
  ds_read_b64_tr_b16 v[42:43], v10 offset:2560
  v_mfma_f32_16x16x32_bf16 v[144:147], v[64:67], v[80:83], v[144:147]
  ds_read_b64_tr_b16 v[44:45], v11 offset:2048
  v_mfma_f32_16x16x32_bf16 v[152:155], v[68:71], v[80:83], v[152:155]
  ds_read_b64_tr_b16 v[46:47], v11 offset:2560
  v_mfma_f32_16x16x32_bf16 v[132:135], v[56:59], v[84:87], v[132:135]
  ds_read_b64_tr_b16 v[48:49], v10 offset:4096
  v_mfma_f32_16x16x32_bf16 v[140:143], v[60:63], v[84:87], v[140:143]
  ds_read_b64_tr_b16 v[50:51], v10 offset:4608
  v_mfma_f32_16x16x32_bf16 v[148:151], v[64:67], v[84:87], v[148:151]
  ds_read_b64_tr_b16 v[52:53], v11 offset:4096
  v_mfma_f32_16x16x32_bf16 v[156:159], v[68:71], v[84:87], v[156:159]
  ds_read_b64_tr_b16 v[54:55], v11 offset:4608
  v_mfma_f32_16x16x32_bf16 v[160:163], v[56:59], v[88:91], v[160:163]
  v_mfma_f32_16x16x32_bf16 v[168:171], v[60:63], v[88:91], v[168:171]
  v_mfma_f32_16x16x32_bf16 v[176:179], v[64:67], v[88:91], v[176:179]
  v_mfma_f32_16x16x32_bf16 v[184:187], v[68:71], v[88:91], v[184:187]
  v_mfma_f32_16x16x32_bf16 v[164:167], v[56:59], v[92:95], v[164:167]
  v_mfma_f32_16x16x32_bf16 v[172:175], v[60:63], v[92:95], v[172:175]
  v_mfma_f32_16x16x32_bf16 v[180:183], v[64:67], v[92:95], v[180:183]
  v_mfma_f32_16x16x32_bf16 v[188:191], v[68:71], v[92:95], v[188:191]
  s_waitcnt lgkmcnt(13)
  v_mfma_f32_16x16x32_bf16 v[96:99], v[32:35], v[16:19], v[96:99]
  ds_read_b128 v[56:59], v7 offset:0
  s_waitcnt lgkmcnt(13)
  v_mfma_f32_16x16x32_bf16 v[104:107], v[32:35], v[20:23], v[104:107]
  ds_read_b64_tr_b16 v[72:73], v10 offset:12288
  s_waitcnt lgkmcnt(13)
  v_mfma_f32_16x16x32_bf16 v[112:115], v[32:35], v[24:27], v[112:115]
  ds_read_b64_tr_b16 v[74:75], v10 offset:12800
  s_waitcnt lgkmcnt(13)
  v_mfma_f32_16x16x32_bf16 v[120:123], v[32:35], v[28:31], v[120:123]
  ds_read_b128 v[60:63], v7 offset:2048
  s_waitcnt lgkmcnt(12)
  v_mfma_f32_16x16x32_bf16 v[100:103], v[36:39], v[16:19], v[100:103]
  ds_read_b128 v[64:67], v7 offset:4096
  v_mfma_f32_16x16x32_bf16 v[108:111], v[36:39], v[20:23], v[108:111]
  ds_read_b128 v[68:71], v7 offset:6144
  v_mfma_f32_16x16x32_bf16 v[116:119], v[36:39], v[24:27], v[116:119]
  ds_read_b64_tr_b16 v[76:77], v11 offset:12288
  v_mfma_f32_16x16x32_bf16 v[124:127], v[36:39], v[28:31], v[124:127]
  ds_read_b64_tr_b16 v[78:79], v11 offset:12800
  s_waitcnt lgkmcnt(14)
  v_mfma_f32_16x16x32_bf16 v[128:131], v[16:19], v[40:43], v[128:131]
  ds_read_b64_tr_b16 v[80:81], v10 offset:14336
  v_mfma_f32_16x16x32_bf16 v[136:139], v[20:23], v[40:43], v[136:139]
  ds_read_b64_tr_b16 v[82:83], v10 offset:14848
  v_mfma_f32_16x16x32_bf16 v[144:147], v[24:27], v[40:43], v[144:147]
  ds_read_b64_tr_b16 v[84:85], v11 offset:14336
  v_mfma_f32_16x16x32_bf16 v[152:155], v[28:31], v[40:43], v[152:155]
  ds_read_b64_tr_b16 v[86:87], v11 offset:14848
  s_waitcnt lgkmcnt(15)
  v_mfma_f32_16x16x32_bf16 v[132:135], v[16:19], v[44:47], v[132:135]
  ds_read_b64_tr_b16 v[88:89], v10 offset:16384
  v_mfma_f32_16x16x32_bf16 v[140:143], v[20:23], v[44:47], v[140:143]
  ds_read_b64_tr_b16 v[90:91], v10 offset:16896
  v_mfma_f32_16x16x32_bf16 v[148:151], v[24:27], v[44:47], v[148:151]
  ds_read_b64_tr_b16 v[92:93], v11 offset:16384
  v_mfma_f32_16x16x32_bf16 v[156:159], v[28:31], v[44:47], v[156:159]
  ds_read_b64_tr_b16 v[94:95], v11 offset:16896
  s_waitcnt lgkmcnt(15)
  v_mfma_f32_16x16x32_bf16 v[160:163], v[16:19], v[48:51], v[160:163]
  v_mfma_f32_16x16x32_bf16 v[168:171], v[20:23], v[48:51], v[168:171]
  v_mfma_f32_16x16x32_bf16 v[176:179], v[24:27], v[48:51], v[176:179]
  v_mfma_f32_16x16x32_bf16 v[184:187], v[28:31], v[48:51], v[184:187]
  v_mfma_f32_16x16x32_bf16 v[164:167], v[16:19], v[52:55], v[164:167]
  v_mfma_f32_16x16x32_bf16 v[172:175], v[20:23], v[52:55], v[172:175]
  v_mfma_f32_16x16x32_bf16 v[180:183], v[24:27], v[52:55], v[180:183]
  v_mfma_f32_16x16x32_bf16 v[188:191], v[28:31], v[52:55], v[188:191]
  s_waitcnt lgkmcnt(0)
  s_barrier
  s_sub_u32 s55, s55, 1
  s_cbranch_scc1 K3_event2
K3_noev2:
  s_sub_u32 s70, s70, 1
  s_cbranch_scc1 K3_evB2
K3_noevB2:
  s_sub_u32 s71, s71, 1
  s_cbranch_scc1 K3_evC2
K3_noevC2:
  v_mfma_f32_16x16x32_bf16 v[96:99], v[72:75], v[56:59], v[96:99]
  ds_read_b128 v[16:19], v6 offset:40960
  v_mfma_f32_16x16x32_bf16 v[104:107], v[72:75], v[60:63], v[104:107]
  ds_read_b64_tr_b16 v[32:33], v10 offset:40960
  v_mfma_f32_16x16x32_bf16 v[112:115], v[72:75], v[64:67], v[112:115]
  ds_read_b64_tr_b16 v[34:35], v10 offset:41472
  v_mfma_f32_16x16x32_bf16 v[120:123], v[72:75], v[68:71], v[120:123]
  ds_read_b128 v[20:23], v6 offset:43008
  v_mfma_f32_16x16x32_bf16 v[100:103], v[76:79], v[56:59], v[100:103]
  ds_read_b128 v[24:27], v6 offset:45056
  v_mfma_f32_16x16x32_bf16 v[108:111], v[76:79], v[60:63], v[108:111]
  ds_read_b128 v[28:31], v6 offset:47104
  v_mfma_f32_16x16x32_bf16 v[116:119], v[76:79], v[64:67], v[116:119]
  ds_read_b64_tr_b16 v[36:37], v11 offset:40960
  v_mfma_f32_16x16x32_bf16 v[124:127], v[76:79], v[68:71], v[124:127]
  ds_read_b64_tr_b16 v[38:39], v11 offset:41472
  v_mfma_f32_16x16x32_bf16 v[128:131], v[56:59], v[80:83], v[128:131]
  ds_read_b64_tr_b16 v[40:41], v10 offset:43008
  v_mfma_f32_16x16x32_bf16 v[136:139], v[60:63], v[80:83], v[136:139]
  ds_read_b64_tr_b16 v[42:43], v10 offset:43520
  v_mfma_f32_16x16x32_bf16 v[144:147], v[64:67], v[80:83], v[144:147]
  ds_read_b64_tr_b16 v[44:45], v11 offset:43008
  v_mfma_f32_16x16x32_bf16 v[152:155], v[68:71], v[80:83], v[152:155]
  ds_read_b64_tr_b16 v[46:47], v11 offset:43520
  v_mfma_f32_16x16x32_bf16 v[132:135], v[56:59], v[84:87], v[132:135]
  ds_read_b64_tr_b16 v[48:49], v10 offset:45056
  v_mfma_f32_16x16x32_bf16 v[140:143], v[60:63], v[84:87], v[140:143]
  ds_read_b64_tr_b16 v[50:51], v10 offset:45568
  v_mfma_f32_16x16x32_bf16 v[148:151], v[64:67], v[84:87], v[148:151]
  ds_read_b64_tr_b16 v[52:53], v11 offset:45056
  v_mfma_f32_16x16x32_bf16 v[156:159], v[68:71], v[84:87], v[156:159]
  ds_read_b64_tr_b16 v[54:55], v11 offset:45568
  v_mfma_f32_16x16x32_bf16 v[160:163], v[56:59], v[88:91], v[160:163]
  v_mfma_f32_16x16x32_bf16 v[168:171], v[60:63], v[88:91], v[168:171]
  v_mfma_f32_16x16x32_bf16 v[176:179], v[64:67], v[88:91], v[176:179]
  v_mfma_f32_16x16x32_bf16 v[184:187], v[68:71], v[88:91], v[184:187]
  v_mfma_f32_16x16x32_bf16 v[164:167], v[56:59], v[92:95], v[164:167]
  v_mfma_f32_16x16x32_bf16 v[172:175], v[60:63], v[92:95], v[172:175]
  v_mfma_f32_16x16x32_bf16 v[180:183], v[64:67], v[92:95], v[180:183]
  v_mfma_f32_16x16x32_bf16 v[188:191], v[68:71], v[92:95], v[188:191]
  s_waitcnt lgkmcnt(13)
  v_mfma_f32_16x16x32_bf16 v[96:99], v[32:35], v[16:19], v[96:99]
  ds_read_b128 v[56:59], v7 offset:40960
  s_waitcnt lgkmcnt(13)
  v_mfma_f32_16x16x32_bf16 v[104:107], v[32:35], v[20:23], v[104:107]
  ds_read_b64_tr_b16 v[72:73], v10 offset:53248
  s_waitcnt lgkmcnt(13)
  v_mfma_f32_16x16x32_bf16 v[112:115], v[32:35], v[24:27], v[112:115]
  ds_read_b64_tr_b16 v[74:75], v10 offset:53760
  s_waitcnt lgkmcnt(13)
  v_mfma_f32_16x16x32_bf16 v[120:123], v[32:35], v[28:31], v[120:123]
  ds_read_b128 v[60:63], v7 offset:43008
  s_waitcnt lgkmcnt(12)
  v_mfma_f32_16x16x32_bf16 v[100:103], v[36:39], v[16:19], v[100:103]
  ds_read_b128 v[64:67], v7 offset:45056
  v_mfma_f32_16x16x32_bf16 v[108:111], v[36:39], v[20:23], v[108:111]
  ds_read_b128 v[68:71], v7 offset:47104
  v_mfma_f32_16x16x32_bf16 v[116:119], v[36:39], v[24:27], v[116:119]
  ds_read_b64_tr_b16 v[76:77], v11 offset:53248
  v_mfma_f32_16x16x32_bf16 v[124:127], v[36:39], v[28:31], v[124:127]
  ds_read_b64_tr_b16 v[78:79], v11 offset:53760
  s_waitcnt lgkmcnt(14)
  v_mfma_f32_16x16x32_bf16 v[128:131], v[16:19], v[40:43], v[128:131]
  ds_read_b64_tr_b16 v[80:81], v10 offset:55296
  v_mfma_f32_16x16x32_bf16 v[136:139], v[20:23], v[40:43], v[136:139]
  ds_read_b64_tr_b16 v[82:83], v10 offset:55808
  v_mfma_f32_16x16x32_bf16 v[144:147], v[24:27], v[40:43], v[144:147]
  ds_read_b64_tr_b16 v[84:85], v11 offset:55296
  v_mfma_f32_16x16x32_bf16 v[152:155], v[28:31], v[40:43], v[152:155]
  ds_read_b64_tr_b16 v[86:87], v11 offset:55808
  s_waitcnt lgkmcnt(15)
  v_mfma_f32_16x16x32_bf16 v[132:135], v[16:19], v[44:47], v[132:135]
  ds_read_b64_tr_b16 v[88:89], v10 offset:57344
  v_mfma_f32_16x16x32_bf16 v[140:143], v[20:23], v[44:47], v[140:143]
  ds_read_b64_tr_b16 v[90:91], v10 offset:57856
  v_mfma_f32_16x16x32_bf16 v[148:151], v[24:27], v[44:47], v[148:151]
  ds_read_b64_tr_b16 v[92:93], v11 offset:57344
  v_mfma_f32_16x16x32_bf16 v[156:159], v[28:31], v[44:47], v[156:159]
  ds_read_b64_tr_b16 v[94:95], v11 offset:57856
  s_waitcnt lgkmcnt(15)
  v_mfma_f32_16x16x32_bf16 v[160:163], v[16:19], v[48:51], v[160:163]
  v_mfma_f32_16x16x32_bf16 v[168:171], v[20:23], v[48:51], v[168:171]
  v_mfma_f32_16x16x32_bf16 v[176:179], v[24:27], v[48:51], v[176:179]
  v_mfma_f32_16x16x32_bf16 v[184:187], v[28:31], v[48:51], v[184:187]
  v_mfma_f32_16x16x32_bf16 v[164:167], v[16:19], v[52:55], v[164:167]
  v_mfma_f32_16x16x32_bf16 v[172:175], v[20:23], v[52:55], v[172:175]
  v_mfma_f32_16x16x32_bf16 v[180:183], v[24:27], v[52:55], v[180:183]
  v_mfma_f32_16x16x32_bf16 v[188:191], v[28:31], v[52:55], v[188:191]
  s_waitcnt lgkmcnt(0)
  s_barrier
  s_sub_u32 s55, s55, 1
  s_cbranch_scc1 K3_event3
K3_noev3:
  s_sub_u32 s70, s70, 1
  s_cbranch_scc1 K3_evB3
K3_noevB3:
  s_sub_u32 s71, s71, 1
  s_cbranch_scc1 K3_evC3
K3_noevC3:
  v_mfma_f32_16x16x32_bf16 v[96:99], v[72:75], v[56:59], v[96:99]
  ds_read_b128 v[16:19], v4 offset:0
  v_mfma_f32_16x16x32_bf16 v[104:107], v[72:75], v[60:63], v[104:107]
  ds_read_b64_tr_b16 v[32:33], v8 offset:0
  v_mfma_f32_16x16x32_bf16 v[112:115], v[72:75], v[64:67], v[112:115]
  ds_read_b64_tr_b16 v[34:35], v8 offset:512
  v_mfma_f32_16x16x32_bf16 v[120:123], v[72:75], v[68:71], v[120:123]
  ds_read_b128 v[20:23], v4 offset:2048
  v_mfma_f32_16x16x32_bf16 v[100:103], v[76:79], v[56:59], v[100:103]
  ds_read_b128 v[24:27], v4 offset:4096
  v_mfma_f32_16x16x32_bf16 v[108:111], v[76:79], v[60:63], v[108:111]
  ds_read_b128 v[28:31], v4 offset:6144
  v_mfma_f32_16x16x32_bf16 v[116:119], v[76:79], v[64:67], v[116:119]
  ds_read_b64_tr_b16 v[36:37], v9 offset:0
  v_mfma_f32_16x16x32_bf16 v[124:127], v[76:79], v[68:71], v[124:127]
  ds_read_b64_tr_b16 v[38:39], v9 offset:512
  v_mfma_f32_16x16x32_bf16 v[128:131], v[56:59], v[80:83], v[128:131]
  ds_read_b64_tr_b16 v[40:41], v8 offset:2048
  v_mfma_f32_16x16x32_bf16 v[136:139], v[60:63], v[80:83], v[136:139]
  ds_read_b64_tr_b16 v[42:43], v8 offset:2560
  v_mfma_f32_16x16x32_bf16 v[144:147], v[64:67], v[80:83], v[144:147]
  ds_read_b64_tr_b16 v[44:45], v9 offset:2048
  v_mfma_f32_16x16x32_bf16 v[152:155], v[68:71], v[80:83], v[152:155]
  ds_read_b64_tr_b16 v[46:47], v9 offset:2560
  v_mfma_f32_16x16x32_bf16 v[132:135], v[56:59], v[84:87], v[132:135]
  ds_read_b64_tr_b16 v[48:49], v8 offset:4096
  v_mfma_f32_16x16x32_bf16 v[140:143], v[60:63], v[84:87], v[140:143]
  ds_read_b64_tr_b16 v[50:51], v8 offset:4608
  v_mfma_f32_16x16x32_bf16 v[148:151], v[64:67], v[84:87], v[148:151]
  ds_read_b64_tr_b16 v[52:53], v9 offset:4096
  v_mfma_f32_16x16x32_bf16 v[156:159], v[68:71], v[84:87], v[156:159]
  ds_read_b64_tr_b16 v[54:55], v9 offset:4608
  v_mfma_f32_16x16x32_bf16 v[160:163], v[56:59], v[88:91], v[160:163]
  v_mfma_f32_16x16x32_bf16 v[168:171], v[60:63], v[88:91], v[168:171]
  v_mfma_f32_16x16x32_bf16 v[176:179], v[64:67], v[88:91], v[176:179]
  v_mfma_f32_16x16x32_bf16 v[184:187], v[68:71], v[88:91], v[184:187]
  v_mfma_f32_16x16x32_bf16 v[164:167], v[56:59], v[92:95], v[164:167]
  v_mfma_f32_16x16x32_bf16 v[172:175], v[60:63], v[92:95], v[172:175]
  v_mfma_f32_16x16x32_bf16 v[180:183], v[64:67], v[92:95], v[180:183]
  v_mfma_f32_16x16x32_bf16 v[188:191], v[68:71], v[92:95], v[188:191]
  s_sub_u32 s39, s39, 1
  s_cmp_lg_u32 s39, 0
  s_waitcnt lgkmcnt(0)
  s_cbranch_scc1 K3_loop
  s_mov_b32 s44, 1069066811
  s_mov_b32 s45, 1069066811
  s_mov_b32 s46, 897988541
  s_mov_b32 s47, 897988541
  v_mov_b32 v10, 38912
  v_mov_b32 v11, 1
  v_cvt_pk_bf16_f32 v16, v160, v161
  v_cvt_pk_bf16_f32 v17, v162, v163
  v_cvt_pk_bf16_f32 v18, v168, v169
  v_cvt_pk_bf16_f32 v19, v170, v171
  v_cvt_pk_bf16_f32 v20, v176, v177
  v_cvt_pk_bf16_f32 v21, v178, v179
  v_cvt_pk_bf16_f32 v22, v184, v185
  v_cvt_pk_bf16_f32 v23, v186, v187
  v_cvt_pk_bf16_f32 v24, v164, v165
  v_cvt_pk_bf16_f32 v25, v166, v167
  v_cvt_pk_bf16_f32 v26, v172, v173
  v_cvt_pk_bf16_f32 v27, v174, v175
  v_cvt_pk_bf16_f32 v28, v180, v181
  v_cvt_pk_bf16_f32 v29, v182, v183
  v_cvt_pk_bf16_f32 v30, v188, v189
  v_cvt_pk_bf16_f32 v31, v190, v191
  v_mov_b32 v48, 0x3f803f80
  v_mov_b32 v49, 0x3f803f80
  v_mov_b32 v50, 0x3f803f80
  v_mov_b32 v51, 0x3f803f80
  v_cvt_pk_bf16_f32 v52, v128, v129
  v_cvt_pk_bf16_f32 v53, v130, v131
  v_cvt_pk_bf16_f32 v54, v136, v137
  v_cvt_pk_bf16_f32 v55, v138, v139
  v_lshlrev_b32 v56, 16, v52
  v_and_b32 v57, 0xffff0000, v52
  v_lshlrev_b32 v58, 16, v53
  v_and_b32 v59, 0xffff0000, v53
  v_lshlrev_b32 v60, 16, v54
  v_and_b32 v61, 0xffff0000, v54
  v_lshlrev_b32 v62, 16, v55
  v_and_b32 v63, 0xffff0000, v55
  v_min_f32 v64, 0, v56
  v_min_f32 v65, 0, v57
  v_min_f32 v66, 0, v58
  v_min_f32 v67, 0, v59
  v_min_f32 v68, 0, v60
  v_min_f32 v69, 0, v61
  v_min_f32 v70, 0, v62
  v_min_f32 v71, 0, v63
  v_pk_mul_f32 v[72:73], v[64:65], s[44:45]
  v_pk_mul_f32 v[74:75], v[66:67], s[44:45]
  v_pk_mul_f32 v[76:77], v[68:69], s[44:45]
  v_pk_mul_f32 v[78:79], v[70:71], s[44:45]
  v_exp_f32 v72, v72
  v_exp_f32 v73, v73
  v_exp_f32 v74, v74
  v_exp_f32 v75, v75
  v_exp_f32 v76, v76
  v_exp_f32 v77, v77
  v_exp_f32 v78, v78
  v_exp_f32 v79, v79
  v_pk_add_f32 v[56:57], v[56:57], v[64:65] neg_lo:[0,1] neg_hi:[0,1]
  v_pk_add_f32 v[58:59], v[58:59], v[66:67] neg_lo:[0,1] neg_hi:[0,1]
  v_pk_add_f32 v[60:61], v[60:61], v[68:69] neg_lo:[0,1] neg_hi:[0,1]
  v_pk_add_f32 v[62:63], v[62:63], v[70:71] neg_lo:[0,1] neg_hi:[0,1]
  v_pk_add_f32 v[56:57], v[56:57], v[72:73]
  v_pk_add_f32 v[58:59], v[58:59], v[74:75]
  v_pk_add_f32 v[60:61], v[60:61], v[76:77]
  v_pk_add_f32 v[62:63], v[62:63], v[78:79]
  v_pk_add_f32 v[56:57], v[56:57], s[46:47]
  v_pk_add_f32 v[58:59], v[58:59], s[46:47]
  v_pk_add_f32 v[60:61], v[60:61], s[46:47]
  v_pk_add_f32 v[62:63], v[62:63], s[46:47]
  v_cvt_pk_bf16_f32 v32, v56, v57
  v_cvt_pk_bf16_f32 v33, v58, v59
  v_cvt_pk_bf16_f32 v34, v60, v61
  v_cvt_pk_bf16_f32 v35, v62, v63
  s_nop 1
  v_mfma_f32_16x16x32_bf16 v[160:163], v[32:35], v[16:19], 0
  v_mfma_f32_16x16x32_bf16 v[168:171], v[32:35], v[24:27], 0
  v_mfma_f32_16x16x32_bf16 v[176:179], v[32:35], v[48:51], 0
  v_cvt_pk_bf16_f32 v52, v132, v133
  v_cvt_pk_bf16_f32 v53, v134, v135
  v_cvt_pk_bf16_f32 v54, v140, v141
  v_cvt_pk_bf16_f32 v55, v142, v143
  v_lshlrev_b32 v56, 16, v52
  v_and_b32 v57, 0xffff0000, v52
  v_lshlrev_b32 v58, 16, v53
  v_and_b32 v59, 0xffff0000, v53
  v_lshlrev_b32 v60, 16, v54
  v_and_b32 v61, 0xffff0000, v54
  v_lshlrev_b32 v62, 16, v55
  v_and_b32 v63, 0xffff0000, v55
  v_min_f32 v64, 0, v56
  v_min_f32 v65, 0, v57
  v_min_f32 v66, 0, v58
  v_min_f32 v67, 0, v59
  v_min_f32 v68, 0, v60
  v_min_f32 v69, 0, v61
  v_min_f32 v70, 0, v62
  v_min_f32 v71, 0, v63
  v_pk_mul_f32 v[72:73], v[64:65], s[44:45]
  v_pk_mul_f32 v[74:75], v[66:67], s[44:45]
  v_pk_mul_f32 v[76:77], v[68:69], s[44:45]
  v_pk_mul_f32 v[78:79], v[70:71], s[44:45]
  v_exp_f32 v72, v72
  v_exp_f32 v73, v73
  v_exp_f32 v74, v74
  v_exp_f32 v75, v75
  v_exp_f32 v76, v76
  v_exp_f32 v77, v77
  v_exp_f32 v78, v78
  v_exp_f32 v79, v79
  v_pk_add_f32 v[56:57], v[56:57], v[64:65] neg_lo:[0,1] neg_hi:[0,1]
  v_pk_add_f32 v[58:59], v[58:59], v[66:67] neg_lo:[0,1] neg_hi:[0,1]
  v_pk_add_f32 v[60:61], v[60:61], v[68:69] neg_lo:[0,1] neg_hi:[0,1]
  v_pk_add_f32 v[62:63], v[62:63], v[70:71] neg_lo:[0,1] neg_hi:[0,1]
  v_pk_add_f32 v[56:57], v[56:57], v[72:73]
  v_pk_add_f32 v[58:59], v[58:59], v[74:75]
  v_pk_add_f32 v[60:61], v[60:61], v[76:77]
  v_pk_add_f32 v[62:63], v[62:63], v[78:79]
  v_pk_add_f32 v[56:57], v[56:57], s[46:47]
  v_pk_add_f32 v[58:59], v[58:59], s[46:47]
  v_pk_add_f32 v[60:61], v[60:61], s[46:47]
  v_pk_add_f32 v[62:63], v[62:63], s[46:47]
  v_cvt_pk_bf16_f32 v40, v56, v57
  v_cvt_pk_bf16_f32 v41, v58, v59
  v_cvt_pk_bf16_f32 v42, v60, v61
  v_cvt_pk_bf16_f32 v43, v62, v63
  s_nop 1
  v_mfma_f32_16x16x32_bf16 v[164:167], v[40:43], v[16:19], 0
  v_mfma_f32_16x16x32_bf16 v[172:175], v[40:43], v[24:27], 0
  v_mfma_f32_16x16x32_bf16 v[180:183], v[40:43], v[48:51], 0
  v_cvt_pk_bf16_f32 v52, v144, v145
  v_cvt_pk_bf16_f32 v53, v146, v147
  v_cvt_pk_bf16_f32 v54, v152, v153
  v_cvt_pk_bf16_f32 v55, v154, v155
  v_lshlrev_b32 v56, 16, v52
  v_and_b32 v57, 0xffff0000, v52
  v_lshlrev_b32 v58, 16, v53
  v_and_b32 v59, 0xffff0000, v53
  v_lshlrev_b32 v60, 16, v54
  v_and_b32 v61, 0xffff0000, v54
  v_lshlrev_b32 v62, 16, v55
  v_and_b32 v63, 0xffff0000, v55
  v_min_f32 v64, 0, v56
  v_min_f32 v65, 0, v57
  v_min_f32 v66, 0, v58
  v_min_f32 v67, 0, v59
  v_min_f32 v68, 0, v60
  v_min_f32 v69, 0, v61
  v_min_f32 v70, 0, v62
  v_min_f32 v71, 0, v63
  v_pk_mul_f32 v[72:73], v[64:65], s[44:45]
  v_pk_mul_f32 v[74:75], v[66:67], s[44:45]
  v_pk_mul_f32 v[76:77], v[68:69], s[44:45]
  v_pk_mul_f32 v[78:79], v[70:71], s[44:45]
  v_exp_f32 v72, v72
  v_exp_f32 v73, v73
  v_exp_f32 v74, v74
  v_exp_f32 v75, v75
  v_exp_f32 v76, v76
  v_exp_f32 v77, v77
  v_exp_f32 v78, v78
  v_exp_f32 v79, v79
  v_pk_add_f32 v[56:57], v[56:57], v[64:65] neg_lo:[0,1] neg_hi:[0,1]
  v_pk_add_f32 v[58:59], v[58:59], v[66:67] neg_lo:[0,1] neg_hi:[0,1]
  v_pk_add_f32 v[60:61], v[60:61], v[68:69] neg_lo:[0,1] neg_hi:[0,1]
  v_pk_add_f32 v[62:63], v[62:63], v[70:71] neg_lo:[0,1] neg_hi:[0,1]
  v_pk_add_f32 v[56:57], v[56:57], v[72:73]
  v_pk_add_f32 v[58:59], v[58:59], v[74:75]
  v_pk_add_f32 v[60:61], v[60:61], v[76:77]
  v_pk_add_f32 v[62:63], v[62:63], v[78:79]
  v_pk_add_f32 v[56:57], v[56:57], s[46:47]
  v_pk_add_f32 v[58:59], v[58:59], s[46:47]
  v_pk_add_f32 v[60:61], v[60:61], s[46:47]
  v_pk_add_f32 v[62:63], v[62:63], s[46:47]
  v_cvt_pk_bf16_f32 v36, v56, v57
  v_cvt_pk_bf16_f32 v37, v58, v59
  v_cvt_pk_bf16_f32 v38, v60, v61
  v_cvt_pk_bf16_f32 v39, v62, v63
  s_nop 1
  v_mfma_f32_16x16x32_bf16 v[160:163], v[36:39], v[20:23], v[160:163]
  v_mfma_f32_16x16x32_bf16 v[168:171], v[36:39], v[28:31], v[168:171]
  v_mfma_f32_16x16x32_bf16 v[176:179], v[36:39], v[48:51], v[176:179]
  v_cvt_pk_bf16_f32 v52, v148, v149
  v_cvt_pk_bf16_f32 v53, v150, v151
  v_cvt_pk_bf16_f32 v54, v156, v157
  v_cvt_pk_bf16_f32 v55, v158, v159
  v_lshlrev_b32 v56, 16, v52
  v_and_b32 v57, 0xffff0000, v52
  v_lshlrev_b32 v58, 16, v53
  v_and_b32 v59, 0xffff0000, v53
  v_lshlrev_b32 v60, 16, v54
  v_and_b32 v61, 0xffff0000, v54
  v_lshlrev_b32 v62, 16, v55
  v_and_b32 v63, 0xffff0000, v55
  v_min_f32 v64, 0, v56
  v_min_f32 v65, 0, v57
  v_min_f32 v66, 0, v58
  v_min_f32 v67, 0, v59
  v_min_f32 v68, 0, v60
  v_min_f32 v69, 0, v61
  v_min_f32 v70, 0, v62
  v_min_f32 v71, 0, v63
  v_pk_mul_f32 v[72:73], v[64:65], s[44:45]
  v_pk_mul_f32 v[74:75], v[66:67], s[44:45]
  v_pk_mul_f32 v[76:77], v[68:69], s[44:45]
  v_pk_mul_f32 v[78:79], v[70:71], s[44:45]
  v_exp_f32 v72, v72
  v_exp_f32 v73, v73
  v_exp_f32 v74, v74
  v_exp_f32 v75, v75
  v_exp_f32 v76, v76
  v_exp_f32 v77, v77
  v_exp_f32 v78, v78
  v_exp_f32 v79, v79
  v_pk_add_f32 v[56:57], v[56:57], v[64:65] neg_lo:[0,1] neg_hi:[0,1]
  v_pk_add_f32 v[58:59], v[58:59], v[66:67] neg_lo:[0,1] neg_hi:[0,1]
  v_pk_add_f32 v[60:61], v[60:61], v[68:69] neg_lo:[0,1] neg_hi:[0,1]
  v_pk_add_f32 v[62:63], v[62:63], v[70:71] neg_lo:[0,1] neg_hi:[0,1]
  v_pk_add_f32 v[56:57], v[56:57], v[72:73]
  v_pk_add_f32 v[58:59], v[58:59], v[74:75]
  v_pk_add_f32 v[60:61], v[60:61], v[76:77]
  v_pk_add_f32 v[62:63], v[62:63], v[78:79]
  v_pk_add_f32 v[56:57], v[56:57], s[46:47]
  v_pk_add_f32 v[58:59], v[58:59], s[46:47]
  v_pk_add_f32 v[60:61], v[60:61], s[46:47]
  v_pk_add_f32 v[62:63], v[62:63], s[46:47]
  v_cvt_pk_bf16_f32 v44, v56, v57
  v_cvt_pk_bf16_f32 v45, v58, v59
  v_cvt_pk_bf16_f32 v46, v60, v61
  v_cvt_pk_bf16_f32 v47, v62, v63
  s_nop 1
  v_mfma_f32_16x16x32_bf16 v[164:167], v[44:47], v[20:23], v[164:167]
  v_mfma_f32_16x16x32_bf16 v[172:175], v[44:47], v[28:31], v[172:175]
  v_mfma_f32_16x16x32_bf16 v[180:183], v[44:47], v[48:51], v[180:183]
  s_lshl_b32 s43, s37, 12
  s_add_u32 s43, s43, 155648
  v_add_u32 v4, s43, v3
  s_lshl_b32 s43, s37, 7
  s_add_u32 s43, s43, 39168
  v_lshlrev_b32 v5, 5, v14
  v_add_u32 v5, s43, v5
  s_lshl_b32 s43, s37, 2
  v_add_u32 v6, s43, v10
  s_cmp_eq_u32 s36, 0
  s_cbranch_scc1 K3_wr0
  ds_write_b128 v4, v[160:163] offset:0
  ds_write_b128 v4, v[164:167] offset:1024
  ds_write_b128 v4, v[168:171] offset:2048
  ds_write_b128 v4, v[172:175] offset:3072
  ds_write_b128 v5, v[176:179] offset:0
  ds_write_b128 v5, v[180:183] offset:16
  s_waitcnt lgkmcnt(0)
  s_mov_b64 exec, 1
  ds_add_u32 v6, v11 offset:0
  s_mov_b64 exec, -1
  s_branch K3_q
K3_wr0:
  s_lshl_b32 s48, s5, 4
  s_add_u32 s48, s48, s12
  s_lshl_b32 s49, s48, 12
  s_lshl_b32 s50, s48, 7
  v_lshlrev_b32 v7, 4, v14
  s_mov_b32 s43, 131072
K3_wx:
  ds_read_b32 v8, v6 offset:0
  s_waitcnt lgkmcnt(0)
  v_readfirstlane_b32 s42, v8
  s_sub_u32 s43, s43, 1
  s_cbranch_scc1 K3_wx_ok
  s_cmp_lt_u32 s42, 1
  s_cbranch_scc1 K3_wx
K3_wx_ok:
  ds_read_b128 v[16:19], v4 offset:0
  ds_read_b128 v[20:23], v4 offset:1024
  ds_read_b128 v[24:27], v4 offset:2048
  ds_read_b128 v[28:31], v4 offset:3072
  ds_read_b128 v[32:35], v5 offset:0
  ds_read_b128 v[36:39], v5 offset:16
  s_waitcnt lgkmcnt(5)
  v_pk_add_f32 v[160:161], v[160:161], v[16:17]
  v_pk_add_f32 v[162:163], v[162:163], v[18:19]
  v_cvt_pk_bf16_f32 v40, v160, v161
  v_cvt_pk_bf16_f32 v41, v162, v163
  v_or_b32 v40, 1, v40
  v_or_b32 v41, 1, v41
  s_waitcnt lgkmcnt(4)
  v_pk_add_f32 v[164:165], v[164:165], v[20:21]
  v_pk_add_f32 v[166:167], v[166:167], v[22:23]
  v_cvt_pk_bf16_f32 v42, v164, v165
  v_cvt_pk_bf16_f32 v43, v166, v167
  v_or_b32 v42, 1, v42
  v_or_b32 v43, 1, v43
  buffer_store_dwordx4 v[40:43], v3, s[28:31], s49 offen offset:0 sc1
  s_waitcnt lgkmcnt(3)
  v_pk_add_f32 v[168:169], v[168:169], v[24:25]
  v_pk_add_f32 v[170:171], v[170:171], v[26:27]
  v_cvt_pk_bf16_f32 v44, v168, v169
  v_cvt_pk_bf16_f32 v45, v170, v171
  v_or_b32 v44, 1, v44
  v_or_b32 v45, 1, v45
  s_waitcnt lgkmcnt(2)
  v_pk_add_f32 v[172:173], v[172:173], v[28:29]
  v_pk_add_f32 v[174:175], v[174:175], v[30:31]
  v_cvt_pk_bf16_f32 v46, v172, v173
  v_cvt_pk_bf16_f32 v47, v174, v175
  v_or_b32 v46, 1, v46
  v_or_b32 v47, 1, v47
  buffer_store_dwordx4 v[44:47], v3, s[28:31], s49 offen offset:1024 sc1
  s_waitcnt lgkmcnt(1)
  v_pk_add_f32 v[176:177], v[176:177], v[32:33]
  v_pk_add_f32 v[178:179], v[178:179], v[34:35]
  v_or_b32 v176, 1, v176
  v_or_b32 v177, 1, v177
  v_or_b32 v178, 1, v178
  v_or_b32 v179, 1, v179
  s_waitcnt lgkmcnt(0)
  v_pk_add_f32 v[180:181], v[180:181], v[36:37]
  v_pk_add_f32 v[182:183], v[182:183], v[38:39]
  v_or_b32 v180, 1, v180
  v_or_b32 v181, 1, v181
  v_or_b32 v182, 1, v182
  v_or_b32 v183, 1, v183
  s_mov_b32 exec_lo, 0x00010001
  s_mov_b32 exec_hi, 0x00010001
  buffer_store_dwordx4 v[176:179], v7, s[32:35], s50 offen offset:0 sc1
  buffer_store_dwordx4 v[180:183], v7, s[32:35], s50 offen offset:64 sc1
  s_mov_b64 exec, -1
  s_mov_b64 exec, 1
  ds_add_u32 v10, v11 offset:84
  s_mov_b64 exec, -1
K3_q:
  s_lshl_b32 s43, s3, 12
  s_add_u32 s43, s43, 139264
  v_add_u32 v4, s43, v3
  v_cvt_pk_bf16_f32 v52, v96, v97
  v_cvt_pk_bf16_f32 v53, v98, v99
  v_cvt_pk_bf16_f32 v54, v100, v101
  v_cvt_pk_bf16_f32 v55, v102, v103
  v_lshlrev_b32 v56, 16, v52
  v_and_b32 v57, 0xffff0000, v52
  v_lshlrev_b32 v58, 16, v53
  v_and_b32 v59, 0xffff0000, v53
  v_lshlrev_b32 v60, 16, v54
  v_and_b32 v61, 0xffff0000, v54
  v_lshlrev_b32 v62, 16, v55
  v_and_b32 v63, 0xffff0000, v55
  v_min_f32 v64, 0, v56
  v_min_f32 v65, 0, v57
  v_min_f32 v66, 0, v58
  v_min_f32 v67, 0, v59
  v_min_f32 v68, 0, v60
  v_min_f32 v69, 0, v61
  v_min_f32 v70, 0, v62
  v_min_f32 v71, 0, v63
  v_pk_mul_f32 v[72:73], v[64:65], s[44:45]
  v_pk_mul_f32 v[74:75], v[66:67], s[44:45]
  v_pk_mul_f32 v[76:77], v[68:69], s[44:45]
  v_pk_mul_f32 v[78:79], v[70:71], s[44:45]
  v_exp_f32 v72, v72
  v_exp_f32 v73, v73
  v_exp_f32 v74, v74
  v_exp_f32 v75, v75
  v_exp_f32 v76, v76
  v_exp_f32 v77, v77
  v_exp_f32 v78, v78
  v_exp_f32 v79, v79
  v_pk_add_f32 v[56:57], v[56:57], v[64:65] neg_lo:[0,1] neg_hi:[0,1]
  v_pk_add_f32 v[58:59], v[58:59], v[66:67] neg_lo:[0,1] neg_hi:[0,1]
  v_pk_add_f32 v[60:61], v[60:61], v[68:69] neg_lo:[0,1] neg_hi:[0,1]
  v_pk_add_f32 v[62:63], v[62:63], v[70:71] neg_lo:[0,1] neg_hi:[0,1]
  v_pk_add_f32 v[56:57], v[56:57], v[72:73]
  v_pk_add_f32 v[58:59], v[58:59], v[74:75]
  v_pk_add_f32 v[60:61], v[60:61], v[76:77]
  v_pk_add_f32 v[62:63], v[62:63], v[78:79]
  v_pk_add_f32 v[56:57], v[56:57], s[46:47]
  v_pk_add_f32 v[58:59], v[58:59], s[46:47]
  v_pk_add_f32 v[60:61], v[60:61], s[46:47]
  v_pk_add_f32 v[62:63], v[62:63], s[46:47]
  v_cvt_pk_bf16_f32 v80, v56, v57
  v_cvt_pk_bf16_f32 v81, v58, v59
  v_cvt_pk_bf16_f32 v82, v60, v61
  v_cvt_pk_bf16_f32 v83, v62, v63
  ds_write_b128 v4, v[80:83] offset:0
  v_cvt_pk_bf16_f32 v52, v104, v105
  v_cvt_pk_bf16_f32 v53, v106, v107
  v_cvt_pk_bf16_f32 v54, v108, v109
  v_cvt_pk_bf16_f32 v55, v110, v111
  v_lshlrev_b32 v56, 16, v52
  v_and_b32 v57, 0xffff0000, v52
  v_lshlrev_b32 v58, 16, v53
  v_and_b32 v59, 0xffff0000, v53
  v_lshlrev_b32 v60, 16, v54
  v_and_b32 v61, 0xffff0000, v54
  v_lshlrev_b32 v62, 16, v55
  v_and_b32 v63, 0xffff0000, v55
  v_min_f32 v64, 0, v56
  v_min_f32 v65, 0, v57
  v_min_f32 v66, 0, v58
  v_min_f32 v67, 0, v59
  v_min_f32 v68, 0, v60
  v_min_f32 v69, 0, v61
  v_min_f32 v70, 0, v62
  v_min_f32 v71, 0, v63
  v_pk_mul_f32 v[72:73], v[64:65], s[44:45]
  v_pk_mul_f32 v[74:75], v[66:67], s[44:45]
  v_pk_mul_f32 v[76:77], v[68:69], s[44:45]
  v_pk_mul_f32 v[78:79], v[70:71], s[44:45]
  v_exp_f32 v72, v72
  v_exp_f32 v73, v73
  v_exp_f32 v74, v74
  v_exp_f32 v75, v75
  v_exp_f32 v76, v76
  v_exp_f32 v77, v77
  v_exp_f32 v78, v78
  v_exp_f32 v79, v79
  v_pk_add_f32 v[56:57], v[56:57], v[64:65] neg_lo:[0,1] neg_hi:[0,1]
  v_pk_add_f32 v[58:59], v[58:59], v[66:67] neg_lo:[0,1] neg_hi:[0,1]
  v_pk_add_f32 v[60:61], v[60:61], v[68:69] neg_lo:[0,1] neg_hi:[0,1]
  v_pk_add_f32 v[62:63], v[62:63], v[70:71] neg_lo:[0,1] neg_hi:[0,1]
  v_pk_add_f32 v[56:57], v[56:57], v[72:73]
  v_pk_add_f32 v[58:59], v[58:59], v[74:75]
  v_pk_add_f32 v[60:61], v[60:61], v[76:77]
  v_pk_add_f32 v[62:63], v[62:63], v[78:79]
  v_pk_add_f32 v[56:57], v[56:57], s[46:47]
  v_pk_add_f32 v[58:59], v[58:59], s[46:47]
  v_pk_add_f32 v[60:61], v[60:61], s[46:47]
  v_pk_add_f32 v[62:63], v[62:63], s[46:47]
  v_cvt_pk_bf16_f32 v84, v56, v57
  v_cvt_pk_bf16_f32 v85, v58, v59
  v_cvt_pk_bf16_f32 v86, v60, v61
  v_cvt_pk_bf16_f32 v87, v62, v63
  ds_write_b128 v4, v[84:87] offset:1024
  v_cvt_pk_bf16_f32 v52, v112, v113
  v_cvt_pk_bf16_f32 v53, v114, v115
  v_cvt_pk_bf16_f32 v54, v116, v117
  v_cvt_pk_bf16_f32 v55, v118, v119
  v_lshlrev_b32 v56, 16, v52
  v_and_b32 v57, 0xffff0000, v52
  v_lshlrev_b32 v58, 16, v53
  v_and_b32 v59, 0xffff0000, v53
  v_lshlrev_b32 v60, 16, v54
  v_and_b32 v61, 0xffff0000, v54
  v_lshlrev_b32 v62, 16, v55
  v_and_b32 v63, 0xffff0000, v55
  v_min_f32 v64, 0, v56
  v_min_f32 v65, 0, v57
  v_min_f32 v66, 0, v58
  v_min_f32 v67, 0, v59
  v_min_f32 v68, 0, v60
  v_min_f32 v69, 0, v61
  v_min_f32 v70, 0, v62
  v_min_f32 v71, 0, v63
  v_pk_mul_f32 v[72:73], v[64:65], s[44:45]
  v_pk_mul_f32 v[74:75], v[66:67], s[44:45]
  v_pk_mul_f32 v[76:77], v[68:69], s[44:45]
  v_pk_mul_f32 v[78:79], v[70:71], s[44:45]
  v_exp_f32 v72, v72
  v_exp_f32 v73, v73
  v_exp_f32 v74, v74
  v_exp_f32 v75, v75
  v_exp_f32 v76, v76
  v_exp_f32 v77, v77
  v_exp_f32 v78, v78
  v_exp_f32 v79, v79
  v_pk_add_f32 v[56:57], v[56:57], v[64:65] neg_lo:[0,1] neg_hi:[0,1]
  v_pk_add_f32 v[58:59], v[58:59], v[66:67] neg_lo:[0,1] neg_hi:[0,1]
  v_pk_add_f32 v[60:61], v[60:61], v[68:69] neg_lo:[0,1] neg_hi:[0,1]
  v_pk_add_f32 v[62:63], v[62:63], v[70:71] neg_lo:[0,1] neg_hi:[0,1]
  v_pk_add_f32 v[56:57], v[56:57], v[72:73]
  v_pk_add_f32 v[58:59], v[58:59], v[74:75]
  v_pk_add_f32 v[60:61], v[60:61], v[76:77]
  v_pk_add_f32 v[62:63], v[62:63], v[78:79]
  v_pk_add_f32 v[56:57], v[56:57], s[46:47]
  v_pk_add_f32 v[58:59], v[58:59], s[46:47]
  v_pk_add_f32 v[60:61], v[60:61], s[46:47]
  v_pk_add_f32 v[62:63], v[62:63], s[46:47]
  v_cvt_pk_bf16_f32 v88, v56, v57
  v_cvt_pk_bf16_f32 v89, v58, v59
  v_cvt_pk_bf16_f32 v90, v60, v61
  v_cvt_pk_bf16_f32 v91, v62, v63
  ds_write_b128 v4, v[88:91] offset:2048
  v_cvt_pk_bf16_f32 v52, v120, v121
  v_cvt_pk_bf16_f32 v53, v122, v123
  v_cvt_pk_bf16_f32 v54, v124, v125
  v_cvt_pk_bf16_f32 v55, v126, v127
  v_lshlrev_b32 v56, 16, v52
  v_and_b32 v57, 0xffff0000, v52
  v_lshlrev_b32 v58, 16, v53
  v_and_b32 v59, 0xffff0000, v53
  v_lshlrev_b32 v60, 16, v54
  v_and_b32 v61, 0xffff0000, v54
  v_lshlrev_b32 v62, 16, v55
  v_and_b32 v63, 0xffff0000, v55
  v_min_f32 v64, 0, v56
  v_min_f32 v65, 0, v57
  v_min_f32 v66, 0, v58
  v_min_f32 v67, 0, v59
  v_min_f32 v68, 0, v60
  v_min_f32 v69, 0, v61
  v_min_f32 v70, 0, v62
  v_min_f32 v71, 0, v63
  v_pk_mul_f32 v[72:73], v[64:65], s[44:45]
  v_pk_mul_f32 v[74:75], v[66:67], s[44:45]
  v_pk_mul_f32 v[76:77], v[68:69], s[44:45]
  v_pk_mul_f32 v[78:79], v[70:71], s[44:45]
  v_exp_f32 v72, v72
  v_exp_f32 v73, v73
  v_exp_f32 v74, v74
  v_exp_f32 v75, v75
  v_exp_f32 v76, v76
  v_exp_f32 v77, v77
  v_exp_f32 v78, v78
  v_exp_f32 v79, v79
  v_pk_add_f32 v[56:57], v[56:57], v[64:65] neg_lo:[0,1] neg_hi:[0,1]
  v_pk_add_f32 v[58:59], v[58:59], v[66:67] neg_lo:[0,1] neg_hi:[0,1]
  v_pk_add_f32 v[60:61], v[60:61], v[68:69] neg_lo:[0,1] neg_hi:[0,1]
  v_pk_add_f32 v[62:63], v[62:63], v[70:71] neg_lo:[0,1] neg_hi:[0,1]
  v_pk_add_f32 v[56:57], v[56:57], v[72:73]
  v_pk_add_f32 v[58:59], v[58:59], v[74:75]
  v_pk_add_f32 v[60:61], v[60:61], v[76:77]
  v_pk_add_f32 v[62:63], v[62:63], v[78:79]
  v_pk_add_f32 v[56:57], v[56:57], s[46:47]
  v_pk_add_f32 v[58:59], v[58:59], s[46:47]
  v_pk_add_f32 v[60:61], v[60:61], s[46:47]
  v_pk_add_f32 v[62:63], v[62:63], s[46:47]
  v_cvt_pk_bf16_f32 v92, v56, v57
  v_cvt_pk_bf16_f32 v93, v58, v59
  v_cvt_pk_bf16_f32 v94, v60, v61
  v_cvt_pk_bf16_f32 v95, v62, v63
  ds_write_b128 v4, v[92:95] offset:3072
  s_lshl_b32 s43, s3, 2
  v_add_u32 v9, s43, v10
  v_and_b32 v6, 3, v2
  v_bfe_u32 v7, v2, 2, 2
  v_add_u32 v12, v6, v7
  v_lshlrev_b32 v12, 3, v12
  v_lshl_add_u32 v12, v14, 6, v12
  s_add_u32 s43, s7, 8
  v_add_u32 v12, s43, v12
  v_lshlrev_b32 v13, 5, v6
  v_lshlrev_b32 v7, 3, v7
  v_sub_u32 v13, v13, v7
  v_lshlrev_b32 v7, 6, v14
  v_sub_u32 v13, v13, v7
  s_add_u32 s43, s7, 4376
  v_add_u32 v13, s43, v13
  s_add_u32 s43, s7, 4384
  v_add_u32 v8, s43, v3
  s_waitcnt lgkmcnt(0)
  s_mov_b64 exec, 1
  ds_add_u32 v9, v11 offset:24
  s_mov_b64 exec, -1
  s_mov_b32 s43, 131072
K3_whu:
  ds_read_b32 v16, v9 offset:8
  s_waitcnt lgkmcnt(0)
  v_readfirstlane_b32 s42, v16
  s_sub_u32 s43, s43, 1
  s_cbranch_scc1 K3_whu_ok
  s_cmp_lt_u32 s42, 1
  s_cbranch_scc1 K3_whu
K3_whu_ok:
  ds_read_b64_tr_b16 v[96:97], v13 offset:32
  ds_read_b64_tr_b16 v[98:99], v13 offset:0
  ds_read_b64_tr_b16 v[32:33], v12 offset:0
  ds_read_b64_tr_b16 v[34:35], v12 offset:32
  ds_read_b64_tr_b16 v[100:101], v13 offset:160
  ds_read_b64_tr_b16 v[102:103], v13 offset:128
  ds_read_b64_tr_b16 v[104:105], v13 offset:288
  ds_read_b64_tr_b16 v[106:107], v13 offset:256
  ds_read_b64_tr_b16 v[36:37], v12 offset:256
  ds_read_b64_tr_b16 v[38:39], v12 offset:288
  s_waitcnt lgkmcnt(6)
  v_mfma_f32_16x16x32_bf16 v[16:19], v[96:99], v[32:35], 0
  ds_read_b64_tr_b16 v[108:109], v13 offset:416
  ds_read_b64_tr_b16 v[110:111], v13 offset:384
  s_waitcnt lgkmcnt(6)
  v_mfma_f32_16x16x32_bf16 v[20:23], v[100:103], v[32:35], 0
  ds_read_b64_tr_b16 v[112:113], v13 offset:544
  ds_read_b64_tr_b16 v[114:115], v13 offset:512
  ds_read_b64_tr_b16 v[40:41], v12 offset:512
  ds_read_b64_tr_b16 v[42:43], v12 offset:544
  s_waitcnt lgkmcnt(8)
  v_mfma_f32_16x16x32_bf16 v[24:27], v[104:107], v[32:35], 0
  ds_read_b64_tr_b16 v[116:117], v13 offset:672
  ds_read_b64_tr_b16 v[118:119], v13 offset:640
  v_add_f32_dpp v224, v19, v18 wave_shr:1 row_mask:0xf bank_mask:0xf bound_ctrl:0
  s_nop 1
  v_add_f32_dpp v226, v224, v17 wave_shr:1 row_mask:0xf bank_mask:0xf bound_ctrl:0
  s_waitcnt lgkmcnt(8)
  v_mfma_f32_16x16x32_bf16 v[24:27], v[96:99], v[36:39], v[24:27]
  v_add_f32_dpp v228, v226, v16 wave_shr:1 row_mask:0xf bank_mask:0xf bound_ctrl:0
  s_waitcnt lgkmcnt(6)
  v_mfma_f32_16x16x32_bf16 v[28:31], v[108:111], v[32:35], 0
  ds_read_b64_tr_b16 v[120:121], v13 offset:800
  ds_read_b64_tr_b16 v[122:123], v13 offset:768
  ds_read_b64_tr_b16 v[44:45], v12 offset:768
  ds_read_b64_tr_b16 v[46:47], v12 offset:800
  v_add_f32_dpp v225, v19, v22 wave_ror:1 row_mask:0xf bank_mask:0xf
  v_add_f32_dpp v227, v224, v21 wave_ror:1 row_mask:0xf bank_mask:0xf
  v_add_f32_dpp v229, v226, v20 wave_ror:1 row_mask:0xf bank_mask:0xf
  v_add_f32_dpp v225, v23, v22 wave_shr:1 row_mask:0xf bank_mask:0xf
  v_mfma_f32_16x16x32_bf16 v[28:31], v[100:103], v[36:39], v[28:31]
  s_nop 0
  v_add_f32_dpp v227, v225, v21 wave_shr:1 row_mask:0xf bank_mask:0xf
  s_nop 1
  v_add_f32_dpp v229, v227, v20 wave_shr:1 row_mask:0xf bank_mask:0xf
  v_cvt_pk_bf16_f32 v232, v228, v229
  v_or_b32 v232, 1, v232
  s_waitcnt lgkmcnt(8)
  v_mfma_f32_16x16x32_bf16 v[16:19], v[112:115], v[32:35], 0
  ds_read_b64_tr_b16 v[124:125], v13 offset:928
  ds_read_b64_tr_b16 v[126:127], v13 offset:896
  v_add_f32_dpp v224, v23, v26 wave_ror:1 row_mask:0xf bank_mask:0xf
  v_add_f32_dpp v226, v225, v25 wave_ror:1 row_mask:0xf bank_mask:0xf
  v_mfma_f32_16x16x32_bf16 v[16:19], v[104:107], v[36:39], v[16:19]
  v_add_f32_dpp v228, v227, v24 wave_ror:1 row_mask:0xf bank_mask:0xf
  v_add_f32_dpp v224, v27, v26 wave_shr:1 row_mask:0xf bank_mask:0xf
  s_waitcnt lgkmcnt(8)
  v_mfma_f32_16x16x32_bf16 v[16:19], v[96:99], v[40:43], v[16:19]
  v_add_f32_dpp v226, v224, v25 wave_shr:1 row_mask:0xf bank_mask:0xf
  s_nop 1
  v_add_f32_dpp v228, v226, v24 wave_shr:1 row_mask:0xf bank_mask:0xf
  s_waitcnt lgkmcnt(6)
  v_mfma_f32_16x16x32_bf16 v[20:23], v[116:119], v[32:35], 0
  ds_read_b64_tr_b16 v[128:129], v13 offset:1056
  ds_read_b64_tr_b16 v[130:131], v13 offset:1024
  ds_read_b64_tr_b16 v[48:49], v12 offset:1024
  ds_read_b64_tr_b16 v[50:51], v12 offset:1056
  v_add_f32_dpp v225, v27, v30 wave_ror:1 row_mask:0xf bank_mask:0xf
  v_add_f32_dpp v227, v224, v29 wave_ror:1 row_mask:0xf bank_mask:0xf
  v_add_f32_dpp v229, v226, v28 wave_ror:1 row_mask:0xf bank_mask:0xf
  v_mfma_f32_16x16x32_bf16 v[20:23], v[108:111], v[36:39], v[20:23]
  v_add_f32_dpp v225, v31, v30 wave_shr:1 row_mask:0xf bank_mask:0xf
  s_nop 1
  v_add_f32_dpp v227, v225, v29 wave_shr:1 row_mask:0xf bank_mask:0xf
  s_nop 1
  v_add_f32_dpp v229, v227, v28 wave_shr:1 row_mask:0xf bank_mask:0xf
  v_mfma_f32_16x16x32_bf16 v[20:23], v[100:103], v[40:43], v[20:23]
  v_cvt_pk_bf16_f32 v233, v228, v229
  v_or_b32 v233, 1, v233
  s_waitcnt lgkmcnt(8)
  v_mfma_f32_16x16x32_bf16 v[24:27], v[120:123], v[32:35], 0
  ds_read_b64_tr_b16 v[132:133], v13 offset:1184
  ds_read_b64_tr_b16 v[134:135], v13 offset:1152
  v_add_f32_dpp v224, v31, v18 wave_ror:1 row_mask:0xf bank_mask:0xf
  v_add_f32_dpp v226, v225, v17 wave_ror:1 row_mask:0xf bank_mask:0xf
  v_mfma_f32_16x16x32_bf16 v[24:27], v[112:115], v[36:39], v[24:27]
  v_add_f32_dpp v228, v227, v16 wave_ror:1 row_mask:0xf bank_mask:0xf
  v_add_f32_dpp v224, v19, v18 wave_shr:1 row_mask:0xf bank_mask:0xf
  v_mfma_f32_16x16x32_bf16 v[24:27], v[104:107], v[40:43], v[24:27]
  s_nop 0
  v_add_f32_dpp v226, v224, v17 wave_shr:1 row_mask:0xf bank_mask:0xf
  s_waitcnt lgkmcnt(8)
  v_mfma_f32_16x16x32_bf16 v[24:27], v[96:99], v[44:47], v[24:27]
  v_add_f32_dpp v228, v226, v16 wave_shr:1 row_mask:0xf bank_mask:0xf
  s_waitcnt lgkmcnt(6)
  v_mfma_f32_16x16x32_bf16 v[28:31], v[124:127], v[32:35], 0
  ds_read_b64_tr_b16 v[136:137], v13 offset:1312
  ds_read_b64_tr_b16 v[138:139], v13 offset:1280
  ds_read_b64_tr_b16 v[52:53], v12 offset:1280
  ds_read_b64_tr_b16 v[54:55], v12 offset:1312
  v_add_f32_dpp v225, v19, v22 wave_ror:1 row_mask:0xf bank_mask:0xf
  v_add_f32_dpp v227, v224, v21 wave_ror:1 row_mask:0xf bank_mask:0xf
  v_mfma_f32_16x16x32_bf16 v[28:31], v[116:119], v[36:39], v[28:31]
  v_add_f32_dpp v229, v226, v20 wave_ror:1 row_mask:0xf bank_mask:0xf
  v_add_f32_dpp v225, v23, v22 wave_shr:1 row_mask:0xf bank_mask:0xf
  v_mfma_f32_16x16x32_bf16 v[28:31], v[108:111], v[40:43], v[28:31]
  s_nop 0
  v_add_f32_dpp v227, v225, v21 wave_shr:1 row_mask:0xf bank_mask:0xf
  s_nop 1
  v_add_f32_dpp v229, v227, v20 wave_shr:1 row_mask:0xf bank_mask:0xf
  v_mfma_f32_16x16x32_bf16 v[28:31], v[100:103], v[44:47], v[28:31]
  v_cvt_pk_bf16_f32 v234, v228, v229
  v_or_b32 v234, 1, v234
  s_waitcnt lgkmcnt(8)
  v_mfma_f32_16x16x32_bf16 v[16:19], v[128:131], v[32:35], 0
  ds_read_b64_tr_b16 v[140:141], v13 offset:1440
  ds_read_b64_tr_b16 v[142:143], v13 offset:1408
  v_add_f32_dpp v224, v23, v26 wave_ror:1 row_mask:0xf bank_mask:0xf
  v_add_f32_dpp v226, v225, v25 wave_ror:1 row_mask:0xf bank_mask:0xf
  v_mfma_f32_16x16x32_bf16 v[16:19], v[120:123], v[36:39], v[16:19]
  v_add_f32_dpp v228, v227, v24 wave_ror:1 row_mask:0xf bank_mask:0xf
  v_mfma_f32_16x16x32_bf16 v[16:19], v[112:115], v[40:43], v[16:19]
  v_add_f32_dpp v224, v27, v26 wave_shr:1 row_mask:0xf bank_mask:0xf
  v_mfma_f32_16x16x32_bf16 v[16:19], v[104:107], v[44:47], v[16:19]
  s_nop 0
  v_add_f32_dpp v226, v224, v25 wave_shr:1 row_mask:0xf bank_mask:0xf
  s_waitcnt lgkmcnt(8)
  v_mfma_f32_16x16x32_bf16 v[16:19], v[96:99], v[48:51], v[16:19]
  v_add_f32_dpp v228, v226, v24 wave_shr:1 row_mask:0xf bank_mask:0xf
  s_waitcnt lgkmcnt(6)
  v_mfma_f32_16x16x32_bf16 v[20:23], v[132:135], v[32:35], 0
  ds_read_b64_tr_b16 v[144:145], v13 offset:1568
  ds_read_b64_tr_b16 v[146:147], v13 offset:1536
  ds_read_b64_tr_b16 v[56:57], v12 offset:1536
  ds_read_b64_tr_b16 v[58:59], v12 offset:1568
  v_add_f32_dpp v225, v27, v30 wave_ror:1 row_mask:0xf bank_mask:0xf
  v_add_f32_dpp v227, v224, v29 wave_ror:1 row_mask:0xf bank_mask:0xf
  v_mfma_f32_16x16x32_bf16 v[20:23], v[124:127], v[36:39], v[20:23]
  v_add_f32_dpp v229, v226, v28 wave_ror:1 row_mask:0xf bank_mask:0xf
  v_add_f32_dpp v225, v31, v30 wave_shr:1 row_mask:0xf bank_mask:0xf
  v_mfma_f32_16x16x32_bf16 v[20:23], v[116:119], v[40:43], v[20:23]
  s_nop 0
  v_add_f32_dpp v227, v225, v29 wave_shr:1 row_mask:0xf bank_mask:0xf
  s_nop 1
  v_add_f32_dpp v229, v227, v28 wave_shr:1 row_mask:0xf bank_mask:0xf
  v_mfma_f32_16x16x32_bf16 v[20:23], v[108:111], v[44:47], v[20:23]
  v_cvt_pk_bf16_f32 v235, v228, v229
  v_mfma_f32_16x16x32_bf16 v[20:23], v[100:103], v[48:51], v[20:23]
  v_or_b32 v235, 1, v235
  s_waitcnt lgkmcnt(8)
  v_mfma_f32_16x16x32_bf16 v[24:27], v[136:139], v[32:35], 0
  ds_read_b64_tr_b16 v[148:149], v13 offset:1696
  ds_read_b64_tr_b16 v[150:151], v13 offset:1664
  v_add_f32_dpp v224, v31, v18 wave_ror:1 row_mask:0xf bank_mask:0xf
  v_mfma_f32_16x16x32_bf16 v[24:27], v[128:131], v[36:39], v[24:27]
  v_add_f32_dpp v226, v225, v17 wave_ror:1 row_mask:0xf bank_mask:0xf
  v_mfma_f32_16x16x32_bf16 v[24:27], v[120:123], v[40:43], v[24:27]
  v_add_f32_dpp v228, v227, v16 wave_ror:1 row_mask:0xf bank_mask:0xf
  v_mfma_f32_16x16x32_bf16 v[24:27], v[112:115], v[44:47], v[24:27]
  v_add_f32_dpp v224, v19, v18 wave_shr:1 row_mask:0xf bank_mask:0xf
  v_mfma_f32_16x16x32_bf16 v[24:27], v[104:107], v[48:51], v[24:27]
  s_nop 0
  v_add_f32_dpp v226, v224, v17 wave_shr:1 row_mask:0xf bank_mask:0xf
  s_waitcnt lgkmcnt(8)
  v_mfma_f32_16x16x32_bf16 v[24:27], v[96:99], v[52:55], v[24:27]
  v_add_f32_dpp v228, v226, v16 wave_shr:1 row_mask:0xf bank_mask:0xf
  s_waitcnt lgkmcnt(6)
  v_mfma_f32_16x16x32_bf16 v[28:31], v[140:143], v[32:35], 0
  ds_read_b64_tr_b16 v[152:153], v13 offset:1824
  ds_read_b64_tr_b16 v[154:155], v13 offset:1792
  ds_read_b64_tr_b16 v[60:61], v12 offset:1792
  ds_read_b64_tr_b16 v[62:63], v12 offset:1824
  v_add_f32_dpp v225, v19, v22 wave_ror:1 row_mask:0xf bank_mask:0xf
  v_add_f32_dpp v227, v224, v21 wave_ror:1 row_mask:0xf bank_mask:0xf
  v_mfma_f32_16x16x32_bf16 v[28:31], v[132:135], v[36:39], v[28:31]
  v_add_f32_dpp v229, v226, v20 wave_ror:1 row_mask:0xf bank_mask:0xf
  v_add_f32_dpp v225, v23, v22 wave_shr:1 row_mask:0xf bank_mask:0xf
  v_mfma_f32_16x16x32_bf16 v[28:31], v[124:127], v[40:43], v[28:31]
  s_nop 0
  v_add_f32_dpp v227, v225, v21 wave_shr:1 row_mask:0xf bank_mask:0xf
  v_mfma_f32_16x16x32_bf16 v[28:31], v[116:119], v[44:47], v[28:31]
  s_nop 0
  v_add_f32_dpp v229, v227, v20 wave_shr:1 row_mask:0xf bank_mask:0xf
  v_mfma_f32_16x16x32_bf16 v[28:31], v[108:111], v[48:51], v[28:31]
  v_cvt_pk_bf16_f32 v236, v228, v229
  v_mfma_f32_16x16x32_bf16 v[28:31], v[100:103], v[52:55], v[28:31]
  v_or_b32 v236, 1, v236
  s_waitcnt lgkmcnt(8)
  v_mfma_f32_16x16x32_bf16 v[16:19], v[144:147], v[32:35], 0
  ds_read_b64_tr_b16 v[156:157], v13 offset:1952
  ds_read_b64_tr_b16 v[158:159], v13 offset:1920
  v_add_f32_dpp v224, v23, v26 wave_ror:1 row_mask:0xf bank_mask:0xf
  v_mfma_f32_16x16x32_bf16 v[16:19], v[136:139], v[36:39], v[16:19]
  v_add_f32_dpp v226, v225, v25 wave_ror:1 row_mask:0xf bank_mask:0xf
  v_mfma_f32_16x16x32_bf16 v[16:19], v[128:131], v[40:43], v[16:19]
  v_add_f32_dpp v228, v227, v24 wave_ror:1 row_mask:0xf bank_mask:0xf
  v_mfma_f32_16x16x32_bf16 v[16:19], v[120:123], v[44:47], v[16:19]
  v_add_f32_dpp v224, v27, v26 wave_shr:1 row_mask:0xf bank_mask:0xf
  v_mfma_f32_16x16x32_bf16 v[16:19], v[112:115], v[48:51], v[16:19]
  s_nop 0
  v_add_f32_dpp v226, v224, v25 wave_shr:1 row_mask:0xf bank_mask:0xf
  v_mfma_f32_16x16x32_bf16 v[16:19], v[104:107], v[52:55], v[16:19]
  s_nop 0
  v_add_f32_dpp v228, v226, v24 wave_shr:1 row_mask:0xf bank_mask:0xf
  s_waitcnt lgkmcnt(8)
  v_mfma_f32_16x16x32_bf16 v[16:19], v[96:99], v[56:59], v[16:19]
  s_waitcnt lgkmcnt(6)
  v_mfma_f32_16x16x32_bf16 v[20:23], v[148:151], v[32:35], 0
  ds_read_b64_tr_b16 v[160:161], v13 offset:2080
  ds_read_b64_tr_b16 v[162:163], v13 offset:2048
  ds_read_b64_tr_b16 v[64:65], v12 offset:2048
  ds_read_b64_tr_b16 v[66:67], v12 offset:2080
  v_add_f32_dpp v225, v27, v30 wave_ror:1 row_mask:0xf bank_mask:0xf
  v_add_f32_dpp v227, v224, v29 wave_ror:1 row_mask:0xf bank_mask:0xf
  v_mfma_f32_16x16x32_bf16 v[20:23], v[140:143], v[36:39], v[20:23]
  v_add_f32_dpp v229, v226, v28 wave_ror:1 row_mask:0xf bank_mask:0xf
  v_mfma_f32_16x16x32_bf16 v[20:23], v[132:135], v[40:43], v[20:23]
  v_add_f32_dpp v225, v31, v30 wave_shr:1 row_mask:0xf bank_mask:0xf
  v_mfma_f32_16x16x32_bf16 v[20:23], v[124:127], v[44:47], v[20:23]
  s_nop 0
  v_add_f32_dpp v227, v225, v29 wave_shr:1 row_mask:0xf bank_mask:0xf
  v_mfma_f32_16x16x32_bf16 v[20:23], v[116:119], v[48:51], v[20:23]
  s_nop 0
  v_add_f32_dpp v229, v227, v28 wave_shr:1 row_mask:0xf bank_mask:0xf
  v_mfma_f32_16x16x32_bf16 v[20:23], v[108:111], v[52:55], v[20:23]
  v_cvt_pk_bf16_f32 v237, v228, v229
  v_mfma_f32_16x16x32_bf16 v[20:23], v[100:103], v[56:59], v[20:23]
  v_or_b32 v237, 1, v237
  s_waitcnt lgkmcnt(8)
  v_mfma_f32_16x16x32_bf16 v[24:27], v[152:155], v[32:35], 0
  ds_read_b64_tr_b16 v[164:165], v13 offset:2208
  ds_read_b64_tr_b16 v[166:167], v13 offset:2176
  v_add_f32_dpp v224, v31, v18 wave_ror:1 row_mask:0xf bank_mask:0xf
  v_mfma_f32_16x16x32_bf16 v[24:27], v[144:147], v[36:39], v[24:27]
  v_add_f32_dpp v226, v225, v17 wave_ror:1 row_mask:0xf bank_mask:0xf
  v_mfma_f32_16x16x32_bf16 v[24:27], v[136:139], v[40:43], v[24:27]
  v_add_f32_dpp v228, v227, v16 wave_ror:1 row_mask:0xf bank_mask:0xf
  v_mfma_f32_16x16x32_bf16 v[24:27], v[128:131], v[44:47], v[24:27]
  v_add_f32_dpp v224, v19, v18 wave_shr:1 row_mask:0xf bank_mask:0xf
  v_mfma_f32_16x16x32_bf16 v[24:27], v[120:123], v[48:51], v[24:27]
  s_nop 0
  v_add_f32_dpp v226, v224, v17 wave_shr:1 row_mask:0xf bank_mask:0xf
  v_mfma_f32_16x16x32_bf16 v[24:27], v[112:115], v[52:55], v[24:27]
  s_nop 0
  v_add_f32_dpp v228, v226, v16 wave_shr:1 row_mask:0xf bank_mask:0xf
  v_mfma_f32_16x16x32_bf16 v[24:27], v[104:107], v[56:59], v[24:27]
  s_waitcnt lgkmcnt(8)
  v_mfma_f32_16x16x32_bf16 v[24:27], v[96:99], v[60:63], v[24:27]
  s_waitcnt lgkmcnt(6)
  v_mfma_f32_16x16x32_bf16 v[28:31], v[156:159], v[32:35], 0
  ds_read_b64_tr_b16 v[168:169], v13 offset:2336
  ds_read_b64_tr_b16 v[170:171], v13 offset:2304
  ds_read_b64_tr_b16 v[68:69], v12 offset:2304
  ds_read_b64_tr_b16 v[70:71], v12 offset:2336
  v_add_f32_dpp v225, v19, v22 wave_ror:1 row_mask:0xf bank_mask:0xf
  v_mfma_f32_16x16x32_bf16 v[28:31], v[148:151], v[36:39], v[28:31]
  v_add_f32_dpp v227, v224, v21 wave_ror:1 row_mask:0xf bank_mask:0xf
  v_mfma_f32_16x16x32_bf16 v[28:31], v[140:143], v[40:43], v[28:31]
  v_add_f32_dpp v229, v226, v20 wave_ror:1 row_mask:0xf bank_mask:0xf
  v_mfma_f32_16x16x32_bf16 v[28:31], v[132:135], v[44:47], v[28:31]
  v_add_f32_dpp v225, v23, v22 wave_shr:1 row_mask:0xf bank_mask:0xf
  v_mfma_f32_16x16x32_bf16 v[28:31], v[124:127], v[48:51], v[28:31]
  s_nop 0
  v_add_f32_dpp v227, v225, v21 wave_shr:1 row_mask:0xf bank_mask:0xf
  v_mfma_f32_16x16x32_bf16 v[28:31], v[116:119], v[52:55], v[28:31]
  s_nop 0
  v_add_f32_dpp v229, v227, v20 wave_shr:1 row_mask:0xf bank_mask:0xf
  v_mfma_f32_16x16x32_bf16 v[28:31], v[108:111], v[56:59], v[28:31]
  v_cvt_pk_bf16_f32 v238, v228, v229
  v_mfma_f32_16x16x32_bf16 v[28:31], v[100:103], v[60:63], v[28:31]
  v_or_b32 v238, 1, v238
  s_waitcnt lgkmcnt(8)
  v_mfma_f32_16x16x32_bf16 v[16:19], v[160:163], v[32:35], 0
  ds_read_b64_tr_b16 v[172:173], v13 offset:2464
  ds_read_b64_tr_b16 v[174:175], v13 offset:2432
  v_add_f32_dpp v224, v23, v26 wave_ror:1 row_mask:0xf bank_mask:0xf
  v_mfma_f32_16x16x32_bf16 v[16:19], v[152:155], v[36:39], v[16:19]
  v_add_f32_dpp v226, v225, v25 wave_ror:1 row_mask:0xf bank_mask:0xf
  v_mfma_f32_16x16x32_bf16 v[16:19], v[144:147], v[40:43], v[16:19]
  v_add_f32_dpp v228, v227, v24 wave_ror:1 row_mask:0xf bank_mask:0xf
  v_mfma_f32_16x16x32_bf16 v[16:19], v[136:139], v[44:47], v[16:19]
  v_add_f32_dpp v224, v27, v26 wave_shr:1 row_mask:0xf bank_mask:0xf
  v_mfma_f32_16x16x32_bf16 v[16:19], v[128:131], v[48:51], v[16:19]
  s_nop 0
  v_add_f32_dpp v226, v224, v25 wave_shr:1 row_mask:0xf bank_mask:0xf
  v_mfma_f32_16x16x32_bf16 v[16:19], v[120:123], v[52:55], v[16:19]
  s_nop 0
  v_add_f32_dpp v228, v226, v24 wave_shr:1 row_mask:0xf bank_mask:0xf
  v_mfma_f32_16x16x32_bf16 v[16:19], v[112:115], v[56:59], v[16:19]
  v_mfma_f32_16x16x32_bf16 v[16:19], v[104:107], v[60:63], v[16:19]
  s_waitcnt lgkmcnt(8)
  v_mfma_f32_16x16x32_bf16 v[16:19], v[96:99], v[64:67], v[16:19]
  s_waitcnt lgkmcnt(6)
  v_mfma_f32_16x16x32_bf16 v[20:23], v[164:167], v[32:35], 0
  ds_read_b64_tr_b16 v[176:177], v13 offset:2592
  ds_read_b64_tr_b16 v[178:179], v13 offset:2560
  ds_read_b64_tr_b16 v[72:73], v12 offset:2560
  ds_read_b64_tr_b16 v[74:75], v12 offset:2592
  v_add_f32_dpp v225, v27, v30 wave_ror:1 row_mask:0xf bank_mask:0xf
  v_mfma_f32_16x16x32_bf16 v[20:23], v[156:159], v[36:39], v[20:23]
  v_add_f32_dpp v227, v224, v29 wave_ror:1 row_mask:0xf bank_mask:0xf
  v_mfma_f32_16x16x32_bf16 v[20:23], v[148:151], v[40:43], v[20:23]
  v_add_f32_dpp v229, v226, v28 wave_ror:1 row_mask:0xf bank_mask:0xf
  v_mfma_f32_16x16x32_bf16 v[20:23], v[140:143], v[44:47], v[20:23]
  v_add_f32_dpp v225, v31, v30 wave_shr:1 row_mask:0xf bank_mask:0xf
  v_mfma_f32_16x16x32_bf16 v[20:23], v[132:135], v[48:51], v[20:23]
  s_nop 0
  v_add_f32_dpp v227, v225, v29 wave_shr:1 row_mask:0xf bank_mask:0xf
  v_mfma_f32_16x16x32_bf16 v[20:23], v[124:127], v[52:55], v[20:23]
  s_nop 0
  v_add_f32_dpp v229, v227, v28 wave_shr:1 row_mask:0xf bank_mask:0xf
  v_mfma_f32_16x16x32_bf16 v[20:23], v[116:119], v[56:59], v[20:23]
  v_cvt_pk_bf16_f32 v239, v228, v229
  v_mfma_f32_16x16x32_bf16 v[20:23], v[108:111], v[60:63], v[20:23]
  v_or_b32 v239, 1, v239
  v_mfma_f32_16x16x32_bf16 v[20:23], v[100:103], v[64:67], v[20:23]
  s_waitcnt lgkmcnt(8)
  v_mfma_f32_16x16x32_bf16 v[24:27], v[168:171], v[32:35], 0
  ds_read_b64_tr_b16 v[180:181], v13 offset:2720
  ds_read_b64_tr_b16 v[182:183], v13 offset:2688
  v_add_f32_dpp v224, v31, v18 wave_ror:1 row_mask:0xf bank_mask:0xf
  v_mfma_f32_16x16x32_bf16 v[24:27], v[160:163], v[36:39], v[24:27]
  v_add_f32_dpp v226, v225, v17 wave_ror:1 row_mask:0xf bank_mask:0xf
  v_mfma_f32_16x16x32_bf16 v[24:27], v[152:155], v[40:43], v[24:27]
  v_add_f32_dpp v228, v227, v16 wave_ror:1 row_mask:0xf bank_mask:0xf
  v_mfma_f32_16x16x32_bf16 v[24:27], v[144:147], v[44:47], v[24:27]
  v_add_f32_dpp v224, v19, v18 wave_shr:1 row_mask:0xf bank_mask:0xf
  v_mfma_f32_16x16x32_bf16 v[24:27], v[136:139], v[48:51], v[24:27]
  s_nop 0
  v_add_f32_dpp v226, v224, v17 wave_shr:1 row_mask:0xf bank_mask:0xf
  v_mfma_f32_16x16x32_bf16 v[24:27], v[128:131], v[52:55], v[24:27]
  s_nop 0
  v_add_f32_dpp v228, v226, v16 wave_shr:1 row_mask:0xf bank_mask:0xf
  v_mfma_f32_16x16x32_bf16 v[24:27], v[120:123], v[56:59], v[24:27]
  v_mfma_f32_16x16x32_bf16 v[24:27], v[112:115], v[60:63], v[24:27]
  v_mfma_f32_16x16x32_bf16 v[24:27], v[104:107], v[64:67], v[24:27]
  s_waitcnt lgkmcnt(8)
  v_mfma_f32_16x16x32_bf16 v[24:27], v[96:99], v[68:71], v[24:27]
  s_waitcnt lgkmcnt(6)
  v_mfma_f32_16x16x32_bf16 v[28:31], v[172:175], v[32:35], 0
  ds_read_b64_tr_b16 v[184:185], v13 offset:2848
  ds_read_b64_tr_b16 v[186:187], v13 offset:2816
  ds_read_b64_tr_b16 v[76:77], v12 offset:2816
  ds_read_b64_tr_b16 v[78:79], v12 offset:2848
  v_add_f32_dpp v225, v19, v22 wave_ror:1 row_mask:0xf bank_mask:0xf
  v_mfma_f32_16x16x32_bf16 v[28:31], v[164:167], v[36:39], v[28:31]
  v_add_f32_dpp v227, v224, v21 wave_ror:1 row_mask:0xf bank_mask:0xf
  v_mfma_f32_16x16x32_bf16 v[28:31], v[156:159], v[40:43], v[28:31]
  v_add_f32_dpp v229, v226, v20 wave_ror:1 row_mask:0xf bank_mask:0xf
  v_mfma_f32_16x16x32_bf16 v[28:31], v[148:151], v[44:47], v[28:31]
  v_add_f32_dpp v225, v23, v22 wave_shr:1 row_mask:0xf bank_mask:0xf
  v_mfma_f32_16x16x32_bf16 v[28:31], v[140:143], v[48:51], v[28:31]
  s_nop 0
  v_add_f32_dpp v227, v225, v21 wave_shr:1 row_mask:0xf bank_mask:0xf
  v_mfma_f32_16x16x32_bf16 v[28:31], v[132:135], v[52:55], v[28:31]
  s_nop 0
  v_add_f32_dpp v229, v227, v20 wave_shr:1 row_mask:0xf bank_mask:0xf
  v_mfma_f32_16x16x32_bf16 v[28:31], v[124:127], v[56:59], v[28:31]
  v_cvt_pk_bf16_f32 v240, v228, v229
  v_mfma_f32_16x16x32_bf16 v[28:31], v[116:119], v[60:63], v[28:31]
  v_or_b32 v240, 1, v240
  v_mfma_f32_16x16x32_bf16 v[28:31], v[108:111], v[64:67], v[28:31]
  v_mfma_f32_16x16x32_bf16 v[28:31], v[100:103], v[68:71], v[28:31]
  s_waitcnt lgkmcnt(8)
  v_mfma_f32_16x16x32_bf16 v[16:19], v[176:179], v[32:35], 0
  ds_read_b64_tr_b16 v[188:189], v13 offset:2976
  ds_read_b64_tr_b16 v[190:191], v13 offset:2944
  v_add_f32_dpp v224, v23, v26 wave_ror:1 row_mask:0xf bank_mask:0xf
  v_mfma_f32_16x16x32_bf16 v[16:19], v[168:171], v[36:39], v[16:19]
  v_add_f32_dpp v226, v225, v25 wave_ror:1 row_mask:0xf bank_mask:0xf
  v_mfma_f32_16x16x32_bf16 v[16:19], v[160:163], v[40:43], v[16:19]
  v_add_f32_dpp v228, v227, v24 wave_ror:1 row_mask:0xf bank_mask:0xf
  v_mfma_f32_16x16x32_bf16 v[16:19], v[152:155], v[44:47], v[16:19]
  v_add_f32_dpp v224, v27, v26 wave_shr:1 row_mask:0xf bank_mask:0xf
  v_mfma_f32_16x16x32_bf16 v[16:19], v[144:147], v[48:51], v[16:19]
  s_nop 0
  v_add_f32_dpp v226, v224, v25 wave_shr:1 row_mask:0xf bank_mask:0xf
  v_mfma_f32_16x16x32_bf16 v[16:19], v[136:139], v[52:55], v[16:19]
  s_nop 0
  v_add_f32_dpp v228, v226, v24 wave_shr:1 row_mask:0xf bank_mask:0xf
  v_mfma_f32_16x16x32_bf16 v[16:19], v[128:131], v[56:59], v[16:19]
  v_mfma_f32_16x16x32_bf16 v[16:19], v[120:123], v[60:63], v[16:19]
  v_mfma_f32_16x16x32_bf16 v[16:19], v[112:115], v[64:67], v[16:19]
  v_mfma_f32_16x16x32_bf16 v[16:19], v[104:107], v[68:71], v[16:19]
  s_waitcnt lgkmcnt(8)
  v_mfma_f32_16x16x32_bf16 v[16:19], v[96:99], v[72:75], v[16:19]
  s_waitcnt lgkmcnt(6)
  v_mfma_f32_16x16x32_bf16 v[20:23], v[180:183], v[32:35], 0
  ds_read_b64_tr_b16 v[192:193], v13 offset:3104
  ds_read_b64_tr_b16 v[194:195], v13 offset:3072
  ds_read_b64_tr_b16 v[80:81], v12 offset:3072
  ds_read_b64_tr_b16 v[82:83], v12 offset:3104
  v_add_f32_dpp v225, v27, v30 wave_ror:1 row_mask:0xf bank_mask:0xf
  v_mfma_f32_16x16x32_bf16 v[20:23], v[172:175], v[36:39], v[20:23]
  v_add_f32_dpp v227, v224, v29 wave_ror:1 row_mask:0xf bank_mask:0xf
  v_mfma_f32_16x16x32_bf16 v[20:23], v[164:167], v[40:43], v[20:23]
  v_add_f32_dpp v229, v226, v28 wave_ror:1 row_mask:0xf bank_mask:0xf
  v_mfma_f32_16x16x32_bf16 v[20:23], v[156:159], v[44:47], v[20:23]
  v_add_f32_dpp v225, v31, v30 wave_shr:1 row_mask:0xf bank_mask:0xf
  v_mfma_f32_16x16x32_bf16 v[20:23], v[148:151], v[48:51], v[20:23]
  s_nop 0
  v_add_f32_dpp v227, v225, v29 wave_shr:1 row_mask:0xf bank_mask:0xf
  v_mfma_f32_16x16x32_bf16 v[20:23], v[140:143], v[52:55], v[20:23]
  s_nop 0
  v_add_f32_dpp v229, v227, v28 wave_shr:1 row_mask:0xf bank_mask:0xf
  v_mfma_f32_16x16x32_bf16 v[20:23], v[132:135], v[56:59], v[20:23]
  v_cvt_pk_bf16_f32 v241, v228, v229
  v_mfma_f32_16x16x32_bf16 v[20:23], v[124:127], v[60:63], v[20:23]
  v_or_b32 v241, 1, v241
  v_mfma_f32_16x16x32_bf16 v[20:23], v[116:119], v[64:67], v[20:23]
  v_mfma_f32_16x16x32_bf16 v[20:23], v[108:111], v[68:71], v[20:23]
  v_mfma_f32_16x16x32_bf16 v[20:23], v[100:103], v[72:75], v[20:23]
  s_waitcnt lgkmcnt(8)
  v_mfma_f32_16x16x32_bf16 v[24:27], v[184:187], v[32:35], 0
  ds_read_b64_tr_b16 v[196:197], v13 offset:3232
  ds_read_b64_tr_b16 v[198:199], v13 offset:3200
  v_add_f32_dpp v224, v31, v18 wave_ror:1 row_mask:0xf bank_mask:0xf
  v_mfma_f32_16x16x32_bf16 v[24:27], v[176:179], v[36:39], v[24:27]
  v_add_f32_dpp v226, v225, v17 wave_ror:1 row_mask:0xf bank_mask:0xf
  v_mfma_f32_16x16x32_bf16 v[24:27], v[168:171], v[40:43], v[24:27]
  v_add_f32_dpp v228, v227, v16 wave_ror:1 row_mask:0xf bank_mask:0xf
  v_mfma_f32_16x16x32_bf16 v[24:27], v[160:163], v[44:47], v[24:27]
  v_add_f32_dpp v224, v19, v18 wave_shr:1 row_mask:0xf bank_mask:0xf
  v_mfma_f32_16x16x32_bf16 v[24:27], v[152:155], v[48:51], v[24:27]
  s_nop 0
  v_add_f32_dpp v226, v224, v17 wave_shr:1 row_mask:0xf bank_mask:0xf
  v_mfma_f32_16x16x32_bf16 v[24:27], v[144:147], v[52:55], v[24:27]
  s_nop 0
  v_add_f32_dpp v228, v226, v16 wave_shr:1 row_mask:0xf bank_mask:0xf
  v_mfma_f32_16x16x32_bf16 v[24:27], v[136:139], v[56:59], v[24:27]
  v_mfma_f32_16x16x32_bf16 v[24:27], v[128:131], v[60:63], v[24:27]
  v_mfma_f32_16x16x32_bf16 v[24:27], v[120:123], v[64:67], v[24:27]
  v_mfma_f32_16x16x32_bf16 v[24:27], v[112:115], v[68:71], v[24:27]
  v_mfma_f32_16x16x32_bf16 v[24:27], v[104:107], v[72:75], v[24:27]
  s_waitcnt lgkmcnt(8)
  v_mfma_f32_16x16x32_bf16 v[24:27], v[96:99], v[76:79], v[24:27]
  s_waitcnt lgkmcnt(6)
  v_mfma_f32_16x16x32_bf16 v[28:31], v[188:191], v[32:35], 0
  ds_read_b64_tr_b16 v[200:201], v13 offset:3360
  ds_read_b64_tr_b16 v[202:203], v13 offset:3328
  ds_read_b64_tr_b16 v[84:85], v12 offset:3328
  ds_read_b64_tr_b16 v[86:87], v12 offset:3360
  v_add_f32_dpp v225, v19, v22 wave_ror:1 row_mask:0xf bank_mask:0xf
  v_mfma_f32_16x16x32_bf16 v[28:31], v[180:183], v[36:39], v[28:31]
  v_add_f32_dpp v227, v224, v21 wave_ror:1 row_mask:0xf bank_mask:0xf
  v_mfma_f32_16x16x32_bf16 v[28:31], v[172:175], v[40:43], v[28:31]
  v_add_f32_dpp v229, v226, v20 wave_ror:1 row_mask:0xf bank_mask:0xf
  v_mfma_f32_16x16x32_bf16 v[28:31], v[164:167], v[44:47], v[28:31]
  v_add_f32_dpp v225, v23, v22 wave_shr:1 row_mask:0xf bank_mask:0xf
  v_mfma_f32_16x16x32_bf16 v[28:31], v[156:159], v[48:51], v[28:31]
  s_nop 0
  v_add_f32_dpp v227, v225, v21 wave_shr:1 row_mask:0xf bank_mask:0xf
  v_mfma_f32_16x16x32_bf16 v[28:31], v[148:151], v[52:55], v[28:31]
  s_nop 0
  v_add_f32_dpp v229, v227, v20 wave_shr:1 row_mask:0xf bank_mask:0xf
  v_mfma_f32_16x16x32_bf16 v[28:31], v[140:143], v[56:59], v[28:31]
  v_cvt_pk_bf16_f32 v242, v228, v229
  v_mfma_f32_16x16x32_bf16 v[28:31], v[132:135], v[60:63], v[28:31]
  v_or_b32 v242, 1, v242
  v_mfma_f32_16x16x32_bf16 v[28:31], v[124:127], v[64:67], v[28:31]
  v_mfma_f32_16x16x32_bf16 v[28:31], v[116:119], v[68:71], v[28:31]
  v_mfma_f32_16x16x32_bf16 v[28:31], v[108:111], v[72:75], v[28:31]
  v_mfma_f32_16x16x32_bf16 v[28:31], v[100:103], v[76:79], v[28:31]
  s_waitcnt lgkmcnt(8)
  v_mfma_f32_16x16x32_bf16 v[16:19], v[192:195], v[32:35], 0
  ds_read_b64_tr_b16 v[204:205], v13 offset:3488
  ds_read_b64_tr_b16 v[206:207], v13 offset:3456
  v_add_f32_dpp v224, v23, v26 wave_ror:1 row_mask:0xf bank_mask:0xf
  v_mfma_f32_16x16x32_bf16 v[16:19], v[184:187], v[36:39], v[16:19]
  v_add_f32_dpp v226, v225, v25 wave_ror:1 row_mask:0xf bank_mask:0xf
  v_mfma_f32_16x16x32_bf16 v[16:19], v[176:179], v[40:43], v[16:19]
  v_add_f32_dpp v228, v227, v24 wave_ror:1 row_mask:0xf bank_mask:0xf
  v_mfma_f32_16x16x32_bf16 v[16:19], v[168:171], v[44:47], v[16:19]
  v_add_f32_dpp v224, v27, v26 wave_shr:1 row_mask:0xf bank_mask:0xf
  v_mfma_f32_16x16x32_bf16 v[16:19], v[160:163], v[48:51], v[16:19]
  s_nop 0
  v_add_f32_dpp v226, v224, v25 wave_shr:1 row_mask:0xf bank_mask:0xf
  v_mfma_f32_16x16x32_bf16 v[16:19], v[152:155], v[52:55], v[16:19]
  s_nop 0
  v_add_f32_dpp v228, v226, v24 wave_shr:1 row_mask:0xf bank_mask:0xf
  v_mfma_f32_16x16x32_bf16 v[16:19], v[144:147], v[56:59], v[16:19]
  v_mfma_f32_16x16x32_bf16 v[16:19], v[136:139], v[60:63], v[16:19]
  v_mfma_f32_16x16x32_bf16 v[16:19], v[128:131], v[64:67], v[16:19]
  v_mfma_f32_16x16x32_bf16 v[16:19], v[120:123], v[68:71], v[16:19]
  v_mfma_f32_16x16x32_bf16 v[16:19], v[112:115], v[72:75], v[16:19]
  v_mfma_f32_16x16x32_bf16 v[16:19], v[104:107], v[76:79], v[16:19]
  s_waitcnt lgkmcnt(8)
  v_mfma_f32_16x16x32_bf16 v[16:19], v[96:99], v[80:83], v[16:19]
  s_waitcnt lgkmcnt(6)
  v_mfma_f32_16x16x32_bf16 v[20:23], v[196:199], v[32:35], 0
  ds_read_b64_tr_b16 v[208:209], v13 offset:3616
  ds_read_b64_tr_b16 v[210:211], v13 offset:3584
  ds_read_b64_tr_b16 v[88:89], v12 offset:3584
  ds_read_b64_tr_b16 v[90:91], v12 offset:3616
  v_add_f32_dpp v225, v27, v30 wave_ror:1 row_mask:0xf bank_mask:0xf
  v_mfma_f32_16x16x32_bf16 v[20:23], v[188:191], v[36:39], v[20:23]
  v_add_f32_dpp v227, v224, v29 wave_ror:1 row_mask:0xf bank_mask:0xf
  v_mfma_f32_16x16x32_bf16 v[20:23], v[180:183], v[40:43], v[20:23]
  v_add_f32_dpp v229, v226, v28 wave_ror:1 row_mask:0xf bank_mask:0xf
  v_mfma_f32_16x16x32_bf16 v[20:23], v[172:175], v[44:47], v[20:23]
  v_add_f32_dpp v225, v31, v30 wave_shr:1 row_mask:0xf bank_mask:0xf
  v_mfma_f32_16x16x32_bf16 v[20:23], v[164:167], v[48:51], v[20:23]
  s_nop 0
  v_add_f32_dpp v227, v225, v29 wave_shr:1 row_mask:0xf bank_mask:0xf
  v_mfma_f32_16x16x32_bf16 v[20:23], v[156:159], v[52:55], v[20:23]
  s_nop 0
  v_add_f32_dpp v229, v227, v28 wave_shr:1 row_mask:0xf bank_mask:0xf
  v_mfma_f32_16x16x32_bf16 v[20:23], v[148:151], v[56:59], v[20:23]
  v_cvt_pk_bf16_f32 v243, v228, v229
  v_mfma_f32_16x16x32_bf16 v[20:23], v[140:143], v[60:63], v[20:23]
  v_or_b32 v243, 1, v243
  v_mfma_f32_16x16x32_bf16 v[20:23], v[132:135], v[64:67], v[20:23]
  v_mfma_f32_16x16x32_bf16 v[20:23], v[124:127], v[68:71], v[20:23]
  v_mfma_f32_16x16x32_bf16 v[20:23], v[116:119], v[72:75], v[20:23]
  v_mfma_f32_16x16x32_bf16 v[20:23], v[108:111], v[76:79], v[20:23]
  v_mfma_f32_16x16x32_bf16 v[20:23], v[100:103], v[80:83], v[20:23]
  s_waitcnt lgkmcnt(8)
  v_mfma_f32_16x16x32_bf16 v[24:27], v[200:203], v[32:35], 0
  ds_read_b64_tr_b16 v[212:213], v13 offset:3744
  ds_read_b64_tr_b16 v[214:215], v13 offset:3712
  v_add_f32_dpp v224, v31, v18 wave_ror:1 row_mask:0xf bank_mask:0xf
  v_mfma_f32_16x16x32_bf16 v[24:27], v[192:195], v[36:39], v[24:27]
  v_add_f32_dpp v226, v225, v17 wave_ror:1 row_mask:0xf bank_mask:0xf
  v_mfma_f32_16x16x32_bf16 v[24:27], v[184:187], v[40:43], v[24:27]
  v_add_f32_dpp v228, v227, v16 wave_ror:1 row_mask:0xf bank_mask:0xf
  v_mfma_f32_16x16x32_bf16 v[24:27], v[176:179], v[44:47], v[24:27]
  v_add_f32_dpp v224, v19, v18 wave_shr:1 row_mask:0xf bank_mask:0xf
  v_mfma_f32_16x16x32_bf16 v[24:27], v[168:171], v[48:51], v[24:27]
  s_nop 0
  v_add_f32_dpp v226, v224, v17 wave_shr:1 row_mask:0xf bank_mask:0xf
  v_mfma_f32_16x16x32_bf16 v[24:27], v[160:163], v[52:55], v[24:27]
  s_nop 0
  v_add_f32_dpp v228, v226, v16 wave_shr:1 row_mask:0xf bank_mask:0xf
  v_mfma_f32_16x16x32_bf16 v[24:27], v[152:155], v[56:59], v[24:27]
  v_mfma_f32_16x16x32_bf16 v[24:27], v[144:147], v[60:63], v[24:27]
  v_mfma_f32_16x16x32_bf16 v[24:27], v[136:139], v[64:67], v[24:27]
  v_mfma_f32_16x16x32_bf16 v[24:27], v[128:131], v[68:71], v[24:27]
  v_mfma_f32_16x16x32_bf16 v[24:27], v[120:123], v[72:75], v[24:27]
  v_mfma_f32_16x16x32_bf16 v[24:27], v[112:115], v[76:79], v[24:27]
  v_mfma_f32_16x16x32_bf16 v[24:27], v[104:107], v[80:83], v[24:27]
  s_waitcnt lgkmcnt(8)
  v_mfma_f32_16x16x32_bf16 v[24:27], v[96:99], v[84:87], v[24:27]
  s_waitcnt lgkmcnt(6)
  v_mfma_f32_16x16x32_bf16 v[28:31], v[204:207], v[32:35], 0
  ds_read_b64_tr_b16 v[216:217], v13 offset:3872
  ds_read_b64_tr_b16 v[218:219], v13 offset:3840
  ds_read_b64_tr_b16 v[92:93], v12 offset:3840
  ds_read_b64_tr_b16 v[94:95], v12 offset:3872
  v_add_f32_dpp v225, v19, v22 wave_ror:1 row_mask:0xf bank_mask:0xf
  v_mfma_f32_16x16x32_bf16 v[28:31], v[196:199], v[36:39], v[28:31]
  v_add_f32_dpp v227, v224, v21 wave_ror:1 row_mask:0xf bank_mask:0xf
  v_mfma_f32_16x16x32_bf16 v[28:31], v[188:191], v[40:43], v[28:31]
  v_add_f32_dpp v229, v226, v20 wave_ror:1 row_mask:0xf bank_mask:0xf
  v_mfma_f32_16x16x32_bf16 v[28:31], v[180:183], v[44:47], v[28:31]
  v_add_f32_dpp v225, v23, v22 wave_shr:1 row_mask:0xf bank_mask:0xf
  v_mfma_f32_16x16x32_bf16 v[28:31], v[172:175], v[48:51], v[28:31]
  s_nop 0
  v_add_f32_dpp v227, v225, v21 wave_shr:1 row_mask:0xf bank_mask:0xf
  v_mfma_f32_16x16x32_bf16 v[28:31], v[164:167], v[52:55], v[28:31]
  s_nop 0
  v_add_f32_dpp v229, v227, v20 wave_shr:1 row_mask:0xf bank_mask:0xf
  v_mfma_f32_16x16x32_bf16 v[28:31], v[156:159], v[56:59], v[28:31]
  v_cvt_pk_bf16_f32 v244, v228, v229
  v_mfma_f32_16x16x32_bf16 v[28:31], v[148:151], v[60:63], v[28:31]
  v_or_b32 v244, 1, v244
  v_mfma_f32_16x16x32_bf16 v[28:31], v[140:143], v[64:67], v[28:31]
  v_mfma_f32_16x16x32_bf16 v[28:31], v[132:135], v[68:71], v[28:31]
  v_mfma_f32_16x16x32_bf16 v[28:31], v[124:127], v[72:75], v[28:31]
  v_mfma_f32_16x16x32_bf16 v[28:31], v[116:119], v[76:79], v[28:31]
  v_mfma_f32_16x16x32_bf16 v[28:31], v[108:111], v[80:83], v[28:31]
  v_mfma_f32_16x16x32_bf16 v[28:31], v[100:103], v[84:87], v[28:31]
  s_waitcnt lgkmcnt(8)
  v_mfma_f32_16x16x32_bf16 v[16:19], v[208:211], v[32:35], 0
  ds_read_b64_tr_b16 v[220:221], v13 offset:4000
  ds_read_b64_tr_b16 v[222:223], v13 offset:3968
  v_add_f32_dpp v224, v23, v26 wave_ror:1 row_mask:0xf bank_mask:0xf
  v_mfma_f32_16x16x32_bf16 v[16:19], v[200:203], v[36:39], v[16:19]
  v_add_f32_dpp v226, v225, v25 wave_ror:1 row_mask:0xf bank_mask:0xf
  v_mfma_f32_16x16x32_bf16 v[16:19], v[192:195], v[40:43], v[16:19]
  v_add_f32_dpp v228, v227, v24 wave_ror:1 row_mask:0xf bank_mask:0xf
  v_mfma_f32_16x16x32_bf16 v[16:19], v[184:187], v[44:47], v[16:19]
  v_add_f32_dpp v224, v27, v26 wave_shr:1 row_mask:0xf bank_mask:0xf
  v_mfma_f32_16x16x32_bf16 v[16:19], v[176:179], v[48:51], v[16:19]
  s_nop 0
  v_add_f32_dpp v226, v224, v25 wave_shr:1 row_mask:0xf bank_mask:0xf
  v_mfma_f32_16x16x32_bf16 v[16:19], v[168:171], v[52:55], v[16:19]
  s_nop 0
  v_add_f32_dpp v228, v226, v24 wave_shr:1 row_mask:0xf bank_mask:0xf
  v_mfma_f32_16x16x32_bf16 v[16:19], v[160:163], v[56:59], v[16:19]
  v_mfma_f32_16x16x32_bf16 v[16:19], v[152:155], v[60:63], v[16:19]
  v_mfma_f32_16x16x32_bf16 v[16:19], v[144:147], v[64:67], v[16:19]
  v_mfma_f32_16x16x32_bf16 v[16:19], v[136:139], v[68:71], v[16:19]
  v_mfma_f32_16x16x32_bf16 v[16:19], v[128:131], v[72:75], v[16:19]
  v_mfma_f32_16x16x32_bf16 v[16:19], v[120:123], v[76:79], v[16:19]
  v_mfma_f32_16x16x32_bf16 v[16:19], v[112:115], v[80:83], v[16:19]
  v_mfma_f32_16x16x32_bf16 v[16:19], v[104:107], v[84:87], v[16:19]
  s_waitcnt lgkmcnt(8)
  v_mfma_f32_16x16x32_bf16 v[16:19], v[96:99], v[88:91], v[16:19]
  s_waitcnt lgkmcnt(6)
  v_mfma_f32_16x16x32_bf16 v[20:23], v[212:215], v[32:35], 0
  v_add_f32_dpp v225, v27, v30 wave_ror:1 row_mask:0xf bank_mask:0xf
  v_mfma_f32_16x16x32_bf16 v[20:23], v[204:207], v[36:39], v[20:23]
  v_add_f32_dpp v227, v224, v29 wave_ror:1 row_mask:0xf bank_mask:0xf
  v_mfma_f32_16x16x32_bf16 v[20:23], v[196:199], v[40:43], v[20:23]
  v_add_f32_dpp v229, v226, v28 wave_ror:1 row_mask:0xf bank_mask:0xf
  v_mfma_f32_16x16x32_bf16 v[20:23], v[188:191], v[44:47], v[20:23]
  v_add_f32_dpp v225, v31, v30 wave_shr:1 row_mask:0xf bank_mask:0xf
  v_mfma_f32_16x16x32_bf16 v[20:23], v[180:183], v[48:51], v[20:23]
  s_nop 0
  v_add_f32_dpp v227, v225, v29 wave_shr:1 row_mask:0xf bank_mask:0xf
  v_mfma_f32_16x16x32_bf16 v[20:23], v[172:175], v[52:55], v[20:23]
  s_nop 0
  v_add_f32_dpp v229, v227, v28 wave_shr:1 row_mask:0xf bank_mask:0xf
  v_mfma_f32_16x16x32_bf16 v[20:23], v[164:167], v[56:59], v[20:23]
  v_cvt_pk_bf16_f32 v245, v228, v229
  v_mfma_f32_16x16x32_bf16 v[20:23], v[156:159], v[60:63], v[20:23]
  v_or_b32 v245, 1, v245
  v_mfma_f32_16x16x32_bf16 v[20:23], v[148:151], v[64:67], v[20:23]
  v_mfma_f32_16x16x32_bf16 v[20:23], v[140:143], v[68:71], v[20:23]
  v_mfma_f32_16x16x32_bf16 v[20:23], v[132:135], v[72:75], v[20:23]
  v_mfma_f32_16x16x32_bf16 v[20:23], v[124:127], v[76:79], v[20:23]
  v_mfma_f32_16x16x32_bf16 v[20:23], v[116:119], v[80:83], v[20:23]
  v_mfma_f32_16x16x32_bf16 v[20:23], v[108:111], v[84:87], v[20:23]
  v_mfma_f32_16x16x32_bf16 v[20:23], v[100:103], v[88:91], v[20:23]
  s_waitcnt lgkmcnt(4)
  v_mfma_f32_16x16x32_bf16 v[24:27], v[216:219], v[32:35], 0
  v_add_f32_dpp v224, v31, v18 wave_ror:1 row_mask:0xf bank_mask:0xf
  v_mfma_f32_16x16x32_bf16 v[24:27], v[208:211], v[36:39], v[24:27]
  v_add_f32_dpp v226, v225, v17 wave_ror:1 row_mask:0xf bank_mask:0xf
  v_mfma_f32_16x16x32_bf16 v[24:27], v[200:203], v[40:43], v[24:27]
  v_add_f32_dpp v228, v227, v16 wave_ror:1 row_mask:0xf bank_mask:0xf
  v_mfma_f32_16x16x32_bf16 v[24:27], v[192:195], v[44:47], v[24:27]
  v_add_f32_dpp v224, v19, v18 wave_shr:1 row_mask:0xf bank_mask:0xf
  v_mfma_f32_16x16x32_bf16 v[24:27], v[184:187], v[48:51], v[24:27]
  s_nop 0
  v_add_f32_dpp v226, v224, v17 wave_shr:1 row_mask:0xf bank_mask:0xf
  v_mfma_f32_16x16x32_bf16 v[24:27], v[176:179], v[52:55], v[24:27]
  s_nop 0
  v_add_f32_dpp v228, v226, v16 wave_shr:1 row_mask:0xf bank_mask:0xf
  v_mfma_f32_16x16x32_bf16 v[24:27], v[168:171], v[56:59], v[24:27]
  v_mfma_f32_16x16x32_bf16 v[24:27], v[160:163], v[60:63], v[24:27]
  v_mfma_f32_16x16x32_bf16 v[24:27], v[152:155], v[64:67], v[24:27]
  v_mfma_f32_16x16x32_bf16 v[24:27], v[144:147], v[68:71], v[24:27]
  v_mfma_f32_16x16x32_bf16 v[24:27], v[136:139], v[72:75], v[24:27]
  v_mfma_f32_16x16x32_bf16 v[24:27], v[128:131], v[76:79], v[24:27]
  v_mfma_f32_16x16x32_bf16 v[24:27], v[120:123], v[80:83], v[24:27]
  v_mfma_f32_16x16x32_bf16 v[24:27], v[112:115], v[84:87], v[24:27]
  v_mfma_f32_16x16x32_bf16 v[24:27], v[104:107], v[88:91], v[24:27]
  s_waitcnt lgkmcnt(2)
  v_mfma_f32_16x16x32_bf16 v[24:27], v[96:99], v[92:95], v[24:27]
  s_waitcnt lgkmcnt(0)
  v_mfma_f32_16x16x32_bf16 v[28:31], v[220:223], v[32:35], 0
  v_add_f32_dpp v225, v19, v22 wave_ror:1 row_mask:0xf bank_mask:0xf
  v_mfma_f32_16x16x32_bf16 v[28:31], v[212:215], v[36:39], v[28:31]
  v_add_f32_dpp v227, v224, v21 wave_ror:1 row_mask:0xf bank_mask:0xf
  v_mfma_f32_16x16x32_bf16 v[28:31], v[204:207], v[40:43], v[28:31]
  v_add_f32_dpp v229, v226, v20 wave_ror:1 row_mask:0xf bank_mask:0xf
  v_mfma_f32_16x16x32_bf16 v[28:31], v[196:199], v[44:47], v[28:31]
  v_add_f32_dpp v225, v23, v22 wave_shr:1 row_mask:0xf bank_mask:0xf
  v_mfma_f32_16x16x32_bf16 v[28:31], v[188:191], v[48:51], v[28:31]
  s_nop 0
  v_add_f32_dpp v227, v225, v21 wave_shr:1 row_mask:0xf bank_mask:0xf
  v_mfma_f32_16x16x32_bf16 v[28:31], v[180:183], v[52:55], v[28:31]
  s_nop 0
  v_add_f32_dpp v229, v227, v20 wave_shr:1 row_mask:0xf bank_mask:0xf
  v_mfma_f32_16x16x32_bf16 v[28:31], v[172:175], v[56:59], v[28:31]
  v_cvt_pk_bf16_f32 v246, v228, v229
  v_mfma_f32_16x16x32_bf16 v[28:31], v[164:167], v[60:63], v[28:31]
  v_or_b32 v246, 1, v246
  v_mfma_f32_16x16x32_bf16 v[28:31], v[156:159], v[64:67], v[28:31]
  v_mfma_f32_16x16x32_bf16 v[28:31], v[148:151], v[68:71], v[28:31]
  v_mfma_f32_16x16x32_bf16 v[28:31], v[140:143], v[72:75], v[28:31]
  v_mfma_f32_16x16x32_bf16 v[28:31], v[132:135], v[76:79], v[28:31]
  v_mfma_f32_16x16x32_bf16 v[28:31], v[124:127], v[80:83], v[28:31]
  v_mfma_f32_16x16x32_bf16 v[28:31], v[116:119], v[84:87], v[28:31]
  v_mfma_f32_16x16x32_bf16 v[28:31], v[108:111], v[88:91], v[28:31]
  v_mfma_f32_16x16x32_bf16 v[28:31], v[100:103], v[92:95], v[28:31]
  v_add_f32_dpp v224, v23, v26 wave_ror:1 row_mask:0xf bank_mask:0xf
  v_add_f32_dpp v226, v225, v25 wave_ror:1 row_mask:0xf bank_mask:0xf
  v_add_f32_dpp v228, v227, v24 wave_ror:1 row_mask:0xf bank_mask:0xf
  v_add_f32_dpp v224, v27, v26 wave_shr:1 row_mask:0xf bank_mask:0xf
  s_nop 1
  v_add_f32_dpp v226, v224, v25 wave_shr:1 row_mask:0xf bank_mask:0xf
  s_nop 1
  v_add_f32_dpp v228, v226, v24 wave_shr:1 row_mask:0xf bank_mask:0xf
  v_add_f32_dpp v225, v27, v30 wave_ror:1 row_mask:0xf bank_mask:0xf
  v_add_f32_dpp v227, v224, v29 wave_ror:1 row_mask:0xf bank_mask:0xf
  v_add_f32_dpp v229, v226, v28 wave_ror:1 row_mask:0xf bank_mask:0xf
  v_add_f32_dpp v225, v31, v30 wave_shr:1 row_mask:0xf bank_mask:0xf
  s_nop 1
  v_add_f32_dpp v227, v225, v29 wave_shr:1 row_mask:0xf bank_mask:0xf
  s_nop 1
  v_add_f32_dpp v229, v227, v28 wave_shr:1 row_mask:0xf bank_mask:0xf
  v_cvt_pk_bf16_f32 v247, v228, v229
  v_or_b32 v247, 1, v247
  s_add_u32 s28, s98, 16777216
  s_addc_u32 s29, s99, 0
  s_mov_b32 s30, 4194304
  s_mov_b32 s31, 0x20000
  s_lshl_b32 s40, s6, 12
  buffer_store_dwordx4 v[232:235], v3, s[28:31], s40 offen offset:0 sc1
  buffer_store_dwordx4 v[236:239], v3, s[28:31], s40 offen offset:1024 sc1
  buffer_store_dwordx4 v[240:243], v3, s[28:31], s40 offen offset:2048 sc1
  buffer_store_dwordx4 v[244:247], v3, s[28:31], s40 offen offset:3072 sc1
  s_and_b32 s40, s10, 3
  s_lshl_b32 s40, s40, 2
  s_and_b32 s41, s11, 3
  s_add_u32 s40, s40, s41
  s_lshl_b32 s41, s40, 3
  s_lshl_b32 s42, s3, 1
  s_add_u32 s41, s41, s42
  s_lshl_b32 s48, s41, 15
  s_mov_b32 s47, s48
  v_lshrrev_b32 v5, 5, v2
  v_and_b32 v6, 1, v14
  v_lshlrev_b32 v12, 15, v6
  v_lshl_add_u32 v12, v5, 8, v12
  v_lshl_add_u32 v12, v15, 4, v12
  s_add_u32 s28, s98, 0
  s_addc_u32 s29, s99, 0
  s_mov_b32 s30, 4194304
  s_mov_b32 s31, 0x20000
  s_mov_b32 s32, s94
  s_mov_b32 s33, s95
  s_mov_b32 s34, 8388608
  s_mov_b32 s35, 0x20000
  s_waitcnt lgkmcnt(0)
  s_mov_b64 exec, 1
  ds_add_u32 v9, v11 offset:56
  s_mov_b64 exec, -1
  s_mov_b32 s43, 131072
K3_wwo:
  ds_read_b32 v80, v10 offset:48
  s_waitcnt lgkmcnt(0)
  v_readfirstlane_b32 s42, v80
  s_sub_u32 s43, s43, 1
  s_cbranch_scc1 K3_wwo_ok
  s_cmp_lt_u32 s42, 4
  s_cbranch_scc1 K3_wwo
K3_wwo_ok:
  s_setprio 1
  buffer_load_dwordx4 v[96:99], v12, s[28:31], s48 offen offset:0
  buffer_load_dwordx4 v[100:103], v12, s[28:31], s48 offen offset:512
  buffer_load_dwordx4 v[104:107], v12, s[28:31], s48 offen offset:1024
  buffer_load_dwordx4 v[108:111], v12, s[28:31], s48 offen offset:1536
  buffer_load_dwordx4 v[112:115], v12, s[28:31], s48 offen offset:2048
  buffer_load_dwordx4 v[116:119], v12, s[28:31], s48 offen offset:2560
  buffer_load_dwordx4 v[120:123], v12, s[28:31], s48 offen offset:3072
  buffer_load_dwordx4 v[124:127], v12, s[28:31], s48 offen offset:3584
  s_add_u32 s48, s48, 4096
  buffer_load_dwordx4 v[128:131], v12, s[28:31], s48 offen offset:0
  buffer_load_dwordx4 v[132:135], v12, s[28:31], s48 offen offset:512
  buffer_load_dwordx4 v[136:139], v12, s[28:31], s48 offen offset:1024
  buffer_load_dwordx4 v[140:143], v12, s[28:31], s48 offen offset:1536
  buffer_load_dwordx4 v[144:147], v12, s[28:31], s48 offen offset:2048
  buffer_load_dwordx4 v[148:151], v12, s[28:31], s48 offen offset:2560
  buffer_load_dwordx4 v[152:155], v12, s[28:31], s48 offen offset:3072
  buffer_load_dwordx4 v[156:159], v12, s[28:31], s48 offen offset:3584
  s_add_u32 s48, s48, 4096
  buffer_load_dwordx4 v[160:163], v12, s[28:31], s48 offen offset:0
  buffer_load_dwordx4 v[164:167], v12, s[28:31], s48 offen offset:512
  buffer_load_dwordx4 v[168:171], v12, s[28:31], s48 offen offset:1024
  buffer_load_dwordx4 v[172:175], v12, s[28:31], s48 offen offset:1536
  buffer_load_dwordx4 v[176:179], v12, s[28:31], s48 offen offset:2048
  buffer_load_dwordx4 v[180:183], v12, s[28:31], s48 offen offset:2560
  buffer_load_dwordx4 v[184:187], v12, s[28:31], s48 offen offset:3072
  buffer_load_dwordx4 v[188:191], v12, s[28:31], s48 offen offset:3584
  s_add_u32 s48, s48, 4096
  v_bfe_u32 v4, v2, 2, 2
  v_and_b32 v7, 3, v2
  v_lshlrev_b32 v4, 6, v4
  v_lshl_add_u32 v4, v7, 3, v4
  v_lshl_add_u32 v4, v5, 9, v4
  v_xor_b32 v7, v6, v5
  v_lshl_add_u32 v13, v7, 5, v4
  v_add_u32 v4, 40960, v13
  v_add_u32 v8, 106496, v13
  ds_read_b64_tr_b16 v[48:49], v4 offset:0
  ds_read_b64_tr_b16 v[50:51], v4 offset:2048
  ds_read_b64_tr_b16 v[52:53], v4 offset:256
  ds_read_b64_tr_b16 v[54:55], v4 offset:2304
  ds_read_b64_tr_b16 v[56:57], v4 offset:1024
  ds_read_b64_tr_b16 v[58:59], v4 offset:3072
  ds_read_b64_tr_b16 v[60:61], v4 offset:1280
  ds_read_b64_tr_b16 v[62:63], v4 offset:3328
  s_waitcnt vmcnt(16)
  v_bitop3_b32 v81, v96, v97, v98 bitop3:0x80
  v_bitop3_b32 v81, v81, v99, v100 bitop3:0x80
  v_bitop3_b32 v81, v81, v101, v102 bitop3:0x80
  v_bitop3_b32 v81, v81, v103, v104 bitop3:0x80
  v_bitop3_b32 v81, v81, v105, v106 bitop3:0x80
  v_bitop3_b32 v81, v81, v107, v108 bitop3:0x80
  v_bitop3_b32 v81, v81, v109, v110 bitop3:0x80
  v_bitop3_b32 v81, v81, v111, v112 bitop3:0x80
  v_bitop3_b32 v81, v81, v113, v114 bitop3:0x80
  v_bitop3_b32 v81, v81, v115, v116 bitop3:0x80
  v_bitop3_b32 v81, v81, v117, v118 bitop3:0x80
  v_bitop3_b32 v81, v81, v119, v120 bitop3:0x80
  v_bitop3_b32 v81, v81, v121, v122 bitop3:0x80
  v_bitop3_b32 v81, v81, v123, v124 bitop3:0x80
  v_bitop3_b32 v81, v81, v125, v126 bitop3:0x80
  v_bitop3_b32 v81, v81, v127, 1 bitop3:0x80
  v_cmp_eq_u32 vcc, 0, v81
  s_nop 0
  s_cmp_lg_u64 vcc, 0
  s_cbranch_scc1 K3_retry0
K3_retry0_ret:
  s_waitcnt lgkmcnt(6)
  v_mfma_f32_32x32x16_bf16 v[16:31], v[48:51], v[96:99], 0
  ds_read_b64_tr_b16 v[64:65], v4 offset:4096
  ds_read_b64_tr_b16 v[66:67], v4 offset:6144
  s_waitcnt lgkmcnt(6)
  v_mfma_f32_32x32x16_bf16 v[32:47], v[52:55], v[96:99], 0
  ds_read_b64_tr_b16 v[68:69], v4 offset:4352
  ds_read_b64_tr_b16 v[70:71], v4 offset:6400
  s_waitcnt lgkmcnt(6)
  v_mfma_f32_32x32x16_bf16 v[16:31], v[56:59], v[100:103], v[16:31]
  ds_read_b64_tr_b16 v[72:73], v4 offset:5120
  ds_read_b64_tr_b16 v[74:75], v4 offset:7168
  s_waitcnt lgkmcnt(6)
  v_mfma_f32_32x32x16_bf16 v[32:47], v[60:63], v[100:103], v[32:47]
  ds_read_b64_tr_b16 v[76:77], v4 offset:5376
  ds_read_b64_tr_b16 v[78:79], v4 offset:7424
  buffer_load_dwordx4 v[192:195], v12, s[28:31], s48 offen offset:0
  buffer_load_dwordx4 v[196:199], v12, s[28:31], s48 offen offset:512
  buffer_load_dwordx4 v[200:203], v12, s[28:31], s48 offen offset:1024
  buffer_load_dwordx4 v[204:207], v12, s[28:31], s48 offen offset:1536
  s_waitcnt lgkmcnt(6)
  v_mfma_f32_32x32x16_bf16 v[16:31], v[64:67], v[104:107], v[16:31]
  ds_read_b64_tr_b16 v[48:49], v4 offset:8192
  ds_read_b64_tr_b16 v[50:51], v4 offset:10240
  s_waitcnt lgkmcnt(6)
  v_mfma_f32_32x32x16_bf16 v[32:47], v[68:71], v[104:107], v[32:47]
  ds_read_b64_tr_b16 v[52:53], v4 offset:8448
  ds_read_b64_tr_b16 v[54:55], v4 offset:10496
  s_waitcnt lgkmcnt(6)
  v_mfma_f32_32x32x16_bf16 v[16:31], v[72:75], v[108:111], v[16:31]
  ds_read_b64_tr_b16 v[56:57], v4 offset:9216
  ds_read_b64_tr_b16 v[58:59], v4 offset:11264
  s_waitcnt lgkmcnt(6)
  v_mfma_f32_32x32x16_bf16 v[32:47], v[76:79], v[108:111], v[32:47]
  ds_read_b64_tr_b16 v[60:61], v4 offset:9472
  ds_read_b64_tr_b16 v[62:63], v4 offset:11520
  buffer_load_dwordx4 v[208:211], v12, s[28:31], s48 offen offset:2048
  buffer_load_dwordx4 v[212:215], v12, s[28:31], s48 offen offset:2560
  buffer_load_dwordx4 v[216:219], v12, s[28:31], s48 offen offset:3072
  buffer_load_dwordx4 v[220:223], v12, s[28:31], s48 offen offset:3584
  s_add_u32 s48, s48, 4096
  s_waitcnt vmcnt(16)
  s_waitcnt lgkmcnt(6)
  v_mfma_f32_32x32x16_bf16 v[16:31], v[48:51], v[112:115], v[16:31]
  ds_read_b64_tr_b16 v[64:65], v4 offset:12288
  v_bitop3_b32 v81, v128, v129, v130 bitop3:0x80
  ds_read_b64_tr_b16 v[66:67], v4 offset:14336
  v_bitop3_b32 v81, v81, v131, v132 bitop3:0x80
  s_waitcnt lgkmcnt(6)
  v_mfma_f32_32x32x16_bf16 v[32:47], v[52:55], v[112:115], v[32:47]
  ds_read_b64_tr_b16 v[68:69], v4 offset:12544
  v_bitop3_b32 v81, v81, v133, v134 bitop3:0x80
  ds_read_b64_tr_b16 v[70:71], v4 offset:14592
  v_bitop3_b32 v81, v81, v135, v136 bitop3:0x80
  s_waitcnt lgkmcnt(6)
  v_mfma_f32_32x32x16_bf16 v[16:31], v[56:59], v[116:119], v[16:31]
  ds_read_b64_tr_b16 v[72:73], v4 offset:13312
  v_bitop3_b32 v81, v81, v137, v138 bitop3:0x80
  ds_read_b64_tr_b16 v[74:75], v4 offset:15360
  v_bitop3_b32 v81, v81, v139, v140 bitop3:0x80
  s_waitcnt lgkmcnt(6)
  v_mfma_f32_32x32x16_bf16 v[32:47], v[60:63], v[116:119], v[32:47]
  ds_read_b64_tr_b16 v[76:77], v4 offset:13568
  v_bitop3_b32 v81, v81, v141, v142 bitop3:0x80
  ds_read_b64_tr_b16 v[78:79], v4 offset:15616
  v_bitop3_b32 v81, v81, v143, v144 bitop3:0x80
  buffer_load_dwordx4 v[96:99], v12, s[28:31], s48 offen offset:0
  buffer_load_dwordx4 v[100:103], v12, s[28:31], s48 offen offset:512
  buffer_load_dwordx4 v[104:107], v12, s[28:31], s48 offen offset:1024
  buffer_load_dwordx4 v[108:111], v12, s[28:31], s48 offen offset:1536
  s_waitcnt lgkmcnt(6)
  v_mfma_f32_32x32x16_bf16 v[16:31], v[64:67], v[120:123], v[16:31]
  ds_read_b64_tr_b16 v[48:49], v4 offset:16384
  v_bitop3_b32 v81, v81, v145, v146 bitop3:0x80
  ds_read_b64_tr_b16 v[50:51], v4 offset:18432
  v_bitop3_b32 v81, v81, v147, v148 bitop3:0x80
  s_waitcnt lgkmcnt(6)
  v_mfma_f32_32x32x16_bf16 v[32:47], v[68:71], v[120:123], v[32:47]
  ds_read_b64_tr_b16 v[52:53], v4 offset:16640
  v_bitop3_b32 v81, v81, v149, v150 bitop3:0x80
  ds_read_b64_tr_b16 v[54:55], v4 offset:18688
  v_bitop3_b32 v81, v81, v151, v152 bitop3:0x80
  s_waitcnt lgkmcnt(6)
  v_mfma_f32_32x32x16_bf16 v[16:31], v[72:75], v[124:127], v[16:31]
  ds_read_b64_tr_b16 v[56:57], v4 offset:17408
  v_bitop3_b32 v81, v81, v153, v154 bitop3:0x80
  ds_read_b64_tr_b16 v[58:59], v4 offset:19456
  v_bitop3_b32 v81, v81, v155, v156 bitop3:0x80
  s_waitcnt lgkmcnt(6)
  v_mfma_f32_32x32x16_bf16 v[32:47], v[76:79], v[124:127], v[32:47]
  ds_read_b64_tr_b16 v[60:61], v4 offset:17664
  v_bitop3_b32 v81, v81, v157, v158 bitop3:0x80
  ds_read_b64_tr_b16 v[62:63], v4 offset:19712
  v_bitop3_b32 v81, v81, v159, 1 bitop3:0x80
  v_cmp_eq_u32 vcc, 0, v81
  s_nop 0
  s_cmp_lg_u64 vcc, 0
  s_cbranch_scc1 K3_retry1
K3_retry1_ret:
  buffer_load_dwordx4 v[112:115], v12, s[28:31], s48 offen offset:2048
  buffer_load_dwordx4 v[116:119], v12, s[28:31], s48 offen offset:2560
  buffer_load_dwordx4 v[120:123], v12, s[28:31], s48 offen offset:3072
  buffer_load_dwordx4 v[124:127], v12, s[28:31], s48 offen offset:3584
  s_add_u32 s48, s48, 4096
  s_waitcnt lgkmcnt(6)
  v_mfma_f32_32x32x16_bf16 v[16:31], v[48:51], v[128:131], v[16:31]
  ds_read_b64_tr_b16 v[64:65], v4 offset:20480
  ds_read_b64_tr_b16 v[66:67], v4 offset:22528
  s_waitcnt lgkmcnt(6)
  v_mfma_f32_32x32x16_bf16 v[32:47], v[52:55], v[128:131], v[32:47]
  ds_read_b64_tr_b16 v[68:69], v4 offset:20736
  ds_read_b64_tr_b16 v[70:71], v4 offset:22784
  s_waitcnt lgkmcnt(6)
  v_mfma_f32_32x32x16_bf16 v[16:31], v[56:59], v[132:135], v[16:31]
  ds_read_b64_tr_b16 v[72:73], v4 offset:21504
  ds_read_b64_tr_b16 v[74:75], v4 offset:23552
  s_waitcnt lgkmcnt(6)
  v_mfma_f32_32x32x16_bf16 v[32:47], v[60:63], v[132:135], v[32:47]
  ds_read_b64_tr_b16 v[76:77], v4 offset:21760
  ds_read_b64_tr_b16 v[78:79], v4 offset:23808
  buffer_load_dwordx4 v[128:131], v12, s[28:31], s48 offen offset:0
  buffer_load_dwordx4 v[132:135], v12, s[28:31], s48 offen offset:512
  s_waitcnt lgkmcnt(6)
  v_mfma_f32_32x32x16_bf16 v[16:31], v[64:67], v[136:139], v[16:31]
  ds_read_b64_tr_b16 v[48:49], v4 offset:24576
  ds_read_b64_tr_b16 v[50:51], v4 offset:26624
  s_waitcnt lgkmcnt(6)
  v_mfma_f32_32x32x16_bf16 v[32:47], v[68:71], v[136:139], v[32:47]
  ds_read_b64_tr_b16 v[52:53], v4 offset:24832
  ds_read_b64_tr_b16 v[54:55], v4 offset:26880
  s_waitcnt lgkmcnt(6)
  v_mfma_f32_32x32x16_bf16 v[16:31], v[72:75], v[140:143], v[16:31]
  ds_read_b64_tr_b16 v[56:57], v4 offset:25600
  ds_read_b64_tr_b16 v[58:59], v4 offset:27648
  s_waitcnt lgkmcnt(6)
  v_mfma_f32_32x32x16_bf16 v[32:47], v[76:79], v[140:143], v[32:47]
  ds_read_b64_tr_b16 v[60:61], v4 offset:25856
  ds_read_b64_tr_b16 v[62:63], v4 offset:27904
  buffer_load_dwordx4 v[136:139], v12, s[28:31], s48 offen offset:1024
  buffer_load_dwordx4 v[140:143], v12, s[28:31], s48 offen offset:1536
  s_waitcnt vmcnt(20)
  s_waitcnt lgkmcnt(6)
  v_mfma_f32_32x32x16_bf16 v[16:31], v[48:51], v[144:147], v[16:31]
  ds_read_b64_tr_b16 v[64:65], v4 offset:28672
  v_bitop3_b32 v81, v160, v161, v162 bitop3:0x80
  ds_read_b64_tr_b16 v[66:67], v4 offset:30720
  v_bitop3_b32 v81, v81, v163, v164 bitop3:0x80
  s_waitcnt lgkmcnt(6)
  v_mfma_f32_32x32x16_bf16 v[32:47], v[52:55], v[144:147], v[32:47]
  ds_read_b64_tr_b16 v[68:69], v4 offset:28928
  v_bitop3_b32 v81, v81, v165, v166 bitop3:0x80
  ds_read_b64_tr_b16 v[70:71], v4 offset:30976
  v_bitop3_b32 v81, v81, v167, v168 bitop3:0x80
  s_waitcnt lgkmcnt(6)
  v_mfma_f32_32x32x16_bf16 v[16:31], v[56:59], v[148:151], v[16:31]
  ds_read_b64_tr_b16 v[72:73], v4 offset:29696
  v_bitop3_b32 v81, v81, v169, v170 bitop3:0x80
  ds_read_b64_tr_b16 v[74:75], v4 offset:31744
  v_bitop3_b32 v81, v81, v171, v172 bitop3:0x80
  s_waitcnt lgkmcnt(6)
  v_mfma_f32_32x32x16_bf16 v[32:47], v[60:63], v[148:151], v[32:47]
  ds_read_b64_tr_b16 v[76:77], v4 offset:29952
  v_bitop3_b32 v81, v81, v173, v174 bitop3:0x80
  ds_read_b64_tr_b16 v[78:79], v4 offset:32000
  v_bitop3_b32 v81, v81, v175, v176 bitop3:0x80
  buffer_load_dwordx4 v[144:147], v12, s[28:31], s48 offen offset:2048
  buffer_load_dwordx4 v[148:151], v12, s[28:31], s48 offen offset:2560
  s_waitcnt lgkmcnt(6)
  v_mfma_f32_32x32x16_bf16 v[16:31], v[64:67], v[152:155], v[16:31]
  ds_read_b64_tr_b16 v[48:49], v4 offset:32768
  v_bitop3_b32 v81, v81, v177, v178 bitop3:0x80
  ds_read_b64_tr_b16 v[50:51], v4 offset:34816
  v_bitop3_b32 v81, v81, v179, v180 bitop3:0x80
  s_waitcnt lgkmcnt(6)
  v_mfma_f32_32x32x16_bf16 v[32:47], v[68:71], v[152:155], v[32:47]
  ds_read_b64_tr_b16 v[52:53], v4 offset:33024
  v_bitop3_b32 v81, v81, v181, v182 bitop3:0x80
  ds_read_b64_tr_b16 v[54:55], v4 offset:35072
  v_bitop3_b32 v81, v81, v183, v184 bitop3:0x80
  s_waitcnt lgkmcnt(6)
  v_mfma_f32_32x32x16_bf16 v[16:31], v[72:75], v[156:159], v[16:31]
  ds_read_b64_tr_b16 v[56:57], v4 offset:33792
  v_bitop3_b32 v81, v81, v185, v186 bitop3:0x80
  ds_read_b64_tr_b16 v[58:59], v4 offset:35840
  v_bitop3_b32 v81, v81, v187, v188 bitop3:0x80
  s_waitcnt lgkmcnt(6)
  v_mfma_f32_32x32x16_bf16 v[32:47], v[76:79], v[156:159], v[32:47]
  ds_read_b64_tr_b16 v[60:61], v4 offset:34048
  v_bitop3_b32 v81, v81, v189, v190 bitop3:0x80
  ds_read_b64_tr_b16 v[62:63], v4 offset:36096
  v_bitop3_b32 v81, v81, v191, 1 bitop3:0x80
  v_cmp_eq_u32 vcc, 0, v81
  s_nop 0
  s_cmp_lg_u64 vcc, 0
  s_cbranch_scc1 K3_retry2
K3_retry2_ret:
  buffer_load_dwordx4 v[152:155], v12, s[28:31], s48 offen offset:3072
  buffer_load_dwordx4 v[156:159], v12, s[28:31], s48 offen offset:3584
  s_add_u32 s48, s48, 4096
  s_waitcnt lgkmcnt(6)
  v_mfma_f32_32x32x16_bf16 v[16:31], v[48:51], v[160:163], v[16:31]
  ds_read_b64_tr_b16 v[64:65], v4 offset:36864
  ds_read_b64_tr_b16 v[66:67], v4 offset:38912
  s_waitcnt lgkmcnt(6)
  v_mfma_f32_32x32x16_bf16 v[32:47], v[52:55], v[160:163], v[32:47]
  ds_read_b64_tr_b16 v[68:69], v4 offset:37120
  ds_read_b64_tr_b16 v[70:71], v4 offset:39168
  s_waitcnt lgkmcnt(6)
  v_mfma_f32_32x32x16_bf16 v[16:31], v[56:59], v[164:167], v[16:31]
  ds_read_b64_tr_b16 v[72:73], v4 offset:37888
  ds_read_b64_tr_b16 v[74:75], v4 offset:39936
  s_waitcnt lgkmcnt(6)
  v_mfma_f32_32x32x16_bf16 v[32:47], v[60:63], v[164:167], v[32:47]
  ds_read_b64_tr_b16 v[76:77], v4 offset:38144
  ds_read_b64_tr_b16 v[78:79], v4 offset:40192
  buffer_load_dwordx4 v[160:163], v12, s[28:31], s48 offen offset:0
  buffer_load_dwordx4 v[164:167], v12, s[28:31], s48 offen offset:512
  s_waitcnt lgkmcnt(6)
  v_mfma_f32_32x32x16_bf16 v[16:31], v[64:67], v[168:171], v[16:31]
  ds_read_b64_tr_b16 v[48:49], v4 offset:40960
  ds_read_b64_tr_b16 v[50:51], v4 offset:43008
  s_waitcnt lgkmcnt(6)
  v_mfma_f32_32x32x16_bf16 v[32:47], v[68:71], v[168:171], v[32:47]
  ds_read_b64_tr_b16 v[52:53], v4 offset:41216
  ds_read_b64_tr_b16 v[54:55], v4 offset:43264
  s_waitcnt lgkmcnt(6)
  v_mfma_f32_32x32x16_bf16 v[16:31], v[72:75], v[172:175], v[16:31]
  ds_read_b64_tr_b16 v[56:57], v4 offset:41984
  ds_read_b64_tr_b16 v[58:59], v4 offset:44032
  s_waitcnt lgkmcnt(6)
  v_mfma_f32_32x32x16_bf16 v[32:47], v[76:79], v[172:175], v[32:47]
  ds_read_b64_tr_b16 v[60:61], v4 offset:42240
  ds_read_b64_tr_b16 v[62:63], v4 offset:44288
  buffer_load_dwordx4 v[168:171], v12, s[28:31], s48 offen offset:1024
  buffer_load_dwordx4 v[172:175], v12, s[28:31], s48 offen offset:1536
  s_waitcnt vmcnt(20)
  s_waitcnt lgkmcnt(6)
  v_mfma_f32_32x32x16_bf16 v[16:31], v[48:51], v[176:179], v[16:31]
  ds_read_b64_tr_b16 v[64:65], v4 offset:45056
  v_bitop3_b32 v81, v192, v193, v194 bitop3:0x80
  ds_read_b64_tr_b16 v[66:67], v4 offset:47104
  v_bitop3_b32 v81, v81, v195, v196 bitop3:0x80
  s_waitcnt lgkmcnt(6)
  v_mfma_f32_32x32x16_bf16 v[32:47], v[52:55], v[176:179], v[32:47]
  ds_read_b64_tr_b16 v[68:69], v4 offset:45312
  v_bitop3_b32 v81, v81, v197, v198 bitop3:0x80
  ds_read_b64_tr_b16 v[70:71], v4 offset:47360
  v_bitop3_b32 v81, v81, v199, v200 bitop3:0x80
  s_waitcnt lgkmcnt(6)
  v_mfma_f32_32x32x16_bf16 v[16:31], v[56:59], v[180:183], v[16:31]
  ds_read_b64_tr_b16 v[72:73], v4 offset:46080
  v_bitop3_b32 v81, v81, v201, v202 bitop3:0x80
  ds_read_b64_tr_b16 v[74:75], v4 offset:48128
  v_bitop3_b32 v81, v81, v203, v204 bitop3:0x80
  s_waitcnt lgkmcnt(6)
  v_mfma_f32_32x32x16_bf16 v[32:47], v[60:63], v[180:183], v[32:47]
  ds_read_b64_tr_b16 v[76:77], v4 offset:46336
  v_bitop3_b32 v81, v81, v205, v206 bitop3:0x80
  ds_read_b64_tr_b16 v[78:79], v4 offset:48384
  v_bitop3_b32 v81, v81, v207, v208 bitop3:0x80
  buffer_load_dwordx4 v[176:179], v12, s[28:31], s48 offen offset:2048
  buffer_load_dwordx4 v[180:183], v12, s[28:31], s48 offen offset:2560
  s_waitcnt lgkmcnt(6)
  v_mfma_f32_32x32x16_bf16 v[16:31], v[64:67], v[184:187], v[16:31]
  ds_read_b64_tr_b16 v[48:49], v4 offset:49152
  v_bitop3_b32 v81, v81, v209, v210 bitop3:0x80
  ds_read_b64_tr_b16 v[50:51], v4 offset:51200
  v_bitop3_b32 v81, v81, v211, v212 bitop3:0x80
  s_waitcnt lgkmcnt(6)
  v_mfma_f32_32x32x16_bf16 v[32:47], v[68:71], v[184:187], v[32:47]
  ds_read_b64_tr_b16 v[52:53], v4 offset:49408
  v_bitop3_b32 v81, v81, v213, v214 bitop3:0x80
  ds_read_b64_tr_b16 v[54:55], v4 offset:51456
  v_bitop3_b32 v81, v81, v215, v216 bitop3:0x80
  s_waitcnt lgkmcnt(6)
  v_mfma_f32_32x32x16_bf16 v[16:31], v[72:75], v[188:191], v[16:31]
  ds_read_b64_tr_b16 v[56:57], v4 offset:50176
  v_bitop3_b32 v81, v81, v217, v218 bitop3:0x80
  ds_read_b64_tr_b16 v[58:59], v4 offset:52224
  v_bitop3_b32 v81, v81, v219, v220 bitop3:0x80
  s_waitcnt lgkmcnt(6)
  v_mfma_f32_32x32x16_bf16 v[32:47], v[76:79], v[188:191], v[32:47]
  ds_read_b64_tr_b16 v[60:61], v4 offset:50432
  v_bitop3_b32 v81, v81, v221, v222 bitop3:0x80
  ds_read_b64_tr_b16 v[62:63], v4 offset:52480
  v_bitop3_b32 v81, v81, v223, 1 bitop3:0x80
  v_cmp_eq_u32 vcc, 0, v81
  s_nop 0
  s_cmp_lg_u64 vcc, 0
  s_cbranch_scc1 K3_retry3
K3_retry3_ret:
  buffer_load_dwordx4 v[184:187], v12, s[28:31], s48 offen offset:3072
  buffer_load_dwordx4 v[188:191], v12, s[28:31], s48 offen offset:3584
  s_add_u32 s48, s48, 4096
  s_waitcnt lgkmcnt(6)
  v_mfma_f32_32x32x16_bf16 v[16:31], v[48:51], v[192:195], v[16:31]
  ds_read_b64_tr_b16 v[64:65], v4 offset:53248
  ds_read_b64_tr_b16 v[66:67], v4 offset:55296
  s_waitcnt lgkmcnt(6)
  v_mfma_f32_32x32x16_bf16 v[32:47], v[52:55], v[192:195], v[32:47]
  ds_read_b64_tr_b16 v[68:69], v4 offset:53504
  ds_read_b64_tr_b16 v[70:71], v4 offset:55552
  s_waitcnt lgkmcnt(6)
  v_mfma_f32_32x32x16_bf16 v[16:31], v[56:59], v[196:199], v[16:31]
  ds_read_b64_tr_b16 v[72:73], v4 offset:54272
  ds_read_b64_tr_b16 v[74:75], v4 offset:56320
  s_waitcnt lgkmcnt(6)
  v_mfma_f32_32x32x16_bf16 v[32:47], v[60:63], v[196:199], v[32:47]
  ds_read_b64_tr_b16 v[76:77], v4 offset:54528
  ds_read_b64_tr_b16 v[78:79], v4 offset:56576
  buffer_load_dwordx4 v[192:195], v12, s[28:31], s48 offen offset:0
  buffer_load_dwordx4 v[196:199], v12, s[28:31], s48 offen offset:512
  s_waitcnt lgkmcnt(6)
  v_mfma_f32_32x32x16_bf16 v[16:31], v[64:67], v[200:203], v[16:31]
  ds_read_b64_tr_b16 v[48:49], v4 offset:57344
  ds_read_b64_tr_b16 v[50:51], v4 offset:59392
  s_waitcnt lgkmcnt(6)
  v_mfma_f32_32x32x16_bf16 v[32:47], v[68:71], v[200:203], v[32:47]
  ds_read_b64_tr_b16 v[52:53], v4 offset:57600
  ds_read_b64_tr_b16 v[54:55], v4 offset:59648
  s_waitcnt lgkmcnt(6)
  v_mfma_f32_32x32x16_bf16 v[16:31], v[72:75], v[204:207], v[16:31]
  ds_read_b64_tr_b16 v[56:57], v4 offset:58368
  ds_read_b64_tr_b16 v[58:59], v4 offset:60416
  s_waitcnt lgkmcnt(6)
  v_mfma_f32_32x32x16_bf16 v[32:47], v[76:79], v[204:207], v[32:47]
  ds_read_b64_tr_b16 v[60:61], v4 offset:58624
  ds_read_b64_tr_b16 v[62:63], v4 offset:60672
  buffer_load_dwordx4 v[200:203], v12, s[28:31], s48 offen offset:1024
  buffer_load_dwordx4 v[204:207], v12, s[28:31], s48 offen offset:1536
  s_waitcnt vmcnt(20)
  s_waitcnt lgkmcnt(6)
  v_mfma_f32_32x32x16_bf16 v[16:31], v[48:51], v[208:211], v[16:31]
  ds_read_b64_tr_b16 v[64:65], v4 offset:61440
  v_bitop3_b32 v81, v96, v97, v98 bitop3:0x80
  ds_read_b64_tr_b16 v[66:67], v4 offset:63488
  v_bitop3_b32 v81, v81, v99, v100 bitop3:0x80
  s_waitcnt lgkmcnt(6)
  v_mfma_f32_32x32x16_bf16 v[32:47], v[52:55], v[208:211], v[32:47]
  ds_read_b64_tr_b16 v[68:69], v4 offset:61696
  v_bitop3_b32 v81, v81, v101, v102 bitop3:0x80
  ds_read_b64_tr_b16 v[70:71], v4 offset:63744
  v_bitop3_b32 v81, v81, v103, v104 bitop3:0x80
  s_waitcnt lgkmcnt(6)
  v_mfma_f32_32x32x16_bf16 v[16:31], v[56:59], v[212:215], v[16:31]
  ds_read_b64_tr_b16 v[72:73], v4 offset:62464
  v_bitop3_b32 v81, v81, v105, v106 bitop3:0x80
  ds_read_b64_tr_b16 v[74:75], v4 offset:64512
  v_bitop3_b32 v81, v81, v107, v108 bitop3:0x80
  s_waitcnt lgkmcnt(6)
  v_mfma_f32_32x32x16_bf16 v[32:47], v[60:63], v[212:215], v[32:47]
  ds_read_b64_tr_b16 v[76:77], v4 offset:62720
  v_bitop3_b32 v81, v81, v109, v110 bitop3:0x80
  ds_read_b64_tr_b16 v[78:79], v4 offset:64768
  v_bitop3_b32 v81, v81, v111, v112 bitop3:0x80
  buffer_load_dwordx4 v[208:211], v12, s[28:31], s48 offen offset:2048
  buffer_load_dwordx4 v[212:215], v12, s[28:31], s48 offen offset:2560
  s_waitcnt lgkmcnt(6)
  v_mfma_f32_32x32x16_bf16 v[16:31], v[64:67], v[216:219], v[16:31]
  ds_read_b64_tr_b16 v[48:49], v8 offset:0
  v_bitop3_b32 v81, v81, v113, v114 bitop3:0x80
  ds_read_b64_tr_b16 v[50:51], v8 offset:2048
  v_bitop3_b32 v81, v81, v115, v116 bitop3:0x80
  s_waitcnt lgkmcnt(6)
  v_mfma_f32_32x32x16_bf16 v[32:47], v[68:71], v[216:219], v[32:47]
  ds_read_b64_tr_b16 v[52:53], v8 offset:256
  v_bitop3_b32 v81, v81, v117, v118 bitop3:0x80
  ds_read_b64_tr_b16 v[54:55], v8 offset:2304
  v_bitop3_b32 v81, v81, v119, v120 bitop3:0x80
  s_waitcnt lgkmcnt(6)
  v_mfma_f32_32x32x16_bf16 v[16:31], v[72:75], v[220:223], v[16:31]
  ds_read_b64_tr_b16 v[56:57], v8 offset:1024
  v_bitop3_b32 v81, v81, v121, v122 bitop3:0x80
  ds_read_b64_tr_b16 v[58:59], v8 offset:3072
  v_bitop3_b32 v81, v81, v123, v124 bitop3:0x80
  s_waitcnt lgkmcnt(6)
  v_mfma_f32_32x32x16_bf16 v[32:47], v[76:79], v[220:223], v[32:47]
  ds_read_b64_tr_b16 v[60:61], v8 offset:1280
  v_bitop3_b32 v81, v81, v125, v126 bitop3:0x80
  ds_read_b64_tr_b16 v[62:63], v8 offset:3328
  v_bitop3_b32 v81, v81, v127, 1 bitop3:0x80
  v_cmp_eq_u32 vcc, 0, v81
  s_nop 0
  s_cmp_lg_u64 vcc, 0
  s_cbranch_scc1 K3_retry4
K3_retry4_ret:
  buffer_load_dwordx4 v[216:219], v12, s[28:31], s48 offen offset:3072
  buffer_load_dwordx4 v[220:223], v12, s[28:31], s48 offen offset:3584
  s_add_u32 s48, s48, 4096
  s_mov_b64 exec, 1
  ds_add_u32 v9, v11 offset:112
  s_mov_b64 exec, -1
  s_waitcnt lgkmcnt(7)
  v_mfma_f32_32x32x16_bf16 v[16:31], v[48:51], v[96:99], v[16:31]
  ds_read_b64_tr_b16 v[64:65], v8 offset:4096
  ds_read_b64_tr_b16 v[66:67], v8 offset:6144
  s_waitcnt lgkmcnt(7)
  v_mfma_f32_32x32x16_bf16 v[32:47], v[52:55], v[96:99], v[32:47]
  ds_read_b64_tr_b16 v[68:69], v8 offset:4352
  ds_read_b64_tr_b16 v[70:71], v8 offset:6400
  s_waitcnt lgkmcnt(7)
  v_mfma_f32_32x32x16_bf16 v[16:31], v[56:59], v[100:103], v[16:31]
  ds_read_b64_tr_b16 v[72:73], v8 offset:5120
  ds_read_b64_tr_b16 v[74:75], v8 offset:7168
  s_waitcnt lgkmcnt(7)
  v_mfma_f32_32x32x16_bf16 v[32:47], v[60:63], v[100:103], v[32:47]
  ds_read_b64_tr_b16 v[76:77], v8 offset:5376
  ds_read_b64_tr_b16 v[78:79], v8 offset:7424
  s_waitcnt lgkmcnt(6)
  v_mfma_f32_32x32x16_bf16 v[16:31], v[64:67], v[104:107], v[16:31]
  ds_read_b64_tr_b16 v[48:49], v8 offset:8192
  ds_read_b64_tr_b16 v[50:51], v8 offset:10240
  s_waitcnt lgkmcnt(6)
  v_mfma_f32_32x32x16_bf16 v[32:47], v[68:71], v[104:107], v[32:47]
  ds_read_b64_tr_b16 v[52:53], v8 offset:8448
  ds_read_b64_tr_b16 v[54:55], v8 offset:10496
  s_waitcnt lgkmcnt(6)
  v_mfma_f32_32x32x16_bf16 v[16:31], v[72:75], v[108:111], v[16:31]
  ds_read_b64_tr_b16 v[56:57], v8 offset:9216
  ds_read_b64_tr_b16 v[58:59], v8 offset:11264
  s_waitcnt lgkmcnt(6)
  v_mfma_f32_32x32x16_bf16 v[32:47], v[76:79], v[108:111], v[32:47]
  ds_read_b64_tr_b16 v[60:61], v8 offset:9472
  ds_read_b64_tr_b16 v[62:63], v8 offset:11520
  s_waitcnt vmcnt(16)
  s_waitcnt lgkmcnt(6)
  v_mfma_f32_32x32x16_bf16 v[16:31], v[48:51], v[112:115], v[16:31]
  ds_read_b64_tr_b16 v[64:65], v8 offset:12288
  v_bitop3_b32 v81, v128, v129, v130 bitop3:0x80
  ds_read_b64_tr_b16 v[66:67], v8 offset:14336
  v_bitop3_b32 v81, v81, v131, v132 bitop3:0x80
  s_waitcnt lgkmcnt(6)
  v_mfma_f32_32x32x16_bf16 v[32:47], v[52:55], v[112:115], v[32:47]
  ds_read_b64_tr_b16 v[68:69], v8 offset:12544
  v_bitop3_b32 v81, v81, v133, v134 bitop3:0x80
  ds_read_b64_tr_b16 v[70:71], v8 offset:14592
  v_bitop3_b32 v81, v81, v135, v136 bitop3:0x80
  s_waitcnt lgkmcnt(6)
  v_mfma_f32_32x32x16_bf16 v[16:31], v[56:59], v[116:119], v[16:31]
  ds_read_b64_tr_b16 v[72:73], v8 offset:13312
  v_bitop3_b32 v81, v81, v137, v138 bitop3:0x80
  ds_read_b64_tr_b16 v[74:75], v8 offset:15360
  v_bitop3_b32 v81, v81, v139, v140 bitop3:0x80
  s_waitcnt lgkmcnt(6)
  v_mfma_f32_32x32x16_bf16 v[32:47], v[60:63], v[116:119], v[32:47]
  ds_read_b64_tr_b16 v[76:77], v8 offset:13568
  v_bitop3_b32 v81, v81, v141, v142 bitop3:0x80
  ds_read_b64_tr_b16 v[78:79], v8 offset:15616
  v_bitop3_b32 v81, v81, v143, v144 bitop3:0x80
  s_waitcnt lgkmcnt(6)
  v_mfma_f32_32x32x16_bf16 v[16:31], v[64:67], v[120:123], v[16:31]
  ds_read_b64_tr_b16 v[48:49], v8 offset:16384
  v_bitop3_b32 v81, v81, v145, v146 bitop3:0x80
  ds_read_b64_tr_b16 v[50:51], v8 offset:18432
  v_bitop3_b32 v81, v81, v147, v148 bitop3:0x80
  s_waitcnt lgkmcnt(6)
  v_mfma_f32_32x32x16_bf16 v[32:47], v[68:71], v[120:123], v[32:47]
  ds_read_b64_tr_b16 v[52:53], v8 offset:16640
  v_bitop3_b32 v81, v81, v149, v150 bitop3:0x80
  ds_read_b64_tr_b16 v[54:55], v8 offset:18688
  v_bitop3_b32 v81, v81, v151, v152 bitop3:0x80
  s_waitcnt lgkmcnt(6)
  v_mfma_f32_32x32x16_bf16 v[16:31], v[72:75], v[124:127], v[16:31]
  ds_read_b64_tr_b16 v[56:57], v8 offset:17408
  v_bitop3_b32 v81, v81, v153, v154 bitop3:0x80
  ds_read_b64_tr_b16 v[58:59], v8 offset:19456
  v_bitop3_b32 v81, v81, v155, v156 bitop3:0x80
  s_waitcnt lgkmcnt(6)
  v_mfma_f32_32x32x16_bf16 v[32:47], v[76:79], v[124:127], v[32:47]
  ds_read_b64_tr_b16 v[60:61], v8 offset:17664
  v_bitop3_b32 v81, v81, v157, v158 bitop3:0x80
  ds_read_b64_tr_b16 v[62:63], v8 offset:19712
  v_bitop3_b32 v81, v81, v159, 1 bitop3:0x80
  v_cmp_eq_u32 vcc, 0, v81
  s_nop 0
  s_cmp_lg_u64 vcc, 0
  s_cbranch_scc1 K3_retry5
K3_retry5_ret:
  s_waitcnt lgkmcnt(6)
  v_mfma_f32_32x32x16_bf16 v[16:31], v[48:51], v[128:131], v[16:31]
  ds_read_b64_tr_b16 v[64:65], v8 offset:20480
  ds_read_b64_tr_b16 v[66:67], v8 offset:22528
  s_waitcnt lgkmcnt(6)
  v_mfma_f32_32x32x16_bf16 v[32:47], v[52:55], v[128:131], v[32:47]
  ds_read_b64_tr_b16 v[68:69], v8 offset:20736
  ds_read_b64_tr_b16 v[70:71], v8 offset:22784
  s_waitcnt lgkmcnt(6)
  v_mfma_f32_32x32x16_bf16 v[16:31], v[56:59], v[132:135], v[16:31]
  ds_read_b64_tr_b16 v[72:73], v8 offset:21504
  ds_read_b64_tr_b16 v[74:75], v8 offset:23552
  s_waitcnt lgkmcnt(6)
  v_mfma_f32_32x32x16_bf16 v[32:47], v[60:63], v[132:135], v[32:47]
  ds_read_b64_tr_b16 v[76:77], v8 offset:21760
  ds_read_b64_tr_b16 v[78:79], v8 offset:23808
  s_waitcnt lgkmcnt(6)
  v_mfma_f32_32x32x16_bf16 v[16:31], v[64:67], v[136:139], v[16:31]
  ds_read_b64_tr_b16 v[48:49], v8 offset:24576
  ds_read_b64_tr_b16 v[50:51], v8 offset:26624
  s_waitcnt lgkmcnt(6)
  v_mfma_f32_32x32x16_bf16 v[32:47], v[68:71], v[136:139], v[32:47]
  ds_read_b64_tr_b16 v[52:53], v8 offset:24832
  ds_read_b64_tr_b16 v[54:55], v8 offset:26880
  s_waitcnt lgkmcnt(6)
  v_mfma_f32_32x32x16_bf16 v[16:31], v[72:75], v[140:143], v[16:31]
  ds_read_b64_tr_b16 v[56:57], v8 offset:25600
  ds_read_b64_tr_b16 v[58:59], v8 offset:27648
  s_waitcnt lgkmcnt(6)
  v_mfma_f32_32x32x16_bf16 v[32:47], v[76:79], v[140:143], v[32:47]
  ds_read_b64_tr_b16 v[60:61], v8 offset:25856
  ds_read_b64_tr_b16 v[62:63], v8 offset:27904
  s_waitcnt vmcnt(8)
  s_waitcnt lgkmcnt(6)
  v_mfma_f32_32x32x16_bf16 v[16:31], v[48:51], v[144:147], v[16:31]
  ds_read_b64_tr_b16 v[64:65], v8 offset:28672
  v_bitop3_b32 v81, v160, v161, v162 bitop3:0x80
  ds_read_b64_tr_b16 v[66:67], v8 offset:30720
  v_bitop3_b32 v81, v81, v163, v164 bitop3:0x80
  s_waitcnt lgkmcnt(6)
  v_mfma_f32_32x32x16_bf16 v[32:47], v[52:55], v[144:147], v[32:47]
  ds_read_b64_tr_b16 v[68:69], v8 offset:28928
  v_bitop3_b32 v81, v81, v165, v166 bitop3:0x80
  ds_read_b64_tr_b16 v[70:71], v8 offset:30976
  v_bitop3_b32 v81, v81, v167, v168 bitop3:0x80
  s_waitcnt lgkmcnt(6)
  v_mfma_f32_32x32x16_bf16 v[16:31], v[56:59], v[148:151], v[16:31]
  ds_read_b64_tr_b16 v[72:73], v8 offset:29696
  v_bitop3_b32 v81, v81, v169, v170 bitop3:0x80
  ds_read_b64_tr_b16 v[74:75], v8 offset:31744
  v_bitop3_b32 v81, v81, v171, v172 bitop3:0x80
  s_waitcnt lgkmcnt(6)
  v_mfma_f32_32x32x16_bf16 v[32:47], v[60:63], v[148:151], v[32:47]
  ds_read_b64_tr_b16 v[76:77], v8 offset:29952
  v_bitop3_b32 v81, v81, v173, v174 bitop3:0x80
  ds_read_b64_tr_b16 v[78:79], v8 offset:32000
  v_bitop3_b32 v81, v81, v175, v176 bitop3:0x80
  s_waitcnt lgkmcnt(6)
  v_mfma_f32_32x32x16_bf16 v[16:31], v[64:67], v[152:155], v[16:31]
  ds_read_b64_tr_b16 v[48:49], v8 offset:32768
  v_bitop3_b32 v81, v81, v177, v178 bitop3:0x80
  ds_read_b64_tr_b16 v[50:51], v8 offset:34816
  v_bitop3_b32 v81, v81, v179, v180 bitop3:0x80
  s_waitcnt lgkmcnt(6)
  v_mfma_f32_32x32x16_bf16 v[32:47], v[68:71], v[152:155], v[32:47]
  ds_read_b64_tr_b16 v[52:53], v8 offset:33024
  v_bitop3_b32 v81, v81, v181, v182 bitop3:0x80
  ds_read_b64_tr_b16 v[54:55], v8 offset:35072
  v_bitop3_b32 v81, v81, v183, v184 bitop3:0x80
  s_waitcnt lgkmcnt(6)
  v_mfma_f32_32x32x16_bf16 v[16:31], v[72:75], v[156:159], v[16:31]
  ds_read_b64_tr_b16 v[56:57], v8 offset:33792
  v_bitop3_b32 v81, v81, v185, v186 bitop3:0x80
  ds_read_b64_tr_b16 v[58:59], v8 offset:35840
  v_bitop3_b32 v81, v81, v187, v188 bitop3:0x80
  s_waitcnt lgkmcnt(6)
  v_mfma_f32_32x32x16_bf16 v[32:47], v[76:79], v[156:159], v[32:47]
  ds_read_b64_tr_b16 v[60:61], v8 offset:34048
  v_bitop3_b32 v81, v81, v189, v190 bitop3:0x80
  ds_read_b64_tr_b16 v[62:63], v8 offset:36096
  v_bitop3_b32 v81, v81, v191, 1 bitop3:0x80
  v_cmp_eq_u32 vcc, 0, v81
  s_nop 0
  s_cmp_lg_u64 vcc, 0
  s_cbranch_scc1 K3_retry6
K3_retry6_ret:
  s_waitcnt lgkmcnt(6)
  v_mfma_f32_32x32x16_bf16 v[16:31], v[48:51], v[160:163], v[16:31]
  ds_read_b64_tr_b16 v[64:65], v8 offset:36864
  ds_read_b64_tr_b16 v[66:67], v8 offset:38912
  s_waitcnt lgkmcnt(6)
  v_mfma_f32_32x32x16_bf16 v[32:47], v[52:55], v[160:163], v[32:47]
  ds_read_b64_tr_b16 v[68:69], v8 offset:37120
  ds_read_b64_tr_b16 v[70:71], v8 offset:39168
  s_waitcnt lgkmcnt(6)
  v_mfma_f32_32x32x16_bf16 v[16:31], v[56:59], v[164:167], v[16:31]
  ds_read_b64_tr_b16 v[72:73], v8 offset:37888
  ds_read_b64_tr_b16 v[74:75], v8 offset:39936
  s_waitcnt lgkmcnt(6)
  v_mfma_f32_32x32x16_bf16 v[32:47], v[60:63], v[164:167], v[32:47]
  ds_read_b64_tr_b16 v[76:77], v8 offset:38144
  ds_read_b64_tr_b16 v[78:79], v8 offset:40192
  s_waitcnt lgkmcnt(6)
  v_mfma_f32_32x32x16_bf16 v[16:31], v[64:67], v[168:171], v[16:31]
  ds_read_b64_tr_b16 v[48:49], v8 offset:40960
  ds_read_b64_tr_b16 v[50:51], v8 offset:43008
  s_waitcnt lgkmcnt(6)
  v_mfma_f32_32x32x16_bf16 v[32:47], v[68:71], v[168:171], v[32:47]
  ds_read_b64_tr_b16 v[52:53], v8 offset:41216
  ds_read_b64_tr_b16 v[54:55], v8 offset:43264
  s_waitcnt lgkmcnt(6)
  v_mfma_f32_32x32x16_bf16 v[16:31], v[72:75], v[172:175], v[16:31]
  ds_read_b64_tr_b16 v[56:57], v8 offset:41984
  ds_read_b64_tr_b16 v[58:59], v8 offset:44032
  s_waitcnt lgkmcnt(6)
  v_mfma_f32_32x32x16_bf16 v[32:47], v[76:79], v[172:175], v[32:47]
  ds_read_b64_tr_b16 v[60:61], v8 offset:42240
  ds_read_b64_tr_b16 v[62:63], v8 offset:44288
  s_waitcnt vmcnt(0)
  s_waitcnt lgkmcnt(6)
  v_mfma_f32_32x32x16_bf16 v[16:31], v[48:51], v[176:179], v[16:31]
  ds_read_b64_tr_b16 v[64:65], v8 offset:45056
  v_bitop3_b32 v81, v192, v193, v194 bitop3:0x80
  ds_read_b64_tr_b16 v[66:67], v8 offset:47104
  v_bitop3_b32 v81, v81, v195, v196 bitop3:0x80
  s_waitcnt lgkmcnt(6)
  v_mfma_f32_32x32x16_bf16 v[32:47], v[52:55], v[176:179], v[32:47]
  ds_read_b64_tr_b16 v[68:69], v8 offset:45312
  v_bitop3_b32 v81, v81, v197, v198 bitop3:0x80
  ds_read_b64_tr_b16 v[70:71], v8 offset:47360
  v_bitop3_b32 v81, v81, v199, v200 bitop3:0x80
  s_waitcnt lgkmcnt(6)
  v_mfma_f32_32x32x16_bf16 v[16:31], v[56:59], v[180:183], v[16:31]
  ds_read_b64_tr_b16 v[72:73], v8 offset:46080
  v_bitop3_b32 v81, v81, v201, v202 bitop3:0x80
  ds_read_b64_tr_b16 v[74:75], v8 offset:48128
  v_bitop3_b32 v81, v81, v203, v204 bitop3:0x80
  s_waitcnt lgkmcnt(6)
  v_mfma_f32_32x32x16_bf16 v[32:47], v[60:63], v[180:183], v[32:47]
  ds_read_b64_tr_b16 v[76:77], v8 offset:46336
  v_bitop3_b32 v81, v81, v205, v206 bitop3:0x80
  ds_read_b64_tr_b16 v[78:79], v8 offset:48384
  v_bitop3_b32 v81, v81, v207, v208 bitop3:0x80
  s_waitcnt lgkmcnt(0)
  s_mov_b32 s43, 131072
K3_wwt:
  ds_read_b32 v80, v10 offset:52
  s_waitcnt lgkmcnt(0)
  v_readfirstlane_b32 s42, v80
  s_sub_u32 s43, s43, 1
  s_cbranch_scc1 K3_wwt_ok
  s_cmp_lt_u32 s42, 4
  s_cbranch_scc1 K3_wwt
K3_wwt_ok:
  v_mfma_f32_32x32x16_bf16 v[16:31], v[64:67], v[184:187], v[16:31]
  ds_read_b64_tr_b16 v[48:49], v13 offset:0
  v_bitop3_b32 v81, v81, v209, v210 bitop3:0x80
  ds_read_b64_tr_b16 v[50:51], v13 offset:2048
  v_bitop3_b32 v81, v81, v211, v212 bitop3:0x80
  v_mfma_f32_32x32x16_bf16 v[32:47], v[68:71], v[184:187], v[32:47]
  ds_read_b64_tr_b16 v[52:53], v13 offset:256
  v_bitop3_b32 v81, v81, v213, v214 bitop3:0x80
  ds_read_b64_tr_b16 v[54:55], v13 offset:2304
  v_bitop3_b32 v81, v81, v215, v216 bitop3:0x80
  v_mfma_f32_32x32x16_bf16 v[16:31], v[72:75], v[188:191], v[16:31]
  ds_read_b64_tr_b16 v[56:57], v13 offset:1024
  v_bitop3_b32 v81, v81, v217, v218 bitop3:0x80
  ds_read_b64_tr_b16 v[58:59], v13 offset:3072
  v_bitop3_b32 v81, v81, v219, v220 bitop3:0x80
  v_mfma_f32_32x32x16_bf16 v[32:47], v[76:79], v[188:191], v[32:47]
  ds_read_b64_tr_b16 v[60:61], v13 offset:1280
  v_bitop3_b32 v81, v81, v221, v222 bitop3:0x80
  ds_read_b64_tr_b16 v[62:63], v13 offset:3328
  v_bitop3_b32 v81, v81, v223, 1 bitop3:0x80
  v_cmp_eq_u32 vcc, 0, v81
  s_nop 0
  s_cmp_lg_u64 vcc, 0
  s_cbranch_scc1 K3_retry7
K3_retry7_ret:
  s_waitcnt lgkmcnt(6)
  v_mfma_f32_32x32x16_bf16 v[16:31], v[48:51], v[192:195], v[16:31]
  ds_read_b64_tr_b16 v[64:65], v13 offset:8704
  ds_read_b64_tr_b16 v[66:67], v13 offset:10752
  s_waitcnt lgkmcnt(6)
  v_mfma_f32_32x32x16_bf16 v[32:47], v[52:55], v[192:195], v[32:47]
  ds_read_b64_tr_b16 v[68:69], v13 offset:8960
  ds_read_b64_tr_b16 v[70:71], v13 offset:11008
  s_waitcnt lgkmcnt(6)
  v_mfma_f32_32x32x16_bf16 v[16:31], v[56:59], v[196:199], v[16:31]
  ds_read_b64_tr_b16 v[72:73], v13 offset:9728
  ds_read_b64_tr_b16 v[74:75], v13 offset:11776
  s_waitcnt lgkmcnt(6)
  v_mfma_f32_32x32x16_bf16 v[32:47], v[60:63], v[196:199], v[32:47]
  ds_read_b64_tr_b16 v[76:77], v13 offset:9984
  ds_read_b64_tr_b16 v[78:79], v13 offset:12032
  s_waitcnt lgkmcnt(6)
  v_mfma_f32_32x32x16_bf16 v[16:31], v[64:67], v[200:203], v[16:31]
  ds_read_b64_tr_b16 v[48:49], v13 offset:17408
  ds_read_b64_tr_b16 v[50:51], v13 offset:19456
  s_waitcnt lgkmcnt(6)
  v_mfma_f32_32x32x16_bf16 v[32:47], v[68:71], v[200:203], v[32:47]
  ds_read_b64_tr_b16 v[52:53], v13 offset:17664
  ds_read_b64_tr_b16 v[54:55], v13 offset:19712
  s_waitcnt lgkmcnt(6)
  v_mfma_f32_32x32x16_bf16 v[16:31], v[72:75], v[204:207], v[16:31]
  ds_read_b64_tr_b16 v[56:57], v13 offset:18432
  ds_read_b64_tr_b16 v[58:59], v13 offset:20480
  s_waitcnt lgkmcnt(6)
  v_mfma_f32_32x32x16_bf16 v[32:47], v[76:79], v[204:207], v[32:47]
  ds_read_b64_tr_b16 v[60:61], v13 offset:18688
  ds_read_b64_tr_b16 v[62:63], v13 offset:20736
  s_waitcnt lgkmcnt(6)
  v_mfma_f32_32x32x16_bf16 v[16:31], v[48:51], v[208:211], v[16:31]
  ds_read_b64_tr_b16 v[64:65], v13 offset:26112
  ds_read_b64_tr_b16 v[66:67], v13 offset:28160
  s_waitcnt lgkmcnt(6)
  v_mfma_f32_32x32x16_bf16 v[32:47], v[52:55], v[208:211], v[32:47]
  ds_read_b64_tr_b16 v[68:69], v13 offset:26368
  ds_read_b64_tr_b16 v[70:71], v13 offset:28416
  s_waitcnt lgkmcnt(6)
  v_mfma_f32_32x32x16_bf16 v[16:31], v[56:59], v[212:215], v[16:31]
  ds_read_b64_tr_b16 v[72:73], v13 offset:27136
  ds_read_b64_tr_b16 v[74:75], v13 offset:29184
  s_waitcnt lgkmcnt(6)
  v_mfma_f32_32x32x16_bf16 v[32:47], v[60:63], v[212:215], v[32:47]
  ds_read_b64_tr_b16 v[76:77], v13 offset:27392
  ds_read_b64_tr_b16 v[78:79], v13 offset:29440
  s_waitcnt lgkmcnt(6)
  v_mfma_f32_32x32x16_bf16 v[16:31], v[64:67], v[216:219], v[16:31]
  s_waitcnt lgkmcnt(4)
  v_mfma_f32_32x32x16_bf16 v[32:47], v[68:71], v[216:219], v[32:47]
  s_waitcnt lgkmcnt(2)
  v_mfma_f32_32x32x16_bf16 v[16:31], v[72:75], v[220:223], v[16:31]
  s_waitcnt lgkmcnt(0)
  v_mfma_f32_32x32x16_bf16 v[32:47], v[76:79], v[220:223], v[32:47]
  v_and_b32 v4, 31, v2
  v_lshlrev_b32 v4, 12, v4
  v_lshl_add_u32 v4, v5, 4, v4
  s_lshr_b32 s36, s10, 2
  s_lshl_b32 s36, s36, 3
  s_lshr_b32 s37, s11, 2
  s_add_u32 s36, s36, s37
  s_lshl_b32 s38, s41, 16
  s_lshl_b32 s39, s36, 7
  s_add_u32 s38, s38, s39
  s_add_u32 s38, s38, 2048
  v_and_b32 v6, 31, v2
  v_and_b32 v7, 7, v2
  v_xor_b32 v7, v7, v5
  v_lshlrev_b32 v6, 7, v6
  s_add_u32 s39, s7, 4384
  v_add_u32 v6, s39, v6
  v_lshrrev_b32 v8, 3, v2
  v_and_b32 v13, 7, v2
  v_xor_b32 v96, v13, v8
  v_lshlrev_b32 v96, 4, v96
  v_lshl_add_u32 v96, v8, 7, v96
  v_add_u32 v96, s39, v96
  v_lshlrev_b32 v4, 12, v8
  v_lshl_add_u32 v4, v13, 4, v4
  v_cvt_pk_bf16_f32 v80, v16, v17
  v_cvt_pk_bf16_f32 v81, v18, v19
  v_cvt_pk_bf16_f32 v82, v20, v21
  v_cvt_pk_bf16_f32 v83, v22, v23
  s_nop 0
  v_permlane32_swap_b32 v80, v82
  v_permlane32_swap_b32 v81, v83
  v_xor_b32 v97, 0, v7
  v_lshl_add_u32 v97, v97, 4, v6
  ds_write_b128 v97, v[80:83]
  v_cvt_pk_bf16_f32 v84, v24, v25
  v_cvt_pk_bf16_f32 v85, v26, v27
  v_cvt_pk_bf16_f32 v86, v28, v29
  v_cvt_pk_bf16_f32 v87, v30, v31
  s_nop 0
  v_permlane32_swap_b32 v84, v86
  v_permlane32_swap_b32 v85, v87
  v_xor_b32 v97, 2, v7
  v_lshl_add_u32 v97, v97, 4, v6
  ds_write_b128 v97, v[84:87]
  v_cvt_pk_bf16_f32 v88, v32, v33
  v_cvt_pk_bf16_f32 v89, v34, v35
  v_cvt_pk_bf16_f32 v90, v36, v37
  v_cvt_pk_bf16_f32 v91, v38, v39
  s_nop 0
  v_permlane32_swap_b32 v88, v90
  v_permlane32_swap_b32 v89, v91
  v_xor_b32 v97, 4, v7
  v_lshl_add_u32 v97, v97, 4, v6
  ds_write_b128 v97, v[88:91]
  v_cvt_pk_bf16_f32 v92, v40, v41
  v_cvt_pk_bf16_f32 v93, v42, v43
  v_cvt_pk_bf16_f32 v94, v44, v45
  v_cvt_pk_bf16_f32 v95, v46, v47
  s_nop 0
  v_permlane32_swap_b32 v92, v94
  v_permlane32_swap_b32 v93, v95
  v_xor_b32 v97, 6, v7
  v_lshl_add_u32 v97, v97, 4, v6
  ds_write_b128 v97, v[92:95]
  ds_read_b128 v[100:103], v96 offset:0
  ds_read_b128 v[104:107], v96 offset:1024
  ds_read_b128 v[108:111], v96 offset:2048
  ds_read_b128 v[112:115], v96 offset:3072
  s_waitcnt lgkmcnt(3)
  buffer_store_dwordx4 v[100:103], v4, s[32:35], s38 offen sc1
  s_add_u32 s38, s38, 32768
  s_waitcnt lgkmcnt(2)
  buffer_store_dwordx4 v[104:107], v4, s[32:35], s38 offen sc1
  s_add_u32 s38, s38, 32768
  s_waitcnt lgkmcnt(1)
  buffer_store_dwordx4 v[108:111], v4, s[32:35], s38 offen sc1
  s_add_u32 s38, s38, 32768
  s_waitcnt lgkmcnt(0)
  buffer_store_dwordx4 v[112:115], v4, s[32:35], s38 offen sc1
  s_add_u32 s38, s38, 32768
  s_endpgm
K3_retry0:
  s_mov_b32 s46, 4000
  s_add_u32 s44, s47, 0
K3_retry0_l:
  s_add_u32 s75, s75, 1
  s_sleep 4
  buffer_load_dwordx4 v[96:99], v12, s[28:31], s44 offen offset:0 sc1
  buffer_load_dwordx4 v[100:103], v12, s[28:31], s44 offen offset:512 sc1
  buffer_load_dwordx4 v[104:107], v12, s[28:31], s44 offen offset:1024 sc1
  buffer_load_dwordx4 v[108:111], v12, s[28:31], s44 offen offset:1536 sc1
  buffer_load_dwordx4 v[112:115], v12, s[28:31], s44 offen offset:2048 sc1
  buffer_load_dwordx4 v[116:119], v12, s[28:31], s44 offen offset:2560 sc1
  buffer_load_dwordx4 v[120:123], v12, s[28:31], s44 offen offset:3072 sc1
  buffer_load_dwordx4 v[124:127], v12, s[28:31], s44 offen offset:3584 sc1
  s_waitcnt vmcnt(0)
  v_bitop3_b32 v81, v96, v97, v98 bitop3:0x80
  v_bitop3_b32 v81, v81, v99, v100 bitop3:0x80
  v_bitop3_b32 v81, v81, v101, v102 bitop3:0x80
  v_bitop3_b32 v81, v81, v103, v104 bitop3:0x80
  v_bitop3_b32 v81, v81, v105, v106 bitop3:0x80
  v_bitop3_b32 v81, v81, v107, v108 bitop3:0x80
  v_bitop3_b32 v81, v81, v109, v110 bitop3:0x80
  v_bitop3_b32 v81, v81, v111, v112 bitop3:0x80
  v_bitop3_b32 v81, v81, v113, v114 bitop3:0x80
  v_bitop3_b32 v81, v81, v115, v116 bitop3:0x80
  v_bitop3_b32 v81, v81, v117, v118 bitop3:0x80
  v_bitop3_b32 v81, v81, v119, v120 bitop3:0x80
  v_bitop3_b32 v81, v81, v121, v122 bitop3:0x80
  v_bitop3_b32 v81, v81, v123, v124 bitop3:0x80
  v_bitop3_b32 v81, v81, v125, v126 bitop3:0x80
  v_bitop3_b32 v81, v81, v127, 1 bitop3:0x80
  v_cmp_eq_u32 vcc, 0, v81
  s_sub_u32 s46, s46, 1
  s_cbranch_scc1 K3_retry0_ret
  s_cmp_lg_u64 vcc, 0
  s_cbranch_scc1 K3_retry0_l
  s_branch K3_retry0_ret
K3_retry1:
  s_mov_b32 s46, 4000
  s_add_u32 s44, s47, 4096
K3_retry1_l:
  s_add_u32 s75, s75, 1
  s_sleep 4
  buffer_load_dwordx4 v[128:131], v12, s[28:31], s44 offen offset:0 sc1
  buffer_load_dwordx4 v[132:135], v12, s[28:31], s44 offen offset:512 sc1
  buffer_load_dwordx4 v[136:139], v12, s[28:31], s44 offen offset:1024 sc1
  buffer_load_dwordx4 v[140:143], v12, s[28:31], s44 offen offset:1536 sc1
  buffer_load_dwordx4 v[144:147], v12, s[28:31], s44 offen offset:2048 sc1
  buffer_load_dwordx4 v[148:151], v12, s[28:31], s44 offen offset:2560 sc1
  buffer_load_dwordx4 v[152:155], v12, s[28:31], s44 offen offset:3072 sc1
  buffer_load_dwordx4 v[156:159], v12, s[28:31], s44 offen offset:3584 sc1
  s_waitcnt vmcnt(0)
  v_bitop3_b32 v81, v128, v129, v130 bitop3:0x80
  v_bitop3_b32 v81, v81, v131, v132 bitop3:0x80
  v_bitop3_b32 v81, v81, v133, v134 bitop3:0x80
  v_bitop3_b32 v81, v81, v135, v136 bitop3:0x80
  v_bitop3_b32 v81, v81, v137, v138 bitop3:0x80
  v_bitop3_b32 v81, v81, v139, v140 bitop3:0x80
  v_bitop3_b32 v81, v81, v141, v142 bitop3:0x80
  v_bitop3_b32 v81, v81, v143, v144 bitop3:0x80
  v_bitop3_b32 v81, v81, v145, v146 bitop3:0x80
  v_bitop3_b32 v81, v81, v147, v148 bitop3:0x80
  v_bitop3_b32 v81, v81, v149, v150 bitop3:0x80
  v_bitop3_b32 v81, v81, v151, v152 bitop3:0x80
  v_bitop3_b32 v81, v81, v153, v154 bitop3:0x80
  v_bitop3_b32 v81, v81, v155, v156 bitop3:0x80
  v_bitop3_b32 v81, v81, v157, v158 bitop3:0x80
  v_bitop3_b32 v81, v81, v159, 1 bitop3:0x80
  v_cmp_eq_u32 vcc, 0, v81
  s_sub_u32 s46, s46, 1
  s_cbranch_scc1 K3_retry1_ret
  s_cmp_lg_u64 vcc, 0
  s_cbranch_scc1 K3_retry1_l
  s_branch K3_retry1_ret
K3_retry2:
  s_mov_b32 s46, 4000
  s_add_u32 s44, s47, 8192
K3_retry2_l:
  s_add_u32 s75, s75, 1
  s_sleep 4
  buffer_load_dwordx4 v[160:163], v12, s[28:31], s44 offen offset:0 sc1
  buffer_load_dwordx4 v[164:167], v12, s[28:31], s44 offen offset:512 sc1
  buffer_load_dwordx4 v[168:171], v12, s[28:31], s44 offen offset:1024 sc1
  buffer_load_dwordx4 v[172:175], v12, s[28:31], s44 offen offset:1536 sc1
  buffer_load_dwordx4 v[176:179], v12, s[28:31], s44 offen offset:2048 sc1
  buffer_load_dwordx4 v[180:183], v12, s[28:31], s44 offen offset:2560 sc1
  buffer_load_dwordx4 v[184:187], v12, s[28:31], s44 offen offset:3072 sc1
  buffer_load_dwordx4 v[188:191], v12, s[28:31], s44 offen offset:3584 sc1
  s_waitcnt vmcnt(0)
  v_bitop3_b32 v81, v160, v161, v162 bitop3:0x80
  v_bitop3_b32 v81, v81, v163, v164 bitop3:0x80
  v_bitop3_b32 v81, v81, v165, v166 bitop3:0x80
  v_bitop3_b32 v81, v81, v167, v168 bitop3:0x80
  v_bitop3_b32 v81, v81, v169, v170 bitop3:0x80
  v_bitop3_b32 v81, v81, v171, v172 bitop3:0x80
  v_bitop3_b32 v81, v81, v173, v174 bitop3:0x80
  v_bitop3_b32 v81, v81, v175, v176 bitop3:0x80
  v_bitop3_b32 v81, v81, v177, v178 bitop3:0x80
  v_bitop3_b32 v81, v81, v179, v180 bitop3:0x80
  v_bitop3_b32 v81, v81, v181, v182 bitop3:0x80
  v_bitop3_b32 v81, v81, v183, v184 bitop3:0x80
  v_bitop3_b32 v81, v81, v185, v186 bitop3:0x80
  v_bitop3_b32 v81, v81, v187, v188 bitop3:0x80
  v_bitop3_b32 v81, v81, v189, v190 bitop3:0x80
  v_bitop3_b32 v81, v81, v191, 1 bitop3:0x80
  v_cmp_eq_u32 vcc, 0, v81
  s_sub_u32 s46, s46, 1
  s_cbranch_scc1 K3_retry2_ret
  s_cmp_lg_u64 vcc, 0
  s_cbranch_scc1 K3_retry2_l
  s_branch K3_retry2_ret
K3_retry3:
  s_mov_b32 s46, 4000
  s_add_u32 s44, s47, 12288
K3_retry3_l:
  s_add_u32 s75, s75, 1
  s_sleep 4
  buffer_load_dwordx4 v[192:195], v12, s[28:31], s44 offen offset:0 sc1
  buffer_load_dwordx4 v[196:199], v12, s[28:31], s44 offen offset:512 sc1
  buffer_load_dwordx4 v[200:203], v12, s[28:31], s44 offen offset:1024 sc1
  buffer_load_dwordx4 v[204:207], v12, s[28:31], s44 offen offset:1536 sc1
  buffer_load_dwordx4 v[208:211], v12, s[28:31], s44 offen offset:2048 sc1
  buffer_load_dwordx4 v[212:215], v12, s[28:31], s44 offen offset:2560 sc1
  buffer_load_dwordx4 v[216:219], v12, s[28:31], s44 offen offset:3072 sc1
  buffer_load_dwordx4 v[220:223], v12, s[28:31], s44 offen offset:3584 sc1
  s_waitcnt vmcnt(0)
  v_bitop3_b32 v81, v192, v193, v194 bitop3:0x80
  v_bitop3_b32 v81, v81, v195, v196 bitop3:0x80
  v_bitop3_b32 v81, v81, v197, v198 bitop3:0x80
  v_bitop3_b32 v81, v81, v199, v200 bitop3:0x80
  v_bitop3_b32 v81, v81, v201, v202 bitop3:0x80
  v_bitop3_b32 v81, v81, v203, v204 bitop3:0x80
  v_bitop3_b32 v81, v81, v205, v206 bitop3:0x80
  v_bitop3_b32 v81, v81, v207, v208 bitop3:0x80
  v_bitop3_b32 v81, v81, v209, v210 bitop3:0x80
  v_bitop3_b32 v81, v81, v211, v212 bitop3:0x80
  v_bitop3_b32 v81, v81, v213, v214 bitop3:0x80
  v_bitop3_b32 v81, v81, v215, v216 bitop3:0x80
  v_bitop3_b32 v81, v81, v217, v218 bitop3:0x80
  v_bitop3_b32 v81, v81, v219, v220 bitop3:0x80
  v_bitop3_b32 v81, v81, v221, v222 bitop3:0x80
  v_bitop3_b32 v81, v81, v223, 1 bitop3:0x80
  v_cmp_eq_u32 vcc, 0, v81
  s_sub_u32 s46, s46, 1
  s_cbranch_scc1 K3_retry3_ret
  s_cmp_lg_u64 vcc, 0
  s_cbranch_scc1 K3_retry3_l
  s_branch K3_retry3_ret
K3_retry4:
  s_mov_b32 s46, 4000
  s_add_u32 s44, s47, 16384
K3_retry4_l:
  s_add_u32 s75, s75, 1
  s_sleep 4
  buffer_load_dwordx4 v[96:99], v12, s[28:31], s44 offen offset:0 sc1
  buffer_load_dwordx4 v[100:103], v12, s[28:31], s44 offen offset:512 sc1
  buffer_load_dwordx4 v[104:107], v12, s[28:31], s44 offen offset:1024 sc1
  buffer_load_dwordx4 v[108:111], v12, s[28:31], s44 offen offset:1536 sc1
  buffer_load_dwordx4 v[112:115], v12, s[28:31], s44 offen offset:2048 sc1
  buffer_load_dwordx4 v[116:119], v12, s[28:31], s44 offen offset:2560 sc1
  buffer_load_dwordx4 v[120:123], v12, s[28:31], s44 offen offset:3072 sc1
  buffer_load_dwordx4 v[124:127], v12, s[28:31], s44 offen offset:3584 sc1
  s_waitcnt vmcnt(0)
  v_bitop3_b32 v81, v96, v97, v98 bitop3:0x80
  v_bitop3_b32 v81, v81, v99, v100 bitop3:0x80
  v_bitop3_b32 v81, v81, v101, v102 bitop3:0x80
  v_bitop3_b32 v81, v81, v103, v104 bitop3:0x80
  v_bitop3_b32 v81, v81, v105, v106 bitop3:0x80
  v_bitop3_b32 v81, v81, v107, v108 bitop3:0x80
  v_bitop3_b32 v81, v81, v109, v110 bitop3:0x80
  v_bitop3_b32 v81, v81, v111, v112 bitop3:0x80
  v_bitop3_b32 v81, v81, v113, v114 bitop3:0x80
  v_bitop3_b32 v81, v81, v115, v116 bitop3:0x80
  v_bitop3_b32 v81, v81, v117, v118 bitop3:0x80
  v_bitop3_b32 v81, v81, v119, v120 bitop3:0x80
  v_bitop3_b32 v81, v81, v121, v122 bitop3:0x80
  v_bitop3_b32 v81, v81, v123, v124 bitop3:0x80
  v_bitop3_b32 v81, v81, v125, v126 bitop3:0x80
  v_bitop3_b32 v81, v81, v127, 1 bitop3:0x80
  v_cmp_eq_u32 vcc, 0, v81
  s_sub_u32 s46, s46, 1
  s_cbranch_scc1 K3_retry4_ret
  s_cmp_lg_u64 vcc, 0
  s_cbranch_scc1 K3_retry4_l
  s_branch K3_retry4_ret
K3_retry5:
  s_mov_b32 s46, 4000
  s_add_u32 s44, s47, 20480
K3_retry5_l:
  s_add_u32 s75, s75, 1
  s_sleep 4
  buffer_load_dwordx4 v[128:131], v12, s[28:31], s44 offen offset:0 sc1
  buffer_load_dwordx4 v[132:135], v12, s[28:31], s44 offen offset:512 sc1
  buffer_load_dwordx4 v[136:139], v12, s[28:31], s44 offen offset:1024 sc1
  buffer_load_dwordx4 v[140:143], v12, s[28:31], s44 offen offset:1536 sc1
  buffer_load_dwordx4 v[144:147], v12, s[28:31], s44 offen offset:2048 sc1
  buffer_load_dwordx4 v[148:151], v12, s[28:31], s44 offen offset:2560 sc1
  buffer_load_dwordx4 v[152:155], v12, s[28:31], s44 offen offset:3072 sc1
  buffer_load_dwordx4 v[156:159], v12, s[28:31], s44 offen offset:3584 sc1
  s_waitcnt vmcnt(0)
  v_bitop3_b32 v81, v128, v129, v130 bitop3:0x80
  v_bitop3_b32 v81, v81, v131, v132 bitop3:0x80
  v_bitop3_b32 v81, v81, v133, v134 bitop3:0x80
  v_bitop3_b32 v81, v81, v135, v136 bitop3:0x80
  v_bitop3_b32 v81, v81, v137, v138 bitop3:0x80
  v_bitop3_b32 v81, v81, v139, v140 bitop3:0x80
  v_bitop3_b32 v81, v81, v141, v142 bitop3:0x80
  v_bitop3_b32 v81, v81, v143, v144 bitop3:0x80
  v_bitop3_b32 v81, v81, v145, v146 bitop3:0x80
  v_bitop3_b32 v81, v81, v147, v148 bitop3:0x80
  v_bitop3_b32 v81, v81, v149, v150 bitop3:0x80
  v_bitop3_b32 v81, v81, v151, v152 bitop3:0x80
  v_bitop3_b32 v81, v81, v153, v154 bitop3:0x80
  v_bitop3_b32 v81, v81, v155, v156 bitop3:0x80
  v_bitop3_b32 v81, v81, v157, v158 bitop3:0x80
  v_bitop3_b32 v81, v81, v159, 1 bitop3:0x80
  v_cmp_eq_u32 vcc, 0, v81
  s_sub_u32 s46, s46, 1
  s_cbranch_scc1 K3_retry5_ret
  s_cmp_lg_u64 vcc, 0
  s_cbranch_scc1 K3_retry5_l
  s_branch K3_retry5_ret
K3_retry6:
  s_mov_b32 s46, 4000
  s_add_u32 s44, s47, 24576
K3_retry6_l:
  s_add_u32 s75, s75, 1
  s_sleep 4
  buffer_load_dwordx4 v[160:163], v12, s[28:31], s44 offen offset:0 sc1
  buffer_load_dwordx4 v[164:167], v12, s[28:31], s44 offen offset:512 sc1
  buffer_load_dwordx4 v[168:171], v12, s[28:31], s44 offen offset:1024 sc1
  buffer_load_dwordx4 v[172:175], v12, s[28:31], s44 offen offset:1536 sc1
  buffer_load_dwordx4 v[176:179], v12, s[28:31], s44 offen offset:2048 sc1
  buffer_load_dwordx4 v[180:183], v12, s[28:31], s44 offen offset:2560 sc1
  buffer_load_dwordx4 v[184:187], v12, s[28:31], s44 offen offset:3072 sc1
  buffer_load_dwordx4 v[188:191], v12, s[28:31], s44 offen offset:3584 sc1
  s_waitcnt vmcnt(0)
  v_bitop3_b32 v81, v160, v161, v162 bitop3:0x80
  v_bitop3_b32 v81, v81, v163, v164 bitop3:0x80
  v_bitop3_b32 v81, v81, v165, v166 bitop3:0x80
  v_bitop3_b32 v81, v81, v167, v168 bitop3:0x80
  v_bitop3_b32 v81, v81, v169, v170 bitop3:0x80
  v_bitop3_b32 v81, v81, v171, v172 bitop3:0x80
  v_bitop3_b32 v81, v81, v173, v174 bitop3:0x80
  v_bitop3_b32 v81, v81, v175, v176 bitop3:0x80
  v_bitop3_b32 v81, v81, v177, v178 bitop3:0x80
  v_bitop3_b32 v81, v81, v179, v180 bitop3:0x80
  v_bitop3_b32 v81, v81, v181, v182 bitop3:0x80
  v_bitop3_b32 v81, v81, v183, v184 bitop3:0x80
  v_bitop3_b32 v81, v81, v185, v186 bitop3:0x80
  v_bitop3_b32 v81, v81, v187, v188 bitop3:0x80
  v_bitop3_b32 v81, v81, v189, v190 bitop3:0x80
  v_bitop3_b32 v81, v81, v191, 1 bitop3:0x80
  v_cmp_eq_u32 vcc, 0, v81
  s_sub_u32 s46, s46, 1
  s_cbranch_scc1 K3_retry6_ret
  s_cmp_lg_u64 vcc, 0
  s_cbranch_scc1 K3_retry6_l
  s_branch K3_retry6_ret
K3_retry7:
  s_mov_b32 s46, 4000
  s_add_u32 s44, s47, 28672
K3_retry7_l:
  s_add_u32 s75, s75, 1
  s_sleep 4
  buffer_load_dwordx4 v[192:195], v12, s[28:31], s44 offen offset:0 sc1
  buffer_load_dwordx4 v[196:199], v12, s[28:31], s44 offen offset:512 sc1
  buffer_load_dwordx4 v[200:203], v12, s[28:31], s44 offen offset:1024 sc1
  buffer_load_dwordx4 v[204:207], v12, s[28:31], s44 offen offset:1536 sc1
  buffer_load_dwordx4 v[208:211], v12, s[28:31], s44 offen offset:2048 sc1
  buffer_load_dwordx4 v[212:215], v12, s[28:31], s44 offen offset:2560 sc1
  buffer_load_dwordx4 v[216:219], v12, s[28:31], s44 offen offset:3072 sc1
  buffer_load_dwordx4 v[220:223], v12, s[28:31], s44 offen offset:3584 sc1
  s_waitcnt vmcnt(0)
  v_bitop3_b32 v81, v192, v193, v194 bitop3:0x80
  v_bitop3_b32 v81, v81, v195, v196 bitop3:0x80
  v_bitop3_b32 v81, v81, v197, v198 bitop3:0x80
  v_bitop3_b32 v81, v81, v199, v200 bitop3:0x80
  v_bitop3_b32 v81, v81, v201, v202 bitop3:0x80
  v_bitop3_b32 v81, v81, v203, v204 bitop3:0x80
  v_bitop3_b32 v81, v81, v205, v206 bitop3:0x80
  v_bitop3_b32 v81, v81, v207, v208 bitop3:0x80
  v_bitop3_b32 v81, v81, v209, v210 bitop3:0x80
  v_bitop3_b32 v81, v81, v211, v212 bitop3:0x80
  v_bitop3_b32 v81, v81, v213, v214 bitop3:0x80
  v_bitop3_b32 v81, v81, v215, v216 bitop3:0x80
  v_bitop3_b32 v81, v81, v217, v218 bitop3:0x80
  v_bitop3_b32 v81, v81, v219, v220 bitop3:0x80
  v_bitop3_b32 v81, v81, v221, v222 bitop3:0x80
  v_bitop3_b32 v81, v81, v223, 1 bitop3:0x80
  v_cmp_eq_u32 vcc, 0, v81
  s_sub_u32 s46, s46, 1
  s_cbranch_scc1 K3_retry7_ret
  s_cmp_lg_u64 vcc, 0
  s_cbranch_scc1 K3_retry7_l
  s_branch K3_retry7_ret
K3_event0:
  s_add_u32 s54, s54, 1
  s_cmp_lg_u32 s54, 1
  s_cbranch_scc1 K3_ev2_0
  buffer_load_dword v195, v192, s[40:43], s44 offen
  s_mov_b32 s55, s52
  s_branch K3_noev0
K3_ev2_0:
  buffer_load_dword v195, v193, s[48:51], s45 offen
  s_mov_b32 s55, 1000
  s_branch K3_noev0
K3_evB0:
  buffer_load_dword v195, v194, s[64:67], s68 offen
  buffer_load_dword v195, v194, s[64:67], s69 offen
  s_branch K3_noevB0
K3_evC0:
  s_add_u32 s53, s53, 1
  s_cmp_lg_u32 s53, 1
  s_cbranch_scc1 K3_ev4_0
  buffer_load_dword v196, v199, s[56:59], 0 offen sc1
  s_mov_b32 s71, 3
  s_branch K3_noevC0
K3_ev4_0:
  s_cmp_lg_u32 s53, 2
  s_cbranch_scc1 K3_ev6_0
  s_waitcnt vmcnt(0)
  v_readfirstlane_b32 s46, v196
  s_mov_b64 exec, 1
  s_cmp_lg_u32 s46, 0
  s_cbranch_scc1 K3_ev5_0
  v_mov_b32 v196, v198
  v_mov_b32 v197, 0
  buffer_atomic_cmpswap v[196:197], v199, s[56:59], 0 offen sc0 sc1
  s_waitcnt vmcnt(0)
  v_cmp_eq_u32 vcc, 0, v196
  s_nop 1
  v_cndmask_b32 v196, v196, v198, vcc
K3_ev5_0:
  buffer_store_dword v196, v199, s[60:63], s47 offen sc1
  s_mov_b64 exec, -1
  s_mov_b32 s71, 0
  s_branch K3_noevC0
K3_ev6_0:
  s_mov_b64 exec, 1
  buffer_store_dword v196, v199, s[60:63], s47 offen offset:32 sc1
  s_mov_b64 exec, -1
  s_mov_b32 s71, 1000
  s_branch K3_noevC0
K3_event1:
  s_add_u32 s54, s54, 1
  s_cmp_lg_u32 s54, 1
  s_cbranch_scc1 K3_ev2_1
  buffer_load_dword v195, v192, s[40:43], s44 offen
  s_mov_b32 s55, s52
  s_branch K3_noev1
K3_ev2_1:
  buffer_load_dword v195, v193, s[48:51], s45 offen
  s_mov_b32 s55, 1000
  s_branch K3_noev1
K3_evB1:
  buffer_load_dword v195, v194, s[64:67], s68 offen
  buffer_load_dword v195, v194, s[64:67], s69 offen
  s_branch K3_noevB1
K3_evC1:
  s_add_u32 s53, s53, 1
  s_cmp_lg_u32 s53, 1
  s_cbranch_scc1 K3_ev4_1
  buffer_load_dword v196, v199, s[56:59], 0 offen sc1
  s_mov_b32 s71, 3
  s_branch K3_noevC1
K3_ev4_1:
  s_cmp_lg_u32 s53, 2
  s_cbranch_scc1 K3_ev6_1
  s_waitcnt vmcnt(0)
  v_readfirstlane_b32 s46, v196
  s_mov_b64 exec, 1
  s_cmp_lg_u32 s46, 0
  s_cbranch_scc1 K3_ev5_1
  v_mov_b32 v196, v198
  v_mov_b32 v197, 0
  buffer_atomic_cmpswap v[196:197], v199, s[56:59], 0 offen sc0 sc1
  s_waitcnt vmcnt(0)
  v_cmp_eq_u32 vcc, 0, v196
  s_nop 1
  v_cndmask_b32 v196, v196, v198, vcc
K3_ev5_1:
  buffer_store_dword v196, v199, s[60:63], s47 offen sc1
  s_mov_b64 exec, -1
  s_mov_b32 s71, 0
  s_branch K3_noevC1
K3_ev6_1:
  s_mov_b64 exec, 1
  buffer_store_dword v196, v199, s[60:63], s47 offen offset:32 sc1
  s_mov_b64 exec, -1
  s_mov_b32 s71, 1000
  s_branch K3_noevC1
K3_event2:
  s_add_u32 s54, s54, 1
  s_cmp_lg_u32 s54, 1
  s_cbranch_scc1 K3_ev2_2
  buffer_load_dword v195, v192, s[40:43], s44 offen
  s_mov_b32 s55, s52
  s_branch K3_noev2
K3_ev2_2:
  buffer_load_dword v195, v193, s[48:51], s45 offen
  s_mov_b32 s55, 1000
  s_branch K3_noev2
K3_evB2:
  buffer_load_dword v195, v194, s[64:67], s68 offen
  buffer_load_dword v195, v194, s[64:67], s69 offen
  s_branch K3_noevB2
K3_evC2:
  s_add_u32 s53, s53, 1
  s_cmp_lg_u32 s53, 1
  s_cbranch_scc1 K3_ev4_2
  buffer_load_dword v196, v199, s[56:59], 0 offen sc1
  s_mov_b32 s71, 3
  s_branch K3_noevC2
K3_ev4_2:
  s_cmp_lg_u32 s53, 2
  s_cbranch_scc1 K3_ev6_2
  s_waitcnt vmcnt(0)
  v_readfirstlane_b32 s46, v196
  s_mov_b64 exec, 1
  s_cmp_lg_u32 s46, 0
  s_cbranch_scc1 K3_ev5_2
  v_mov_b32 v196, v198
  v_mov_b32 v197, 0
  buffer_atomic_cmpswap v[196:197], v199, s[56:59], 0 offen sc0 sc1
  s_waitcnt vmcnt(0)
  v_cmp_eq_u32 vcc, 0, v196
  s_nop 1
  v_cndmask_b32 v196, v196, v198, vcc
K3_ev5_2:
  buffer_store_dword v196, v199, s[60:63], s47 offen sc1
  s_mov_b64 exec, -1
  s_mov_b32 s71, 0
  s_branch K3_noevC2
K3_ev6_2:
  s_mov_b64 exec, 1
  buffer_store_dword v196, v199, s[60:63], s47 offen offset:32 sc1
  s_mov_b64 exec, -1
  s_mov_b32 s71, 1000
  s_branch K3_noevC2
K3_event3:
  s_add_u32 s54, s54, 1
  s_cmp_lg_u32 s54, 1
  s_cbranch_scc1 K3_ev2_3
  buffer_load_dword v195, v192, s[40:43], s44 offen
  s_mov_b32 s55, s52
  s_branch K3_noev3
K3_ev2_3:
  buffer_load_dword v195, v193, s[48:51], s45 offen
  s_mov_b32 s55, 1000
  s_branch K3_noev3
K3_evB3:
  buffer_load_dword v195, v194, s[64:67], s68 offen
  buffer_load_dword v195, v194, s[64:67], s69 offen
  s_branch K3_noevB3
K3_evC3:
  s_add_u32 s53, s53, 1
  s_cmp_lg_u32 s53, 1
  s_cbranch_scc1 K3_ev4_3
  buffer_load_dword v196, v199, s[56:59], 0 offen sc1
  s_mov_b32 s71, 3
  s_branch K3_noevC3
K3_ev4_3:
  s_cmp_lg_u32 s53, 2
  s_cbranch_scc1 K3_ev6_3
  s_waitcnt vmcnt(0)
  v_readfirstlane_b32 s46, v196
  s_mov_b64 exec, 1
  s_cmp_lg_u32 s46, 0
  s_cbranch_scc1 K3_ev5_3
  v_mov_b32 v196, v198
  v_mov_b32 v197, 0
  buffer_atomic_cmpswap v[196:197], v199, s[56:59], 0 offen sc0 sc1
  s_waitcnt vmcnt(0)
  v_cmp_eq_u32 vcc, 0, v196
  s_nop 1
  v_cndmask_b32 v196, v196, v198, vcc
K3_ev5_3:
  buffer_store_dword v196, v199, s[60:63], s47 offen sc1
  s_mov_b64 exec, -1
  s_mov_b32 s71, 0
  s_branch K3_noevC3
K3_ev6_3:
  s_mov_b64 exec, 1
  buffer_store_dword v196, v199, s[60:63], s47 offen offset:32 sc1
  s_mov_b64 exec, -1
  s_mov_b32 s71, 1000
  s_branch K3_noevC3
K3_L:
  v_lshrrev_b32 v4, 3, v2
  v_and_b32 v5, 7, v2
  v_add_u32 v6, 0, v14
  v_xor_b32 v6, v6, v5
  v_lshlrev_b32 v6, 4, v6
  v_lshl_add_u32 v6, v4, 11, v6
  v_add_u32 v240, 0, v6
  v_add_u32 v6, 4, v14
  v_xor_b32 v6, v6, v5
  v_lshlrev_b32 v6, 4, v6
  v_lshl_add_u32 v6, v4, 11, v6
  v_add_u32 v241, 15360, v6
  v_add_u32 v6, 0, v14
  v_xor_b32 v6, v6, v5
  v_lshlrev_b32 v6, 4, v6
  v_lshl_add_u32 v6, v4, 11, v6
  v_add_u32 v242, 30720, v6
  v_add_u32 v6, 4, v14
  v_xor_b32 v6, v6, v5
  v_lshlrev_b32 v6, 4, v6
  v_lshl_add_u32 v6, v4, 11, v6
  v_add_u32 v243, 46080, v6
  v_lshrrev_b32 v6, 5, v2
  v_bfe_u32 v7, v2, 2, 2
  v_lshl_add_u32 v6, v6, 2, v7
  v_mul_u32_u24 v6, 6144, v6
  v_bfe_u32 v7, v2, 4, 1
  v_lshl_add_u32 v6, v7, 6, v6
  v_and_b32 v7, 3, v2
  v_lshl_add_u32 v6, v7, 4, v6
  v_xor_b32 v7, 32, v6
  s_and_b32 s40, s13, 1
  s_lshl_b32 s40, s40, 7
  s_xor_b32 s41, s40, 128
  v_add_u32 v244, 0, v6
  v_add_u32 v244, s41, v244
  v_add_u32 v245, 48128, v7
  v_add_u32 v245, s41, v245
  v_add_u32 v246, 0, v6
  v_add_u32 v246, s40, v246
  v_add_u32 v247, 48128, v7
  v_add_u32 v247, s40, v247
  v_add_u32 v248, 4096, v6
  v_add_u32 v248, s40, v248
  v_add_u32 v249, 52224, v7
  v_add_u32 v249, s40, v249
  s_lshl_b32 s38, s12, 7
  s_lshl_b32 s40, s4, 5
  s_add_u32 s38, s38, s40
  s_lshl_b32 s38, s38, 11
  s_mul_i32 s39, s4, 98304
  s_lshr_b32 s40, s13, 1
  s_lshl_b32 s40, s40, 8
  s_add_u32 s39, s39, s40
  s_lshl_b32 s41, s4, 12
  s_mul_i32 s42, s4, 6144
  s_add_u32 s42, s42, 16384
  s_waitcnt lgkmcnt(0)
  s_mov_b32 s16, s88
  s_mov_b32 s17, s89
  s_mov_b32 s18, 4194304
  s_mov_b32 s19, 0x20000
  s_mov_b32 s20, s90
  s_mov_b32 s21, s91
  s_mov_b32 s22, 6291456
  s_mov_b32 s23, 0x20000
  s_add_u32 m0, s41, 0
  s_nop 0
  buffer_load_dwordx4 v240, s[16:19], s38 offen offset:0 lds
  buffer_load_dwordx4 v241, s[16:19], s38 offen offset:1024 lds
  buffer_load_dwordx4 v242, s[16:19], s38 offen offset:2048 lds
  buffer_load_dwordx4 v243, s[16:19], s38 offen offset:3072 lds
  s_add_u32 m0, s42, 0
  s_nop 0
  buffer_load_dwordx4 v244, s[20:23], s39 offen offset:0 lds
  buffer_load_dwordx4 v245, s[20:23], s39 offen offset:1024 lds
  buffer_load_dwordx4 v246, s[20:23], s39 offen offset:2048 lds
  buffer_load_dwordx4 v247, s[20:23], s39 offen offset:3072 lds
  s_add_u32 m0, s42, 4096
  s_nop 0
  buffer_load_dwordx4 v248, s[20:23], s39 offen offset:0 lds
  buffer_load_dwordx4 v249, s[20:23], s39 offen offset:1024 lds
  s_add_u32 s38, s38, 128
  s_add_u32 s39, s39, 393216
  s_add_u32 m0, s41, 40960
  s_nop 0
  buffer_load_dwordx4 v240, s[16:19], s38 offen offset:0 lds
  buffer_load_dwordx4 v241, s[16:19], s38 offen offset:1024 lds
  buffer_load_dwordx4 v242, s[16:19], s38 offen offset:2048 lds
  buffer_load_dwordx4 v243, s[16:19], s38 offen offset:3072 lds
  s_add_u32 m0, s42, 40960
  s_nop 0
  buffer_load_dwordx4 v244, s[20:23], s39 offen offset:0 lds
  buffer_load_dwordx4 v245, s[20:23], s39 offen offset:1024 lds
  buffer_load_dwordx4 v246, s[20:23], s39 offen offset:2048 lds
  buffer_load_dwordx4 v247, s[20:23], s39 offen offset:3072 lds
  s_add_u32 m0, s42, 45056
  s_nop 0
  buffer_load_dwordx4 v248, s[20:23], s39 offen offset:0 lds
  buffer_load_dwordx4 v249, s[20:23], s39 offen offset:1024 lds
  s_add_u32 s38, s38, 128
  s_add_u32 s39, s39, 393216
  s_add_u32 m0, s41, 81920
  s_nop 0
  buffer_load_dwordx4 v240, s[16:19], s38 offen offset:0 lds
  buffer_load_dwordx4 v241, s[16:19], s38 offen offset:1024 lds
  buffer_load_dwordx4 v242, s[16:19], s38 offen offset:2048 lds
  buffer_load_dwordx4 v243, s[16:19], s38 offen offset:3072 lds
  s_add_u32 m0, s42, 81920
  s_nop 0
  buffer_load_dwordx4 v244, s[20:23], s39 offen offset:0 lds
  buffer_load_dwordx4 v245, s[20:23], s39 offen offset:1024 lds
  buffer_load_dwordx4 v246, s[20:23], s39 offen offset:2048 lds
  buffer_load_dwordx4 v247, s[20:23], s39 offen offset:3072 lds
  s_add_u32 m0, s42, 86016
  s_nop 0
  buffer_load_dwordx4 v248, s[20:23], s39 offen offset:0 lds
  buffer_load_dwordx4 v249, s[20:23], s39 offen offset:1024 lds
  s_add_u32 s38, s38, 128
  s_add_u32 s39, s39, 393216
  s_mov_b32 s24, s78
  s_mov_b32 s25, s79
  s_mov_b32 s26, 4194304
  s_mov_b32 s27, 0x20000
  s_mov_b32 s28, s80
  s_mov_b32 s29, s81
  s_mov_b32 s30, 4194304
  s_mov_b32 s31, 0x20000
  s_mov_b32 s32, s82
  s_mov_b32 s33, s83
  s_mov_b32 s34, 8192
  s_mov_b32 s35, 0x20000
  s_add_u32 s44, s98, 16777216
  s_addc_u32 s45, s99, 0
  s_mov_b32 s46, 4194304
  s_mov_b32 s47, 0x20000
  s_add_u32 s48, s98, 0
  s_addc_u32 s49, s99, 0
  s_mov_b32 s50, 4194304
  s_mov_b32 s51, 0x20000
  s_add_u32 s52, s98, 8388608
  s_addc_u32 s53, s99, 0
  s_mov_b32 s54, 2097152
  s_mov_b32 s55, 0x20000
  s_add_u32 s56, s98, 12582912
  s_addc_u32 s57, s99, 0
  s_mov_b32 s58, 65536
  s_mov_b32 s59, 0x20000
  s_lshl_b32 s60, s2, 2
  s_add_u32 s60, s60, s4
  s_and_b32 s61, s60, 15
  s_lshr_b32 s60, s60, 4
  s_lshl_b32 s62, s60, 16
  s_lshl_b32 s63, s61, 7
  s_add_u32 s62, s62, s63
  v_lshlrev_b32 v21, 14, v14
  v_lshl_add_u32 v21, v15, 3, v21
  v_add_u32 v21, s62, v21
  s_lshl_b32 s63, s61, 9
  v_lshlrev_b32 v22, 5, v15
  s_lshl_b32 s62, s61, 18
  s_lshl_b32 s64, s60, 6
  s_add_u32 s62, s62, s64
  v_lshlrev_b32 v19, 14, v15
  v_lshl_add_u32 v19, v14, 4, v19
  s_lshl_b32 s64, s12, 3
  s_lshl_b32 s65, s4, 1
  s_add_u32 s64, s64, s65
  s_lshl_b32 s64, s64, 15
  s_lshr_b32 s65, s15, 1
  s_lshl_b32 s65, s65, 11
  s_add_u32 s64, s64, s65
  s_add_u32 s65, s64, 32768
  s_lshl_b32 s66, s5, 4
  s_add_u32 s66, s66, s12
  s_lshl_b32 s67, s66, 7
  s_lshl_b32 s66, s66, 12
  s_lshl_b32 s68, s36, 10
  s_add_u32 s66, s66, s68
  v_mov_b32 v160, 0
  v_mov_b32 v161, 0
  v_mov_b32 v162, 0
  v_mov_b32 v163, 0
  v_and_b32 v18, 7, v2
  v_lshlrev_b32 v18, 4, v18
  v_lshrrev_b32 v6, 5, v2
  v_bfe_u32 v7, v2, 2, 2
  v_lshl_add_u32 v7, v6, 2, v7
  v_lshlrev_b32 v7, 11, v7
  v_bfe_u32 v8, v2, 4, 1
  v_lshl_add_u32 v7, v8, 6, v7
  v_and_b32 v8, 3, v2
  v_lshlrev_b32 v6, 1, v6
  v_xor_b32 v8, v8, v6
  v_lshl_add_u32 v7, v8, 4, v7
  v_add_u32 v232, 0, v7
  v_add_u32 v233, 15360, v7
  v_add_u32 v234, 30720, v7
  v_add_u32 v235, 46080, v7
  s_lshl_b32 s69, s4, 16
  s_lshr_b32 s70, s10, 2
  s_lshl_b32 s70, s70, 3
  s_lshr_b32 s71, s11, 2
  s_add_u32 s70, s70, s71
  s_lshl_b32 s70, s70, 7
  s_add_u32 s69, s69, s70
  s_lshl_b32 s70, s4, 12
  s_add_u32 s70, s70, 40960
  s_lshl_b32 s71, s6, 12
  v_mov_b32 v10, 38912
  v_mov_b32 v11, 1
  s_lshl_b32 s43, s4, 2
  v_add_u32 v9, s43, v10
  s_waitcnt vmcnt(20)
  s_barrier
  s_add_u32 m0, s41, 122880
  s_nop 0
  buffer_load_dwordx4 v240, s[16:19], s38 offen offset:0 lds
  buffer_load_dwordx4 v241, s[16:19], s38 offen offset:1024 lds
  buffer_load_dwordx4 v242, s[16:19], s38 offen offset:2048 lds
  buffer_load_dwordx4 v243, s[16:19], s38 offen offset:3072 lds
  s_add_u32 m0, s42, 122880
  s_nop 0
  buffer_load_dwordx4 v244, s[20:23], s39 offen offset:0 lds
  buffer_load_dwordx4 v245, s[20:23], s39 offen offset:1024 lds
  buffer_load_dwordx4 v246, s[20:23], s39 offen offset:2048 lds
  buffer_load_dwordx4 v247, s[20:23], s39 offen offset:3072 lds
  s_add_u32 m0, s42, 126976
  s_nop 0
  buffer_load_dwordx4 v248, s[20:23], s39 offen offset:0 lds
  buffer_load_dwordx4 v249, s[20:23], s39 offen offset:1024 lds
  s_add_u32 s38, s38, 128
  s_add_u32 s39, s39, 393216
  buffer_store_dwordx4 v[160:163], v3, s[48:51], s64 offen sc1
  s_waitcnt vmcnt(21)
  s_barrier
  s_add_u32 m0, s41, 0
  s_nop 0
  buffer_load_dwordx4 v240, s[16:19], s38 offen offset:0 lds
  buffer_load_dwordx4 v241, s[16:19], s38 offen offset:1024 lds
  buffer_load_dwordx4 v242, s[16:19], s38 offen offset:2048 lds
  buffer_load_dwordx4 v243, s[16:19], s38 offen offset:3072 lds
  s_add_u32 m0, s42, 0
  s_nop 0
  buffer_load_dwordx4 v244, s[20:23], s39 offen offset:0 lds
  buffer_load_dwordx4 v245, s[20:23], s39 offen offset:1024 lds
  buffer_load_dwordx4 v246, s[20:23], s39 offen offset:2048 lds
  buffer_load_dwordx4 v247, s[20:23], s39 offen offset:3072 lds
  s_add_u32 m0, s42, 4096
  s_nop 0
  buffer_load_dwordx4 v248, s[20:23], s39 offen offset:0 lds
  buffer_load_dwordx4 v249, s[20:23], s39 offen offset:1024 lds
  s_add_u32 s38, s38, 128
  s_add_u32 s39, s39, 393216
  buffer_store_dwordx4 v[160:163], v3, s[48:51], s64 offen offset:1024 sc1
  s_waitcnt vmcnt(22)
  s_barrier
  s_add_u32 m0, s41, 40960
  s_nop 0
  buffer_load_dwordx4 v240, s[16:19], s38 offen offset:0 lds
  buffer_load_dwordx4 v241, s[16:19], s38 offen offset:1024 lds
  buffer_load_dwordx4 v242, s[16:19], s38 offen offset:2048 lds
  buffer_load_dwordx4 v243, s[16:19], s38 offen offset:3072 lds
  s_add_u32 m0, s42, 40960
  s_nop 0
  buffer_load_dwordx4 v244, s[20:23], s39 offen offset:0 lds
  buffer_load_dwordx4 v245, s[20:23], s39 offen offset:1024 lds
  buffer_load_dwordx4 v246, s[20:23], s39 offen offset:2048 lds
  buffer_load_dwordx4 v247, s[20:23], s39 offen offset:3072 lds
  s_add_u32 m0, s42, 45056
  s_nop 0
  buffer_load_dwordx4 v248, s[20:23], s39 offen offset:0 lds
  buffer_load_dwordx4 v249, s[20:23], s39 offen offset:1024 lds
  s_add_u32 s38, s38, 128
  s_add_u32 s39, s39, 393216
  buffer_store_dwordx4 v[160:163], v3, s[48:51], s65 offen sc1
  s_waitcnt vmcnt(23)
  s_barrier
  s_add_u32 m0, s41, 81920
  s_nop 0
  buffer_load_dwordx4 v240, s[16:19], s38 offen offset:0 lds
  buffer_load_dwordx4 v241, s[16:19], s38 offen offset:1024 lds
  buffer_load_dwordx4 v242, s[16:19], s38 offen offset:2048 lds
  buffer_load_dwordx4 v243, s[16:19], s38 offen offset:3072 lds
  s_add_u32 m0, s42, 81920
  s_nop 0
  buffer_load_dwordx4 v244, s[20:23], s39 offen offset:0 lds
  buffer_load_dwordx4 v245, s[20:23], s39 offen offset:1024 lds
  buffer_load_dwordx4 v246, s[20:23], s39 offen offset:2048 lds
  buffer_load_dwordx4 v247, s[20:23], s39 offen offset:3072 lds
  s_add_u32 m0, s42, 86016
  s_nop 0
  buffer_load_dwordx4 v248, s[20:23], s39 offen offset:0 lds
  buffer_load_dwordx4 v249, s[20:23], s39 offen offset:1024 lds
  s_add_u32 s38, s38, 128
  s_add_u32 s39, s39, 393216
  buffer_store_dwordx4 v[160:163], v3, s[48:51], s65 offen offset:1024 sc1
  s_waitcnt vmcnt(23)
  s_barrier
  s_add_u32 m0, s41, 122880
  s_nop 0
  buffer_load_dwordx4 v240, s[16:19], s38 offen offset:0 lds
  buffer_load_dwordx4 v241, s[16:19], s38 offen offset:1024 lds
  buffer_load_dwordx4 v242, s[16:19], s38 offen offset:2048 lds
  buffer_load_dwordx4 v243, s[16:19], s38 offen offset:3072 lds
  s_add_u32 m0, s42, 122880
  s_nop 0
  buffer_load_dwordx4 v244, s[20:23], s39 offen offset:0 lds
  buffer_load_dwordx4 v245, s[20:23], s39 offen offset:1024 lds
  buffer_load_dwordx4 v246, s[20:23], s39 offen offset:2048 lds
  buffer_load_dwordx4 v247, s[20:23], s39 offen offset:3072 lds
  s_add_u32 m0, s42, 126976
  s_nop 0
  buffer_load_dwordx4 v248, s[20:23], s39 offen offset:0 lds
  buffer_load_dwordx4 v249, s[20:23], s39 offen offset:1024 lds
  s_add_u32 s38, s38, 128
  s_add_u32 s39, s39, 393216
  buffer_store_dwordx4 v[160:163], v3, s[52:55], s66 offen sc1
  buffer_load_dwordx4 v[24:27], v22, s[32:35], s63 offen offset:0
  buffer_load_dwordx4 v[28:31], v22, s[32:35], s63 offen offset:16
  v_add_u32 v23, 4294961152, v21
  buffer_load_dwordx2 v[32:33], v23, s[24:27], 0 offen nt
  v_add_u32 v23, 4294963200, v21
  buffer_load_dwordx2 v[34:35], v23, s[24:27], 0 offen nt
  v_add_u32 v23, 4294965248, v21
  buffer_load_dwordx2 v[36:37], v23, s[24:27], 0 offen nt
  v_add_u32 v23, 0, v21
  buffer_load_dwordx2 v[38:39], v23, s[24:27], 0 offen nt
  v_add_u32 v23, 2048, v21
  buffer_load_dwordx2 v[40:41], v23, s[24:27], 0 offen nt
  v_add_u32 v23, 4096, v21
  buffer_load_dwordx2 v[42:43], v23, s[24:27], 0 offen nt
  v_add_u32 v23, 6144, v21
  buffer_load_dwordx2 v[44:45], v23, s[24:27], 0 offen nt
  v_add_u32 v23, 8192, v21
  buffer_load_dwordx2 v[46:47], v23, s[24:27], 0 offen nt
  v_add_u32 v23, 10240, v21
  buffer_load_dwordx2 v[48:49], v23, s[24:27], 0 offen nt
  s_waitcnt vmcnt(34)
  s_barrier
  s_add_u32 m0, s41, 0
  s_nop 0
  buffer_load_dwordx4 v240, s[16:19], s38 offen offset:0 lds
  buffer_load_dwordx4 v241, s[16:19], s38 offen offset:1024 lds
  buffer_load_dwordx4 v242, s[16:19], s38 offen offset:2048 lds
  buffer_load_dwordx4 v243, s[16:19], s38 offen offset:3072 lds
  s_add_u32 m0, s42, 0
  s_nop 0
  buffer_load_dwordx4 v244, s[20:23], s39 offen offset:0 lds
  buffer_load_dwordx4 v245, s[20:23], s39 offen offset:1024 lds
  buffer_load_dwordx4 v246, s[20:23], s39 offen offset:2048 lds
  buffer_load_dwordx4 v247, s[20:23], s39 offen offset:3072 lds
  s_add_u32 m0, s42, 4096
  s_nop 0
  buffer_load_dwordx4 v248, s[20:23], s39 offen offset:0 lds
  buffer_load_dwordx4 v249, s[20:23], s39 offen offset:1024 lds
  s_add_u32 s38, s38, 128
  s_add_u32 s39, s39, 393216
  buffer_store_dwordx4 v[160:163], v18, s[56:59], s67 offen sc1
  v_add_u32 v23, 12288, v21
  buffer_load_dwordx2 v[50:51], v23, s[24:27], 0 offen nt
  v_add_u32 v23, 14336, v21
  buffer_load_dwordx2 v[52:53], v23, s[24:27], 0 offen nt
  v_add_u32 v23, 0, v21
  buffer_load_dwordx2 v[54:55], v23, s[28:31], 0 offen nt
  v_add_u32 v23, 2048, v21
  buffer_load_dwordx2 v[56:57], v23, s[28:31], 0 offen nt
  v_add_u32 v23, 4096, v21
  buffer_load_dwordx2 v[58:59], v23, s[28:31], 0 offen nt
  v_add_u32 v23, 6144, v21
  buffer_load_dwordx2 v[60:61], v23, s[28:31], 0 offen nt
  v_add_u32 v23, 8192, v21
  buffer_load_dwordx2 v[62:63], v23, s[28:31], 0 offen nt
  v_add_u32 v23, 10240, v21
  buffer_load_dwordx2 v[64:65], v23, s[28:31], 0 offen nt
  v_add_u32 v23, 12288, v21
  buffer_load_dwordx2 v[66:67], v23, s[28:31], 0 offen nt
  v_add_u32 v23, 14336, v21
  buffer_load_dwordx2 v[68:69], v23, s[28:31], 0 offen nt
  s_waitcnt vmcnt(44)
  s_barrier
  s_add_u32 m0, s41, 40960
  s_nop 0
  buffer_load_dwordx4 v240, s[16:19], s38 offen offset:0 lds
  buffer_load_dwordx4 v241, s[16:19], s38 offen offset:1024 lds
  buffer_load_dwordx4 v242, s[16:19], s38 offen offset:2048 lds
  buffer_load_dwordx4 v243, s[16:19], s38 offen offset:3072 lds
  s_add_u32 m0, s42, 40960
  s_nop 0
  buffer_load_dwordx4 v244, s[20:23], s39 offen offset:0 lds
  buffer_load_dwordx4 v245, s[20:23], s39 offen offset:1024 lds
  buffer_load_dwordx4 v246, s[20:23], s39 offen offset:2048 lds
  buffer_load_dwordx4 v247, s[20:23], s39 offen offset:3072 lds
  s_add_u32 m0, s42, 45056
  s_nop 0
  buffer_load_dwordx4 v248, s[20:23], s39 offen offset:0 lds
  buffer_load_dwordx4 v249, s[20:23], s39 offen offset:1024 lds
  s_add_u32 s38, s38, 128
  s_add_u32 s39, s39, 393216
  s_waitcnt vmcnt(10)
  v_lshlrev_b32 v72, 16, v24
  v_and_b32 v76, 0xffff0000, v24
  v_lshlrev_b32 v80, 16, v25
  v_and_b32 v84, 0xffff0000, v25
  v_lshlrev_b32 v73, 16, v26
  v_and_b32 v77, 0xffff0000, v26
  v_lshlrev_b32 v81, 16, v27
  v_and_b32 v85, 0xffff0000, v27
  v_lshlrev_b32 v74, 16, v28
  v_and_b32 v78, 0xffff0000, v28
  v_lshlrev_b32 v82, 16, v29
  v_and_b32 v86, 0xffff0000, v29
  v_lshlrev_b32 v75, 16, v30
  v_and_b32 v79, 0xffff0000, v30
  v_lshlrev_b32 v83, 16, v31
  v_and_b32 v87, 0xffff0000, v31
  v_lshlrev_b32 v88, 16, v32
  v_and_b32 v89, 0xffff0000, v32
  v_lshlrev_b32 v90, 16, v34
  v_and_b32 v91, 0xffff0000, v34
  v_lshlrev_b32 v92, 16, v36
  v_and_b32 v93, 0xffff0000, v36
  v_lshlrev_b32 v94, 16, v38
  v_and_b32 v95, 0xffff0000, v38
  v_lshlrev_b32 v96, 16, v40
  v_and_b32 v97, 0xffff0000, v40
  v_lshlrev_b32 v98, 16, v42
  v_and_b32 v99, 0xffff0000, v42
  v_lshlrev_b32 v100, 16, v44
  v_and_b32 v101, 0xffff0000, v44
  v_lshlrev_b32 v102, 16, v46
  v_and_b32 v103, 0xffff0000, v46
  v_lshlrev_b32 v104, 16, v48
  v_and_b32 v105, 0xffff0000, v48
  v_lshlrev_b32 v106, 16, v50
  v_and_b32 v107, 0xffff0000, v50
  v_lshlrev_b32 v108, 16, v52
  v_and_b32 v109, 0xffff0000, v52
  v_lshlrev_b32 v110, 16, v54
  v_and_b32 v111, 0xffff0000, v54
  v_lshlrev_b32 v112, 16, v56
  v_and_b32 v113, 0xffff0000, v56
  v_lshlrev_b32 v114, 16, v58
  v_and_b32 v115, 0xffff0000, v58
  v_lshlrev_b32 v116, 16, v60
  v_and_b32 v117, 0xffff0000, v60
  v_lshlrev_b32 v118, 16, v62
  v_and_b32 v119, 0xffff0000, v62
  v_lshlrev_b32 v120, 16, v64
  v_and_b32 v121, 0xffff0000, v64
  v_lshlrev_b32 v122, 16, v66
  v_and_b32 v123, 0xffff0000, v66
  v_lshlrev_b32 v124, 16, v68
  v_and_b32 v125, 0xffff0000, v68
  v_mul_f32 v126, v88, v84
  v_mul_f32 v127, v89, v85
  v_mul_f32 v128, v90, v84
  v_mul_f32 v129, v91, v85
  v_mul_f32 v130, v92, v84
  v_mul_f32 v131, v93, v85
  v_mul_f32 v132, v94, v84
  v_mul_f32 v133, v95, v85
  v_mul_f32 v134, v96, v84
  v_mul_f32 v135, v97, v85
  v_mul_f32 v136, v98, v84
  v_mul_f32 v137, v99, v85
  v_mul_f32 v138, v100, v84
  v_mul_f32 v139, v101, v85
  v_mul_f32 v140, v102, v84
  v_mul_f32 v141, v103, v85
  v_fmac_f32 v126, v90, v80
  v_fmac_f32 v127, v91, v81
  v_fmac_f32 v128, v92, v80
  v_fmac_f32 v129, v93, v81
  v_fmac_f32 v130, v94, v80
  v_fmac_f32 v131, v95, v81
  v_fmac_f32 v132, v96, v80
  v_fmac_f32 v133, v97, v81
  v_fmac_f32 v134, v98, v80
  v_fmac_f32 v135, v99, v81
  v_fmac_f32 v136, v100, v80
  v_fmac_f32 v137, v101, v81
  v_fmac_f32 v138, v102, v80
  v_fmac_f32 v139, v103, v81
  v_fmac_f32 v140, v104, v80
  v_fmac_f32 v141, v105, v81
  v_fmac_f32 v126, v92, v76
  v_fmac_f32 v127, v93, v77
  v_fmac_f32 v128, v94, v76
  v_fmac_f32 v129, v95, v77
  v_fmac_f32 v130, v96, v76
  v_fmac_f32 v131, v97, v77
  v_fmac_f32 v132, v98, v76
  v_fmac_f32 v133, v99, v77
  v_fmac_f32 v134, v100, v76
  v_fmac_f32 v135, v101, v77
  v_fmac_f32 v136, v102, v76
  v_fmac_f32 v137, v103, v77
  s_barrier
  s_add_u32 m0, s41, 81920
  s_nop 0
  buffer_load_dwordx4 v240, s[16:19], s38 offen offset:0 lds
  buffer_load_dwordx4 v241, s[16:19], s38 offen offset:1024 lds
  buffer_load_dwordx4 v242, s[16:19], s38 offen offset:2048 lds
  buffer_load_dwordx4 v243, s[16:19], s38 offen offset:3072 lds
  s_add_u32 m0, s42, 81920
  s_nop 0
  buffer_load_dwordx4 v244, s[20:23], s39 offen offset:0 lds
  buffer_load_dwordx4 v245, s[20:23], s39 offen offset:1024 lds
  buffer_load_dwordx4 v246, s[20:23], s39 offen offset:2048 lds
  buffer_load_dwordx4 v247, s[20:23], s39 offen offset:3072 lds
  s_add_u32 m0, s42, 86016
  s_nop 0
  buffer_load_dwordx4 v248, s[20:23], s39 offen offset:0 lds
  buffer_load_dwordx4 v249, s[20:23], s39 offen offset:1024 lds
  s_add_u32 s38, s38, 128
  s_add_u32 s39, s39, 393216
  v_fmac_f32 v138, v104, v76
  v_fmac_f32 v139, v105, v77
  v_fmac_f32 v140, v106, v76
  v_fmac_f32 v141, v107, v77
  v_fmac_f32 v126, v94, v72
  v_fmac_f32 v127, v95, v73
  v_fmac_f32 v128, v96, v72
  v_fmac_f32 v129, v97, v73
  v_fmac_f32 v130, v98, v72
  v_fmac_f32 v131, v99, v73
  v_fmac_f32 v132, v100, v72
  v_fmac_f32 v133, v101, v73
  v_fmac_f32 v134, v102, v72
  v_fmac_f32 v135, v103, v73
  v_fmac_f32 v136, v104, v72
  v_fmac_f32 v137, v105, v73
  v_fmac_f32 v138, v106, v72
  v_fmac_f32 v139, v107, v73
  v_fmac_f32 v140, v108, v72
  v_fmac_f32 v141, v109, v73
  v_mul_f32 v126, v126, v110
  v_mul_f32 v127, v127, v111
  v_mul_f32 v128, v128, v112
  v_mul_f32 v129, v129, v113
  v_mul_f32 v130, v130, v114
  v_mul_f32 v131, v131, v115
  v_mul_f32 v132, v132, v116
  v_mul_f32 v133, v133, v117
  v_mul_f32 v134, v134, v118
  v_mul_f32 v135, v135, v119
  v_mul_f32 v136, v136, v120
  v_mul_f32 v137, v137, v121
  v_mul_f32 v138, v138, v122
  v_mul_f32 v139, v139, v123
  v_mul_f32 v140, v140, v124
  v_mul_f32 v141, v141, v125
  v_cvt_pk_bf16_f32 v144, v126, v128
  v_cvt_pk_bf16_f32 v145, v130, v132
  v_cvt_pk_bf16_f32 v146, v134, v136
  v_cvt_pk_bf16_f32 v147, v138, v140
  v_cvt_pk_bf16_f32 v148, v127, v129
  v_cvt_pk_bf16_f32 v149, v131, v133
  v_cvt_pk_bf16_f32 v150, v135, v137
  v_cvt_pk_bf16_f32 v151, v139, v141
  v_and_b32 v144, -2, v144
  v_and_b32 v145, -2, v145
  v_and_b32 v146, -2, v146
  v_and_b32 v147, -2, v147
  v_and_b32 v148, -2, v148
  v_and_b32 v149, -2, v149
  v_and_b32 v150, -2, v150
  v_and_b32 v151, -2, v151
  buffer_store_dwordx4 v[144:147], v19, s[44:47], s62 offen sc1
  s_add_u32 s62, s62, 4096
  buffer_store_dwordx4 v[148:151], v19, s[44:47], s62 offen sc1
  s_add_u32 s62, s62, 4096
  v_lshlrev_b32 v88, 16, v33
  v_and_b32 v89, 0xffff0000, v33
  v_lshlrev_b32 v90, 16, v35
  v_and_b32 v91, 0xffff0000, v35
  v_lshlrev_b32 v92, 16, v37
  v_and_b32 v93, 0xffff0000, v37
  v_lshlrev_b32 v94, 16, v39
  v_and_b32 v95, 0xffff0000, v39
  v_lshlrev_b32 v96, 16, v41
  v_and_b32 v97, 0xffff0000, v41
  v_lshlrev_b32 v98, 16, v43
  v_and_b32 v99, 0xffff0000, v43
  v_lshlrev_b32 v100, 16, v45
  v_and_b32 v101, 0xffff0000, v45
  v_lshlrev_b32 v102, 16, v47
  v_and_b32 v103, 0xffff0000, v47
  v_lshlrev_b32 v104, 16, v49
  v_and_b32 v105, 0xffff0000, v49
  v_lshlrev_b32 v106, 16, v51
  v_and_b32 v107, 0xffff0000, v51
  v_lshlrev_b32 v108, 16, v53
  v_and_b32 v109, 0xffff0000, v53
  v_lshlrev_b32 v110, 16, v55
  v_and_b32 v111, 0xffff0000, v55
  v_lshlrev_b32 v112, 16, v57
  v_and_b32 v113, 0xffff0000, v57
  v_lshlrev_b32 v114, 16, v59
  v_and_b32 v115, 0xffff0000, v59
  v_lshlrev_b32 v116, 16, v61
  v_and_b32 v117, 0xffff0000, v61
  v_lshlrev_b32 v118, 16, v63
  v_and_b32 v119, 0xffff0000, v63
  v_lshlrev_b32 v120, 16, v65
  v_and_b32 v121, 0xffff0000, v65
  v_lshlrev_b32 v122, 16, v67
  v_and_b32 v123, 0xffff0000, v67
  v_lshlrev_b32 v124, 16, v69
  v_and_b32 v125, 0xffff0000, v69
  v_mul_f32 v126, v88, v86
  v_mul_f32 v127, v89, v87
  v_mul_f32 v128, v90, v86
  v_mul_f32 v129, v91, v87
  s_barrier
  s_add_u32 m0, s41, 122880
  s_nop 0
  buffer_load_dwordx4 v240, s[16:19], s38 offen offset:0 lds
  buffer_load_dwordx4 v241, s[16:19], s38 offen offset:1024 lds
  buffer_load_dwordx4 v242, s[16:19], s38 offen offset:2048 lds
  buffer_load_dwordx4 v243, s[16:19], s38 offen offset:3072 lds
  s_add_u32 m0, s42, 122880
  s_nop 0
  buffer_load_dwordx4 v244, s[20:23], s39 offen offset:0 lds
  buffer_load_dwordx4 v245, s[20:23], s39 offen offset:1024 lds
  buffer_load_dwordx4 v246, s[20:23], s39 offen offset:2048 lds
  buffer_load_dwordx4 v247, s[20:23], s39 offen offset:3072 lds
  s_add_u32 m0, s42, 126976
  s_nop 0
  buffer_load_dwordx4 v248, s[20:23], s39 offen offset:0 lds
  buffer_load_dwordx4 v249, s[20:23], s39 offen offset:1024 lds
  s_add_u32 s38, s38, 128
  s_add_u32 s39, s39, 393216
  v_mul_f32 v130, v92, v86
  v_mul_f32 v131, v93, v87
  v_mul_f32 v132, v94, v86
  v_mul_f32 v133, v95, v87
  v_mul_f32 v134, v96, v86
  v_mul_f32 v135, v97, v87
  v_mul_f32 v136, v98, v86
  v_mul_f32 v137, v99, v87
  v_mul_f32 v138, v100, v86
  v_mul_f32 v139, v101, v87
  v_mul_f32 v140, v102, v86
  v_mul_f32 v141, v103, v87
  v_fmac_f32 v126, v90, v82
  v_fmac_f32 v127, v91, v83
  v_fmac_f32 v128, v92, v82
  v_fmac_f32 v129, v93, v83
  v_fmac_f32 v130, v94, v82
  v_fmac_f32 v131, v95, v83
  v_fmac_f32 v132, v96, v82
  v_fmac_f32 v133, v97, v83
  v_fmac_f32 v134, v98, v82
  v_fmac_f32 v135, v99, v83
  v_fmac_f32 v136, v100, v82
  v_fmac_f32 v137, v101, v83
  v_fmac_f32 v138, v102, v82
  v_fmac_f32 v139, v103, v83
  v_fmac_f32 v140, v104, v82
  v_fmac_f32 v141, v105, v83
  v_fmac_f32 v126, v92, v78
  v_fmac_f32 v127, v93, v79
  v_fmac_f32 v128, v94, v78
  v_fmac_f32 v129, v95, v79
  v_fmac_f32 v130, v96, v78
  v_fmac_f32 v131, v97, v79
  v_fmac_f32 v132, v98, v78
  v_fmac_f32 v133, v99, v79
  v_fmac_f32 v134, v100, v78
  v_fmac_f32 v135, v101, v79
  v_fmac_f32 v136, v102, v78
  v_fmac_f32 v137, v103, v79
  v_fmac_f32 v138, v104, v78
  v_fmac_f32 v139, v105, v79
  v_fmac_f32 v140, v106, v78
  v_fmac_f32 v141, v107, v79
  v_fmac_f32 v126, v94, v74
  v_fmac_f32 v127, v95, v75
  v_fmac_f32 v128, v96, v74
  v_fmac_f32 v129, v97, v75
  v_fmac_f32 v130, v98, v74
  v_fmac_f32 v131, v99, v75
  v_fmac_f32 v132, v100, v74
  v_fmac_f32 v133, v101, v75
  v_fmac_f32 v134, v102, v74
  v_fmac_f32 v135, v103, v75
  v_fmac_f32 v136, v104, v74
  v_fmac_f32 v137, v105, v75
  v_fmac_f32 v138, v106, v74
  v_fmac_f32 v139, v107, v75
  v_fmac_f32 v140, v108, v74
  v_fmac_f32 v141, v109, v75
  v_mul_f32 v126, v126, v110
  v_mul_f32 v127, v127, v111
  v_mul_f32 v128, v128, v112
  v_mul_f32 v129, v129, v113
  v_mul_f32 v130, v130, v114
  v_mul_f32 v131, v131, v115
  v_mul_f32 v132, v132, v116
  v_mul_f32 v133, v133, v117
  v_mul_f32 v134, v134, v118
  v_mul_f32 v135, v135, v119
  v_mul_f32 v136, v136, v120
  v_mul_f32 v137, v137, v121
  v_mul_f32 v138, v138, v122
  v_mul_f32 v139, v139, v123
  v_mul_f32 v140, v140, v124
  v_mul_f32 v141, v141, v125
  v_cvt_pk_bf16_f32 v152, v126, v128
  v_cvt_pk_bf16_f32 v153, v130, v132
  v_cvt_pk_bf16_f32 v154, v134, v136
  v_cvt_pk_bf16_f32 v155, v138, v140
  v_cvt_pk_bf16_f32 v156, v127, v129
  v_cvt_pk_bf16_f32 v157, v131, v133
  v_cvt_pk_bf16_f32 v158, v135, v137
  v_cvt_pk_bf16_f32 v159, v139, v141
  v_and_b32 v152, -2, v152
  v_and_b32 v153, -2, v153
  v_and_b32 v154, -2, v154
  v_and_b32 v155, -2, v155
  v_and_b32 v156, -2, v156
  v_and_b32 v157, -2, v157
  v_and_b32 v158, -2, v158
  v_and_b32 v159, -2, v159
  buffer_store_dwordx4 v[152:155], v19, s[44:47], s62 offen sc1
  s_add_u32 s62, s62, 4096
  buffer_store_dwordx4 v[156:159], v19, s[44:47], s62 offen sc1
  s_add_u32 s62, s62, 4096
  s_waitcnt vmcnt(24)
  s_barrier
  s_add_u32 m0, s41, 0
  s_nop 0
  buffer_load_dwordx4 v240, s[16:19], s38 offen offset:0 lds
  buffer_load_dwordx4 v241, s[16:19], s38 offen offset:1024 lds
  buffer_load_dwordx4 v242, s[16:19], s38 offen offset:2048 lds
  buffer_load_dwordx4 v243, s[16:19], s38 offen offset:3072 lds
  s_add_u32 m0, s42, 0
  s_nop 0
  buffer_load_dwordx4 v244, s[20:23], s39 offen offset:0 lds
  buffer_load_dwordx4 v245, s[20:23], s39 offen offset:1024 lds
  buffer_load_dwordx4 v246, s[20:23], s39 offen offset:2048 lds
  buffer_load_dwordx4 v247, s[20:23], s39 offen offset:3072 lds
  s_add_u32 m0, s42, 4096
  s_nop 0
  buffer_load_dwordx4 v248, s[20:23], s39 offen offset:0 lds
  buffer_load_dwordx4 v249, s[20:23], s39 offen offset:1024 lds
  s_add_u32 s38, s38, 128
  s_add_u32 s39, s39, 393216
  s_waitcnt vmcnt(24)
  s_barrier
  s_add_u32 m0, s41, 40960
  s_nop 0
  buffer_load_dwordx4 v240, s[16:19], s38 offen offset:0 lds
  buffer_load_dwordx4 v241, s[16:19], s38 offen offset:1024 lds
  buffer_load_dwordx4 v242, s[16:19], s38 offen offset:2048 lds
  buffer_load_dwordx4 v243, s[16:19], s38 offen offset:3072 lds
  s_add_u32 m0, s42, 40960
  s_nop 0
  buffer_load_dwordx4 v244, s[20:23], s39 offen offset:0 lds
  buffer_load_dwordx4 v245, s[20:23], s39 offen offset:1024 lds
  buffer_load_dwordx4 v246, s[20:23], s39 offen offset:2048 lds
  buffer_load_dwordx4 v247, s[20:23], s39 offen offset:3072 lds
  s_add_u32 m0, s42, 45056
  s_nop 0
  buffer_load_dwordx4 v248, s[20:23], s39 offen offset:0 lds
  buffer_load_dwordx4 v249, s[20:23], s39 offen offset:1024 lds
  s_add_u32 s38, s38, 128
  s_add_u32 s39, s39, 393216
  s_waitcnt vmcnt(22)
  s_barrier
  s_add_u32 m0, s41, 81920
  s_nop 0
  buffer_load_dwordx4 v240, s[16:19], s38 offen offset:0 lds
  buffer_load_dwordx4 v241, s[16:19], s38 offen offset:1024 lds
  buffer_load_dwordx4 v242, s[16:19], s38 offen offset:2048 lds
  buffer_load_dwordx4 v243, s[16:19], s38 offen offset:3072 lds
  s_add_u32 m0, s42, 81920
  s_nop 0
  buffer_load_dwordx4 v244, s[20:23], s39 offen offset:0 lds
  buffer_load_dwordx4 v245, s[20:23], s39 offen offset:1024 lds
  buffer_load_dwordx4 v246, s[20:23], s39 offen offset:2048 lds
  buffer_load_dwordx4 v247, s[20:23], s39 offen offset:3072 lds
  s_add_u32 m0, s42, 86016
  s_nop 0
  buffer_load_dwordx4 v248, s[20:23], s39 offen offset:0 lds
  buffer_load_dwordx4 v249, s[20:23], s39 offen offset:1024 lds
  s_add_u32 s38, s38, 128
  s_add_u32 s39, s39, 393216
  s_waitcnt vmcnt(20)
  s_barrier
  s_add_u32 m0, s41, 122880
  s_nop 0
  buffer_load_dwordx4 v240, s[16:19], s38 offen offset:0 lds
  buffer_load_dwordx4 v241, s[16:19], s38 offen offset:1024 lds
  buffer_load_dwordx4 v242, s[16:19], s38 offen offset:2048 lds
  buffer_load_dwordx4 v243, s[16:19], s38 offen offset:3072 lds
  s_add_u32 m0, s42, 122880
  s_nop 0
  buffer_load_dwordx4 v244, s[20:23], s39 offen offset:0 lds
  buffer_load_dwordx4 v245, s[20:23], s39 offen offset:1024 lds
  buffer_load_dwordx4 v246, s[20:23], s39 offen offset:2048 lds
  buffer_load_dwordx4 v247, s[20:23], s39 offen offset:3072 lds
  s_add_u32 m0, s42, 126976
  s_nop 0
  buffer_load_dwordx4 v248, s[20:23], s39 offen offset:0 lds
  buffer_load_dwordx4 v249, s[20:23], s39 offen offset:1024 lds
  s_add_u32 s38, s38, 128
  s_add_u32 s39, s39, 393216
  s_waitcnt vmcnt(20)
  s_barrier
  s_lshl_b32 s16, s10, 1
  s_lshr_b32 s17, s11, 4
  s_add_u32 s16, s16, s17
  s_and_b32 s17, s11, 15
  s_lshl_b32 s17, s17, 2
  s_add_u32 s17, s17, s4
  s_lshr_b32 s18, s17, 4
  s_and_b32 s17, s17, 15
  s_lshl_b32 s19, s18, 9
  s_lshl_b32 s64, s17, 2
  s_add_u32 s19, s19, s64
  s_lshl_b32 s64, s19, 11
  s_lshl_b32 s65, s16, 7
  s_add_u32 s64, s64, s65
  s_lshl_b32 s72, s19, 12
  s_add_u32 s72, s72, s65
  s_lshl_b32 s73, s16, 18
  s_lshl_b32 s65, s18, 10
  s_add_u32 s73, s73, s65
  s_lshl_b32 s65, s17, 6
  s_add_u32 s73, s73, s65
  s_add_u32 s65, s73, 4096
  s_add_u32 s66, s73, 8192
  s_add_u32 s67, s73, 12288
  v_lshlrev_b32 v224, 12, v14
  v_lshl_add_u32 v224, v15, 3, v224
  v_lshlrev_b32 v225, 14, v15
  v_lshl_add_u32 v225, v14, 4, v225
  s_mov_b32 s16, s84
  s_mov_b32 s17, s85
  s_mov_b32 s18, 4194304
  s_mov_b32 s19, 0x20000
  s_mov_b32 s20, s86
  s_mov_b32 s21, s87
  s_mov_b32 s22, 2048
  s_mov_b32 s23, 0x20000
  v_mov_b32 v4, 0
  v_lshlrev_b32 v5, 2, v2
  v_add_u32 v6, 38912, v5
  ds_write_b32 v6, v4
  v_add_u32 v6, s7, v5
  ds_write_b32 v6, v4 offset:4128
  v_and_b32 v6, 7, v2
  v_lshlrev_b32 v6, 2, v6
  v_add_u32 v6, s7, v6
  ds_write_b32 v6, v4
  s_add_u32 m0, s7, 32
  s_nop 0
  buffer_load_dwordx4 v3, s[16:19], s71 offen offset:0 nt lds
  buffer_load_dwordx4 v3, s[16:19], s71 offen offset:1024 nt lds
  buffer_load_dwordx4 v3, s[16:19], s71 offen offset:2048 nt lds
  buffer_load_dwordx4 v3, s[16:19], s71 offen offset:3072 nt lds
  s_lshl_b32 s43, s6, 1
  v_mov_b32 v4, 0
  buffer_load_ushort v164, v4, s[20:23], s43 offen
  s_mov_b32 s20, s92
  s_mov_b32 s21, s93
  s_mov_b32 s22, 2097152
  s_mov_b32 s23, 0x20000
  s_waitcnt vmcnt(15)
  s_waitcnt lgkmcnt(0)
  s_barrier
  s_add_u32 m0, s70, 0
  s_nop 0
  buffer_load_dwordx4 v232, s[20:23], s69 offen offset:0 lds
  buffer_load_dwordx4 v233, s[20:23], s69 offen offset:1024 lds
  buffer_load_dwordx4 v234, s[20:23], s69 offen offset:2048 lds
  buffer_load_dwordx4 v235, s[20:23], s69 offen offset:3072 lds
  s_add_u32 s69, s69, 262144
  s_add_u32 m0, s70, 16384
  s_nop 0
  buffer_load_dwordx4 v232, s[20:23], s69 offen offset:0 lds
  buffer_load_dwordx4 v233, s[20:23], s69 offen offset:1024 lds
  buffer_load_dwordx4 v234, s[20:23], s69 offen offset:2048 lds
  buffer_load_dwordx4 v235, s[20:23], s69 offen offset:3072 lds
  s_add_u32 s69, s69, 262144
  s_waitcnt vmcnt(13)
  s_barrier
  s_add_u32 m0, s70, 32768
  s_nop 0
  buffer_load_dwordx4 v232, s[20:23], s69 offen offset:0 lds
  buffer_load_dwordx4 v233, s[20:23], s69 offen offset:1024 lds
  buffer_load_dwordx4 v234, s[20:23], s69 offen offset:2048 lds
  buffer_load_dwordx4 v235, s[20:23], s69 offen offset:3072 lds
  s_add_u32 s69, s69, 262144
  s_add_u32 m0, s70, 49152
  s_nop 0
  buffer_load_dwordx4 v232, s[20:23], s69 offen offset:0 lds
  buffer_load_dwordx4 v233, s[20:23], s69 offen offset:1024 lds
  buffer_load_dwordx4 v234, s[20:23], s69 offen offset:2048 lds
  buffer_load_dwordx4 v235, s[20:23], s69 offen offset:3072 lds
  s_add_u32 s69, s69, 262144
  s_barrier
  s_mov_b32 s24, s96
  s_mov_b32 s25, s97
  s_mov_b32 s26, 256
  s_mov_b32 s27, 0x20000
  s_mov_b32 s32, s94
  s_mov_b32 s33, s95
  s_mov_b32 s34, 8388608
  s_mov_b32 s35, 0x20000
  s_mov_b32 s40, 0
  s_mov_b32 s42, 0
  v_lshrrev_b32 v5, 1, v2
  v_lshlrev_b32 v5, 7, v5
  v_and_b32 v4, 1, v2
  v_lshl_add_u32 v5, v4, 4, v5
  v_mov_b32 v4, 0
  buffer_load_dword v226, v4, s[24:27], 0 offen sc1
  s_add_u32 s24, s98, 13631488
  s_addc_u32 s25, s99, 0
  s_mov_b32 s26, 4096
  s_mov_b32 s27, 0x20000
  v_lshlrev_b32 v6, 7, v15
  v_lshl_add_u32 v6, v14, 4, v6
  s_lshl_b32 s60, s15, 11
  s_lshl_b32 s61, s15, 16
  s_lshl_b32 s62, s36, 10
  s_add_u32 s61, s61, s62
  s_mov_b32 s43, 4000
K3_fp:
  buffer_load_dwordx4 v[24:27], v5, s[24:27], 0 offen sc1
  buffer_load_dwordx4 v[28:31], v5, s[24:27], 0 offen offset:32 sc1
  s_waitcnt vmcnt(0)
  v_xor_b32 v24, v24, v226
  v_xor_b32 v25, v25, v226
  v_xor_b32 v26, v26, v226
  v_xor_b32 v27, v27, v226
  v_or3_b32 v24, v24, v25, v26
  v_or_b32 v24, v24, v27
  v_cmp_ne_u32 vcc, 0, v24
  s_sub_u32 s43, s43, 1
  s_cbranch_scc1 K3_fp_ok
  s_cmp_eq_u64 vcc, 0
  s_cbranch_scc1 K3_fp_ok
  s_add_u32 s75, s75, 1
  s_sleep 8
  s_branch K3_fp
K3_fp_ok:
  v_mov_b32 v4, s7
  ds_read_u16 v7, v4 offset:32
  v_lshlrev_b32 v164, 16, v164
  s_waitcnt lgkmcnt(0)
  v_lshlrev_b32 v7, 16, v7
  v_add_f32 v7, v7, v164
  v_cvt_pk_bf16_f32 v7, v7, v7
  ds_write_b16 v4, v7 offset:32
  v_xor_b32 v28, v28, v226
  v_xor_b32 v29, v29, v226
  v_xor_b32 v30, v30, v226
  v_xor_b32 v31, v31, v226
  v_or3_b32 v28, v28, v29, v30
  v_or_b32 v28, v28, v31
  v_cmp_ne_u32 vcc, 0, v28
  s_nop 0
  s_cmp_lg_u64 vcc, 0
  s_cbranch_scc1 K3_nou0
  s_add_u32 m0, s7, 4384
  s_nop 0
  buffer_load_dwordx4 v3, s[44:47], s71 offen offset:0 sc1 lds
  buffer_load_dwordx4 v3, s[44:47], s71 offen offset:1024 sc1 lds
  buffer_load_dwordx4 v3, s[44:47], s71 offen offset:2048 sc1 lds
  buffer_load_dwordx4 v3, s[44:47], s71 offen offset:3072 sc1 lds
  s_mov_b32 s42, 1
  s_waitcnt vmcnt(0) lgkmcnt(0)
  s_mov_b64 exec, 1
  ds_add_u32 v9, v11 offset:8
  s_mov_b64 exec, -1
K3_nou0:
  s_mov_b32 s63, 131072
K3_wkvs:
  s_sleep 1
  ds_read_b32 v16, v10 offset:84
  s_waitcnt lgkmcnt(0)
  v_readfirstlane_b32 s62, v16
  s_sub_u32 s63, s63, 1
  s_cbranch_scc1 K3_wkvs_ok
  s_cmp_lt_u32 s62, 2
  s_cbranch_scc1 K3_wkvs
K3_wkvs_ok:
  s_add_u32 m0, s70, 65536
  s_nop 0
  buffer_load_dwordx4 v232, s[20:23], s69 offen offset:0 lds
  buffer_load_dwordx4 v233, s[20:23], s69 offen offset:1024 lds
  buffer_load_dwordx4 v234, s[20:23], s69 offen offset:2048 lds
  buffer_load_dwordx4 v235, s[20:23], s69 offen offset:3072 lds
  s_add_u32 s69, s69, 262144
  s_add_u32 m0, s70, 81920
  s_nop 0
  buffer_load_dwordx4 v232, s[20:23], s69 offen offset:0 lds
  buffer_load_dwordx4 v233, s[20:23], s69 offen offset:1024 lds
  buffer_load_dwordx4 v234, s[20:23], s69 offen offset:2048 lds
  buffer_load_dwordx4 v235, s[20:23], s69 offen offset:3072 lds
  s_add_u32 s69, s69, 262144
  v_and_b32 v7, 31, v2
  v_lshlrev_b32 v7, 11, v7
  s_add_u32 s62, s69, 262144
  buffer_load_dword v165, v7, s[20:23], s62 offen
  s_lshl_b32 s43, s4, 12
  s_add_u32 s43, s43, 139264
  v_add_u32 v8, s43, v3
  s_mov_b32 s63, 131072
K3_wpq:
  s_sleep 1
  ds_read_b32 v16, v9 offset:24
  s_waitcnt lgkmcnt(0)
  v_readfirstlane_b32 s62, v16
  s_sub_u32 s63, s63, 1
  s_cbranch_scc1 K3_wpq_ok
  s_cmp_lt_u32 s62, 1
  s_cbranch_scc1 K3_wpq
K3_wpq_ok:
  ds_read_b128 v[192:195], v8 offset:0
  ds_read_b128 v[196:199], v8 offset:1024
  ds_read_b128 v[200:203], v8 offset:2048
  ds_read_b128 v[204:207], v8 offset:3072
  s_waitcnt lgkmcnt(0)
  s_add_u32 m0, s70, 98304
  s_nop 0
  buffer_load_dwordx4 v232, s[20:23], s69 offen offset:0 lds
  buffer_load_dwordx4 v233, s[20:23], s69 offen offset:1024 lds
  buffer_load_dwordx4 v234, s[20:23], s69 offen offset:2048 lds
  buffer_load_dwordx4 v235, s[20:23], s69 offen offset:3072 lds
  s_add_u32 s69, s69, 262144
  s_mov_b32 s43, 4000
K3_zp:
  buffer_load_dwordx4 v[32:35], v6, s[56:59], s60 offen offset:0 sc1
  buffer_load_dwordx4 v[36:39], v6, s[56:59], s60 offen offset:64 sc1
  s_cmp_lg_u32 s42, 0
  s_cbranch_scc1 K3_zp_nf
  buffer_load_dwordx4 v[28:31], v5, s[24:27], 0 offen offset:32 sc1
  s_waitcnt vmcnt(0)
  v_xor_b32 v28, v28, v226
  v_xor_b32 v29, v29, v226
  v_xor_b32 v30, v30, v226
  v_xor_b32 v31, v31, v226
  v_or3_b32 v28, v28, v29, v30
  v_or_b32 v28, v28, v31
  v_cmp_ne_u32 vcc, 0, v28
  s_nop 0
  s_cmp_lg_u64 vcc, 0
  s_cbranch_scc1 K3_zp_nf
  s_add_u32 m0, s7, 4384
  s_nop 0
  buffer_load_dwordx4 v3, s[44:47], s71 offen offset:0 sc1 lds
  buffer_load_dwordx4 v3, s[44:47], s71 offen offset:1024 sc1 lds
  buffer_load_dwordx4 v3, s[44:47], s71 offen offset:2048 sc1 lds
  buffer_load_dwordx4 v3, s[44:47], s71 offen offset:3072 sc1 lds
  s_mov_b32 s42, 1
  s_waitcnt vmcnt(0) lgkmcnt(0)
  s_mov_b64 exec, 1
  ds_add_u32 v9, v11 offset:8
  s_mov_b64 exec, -1
K3_zp_nf:
  ds_read_b32 v17, v9 offset:56
  s_waitcnt vmcnt(0) lgkmcnt(0)
  v_bitop3_b32 v16, v32, v33, 1 bitop3:0x80
  v_bitop3_b32 v16, v16, v34, v35 bitop3:0x80
  v_bitop3_b32 v16, v16, v36, v37 bitop3:0x80
  v_bitop3_b32 v16, v16, v38, v39 bitop3:0x80
  v_readfirstlane_b32 s41, v17
  v_cmp_eq_u32 vcc, 0, v16
  s_sub_u32 s43, s43, 1
  s_cbranch_scc1 K3_zp_ok
  s_cmp_eq_u64 vcc, 0
  s_cbranch_scc1 K3_zp_ok
  s_cmp_lg_u32 s40, 0
  s_cbranch_scc1 K3_zp_s2
K3_zp_s2:
  s_sleep 10
  s_branch K3_zp
K3_zp_ok:
  s_setprio 2
  s_mov_b32 s43, 4000
  s_mov_b32 s62, s61
  buffer_load_dwordx4 v[96:99], v3, s[52:55], s62 offen offset:0
  s_add_u32 s62, s62, 4096
  buffer_load_dwordx4 v[100:103], v3, s[52:55], s62 offen offset:0
  s_add_u32 s62, s62, 4096
  buffer_load_dwordx4 v[104:107], v3, s[52:55], s62 offen offset:0
  s_add_u32 s62, s62, 4096
  buffer_load_dwordx4 v[108:111], v3, s[52:55], s62 offen offset:0
  s_add_u32 s62, s62, 4096
  buffer_load_dwordx4 v[112:115], v3, s[52:55], s62 offen offset:0
  s_add_u32 s62, s62, 4096
  buffer_load_dwordx4 v[116:119], v3, s[52:55], s62 offen offset:0
  s_add_u32 s62, s62, 4096
  buffer_load_dwordx4 v[120:123], v3, s[52:55], s62 offen offset:0
  s_add_u32 s62, s62, 4096
  buffer_load_dwordx4 v[124:127], v3, s[52:55], s62 offen offset:0
  s_add_u32 s62, s62, 4096
  buffer_load_dwordx4 v[128:131], v3, s[52:55], s62 offen offset:0
  s_add_u32 s62, s62, 4096
  buffer_load_dwordx4 v[132:135], v3, s[52:55], s62 offen offset:0
  s_add_u32 s62, s62, 4096
  buffer_load_dwordx4 v[136:139], v3, s[52:55], s62 offen offset:0
  s_add_u32 s62, s62, 4096
  buffer_load_dwordx4 v[140:143], v3, s[52:55], s62 offen offset:0
  s_add_u32 s62, s62, 4096
  buffer_load_dwordx4 v[144:147], v3, s[52:55], s62 offen offset:0
  s_add_u32 s62, s62, 4096
  buffer_load_dwordx4 v[148:151], v3, s[52:55], s62 offen offset:0
  s_add_u32 s62, s62, 4096
  buffer_load_dwordx4 v[152:155], v3, s[52:55], s62 offen offset:0
  s_add_u32 s62, s62, 4096
  buffer_load_dwordx4 v[156:159], v3, s[52:55], s62 offen offset:0
  s_add_u32 s62, s62, 4096
  s_mov_b32 s16, s76
  s_mov_b32 s17, s77
  s_mov_b32 s18, 4194304
  s_mov_b32 s19, 0x20000
  v_lshlrev_b32 v4, 11, v14
  v_lshl_add_u32 v4, v15, 3, v4
  buffer_load_dwordx2 v[208:209], v4, s[16:19], s64 offen nt
  s_add_u32 s64, s64, 131072
  buffer_load_dwordx2 v[210:211], v4, s[16:19], s64 offen nt
  s_add_u32 s64, s64, 131072
  buffer_load_dwordx2 v[212:213], v4, s[16:19], s64 offen nt
  s_add_u32 s64, s64, 131072
  buffer_load_dwordx2 v[214:215], v4, s[16:19], s64 offen nt
  s_add_u32 s64, s64, 131072
  buffer_load_dwordx2 v[216:217], v4, s[16:19], s64 offen nt
  s_add_u32 s64, s64, 131072
  buffer_load_dwordx2 v[218:219], v4, s[16:19], s64 offen nt
  s_add_u32 s64, s64, 131072
  buffer_load_dwordx2 v[220:221], v4, s[16:19], s64 offen nt
  s_add_u32 s64, s64, 131072
  buffer_load_dwordx2 v[222:223], v4, s[16:19], s64 offen nt
  s_add_u32 s64, s64, 131072
K3_gl:
  v_add_f32_dpp v40, v32, v32 row_ror:8 row_mask:0xf bank_mask:0xf
  v_add_f32_dpp v41, v33, v33 row_ror:8 row_mask:0xf bank_mask:0xf
  v_add_f32_dpp v42, v34, v34 row_ror:8 row_mask:0xf bank_mask:0xf
  v_add_f32_dpp v43, v35, v35 row_ror:8 row_mask:0xf bank_mask:0xf
  v_add_f32_dpp v44, v36, v36 row_ror:8 row_mask:0xf bank_mask:0xf
  v_add_f32_dpp v45, v37, v37 row_ror:8 row_mask:0xf bank_mask:0xf
  v_add_f32_dpp v46, v38, v38 row_ror:8 row_mask:0xf bank_mask:0xf
  v_add_f32_dpp v47, v39, v39 row_ror:8 row_mask:0xf bank_mask:0xf
  v_add_f32_dpp v40, v40, v40 row_ror:4 row_mask:0xf bank_mask:0xf
  v_add_f32_dpp v41, v41, v41 row_ror:4 row_mask:0xf bank_mask:0xf
  v_add_f32_dpp v42, v42, v42 row_ror:4 row_mask:0xf bank_mask:0xf
  v_add_f32_dpp v43, v43, v43 row_ror:4 row_mask:0xf bank_mask:0xf
  v_add_f32_dpp v44, v44, v44 row_ror:4 row_mask:0xf bank_mask:0xf
  v_add_f32_dpp v45, v45, v45 row_ror:4 row_mask:0xf bank_mask:0xf
  v_add_f32_dpp v46, v46, v46 row_ror:4 row_mask:0xf bank_mask:0xf
  v_add_f32_dpp v47, v47, v47 row_ror:4 row_mask:0xf bank_mask:0xf
  v_add_f32_dpp v40, v40, v40 row_ror:2 row_mask:0xf bank_mask:0xf
  v_add_f32_dpp v41, v41, v41 row_ror:2 row_mask:0xf bank_mask:0xf
  v_add_f32_dpp v42, v42, v42 row_ror:2 row_mask:0xf bank_mask:0xf
  v_add_f32_dpp v43, v43, v43 row_ror:2 row_mask:0xf bank_mask:0xf
  v_add_f32_dpp v44, v44, v44 row_ror:2 row_mask:0xf bank_mask:0xf
  v_add_f32_dpp v45, v45, v45 row_ror:2 row_mask:0xf bank_mask:0xf
  v_add_f32_dpp v46, v46, v46 row_ror:2 row_mask:0xf bank_mask:0xf
  v_add_f32_dpp v47, v47, v47 row_ror:2 row_mask:0xf bank_mask:0xf
  v_add_f32_dpp v40, v40, v40 row_ror:1 row_mask:0xf bank_mask:0xf
  v_add_f32_dpp v41, v41, v41 row_ror:1 row_mask:0xf bank_mask:0xf
  v_add_f32_dpp v42, v42, v42 row_ror:1 row_mask:0xf bank_mask:0xf
  v_add_f32_dpp v43, v43, v43 row_ror:1 row_mask:0xf bank_mask:0xf
  v_add_f32_dpp v44, v44, v44 row_ror:1 row_mask:0xf bank_mask:0xf
  v_add_f32_dpp v45, v45, v45 row_ror:1 row_mask:0xf bank_mask:0xf
  v_add_f32_dpp v46, v46, v46 row_ror:1 row_mask:0xf bank_mask:0xf
  v_add_f32_dpp v47, v47, v47 row_ror:1 row_mask:0xf bank_mask:0xf
  v_cvt_pk_bf16_f32 v48, v40, v41
  v_cvt_pk_bf16_f32 v49, v42, v43
  v_cvt_pk_bf16_f32 v50, v44, v45
  v_cvt_pk_bf16_f32 v51, v46, v47
  v_mov_b32 v16, 1
  s_waitcnt vmcnt(23)
  v_bitop3_b32 v16, v16, v96, v97 bitop3:0x80
  v_bitop3_b32 v16, v16, v98, v99 bitop3:0x80
  v_lshlrev_b32 v64, 16, v96
  v_and_b32 v65, 0xffff0000, v96
  v_lshlrev_b32 v66, 16, v97
  v_and_b32 v67, 0xffff0000, v97
  v_lshlrev_b32 v68, 16, v98
  v_and_b32 v69, 0xffff0000, v98
  v_lshlrev_b32 v70, 16, v99
  v_and_b32 v71, 0xffff0000, v99
  s_waitcnt vmcnt(22)
  v_bitop3_b32 v16, v16, v100, v101 bitop3:0x80
  v_bitop3_b32 v16, v16, v102, v103 bitop3:0x80
  v_lshlrev_b32 v72, 16, v100
  v_and_b32 v73, 0xffff0000, v100
  v_lshlrev_b32 v74, 16, v101
  v_and_b32 v75, 0xffff0000, v101
  v_lshlrev_b32 v76, 16, v102
  v_and_b32 v77, 0xffff0000, v102
  v_lshlrev_b32 v78, 16, v103
  v_and_b32 v79, 0xffff0000, v103
  v_add_f32 v64, v64, v72
  v_add_f32 v65, v65, v73
  v_add_f32 v66, v66, v74
  v_add_f32 v67, v67, v75
  v_add_f32 v68, v68, v76
  v_add_f32 v69, v69, v77
  v_add_f32 v70, v70, v78
  v_add_f32 v71, v71, v79
  s_waitcnt vmcnt(21)
  v_bitop3_b32 v16, v16, v104, v105 bitop3:0x80
  v_bitop3_b32 v16, v16, v106, v107 bitop3:0x80
  v_lshlrev_b32 v72, 16, v104
  v_and_b32 v73, 0xffff0000, v104
  v_lshlrev_b32 v74, 16, v105
  v_and_b32 v75, 0xffff0000, v105
  v_lshlrev_b32 v76, 16, v106
  v_and_b32 v77, 0xffff0000, v106
  v_lshlrev_b32 v78, 16, v107
  v_and_b32 v79, 0xffff0000, v107
  v_add_f32 v64, v64, v72
  v_add_f32 v65, v65, v73
  v_add_f32 v66, v66, v74
  v_add_f32 v67, v67, v75
  v_add_f32 v68, v68, v76
  v_add_f32 v69, v69, v77
  v_add_f32 v70, v70, v78
  v_add_f32 v71, v71, v79
  s_waitcnt vmcnt(20)
  v_bitop3_b32 v16, v16, v108, v109 bitop3:0x80
  v_bitop3_b32 v16, v16, v110, v111 bitop3:0x80
  v_lshlrev_b32 v72, 16, v108
  v_and_b32 v73, 0xffff0000, v108
  v_lshlrev_b32 v74, 16, v109
  v_and_b32 v75, 0xffff0000, v109
  v_lshlrev_b32 v76, 16, v110
  v_and_b32 v77, 0xffff0000, v110
  v_lshlrev_b32 v78, 16, v111
  v_and_b32 v79, 0xffff0000, v111
  v_add_f32 v64, v64, v72
  v_add_f32 v65, v65, v73
  v_add_f32 v66, v66, v74
  v_add_f32 v67, v67, v75
  v_add_f32 v68, v68, v76
  v_add_f32 v69, v69, v77
  v_add_f32 v70, v70, v78
  v_add_f32 v71, v71, v79
  s_waitcnt vmcnt(19)
  v_bitop3_b32 v16, v16, v112, v113 bitop3:0x80
  v_bitop3_b32 v16, v16, v114, v115 bitop3:0x80
  v_lshlrev_b32 v72, 16, v112
  v_and_b32 v73, 0xffff0000, v112
  v_lshlrev_b32 v74, 16, v113
  v_and_b32 v75, 0xffff0000, v113
  v_lshlrev_b32 v76, 16, v114
  v_and_b32 v77, 0xffff0000, v114
  v_lshlrev_b32 v78, 16, v115
  v_and_b32 v79, 0xffff0000, v115
  v_add_f32 v64, v64, v72
  v_add_f32 v65, v65, v73
  v_add_f32 v66, v66, v74
  v_add_f32 v67, v67, v75
  v_add_f32 v68, v68, v76
  v_add_f32 v69, v69, v77
  v_add_f32 v70, v70, v78
  v_add_f32 v71, v71, v79
  s_waitcnt vmcnt(18)
  v_bitop3_b32 v16, v16, v116, v117 bitop3:0x80
  v_bitop3_b32 v16, v16, v118, v119 bitop3:0x80
  v_lshlrev_b32 v72, 16, v116
  v_and_b32 v73, 0xffff0000, v116
  v_lshlrev_b32 v74, 16, v117
  v_and_b32 v75, 0xffff0000, v117
  v_lshlrev_b32 v76, 16, v118
  v_and_b32 v77, 0xffff0000, v118
  v_lshlrev_b32 v78, 16, v119
  v_and_b32 v79, 0xffff0000, v119
  v_add_f32 v64, v64, v72
  v_add_f32 v65, v65, v73
  v_add_f32 v66, v66, v74
  v_add_f32 v67, v67, v75
  v_add_f32 v68, v68, v76
  v_add_f32 v69, v69, v77
  v_add_f32 v70, v70, v78
  v_add_f32 v71, v71, v79
  s_waitcnt vmcnt(17)
  v_bitop3_b32 v16, v16, v120, v121 bitop3:0x80
  v_bitop3_b32 v16, v16, v122, v123 bitop3:0x80
  v_lshlrev_b32 v72, 16, v120
  v_and_b32 v73, 0xffff0000, v120
  v_lshlrev_b32 v74, 16, v121
  v_and_b32 v75, 0xffff0000, v121
  v_lshlrev_b32 v76, 16, v122
  v_and_b32 v77, 0xffff0000, v122
  v_lshlrev_b32 v78, 16, v123
  v_and_b32 v79, 0xffff0000, v123
  v_add_f32 v64, v64, v72
  v_add_f32 v65, v65, v73
  v_add_f32 v66, v66, v74
  v_add_f32 v67, v67, v75
  v_add_f32 v68, v68, v76
  v_add_f32 v69, v69, v77
  v_add_f32 v70, v70, v78
  v_add_f32 v71, v71, v79
  s_waitcnt vmcnt(16)
  v_bitop3_b32 v16, v16, v124, v125 bitop3:0x80
  v_bitop3_b32 v16, v16, v126, v127 bitop3:0x80
  v_lshlrev_b32 v72, 16, v124
  v_and_b32 v73, 0xffff0000, v124
  v_lshlrev_b32 v74, 16, v125
  v_and_b32 v75, 0xffff0000, v125
  v_lshlrev_b32 v76, 16, v126
  v_and_b32 v77, 0xffff0000, v126
  v_lshlrev_b32 v78, 16, v127
  v_and_b32 v79, 0xffff0000, v127
  v_add_f32 v64, v64, v72
  v_add_f32 v65, v65, v73
  v_add_f32 v66, v66, v74
  v_add_f32 v67, v67, v75
  v_add_f32 v68, v68, v76
  v_add_f32 v69, v69, v77
  v_add_f32 v70, v70, v78
  v_add_f32 v71, v71, v79
  s_waitcnt vmcnt(15)
  v_bitop3_b32 v16, v16, v128, v129 bitop3:0x80
  v_bitop3_b32 v16, v16, v130, v131 bitop3:0x80
  v_lshlrev_b32 v72, 16, v128
  v_and_b32 v73, 0xffff0000, v128
  v_lshlrev_b32 v74, 16, v129
  v_and_b32 v75, 0xffff0000, v129
  v_lshlrev_b32 v76, 16, v130
  v_and_b32 v77, 0xffff0000, v130
  v_lshlrev_b32 v78, 16, v131
  v_and_b32 v79, 0xffff0000, v131
  v_add_f32 v64, v64, v72
  v_add_f32 v65, v65, v73
  v_add_f32 v66, v66, v74
  v_add_f32 v67, v67, v75
  v_add_f32 v68, v68, v76
  v_add_f32 v69, v69, v77
  v_add_f32 v70, v70, v78
  v_add_f32 v71, v71, v79
  s_waitcnt vmcnt(14)
  v_bitop3_b32 v16, v16, v132, v133 bitop3:0x80
  v_bitop3_b32 v16, v16, v134, v135 bitop3:0x80
  v_lshlrev_b32 v72, 16, v132
  v_and_b32 v73, 0xffff0000, v132
  v_lshlrev_b32 v74, 16, v133
  v_and_b32 v75, 0xffff0000, v133
  v_lshlrev_b32 v76, 16, v134
  v_and_b32 v77, 0xffff0000, v134
  v_lshlrev_b32 v78, 16, v135
  v_and_b32 v79, 0xffff0000, v135
  v_add_f32 v64, v64, v72
  v_add_f32 v65, v65, v73
  v_add_f32 v66, v66, v74
  v_add_f32 v67, v67, v75
  v_add_f32 v68, v68, v76
  v_add_f32 v69, v69, v77
  v_add_f32 v70, v70, v78
  v_add_f32 v71, v71, v79
  s_waitcnt vmcnt(13)
  v_bitop3_b32 v16, v16, v136, v137 bitop3:0x80
  v_bitop3_b32 v16, v16, v138, v139 bitop3:0x80
  v_lshlrev_b32 v72, 16, v136
  v_and_b32 v73, 0xffff0000, v136
  v_lshlrev_b32 v74, 16, v137
  v_and_b32 v75, 0xffff0000, v137
  v_lshlrev_b32 v76, 16, v138
  v_and_b32 v77, 0xffff0000, v138
  v_lshlrev_b32 v78, 16, v139
  v_and_b32 v79, 0xffff0000, v139
  v_add_f32 v64, v64, v72
  v_add_f32 v65, v65, v73
  v_add_f32 v66, v66, v74
  v_add_f32 v67, v67, v75
  v_add_f32 v68, v68, v76
  v_add_f32 v69, v69, v77
  v_add_f32 v70, v70, v78
  v_add_f32 v71, v71, v79
  s_waitcnt vmcnt(12)
  v_bitop3_b32 v16, v16, v140, v141 bitop3:0x80
  v_bitop3_b32 v16, v16, v142, v143 bitop3:0x80
  v_lshlrev_b32 v72, 16, v140
  v_and_b32 v73, 0xffff0000, v140
  v_lshlrev_b32 v74, 16, v141
  v_and_b32 v75, 0xffff0000, v141
  v_lshlrev_b32 v76, 16, v142
  v_and_b32 v77, 0xffff0000, v142
  v_lshlrev_b32 v78, 16, v143
  v_and_b32 v79, 0xffff0000, v143
  v_add_f32 v64, v64, v72
  v_add_f32 v65, v65, v73
  v_add_f32 v66, v66, v74
  v_add_f32 v67, v67, v75
  v_add_f32 v68, v68, v76
  v_add_f32 v69, v69, v77
  v_add_f32 v70, v70, v78
  v_add_f32 v71, v71, v79
  s_waitcnt vmcnt(11)
  v_bitop3_b32 v16, v16, v144, v145 bitop3:0x80
  v_bitop3_b32 v16, v16, v146, v147 bitop3:0x80
  v_lshlrev_b32 v72, 16, v144
  v_and_b32 v73, 0xffff0000, v144
  v_lshlrev_b32 v74, 16, v145
  v_and_b32 v75, 0xffff0000, v145
  v_lshlrev_b32 v76, 16, v146
  v_and_b32 v77, 0xffff0000, v146
  v_lshlrev_b32 v78, 16, v147
  v_and_b32 v79, 0xffff0000, v147
  v_add_f32 v64, v64, v72
  v_add_f32 v65, v65, v73
  v_add_f32 v66, v66, v74
  v_add_f32 v67, v67, v75
  v_add_f32 v68, v68, v76
  v_add_f32 v69, v69, v77
  v_add_f32 v70, v70, v78
  v_add_f32 v71, v71, v79
  s_waitcnt vmcnt(10)
  v_bitop3_b32 v16, v16, v148, v149 bitop3:0x80
  v_bitop3_b32 v16, v16, v150, v151 bitop3:0x80
  v_lshlrev_b32 v72, 16, v148
  v_and_b32 v73, 0xffff0000, v148
  v_lshlrev_b32 v74, 16, v149
  v_and_b32 v75, 0xffff0000, v149
  v_lshlrev_b32 v76, 16, v150
  v_and_b32 v77, 0xffff0000, v150
  v_lshlrev_b32 v78, 16, v151
  v_and_b32 v79, 0xffff0000, v151
  v_add_f32 v64, v64, v72
  v_add_f32 v65, v65, v73
  v_add_f32 v66, v66, v74
  v_add_f32 v67, v67, v75
  v_add_f32 v68, v68, v76
  v_add_f32 v69, v69, v77
  v_add_f32 v70, v70, v78
  v_add_f32 v71, v71, v79
  s_waitcnt vmcnt(9)
  v_bitop3_b32 v16, v16, v152, v153 bitop3:0x80
  v_bitop3_b32 v16, v16, v154, v155 bitop3:0x80
  v_lshlrev_b32 v72, 16, v152
  v_and_b32 v73, 0xffff0000, v152
  v_lshlrev_b32 v74, 16, v153
  v_and_b32 v75, 0xffff0000, v153
  v_lshlrev_b32 v76, 16, v154
  v_and_b32 v77, 0xffff0000, v154
  v_lshlrev_b32 v78, 16, v155
  v_and_b32 v79, 0xffff0000, v155
  v_add_f32 v64, v64, v72
  v_add_f32 v65, v65, v73
  v_add_f32 v66, v66, v74
  v_add_f32 v67, v67, v75
  v_add_f32 v68, v68, v76
  v_add_f32 v69, v69, v77
  v_add_f32 v70, v70, v78
  v_add_f32 v71, v71, v79
  s_waitcnt vmcnt(8)
  v_bitop3_b32 v16, v16, v156, v157 bitop3:0x80
  v_bitop3_b32 v16, v16, v158, v159 bitop3:0x80
  v_lshlrev_b32 v72, 16, v156
  v_and_b32 v73, 0xffff0000, v156
  v_lshlrev_b32 v74, 16, v157
  v_and_b32 v75, 0xffff0000, v157
  v_lshlrev_b32 v76, 16, v158
  v_and_b32 v77, 0xffff0000, v158
  v_lshlrev_b32 v78, 16, v159
  v_and_b32 v79, 0xffff0000, v159
  v_add_f32 v64, v64, v72
  v_add_f32 v65, v65, v73
  v_add_f32 v66, v66, v74
  v_add_f32 v67, v67, v75
  v_add_f32 v68, v68, v76
  v_add_f32 v69, v69, v77
  v_add_f32 v70, v70, v78
  v_add_f32 v71, v71, v79
  v_cmp_eq_u32 vcc, 0, v16
  s_sub_u32 s43, s43, 1
  s_cbranch_scc1 K3_gl_ok
  s_cmp_eq_u64 vcc, 0
  s_cbranch_scc1 K3_gl_ok
  s_add_u32 s75, s75, 1
  s_sleep 4
  s_mov_b32 s62, s61
  buffer_load_dwordx4 v[96:99], v3, s[52:55], s62 offen offset:0 sc1
  s_add_u32 s62, s62, 4096
  buffer_load_dwordx4 v[100:103], v3, s[52:55], s62 offen offset:0 sc1
  s_add_u32 s62, s62, 4096
  buffer_load_dwordx4 v[104:107], v3, s[52:55], s62 offen offset:0 sc1
  s_add_u32 s62, s62, 4096
  buffer_load_dwordx4 v[108:111], v3, s[52:55], s62 offen offset:0 sc1
  s_add_u32 s62, s62, 4096
  buffer_load_dwordx4 v[112:115], v3, s[52:55], s62 offen offset:0 sc1
  s_add_u32 s62, s62, 4096
  buffer_load_dwordx4 v[116:119], v3, s[52:55], s62 offen offset:0 sc1
  s_add_u32 s62, s62, 4096
  buffer_load_dwordx4 v[120:123], v3, s[52:55], s62 offen offset:0 sc1
  s_add_u32 s62, s62, 4096
  buffer_load_dwordx4 v[124:127], v3, s[52:55], s62 offen offset:0 sc1
  s_add_u32 s62, s62, 4096
  buffer_load_dwordx4 v[128:131], v3, s[52:55], s62 offen offset:0 sc1
  s_add_u32 s62, s62, 4096
  buffer_load_dwordx4 v[132:135], v3, s[52:55], s62 offen offset:0 sc1
  s_add_u32 s62, s62, 4096
  buffer_load_dwordx4 v[136:139], v3, s[52:55], s62 offen offset:0 sc1
  s_add_u32 s62, s62, 4096
  buffer_load_dwordx4 v[140:143], v3, s[52:55], s62 offen offset:0 sc1
  s_add_u32 s62, s62, 4096
  buffer_load_dwordx4 v[144:147], v3, s[52:55], s62 offen offset:0 sc1
  s_add_u32 s62, s62, 4096
  buffer_load_dwordx4 v[148:151], v3, s[52:55], s62 offen offset:0 sc1
  s_add_u32 s62, s62, 4096
  buffer_load_dwordx4 v[152:155], v3, s[52:55], s62 offen offset:0 sc1
  s_add_u32 s62, s62, 4096
  buffer_load_dwordx4 v[156:159], v3, s[52:55], s62 offen offset:0 sc1
  s_add_u32 s62, s62, 4096
  s_waitcnt vmcnt(0)
  s_branch K3_gl
K3_gl_ok:
  v_cvt_pk_bf16_f32 v40, v64, v65
  v_cvt_pk_bf16_f32 v41, v66, v67
  v_cvt_pk_bf16_f32 v42, v68, v69
  v_cvt_pk_bf16_f32 v43, v70, v71
  s_lshl_b32 s43, s4, 10
  s_add_u32 s43, s43, 34816
  v_add_u32 v5, s43, v3
  ds_write_b128 v5, v[40:43]
  s_lshl_b32 s43, s37, 2
  v_add_u32 v7, s43, v10
  s_lshl_b32 s43, s37, 11
  s_add_u32 s43, s43, 34816
  v_add_u32 v5, s43, v3
  s_waitcnt lgkmcnt(0)
  s_mov_b64 exec, 1
  ds_add_u32 v7, v11 offset:40
  s_mov_b64 exec, -1
  s_mov_b32 s61, 131072
K3_wkt:
  ds_read_b32 v52, v7 offset:40
  s_waitcnt lgkmcnt(0)
  v_readfirstlane_b32 s60, v52
  s_sub_u32 s61, s61, 1
  s_cbranch_scc1 K3_wkt_ok
  s_cmp_lt_u32 s60, 2
  s_cbranch_scc1 K3_wkt
K3_wkt_ok:
  ds_read_b128 v[40:43], v5
  ds_read_b128 v[44:47], v5 offset:1024
  s_waitcnt lgkmcnt(0)
  v_mfma_f32_16x16x32_bf16 v[72:75], v[48:51], v[192:195], 0
  v_mfma_f32_16x16x32_bf16 v[64:67], v[40:43], v[192:195], 0
  v_mfma_f32_16x16x32_bf16 v[68:71], v[44:47], v[192:195], 0
  v_mfma_f32_16x16x32_bf16 v[84:87], v[48:51], v[196:199], 0
  v_mfma_f32_16x16x32_bf16 v[76:79], v[40:43], v[196:199], 0
  v_mfma_f32_16x16x32_bf16 v[80:83], v[44:47], v[196:199], 0
  v_mfma_f32_16x16x32_bf16 v[96:99], v[48:51], v[200:203], 0
  v_mfma_f32_16x16x32_bf16 v[88:91], v[40:43], v[200:203], 0
  v_mfma_f32_16x16x32_bf16 v[92:95], v[44:47], v[200:203], 0
  v_mfma_f32_16x16x32_bf16 v[108:111], v[48:51], v[204:207], 0
  v_mfma_f32_16x16x32_bf16 v[100:103], v[40:43], v[204:207], 0
  v_mfma_f32_16x16x32_bf16 v[104:107], v[44:47], v[204:207], 0
  s_lshl_b32 s60, s12, 3
  s_lshl_b32 s61, s36, 2
  s_add_u32 s60, s60, s61
  s_lshl_b32 s60, s60, 5
  s_add_u32 s60, s60, s15
  s_lshl_b32 s60, s60, 10
  s_mov_b32 s61, 897988541
  v_add_f32 v112, s61, v72
  v_rcp_f32 v112, v112
  v_add_f32 v113, s61, v84
  v_rcp_f32 v113, v113
  v_add_f32 v114, s61, v96
  v_rcp_f32 v114, v114
  v_add_f32 v115, s61, v108
  v_rcp_f32 v115, v115
  v_mul_f32 v64, v64, v112
  v_mul_f32 v65, v65, v112
  v_mul_f32 v66, v66, v112
  v_mul_f32 v67, v67, v112
  v_mul_f32 v68, v68, v112
  v_mul_f32 v69, v69, v112
  v_mul_f32 v70, v70, v112
  v_mul_f32 v71, v71, v112
  v_cvt_pk_bf16_f32 v120, v64, v65
  v_cvt_pk_bf16_f32 v121, v66, v67
  v_cvt_pk_bf16_f32 v122, v68, v69
  v_cvt_pk_bf16_f32 v123, v70, v71
  v_or_b32 v120, 1, v120
  v_or_b32 v121, 1, v121
  v_or_b32 v122, 1, v122
  v_or_b32 v123, 1, v123
  buffer_store_dwordx4 v[120:123], v3, s[48:51], s60 offen sc1
  s_add_u32 s60, s60, 32768
  v_mul_f32 v76, v76, v113
  v_mul_f32 v77, v77, v113
  v_mul_f32 v78, v78, v113
  v_mul_f32 v79, v79, v113
  v_mul_f32 v80, v80, v113
  v_mul_f32 v81, v81, v113
  v_mul_f32 v82, v82, v113
  v_mul_f32 v83, v83, v113
  v_cvt_pk_bf16_f32 v124, v76, v77
  v_cvt_pk_bf16_f32 v125, v78, v79
  v_cvt_pk_bf16_f32 v126, v80, v81
  v_cvt_pk_bf16_f32 v127, v82, v83
  v_or_b32 v124, 1, v124
  v_or_b32 v125, 1, v125
  v_or_b32 v126, 1, v126
  v_or_b32 v127, 1, v127
  buffer_store_dwordx4 v[124:127], v3, s[48:51], s60 offen sc1
  s_add_u32 s60, s60, 32768
  v_mul_f32 v88, v88, v114
  v_mul_f32 v89, v89, v114
  v_mul_f32 v90, v90, v114
  v_mul_f32 v91, v91, v114
  v_mul_f32 v92, v92, v114
  v_mul_f32 v93, v93, v114
  v_mul_f32 v94, v94, v114
  v_mul_f32 v95, v95, v114
  v_cvt_pk_bf16_f32 v128, v88, v89
  v_cvt_pk_bf16_f32 v129, v90, v91
  v_cvt_pk_bf16_f32 v130, v92, v93
  v_cvt_pk_bf16_f32 v131, v94, v95
  v_or_b32 v128, 1, v128
  v_or_b32 v129, 1, v129
  v_or_b32 v130, 1, v130
  v_or_b32 v131, 1, v131
  buffer_store_dwordx4 v[128:131], v3, s[48:51], s60 offen sc1
  s_add_u32 s60, s60, 32768
  v_mul_f32 v100, v100, v115
  v_mul_f32 v101, v101, v115
  v_mul_f32 v102, v102, v115
  v_mul_f32 v103, v103, v115
  v_mul_f32 v104, v104, v115
  v_mul_f32 v105, v105, v115
  v_mul_f32 v106, v106, v115
  v_mul_f32 v107, v107, v115
  v_cvt_pk_bf16_f32 v132, v100, v101
  v_cvt_pk_bf16_f32 v133, v102, v103
  v_cvt_pk_bf16_f32 v134, v104, v105
  v_cvt_pk_bf16_f32 v135, v106, v107
  v_or_b32 v132, 1, v132
  v_or_b32 v133, 1, v133
  v_or_b32 v134, 1, v134
  v_or_b32 v135, 1, v135
  buffer_store_dwordx4 v[132:135], v3, s[48:51], s60 offen sc1
  s_add_u32 s60, s60, 32768
  s_setprio 0
  s_mov_b32 s43, 4000
  v_lshrrev_b32 v5, 1, v2
  v_lshlrev_b32 v5, 7, v5
  v_and_b32 v4, 1, v2
  v_lshl_add_u32 v5, v4, 4, v5
K3_ul:
  s_cmp_lg_u32 s42, 0
  s_cbranch_scc1 K3_ul_done
  buffer_load_dwordx4 v[28:31], v5, s[24:27], 0 offen offset:32 sc1
  s_waitcnt vmcnt(0)
  v_xor_b32 v28, v28, v226
  v_xor_b32 v29, v29, v226
  v_xor_b32 v30, v30, v226
  v_xor_b32 v31, v31, v226
  v_or3_b32 v28, v28, v29, v30
  v_or_b32 v28, v28, v31
  v_cmp_ne_u32 vcc, 0, v28
  s_sub_u32 s43, s43, 1
  s_cbranch_scc1 K3_ul_go
  s_cmp_eq_u64 vcc, 0
  s_cbranch_scc1 K3_ul_go
  s_sleep 4
  s_branch K3_ul
K3_ul_go:
  s_add_u32 m0, s7, 4384
  s_nop 0
  buffer_load_dwordx4 v3, s[44:47], s71 offen offset:0 sc1 lds
  buffer_load_dwordx4 v3, s[44:47], s71 offen offset:1024 sc1 lds
  buffer_load_dwordx4 v3, s[44:47], s71 offen offset:2048 sc1 lds
  buffer_load_dwordx4 v3, s[44:47], s71 offen offset:3072 sc1 lds
  s_mov_b32 s42, 1
  s_waitcnt vmcnt(0) lgkmcnt(0)
  s_mov_b64 exec, 1
  ds_add_u32 v9, v11 offset:8
  s_mov_b64 exec, -1
K3_ul_done:
  s_and_b32 s60, s10, 3
  s_lshl_b32 s60, s60, 2
  s_and_b32 s61, s11, 3
  s_add_u32 s60, s60, s61
  s_lshl_b32 s60, s60, 18
  s_lshr_b32 s61, s11, 2
  s_lshl_b32 s61, s61, 2
  s_add_u32 s61, s61, s4
  s_lshl_b32 s61, s61, 13
  s_add_u32 s63, s60, s61
  v_lshlrev_b32 v8, 7, v2
  s_waitcnt vmcnt(0)
  buffer_load_dword v60, v8, s[48:51], s63 offen
  s_waitcnt vmcnt(0)
  s_mov_b64 exec, 1
  ds_add_u32 v10, v11 offset:48
  s_mov_b64 exec, -1
  s_mov_b32 s61, 131072
K3_wcd:
  s_sleep 1
  ds_read_b32 v16, v9 offset:56
  s_waitcnt lgkmcnt(0)
  v_readfirstlane_b32 s60, v16
  s_sub_u32 s61, s61, 1
  s_cbranch_scc1 K3_wcd_ok
  s_cmp_lt_u32 s60, 1
  s_cbranch_scc1 K3_wcd
K3_wcd_ok:
  s_mov_b32 m0, s7
  s_nop 0
  buffer_load_dwordx4 v232, s[20:23], s69 offen offset:0 lds
  buffer_load_dwordx4 v233, s[20:23], s69 offen offset:1024 lds
  buffer_load_dwordx4 v234, s[20:23], s69 offen offset:2048 lds
  buffer_load_dwordx4 v235, s[20:23], s69 offen offset:3072 lds
  s_add_u32 s69, s69, 262144
  s_waitcnt vmcnt(0)
  s_mov_b64 exec, 1
  ds_add_u32 v10, v11 offset:52
  s_mov_b64 exec, -1
  s_cmp_eq_u32 s40, 1
  s_cbranch_scc1 K3_fin
  s_mov_b32 s61, 131072
K3_wg2:
  s_sleep 2
  ds_read_b32 v16, v9 offset:112
  s_waitcnt lgkmcnt(0)
  v_readfirstlane_b32 s60, v16
  s_sub_u32 s61, s61, 1
  s_cbranch_scc1 K3_wg2_ok
  s_cmp_lt_u32 s60, 1
  s_cbranch_scc1 K3_wg2
K3_wg2_ok:
  s_mov_b32 s40, 2
  s_mov_b32 s43, 4000
K3_post:
  buffer_load_dwordx4 v[16:19], v225, s[44:47], s73 offen sc1
  buffer_load_dwordx4 v[20:23], v225, s[44:47], s65 offen sc1
  buffer_load_dwordx4 v[24:27], v225, s[44:47], s66 offen sc1
  buffer_load_dwordx4 v[28:31], v225, s[44:47], s67 offen sc1
  s_waitcnt vmcnt(0)
  v_bitop3_b32 v48, v16, v17, 1 bitop3:0x80
  v_bitop3_b32 v48, v48, v18, v19 bitop3:0x80
  v_bitop3_b32 v48, v48, v20, v21 bitop3:0x80
  v_bitop3_b32 v48, v48, v22, v23 bitop3:0x80
  v_bitop3_b32 v48, v48, v24, v25 bitop3:0x80
  v_bitop3_b32 v48, v48, v26, v27 bitop3:0x80
  v_bitop3_b32 v48, v48, v28, v29 bitop3:0x80
  v_bitop3_b32 v48, v48, v30, v31 bitop3:0x80
  v_cmp_eq_u32 vcc, 0, v48
  s_nop 0
  s_cmp_eq_u64 vcc, 0
  s_cbranch_scc1 K3_yok
  s_add_u32 s75, s75, 1
  s_cmp_eq_u32 s40, 0
  s_cbranch_scc1 K3_zp_s2
  s_sub_u32 s43, s43, 1
  s_cbranch_scc1 K3_yok
  s_sleep 8
  s_branch K3_post
K3_yok:
  v_lshlrev_b32 v48, 16, v16
  v_lshlrev_b32 v49, 16, v20
  v_lshlrev_b32 v50, 16, v24
  v_lshlrev_b32 v51, 16, v28
  v_lshlrev_b32 v52, 16, v208
  v_and_b32 v53, 0xffff0000, v208
  v_lshlrev_b32 v54, 16, v209
  v_and_b32 v55, 0xffff0000, v209
  v_mul_f32 v48, v48, v52
  v_mul_f32 v49, v49, v53
  v_mul_f32 v50, v50, v54
  v_mul_f32 v51, v51, v55
  v_cvt_pk_bf16_f32 v64, v48, v49
  v_cvt_pk_bf16_f32 v65, v50, v51
  buffer_store_dwordx2 v[64:65], v224, s[32:35], s72 offen sc1
  s_add_u32 s72, s72, 262144
  v_and_b32 v56, 0xffff0000, v16
  v_and_b32 v57, 0xffff0000, v20
  v_and_b32 v58, 0xffff0000, v24
  v_and_b32 v59, 0xffff0000, v28
  v_lshlrev_b32 v60, 16, v210
  v_and_b32 v61, 0xffff0000, v210
  v_lshlrev_b32 v62, 16, v211
  v_and_b32 v63, 0xffff0000, v211
  v_mul_f32 v56, v56, v60
  v_mul_f32 v57, v57, v61
  v_mul_f32 v58, v58, v62
  v_mul_f32 v59, v59, v63
  v_cvt_pk_bf16_f32 v66, v56, v57
  v_cvt_pk_bf16_f32 v67, v58, v59
  buffer_store_dwordx2 v[66:67], v224, s[32:35], s72 offen sc1
  s_add_u32 s72, s72, 262144
  v_lshlrev_b32 v48, 16, v17
  v_lshlrev_b32 v49, 16, v21
  v_lshlrev_b32 v50, 16, v25
  v_lshlrev_b32 v51, 16, v29
  v_lshlrev_b32 v52, 16, v212
  v_and_b32 v53, 0xffff0000, v212
  v_lshlrev_b32 v54, 16, v213
  v_and_b32 v55, 0xffff0000, v213
  v_mul_f32 v48, v48, v52
  v_mul_f32 v49, v49, v53
  v_mul_f32 v50, v50, v54
  v_mul_f32 v51, v51, v55
  v_cvt_pk_bf16_f32 v68, v48, v49
  v_cvt_pk_bf16_f32 v69, v50, v51
  buffer_store_dwordx2 v[68:69], v224, s[32:35], s72 offen sc1
  s_add_u32 s72, s72, 262144
  v_and_b32 v56, 0xffff0000, v17
  v_and_b32 v57, 0xffff0000, v21
  v_and_b32 v58, 0xffff0000, v25
  v_and_b32 v59, 0xffff0000, v29
  v_lshlrev_b32 v60, 16, v214
  v_and_b32 v61, 0xffff0000, v214
  v_lshlrev_b32 v62, 16, v215
  v_and_b32 v63, 0xffff0000, v215
  v_mul_f32 v56, v56, v60
  v_mul_f32 v57, v57, v61
  v_mul_f32 v58, v58, v62
  v_mul_f32 v59, v59, v63
  v_cvt_pk_bf16_f32 v70, v56, v57
  v_cvt_pk_bf16_f32 v71, v58, v59
  buffer_store_dwordx2 v[70:71], v224, s[32:35], s72 offen sc1
  s_add_u32 s72, s72, 262144
  v_lshlrev_b32 v48, 16, v18
  v_lshlrev_b32 v49, 16, v22
  v_lshlrev_b32 v50, 16, v26
  v_lshlrev_b32 v51, 16, v30
  v_lshlrev_b32 v52, 16, v216
  v_and_b32 v53, 0xffff0000, v216
  v_lshlrev_b32 v54, 16, v217
  v_and_b32 v55, 0xffff0000, v217
  v_mul_f32 v48, v48, v52
  v_mul_f32 v49, v49, v53
  v_mul_f32 v50, v50, v54
  v_mul_f32 v51, v51, v55
  v_cvt_pk_bf16_f32 v72, v48, v49
  v_cvt_pk_bf16_f32 v73, v50, v51
  buffer_store_dwordx2 v[72:73], v224, s[32:35], s72 offen sc1
  s_add_u32 s72, s72, 262144
  v_and_b32 v56, 0xffff0000, v18
  v_and_b32 v57, 0xffff0000, v22
  v_and_b32 v58, 0xffff0000, v26
  v_and_b32 v59, 0xffff0000, v30
  v_lshlrev_b32 v60, 16, v218
  v_and_b32 v61, 0xffff0000, v218
  v_lshlrev_b32 v62, 16, v219
  v_and_b32 v63, 0xffff0000, v219
  v_mul_f32 v56, v56, v60
  v_mul_f32 v57, v57, v61
  v_mul_f32 v58, v58, v62
  v_mul_f32 v59, v59, v63
  v_cvt_pk_bf16_f32 v74, v56, v57
  v_cvt_pk_bf16_f32 v75, v58, v59
  buffer_store_dwordx2 v[74:75], v224, s[32:35], s72 offen sc1
  s_add_u32 s72, s72, 262144
  v_lshlrev_b32 v48, 16, v19
  v_lshlrev_b32 v49, 16, v23
  v_lshlrev_b32 v50, 16, v27
  v_lshlrev_b32 v51, 16, v31
  v_lshlrev_b32 v52, 16, v220
  v_and_b32 v53, 0xffff0000, v220
  v_lshlrev_b32 v54, 16, v221
  v_and_b32 v55, 0xffff0000, v221
  v_mul_f32 v48, v48, v52
  v_mul_f32 v49, v49, v53
  v_mul_f32 v50, v50, v54
  v_mul_f32 v51, v51, v55
  v_cvt_pk_bf16_f32 v76, v48, v49
  v_cvt_pk_bf16_f32 v77, v50, v51
  buffer_store_dwordx2 v[76:77], v224, s[32:35], s72 offen sc1
  s_add_u32 s72, s72, 262144
  v_and_b32 v56, 0xffff0000, v19
  v_and_b32 v57, 0xffff0000, v23
  v_and_b32 v58, 0xffff0000, v27
  v_and_b32 v59, 0xffff0000, v31
  v_lshlrev_b32 v60, 16, v222
  v_and_b32 v61, 0xffff0000, v222
  v_lshlrev_b32 v62, 16, v223
  v_and_b32 v63, 0xffff0000, v223
  v_mul_f32 v56, v56, v60
  v_mul_f32 v57, v57, v61
  v_mul_f32 v58, v58, v62
  v_mul_f32 v59, v59, v63
  v_cvt_pk_bf16_f32 v78, v56, v57
  v_cvt_pk_bf16_f32 v79, v58, v59
  buffer_store_dwordx2 v[78:79], v224, s[32:35], s72 offen sc1
  s_add_u32 s72, s72, 262144
  s_mov_b32 s41, s40
  s_mov_b32 s40, 1
  s_cmp_eq_u32 s41, 0
  s_cbranch_scc1 K3_zp
K3_fin:
K3_end:
  s_endpgm
K3_code_end:
.section .rodata,"a"
.p2align 6
.amdhsa_kernel concat_heads__ssm_conv_h3__linear_attn_block__prompt_kernel
  .amdhsa_next_free_vgpr 252
  .amdhsa_next_free_sgpr 102
  .amdhsa_accum_offset 252
  .amdhsa_group_segment_fixed_size 0
  .amdhsa_kernarg_size 96
  .amdhsa_user_sgpr_count 2
  .amdhsa_user_sgpr_kernarg_segment_ptr 1
  .amdhsa_system_sgpr_workgroup_id_x 1
.end_amdhsa_kernel
```
